```python
import torch

def _softmax(x, axis=-1):
    return torch.softmax(x, dim=axis)
def _gelu(x):
    return torch.nn.functional.gelu(x, approximate="tanh")
def _silu(x):
    return torch.nn.functional.silu(x)
def _sigmoid(x):
    return torch.sigmoid(x)
def _layernorm(x, axis=-1, eps=1e-5):
    m = x.mean(dim=axis, keepdim=True)
    v = x.var(dim=axis, keepdim=True, unbiased=False)
    return (x - m) / torch.sqrt(v + eps)
def _scatter_add(tgt, idx, src, axis=0):
    return tgt.clone().index_add_(axis, idx, src)
def _segment_sum(src, seg, n):
    out = torch.zeros((n,) + src.shape[1:], dtype=src.dtype)
    return out.index_add_(0, seg, src)
def _pad(x, pw):
    flat = tuple(v for pair in reversed(pw) for v in pair)
    return torch.nn.functional.pad(x, flat)

kernel_name = 'recurrent_scan__compressed_kv_cla__dense_activation_squared_relu__prompt'

def setup_inputs():

    _w = (lambda a: (lambda t: t.to(torch.bfloat16) if t.is_floating_point() else t)(torch.as_tensor(a)))
    def _A_setup():
        B, H, Sq, Sk, D, M = 1, 16, 2048, 2048, 256, 448
        Dc = 4 * D
        return {
            "x": _w((lambda *s: torch.randn(*s, dtype=torch.bfloat16) * 0.05)(B, Sq, M)),
            "c_kv": _w((lambda *s: torch.randn(*s, dtype=torch.bfloat16) * 0.2)(B, Sk, Dc)),
            "w_q": _w((lambda *s: torch.randn(*s, dtype=torch.bfloat16) * 3.2)(M, H, D) * (M ** -0.5)),
            "w_uk": _w((lambda *s: torch.randn(*s, dtype=torch.bfloat16) * 3.2)(Dc, H, D) * (Dc ** -0.5)),
            "w_uv": _w((lambda *s: torch.randn(*s, dtype=torch.bfloat16) * 0.2)(Dc, H, D) * (Dc ** -0.5)),
            "w_o": _w((lambda *s: torch.randn(*s, dtype=torch.bfloat16) * 0.2)(H, D, M) * ((H * D) ** -0.5)),
        }
    _A_in = _A_setup()

    def _B_setup():
        B, S, D, F = 1, 2048, 448, 1792
        return {
            "x": _w((lambda *s: torch.randn(*s, dtype=torch.bfloat16) * 0.05)(B, S, D)),
            "w1": _w((lambda *s: torch.randn(*s, dtype=torch.bfloat16) * 0.1)(D, F)),
            "b1": _w((lambda *s: torch.randn(*s, dtype=torch.bfloat16) * 0.8)(F)),
            "w2": _w((lambda *s: torch.randn(*s, dtype=torch.bfloat16) * 0.1)(F, D)),
            "b2": _w((lambda *s: torch.randn(*s, dtype=torch.bfloat16) * 6.4)(D)),
        }
    _B_in = _B_setup()

    return {
        "A_x": _A_in["x"],
        "A_c_kv": _A_in["c_kv"],
        "A_w_q": _A_in["w_q"],
        "A_w_uk": _A_in["w_uk"],
        "A_w_uv": _A_in["w_uv"],
        "A_w_o": _A_in["w_o"],
        "B_x": _B_in["x"],
        "B_w1": _B_in["w1"],
        "B_b1": _B_in["b1"],
        "B_w2": _B_in["w2"],
        "B_b2": _B_in["b2"],
    }

def reference(A_x, A_c_kv, A_w_q, A_w_uk, A_w_uv, A_w_o, B_x, B_w1, B_b1, B_w2, B_b2):
    def _A_ref(x, c_kv, w_q, w_uk, w_uv, w_o):
        B, Sq, M = x.shape[0], x.shape[1], x.shape[2]
        Sk = c_kv.shape[1]
        H, D = w_q.shape[1], w_q.shape[2]
        q = torch.einsum("bqm,mhd->bhqd", x, w_q)
        k = torch.einsum("bkc,chd->bhkd", c_kv, w_uk)
        v = torch.einsum("bkc,chd->bhkd", c_kv, w_uv)
        scores = torch.einsum("bhqd,bhkd->bhqk", q, k) * (D ** -0.5)
        off = Sk - Sq
        qi = torch.arange(Sq)[:, None]
        kj = torch.arange(Sk)[None, :]
        cmask = kj <= (qi + off)
        scores = torch.where(cmask[None, None], scores, -1e9)
        p = _softmax(scores, axis=-1)
        ctx = torch.einsum("bhqk,bhkd->bhqd", p, v)
        return torch.einsum("bhqd,hdm->bqm", ctx, w_o)

    def _B_ref(x, w1, b1, w2, b2):
        h = torch.einsum("bsd,df->bsf", x, w1) + b1
        zero = torch.zeros_like(h)
        r = torch.where(h > zero, h, zero)
        h = r * r
        out = torch.einsum("bsf,fd->bsd", h, w2) + b2
        return out

    x = A_x
    xn = _layernorm(x, axis=-1)
    s = _A_ref(xn, A_c_kv, A_w_q, A_w_uk, A_w_uv, A_w_o)
    g = _silu(_B_ref(xn, B_w1, B_b1, B_w2, B_b2))
    return x + s * g
```

```asm
; @launch kernel=kf_kernel grid=(256,1,1) block=(256,1,1) lds=163840
.amdgcn_target "amdgcn-amd-amdhsa--gfx950"
.text
.globl kf_kernel
.p2align 8
.type kf_kernel,@function
kf_kernel:
  s_cmp_ge_u32 s2, 256
  s_cbranch_scc1 L_kf_kernel_end_1
  s_load_dwordx2 s[4:5], s[0:1], 8
  s_load_dwordx4 s[28:31], s[0:1], 24
  s_load_dwordx4 s[24:27], s[0:1], 96
  s_getpc_b64 s[96:97]
L_kf_kernel_pc:
  v_lshlrev_b32 v7, 4, v0
  s_mov_b32 s98, L_text_end-L_kf_kernel_pc
  s_mov_b32 s99, 0x20000
  s_andn2_b32 s3, s2, 7
  s_lshl_b32 s3, s3, 9
  buffer_load_dword v15, v7, s[96:99], s3 offen
  v_lshrrev_b32 v16, 6, v0
  v_and_b32 v2, 63, v0
  v_readfirstlane_b32 s64, v16
  s_lshr_b32 s77, s2, 5
  s_lshl_b32 s65, s64, 12
  v_lshrrev_b32 v17, 4, v2
  s_lshl_b32 s100, s77, 7
  s_lshl_b32 s101, s64, 5
  s_add_u32 s100, s100, s101
  v_lshrrev_b32 v60, 3, v2
  v_add_u32 v18, s100, v60
  v_lshlrev_b32 v18, 11, v18
  v_and_b32 v23, 7, v2
  v_xor_b32 v20, v17, v23
  v_lshlrev_b32 v20, 4, v20
  v_add_u32 v24, v20, v18
  v_xor_b32 v20, 64, v24
  v_add_u32 v25, 15360, v20
  v_add_u32 v26, 30720, v24
  v_add_u32 v27, 46080, v20
  s_mov_b32 s6, 0x400000
  s_mov_b32 s7, 0x20000
  s_and_b32 s70, s2, 7
  s_lshl_b32 s70, s70, 8
  s_add_u32 m0, s65, 65536
  s_waitcnt lgkmcnt(0)
  buffer_load_dwordx4 v24, s[4:7], s70 offen offset:0  lds
  buffer_load_dwordx4 v25, s[4:7], s70 offen offset:1024  lds
  buffer_load_dwordx4 v26, s[4:7], s70 offen offset:2048  lds
  buffer_load_dwordx4 v27, s[4:7], s70 offen offset:3072  lds
  s_and_b32 s68, s2, 7
  s_lshl_b32 s68, s68, 1
  s_bfe_u32 s100, s2, 0x10003
  s_add_u32 s68, s68, s100
  s_bfe_u32 s76, s2, 0x10004
  v_lshlrev_b32 v1, 4, v2
  s_and_b32 s78, s64, 1
  v_lshrrev_b32 v18, 5, v2
  v_and_b32 v19, 31, v2
  s_lshl_b32 s100, s64, 16
  s_lshl_b32 s101, s68, 9
  s_add_u32 s100, s100, s101
  s_lshl_b32 s101, s78, 2
  v_add_u32 v20, s101, v18
  v_lshlrev_b32 v20, 1, v20
  v_xor_b32 v20, v20, v19
  v_lshlrev_b32 v20, 4, v20
  v_lshlrev_b32 v21, 13, v18
  v_add_u32 v20, v20, v21
  v_add_u32 v28, s100, v20
  v_xor_b32 v20, 64, v28
  v_add_u32 v29, 15360, v20
  v_add_u32 v30, 30720, v28
  v_add_u32 v31, 46080, v20
  s_mov_b32 s10, 0x800000
  s_mov_b32 s11, 0x20000
  s_or_b32 s71, s70, 0x200000
  s_lshl_b32 s73, s70, 12
  s_add_u32 s72, s73, 262144
  s_cmp_eq_u32 s76, 0
  s_cselect_b32 s8, s28, s30
  s_cselect_b32 s9, s29, s31
  s_add_u32 m0, s65, 0
  s_nop 0
  buffer_load_dwordx4 v28, s[8:11], s73 offen offset:0 nt lds
  buffer_load_dwordx4 v29, s[8:11], s73 offen offset:1024 nt lds
  buffer_load_dwordx4 v30, s[8:11], s73 offen offset:2048 nt lds
  buffer_load_dwordx4 v31, s[8:11], s73 offen offset:3072 nt lds
  s_load_dwordx2 s[16:17], s[0:1], 0
  s_load_dwordx2 s[20:21], s[0:1], 16
  s_load_dwordx2 s[60:61], s[0:1], 40
  s_load_dwordx4 s[56:59], s[0:1], 56
  s_load_dwordx2 s[54:55], s[0:1], 72
  s_load_dwordx4 s[48:51], s[0:1], 80
  s_add_u32 m0, s65, 16384
  s_nop 0
  buffer_load_dwordx4 v28, s[8:11], s72 offen offset:0 nt lds
  buffer_load_dwordx4 v29, s[8:11], s72 offen offset:1024 nt lds
  buffer_load_dwordx4 v30, s[8:11], s72 offen offset:2048 nt lds
  buffer_load_dwordx4 v31, s[8:11], s72 offen offset:3072 nt lds
  s_add_u32 s72, s72, 262144
  s_and_b32 s72, s72, 0x7fffff
  s_add_u32 m0, s65, 32768
  s_nop 0
  buffer_load_dwordx4 v28, s[8:11], s72 offen offset:0 nt lds
  buffer_load_dwordx4 v29, s[8:11], s72 offen offset:1024 nt lds
  buffer_load_dwordx4 v30, s[8:11], s72 offen offset:2048 nt lds
  buffer_load_dwordx4 v31, s[8:11], s72 offen offset:3072 nt lds
  s_add_u32 s72, s72, 262144
  s_and_b32 s72, s72, 0x7fffff
  s_add_u32 s70, s70, 128
  s_and_b32 s70, s70, 0x7ff
  s_lshl_b32 s69, s2, 2
  s_add_u32 s69, s69, s64
  s_mul_i32 s101, s69, 1792
  v_mov_b32 v18, 0x7fffff00
  v_cmp_gt_u32 vcc, 56, v2
  s_nop 1
  v_cndmask_b32 v18, v18, v1, vcc
  s_mov_b32 s14, 134217728
  s_mov_b32 s15, 0x20000
  s_mov_b32 s18, 1835008
  s_mov_b32 s19, 0x20000
  s_waitcnt lgkmcnt(0)
  s_add_u32 s32, s96, kf_kernel_tab-L_kf_kernel_pc
  s_addc_u32 s33, s97, 0
  s_lshl_b32 s34, s2, 4
  s_add_u32 s32, s32, s34
  s_addc_u32 s33, s33, 0
  s_load_dwordx4 s[32:35], s[32:33], 0
  v_lshlrev_b32 v7, 7, v0
  buffer_load_dwordx4 v[96:99], v18, s[16:19], s101 offen
  buffer_load_dwordx4 v[100:103], v18, s[16:19], s101 offen offset:896
  s_mov_b32 s12, s26
  s_mov_b32 s13, s27
  s_mov_b32 s26, 256
  s_mov_b32 s27, 0x20000
  s_mov_b32 s28, s58
  s_mov_b32 s29, s59
  s_mov_b32 s30, 3584
  s_mov_b32 s31, 0x20000
  s_mov_b32 s22, 3670016
  s_mov_b32 s23, 0x20000
  s_mov_b32 s74, s16
  s_mov_b32 s3, s17
  s_mov_b32 s58, s50
  s_mov_b32 s59, s51
  v_and_b32 v18, 15, v2
  s_lshr_b32 s101, s64, 1
  s_lshl_b32 s101, s101, 13
  s_add_u32 s101, s101, 0x10000
  v_lshlrev_b32 v19, 7, v18
  v_add_u32 v19, s101, v19
  v_lshrrev_b32 v20, 1, v18
  v_xor_b32 v21, v17, v20
  v_lshlrev_b32 v21, 4, v21
  v_add_u32 v32, v21, v19
  v_xor_b32 v33, 64, v32
  v_lshrrev_b32 v20, 2, v18
  v_lshlrev_b32 v19, 3, v17
  v_add_u32 v19, v19, v20
  v_lshlrev_b32 v19, 9, v19
  v_and_b32 v21, 3, v18
  v_lshlrev_b32 v21, 3, v21
  v_add_u32 v19, v19, v21
  s_lshl_b32 s101, s78, 8
  v_add_u32 v19, s101, v19
  v_and_b32 v22, 1, v17
  v_lshlrev_b32 v22, 2, v22
  v_add_u32 v22, v20, v22
  v_lshlrev_b32 v22, 5, v22
  v_add_u32 v34, v22, v19
  v_xor_b32 v35, 32, v34
  v_xor_b32 v36, 64, v34
  v_xor_b32 v37, 96, v34
  v_xor_b32 v38, 128, v34
  v_xor_b32 v39, 160, v34
  v_xor_b32 v40, 192, v34
  v_xor_b32 v41, 224, v34
  v_lshlrev_b32 v19, 1, v17
  v_xor_b32 v19, v19, v23
  v_lshlrev_b32 v61, 4, v19
  v_lshlrev_b32 v42, 13, v60
  v_add_u32 v42, v42, v61
  s_add_u32 s1, s65, 131072
  v_lshrrev_b32 v19, 2, v2
  v_lshlrev_b32 v19, 7, v19
  v_and_b32 v22, 3, v60
  v_lshlrev_b32 v22, 5, v22
  v_add3_u32 v43, v19, v22, v21
  v_add_u32 v43, s1, v43
  v_mov_b32 v22, 0xffff
  v_mov_b32 v23, 0
  v_cmp_eq_u32 s[52:53], v20, v17
  v_lshlrev_b32 v21, 1, v21
  s_nop 0
  v_cndmask_b32 v22, 0, v22, s[52:53]
  v_lshlrev_b64 v[62:63], v21, v[22:23]
  s_mov_b32 s52, s48
  s_mov_b32 s53, s49
  v_add_u32 v3, s65, v1
  v_add_u32 v4, 0x4000, v3
  v_add_u32 v6, 131072, v1
  v_lshlrev_b32 v9, 3, v17
  v_mul_u32_u24 v8, 896, v18
  v_add_u32 v8, v8, v9
  v_lshlrev_b32 v13, 2, v2
  s_lshl_b32 s101, s68, 4
  s_lshr_b32 s100, s2, 4
  s_add_u32 s101, s101, s100
  s_lshl_b32 s18, s101, 9
  s_add_u32 s18, s18, 38535168
  v_min_u32 v0, 1, v2
  v_lshlrev_b32 v0, 28, v0
  s_cmp_eq_u32 s64, 0
  s_cselect_b32 s18, s18, 2147418112
  s_cselect_b32 s62, 0, 2147418112
  s_cselect_b32 s16, -1, 0
  s_and_b32 s100, s101, 3
  s_lshl_b32 s100, s100, 3
  s_getreg_b32 s96, hwreg(HW_REG_XCC_ID, 0, 4)
  s_add_u32 s96, s96, 1
  s_lshl_b32 s100, s96, s100
  s_and_b32 s101, s101, 0xfc
  v_mov_b32 v11, s100
  v_add_u32 v10, s101, v0
  v_lshlrev_b32 v14, 28, v17
  v_lshlrev_b32 v12, 9, v18
  v_add_u32 v14, v14, v12
  s_and_b32 s66, s69, 63
  s_lshr_b32 s67, s69, 6
  s_lshr_b32 s45, s66, 1
  s_mul_i32 s45, s45, 114688
  s_and_b32 s100, s66, 1
  s_mul_i32 s100, s100, 28672
  s_add_u32 s45, s45, s100
  s_lshl_b32 s100, s67, 10
  s_add_u32 s45, s45, s100
  s_cmp_ge_u32 s67, 7
  s_cselect_b32 s100, 50176, 0
  s_add_u32 s45, s45, s100
  s_add_u32 s45, s45, 38797312
  s_lshl_b32 s36, s67, 18
  s_lshl_b32 s100, s66, 7
  s_add_u32 s36, s36, s100
  s_cmp_ge_u32 s67, 14
  s_cselect_b32 s45, 2147418112, s45
  s_mov_b32 s49, 7168
  s_mov_b32 s50, 8192
  s_mov_b32 s37, 65536
  s_lshl_b32 s101, s64, 5
  s_add_u32 s101, s101, 147456
  v_lshrrev_b32 v80, 2, v2
  v_mul_u32_u24 v80, 544, v80
  v_and_b32 v81, 1, v2
  v_mul_u32_u24 v81, 272, v81
  v_and_b32 v82, 2, v2
  v_lshlrev_b32 v82, 2, v82
  v_add3_u32 v80, v80, v81, v82
  v_add_u32 v80, s101, v80
  s_mul_i32 s101, s64, 2176
  s_add_u32 s101, s101, 147456
  v_and_b32 v81, 48, v2
  v_add3_u32 v81, s101, v1, v81
  v_lshlrev_b32 v82, 7, v60
  v_add_u32 v82, v82, v1
  v_lshrrev_b32 v83, 5, v2
  v_mul_u32_u24 v83, 130560, v83
  v_add_u32 v83, v83, v1
  v_mov_b32 v84, 0
  v_mov_b32 v85, 0
  v_mov_b32 v86, 0
  v_mov_b32 v87, 0
  s_lshr_b32 s19, s2, 1
  s_mul_i32 s19, s19, 14336
  s_and_b32 s101, s2, 1
  s_lshl_b32 s101, s101, 7
  s_add_u32 s19, s19, s101
  s_add_u32 s19, s19, s65
  s_add_u32 s19, s19, 35651584
  s_cmp_eq_u32 s64, 3
  s_cselect_b32 s79, 2147418112, s19
  s_and_b32 s66, s69, 7
  s_lshr_b32 s67, s69, 3
  s_mul_i32 s63, s67, 28672
  s_lshl_b32 s100, s66, 7
  s_add_u32 s63, s63, s100
  s_lshr_b32 s46, s67, 3
  s_mul_i32 s46, s46, 229376
  s_lshl_b32 s100, s66, 15
  s_add_u32 s46, s46, s100
  s_and_b32 s100, s67, 7
  s_lshl_b32 s100, s100, 10
  s_add_u32 s46, s46, s100
  s_add_u32 s46, s46, 45088768
  s_cmp_eq_u32 s66, 7
  s_cselect_b32 s46, 2147418112, s46
  s_cselect_b32 s63, 2147418112, s63
  s_and_b32 s66, s69, 31
  s_lshr_b32 s67, s69, 5
  s_lshr_b32 s47, s66, 1
  s_mul_i32 s47, s47, 114688
  s_and_b32 s100, s66, 1
  s_mul_i32 s100, s100, 28672
  s_add_u32 s47, s47, s100
  s_lshl_b32 s100, s67, 10
  s_add_u32 s47, s47, s100
  s_cmp_ge_u32 s67, 7
  s_cselect_b32 s100, 50176, 0
  s_add_u32 s47, s47, s100
  s_add_u32 s47, s47, 42467328
  s_mul_i32 s43, s67, 114688
  s_lshl_b32 s100, s66, 7
  s_add_u32 s43, s43, s100
  s_cmp_ge_u32 s66, 28
  s_cselect_b32 s67, 14, s67
  s_cmp_ge_u32 s67, 14
  s_cselect_b32 s47, 2147418112, s47
  s_cselect_b32 s43, 2147418112, s43
  s_sub_u32 s66, s63, 1835008
  s_add_u32 s67, s46, 1835008
  s_mov_b32 s0, 3584
  s_mov_b32 s42, 1605632
  s_cmp_ge_u32 s69, 960
  s_cselect_b32 s67, 2147418112, s67
  s_cmp_ge_u32 s69, 512
  s_cselect_b32 s43, s66, s43
  s_cselect_b32 s47, s67, s47
  s_cselect_b32 s0, 896, s0
  s_cselect_b32 s39, s54, s56
  s_cselect_b32 s40, s55, s57
  s_cselect_b32 s51, s50, s49
  s_cselect_b32 s55, 0, 32
  s_mov_b32 s44, 2147418112
  s_mov_b32 s48, 0
  s_mov_b32 s38, 896
  s_mov_b32 s41, s22
  s_lshr_b32 s54, s69, 1
  s_and_b32 s55, s55, s54
  s_and_b32 s54, s54, 32
  s_or_b32 s54, s54, 16384
  s_or_b32 s55, s55, 16384
  s_mul_i32 s101, s68, 2162688
  s_lshl_b32 s100, s77, 17
  s_add_u32 s101, s101, s100
  s_lshr_b32 s100, s64, 1
  s_lshl_b32 s100, s100, 16
  s_add_u32 s101, s101, s100
  s_add_u32 s100, s76, 12
  s_lshl_b32 s100, s78, s100
  s_add_u32 s101, s101, s100
  s_lshl_b32 s100, s76, 14
  s_add_u32 s99, s101, s100
  s_lshr_b32 s100, 8192, s76
  s_add_u32 s100, s99, s100
  s_add_u32 m0, s65, 81920
  s_nop 0
  buffer_load_dwordx4 v24, s[4:7], s71 offen offset:0  lds
  buffer_load_dwordx4 v25, s[4:7], s71 offen offset:1024  lds
  buffer_load_dwordx4 v26, s[4:7], s71 offen offset:2048  lds
  buffer_load_dwordx4 v27, s[4:7], s71 offen offset:3072  lds
  s_add_u32 m0, s65, 49152
  s_nop 0
  buffer_load_dwordx4 v28, s[8:11], s72 offen offset:0 nt lds
  buffer_load_dwordx4 v29, s[8:11], s72 offen offset:1024 nt lds
  buffer_load_dwordx4 v30, s[8:11], s72 offen offset:2048 nt lds
  buffer_load_dwordx4 v31, s[8:11], s72 offen offset:3072 nt lds
  s_add_u32 m0, s65, 98304
  s_nop 0
  buffer_load_dwordx4 v24, s[4:7], s70 offen offset:0  lds
  buffer_load_dwordx4 v25, s[4:7], s70 offen offset:1024  lds
  buffer_load_dwordx4 v26, s[4:7], s70 offen offset:2048  lds
  buffer_load_dwordx4 v27, s[4:7], s70 offen offset:3072  lds
  s_add_u32 s72, s72, 262144
  s_and_b32 s72, s72, 0x7fffff
  s_add_u32 s71, s71, 128
  s_and_b32 s71, s71, 0x2007ff
  s_waitcnt vmcnt(14) lgkmcnt(0)
  s_barrier
  ds_read_b128 v[44:47], v32
  ds_read_b128 v[48:51], v33
  ds_read_b64_tr_b16 a[128:129], v34 offset:0
  ds_read_b64_tr_b16 a[130:131], v34 offset:2048
  ds_read_b64_tr_b16 a[132:133], v34 offset:16384
  ds_read_b64_tr_b16 a[134:135], v34 offset:18432
  ds_read_b64_tr_b16 a[136:137], v35 offset:0
  ds_read_b64_tr_b16 a[138:139], v35 offset:2048
  ds_read_b64_tr_b16 a[140:141], v35 offset:16384
  ds_read_b64_tr_b16 a[142:143], v35 offset:18432
  ds_read_b64_tr_b16 a[144:145], v36 offset:0
  ds_read_b64_tr_b16 a[146:147], v36 offset:2048
  ds_read_b64_tr_b16 a[148:149], v36 offset:16384
  ds_read_b64_tr_b16 a[150:151], v36 offset:18432
  ds_read_b64_tr_b16 a[152:153], v37 offset:0
  ds_read_b64_tr_b16 a[154:155], v37 offset:2048
  ds_read_b64_tr_b16 a[156:157], v37 offset:16384
  ds_read_b64_tr_b16 a[158:159], v37 offset:18432
  ds_read_b64_tr_b16 a[160:161], v38 offset:0
  ds_read_b64_tr_b16 a[162:163], v38 offset:2048
  ds_read_b64_tr_b16 a[164:165], v38 offset:16384
  ds_read_b64_tr_b16 a[166:167], v38 offset:18432
  ds_read_b64_tr_b16 a[168:169], v39 offset:0
  ds_read_b64_tr_b16 a[170:171], v39 offset:2048
  ds_read_b64_tr_b16 a[172:173], v39 offset:16384
  ds_read_b64_tr_b16 a[174:175], v39 offset:18432
  ds_read_b64_tr_b16 a[176:177], v40 offset:0
  ds_read_b64_tr_b16 a[178:179], v40 offset:2048
  ds_read_b64_tr_b16 a[180:181], v40 offset:16384
  ds_read_b64_tr_b16 a[182:183], v40 offset:18432
  ds_read_b64_tr_b16 a[184:185], v41 offset:0
  ds_read_b64_tr_b16 a[186:187], v41 offset:2048
  ds_read_b64_tr_b16 a[188:189], v41 offset:16384
  ds_read_b64_tr_b16 a[190:191], v41 offset:18432
  s_cmp_eq_u32 s76, 1
  s_cbranch_scc1 L_kf_kernel_kindV_3
  s_waitcnt lgkmcnt(15)
  v_mfma_f32_16x16x32_bf16 a[0:3], a[128:131], v[44:47], 0
  s_mov_b32 s76, 0x3db8aa3b
  v_mfma_f32_16x16x32_bf16 a[0:3], a[132:135], v[48:51], a[0:3]
  s_mov_b32 s75, 0x4e800000
  ds_read_b128 v[52:55], v32 offset:2048
  v_mfma_f32_16x16x32_bf16 a[4:7], a[136:139], v[44:47], 0
  s_mov_b32 s73, 6
  v_mfma_f32_16x16x32_bf16 a[4:7], a[140:143], v[48:51], a[4:7]
  ds_read_b128 v[56:59], v33 offset:2048
  v_mfma_f32_16x16x32_bf16 a[8:11], a[144:147], v[44:47], 0
  s_waitcnt lgkmcnt(0)
  v_mfma_f32_16x16x32_bf16 a[8:11], a[148:151], v[48:51], a[8:11]
  s_barrier
  ds_read_b64_tr_b16 a[192:193], v34 offset:32768
  v_mfma_f32_16x16x32_bf16 a[12:15], a[152:155], v[44:47], 0
  s_add_u32 m0, s65, 0
  v_mfma_f32_16x16x32_bf16 a[12:15], a[156:159], v[48:51], a[12:15]
  ds_read_b64_tr_b16 a[194:195], v34 offset:34816
  v_mfma_f32_16x16x32_bf16 a[16:19], a[160:163], v[44:47], 0
  buffer_load_dwordx4 v28, s[8:11], s72 offen offset:0 nt lds
  v_mfma_f32_16x16x32_bf16 a[16:19], a[164:167], v[48:51], a[16:19]
  ds_read_b64_tr_b16 a[200:201], v35 offset:32768
  s_waitcnt vmcnt(14)
  v_lshlrev_b32 v104, 16, v96
  v_mfma_f32_16x16x32_bf16 a[20:23], a[168:171], v[44:47], 0
  buffer_load_dwordx4 v29, s[8:11], s72 offen offset:1024 nt lds
  v_mfma_f32_16x16x32_bf16 a[20:23], a[172:175], v[48:51], a[20:23]
  ds_read_b64_tr_b16 a[202:203], v35 offset:34816
  v_and_b32 v105, 0xffff0000, v96
  v_mfma_f32_16x16x32_bf16 a[24:27], a[176:179], v[44:47], 0
  buffer_load_dwordx4 v30, s[8:11], s72 offen offset:2048 nt lds
  v_mfma_f32_16x16x32_bf16 a[24:27], a[180:183], v[48:51], a[24:27]
  ds_read_b64_tr_b16 a[208:209], v36 offset:32768
  v_lshlrev_b32 v106, 16, v97
  v_mfma_f32_16x16x32_bf16 a[28:31], a[184:187], v[44:47], 0
  buffer_load_dwordx4 v31, s[8:11], s72 offen offset:3072 nt lds
  v_mfma_f32_16x16x32_bf16 a[28:31], a[188:191], v[48:51], a[28:31]
  ds_read_b64_tr_b16 a[210:211], v36 offset:34816
  s_add_u32 s72, s72, 262144
  v_mfma_f32_16x16x32_bf16 a[32:35], a[128:131], v[52:55], 0
  s_and_b32 s72, s72, 0x7fffff
  v_and_b32 v107, 0xffff0000, v97
  v_lshlrev_b32 v108, 16, v98
  v_mfma_f32_16x16x32_bf16 a[32:35], a[132:135], v[56:59], a[32:35]
  s_add_u32 m0, s65, 114688
  ds_read_b128 v[44:47], v32 offset:4096
  v_and_b32 v109, 0xffff0000, v98
  v_mfma_f32_16x16x32_bf16 a[36:39], a[136:139], v[52:55], 0
  v_lshlrev_b32 v110, 16, v99
  v_and_b32 v111, 0xffff0000, v99
  v_mfma_f32_16x16x32_bf16 a[36:39], a[140:143], v[56:59], a[36:39]
  ds_read_b128 v[48:51], v33 offset:4096
  s_waitcnt vmcnt(16)
  v_lshlrev_b32 v112, 16, v100
  v_mfma_f32_16x16x32_bf16 a[40:43], a[144:147], v[52:55], 0
  buffer_load_dwordx4 v24, s[4:7], s71 offen offset:0  lds
  v_mfma_f32_16x16x32_bf16 a[40:43], a[148:151], v[56:59], a[40:43]
  ds_read_b64_tr_b16 a[216:217], v37 offset:32768
  v_and_b32 v113, 0xffff0000, v100
  v_mfma_f32_16x16x32_bf16 a[44:47], a[152:155], v[52:55], 0
  buffer_load_dwordx4 v25, s[4:7], s71 offen offset:1024  lds
  v_mfma_f32_16x16x32_bf16 a[44:47], a[156:159], v[56:59], a[44:47]
  ds_read_b64_tr_b16 a[218:219], v37 offset:34816
  v_lshlrev_b32 v114, 16, v101
  v_mfma_f32_16x16x32_bf16 a[48:51], a[160:163], v[52:55], 0
  buffer_load_dwordx4 v26, s[4:7], s71 offen offset:2048  lds
  v_mfma_f32_16x16x32_bf16 a[48:51], a[164:167], v[56:59], a[48:51]
  ds_read_b64_tr_b16 a[224:225], v38 offset:32768
  v_and_b32 v115, 0xffff0000, v101
  v_mfma_f32_16x16x32_bf16 a[52:55], a[168:171], v[52:55], 0
  buffer_load_dwordx4 v27, s[4:7], s71 offen offset:3072  lds
  v_mfma_f32_16x16x32_bf16 a[52:55], a[172:175], v[56:59], a[52:55]
  ds_read_b64_tr_b16 a[226:227], v38 offset:34816
  s_add_u32 m0, s65, 16384
  v_mfma_f32_16x16x32_bf16 a[56:59], a[176:179], v[52:55], 0
  v_lshlrev_b32 v116, 16, v102
  v_and_b32 v117, 0xffff0000, v102
  v_mfma_f32_16x16x32_bf16 a[56:59], a[180:183], v[56:59], a[56:59]
  ds_read_b64_tr_b16 a[232:233], v39 offset:32768
  v_lshlrev_b32 v118, 16, v103
  v_mfma_f32_16x16x32_bf16 a[60:63], a[184:187], v[52:55], 0
  ds_read_b64_tr_b16 a[234:235], v39 offset:34816
  v_and_b32 v119, 0xffff0000, v103
  v_mfma_f32_16x16x32_bf16 a[60:63], a[188:191], v[56:59], a[60:63]
  s_waitcnt lgkmcnt(6)
  ds_read_b64_tr_b16 a[240:241], v40 offset:32768
  buffer_load_dwordx4 v28, s[8:11], s72 offen offset:0 nt lds
  v_mfma_f32_16x16x32_bf16 a[64:67], a[128:131], v[44:47], 0
  buffer_load_dwordx4 v29, s[8:11], s72 offen offset:1024 nt lds
  v_mfma_f32_16x16x32_bf16 a[64:67], a[132:135], v[48:51], a[64:67]
  ds_read_b128 v[52:55], v32 offset:6144
  v_add_f32 v120, v104, v105
  v_mfma_f32_16x16x32_bf16 a[68:71], a[136:139], v[44:47], 0
  buffer_load_dwordx4 v30, s[8:11], s72 offen offset:2048 nt lds
  v_mfma_f32_16x16x32_bf16 a[68:71], a[140:143], v[48:51], a[68:71]
  ds_read_b128 v[56:59], v33 offset:6144
  v_add_f32 v120, v120, v106
  v_mfma_f32_16x16x32_bf16 a[72:75], a[144:147], v[44:47], 0
  ds_read_b64_tr_b16 a[242:243], v40 offset:34816
  v_add_f32 v120, v120, v107
  v_mfma_f32_16x16x32_bf16 a[72:75], a[148:151], v[48:51], a[72:75]
  ds_read_b64_tr_b16 a[248:249], v41 offset:32768
  buffer_load_dwordx4 v31, s[8:11], s72 offen offset:3072 nt lds
  v_mfma_f32_16x16x32_bf16 a[76:79], a[152:155], v[44:47], 0
  s_add_u32 s72, s72, 262144
  s_and_b32 s72, s72, 0x7fffff
  v_add_f32 v120, v120, v108
  v_mfma_f32_16x16x32_bf16 a[76:79], a[156:159], v[48:51], a[76:79]
  ds_read_b64_tr_b16 a[250:251], v41 offset:34816
  s_add_u32 s70, s70, 128
  v_mfma_f32_16x16x32_bf16 a[80:83], a[160:163], v[44:47], 0
  s_and_b32 s70, s70, 0x7ff
  v_add_f32 v120, v120, v109
  v_add_f32 v120, v120, v110
  v_mfma_f32_16x16x32_bf16 a[80:83], a[164:167], v[48:51], a[80:83]
  s_add_u32 s71, s71, 128
  s_and_b32 s71, s71, 0x2007ff
  v_add_f32 v120, v120, v111
  v_mfma_f32_16x16x32_bf16 a[84:87], a[168:171], v[44:47], 0
  v_add_f32 v121, v112, v113
  v_add_f32 v121, v121, v114
  v_mfma_f32_16x16x32_bf16 a[84:87], a[172:175], v[48:51], a[84:87]
  v_add_f32 v121, v121, v115
  v_add_f32 v121, v121, v116
  v_mfma_f32_16x16x32_bf16 a[88:91], a[176:179], v[44:47], 0
  s_add_u32 m0, s1, 0
  v_add_f32 v121, v121, v117
  v_add_f32 v121, v121, v118
  v_mfma_f32_16x16x32_bf16 a[88:91], a[180:183], v[48:51], a[88:91]
  buffer_load_dwordx4 v42, s[20:23], s36 offen nt lds
  v_mfma_f32_16x16x32_bf16 a[92:95], a[184:187], v[44:47], 0
  s_waitcnt vmcnt(17) lgkmcnt(0)
  v_add_f32 v121, v121, v119
  v_add_f32_dpp v120, v120, v120 row_shr:1 row_mask:0xf bank_mask:0xf bound_ctrl:0
  v_mfma_f32_16x16x32_bf16 a[92:95], a[188:191], v[48:51], a[92:95]
  s_barrier
  v_add_f32_dpp v121, v121, v121 row_shr:1 row_mask:0xf bank_mask:0xf bound_ctrl:0
  v_add_f32_dpp v120, v120, v120 row_shr:2 row_mask:0xf bank_mask:0xf bound_ctrl:0
  v_mfma_f32_16x16x32_bf16 a[96:99], a[128:131], v[52:55], 0
  s_add_u32 m0, s65, 65536
  v_add_f32_dpp v121, v121, v121 row_shr:2 row_mask:0xf bank_mask:0xf bound_ctrl:0
  v_add_f32_dpp v120, v120, v120 row_shr:4 row_mask:0xf bank_mask:0xf bound_ctrl:0
  v_mfma_f32_16x16x32_bf16 a[96:99], a[132:135], v[56:59], a[96:99]
  ds_read_b128 v[44:47], v32 offset:16384
  v_add_f32_dpp v121, v121, v121 row_shr:4 row_mask:0xf bank_mask:0xf bound_ctrl:0
  v_mfma_f32_16x16x32_bf16 a[100:103], a[136:139], v[52:55], 0
  buffer_load_dwordx4 v24, s[4:7], s70 offen offset:0  lds
  v_mfma_f32_16x16x32_bf16 a[100:103], a[140:143], v[56:59], a[100:103]
  ds_read_b128 v[48:51], v33 offset:16384
  v_add_f32_dpp v120, v120, v120 row_shr:8 row_mask:0xf bank_mask:0xf bound_ctrl:0
  v_mfma_f32_16x16x32_bf16 a[104:107], a[144:147], v[52:55], 0
  s_add_u32 s36, s36, s37
  v_add_f32_dpp v121, v121, v121 row_shr:8 row_mask:0xf bank_mask:0xf bound_ctrl:0
  v_add_f32_dpp v120, v120, v120 row_bcast:15 row_mask:0xa bank_mask:0xf
  v_mfma_f32_16x16x32_bf16 a[104:107], a[148:151], v[56:59], a[104:107]
  v_add_f32_dpp v121, v121, v121 row_bcast:15 row_mask:0xa bank_mask:0xf
  v_add_f32_dpp v120, v120, v120 row_bcast:31 row_mask:0xc bank_mask:0xf
  v_mfma_f32_16x16x32_bf16 a[108:111], a[152:155], v[52:55], 0
  v_add_f32_dpp v121, v121, v121 row_bcast:31 row_mask:0xc bank_mask:0xf
  v_mov_b32 v122, 0x3b124925
  v_mfma_f32_16x16x32_bf16 a[108:111], a[156:159], v[56:59], a[108:111]
  v_readlane_b32 s96, v120, 63
  v_readlane_b32 s97, v121, 63
  v_mfma_f32_16x16x32_bf16 a[112:115], a[160:163], v[52:55], 0
  v_mul_f32 v120, s96, v122
  v_mul_f32 v121, s97, v122
  v_mfma_f32_16x16x32_bf16 a[112:115], a[164:167], v[56:59], a[112:115]
  v_sub_f32 v126, v104, v120
  v_mul_f32 v124, v126, v126
  v_mfma_f32_16x16x32_bf16 a[116:119], a[168:171], v[52:55], 0
  buffer_load_dwordx4 v25, s[4:7], s70 offen offset:1024  lds
  v_mfma_f32_16x16x32_bf16 a[116:119], a[172:175], v[56:59], a[116:119]
  v_sub_f32 v126, v105, v120
  v_fmac_f32 v124, v126, v126
  v_mfma_f32_16x16x32_bf16 a[120:123], a[176:179], v[52:55], 0
  v_sub_f32 v126, v106, v120
  v_fmac_f32 v124, v126, v126
  v_mfma_f32_16x16x32_bf16 a[120:123], a[180:183], v[56:59], a[120:123]
  v_sub_f32 v126, v107, v120
  v_fmac_f32 v124, v126, v126
  v_mfma_f32_16x16x32_bf16 a[124:127], a[184:187], v[52:55], 0
  v_sub_f32 v126, v108, v120
  v_fmac_f32 v124, v126, v126
  v_mfma_f32_16x16x32_bf16 a[124:127], a[188:191], v[56:59], a[124:127]
  s_waitcnt lgkmcnt(0)
  v_sub_f32 v126, v109, v120
  v_fmac_f32 v124, v126, v126
  v_mfma_f32_16x16x32_bf16 v[128:131], a[128:131], v[44:47], 0
  v_sub_f32 v126, v110, v120
  v_fmac_f32 v124, v126, v126
  v_mfma_f32_16x16x32_bf16 v[128:131], a[132:135], v[48:51], v[128:131]
  ds_read_b128 v[52:55], v32 offset:18432
  v_sub_f32 v126, v111, v120
  v_mfma_f32_16x16x32_bf16 v[132:135], a[136:139], v[44:47], 0
  buffer_load_dwordx4 v26, s[4:7], s70 offen offset:2048  lds
  v_mfma_f32_16x16x32_bf16 v[132:135], a[140:143], v[48:51], v[132:135]
  ds_read_b128 v[56:59], v33 offset:18432
  v_fmac_f32 v124, v126, v126
  v_mfma_f32_16x16x32_bf16 v[136:139], a[144:147], v[44:47], 0
  v_cndmask_b32 v124, 0, v124, vcc
  v_sub_f32 v126, v112, v121
  v_mfma_f32_16x16x32_bf16 v[136:139], a[148:151], v[48:51], v[136:139]
  ds_read_b64_tr_b16 a[196:197], v34 offset:49152
  v_mul_f32 v125, v126, v126
  v_mfma_f32_16x16x32_bf16 v[140:143], a[152:155], v[44:47], 0
  v_sub_f32 v126, v113, v121
  v_fmac_f32 v125, v126, v126
  v_mfma_f32_16x16x32_bf16 v[140:143], a[156:159], v[48:51], v[140:143]
  ds_read_b64_tr_b16 a[198:199], v34 offset:51200
  v_sub_f32 v126, v114, v121
  v_mfma_f32_16x16x32_bf16 v[144:147], a[160:163], v[44:47], 0
  v_fmac_f32 v125, v126, v126
  v_sub_f32 v126, v115, v121
  v_mfma_f32_16x16x32_bf16 v[144:147], a[164:167], v[48:51], v[144:147]
  ds_read_b64_tr_b16 a[204:205], v35 offset:49152
  v_fmac_f32 v125, v126, v126
  v_mfma_f32_16x16x32_bf16 v[148:151], a[168:171], v[44:47], 0
  buffer_load_dwordx4 v27, s[4:7], s70 offen offset:3072  lds
  v_mfma_f32_16x16x32_bf16 v[148:151], a[172:175], v[48:51], v[148:151]
  ds_read_b64_tr_b16 a[206:207], v35 offset:51200
  v_sub_f32 v126, v116, v121
  v_mfma_f32_16x16x32_bf16 v[152:155], a[176:179], v[44:47], 0
  v_fmac_f32 v125, v126, v126
  v_sub_f32 v126, v117, v121
  v_mfma_f32_16x16x32_bf16 v[152:155], a[180:183], v[48:51], v[152:155]
  ds_read_b64_tr_b16 a[212:213], v36 offset:49152
  v_fmac_f32 v125, v126, v126
  v_mfma_f32_16x16x32_bf16 v[156:159], a[184:187], v[44:47], 0
  v_sub_f32 v126, v118, v121
  v_fmac_f32 v125, v126, v126
  v_mfma_f32_16x16x32_bf16 v[156:159], a[188:191], v[48:51], v[156:159]
  s_waitcnt lgkmcnt(5)
  ds_read_b64_tr_b16 a[214:215], v36 offset:51200
  v_sub_f32 v126, v119, v121
  v_mfma_f32_16x16x32_bf16 v[160:163], a[128:131], v[52:55], 0
  s_add_u32 m0, s65, 32768
  v_fmac_f32 v125, v126, v126
  v_cndmask_b32 v125, 0, v125, vcc
  v_mfma_f32_16x16x32_bf16 v[160:163], a[132:135], v[56:59], v[160:163]
  ds_read_b128 v[44:47], v32 offset:20480
  v_add_f32_dpp v124, v124, v124 row_shr:1 row_mask:0xf bank_mask:0xf bound_ctrl:0
  v_mfma_f32_16x16x32_bf16 v[164:167], a[136:139], v[52:55], 0
  buffer_load_dwordx4 v28, s[8:11], s72 offen offset:0 nt lds
  v_mfma_f32_16x16x32_bf16 v[164:167], a[140:143], v[56:59], v[164:167]
  ds_read_b128 v[48:51], v33 offset:20480
  v_add_f32_dpp v125, v125, v125 row_shr:1 row_mask:0xf bank_mask:0xf bound_ctrl:0
  v_mfma_f32_16x16x32_bf16 v[168:171], a[144:147], v[52:55], 0
  v_add_f32_dpp v124, v124, v124 row_shr:2 row_mask:0xf bank_mask:0xf bound_ctrl:0
  v_add_f32_dpp v125, v125, v125 row_shr:2 row_mask:0xf bank_mask:0xf bound_ctrl:0
  v_mfma_f32_16x16x32_bf16 v[168:171], a[148:151], v[56:59], v[168:171]
  ds_read_b64_tr_b16 a[220:221], v37 offset:49152
  v_add_f32_dpp v124, v124, v124 row_shr:4 row_mask:0xf bank_mask:0xf bound_ctrl:0
  v_mfma_f32_16x16x32_bf16 v[172:175], a[152:155], v[52:55], 0
  v_add_f32_dpp v125, v125, v125 row_shr:4 row_mask:0xf bank_mask:0xf bound_ctrl:0
  v_add_f32_dpp v124, v124, v124 row_shr:8 row_mask:0xf bank_mask:0xf bound_ctrl:0
  v_mfma_f32_16x16x32_bf16 v[172:175], a[156:159], v[56:59], v[172:175]
  ds_read_b64_tr_b16 a[222:223], v37 offset:51200
  v_add_f32_dpp v125, v125, v125 row_shr:8 row_mask:0xf bank_mask:0xf bound_ctrl:0
  v_mfma_f32_16x16x32_bf16 v[176:179], a[160:163], v[52:55], 0
  v_add_f32_dpp v124, v124, v124 row_bcast:15 row_mask:0xa bank_mask:0xf
  v_add_f32_dpp v125, v125, v125 row_bcast:15 row_mask:0xa bank_mask:0xf
  v_mfma_f32_16x16x32_bf16 v[176:179], a[164:167], v[56:59], v[176:179]
  ds_read_b64_tr_b16 a[228:229], v38 offset:49152
  v_add_f32_dpp v124, v124, v124 row_bcast:31 row_mask:0xc bank_mask:0xf
  v_mfma_f32_16x16x32_bf16 v[180:183], a[168:171], v[52:55], 0
  buffer_load_dwordx4 v29, s[8:11], s72 offen offset:1024 nt lds
  v_mfma_f32_16x16x32_bf16 v[180:183], a[172:175], v[56:59], v[180:183]
  ds_read_b64_tr_b16 a[230:231], v38 offset:51200
  v_add_f32_dpp v125, v125, v125 row_bcast:31 row_mask:0xc bank_mask:0xf
  v_mfma_f32_16x16x32_bf16 v[184:187], a[176:179], v[52:55], 0
  v_readlane_b32 s96, v124, 63
  v_readlane_b32 s97, v125, 63
  v_mfma_f32_16x16x32_bf16 v[184:187], a[180:183], v[56:59], v[184:187]
  ds_read_b64_tr_b16 a[236:237], v39 offset:49152
  v_mul_f32 v124, s96, v122
  v_mfma_f32_16x16x32_bf16 v[188:191], a[184:187], v[52:55], 0
  ds_read_b64_tr_b16 a[238:239], v39 offset:51200
  v_mul_f32 v125, s97, v122
  v_mfma_f32_16x16x32_bf16 v[188:191], a[188:191], v[56:59], v[188:191]
  s_waitcnt lgkmcnt(6)
  ds_read_b64_tr_b16 a[244:245], v40 offset:49152
  v_cvt_pk_bf16_f32 v120, v120, v120
  v_mfma_f32_16x16x32_bf16 v[192:195], a[128:131], v[44:47], 0
  v_and_b32 v120, 0xffff0000, v120
  v_cvt_pk_bf16_f32 v124, v124, v124
  v_mfma_f32_16x16x32_bf16 v[192:195], a[132:135], v[48:51], v[192:195]
  ds_read_b128 v[52:55], v32 offset:22528
  v_and_b32 v124, 0xffff0000, v124
  v_mfma_f32_16x16x32_bf16 v[196:199], a[136:139], v[44:47], 0
  buffer_load_dwordx4 v30, s[8:11], s72 offen offset:2048 nt lds
  v_mfma_f32_16x16x32_bf16 v[196:199], a[140:143], v[48:51], v[196:199]
  ds_read_b128 v[56:59], v33 offset:22528
  v_add_f32 v124, 0x3727c5ac, v124
  v_mfma_f32_16x16x32_bf16 v[200:203], a[144:147], v[44:47], 0
  ds_read_b64_tr_b16 a[246:247], v40 offset:51200
  v_cvt_pk_bf16_f32 v124, v124, v124
  v_mfma_f32_16x16x32_bf16 v[200:203], a[148:151], v[48:51], v[200:203]
  ds_read_b64_tr_b16 a[252:253], v41 offset:49152
  v_and_b32 v124, 0xffff0000, v124
  v_mfma_f32_16x16x32_bf16 v[204:207], a[152:155], v[44:47], 0
  v_sqrt_f32 v124, v124
  v_mfma_f32_16x16x32_bf16 v[204:207], a[156:159], v[48:51], v[204:207]
  ds_read_b64_tr_b16 a[254:255], v41 offset:51200
  v_cvt_pk_bf16_f32 v124, v124, v124
  v_mfma_f32_16x16x32_bf16 v[208:211], a[160:163], v[44:47], 0
  v_and_b32 v124, 0xffff0000, v124
  v_mfma_f32_16x16x32_bf16 v[208:211], a[164:167], v[48:51], v[208:211]
  v_rcp_f32 v124, v124
  v_mfma_f32_16x16x32_bf16 v[212:215], a[168:171], v[44:47], 0
  buffer_load_dwordx4 v31, s[8:11], s72 offen offset:3072 nt lds
  v_mfma_f32_16x16x32_bf16 v[212:215], a[172:175], v[48:51], v[212:215]
  v_sub_f32 v104, v104, v120
  v_sub_f32 v105, v105, v120
  v_mfma_f32_16x16x32_bf16 v[216:219], a[176:179], v[44:47], 0
  s_add_u32 s72, s72, 262144
  s_and_b32 s72, s72, 0x7fffff
  s_add_u32 m0, s1, 1024
  v_mfma_f32_16x16x32_bf16 v[216:219], a[180:183], v[48:51], v[216:219]
  buffer_load_dwordx4 v42, s[20:23], s36 offen nt lds
  v_mfma_f32_16x16x32_bf16 v[220:223], a[184:187], v[44:47], 0
  s_waitcnt vmcnt(18) lgkmcnt(0)
  v_cvt_pk_bf16_f32 v126, v104, v105
  v_lshlrev_b32 v104, 16, v126
  v_mfma_f32_16x16x32_bf16 v[220:223], a[188:191], v[48:51], v[220:223]
  s_barrier
  v_and_b32 v105, 0xffff0000, v126
  v_mul_f32 v104, v104, v124
  v_mfma_f32_16x16x32_bf16 v[224:227], a[128:131], v[52:55], 0
  s_add_u32 m0, s65, 81920
  v_mul_f32 v105, v105, v124
  v_cvt_pk_bf16_f32 v96, v104, v105
  v_mfma_f32_16x16x32_bf16 v[224:227], a[132:135], v[56:59], v[224:227]
  ds_read_b128 v[44:47], v32 offset:32768
  v_sub_f32 v106, v106, v120
  v_mfma_f32_16x16x32_bf16 v[228:231], a[136:139], v[52:55], 0
  buffer_load_dwordx4 v24, s[4:7], s71 offen offset:0  lds
  v_mfma_f32_16x16x32_bf16 v[228:231], a[140:143], v[56:59], v[228:231]
  ds_read_b128 v[48:51], v33 offset:32768
  v_sub_f32 v107, v107, v120
  v_mfma_f32_16x16x32_bf16 v[232:235], a[144:147], v[52:55], 0
  s_add_u32 s36, s36, s37
  v_cvt_pk_bf16_f32 v126, v106, v107
  v_lshlrev_b32 v106, 16, v126
  v_mfma_f32_16x16x32_bf16 v[232:235], a[148:151], v[56:59], v[232:235]
  v_and_b32 v107, 0xffff0000, v126
  v_mul_f32 v106, v106, v124
  v_mfma_f32_16x16x32_bf16 v[236:239], a[152:155], v[52:55], 0
  v_mul_f32 v107, v107, v124
  v_cvt_pk_bf16_f32 v97, v106, v107
  v_mfma_f32_16x16x32_bf16 v[236:239], a[156:159], v[56:59], v[236:239]
  v_sub_f32 v108, v108, v120
  v_sub_f32 v109, v109, v120
  v_mfma_f32_16x16x32_bf16 v[240:243], a[160:163], v[52:55], 0
  v_cvt_pk_bf16_f32 v126, v108, v109
  v_lshlrev_b32 v108, 16, v126
  v_mfma_f32_16x16x32_bf16 v[240:243], a[164:167], v[56:59], v[240:243]
  v_and_b32 v109, 0xffff0000, v126
  v_mul_f32 v108, v108, v124
  v_mfma_f32_16x16x32_bf16 v[244:247], a[168:171], v[52:55], 0
  buffer_load_dwordx4 v25, s[4:7], s71 offen offset:1024  lds
  v_mfma_f32_16x16x32_bf16 v[244:247], a[172:175], v[56:59], v[244:247]
  v_mul_f32 v109, v109, v124
  v_cvt_pk_bf16_f32 v98, v108, v109
  v_mfma_f32_16x16x32_bf16 v[248:251], a[176:179], v[52:55], 0
  v_sub_f32 v110, v110, v120
  v_sub_f32 v111, v111, v120
  v_mfma_f32_16x16x32_bf16 v[248:251], a[180:183], v[56:59], v[248:251]
  v_cvt_pk_bf16_f32 v126, v110, v111
  v_lshlrev_b32 v110, 16, v126
  v_mfma_f32_16x16x32_bf16 v[252:255], a[184:187], v[52:55], 0
  v_and_b32 v111, 0xffff0000, v126
  v_mul_f32 v110, v110, v124
  v_mfma_f32_16x16x32_bf16 v[252:255], a[188:191], v[56:59], v[252:255]
  s_waitcnt lgkmcnt(0)
  v_mul_f32 v111, v111, v124
  v_cvt_pk_bf16_f32 v99, v110, v111
  v_mfma_f32_16x16x32_bf16 a[0:3], a[192:195], v[44:47], a[0:3]
  ds_write_b64 v80, v[96:97] offset:0
  ds_write_b64 v80, v[98:99] offset:128
  v_mfma_f32_16x16x32_bf16 a[0:3], a[196:199], v[48:51], a[0:3]
  ds_read_b128 v[52:55], v32 offset:34816
  v_cvt_pk_bf16_f32 v121, v121, v121
  v_mfma_f32_16x16x32_bf16 a[4:7], a[200:203], v[44:47], a[4:7]
  buffer_load_dwordx4 v26, s[4:7], s71 offen offset:2048  lds
  v_mfma_f32_16x16x32_bf16 a[4:7], a[204:207], v[48:51], a[4:7]
  ds_read_b128 v[56:59], v33 offset:34816
  v_and_b32 v121, 0xffff0000, v121
  v_mfma_f32_16x16x32_bf16 a[8:11], a[208:211], v[44:47], a[8:11]
  v_cvt_pk_bf16_f32 v125, v125, v125
  v_and_b32 v125, 0xffff0000, v125
  v_mfma_f32_16x16x32_bf16 a[8:11], a[212:215], v[48:51], a[8:11]
  ds_read_b64_tr_b16 a[128:129], v34 offset:0
  v_add_f32 v125, 0x3727c5ac, v125
  v_mfma_f32_16x16x32_bf16 a[12:15], a[216:219], v[44:47], a[12:15]
  v_cvt_pk_bf16_f32 v125, v125, v125
  v_and_b32 v125, 0xffff0000, v125
  v_mfma_f32_16x16x32_bf16 a[12:15], a[220:223], v[48:51], a[12:15]
  ds_read_b64_tr_b16 a[130:131], v34 offset:2048
  v_mfma_f32_16x16x32_bf16 a[16:19], a[224:227], v[44:47], a[16:19]
  v_sqrt_f32 v125, v125
  v_mfma_f32_16x16x32_bf16 a[16:19], a[228:231], v[48:51], a[16:19]
  ds_read_b64_tr_b16 a[136:137], v35 offset:0
  v_cvt_pk_bf16_f32 v125, v125, v125
  v_mfma_f32_16x16x32_bf16 a[20:23], a[232:235], v[44:47], a[20:23]
  buffer_load_dwordx4 v27, s[4:7], s71 offen offset:3072  lds
  v_mfma_f32_16x16x32_bf16 a[20:23], a[236:239], v[48:51], a[20:23]
  ds_read_b64_tr_b16 a[138:139], v35 offset:2048
  v_and_b32 v125, 0xffff0000, v125
  v_mfma_f32_16x16x32_bf16 a[24:27], a[240:243], v[44:47], a[24:27]
  v_rcp_f32 v125, v125
  v_mfma_f32_16x16x32_bf16 a[24:27], a[244:247], v[48:51], a[24:27]
  ds_read_b64_tr_b16 a[144:145], v36 offset:0
  v_sub_f32 v112, v112, v121
  v_mfma_f32_16x16x32_bf16 a[28:31], a[248:251], v[44:47], a[28:31]
  s_add_u32 s70, s70, 128
  s_and_b32 s70, s70, 0x7ff
  v_sub_f32 v113, v113, v121
  v_mfma_f32_16x16x32_bf16 a[28:31], a[252:255], v[48:51], a[28:31]
  s_waitcnt lgkmcnt(5)
  ds_read_b64_tr_b16 a[146:147], v36 offset:2048
  v_cvt_pk_bf16_f32 v126, v112, v113
  v_mfma_f32_16x16x32_bf16 a[32:35], a[192:195], v[52:55], a[32:35]
  s_add_u32 m0, s65, 49152
  v_lshlrev_b32 v112, 16, v126
  v_and_b32 v113, 0xffff0000, v126
  v_mfma_f32_16x16x32_bf16 a[32:35], a[196:199], v[56:59], a[32:35]
  ds_read_b128 v[44:47], v32 offset:36864
  v_mul_f32 v112, v112, v125
  v_mfma_f32_16x16x32_bf16 a[36:39], a[200:203], v[52:55], a[36:39]
  buffer_load_dwordx4 v28, s[8:11], s72 offen offset:0 nt lds
  v_mfma_f32_16x16x32_bf16 a[36:39], a[204:207], v[56:59], a[36:39]
  ds_read_b128 v[48:51], v33 offset:36864
  v_mul_f32 v113, v113, v125
  v_mfma_f32_16x16x32_bf16 a[40:43], a[208:211], v[52:55], a[40:43]
  s_add_u32 s71, s71, 128
  s_and_b32 s71, s71, 0x2007ff
  v_cvt_pk_bf16_f32 v100, v112, v113
  v_mfma_f32_16x16x32_bf16 a[40:43], a[212:215], v[56:59], a[40:43]
  ds_read_b64_tr_b16 a[152:153], v37 offset:0
  v_sub_f32 v114, v114, v121
  v_mfma_f32_16x16x32_bf16 a[44:47], a[216:219], v[52:55], a[44:47]
  v_sub_f32 v115, v115, v121
  v_cvt_pk_bf16_f32 v126, v114, v115
  v_mfma_f32_16x16x32_bf16 a[44:47], a[220:223], v[56:59], a[44:47]
  ds_read_b64_tr_b16 a[154:155], v37 offset:2048
  v_lshlrev_b32 v114, 16, v126
  v_mfma_f32_16x16x32_bf16 a[48:51], a[224:227], v[52:55], a[48:51]
  v_and_b32 v115, 0xffff0000, v126
  v_mul_f32 v114, v114, v125
  v_mfma_f32_16x16x32_bf16 a[48:51], a[228:231], v[56:59], a[48:51]
  ds_read_b64_tr_b16 a[160:161], v38 offset:0
  v_mul_f32 v115, v115, v125
  v_mfma_f32_16x16x32_bf16 a[52:55], a[232:235], v[52:55], a[52:55]
  buffer_load_dwordx4 v29, s[8:11], s72 offen offset:1024 nt lds
  v_mfma_f32_16x16x32_bf16 a[52:55], a[236:239], v[56:59], a[52:55]
  ds_read_b64_tr_b16 a[162:163], v38 offset:2048
  v_cvt_pk_bf16_f32 v101, v114, v115
  v_mfma_f32_16x16x32_bf16 a[56:59], a[240:243], v[52:55], a[56:59]
  v_sub_f32 v116, v116, v121
  v_sub_f32 v117, v117, v121
  v_mfma_f32_16x16x32_bf16 a[56:59], a[244:247], v[56:59], a[56:59]
  ds_read_b64_tr_b16 a[168:169], v39 offset:0
  v_cvt_pk_bf16_f32 v126, v116, v117
  v_mfma_f32_16x16x32_bf16 a[60:63], a[248:251], v[52:55], a[60:63]
  ds_read_b64_tr_b16 a[170:171], v39 offset:2048
  v_lshlrev_b32 v116, 16, v126
  v_mfma_f32_16x16x32_bf16 a[60:63], a[252:255], v[56:59], a[60:63]
  s_waitcnt lgkmcnt(6)
  ds_read_b64_tr_b16 a[176:177], v40 offset:0
  v_and_b32 v117, 0xffff0000, v126
  v_mfma_f32_16x16x32_bf16 a[64:67], a[192:195], v[44:47], a[64:67]
  v_mul_f32 v116, v116, v125
  v_mul_f32 v117, v117, v125
  v_mfma_f32_16x16x32_bf16 a[64:67], a[196:199], v[48:51], a[64:67]
  ds_read_b128 v[52:55], v32 offset:38912
  v_cvt_pk_bf16_f32 v102, v116, v117
  v_mfma_f32_16x16x32_bf16 a[68:71], a[200:203], v[44:47], a[68:71]
  buffer_load_dwordx4 v30, s[8:11], s72 offen offset:2048 nt lds
  v_mfma_f32_16x16x32_bf16 a[68:71], a[204:207], v[48:51], a[68:71]
  ds_read_b128 v[56:59], v33 offset:38912
  v_sub_f32 v118, v118, v121
  v_mfma_f32_16x16x32_bf16 a[72:75], a[208:211], v[44:47], a[72:75]
  ds_read_b64_tr_b16 a[178:179], v40 offset:2048
  v_sub_f32 v119, v119, v121
  v_mfma_f32_16x16x32_bf16 a[72:75], a[212:215], v[48:51], a[72:75]
  ds_read_b64_tr_b16 a[184:185], v41 offset:0
  v_cvt_pk_bf16_f32 v126, v118, v119
  v_mfma_f32_16x16x32_bf16 a[76:79], a[216:219], v[44:47], a[76:79]
  v_lshlrev_b32 v118, 16, v126
  v_and_b32 v119, 0xffff0000, v126
  v_mfma_f32_16x16x32_bf16 a[76:79], a[220:223], v[48:51], a[76:79]
  ds_read_b64_tr_b16 a[186:187], v41 offset:2048
  v_mul_f32 v118, v118, v125
  v_mfma_f32_16x16x32_bf16 a[80:83], a[224:227], v[44:47], a[80:83]
  v_mul_f32 v119, v119, v125
  v_cvt_pk_bf16_f32 v103, v118, v119
  v_mfma_f32_16x16x32_bf16 a[80:83], a[228:231], v[48:51], a[80:83]
  ds_write_b64 v80, v[100:101] offset:16
  ds_write_b64 v80, v[102:103] offset:144
  v_mfma_f32_16x16x32_bf16 a[84:87], a[232:235], v[44:47], a[84:87]
  buffer_load_dwordx4 v31, s[8:11], s72 offen offset:3072 nt lds
  v_mfma_f32_16x16x32_bf16 a[84:87], a[236:239], v[48:51], a[84:87]
  v_mfma_f32_16x16x32_bf16 a[88:91], a[240:243], v[44:47], a[88:91]
  s_add_u32 s72, s72, 262144
  s_and_b32 s72, s72, 0x7fffff
  s_add_u32 m0, s1, 2048
  v_mfma_f32_16x16x32_bf16 a[88:91], a[244:247], v[48:51], a[88:91]
  buffer_load_dwordx4 v42, s[20:23], s36 offen nt lds
  v_mfma_f32_16x16x32_bf16 a[92:95], a[248:251], v[44:47], a[92:95]
  s_waitcnt vmcnt(19) lgkmcnt(0)
  v_mfma_f32_16x16x32_bf16 a[92:95], a[252:255], v[48:51], a[92:95]
  s_barrier
  v_mfma_f32_16x16x32_bf16 a[96:99], a[192:195], v[52:55], a[96:99]
  s_add_u32 m0, s65, 98304
  ds_read_b128 v[96:99], v81
  ds_read_b128 v[100:103], v81 offset:1088
  v_mfma_f32_16x16x32_bf16 a[96:99], a[196:199], v[56:59], a[96:99]
  ds_read_b128 v[44:47], v32 offset:49152
  v_mfma_f32_16x16x32_bf16 a[100:103], a[200:203], v[52:55], a[100:103]
  buffer_load_dwordx4 v24, s[4:7], s70 offen offset:0  lds
  v_mfma_f32_16x16x32_bf16 a[100:103], a[204:207], v[56:59], a[100:103]
  ds_read_b128 v[48:51], v33 offset:49152
  v_mfma_f32_16x16x32_bf16 a[104:107], a[208:211], v[52:55], a[104:107]
  s_add_u32 s36, s36, s37
  v_mfma_f32_16x16x32_bf16 a[104:107], a[212:215], v[56:59], a[104:107]
  v_mfma_f32_16x16x32_bf16 a[108:111], a[216:219], v[52:55], a[108:111]
  v_mfma_f32_16x16x32_bf16 a[108:111], a[220:223], v[56:59], a[108:111]
  v_mfma_f32_16x16x32_bf16 a[112:115], a[224:227], v[52:55], a[112:115]
  v_mfma_f32_16x16x32_bf16 a[112:115], a[228:231], v[56:59], a[112:115]
  v_mfma_f32_16x16x32_bf16 a[116:119], a[232:235], v[52:55], a[116:119]
  buffer_load_dwordx4 v25, s[4:7], s70 offen offset:1024  lds
  v_mfma_f32_16x16x32_bf16 a[116:119], a[236:239], v[56:59], a[116:119]
  v_mfma_f32_16x16x32_bf16 a[120:123], a[240:243], v[52:55], a[120:123]
  s_waitcnt lgkmcnt(3)
  buffer_store_dwordx4 v[96:99], v82, s[12:15], s19 offen sc1
  v_mfma_f32_16x16x32_bf16 a[120:123], a[244:247], v[56:59], a[120:123]
  v_mfma_f32_16x16x32_bf16 a[124:127], a[248:251], v[52:55], a[124:127]
  s_waitcnt lgkmcnt(2)
  buffer_store_dwordx4 v[100:103], v82, s[12:15], s79 offen offset:2048 sc1
  v_mfma_f32_16x16x32_bf16 a[124:127], a[252:255], v[56:59], a[124:127]
  s_waitcnt lgkmcnt(0)
  v_mfma_f32_16x16x32_bf16 v[128:131], a[192:195], v[44:47], v[128:131]
  v_mfma_f32_16x16x32_bf16 v[128:131], a[196:199], v[48:51], v[128:131]
  ds_read_b128 v[52:55], v32 offset:51200
  v_mfma_f32_16x16x32_bf16 v[132:135], a[200:203], v[44:47], v[132:135]
  buffer_load_dwordx4 v26, s[4:7], s70 offen offset:2048  lds
  v_mfma_f32_16x16x32_bf16 v[132:135], a[204:207], v[48:51], v[132:135]
  ds_read_b128 v[56:59], v33 offset:51200
  v_mfma_f32_16x16x32_bf16 v[136:139], a[208:211], v[44:47], v[136:139]
  v_mfma_f32_16x16x32_bf16 v[136:139], a[212:215], v[48:51], v[136:139]
  ds_read_b64_tr_b16 a[132:133], v34 offset:16384
  v_mfma_f32_16x16x32_bf16 v[140:143], a[216:219], v[44:47], v[140:143]
  v_mfma_f32_16x16x32_bf16 v[140:143], a[220:223], v[48:51], v[140:143]
  ds_read_b64_tr_b16 a[134:135], v34 offset:18432
  v_mfma_f32_16x16x32_bf16 v[144:147], a[224:227], v[44:47], v[144:147]
  buffer_store_dwordx4 v[84:87], v83, s[12:15], s18 offen sc1
  v_mfma_f32_16x16x32_bf16 v[144:147], a[228:231], v[48:51], v[144:147]
  ds_read_b64_tr_b16 a[140:141], v35 offset:16384
  v_mfma_f32_16x16x32_bf16 v[148:151], a[232:235], v[44:47], v[148:151]
  buffer_load_dwordx4 v27, s[4:7], s70 offen offset:3072  lds
  v_mfma_f32_16x16x32_bf16 v[148:151], a[236:239], v[48:51], v[148:151]
  ds_read_b64_tr_b16 a[142:143], v35 offset:18432
  v_mfma_f32_16x16x32_bf16 v[152:155], a[240:243], v[44:47], v[152:155]
  v_mfma_f32_16x16x32_bf16 v[152:155], a[244:247], v[48:51], v[152:155]
  ds_read_b64_tr_b16 a[148:149], v36 offset:16384
  v_mfma_f32_16x16x32_bf16 v[156:159], a[248:251], v[44:47], v[156:159]
  v_mfma_f32_16x16x32_bf16 v[156:159], a[252:255], v[48:51], v[156:159]
  s_waitcnt lgkmcnt(5)
  ds_read_b64_tr_b16 a[150:151], v36 offset:18432
  v_mfma_f32_16x16x32_bf16 v[160:163], a[192:195], v[52:55], v[160:163]
  s_add_u32 m0, s65, 0
  v_mfma_f32_16x16x32_bf16 v[160:163], a[196:199], v[56:59], v[160:163]
  ds_read_b128 v[44:47], v32 offset:53248
  v_mfma_f32_16x16x32_bf16 v[164:167], a[200:203], v[52:55], v[164:167]
  buffer_load_dwordx4 v28, s[8:11], s72 offen offset:0 nt lds
  v_mfma_f32_16x16x32_bf16 v[164:167], a[204:207], v[56:59], v[164:167]
  ds_read_b128 v[48:51], v33 offset:53248
  v_mfma_f32_16x16x32_bf16 v[168:171], a[208:211], v[52:55], v[168:171]
  v_mfma_f32_16x16x32_bf16 v[168:171], a[212:215], v[56:59], v[168:171]
  ds_read_b64_tr_b16 a[156:157], v37 offset:16384
  v_mfma_f32_16x16x32_bf16 v[172:175], a[216:219], v[52:55], v[172:175]
  v_mfma_f32_16x16x32_bf16 v[172:175], a[220:223], v[56:59], v[172:175]
  ds_read_b64_tr_b16 a[158:159], v37 offset:18432
  v_mfma_f32_16x16x32_bf16 v[176:179], a[224:227], v[52:55], v[176:179]
  v_mfma_f32_16x16x32_bf16 v[176:179], a[228:231], v[56:59], v[176:179]
  ds_read_b64_tr_b16 a[164:165], v38 offset:16384
  v_mfma_f32_16x16x32_bf16 v[180:183], a[232:235], v[52:55], v[180:183]
  buffer_load_dwordx4 v29, s[8:11], s72 offen offset:1024 nt lds
  v_mfma_f32_16x16x32_bf16 v[180:183], a[236:239], v[56:59], v[180:183]
  ds_read_b64_tr_b16 a[166:167], v38 offset:18432
  v_mfma_f32_16x16x32_bf16 v[184:187], a[240:243], v[52:55], v[184:187]
  v_mfma_f32_16x16x32_bf16 v[184:187], a[244:247], v[56:59], v[184:187]
  ds_read_b64_tr_b16 a[172:173], v39 offset:16384
  v_mfma_f32_16x16x32_bf16 v[188:191], a[248:251], v[52:55], v[188:191]
  ds_read_b64_tr_b16 a[174:175], v39 offset:18432
  v_mfma_f32_16x16x32_bf16 v[188:191], a[252:255], v[56:59], v[188:191]
  s_waitcnt lgkmcnt(6)
  ds_read_b64_tr_b16 a[180:181], v40 offset:16384
  v_mfma_f32_16x16x32_bf16 v[192:195], a[192:195], v[44:47], v[192:195]
  buffer_load_dword v15, v7, s[28:31], 0 offen
  v_mfma_f32_16x16x32_bf16 v[192:195], a[196:199], v[48:51], v[192:195]
  ds_read_b128 v[52:55], v32 offset:55296
  v_min_u32 v88, 768, v7
  v_mfma_f32_16x16x32_bf16 v[196:199], a[200:203], v[44:47], v[196:199]
  buffer_load_dwordx4 v30, s[8:11], s72 offen offset:2048 nt lds
  v_mfma_f32_16x16x32_bf16 v[196:199], a[204:207], v[48:51], v[196:199]
  ds_read_b128 v[56:59], v33 offset:55296
  v_mfma_f32_16x16x32_bf16 v[200:203], a[208:211], v[44:47], v[200:203]
  ds_read_b64_tr_b16 a[182:183], v40 offset:18432
  v_mfma_f32_16x16x32_bf16 v[200:203], a[212:215], v[48:51], v[200:203]
  ds_read_b64_tr_b16 a[188:189], v41 offset:16384
  v_mfma_f32_16x16x32_bf16 v[204:207], a[216:219], v[44:47], v[204:207]
  global_load_dword v15, v88, s[52:53]
  v_mfma_f32_16x16x32_bf16 v[204:207], a[220:223], v[48:51], v[204:207]
  ds_read_b64_tr_b16 a[190:191], v41 offset:18432
  v_mfma_f32_16x16x32_bf16 v[208:211], a[224:227], v[44:47], v[208:211]
  v_mfma_f32_16x16x32_bf16 v[208:211], a[228:231], v[48:51], v[208:211]
  v_mfma_f32_16x16x32_bf16 v[212:215], a[232:235], v[44:47], v[212:215]
  buffer_load_dwordx4 v31, s[8:11], s72 offen offset:3072 nt lds
  v_mfma_f32_16x16x32_bf16 v[212:215], a[236:239], v[48:51], v[212:215]
  v_mfma_f32_16x16x32_bf16 v[216:219], a[240:243], v[44:47], v[216:219]
  s_add_u32 s72, s72, 262144
  s_and_b32 s72, s72, 0x7fffff
  s_add_u32 m0, s1, 3072
  v_mfma_f32_16x16x32_bf16 v[216:219], a[244:247], v[48:51], v[216:219]
  buffer_load_dwordx4 v42, s[20:23], s36 offen nt lds
  v_mfma_f32_16x16x32_bf16 v[220:223], a[248:251], v[44:47], v[220:223]
  s_waitcnt vmcnt(24) lgkmcnt(0)
  v_mfma_f32_16x16x32_bf16 v[220:223], a[252:255], v[48:51], v[220:223]
  s_barrier
  v_mfma_f32_16x16x32_bf16 v[224:227], a[192:195], v[52:55], v[224:227]
  s_add_u32 m0, s65, 114688
  v_mfma_f32_16x16x32_bf16 v[224:227], a[196:199], v[56:59], v[224:227]
  ds_read_b128 v[44:47], v32 offset:0
  v_mfma_f32_16x16x32_bf16 v[228:231], a[200:203], v[52:55], v[228:231]
  buffer_load_dwordx4 v24, s[4:7], s71 offen offset:0  lds
  v_mfma_f32_16x16x32_bf16 v[228:231], a[204:207], v[56:59], v[228:231]
  ds_read_b128 v[48:51], v33 offset:0
  v_mfma_f32_16x16x32_bf16 v[232:235], a[208:211], v[52:55], v[232:235]
  v_mfma_f32_16x16x32_bf16 v[232:235], a[212:215], v[56:59], v[232:235]
  v_mfma_f32_16x16x32_bf16 v[236:239], a[216:219], v[52:55], v[236:239]
  v_mfma_f32_16x16x32_bf16 v[236:239], a[220:223], v[56:59], v[236:239]
  v_mfma_f32_16x16x32_bf16 v[240:243], a[224:227], v[52:55], v[240:243]
  v_mfma_f32_16x16x32_bf16 v[240:243], a[228:231], v[56:59], v[240:243]
  v_mfma_f32_16x16x32_bf16 v[244:247], a[232:235], v[52:55], v[244:247]
  buffer_load_dwordx4 v25, s[4:7], s71 offen offset:1024  lds
  v_mfma_f32_16x16x32_bf16 v[244:247], a[236:239], v[56:59], v[244:247]
  v_mfma_f32_16x16x32_bf16 v[248:251], a[240:243], v[52:55], v[248:251]
  v_mfma_f32_16x16x32_bf16 v[248:251], a[244:247], v[56:59], v[248:251]
  s_waitcnt lgkmcnt(0)
  v_mfma_f32_16x16x32_bf16 v[252:255], a[248:251], v[52:55], v[252:255]
  v_mfma_f32_16x16x32_bf16 v[252:255], a[252:255], v[56:59], v[252:255]
  .p2align 6
L_kf_kernel_aloop_5:
  v_mfma_f32_16x16x32_bf16 a[0:3], a[128:131], v[44:47], a[0:3]
  s_mov_b32 s20, s60
  v_mfma_f32_16x16x32_bf16 a[0:3], a[132:135], v[48:51], a[0:3]
  s_mov_b32 s21, s61
  ds_read_b128 v[52:55], v32 offset:2048
  v_mfma_f32_16x16x32_bf16 a[4:7], a[136:139], v[44:47], a[4:7]
  s_mov_b32 s22, s41
  buffer_load_dwordx4 v26, s[4:7], s71 offen offset:2048  lds
  v_mfma_f32_16x16x32_bf16 a[4:7], a[140:143], v[48:51], a[4:7]
  ds_read_b128 v[56:59], v33 offset:2048
  v_mfma_f32_16x16x32_bf16 a[8:11], a[144:147], v[44:47], a[8:11]
  s_mov_b32 s36, s63
  v_mfma_f32_16x16x32_bf16 a[8:11], a[148:151], v[48:51], a[8:11]
  s_lshl_b32 s37, s38, 3
  ds_read_b64_tr_b16 a[192:193], v34 offset:32768
  v_mfma_f32_16x16x32_bf16 a[12:15], a[152:155], v[44:47], a[12:15]
  s_xor_b32 s1, s1, 16384
  v_mad_u32_u24 v42, v60, s38, v61
  v_mfma_f32_16x16x32_bf16 a[12:15], a[156:159], v[48:51], a[12:15]
  ds_read_b64_tr_b16 a[194:195], v34 offset:34816
  v_mfma_f32_16x16x32_bf16 a[16:19], a[160:163], v[44:47], a[16:19]
  v_mfma_f32_16x16x32_bf16 a[16:19], a[164:167], v[48:51], a[16:19]
  ds_read_b64_tr_b16 a[200:201], v35 offset:32768
  v_mfma_f32_16x16x32_bf16 a[20:23], a[168:171], v[44:47], a[20:23]
  buffer_load_dwordx4 v27, s[4:7], s71 offen offset:3072  lds
  v_mfma_f32_16x16x32_bf16 a[20:23], a[172:175], v[48:51], a[20:23]
  ds_read_b64_tr_b16 a[202:203], v35 offset:34816
  v_mfma_f32_16x16x32_bf16 a[24:27], a[176:179], v[44:47], a[24:27]
  v_mfma_f32_16x16x32_bf16 a[24:27], a[180:183], v[48:51], a[24:27]
  ds_read_b64_tr_b16 a[208:209], v36 offset:32768
  v_mfma_f32_16x16x32_bf16 a[28:31], a[184:187], v[44:47], a[28:31]
  s_add_u32 s70, s70, 128
  s_and_b32 s70, s70, 0x7ff
  v_mfma_f32_16x16x32_bf16 a[28:31], a[188:191], v[48:51], a[28:31]
  s_waitcnt lgkmcnt(5)
  ds_read_b64_tr_b16 a[210:211], v36 offset:34816
  v_mfma_f32_16x16x32_bf16 a[32:35], a[128:131], v[52:55], a[32:35]
  s_add_u32 m0, s65, 16384
  v_mfma_f32_16x16x32_bf16 a[32:35], a[132:135], v[56:59], a[32:35]
  ds_read_b128 v[44:47], v32 offset:4096
  v_mfma_f32_16x16x32_bf16 a[36:39], a[136:139], v[52:55], a[36:39]
  buffer_load_dwordx4 v28, s[8:11], s72 offen offset:0 nt lds
  v_mfma_f32_16x16x32_bf16 a[36:39], a[140:143], v[56:59], a[36:39]
  ds_read_b128 v[48:51], v33 offset:4096
  v_mfma_f32_16x16x32_bf16 a[40:43], a[144:147], v[52:55], a[40:43]
  s_add_u32 s71, s71, 128
  s_and_b32 s71, s71, 0x2007ff
  v_mfma_f32_16x16x32_bf16 a[40:43], a[148:151], v[56:59], a[40:43]
  s_sub_u32 s73, s73, 1
  ds_read_b64_tr_b16 a[216:217], v37 offset:32768
  v_mfma_f32_16x16x32_bf16 a[44:47], a[152:155], v[52:55], a[44:47]
  v_mfma_f32_16x16x32_bf16 a[44:47], a[156:159], v[56:59], a[44:47]
  ds_read_b64_tr_b16 a[218:219], v37 offset:34816
  v_mfma_f32_16x16x32_bf16 a[48:51], a[160:163], v[52:55], a[48:51]
  v_mfma_f32_16x16x32_bf16 a[48:51], a[164:167], v[56:59], a[48:51]
  ds_read_b64_tr_b16 a[224:225], v38 offset:32768
  v_mfma_f32_16x16x32_bf16 a[52:55], a[168:171], v[52:55], a[52:55]
  buffer_load_dwordx4 v29, s[8:11], s72 offen offset:1024 nt lds
  v_mfma_f32_16x16x32_bf16 a[52:55], a[172:175], v[56:59], a[52:55]
  ds_read_b64_tr_b16 a[226:227], v38 offset:34816
  v_mfma_f32_16x16x32_bf16 a[56:59], a[176:179], v[52:55], a[56:59]
  v_mfma_f32_16x16x32_bf16 a[56:59], a[180:183], v[56:59], a[56:59]
  ds_read_b64_tr_b16 a[232:233], v39 offset:32768
  v_mfma_f32_16x16x32_bf16 a[60:63], a[184:187], v[52:55], a[60:63]
  ds_read_b64_tr_b16 a[234:235], v39 offset:34816
  v_mfma_f32_16x16x32_bf16 a[60:63], a[188:191], v[56:59], a[60:63]
  s_waitcnt lgkmcnt(6)
  ds_read_b64_tr_b16 a[240:241], v40 offset:32768
  v_mfma_f32_16x16x32_bf16 a[64:67], a[128:131], v[44:47], a[64:67]
  v_mfma_f32_16x16x32_bf16 a[64:67], a[132:135], v[48:51], a[64:67]
  ds_read_b128 v[52:55], v32 offset:6144
  v_mfma_f32_16x16x32_bf16 a[68:71], a[136:139], v[44:47], a[68:71]
  buffer_load_dwordx4 v30, s[8:11], s72 offen offset:2048 nt lds
  v_mfma_f32_16x16x32_bf16 a[68:71], a[140:143], v[48:51], a[68:71]
  ds_read_b128 v[56:59], v33 offset:6144
  v_mfma_f32_16x16x32_bf16 a[72:75], a[144:147], v[44:47], a[72:75]
  ds_read_b64_tr_b16 a[242:243], v40 offset:34816
  v_mfma_f32_16x16x32_bf16 a[72:75], a[148:151], v[48:51], a[72:75]
  ds_read_b64_tr_b16 a[248:249], v41 offset:32768
  v_mfma_f32_16x16x32_bf16 a[76:79], a[152:155], v[44:47], a[76:79]
  v_mfma_f32_16x16x32_bf16 a[76:79], a[156:159], v[48:51], a[76:79]
  ds_read_b64_tr_b16 a[250:251], v41 offset:34816
  v_mfma_f32_16x16x32_bf16 a[80:83], a[160:163], v[44:47], a[80:83]
  v_mfma_f32_16x16x32_bf16 a[80:83], a[164:167], v[48:51], a[80:83]
  v_mfma_f32_16x16x32_bf16 a[84:87], a[168:171], v[44:47], a[84:87]
  buffer_load_dwordx4 v31, s[8:11], s72 offen offset:3072 nt lds
  v_mfma_f32_16x16x32_bf16 a[84:87], a[172:175], v[48:51], a[84:87]
  v_mfma_f32_16x16x32_bf16 a[88:91], a[176:179], v[44:47], a[88:91]
  s_add_u32 s72, s72, 262144
  s_add_u32 m0, s1, 0
  s_and_b32 s72, s72, 0x7fffff
  v_mfma_f32_16x16x32_bf16 a[88:91], a[180:183], v[48:51], a[88:91]
  buffer_load_dwordx4 v42, s[20:23], s36 offen nt lds
  v_mfma_f32_16x16x32_bf16 a[92:95], a[184:187], v[44:47], a[92:95]
  s_waitcnt vmcnt(23) lgkmcnt(0)
  v_mfma_f32_16x16x32_bf16 a[92:95], a[188:191], v[48:51], a[92:95]
  s_barrier
  v_mfma_f32_16x16x32_bf16 a[96:99], a[128:131], v[52:55], a[96:99]
  s_add_u32 m0, s65, 65536
  v_mfma_f32_16x16x32_bf16 a[96:99], a[132:135], v[56:59], a[96:99]
  ds_read_b128 v[44:47], v32 offset:16384
  v_mfma_f32_16x16x32_bf16 a[100:103], a[136:139], v[52:55], a[100:103]
  buffer_load_dwordx4 v24, s[4:7], s70 offen offset:0  lds
  v_mfma_f32_16x16x32_bf16 a[100:103], a[140:143], v[56:59], a[100:103]
  ds_read_b128 v[48:51], v33 offset:16384
  v_mfma_f32_16x16x32_bf16 a[104:107], a[144:147], v[52:55], a[104:107]
  s_add_u32 s36, s36, s37
  v_mfma_f32_16x16x32_bf16 a[104:107], a[148:151], v[56:59], a[104:107]
  v_mfma_f32_16x16x32_bf16 a[108:111], a[152:155], v[52:55], a[108:111]
  v_mfma_f32_16x16x32_bf16 a[108:111], a[156:159], v[56:59], a[108:111]
  v_mfma_f32_16x16x32_bf16 a[112:115], a[160:163], v[52:55], a[112:115]
  v_mfma_f32_16x16x32_bf16 a[112:115], a[164:167], v[56:59], a[112:115]
  v_mfma_f32_16x16x32_bf16 a[116:119], a[168:171], v[52:55], a[116:119]
  buffer_load_dwordx4 v25, s[4:7], s70 offen offset:1024  lds
  v_mfma_f32_16x16x32_bf16 a[116:119], a[172:175], v[56:59], a[116:119]
  v_mfma_f32_16x16x32_bf16 a[120:123], a[176:179], v[52:55], a[120:123]
  s_mov_b32 s60, s39
  v_mfma_f32_16x16x32_bf16 a[120:123], a[180:183], v[56:59], a[120:123]
  s_mov_b32 s61, s40
  v_mfma_f32_16x16x32_bf16 a[124:127], a[184:187], v[52:55], a[124:127]
  s_mov_b32 s41, s42
  v_mfma_f32_16x16x32_bf16 a[124:127], a[188:191], v[56:59], a[124:127]
  s_waitcnt lgkmcnt(0)
  v_mfma_f32_16x16x32_bf16 v[128:131], a[128:131], v[44:47], v[128:131]
  s_mov_b32 s63, s43
  v_mfma_f32_16x16x32_bf16 v[128:131], a[132:135], v[48:51], v[128:131]
  s_mov_b32 s43, 2147418112
  ds_read_b128 v[52:55], v32 offset:18432
  v_mfma_f32_16x16x32_bf16 v[132:135], a[136:139], v[44:47], v[132:135]
  s_mov_b32 s38, s0
  buffer_load_dwordx4 v26, s[4:7], s70 offen offset:2048  lds
  v_mfma_f32_16x16x32_bf16 v[132:135], a[140:143], v[48:51], v[132:135]
  ds_read_b128 v[56:59], v33 offset:18432
  v_mfma_f32_16x16x32_bf16 v[136:139], a[144:147], v[44:47], v[136:139]
  v_mfma_f32_16x16x32_bf16 v[136:139], a[148:151], v[48:51], v[136:139]
  ds_read_b64_tr_b16 a[196:197], v34 offset:49152
  v_mfma_f32_16x16x32_bf16 v[140:143], a[152:155], v[44:47], v[140:143]
  v_mfma_f32_16x16x32_bf16 v[140:143], a[156:159], v[48:51], v[140:143]
  ds_read_b64_tr_b16 a[198:199], v34 offset:51200
  v_mfma_f32_16x16x32_bf16 v[144:147], a[160:163], v[44:47], v[144:147]
  v_mfma_f32_16x16x32_bf16 v[144:147], a[164:167], v[48:51], v[144:147]
  ds_read_b64_tr_b16 a[204:205], v35 offset:49152
  v_mfma_f32_16x16x32_bf16 v[148:151], a[168:171], v[44:47], v[148:151]
  buffer_load_dwordx4 v27, s[4:7], s70 offen offset:3072  lds
  v_mfma_f32_16x16x32_bf16 v[148:151], a[172:175], v[48:51], v[148:151]
  ds_read_b64_tr_b16 a[206:207], v35 offset:51200
  v_mfma_f32_16x16x32_bf16 v[152:155], a[176:179], v[44:47], v[152:155]
  v_mfma_f32_16x16x32_bf16 v[152:155], a[180:183], v[48:51], v[152:155]
  ds_read_b64_tr_b16 a[212:213], v36 offset:49152
  v_mfma_f32_16x16x32_bf16 v[156:159], a[184:187], v[44:47], v[156:159]
  v_mfma_f32_16x16x32_bf16 v[156:159], a[188:191], v[48:51], v[156:159]
  s_waitcnt lgkmcnt(5)
  ds_read_b64_tr_b16 a[214:215], v36 offset:51200
  v_mfma_f32_16x16x32_bf16 v[160:163], a[128:131], v[52:55], v[160:163]
  s_add_u32 m0, s65, 32768
  v_mfma_f32_16x16x32_bf16 v[160:163], a[132:135], v[56:59], v[160:163]
  ds_read_b128 v[44:47], v32 offset:20480
  v_mfma_f32_16x16x32_bf16 v[164:167], a[136:139], v[52:55], v[164:167]
  buffer_load_dwordx4 v28, s[8:11], s72 offen offset:0 nt lds
  v_mfma_f32_16x16x32_bf16 v[164:167], a[140:143], v[56:59], v[164:167]
  ds_read_b128 v[48:51], v33 offset:20480
  v_mfma_f32_16x16x32_bf16 v[168:171], a[144:147], v[52:55], v[168:171]
  v_mfma_f32_16x16x32_bf16 v[168:171], a[148:151], v[56:59], v[168:171]
  ds_read_b64_tr_b16 a[220:221], v37 offset:49152
  v_mfma_f32_16x16x32_bf16 v[172:175], a[152:155], v[52:55], v[172:175]
  v_mfma_f32_16x16x32_bf16 v[172:175], a[156:159], v[56:59], v[172:175]
  ds_read_b64_tr_b16 a[222:223], v37 offset:51200
  v_mfma_f32_16x16x32_bf16 v[176:179], a[160:163], v[52:55], v[176:179]
  v_mfma_f32_16x16x32_bf16 v[176:179], a[164:167], v[56:59], v[176:179]
  ds_read_b64_tr_b16 a[228:229], v38 offset:49152
  v_mfma_f32_16x16x32_bf16 v[180:183], a[168:171], v[52:55], v[180:183]
  buffer_load_dwordx4 v29, s[8:11], s72 offen offset:1024 nt lds
  v_mfma_f32_16x16x32_bf16 v[180:183], a[172:175], v[56:59], v[180:183]
  ds_read_b64_tr_b16 a[230:231], v38 offset:51200
  v_mfma_f32_16x16x32_bf16 v[184:187], a[176:179], v[52:55], v[184:187]
  v_mfma_f32_16x16x32_bf16 v[184:187], a[180:183], v[56:59], v[184:187]
  ds_read_b64_tr_b16 a[236:237], v39 offset:49152
  v_mfma_f32_16x16x32_bf16 v[188:191], a[184:187], v[52:55], v[188:191]
  ds_read_b64_tr_b16 a[238:239], v39 offset:51200
  v_mfma_f32_16x16x32_bf16 v[188:191], a[188:191], v[56:59], v[188:191]
  s_waitcnt lgkmcnt(6)
  ds_read_b64_tr_b16 a[244:245], v40 offset:49152
  v_mfma_f32_16x16x32_bf16 v[192:195], a[128:131], v[44:47], v[192:195]
  v_mfma_f32_16x16x32_bf16 v[192:195], a[132:135], v[48:51], v[192:195]
  ds_read_b128 v[52:55], v32 offset:22528
  v_mfma_f32_16x16x32_bf16 v[196:199], a[136:139], v[44:47], v[196:199]
  buffer_load_dwordx4 v30, s[8:11], s72 offen offset:2048 nt lds
  v_mfma_f32_16x16x32_bf16 v[196:199], a[140:143], v[48:51], v[196:199]
  ds_read_b128 v[56:59], v33 offset:22528
  v_mfma_f32_16x16x32_bf16 v[200:203], a[144:147], v[44:47], v[200:203]
  ds_read_b64_tr_b16 a[246:247], v40 offset:51200
  v_mfma_f32_16x16x32_bf16 v[200:203], a[148:151], v[48:51], v[200:203]
  ds_read_b64_tr_b16 a[252:253], v41 offset:49152
  v_mfma_f32_16x16x32_bf16 v[204:207], a[152:155], v[44:47], v[204:207]
  v_mfma_f32_16x16x32_bf16 v[204:207], a[156:159], v[48:51], v[204:207]
  ds_read_b64_tr_b16 a[254:255], v41 offset:51200
  v_mfma_f32_16x16x32_bf16 v[208:211], a[160:163], v[44:47], v[208:211]
  v_mfma_f32_16x16x32_bf16 v[208:211], a[164:167], v[48:51], v[208:211]
  v_mfma_f32_16x16x32_bf16 v[212:215], a[168:171], v[44:47], v[212:215]
  buffer_load_dwordx4 v31, s[8:11], s72 offen offset:3072 nt lds
  v_mfma_f32_16x16x32_bf16 v[212:215], a[172:175], v[48:51], v[212:215]
  v_mfma_f32_16x16x32_bf16 v[216:219], a[176:179], v[44:47], v[216:219]
  s_add_u32 s72, s72, 262144
  s_and_b32 s72, s72, 0x7fffff
  s_add_u32 m0, s1, 1024
  v_mfma_f32_16x16x32_bf16 v[216:219], a[180:183], v[48:51], v[216:219]
  buffer_load_dwordx4 v42, s[20:23], s36 offen nt lds
  v_mfma_f32_16x16x32_bf16 v[220:223], a[184:187], v[44:47], v[220:223]
  s_waitcnt vmcnt(19) lgkmcnt(0)
  v_mfma_f32_16x16x32_bf16 v[220:223], a[188:191], v[48:51], v[220:223]
  s_barrier
  v_mfma_f32_16x16x32_bf16 v[224:227], a[128:131], v[52:55], v[224:227]
  s_add_u32 m0, s65, 81920
  v_mfma_f32_16x16x32_bf16 v[224:227], a[132:135], v[56:59], v[224:227]
  ds_read_b128 v[44:47], v32 offset:32768
  v_mfma_f32_16x16x32_bf16 v[228:231], a[136:139], v[52:55], v[228:231]
  buffer_load_dwordx4 v24, s[4:7], s71 offen offset:0  lds
  v_mfma_f32_16x16x32_bf16 v[228:231], a[140:143], v[56:59], v[228:231]
  ds_read_b128 v[48:51], v33 offset:32768
  v_mfma_f32_16x16x32_bf16 v[232:235], a[144:147], v[52:55], v[232:235]
  s_add_u32 s36, s36, s37
  v_mfma_f32_16x16x32_bf16 v[232:235], a[148:151], v[56:59], v[232:235]
  v_mfma_f32_16x16x32_bf16 v[236:239], a[152:155], v[52:55], v[236:239]
  v_mfma_f32_16x16x32_bf16 v[236:239], a[156:159], v[56:59], v[236:239]
  v_mfma_f32_16x16x32_bf16 v[240:243], a[160:163], v[52:55], v[240:243]
  v_mfma_f32_16x16x32_bf16 v[240:243], a[164:167], v[56:59], v[240:243]
  v_mfma_f32_16x16x32_bf16 v[244:247], a[168:171], v[52:55], v[244:247]
  buffer_load_dwordx4 v25, s[4:7], s71 offen offset:1024  lds
  v_mfma_f32_16x16x32_bf16 v[244:247], a[172:175], v[56:59], v[244:247]
  v_mfma_f32_16x16x32_bf16 v[248:251], a[176:179], v[52:55], v[248:251]
  v_mfma_f32_16x16x32_bf16 v[248:251], a[180:183], v[56:59], v[248:251]
  s_mov_b32 s44, s45
  v_mfma_f32_16x16x32_bf16 v[252:255], a[184:187], v[52:55], v[252:255]
  s_mov_b32 s45, s46
  v_mfma_f32_16x16x32_bf16 v[252:255], a[188:191], v[56:59], v[252:255]
  s_waitcnt lgkmcnt(0)
  v_mfma_f32_16x16x32_bf16 a[0:3], a[192:195], v[44:47], a[0:3]
  s_mov_b32 s46, s47
  v_mfma_f32_16x16x32_bf16 a[0:3], a[196:199], v[48:51], a[0:3]
  s_mov_b32 s47, 2147418112
  ds_read_b128 v[52:55], v32 offset:34816
  v_mfma_f32_16x16x32_bf16 a[4:7], a[200:203], v[44:47], a[4:7]
  s_mov_b32 s48, s49
  buffer_load_dwordx4 v26, s[4:7], s71 offen offset:2048  lds
  v_mfma_f32_16x16x32_bf16 a[4:7], a[204:207], v[48:51], a[4:7]
  ds_read_b128 v[56:59], v33 offset:34816
  v_mfma_f32_16x16x32_bf16 a[8:11], a[208:211], v[44:47], a[8:11]
  s_mov_b32 s49, s50
  v_mfma_f32_16x16x32_bf16 a[8:11], a[212:215], v[48:51], a[8:11]
  s_mov_b32 s50, s51
  ds_read_b64_tr_b16 a[128:129], v34 offset:0
  v_mfma_f32_16x16x32_bf16 a[12:15], a[216:219], v[44:47], a[12:15]
  v_mfma_f32_16x16x32_bf16 a[12:15], a[220:223], v[48:51], a[12:15]
  ds_read_b64_tr_b16 a[130:131], v34 offset:2048
  v_mfma_f32_16x16x32_bf16 a[16:19], a[224:227], v[44:47], a[16:19]
  v_mfma_f32_16x16x32_bf16 a[16:19], a[228:231], v[48:51], a[16:19]
  ds_read_b64_tr_b16 a[136:137], v35 offset:0
  v_mfma_f32_16x16x32_bf16 a[20:23], a[232:235], v[44:47], a[20:23]
  buffer_load_dwordx4 v27, s[4:7], s71 offen offset:3072  lds
  v_mfma_f32_16x16x32_bf16 a[20:23], a[236:239], v[48:51], a[20:23]
  ds_read_b64_tr_b16 a[138:139], v35 offset:2048
  v_mfma_f32_16x16x32_bf16 a[24:27], a[240:243], v[44:47], a[24:27]
  v_mfma_f32_16x16x32_bf16 a[24:27], a[244:247], v[48:51], a[24:27]
  ds_read_b64_tr_b16 a[144:145], v36 offset:0
  v_mfma_f32_16x16x32_bf16 a[28:31], a[248:251], v[44:47], a[28:31]
  s_add_u32 s70, s70, 128
  s_and_b32 s70, s70, 0x7ff
  v_mfma_f32_16x16x32_bf16 a[28:31], a[252:255], v[48:51], a[28:31]
  s_waitcnt lgkmcnt(5)
  ds_read_b64_tr_b16 a[146:147], v36 offset:2048
  v_mfma_f32_16x16x32_bf16 a[32:35], a[192:195], v[52:55], a[32:35]
  s_add_u32 m0, s65, 49152
  v_mfma_f32_16x16x32_bf16 a[32:35], a[196:199], v[56:59], a[32:35]
  ds_read_b128 v[44:47], v32 offset:36864
  v_mfma_f32_16x16x32_bf16 a[36:39], a[200:203], v[52:55], a[36:39]
  buffer_load_dwordx4 v28, s[8:11], s72 offen offset:0 nt lds
  v_mfma_f32_16x16x32_bf16 a[36:39], a[204:207], v[56:59], a[36:39]
  ds_read_b128 v[48:51], v33 offset:36864
  v_mfma_f32_16x16x32_bf16 a[40:43], a[208:211], v[52:55], a[40:43]
  s_add_u32 s71, s71, 128
  s_and_b32 s71, s71, 0x2007ff
  v_mfma_f32_16x16x32_bf16 a[40:43], a[212:215], v[56:59], a[40:43]
  ds_read_b64_tr_b16 a[152:153], v37 offset:0
  v_mfma_f32_16x16x32_bf16 a[44:47], a[216:219], v[52:55], a[44:47]
  v_mfma_f32_16x16x32_bf16 a[44:47], a[220:223], v[56:59], a[44:47]
  ds_read_b64_tr_b16 a[154:155], v37 offset:2048
  v_mfma_f32_16x16x32_bf16 a[48:51], a[224:227], v[52:55], a[48:51]
  v_mfma_f32_16x16x32_bf16 a[48:51], a[228:231], v[56:59], a[48:51]
  ds_read_b64_tr_b16 a[160:161], v38 offset:0
  v_mfma_f32_16x16x32_bf16 a[52:55], a[232:235], v[52:55], a[52:55]
  buffer_load_dwordx4 v29, s[8:11], s72 offen offset:1024 nt lds
  v_mfma_f32_16x16x32_bf16 a[52:55], a[236:239], v[56:59], a[52:55]
  ds_read_b64_tr_b16 a[162:163], v38 offset:2048
  v_mfma_f32_16x16x32_bf16 a[56:59], a[240:243], v[52:55], a[56:59]
  v_mfma_f32_16x16x32_bf16 a[56:59], a[244:247], v[56:59], a[56:59]
  ds_read_b64_tr_b16 a[168:169], v39 offset:0
  v_mfma_f32_16x16x32_bf16 a[60:63], a[248:251], v[52:55], a[60:63]
  ds_read_b64_tr_b16 a[170:171], v39 offset:2048
  v_mfma_f32_16x16x32_bf16 a[60:63], a[252:255], v[56:59], a[60:63]
  s_waitcnt lgkmcnt(6)
  ds_read_b64_tr_b16 a[176:177], v40 offset:0
  v_mfma_f32_16x16x32_bf16 a[64:67], a[192:195], v[44:47], a[64:67]
  v_mfma_f32_16x16x32_bf16 a[64:67], a[196:199], v[48:51], a[64:67]
  ds_read_b128 v[52:55], v32 offset:38912
  v_mfma_f32_16x16x32_bf16 a[68:71], a[200:203], v[44:47], a[68:71]
  buffer_load_dwordx4 v30, s[8:11], s72 offen offset:2048 nt lds
  v_mfma_f32_16x16x32_bf16 a[68:71], a[204:207], v[48:51], a[68:71]
  ds_read_b128 v[56:59], v33 offset:38912
  v_mfma_f32_16x16x32_bf16 a[72:75], a[208:211], v[44:47], a[72:75]
  ds_read_b64_tr_b16 a[178:179], v40 offset:2048
  v_xor_b32 v17, 32, v43
  v_mfma_f32_16x16x32_bf16 a[72:75], a[212:215], v[48:51], a[72:75]
  ds_read_b64_tr_b16 a[184:185], v41 offset:0
  v_xor_b32 v18, 64, v43
  v_mfma_f32_16x16x32_bf16 a[76:79], a[216:219], v[44:47], a[76:79]
  v_xor_b32 v19, 96, v43
  v_mfma_f32_16x16x32_bf16 a[76:79], a[220:223], v[48:51], a[76:79]
  ds_read_b64_tr_b16 a[186:187], v41 offset:2048
  v_mfma_f32_16x16x32_bf16 a[80:83], a[224:227], v[44:47], a[80:83]
  v_mfma_f32_16x16x32_bf16 a[80:83], a[228:231], v[48:51], a[80:83]
  v_mfma_f32_16x16x32_bf16 a[84:87], a[232:235], v[44:47], a[84:87]
  buffer_load_dwordx4 v31, s[8:11], s72 offen offset:3072 nt lds
  v_mfma_f32_16x16x32_bf16 a[84:87], a[236:239], v[48:51], a[84:87]
  v_mfma_f32_16x16x32_bf16 a[88:91], a[240:243], v[44:47], a[88:91]
  s_add_u32 s72, s72, 262144
  s_and_b32 s72, s72, 0x7fffff
  s_add_u32 m0, s1, 2048
  v_mfma_f32_16x16x32_bf16 a[88:91], a[244:247], v[48:51], a[88:91]
  buffer_load_dwordx4 v42, s[20:23], s36 offen nt lds
  v_mfma_f32_16x16x32_bf16 a[92:95], a[248:251], v[44:47], a[92:95]
  s_waitcnt vmcnt(19) lgkmcnt(0)
  v_mfma_f32_16x16x32_bf16 a[92:95], a[252:255], v[48:51], a[92:95]
  s_barrier
  v_mfma_f32_16x16x32_bf16 a[96:99], a[192:195], v[52:55], a[96:99]
  s_add_u32 m0, s65, 98304
  v_mfma_f32_16x16x32_bf16 a[96:99], a[196:199], v[56:59], a[96:99]
  ds_read_b128 v[44:47], v32 offset:49152
  v_mfma_f32_16x16x32_bf16 a[100:103], a[200:203], v[52:55], a[100:103]
  buffer_load_dwordx4 v24, s[4:7], s70 offen offset:0  lds
  v_mfma_f32_16x16x32_bf16 a[100:103], a[204:207], v[56:59], a[100:103]
  ds_read_b128 v[48:51], v33 offset:49152
  v_mfma_f32_16x16x32_bf16 a[104:107], a[208:211], v[52:55], a[104:107]
  s_add_u32 s36, s36, s37
  ds_read_b64_tr_b16 v[64:65], v43 offset:0
  v_mfma_f32_16x16x32_bf16 a[104:107], a[212:215], v[56:59], a[104:107]
  ds_read_b64_tr_b16 v[66:67], v43 offset:2048
  v_mfma_f32_16x16x32_bf16 a[108:111], a[216:219], v[52:55], a[108:111]
  v_mfma_f32_16x16x32_bf16 a[108:111], a[220:223], v[56:59], a[108:111]
  ds_read_b64_tr_b16 v[68:69], v17 offset:0
  v_mfma_f32_16x16x32_bf16 a[112:115], a[224:227], v[52:55], a[112:115]
  ds_read_b64_tr_b16 v[70:71], v17 offset:2048
  v_mfma_f32_16x16x32_bf16 a[112:115], a[228:231], v[56:59], a[112:115]
  ds_read_b64_tr_b16 v[72:73], v18 offset:0
  v_mfma_f32_16x16x32_bf16 a[116:119], a[232:235], v[52:55], a[116:119]
  buffer_load_dwordx4 v25, s[4:7], s70 offen offset:1024  lds
  v_mfma_f32_16x16x32_bf16 a[116:119], a[236:239], v[56:59], a[116:119]
  ds_read_b64_tr_b16 v[74:75], v18 offset:2048
  v_mfma_f32_16x16x32_bf16 a[120:123], a[240:243], v[52:55], a[120:123]
  ds_read_b64_tr_b16 v[76:77], v19 offset:0
  v_mfma_f32_16x16x32_bf16 a[120:123], a[244:247], v[56:59], a[120:123]
  ds_read_b64_tr_b16 v[78:79], v19 offset:2048
  v_mfma_f32_16x16x32_bf16 a[124:127], a[248:251], v[52:55], a[124:127]
  v_xor_b32 v43, s54, v43
  v_mfma_f32_16x16x32_bf16 a[124:127], a[252:255], v[56:59], a[124:127]
  s_waitcnt lgkmcnt(8)
  v_mfma_f32_16x16x32_bf16 v[128:131], a[192:195], v[44:47], v[128:131]
  s_mov_b32 s54, s55
  v_mfma_f32_16x16x32_bf16 v[128:131], a[196:199], v[48:51], v[128:131]
  ds_read_b128 v[52:55], v32 offset:51200
  v_mfma_f32_16x16x32_bf16 v[132:135], a[200:203], v[44:47], v[132:135]
  buffer_load_dwordx4 v26, s[4:7], s70 offen offset:2048  lds
  v_mfma_f32_16x16x32_bf16 v[132:135], a[204:207], v[48:51], v[132:135]
  ds_read_b128 v[56:59], v33 offset:51200
  v_mfma_f32_16x16x32_bf16 v[136:139], a[208:211], v[44:47], v[136:139]
  v_mfma_f32_16x16x32_bf16 v[136:139], a[212:215], v[48:51], v[136:139]
  ds_read_b64_tr_b16 a[132:133], v34 offset:16384
  v_mfma_f32_16x16x32_bf16 v[140:143], a[216:219], v[44:47], v[140:143]
  s_waitcnt lgkmcnt(9)
  buffer_store_dwordx4 v[64:67], v1, s[12:15], s44 offen sc1
  v_mfma_f32_16x16x32_bf16 v[140:143], a[220:223], v[48:51], v[140:143]
  ds_read_b64_tr_b16 a[134:135], v34 offset:18432
  s_add_u32 s44, s44, s48
  v_mfma_f32_16x16x32_bf16 v[144:147], a[224:227], v[44:47], v[144:147]
  v_mfma_f32_16x16x32_bf16 v[144:147], a[228:231], v[48:51], v[144:147]
  ds_read_b64_tr_b16 a[140:141], v35 offset:16384
  v_mfma_f32_16x16x32_bf16 v[148:151], a[232:235], v[44:47], v[148:151]
  buffer_load_dwordx4 v27, s[4:7], s70 offen offset:3072  lds
  v_mfma_f32_16x16x32_bf16 v[148:151], a[236:239], v[48:51], v[148:151]
  ds_read_b64_tr_b16 a[142:143], v35 offset:18432
  v_mfma_f32_16x16x32_bf16 v[152:155], a[240:243], v[44:47], v[152:155]
  v_mfma_f32_16x16x32_bf16 v[152:155], a[244:247], v[48:51], v[152:155]
  ds_read_b64_tr_b16 a[148:149], v36 offset:16384
  v_mfma_f32_16x16x32_bf16 v[156:159], a[248:251], v[44:47], v[156:159]
  s_waitcnt lgkmcnt(11)
  buffer_store_dwordx4 v[68:71], v1, s[12:15], s44 offen sc1
  v_mfma_f32_16x16x32_bf16 v[156:159], a[252:255], v[48:51], v[156:159]
  s_waitcnt lgkmcnt(5)
  ds_read_b64_tr_b16 a[150:151], v36 offset:18432
  s_add_u32 s44, s44, s48
  v_mfma_f32_16x16x32_bf16 v[160:163], a[192:195], v[52:55], v[160:163]
  s_add_u32 m0, s65, 0
  v_mfma_f32_16x16x32_bf16 v[160:163], a[196:199], v[56:59], v[160:163]
  ds_read_b128 v[44:47], v32 offset:53248
  v_mfma_f32_16x16x32_bf16 v[164:167], a[200:203], v[52:55], v[164:167]
  buffer_load_dwordx4 v28, s[8:11], s72 offen offset:0 nt lds
  v_mfma_f32_16x16x32_bf16 v[164:167], a[204:207], v[56:59], v[164:167]
  ds_read_b128 v[48:51], v33 offset:53248
  v_mfma_f32_16x16x32_bf16 v[168:171], a[208:211], v[52:55], v[168:171]
  v_mfma_f32_16x16x32_bf16 v[168:171], a[212:215], v[56:59], v[168:171]
  ds_read_b64_tr_b16 a[156:157], v37 offset:16384
  v_mfma_f32_16x16x32_bf16 v[172:175], a[216:219], v[52:55], v[172:175]
  buffer_store_dwordx4 v[72:75], v1, s[12:15], s44 offen sc1
  v_mfma_f32_16x16x32_bf16 v[172:175], a[220:223], v[56:59], v[172:175]
  ds_read_b64_tr_b16 a[158:159], v37 offset:18432
  s_add_u32 s44, s44, s48
  v_mfma_f32_16x16x32_bf16 v[176:179], a[224:227], v[52:55], v[176:179]
  v_mfma_f32_16x16x32_bf16 v[176:179], a[228:231], v[56:59], v[176:179]
  ds_read_b64_tr_b16 a[164:165], v38 offset:16384
  v_mfma_f32_16x16x32_bf16 v[180:183], a[232:235], v[52:55], v[180:183]
  buffer_load_dwordx4 v29, s[8:11], s72 offen offset:1024 nt lds
  v_mfma_f32_16x16x32_bf16 v[180:183], a[236:239], v[56:59], v[180:183]
  ds_read_b64_tr_b16 a[166:167], v38 offset:18432
  v_mfma_f32_16x16x32_bf16 v[184:187], a[240:243], v[52:55], v[184:187]
  v_mfma_f32_16x16x32_bf16 v[184:187], a[244:247], v[56:59], v[184:187]
  ds_read_b64_tr_b16 a[172:173], v39 offset:16384
  v_mfma_f32_16x16x32_bf16 v[188:191], a[248:251], v[52:55], v[188:191]
  ds_read_b64_tr_b16 a[174:175], v39 offset:18432
  buffer_store_dwordx4 v[76:79], v1, s[12:15], s44 offen sc1
  v_mfma_f32_16x16x32_bf16 v[188:191], a[252:255], v[56:59], v[188:191]
  s_waitcnt lgkmcnt(6)
  ds_read_b64_tr_b16 a[180:181], v40 offset:16384
  v_mfma_f32_16x16x32_bf16 v[192:195], a[192:195], v[44:47], v[192:195]
  v_mfma_f32_16x16x32_bf16 v[192:195], a[196:199], v[48:51], v[192:195]
  ds_read_b128 v[52:55], v32 offset:55296
  v_mfma_f32_16x16x32_bf16 v[196:199], a[200:203], v[44:47], v[196:199]
  buffer_load_dwordx4 v30, s[8:11], s72 offen offset:2048 nt lds
  v_mfma_f32_16x16x32_bf16 v[196:199], a[204:207], v[48:51], v[196:199]
  ds_read_b128 v[56:59], v33 offset:55296
  v_mfma_f32_16x16x32_bf16 v[200:203], a[208:211], v[44:47], v[200:203]
  ds_read_b64_tr_b16 a[182:183], v40 offset:18432
  v_mfma_f32_16x16x32_bf16 v[200:203], a[212:215], v[48:51], v[200:203]
  ds_read_b64_tr_b16 a[188:189], v41 offset:16384
  v_mfma_f32_16x16x32_bf16 v[204:207], a[216:219], v[44:47], v[204:207]
  v_mfma_f32_16x16x32_bf16 v[204:207], a[220:223], v[48:51], v[204:207]
  ds_read_b64_tr_b16 a[190:191], v41 offset:18432
  v_mfma_f32_16x16x32_bf16 v[208:211], a[224:227], v[44:47], v[208:211]
  v_mfma_f32_16x16x32_bf16 v[208:211], a[228:231], v[48:51], v[208:211]
  v_mfma_f32_16x16x32_bf16 v[212:215], a[232:235], v[44:47], v[212:215]
  buffer_load_dwordx4 v31, s[8:11], s72 offen offset:3072 nt lds
  v_mfma_f32_16x16x32_bf16 v[212:215], a[236:239], v[48:51], v[212:215]
  v_mfma_f32_16x16x32_bf16 v[216:219], a[240:243], v[44:47], v[216:219]
  s_add_u32 s72, s72, 262144
  s_and_b32 s72, s72, 0x7fffff
  s_add_u32 m0, s1, 3072
  v_mfma_f32_16x16x32_bf16 v[216:219], a[244:247], v[48:51], v[216:219]
  buffer_load_dwordx4 v42, s[20:23], s36 offen nt lds
  v_mfma_f32_16x16x32_bf16 v[220:223], a[248:251], v[44:47], v[220:223]
  s_waitcnt vmcnt(23) lgkmcnt(0)
  v_mfma_f32_16x16x32_bf16 v[220:223], a[252:255], v[48:51], v[220:223]
  s_barrier
  v_mfma_f32_16x16x32_bf16 v[224:227], a[192:195], v[52:55], v[224:227]
  s_add_u32 m0, s65, 114688
  v_mfma_f32_16x16x32_bf16 v[224:227], a[196:199], v[56:59], v[224:227]
  ds_read_b128 v[44:47], v32 offset:0
  v_mfma_f32_16x16x32_bf16 v[228:231], a[200:203], v[52:55], v[228:231]
  buffer_load_dwordx4 v24, s[4:7], s71 offen offset:0  lds
  v_mfma_f32_16x16x32_bf16 v[228:231], a[204:207], v[56:59], v[228:231]
  ds_read_b128 v[48:51], v33 offset:0
  v_mfma_f32_16x16x32_bf16 v[232:235], a[208:211], v[52:55], v[232:235]
  v_mfma_f32_16x16x32_bf16 v[232:235], a[212:215], v[56:59], v[232:235]
  v_mfma_f32_16x16x32_bf16 v[236:239], a[216:219], v[52:55], v[236:239]
  v_mfma_f32_16x16x32_bf16 v[236:239], a[220:223], v[56:59], v[236:239]
  v_mfma_f32_16x16x32_bf16 v[240:243], a[224:227], v[52:55], v[240:243]
  v_mfma_f32_16x16x32_bf16 v[240:243], a[228:231], v[56:59], v[240:243]
  v_mfma_f32_16x16x32_bf16 v[244:247], a[232:235], v[52:55], v[244:247]
  buffer_load_dwordx4 v25, s[4:7], s71 offen offset:1024  lds
  v_mfma_f32_16x16x32_bf16 v[244:247], a[236:239], v[56:59], v[244:247]
  v_mfma_f32_16x16x32_bf16 v[248:251], a[240:243], v[52:55], v[248:251]
  v_mfma_f32_16x16x32_bf16 v[248:251], a[244:247], v[56:59], v[248:251]
  s_waitcnt lgkmcnt(0)
  v_mfma_f32_16x16x32_bf16 v[252:255], a[248:251], v[52:55], v[252:255]
  s_cmp_lg_u32 s73, 3
  v_mfma_f32_16x16x32_bf16 v[252:255], a[252:255], v[56:59], v[252:255]
  s_cbranch_scc1 L_kf_kernel_aloop_5
  .p2align 6
L_kf_kernel_aloop_6:
  v_mfma_f32_16x16x32_bf16 a[0:3], a[128:131], v[44:47], a[0:3]
  v_mfma_f32_16x16x32_bf16 a[0:3], a[132:135], v[48:51], a[0:3]
  ds_read_b128 v[52:55], v32 offset:2048
  v_mfma_f32_16x16x32_bf16 a[4:7], a[136:139], v[44:47], a[4:7]
  buffer_load_dwordx4 v26, s[4:7], s71 offen offset:2048  lds
  v_mfma_f32_16x16x32_bf16 a[4:7], a[140:143], v[48:51], a[4:7]
  ds_read_b128 v[56:59], v33 offset:2048
  v_mfma_f32_16x16x32_bf16 a[8:11], a[144:147], v[44:47], a[8:11]
  v_mfma_f32_16x16x32_bf16 a[8:11], a[148:151], v[48:51], a[8:11]
  ds_read_b64_tr_b16 a[192:193], v34 offset:32768
  v_mfma_f32_16x16x32_bf16 a[12:15], a[152:155], v[44:47], a[12:15]
  v_mfma_f32_16x16x32_bf16 a[12:15], a[156:159], v[48:51], a[12:15]
  ds_read_b64_tr_b16 a[194:195], v34 offset:34816
  v_mfma_f32_16x16x32_bf16 a[16:19], a[160:163], v[44:47], a[16:19]
  v_mfma_f32_16x16x32_bf16 a[16:19], a[164:167], v[48:51], a[16:19]
  ds_read_b64_tr_b16 a[200:201], v35 offset:32768
  v_mfma_f32_16x16x32_bf16 a[20:23], a[168:171], v[44:47], a[20:23]
  buffer_load_dwordx4 v27, s[4:7], s71 offen offset:3072  lds
  v_mfma_f32_16x16x32_bf16 a[20:23], a[172:175], v[48:51], a[20:23]
  ds_read_b64_tr_b16 a[202:203], v35 offset:34816
  v_mfma_f32_16x16x32_bf16 a[24:27], a[176:179], v[44:47], a[24:27]
  v_mfma_f32_16x16x32_bf16 a[24:27], a[180:183], v[48:51], a[24:27]
  ds_read_b64_tr_b16 a[208:209], v36 offset:32768
  v_mfma_f32_16x16x32_bf16 a[28:31], a[184:187], v[44:47], a[28:31]
  s_add_u32 s70, s70, 128
  s_and_b32 s70, s70, 0x7ff
  v_mfma_f32_16x16x32_bf16 a[28:31], a[188:191], v[48:51], a[28:31]
  s_waitcnt lgkmcnt(5)
  ds_read_b64_tr_b16 a[210:211], v36 offset:34816
  v_mfma_f32_16x16x32_bf16 a[32:35], a[128:131], v[52:55], a[32:35]
  s_add_u32 m0, s65, 16384
  v_mfma_f32_16x16x32_bf16 a[32:35], a[132:135], v[56:59], a[32:35]
  ds_read_b128 v[44:47], v32 offset:4096
  v_mfma_f32_16x16x32_bf16 a[36:39], a[136:139], v[52:55], a[36:39]
  buffer_load_dwordx4 v28, s[8:11], s72 offen offset:0 nt lds
  v_mfma_f32_16x16x32_bf16 a[36:39], a[140:143], v[56:59], a[36:39]
  ds_read_b128 v[48:51], v33 offset:4096
  v_mfma_f32_16x16x32_bf16 a[40:43], a[144:147], v[52:55], a[40:43]
  s_add_u32 s71, s71, 128
  s_and_b32 s71, s71, 0x2007ff
  v_mfma_f32_16x16x32_bf16 a[40:43], a[148:151], v[56:59], a[40:43]
  s_sub_u32 s73, s73, 1
  ds_read_b64_tr_b16 a[216:217], v37 offset:32768
  v_mfma_f32_16x16x32_bf16 a[44:47], a[152:155], v[52:55], a[44:47]
  s_or_b32 s17, s73, s64
  v_mfma_f32_16x16x32_bf16 a[44:47], a[156:159], v[56:59], a[44:47]
  ds_read_b64_tr_b16 a[218:219], v37 offset:34816
  v_mfma_f32_16x16x32_bf16 a[48:51], a[160:163], v[52:55], a[48:51]
  s_cselect_b32 s17, 2147418112, 0
  v_mfma_f32_16x16x32_bf16 a[48:51], a[164:167], v[56:59], a[48:51]
  s_cmp_eq_u32 s73, 2
  ds_read_b64_tr_b16 a[224:225], v38 offset:32768
  v_mfma_f32_16x16x32_bf16 a[52:55], a[168:171], v[52:55], a[52:55]
  s_cselect_b32 s101, s62, 2147418112
  buffer_load_dwordx4 v29, s[8:11], s72 offen offset:1024 nt lds
  v_mfma_f32_16x16x32_bf16 a[52:55], a[172:175], v[56:59], a[52:55]
  ds_read_b64_tr_b16 a[226:227], v38 offset:34816
  v_mfma_f32_16x16x32_bf16 a[56:59], a[176:179], v[52:55], a[56:59]
  v_mfma_f32_16x16x32_bf16 a[56:59], a[180:183], v[56:59], a[56:59]
  ds_read_b64_tr_b16 a[232:233], v39 offset:32768
  v_mfma_f32_16x16x32_bf16 a[60:63], a[184:187], v[52:55], a[60:63]
  ds_read_b64_tr_b16 a[234:235], v39 offset:34816
  v_mfma_f32_16x16x32_bf16 a[60:63], a[188:191], v[56:59], a[60:63]
  s_waitcnt lgkmcnt(6)
  ds_read_b64_tr_b16 a[240:241], v40 offset:32768
  v_mfma_f32_16x16x32_bf16 a[64:67], a[128:131], v[44:47], a[64:67]
  v_mfma_f32_16x16x32_bf16 a[64:67], a[132:135], v[48:51], a[64:67]
  ds_read_b128 v[52:55], v32 offset:6144
  v_mfma_f32_16x16x32_bf16 a[68:71], a[136:139], v[44:47], a[68:71]
  buffer_load_dwordx4 v30, s[8:11], s72 offen offset:2048 nt lds
  v_mfma_f32_16x16x32_bf16 a[68:71], a[140:143], v[48:51], a[68:71]
  ds_read_b128 v[56:59], v33 offset:6144
  v_mfma_f32_16x16x32_bf16 a[72:75], a[144:147], v[44:47], a[72:75]
  ds_read_b64_tr_b16 a[242:243], v40 offset:34816
  v_mfma_f32_16x16x32_bf16 a[72:75], a[148:151], v[48:51], a[72:75]
  ds_read_b64_tr_b16 a[248:249], v41 offset:32768
  v_mfma_f32_16x16x32_bf16 a[76:79], a[152:155], v[44:47], a[76:79]
  v_mfma_f32_16x16x32_bf16 a[76:79], a[156:159], v[48:51], a[76:79]
  ds_read_b64_tr_b16 a[250:251], v41 offset:34816
  v_mfma_f32_16x16x32_bf16 a[80:83], a[160:163], v[44:47], a[80:83]
  v_mfma_f32_16x16x32_bf16 a[80:83], a[164:167], v[48:51], a[80:83]
  v_mfma_f32_16x16x32_bf16 a[84:87], a[168:171], v[44:47], a[84:87]
  buffer_load_dwordx4 v31, s[8:11], s72 offen offset:3072 nt lds
  v_mfma_f32_16x16x32_bf16 a[84:87], a[172:175], v[48:51], a[84:87]
  v_mfma_f32_16x16x32_bf16 a[88:91], a[176:179], v[44:47], a[88:91]
  s_add_u32 s72, s72, 262144
  s_and_b32 s72, s72, 0x7fffff
  v_mfma_f32_16x16x32_bf16 a[88:91], a[180:183], v[48:51], a[88:91]
  v_mfma_f32_16x16x32_bf16 a[92:95], a[184:187], v[44:47], a[92:95]
  s_waitcnt vmcnt(16) lgkmcnt(0)
  v_mfma_f32_16x16x32_bf16 a[92:95], a[188:191], v[48:51], a[92:95]
  s_barrier
  v_mfma_f32_16x16x32_bf16 a[96:99], a[128:131], v[52:55], a[96:99]
  s_add_u32 m0, s65, 65536
  v_mfma_f32_16x16x32_bf16 a[96:99], a[132:135], v[56:59], a[96:99]
  ds_read_b128 v[44:47], v32 offset:16384
  v_mfma_f32_16x16x32_bf16 a[100:103], a[136:139], v[52:55], a[100:103]
  buffer_load_dwordx4 v24, s[4:7], s70 offen offset:0  lds
  v_mfma_f32_16x16x32_bf16 a[100:103], a[140:143], v[56:59], a[100:103]
  ds_read_b128 v[48:51], v33 offset:16384
  v_mfma_f32_16x16x32_bf16 a[104:107], a[144:147], v[52:55], a[104:107]
  v_mfma_f32_16x16x32_bf16 a[104:107], a[148:151], v[56:59], a[104:107]
  v_mfma_f32_16x16x32_bf16 a[108:111], a[152:155], v[52:55], a[108:111]
  v_mfma_f32_16x16x32_bf16 a[108:111], a[156:159], v[56:59], a[108:111]
  v_mfma_f32_16x16x32_bf16 a[112:115], a[160:163], v[52:55], a[112:115]
  v_mfma_f32_16x16x32_bf16 a[112:115], a[164:167], v[56:59], a[112:115]
  v_mfma_f32_16x16x32_bf16 a[116:119], a[168:171], v[52:55], a[116:119]
  buffer_load_dwordx4 v25, s[4:7], s70 offen offset:1024  lds
  v_mfma_f32_16x16x32_bf16 a[116:119], a[172:175], v[56:59], a[116:119]
  v_mfma_f32_16x16x32_bf16 a[120:123], a[176:179], v[52:55], a[120:123]
  v_mfma_f32_16x16x32_bf16 a[120:123], a[180:183], v[56:59], a[120:123]
  v_mfma_f32_16x16x32_bf16 a[124:127], a[184:187], v[52:55], a[124:127]
  v_mfma_f32_16x16x32_bf16 a[124:127], a[188:191], v[56:59], a[124:127]
  s_waitcnt lgkmcnt(0)
  v_mfma_f32_16x16x32_bf16 v[128:131], a[128:131], v[44:47], v[128:131]
  v_mfma_f32_16x16x32_bf16 v[128:131], a[132:135], v[48:51], v[128:131]
  ds_read_b128 v[52:55], v32 offset:18432
  v_mfma_f32_16x16x32_bf16 v[132:135], a[136:139], v[44:47], v[132:135]
  buffer_load_dwordx4 v26, s[4:7], s70 offen offset:2048  lds
  v_mfma_f32_16x16x32_bf16 v[132:135], a[140:143], v[48:51], v[132:135]
  ds_read_b128 v[56:59], v33 offset:18432
  v_mfma_f32_16x16x32_bf16 v[136:139], a[144:147], v[44:47], v[136:139]
  v_mfma_f32_16x16x32_bf16 v[136:139], a[148:151], v[48:51], v[136:139]
  ds_read_b64_tr_b16 a[196:197], v34 offset:49152
  v_mfma_f32_16x16x32_bf16 v[140:143], a[152:155], v[44:47], v[140:143]
  v_mfma_f32_16x16x32_bf16 v[140:143], a[156:159], v[48:51], v[140:143]
  ds_read_b64_tr_b16 a[198:199], v34 offset:51200
  v_mfma_f32_16x16x32_bf16 v[144:147], a[160:163], v[44:47], v[144:147]
  v_mfma_f32_16x16x32_bf16 v[144:147], a[164:167], v[48:51], v[144:147]
  ds_read_b64_tr_b16 a[204:205], v35 offset:49152
  v_mfma_f32_16x16x32_bf16 v[148:151], a[168:171], v[44:47], v[148:151]
  buffer_load_dwordx4 v27, s[4:7], s70 offen offset:3072  lds
  v_mfma_f32_16x16x32_bf16 v[148:151], a[172:175], v[48:51], v[148:151]
  ds_read_b64_tr_b16 a[206:207], v35 offset:51200
  v_mfma_f32_16x16x32_bf16 v[152:155], a[176:179], v[44:47], v[152:155]
  v_mfma_f32_16x16x32_bf16 v[152:155], a[180:183], v[48:51], v[152:155]
  ds_read_b64_tr_b16 a[212:213], v36 offset:49152
  v_mfma_f32_16x16x32_bf16 v[156:159], a[184:187], v[44:47], v[156:159]
  v_mfma_f32_16x16x32_bf16 v[156:159], a[188:191], v[48:51], v[156:159]
  s_waitcnt lgkmcnt(5)
  ds_read_b64_tr_b16 a[214:215], v36 offset:51200
  v_mfma_f32_16x16x32_bf16 v[160:163], a[128:131], v[52:55], v[160:163]
  s_add_u32 m0, s65, 32768
  v_mfma_f32_16x16x32_bf16 v[160:163], a[132:135], v[56:59], v[160:163]
  ds_read_b128 v[44:47], v32 offset:20480
  v_mfma_f32_16x16x32_bf16 v[164:167], a[136:139], v[52:55], v[164:167]
  buffer_load_dwordx4 v28, s[8:11], s72 offen offset:0 nt lds
  v_mfma_f32_16x16x32_bf16 v[164:167], a[140:143], v[56:59], v[164:167]
  ds_read_b128 v[48:51], v33 offset:20480
  v_mfma_f32_16x16x32_bf16 v[168:171], a[144:147], v[52:55], v[168:171]
  v_mfma_f32_16x16x32_bf16 v[168:171], a[148:151], v[56:59], v[168:171]
  ds_read_b64_tr_b16 a[220:221], v37 offset:49152
  v_mfma_f32_16x16x32_bf16 v[172:175], a[152:155], v[52:55], v[172:175]
  v_mfma_f32_16x16x32_bf16 v[172:175], a[156:159], v[56:59], v[172:175]
  ds_read_b64_tr_b16 a[222:223], v37 offset:51200
  v_mfma_f32_16x16x32_bf16 v[176:179], a[160:163], v[52:55], v[176:179]
  v_mfma_f32_16x16x32_bf16 v[176:179], a[164:167], v[56:59], v[176:179]
  ds_read_b64_tr_b16 a[228:229], v38 offset:49152
  v_mfma_f32_16x16x32_bf16 v[180:183], a[168:171], v[52:55], v[180:183]
  buffer_load_dwordx4 v29, s[8:11], s72 offen offset:1024 nt lds
  v_mfma_f32_16x16x32_bf16 v[180:183], a[172:175], v[56:59], v[180:183]
  ds_read_b64_tr_b16 a[230:231], v38 offset:51200
  v_mfma_f32_16x16x32_bf16 v[184:187], a[176:179], v[52:55], v[184:187]
  v_mfma_f32_16x16x32_bf16 v[184:187], a[180:183], v[56:59], v[184:187]
  ds_read_b64_tr_b16 a[236:237], v39 offset:49152
  v_mfma_f32_16x16x32_bf16 v[188:191], a[184:187], v[52:55], v[188:191]
  ds_read_b64_tr_b16 a[238:239], v39 offset:51200
  v_mfma_f32_16x16x32_bf16 v[188:191], a[188:191], v[56:59], v[188:191]
  s_waitcnt lgkmcnt(6)
  ds_read_b64_tr_b16 a[244:245], v40 offset:49152
  v_mfma_f32_16x16x32_bf16 v[192:195], a[128:131], v[44:47], v[192:195]
  v_mfma_f32_16x16x32_bf16 v[192:195], a[132:135], v[48:51], v[192:195]
  ds_read_b128 v[52:55], v32 offset:22528
  v_mfma_f32_16x16x32_bf16 v[196:199], a[136:139], v[44:47], v[196:199]
  buffer_load_dwordx4 v30, s[8:11], s72 offen offset:2048 nt lds
  v_mfma_f32_16x16x32_bf16 v[196:199], a[140:143], v[48:51], v[196:199]
  ds_read_b128 v[56:59], v33 offset:22528
  v_mfma_f32_16x16x32_bf16 v[200:203], a[144:147], v[44:47], v[200:203]
  ds_read_b64_tr_b16 a[246:247], v40 offset:51200
  v_mfma_f32_16x16x32_bf16 v[200:203], a[148:151], v[48:51], v[200:203]
  ds_read_b64_tr_b16 a[252:253], v41 offset:49152
  v_mfma_f32_16x16x32_bf16 v[204:207], a[152:155], v[44:47], v[204:207]
  v_mfma_f32_16x16x32_bf16 v[204:207], a[156:159], v[48:51], v[204:207]
  ds_read_b64_tr_b16 a[254:255], v41 offset:51200
  v_mfma_f32_16x16x32_bf16 v[208:211], a[160:163], v[44:47], v[208:211]
  v_mfma_f32_16x16x32_bf16 v[208:211], a[164:167], v[48:51], v[208:211]
  v_mfma_f32_16x16x32_bf16 v[212:215], a[168:171], v[44:47], v[212:215]
  buffer_load_dwordx4 v31, s[8:11], s72 offen offset:3072 nt lds
  v_mfma_f32_16x16x32_bf16 v[212:215], a[172:175], v[48:51], v[212:215]
  v_mfma_f32_16x16x32_bf16 v[216:219], a[176:179], v[44:47], v[216:219]
  s_add_u32 s72, s72, 262144
  s_and_b32 s72, s72, 0x7fffff
  v_mfma_f32_16x16x32_bf16 v[216:219], a[180:183], v[48:51], v[216:219]
  v_mfma_f32_16x16x32_bf16 v[220:223], a[184:187], v[44:47], v[220:223]
  s_waitcnt vmcnt(16) lgkmcnt(0)
  v_mfma_f32_16x16x32_bf16 v[220:223], a[188:191], v[48:51], v[220:223]
  s_barrier
  v_mfma_f32_16x16x32_bf16 v[224:227], a[128:131], v[52:55], v[224:227]
  s_add_u32 m0, s65, 81920
  v_mfma_f32_16x16x32_bf16 v[224:227], a[132:135], v[56:59], v[224:227]
  ds_read_b128 v[44:47], v32 offset:32768
  v_mfma_f32_16x16x32_bf16 v[228:231], a[136:139], v[52:55], v[228:231]
  buffer_load_dwordx4 v24, s[4:7], s71 offen offset:0  lds
  v_mfma_f32_16x16x32_bf16 v[228:231], a[140:143], v[56:59], v[228:231]
  ds_read_b128 v[48:51], v33 offset:32768
  v_mfma_f32_16x16x32_bf16 v[232:235], a[144:147], v[52:55], v[232:235]
  v_mfma_f32_16x16x32_bf16 v[232:235], a[148:151], v[56:59], v[232:235]
  v_mfma_f32_16x16x32_bf16 v[236:239], a[152:155], v[52:55], v[236:239]
  v_mfma_f32_16x16x32_bf16 v[236:239], a[156:159], v[56:59], v[236:239]
  v_mfma_f32_16x16x32_bf16 v[240:243], a[160:163], v[52:55], v[240:243]
  v_mfma_f32_16x16x32_bf16 v[240:243], a[164:167], v[56:59], v[240:243]
  v_mfma_f32_16x16x32_bf16 v[244:247], a[168:171], v[52:55], v[244:247]
  buffer_load_dwordx4 v25, s[4:7], s71 offen offset:1024  lds
  v_mfma_f32_16x16x32_bf16 v[244:247], a[172:175], v[56:59], v[244:247]
  v_mfma_f32_16x16x32_bf16 v[248:251], a[176:179], v[52:55], v[248:251]
  v_mfma_f32_16x16x32_bf16 v[248:251], a[180:183], v[56:59], v[248:251]
  v_mfma_f32_16x16x32_bf16 v[252:255], a[184:187], v[52:55], v[252:255]
  buffer_atomic_add v11, v10, s[24:27], s101 offen sc1
  v_mfma_f32_16x16x32_bf16 v[252:255], a[188:191], v[56:59], v[252:255]
  s_waitcnt lgkmcnt(0)
  v_mfma_f32_16x16x32_bf16 a[0:3], a[192:195], v[44:47], a[0:3]
  v_mfma_f32_16x16x32_bf16 a[0:3], a[196:199], v[48:51], a[0:3]
  ds_read_b128 v[52:55], v32 offset:34816
  v_mfma_f32_16x16x32_bf16 a[4:7], a[200:203], v[44:47], a[4:7]
  buffer_load_dwordx4 v26, s[4:7], s71 offen offset:2048  lds
  v_mfma_f32_16x16x32_bf16 a[4:7], a[204:207], v[48:51], a[4:7]
  ds_read_b128 v[56:59], v33 offset:34816
  v_mfma_f32_16x16x32_bf16 a[8:11], a[208:211], v[44:47], a[8:11]
  v_mfma_f32_16x16x32_bf16 a[8:11], a[212:215], v[48:51], a[8:11]
  ds_read_b64_tr_b16 a[128:129], v34 offset:0
  v_mfma_f32_16x16x32_bf16 a[12:15], a[216:219], v[44:47], a[12:15]
  v_mfma_f32_16x16x32_bf16 a[12:15], a[220:223], v[48:51], a[12:15]
  ds_read_b64_tr_b16 a[130:131], v34 offset:2048
  v_mfma_f32_16x16x32_bf16 a[16:19], a[224:227], v[44:47], a[16:19]
  v_mfma_f32_16x16x32_bf16 a[16:19], a[228:231], v[48:51], a[16:19]
  ds_read_b64_tr_b16 a[136:137], v35 offset:0
  v_mfma_f32_16x16x32_bf16 a[20:23], a[232:235], v[44:47], a[20:23]
  buffer_load_dwordx4 v27, s[4:7], s71 offen offset:3072  lds
  v_mfma_f32_16x16x32_bf16 a[20:23], a[236:239], v[48:51], a[20:23]
  ds_read_b64_tr_b16 a[138:139], v35 offset:2048
  v_mfma_f32_16x16x32_bf16 a[24:27], a[240:243], v[44:47], a[24:27]
  v_mfma_f32_16x16x32_bf16 a[24:27], a[244:247], v[48:51], a[24:27]
  ds_read_b64_tr_b16 a[144:145], v36 offset:0
  v_mfma_f32_16x16x32_bf16 a[28:31], a[248:251], v[44:47], a[28:31]
  s_add_u32 s70, s70, 128
  s_and_b32 s70, s70, 0x7ff
  v_mfma_f32_16x16x32_bf16 a[28:31], a[252:255], v[48:51], a[28:31]
  s_waitcnt lgkmcnt(5)
  ds_read_b64_tr_b16 a[146:147], v36 offset:2048
  v_mfma_f32_16x16x32_bf16 a[32:35], a[192:195], v[52:55], a[32:35]
  s_add_u32 m0, s65, 49152
  v_mfma_f32_16x16x32_bf16 a[32:35], a[196:199], v[56:59], a[32:35]
  ds_read_b128 v[44:47], v32 offset:36864
  v_mfma_f32_16x16x32_bf16 a[36:39], a[200:203], v[52:55], a[36:39]
  buffer_load_dwordx4 v28, s[8:11], s72 offen offset:0 nt lds
  v_mfma_f32_16x16x32_bf16 a[36:39], a[204:207], v[56:59], a[36:39]
  ds_read_b128 v[48:51], v33 offset:36864
  v_mfma_f32_16x16x32_bf16 a[40:43], a[208:211], v[52:55], a[40:43]
  s_add_u32 s71, s71, 128
  s_and_b32 s71, s71, 0x2007ff
  v_mfma_f32_16x16x32_bf16 a[40:43], a[212:215], v[56:59], a[40:43]
  ds_read_b64_tr_b16 a[152:153], v37 offset:0
  v_mfma_f32_16x16x32_bf16 a[44:47], a[216:219], v[52:55], a[44:47]
  buffer_load_dword v12, v13, s[24:27], s17 offen sc1
  v_mfma_f32_16x16x32_bf16 a[44:47], a[220:223], v[56:59], a[44:47]
  ds_read_b64_tr_b16 a[154:155], v37 offset:2048
  v_mfma_f32_16x16x32_bf16 a[48:51], a[224:227], v[52:55], a[48:51]
  v_mfma_f32_16x16x32_bf16 a[48:51], a[228:231], v[56:59], a[48:51]
  ds_read_b64_tr_b16 a[160:161], v38 offset:0
  v_mfma_f32_16x16x32_bf16 a[52:55], a[232:235], v[52:55], a[52:55]
  buffer_load_dwordx4 v29, s[8:11], s72 offen offset:1024 nt lds
  v_mfma_f32_16x16x32_bf16 a[52:55], a[236:239], v[56:59], a[52:55]
  ds_read_b64_tr_b16 a[162:163], v38 offset:2048
  v_mfma_f32_16x16x32_bf16 a[56:59], a[240:243], v[52:55], a[56:59]
  v_mfma_f32_16x16x32_bf16 a[56:59], a[244:247], v[56:59], a[56:59]
  ds_read_b64_tr_b16 a[168:169], v39 offset:0
  v_mfma_f32_16x16x32_bf16 a[60:63], a[248:251], v[52:55], a[60:63]
  ds_read_b64_tr_b16 a[170:171], v39 offset:2048
  v_mfma_f32_16x16x32_bf16 a[60:63], a[252:255], v[56:59], a[60:63]
  s_waitcnt lgkmcnt(6)
  ds_read_b64_tr_b16 a[176:177], v40 offset:0
  v_mfma_f32_16x16x32_bf16 a[64:67], a[192:195], v[44:47], a[64:67]
  v_mfma_f32_16x16x32_bf16 a[64:67], a[196:199], v[48:51], a[64:67]
  ds_read_b128 v[52:55], v32 offset:38912
  v_mfma_f32_16x16x32_bf16 a[68:71], a[200:203], v[44:47], a[68:71]
  buffer_load_dwordx4 v30, s[8:11], s72 offen offset:2048 nt lds
  v_mfma_f32_16x16x32_bf16 a[68:71], a[204:207], v[48:51], a[68:71]
  ds_read_b128 v[56:59], v33 offset:38912
  v_mfma_f32_16x16x32_bf16 a[72:75], a[208:211], v[44:47], a[72:75]
  ds_read_b64_tr_b16 a[178:179], v40 offset:2048
  v_mfma_f32_16x16x32_bf16 a[72:75], a[212:215], v[48:51], a[72:75]
  ds_read_b64_tr_b16 a[184:185], v41 offset:0
  v_mfma_f32_16x16x32_bf16 a[76:79], a[216:219], v[44:47], a[76:79]
  v_mfma_f32_16x16x32_bf16 a[76:79], a[220:223], v[48:51], a[76:79]
  ds_read_b64_tr_b16 a[186:187], v41 offset:2048
  v_mfma_f32_16x16x32_bf16 a[80:83], a[224:227], v[44:47], a[80:83]
  v_mfma_f32_16x16x32_bf16 a[80:83], a[228:231], v[48:51], a[80:83]
  v_mfma_f32_16x16x32_bf16 a[84:87], a[232:235], v[44:47], a[84:87]
  buffer_load_dwordx4 v31, s[8:11], s72 offen offset:3072 nt lds
  v_mfma_f32_16x16x32_bf16 a[84:87], a[236:239], v[48:51], a[84:87]
  v_mfma_f32_16x16x32_bf16 a[88:91], a[240:243], v[44:47], a[88:91]
  s_add_u32 s72, s72, 262144
  s_and_b32 s72, s72, 0x7fffff
  v_mfma_f32_16x16x32_bf16 a[88:91], a[244:247], v[48:51], a[88:91]
  v_mfma_f32_16x16x32_bf16 a[92:95], a[248:251], v[44:47], a[92:95]
  s_waitcnt vmcnt(18) lgkmcnt(0)
  v_mfma_f32_16x16x32_bf16 a[92:95], a[252:255], v[48:51], a[92:95]
  s_barrier
  v_mfma_f32_16x16x32_bf16 a[96:99], a[192:195], v[52:55], a[96:99]
  s_add_u32 m0, s65, 98304
  v_mfma_f32_16x16x32_bf16 a[96:99], a[196:199], v[56:59], a[96:99]
  ds_read_b128 v[44:47], v32 offset:49152
  v_mfma_f32_16x16x32_bf16 a[100:103], a[200:203], v[52:55], a[100:103]
  buffer_load_dwordx4 v24, s[4:7], s70 offen offset:0  lds
  v_mfma_f32_16x16x32_bf16 a[100:103], a[204:207], v[56:59], a[100:103]
  ds_read_b128 v[48:51], v33 offset:49152
  v_mfma_f32_16x16x32_bf16 a[104:107], a[208:211], v[52:55], a[104:107]
  v_mfma_f32_16x16x32_bf16 a[104:107], a[212:215], v[56:59], a[104:107]
  v_mfma_f32_16x16x32_bf16 a[108:111], a[216:219], v[52:55], a[108:111]
  v_mfma_f32_16x16x32_bf16 a[108:111], a[220:223], v[56:59], a[108:111]
  v_mfma_f32_16x16x32_bf16 a[112:115], a[224:227], v[52:55], a[112:115]
  v_mfma_f32_16x16x32_bf16 a[112:115], a[228:231], v[56:59], a[112:115]
  v_mfma_f32_16x16x32_bf16 a[116:119], a[232:235], v[52:55], a[116:119]
  buffer_load_dwordx4 v25, s[4:7], s70 offen offset:1024  lds
  v_mfma_f32_16x16x32_bf16 a[116:119], a[236:239], v[56:59], a[116:119]
  v_mfma_f32_16x16x32_bf16 a[120:123], a[240:243], v[52:55], a[120:123]
  v_mfma_f32_16x16x32_bf16 a[120:123], a[244:247], v[56:59], a[120:123]
  v_mfma_f32_16x16x32_bf16 a[124:127], a[248:251], v[52:55], a[124:127]
  v_mfma_f32_16x16x32_bf16 a[124:127], a[252:255], v[56:59], a[124:127]
  s_waitcnt lgkmcnt(0)
  v_mfma_f32_16x16x32_bf16 v[128:131], a[192:195], v[44:47], v[128:131]
  v_mfma_f32_16x16x32_bf16 v[128:131], a[196:199], v[48:51], v[128:131]
  ds_read_b128 v[52:55], v32 offset:51200
  v_mfma_f32_16x16x32_bf16 v[132:135], a[200:203], v[44:47], v[132:135]
  buffer_load_dwordx4 v26, s[4:7], s70 offen offset:2048  lds
  v_mfma_f32_16x16x32_bf16 v[132:135], a[204:207], v[48:51], v[132:135]
  ds_read_b128 v[56:59], v33 offset:51200
  v_mfma_f32_16x16x32_bf16 v[136:139], a[208:211], v[44:47], v[136:139]
  v_mfma_f32_16x16x32_bf16 v[136:139], a[212:215], v[48:51], v[136:139]
  ds_read_b64_tr_b16 a[132:133], v34 offset:16384
  v_mfma_f32_16x16x32_bf16 v[140:143], a[216:219], v[44:47], v[140:143]
  v_mfma_f32_16x16x32_bf16 v[140:143], a[220:223], v[48:51], v[140:143]
  ds_read_b64_tr_b16 a[134:135], v34 offset:18432
  v_mfma_f32_16x16x32_bf16 v[144:147], a[224:227], v[44:47], v[144:147]
  v_mfma_f32_16x16x32_bf16 v[144:147], a[228:231], v[48:51], v[144:147]
  ds_read_b64_tr_b16 a[140:141], v35 offset:16384
  v_mfma_f32_16x16x32_bf16 v[148:151], a[232:235], v[44:47], v[148:151]
  buffer_load_dwordx4 v27, s[4:7], s70 offen offset:3072  lds
  v_mfma_f32_16x16x32_bf16 v[148:151], a[236:239], v[48:51], v[148:151]
  ds_read_b64_tr_b16 a[142:143], v35 offset:18432
  v_mfma_f32_16x16x32_bf16 v[152:155], a[240:243], v[44:47], v[152:155]
  v_mfma_f32_16x16x32_bf16 v[152:155], a[244:247], v[48:51], v[152:155]
  ds_read_b64_tr_b16 a[148:149], v36 offset:16384
  v_mfma_f32_16x16x32_bf16 v[156:159], a[248:251], v[44:47], v[156:159]
  v_mfma_f32_16x16x32_bf16 v[156:159], a[252:255], v[48:51], v[156:159]
  s_waitcnt lgkmcnt(5)
  ds_read_b64_tr_b16 a[150:151], v36 offset:18432
  v_mfma_f32_16x16x32_bf16 v[160:163], a[192:195], v[52:55], v[160:163]
  s_add_u32 m0, s65, 0
  v_mfma_f32_16x16x32_bf16 v[160:163], a[196:199], v[56:59], v[160:163]
  ds_read_b128 v[44:47], v32 offset:53248
  v_mfma_f32_16x16x32_bf16 v[164:167], a[200:203], v[52:55], v[164:167]
  buffer_load_dwordx4 v28, s[8:11], s72 offen offset:0 nt lds
  v_mfma_f32_16x16x32_bf16 v[164:167], a[204:207], v[56:59], v[164:167]
  ds_read_b128 v[48:51], v33 offset:53248
  v_mfma_f32_16x16x32_bf16 v[168:171], a[208:211], v[52:55], v[168:171]
  v_mfma_f32_16x16x32_bf16 v[168:171], a[212:215], v[56:59], v[168:171]
  ds_read_b64_tr_b16 a[156:157], v37 offset:16384
  v_mfma_f32_16x16x32_bf16 v[172:175], a[216:219], v[52:55], v[172:175]
  v_mfma_f32_16x16x32_bf16 v[172:175], a[220:223], v[56:59], v[172:175]
  ds_read_b64_tr_b16 a[158:159], v37 offset:18432
  v_mfma_f32_16x16x32_bf16 v[176:179], a[224:227], v[52:55], v[176:179]
  v_mfma_f32_16x16x32_bf16 v[176:179], a[228:231], v[56:59], v[176:179]
  ds_read_b64_tr_b16 a[164:165], v38 offset:16384
  v_mfma_f32_16x16x32_bf16 v[180:183], a[232:235], v[52:55], v[180:183]
  buffer_load_dwordx4 v29, s[8:11], s72 offen offset:1024 nt lds
  v_mfma_f32_16x16x32_bf16 v[180:183], a[236:239], v[56:59], v[180:183]
  ds_read_b64_tr_b16 a[166:167], v38 offset:18432
  v_mfma_f32_16x16x32_bf16 v[184:187], a[240:243], v[52:55], v[184:187]
  v_mfma_f32_16x16x32_bf16 v[184:187], a[244:247], v[56:59], v[184:187]
  ds_read_b64_tr_b16 a[172:173], v39 offset:16384
  v_mfma_f32_16x16x32_bf16 v[188:191], a[248:251], v[52:55], v[188:191]
  ds_read_b64_tr_b16 a[174:175], v39 offset:18432
  v_mfma_f32_16x16x32_bf16 v[188:191], a[252:255], v[56:59], v[188:191]
  s_waitcnt lgkmcnt(6)
  ds_read_b64_tr_b16 a[180:181], v40 offset:16384
  v_mfma_f32_16x16x32_bf16 v[192:195], a[192:195], v[44:47], v[192:195]
  v_mfma_f32_16x16x32_bf16 v[192:195], a[196:199], v[48:51], v[192:195]
  ds_read_b128 v[52:55], v32 offset:55296
  v_mfma_f32_16x16x32_bf16 v[196:199], a[200:203], v[44:47], v[196:199]
  buffer_load_dwordx4 v30, s[8:11], s72 offen offset:2048 nt lds
  v_mfma_f32_16x16x32_bf16 v[196:199], a[204:207], v[48:51], v[196:199]
  ds_read_b128 v[56:59], v33 offset:55296
  v_mfma_f32_16x16x32_bf16 v[200:203], a[208:211], v[44:47], v[200:203]
  ds_read_b64_tr_b16 a[182:183], v40 offset:18432
  v_mfma_f32_16x16x32_bf16 v[200:203], a[212:215], v[48:51], v[200:203]
  ds_read_b64_tr_b16 a[188:189], v41 offset:16384
  v_mfma_f32_16x16x32_bf16 v[204:207], a[216:219], v[44:47], v[204:207]
  v_mfma_f32_16x16x32_bf16 v[204:207], a[220:223], v[48:51], v[204:207]
  ds_read_b64_tr_b16 a[190:191], v41 offset:18432
  v_mfma_f32_16x16x32_bf16 v[208:211], a[224:227], v[44:47], v[208:211]
  v_mfma_f32_16x16x32_bf16 v[208:211], a[228:231], v[48:51], v[208:211]
  v_mfma_f32_16x16x32_bf16 v[212:215], a[232:235], v[44:47], v[212:215]
  buffer_load_dwordx4 v31, s[8:11], s72 offen offset:3072 nt lds
  v_mfma_f32_16x16x32_bf16 v[212:215], a[236:239], v[48:51], v[212:215]
  v_mfma_f32_16x16x32_bf16 v[216:219], a[240:243], v[44:47], v[216:219]
  s_add_u32 s72, s72, 262144
  s_and_b32 s72, s72, 0x7fffff
  v_mfma_f32_16x16x32_bf16 v[216:219], a[244:247], v[48:51], v[216:219]
  v_mfma_f32_16x16x32_bf16 v[220:223], a[248:251], v[44:47], v[220:223]
  s_waitcnt vmcnt(18) lgkmcnt(0)
  v_mfma_f32_16x16x32_bf16 v[220:223], a[252:255], v[48:51], v[220:223]
  s_barrier
  v_mfma_f32_16x16x32_bf16 v[224:227], a[192:195], v[52:55], v[224:227]
  s_add_u32 m0, s65, 114688
  v_mfma_f32_16x16x32_bf16 v[224:227], a[196:199], v[56:59], v[224:227]
  ds_read_b128 v[44:47], v32 offset:0
  v_mfma_f32_16x16x32_bf16 v[228:231], a[200:203], v[52:55], v[228:231]
  buffer_load_dwordx4 v24, s[4:7], s71 offen offset:0  lds
  v_mfma_f32_16x16x32_bf16 v[228:231], a[204:207], v[56:59], v[228:231]
  ds_read_b128 v[48:51], v33 offset:0
  v_mfma_f32_16x16x32_bf16 v[232:235], a[208:211], v[52:55], v[232:235]
  v_mfma_f32_16x16x32_bf16 v[232:235], a[212:215], v[56:59], v[232:235]
  v_mfma_f32_16x16x32_bf16 v[236:239], a[216:219], v[52:55], v[236:239]
  v_mfma_f32_16x16x32_bf16 v[236:239], a[220:223], v[56:59], v[236:239]
  v_mfma_f32_16x16x32_bf16 v[240:243], a[224:227], v[52:55], v[240:243]
  v_mfma_f32_16x16x32_bf16 v[240:243], a[228:231], v[56:59], v[240:243]
  v_mfma_f32_16x16x32_bf16 v[244:247], a[232:235], v[52:55], v[244:247]
  buffer_load_dwordx4 v25, s[4:7], s71 offen offset:1024  lds
  v_mfma_f32_16x16x32_bf16 v[244:247], a[236:239], v[56:59], v[244:247]
  v_mfma_f32_16x16x32_bf16 v[248:251], a[240:243], v[52:55], v[248:251]
  v_mfma_f32_16x16x32_bf16 v[248:251], a[244:247], v[56:59], v[248:251]
  s_waitcnt lgkmcnt(0)
  v_mfma_f32_16x16x32_bf16 v[252:255], a[248:251], v[52:55], v[252:255]
  s_cmp_lg_u32 s73, 0
  v_mfma_f32_16x16x32_bf16 v[252:255], a[252:255], v[56:59], v[252:255]
  s_cbranch_scc1 L_kf_kernel_aloop_6
  v_mfma_f32_16x16x32_bf16 a[0:3], a[128:131], v[44:47], a[0:3]
  s_getreg_b32 s51, hwreg(HW_REG_XCC_ID, 0, 4)
  ds_read_b64_tr_b16 a[192:193], v34 offset:32768
  v_mfma_f32_16x16x32_bf16 a[0:3], a[132:135], v[48:51], a[0:3]
  s_add_u32 s51, s51, 1
  ds_read_b128 v[52:55], v32 offset:2048
  v_mfma_f32_16x16x32_bf16 a[4:7], a[136:139], v[44:47], a[4:7]
  s_mul_i32 s51, s51, 0x1010101
  buffer_load_dwordx4 v26, s[4:7], s71 offen offset:2048  lds
  v_mfma_f32_16x16x32_bf16 a[4:7], a[140:143], v[48:51], a[4:7]
  ds_read_b128 v[56:59], v33 offset:2048
  v_mfma_f32_16x16x32_bf16 a[8:11], a[144:147], v[44:47], a[8:11]
  s_and_b32 s69, s32, 255
  ds_read_b64_tr_b16 a[194:195], v34 offset:34816
  v_mfma_f32_16x16x32_bf16 a[8:11], a[148:151], v[48:51], a[8:11]
  s_lshl_b32 s96, s69, 3
  ds_read_b64_tr_b16 a[200:201], v35 offset:32768
  v_mfma_f32_16x16x32_bf16 a[12:15], a[152:155], v[44:47], a[12:15]
  s_add_u32 s96, s96, s64
  ds_read_b64_tr_b16 a[202:203], v35 offset:34816
  v_mfma_f32_16x16x32_bf16 a[12:15], a[156:159], v[48:51], a[12:15]
  ds_read_b64_tr_b16 a[208:209], v36 offset:32768
  v_mfma_f32_16x16x32_bf16 a[16:19], a[160:163], v[44:47], a[16:19]
  s_mul_i32 s79, s96, 14336
  ds_read_b64_tr_b16 a[210:211], v36 offset:34816
  v_mfma_f32_16x16x32_bf16 a[16:19], a[164:167], v[48:51], a[16:19]
  s_add_u32 s79, s79, 35651584
  ds_read_b64_tr_b16 a[216:217], v37 offset:32768
  v_mfma_f32_16x16x32_bf16 a[20:23], a[168:171], v[44:47], a[20:23]
  s_mul_i32 s66, s68, 229376
  buffer_load_dwordx4 v27, s[4:7], s71 offen offset:3072  lds
  v_mfma_f32_16x16x32_bf16 a[20:23], a[172:175], v[48:51], a[20:23]
  ds_read_b64_tr_b16 a[218:219], v37 offset:34816
  s_add_u32 s66, s66, 38797312
  v_mfma_f32_16x16x32_bf16 a[24:27], a[176:179], v[44:47], a[24:27]
  s_mov_b32 s67, 0
  ds_read_b64_tr_b16 a[224:225], v38 offset:32768
  v_mov_b32 v11, 1
  v_mfma_f32_16x16x32_bf16 a[24:27], a[180:183], v[48:51], a[24:27]
  ds_read_b64_tr_b16 a[226:227], v38 offset:34816
  s_waitcnt vmcnt(15)
  v_cmp_ne_u32 s[56:57], s51, v12
  v_mfma_f32_16x16x32_bf16 a[28:31], a[184:187], v[44:47], a[28:31]
  s_add_u32 m0, s67, s65
  ds_read_b64_tr_b16 a[232:233], v39 offset:32768
  v_add_u32 v12, 0xfefefeff, v12
  v_mfma_f32_16x16x32_bf16 a[28:31], a[188:191], v[48:51], a[28:31]
  s_waitcnt lgkmcnt(10)
  ds_read_b64_tr_b16 a[234:235], v39 offset:34816
  v_and_b32 v12, 0x80808080, v12
  v_mfma_f32_16x16x32_bf16 a[32:35], a[128:131], v[52:55], a[32:35]
  s_add_u32 s67, s67, 0x8000
  ds_read_b64_tr_b16 a[240:241], v40 offset:32768
  v_and_b32 v12, s16, v12
  v_mfma_f32_16x16x32_bf16 a[32:35], a[132:135], v[56:59], a[32:35]
  s_and_b32 s67, s67, 0x1ffff
  ds_read_b128 v[44:47], v32 offset:4096
  v_cmp_ne_u32 vcc, 0, v12
  v_mfma_f32_16x16x32_bf16 a[36:39], a[136:139], v[52:55], a[36:39]
  s_cbranch_vccnz L_kf_kernel_spin_8
L_kf_kernel_spinr_9:
  ds_read_b64_tr_b16 a[242:243], v40 offset:34816
  v_mfma_f32_16x16x32_bf16 a[36:39], a[140:143], v[56:59], a[36:39]
  ds_read_b128 v[48:51], v33 offset:4096
  v_mfma_f32_16x16x32_bf16 a[40:43], a[144:147], v[52:55], a[40:43]
  ds_read_b64_tr_b16 a[248:249], v41 offset:32768
  v_mfma_f32_16x16x32_bf16 a[40:43], a[148:151], v[56:59], a[40:43]
  ds_read_b64_tr_b16 a[250:251], v41 offset:34816
  v_mfma_f32_16x16x32_bf16 a[44:47], a[152:155], v[52:55], a[44:47]
  v_mfma_f32_16x16x32_bf16 a[44:47], a[156:159], v[56:59], a[44:47]
  v_mfma_f32_16x16x32_bf16 a[48:51], a[160:163], v[52:55], a[48:51]
  s_waitcnt vmcnt(12)
  v_mfma_f32_16x16x32_bf16 a[48:51], a[164:167], v[56:59], a[48:51]
  s_barrier
  v_mfma_f32_16x16x32_bf16 a[52:55], a[168:171], v[52:55], a[52:55]
  s_lshl_b32 s51, s68, 2
  ds_read_b64_tr_b16 a[196:197], v34 offset:49152
  v_mfma_f32_16x16x32_bf16 a[52:55], a[172:175], v[56:59], a[52:55]
  ds_read_b64_tr_b16 a[198:199], v34 offset:51200
  v_mfma_f32_16x16x32_bf16 a[56:59], a[176:179], v[52:55], a[56:59]
  s_lshr_b64 s[56:57], s[56:57], s51
  buffer_load_dwordx4 v3, s[12:15], s66 offen offset:0 sc1 lds
  v_mfma_f32_16x16x32_bf16 a[56:59], a[180:183], v[56:59], a[56:59]
  s_and_b32 s56, s56, 15
  ds_read_b64_tr_b16 a[204:205], v35 offset:49152
  v_mov_b32 v12, s56
  v_mfma_f32_16x16x32_bf16 a[60:63], a[184:187], v[52:55], a[60:63]
  ds_read_b64_tr_b16 a[206:207], v35 offset:51200
  v_add_u32 v42, 131072, v3
  v_mfma_f32_16x16x32_bf16 a[60:63], a[188:191], v[56:59], a[60:63]
  s_waitcnt lgkmcnt(6)
  ds_read_b64_tr_b16 a[212:213], v36 offset:49152
  v_mfma_f32_16x16x32_bf16 a[64:67], a[128:131], v[44:47], a[64:67]
  ds_read_b64_tr_b16 a[214:215], v36 offset:51200
  v_mfma_f32_16x16x32_bf16 a[64:67], a[132:135], v[48:51], a[64:67]
  ds_read_b128 v[52:55], v32 offset:6144
  v_mfma_f32_16x16x32_bf16 a[68:71], a[136:139], v[44:47], a[68:71]
  ds_read_b64_tr_b16 a[220:221], v37 offset:49152
  v_mfma_f32_16x16x32_bf16 a[68:71], a[140:143], v[48:51], a[68:71]
  ds_read_b128 v[56:59], v33 offset:6144
  v_mfma_f32_16x16x32_bf16 a[72:75], a[144:147], v[44:47], a[72:75]
  buffer_load_dwordx4 v3, s[12:15], s66 offen offset:1024 sc1 lds
  v_mfma_f32_16x16x32_bf16 a[72:75], a[148:151], v[48:51], a[72:75]
  ds_read_b64_tr_b16 a[222:223], v37 offset:51200
  v_mfma_f32_16x16x32_bf16 a[76:79], a[152:155], v[44:47], a[76:79]
  ds_read_b64_tr_b16 a[228:229], v38 offset:49152
  v_mfma_f32_16x16x32_bf16 a[76:79], a[156:159], v[48:51], a[76:79]
  ds_read_b64_tr_b16 a[230:231], v38 offset:51200
  v_mfma_f32_16x16x32_bf16 a[80:83], a[160:163], v[44:47], a[80:83]
  ds_read_b64_tr_b16 a[236:237], v39 offset:49152
  v_mfma_f32_16x16x32_bf16 a[80:83], a[164:167], v[48:51], a[80:83]
  ds_read_b64_tr_b16 a[238:239], v39 offset:51200
  v_mfma_f32_16x16x32_bf16 a[84:87], a[168:171], v[44:47], a[84:87]
  ds_read_b64_tr_b16 a[244:245], v40 offset:49152
  v_mfma_f32_16x16x32_bf16 a[84:87], a[172:175], v[48:51], a[84:87]
  ds_read_b64_tr_b16 a[246:247], v40 offset:51200
  v_mfma_f32_16x16x32_bf16 a[88:91], a[176:179], v[44:47], a[88:91]
  buffer_load_dwordx4 v3, s[12:15], s66 offen offset:2048 sc1 lds
  v_mfma_f32_16x16x32_bf16 a[88:91], a[180:183], v[48:51], a[88:91]
  v_mfma_f32_16x16x32_bf16 a[92:95], a[184:187], v[44:47], a[92:95]
  s_waitcnt vmcnt(7) lgkmcnt(7)
  v_mfma_f32_16x16x32_bf16 a[92:95], a[188:191], v[48:51], a[92:95]
  s_barrier
  v_mfma_f32_16x16x32_bf16 a[96:99], a[128:131], v[52:55], a[96:99]
  buffer_load_dwordx4 v3, s[12:15], s66 offen offset:3072 sc1 lds
  v_mfma_f32_16x16x32_bf16 a[96:99], a[132:135], v[56:59], a[96:99]
  s_add_u32 m0, m0, 0x4000
  ds_read_b128 v[44:47], v32 offset:32768
  v_mfma_f32_16x16x32_bf16 a[100:103], a[136:139], v[52:55], a[100:103]
  v_mfma_f32_16x16x32_bf16 a[100:103], a[140:143], v[56:59], a[100:103]
  ds_read_b128 v[48:51], v33 offset:32768
  v_mfma_f32_16x16x32_bf16 a[104:107], a[144:147], v[52:55], a[104:107]
  buffer_load_dwordx4 v4, s[12:15], s66 offen offset:0 sc1 lds
  v_mfma_f32_16x16x32_bf16 a[104:107], a[148:151], v[56:59], a[104:107]
  ds_read_b64_tr_b16 a[252:253], v41 offset:49152
  v_mfma_f32_16x16x32_bf16 a[108:111], a[152:155], v[52:55], a[108:111]
  ds_read_b64_tr_b16 a[254:255], v41 offset:51200
  v_mfma_f32_16x16x32_bf16 a[108:111], a[156:159], v[56:59], a[108:111]
  v_mfma_f32_16x16x32_bf16 a[112:115], a[160:163], v[52:55], a[112:115]
  buffer_load_dwordx4 v4, s[12:15], s66 offen offset:1024 sc1 lds
  v_mfma_f32_16x16x32_bf16 a[112:115], a[164:167], v[56:59], a[112:115]
  v_mfma_f32_16x16x32_bf16 a[116:119], a[168:171], v[52:55], a[116:119]
  v_mfma_f32_16x16x32_bf16 a[116:119], a[172:175], v[56:59], a[116:119]
  v_mfma_f32_16x16x32_bf16 a[120:123], a[176:179], v[52:55], a[120:123]
  buffer_load_dwordx4 v4, s[12:15], s66 offen offset:2048 sc1 lds
  v_mfma_f32_16x16x32_bf16 a[120:123], a[180:183], v[56:59], a[120:123]
  v_mfma_f32_16x16x32_bf16 a[124:127], a[184:187], v[52:55], a[124:127]
  v_mfma_f32_16x16x32_bf16 a[124:127], a[188:191], v[56:59], a[124:127]
  s_waitcnt lgkmcnt(2)
  v_mfma_f32_16x16x32_bf16 a[0:3], a[192:195], v[44:47], a[0:3]
  buffer_load_dwordx4 v4, s[12:15], s66 offen offset:3072 sc1 lds
  v_mfma_f32_16x16x32_bf16 a[0:3], a[196:199], v[48:51], a[0:3]
  s_add_u32 m0, s65, 32768
  ds_read_b128 v[52:55], v32 offset:34816
  s_add_u32 s98, s66, 32768
  v_mfma_f32_16x16x32_bf16 a[4:7], a[200:203], v[44:47], a[4:7]
  v_mfma_f32_16x16x32_bf16 a[4:7], a[204:207], v[48:51], a[4:7]
  ds_read_b128 v[56:59], v33 offset:34816
  v_mfma_f32_16x16x32_bf16 a[8:11], a[208:211], v[44:47], a[8:11]
  buffer_load_dwordx4 v3, s[12:15], s98 offen offset:0 sc1 lds
  v_mfma_f32_16x16x32_bf16 a[8:11], a[212:215], v[48:51], a[8:11]
  v_accvgpr_read_b32 v16, a0
  v_accvgpr_read_b32 v17, a1
  v_mfma_f32_16x16x32_bf16 a[12:15], a[216:219], v[44:47], a[12:15]
  v_accvgpr_read_b32 v18, a2
  v_accvgpr_read_b32 v19, a3
  v_mfma_f32_16x16x32_bf16 a[12:15], a[220:223], v[48:51], a[12:15]
  v_accvgpr_read_b32 v20, a4
  v_accvgpr_read_b32 v21, a5
  v_mfma_f32_16x16x32_bf16 a[16:19], a[224:227], v[44:47], a[16:19]
  v_accvgpr_read_b32 v22, a6
  v_accvgpr_read_b32 v23, a7
  v_mfma_f32_16x16x32_bf16 a[16:19], a[228:231], v[48:51], a[16:19]
  v_cvt_pk_bf16_f32 v64, v16, v17
  v_cvt_pk_bf16_f32 v65, v18, v19
  v_mfma_f32_16x16x32_bf16 a[20:23], a[232:235], v[44:47], a[20:23]
  buffer_load_dwordx4 v3, s[12:15], s98 offen offset:1024 sc1 lds
  v_mfma_f32_16x16x32_bf16 a[20:23], a[236:239], v[48:51], a[20:23]
  s_waitcnt lgkmcnt(2)
  v_cvt_pk_bf16_f32 v66, v20, v21
  v_cvt_pk_bf16_f32 v67, v22, v23
  v_mfma_f32_16x16x32_bf16 a[24:27], a[240:243], v[44:47], a[24:27]
  s_add_u32 s60, s79, 0
  buffer_load_dwordx4 a[0:3], v1, s[12:15], s60 offen offset:0 sc1
  v_mfma_f32_16x16x32_bf16 a[24:27], a[244:247], v[48:51], a[24:27]
  buffer_load_dwordx4 a[4:7], v1, s[12:15], s60 offen offset:1024 sc1
  v_mfma_f32_16x16x32_bf16 a[28:31], a[248:251], v[44:47], a[28:31]
  v_accvgpr_read_b32 v24, a8
  v_accvgpr_read_b32 v25, a9
  v_mfma_f32_16x16x32_bf16 a[28:31], a[252:255], v[48:51], a[28:31]
  s_waitcnt lgkmcnt(0)
  v_accvgpr_read_b32 v26, a10
  v_accvgpr_read_b32 v27, a11
  v_mfma_f32_16x16x32_bf16 a[32:35], a[192:195], v[52:55], a[32:35]
  buffer_load_dwordx4 v3, s[12:15], s98 offen offset:2048 sc1 lds
  v_mfma_f32_16x16x32_bf16 a[32:35], a[196:199], v[56:59], a[32:35]
  ds_read_b128 v[44:47], v32 offset:36864
  v_accvgpr_read_b32 v28, a12
  v_mfma_f32_16x16x32_bf16 a[36:39], a[200:203], v[52:55], a[36:39]
  v_accvgpr_read_b32 v29, a13
  v_accvgpr_read_b32 v30, a14
  v_mfma_f32_16x16x32_bf16 a[36:39], a[204:207], v[56:59], a[36:39]
  ds_read_b128 v[48:51], v33 offset:36864
  v_accvgpr_read_b32 v31, a15
  v_mfma_f32_16x16x32_bf16 a[40:43], a[208:211], v[52:55], a[40:43]
  v_cvt_pk_bf16_f32 v68, v24, v25
  v_cvt_pk_bf16_f32 v69, v26, v27
  v_mfma_f32_16x16x32_bf16 a[40:43], a[212:215], v[56:59], a[40:43]
  v_cvt_pk_bf16_f32 v70, v28, v29
  v_cvt_pk_bf16_f32 v71, v30, v31
  v_mfma_f32_16x16x32_bf16 a[44:47], a[216:219], v[52:55], a[44:47]
  buffer_load_dwordx4 v3, s[12:15], s98 offen offset:3072 sc1 lds
  v_mfma_f32_16x16x32_bf16 a[44:47], a[220:223], v[56:59], a[44:47]
  buffer_load_dwordx4 a[8:11], v1, s[12:15], s60 offen offset:2048 sc1
  v_mfma_f32_16x16x32_bf16 a[48:51], a[224:227], v[52:55], a[48:51]
  buffer_load_dwordx4 a[12:15], v1, s[12:15], s60 offen offset:3072 sc1
  v_mfma_f32_16x16x32_bf16 a[48:51], a[228:231], v[56:59], a[48:51]
  s_add_u32 m0, s65, 65536
  s_add_u32 s98, s66, 65536
  v_mfma_f32_16x16x32_bf16 a[52:55], a[232:235], v[52:55], a[52:55]
  buffer_store_dwordx4 v[64:67], v1, s[12:15], s99 offen offset:0
  v_mfma_f32_16x16x32_bf16 a[52:55], a[236:239], v[56:59], a[52:55]
  v_accvgpr_read_b32 v16, a16
  v_accvgpr_read_b32 v17, a17
  v_mfma_f32_16x16x32_bf16 a[56:59], a[240:243], v[52:55], a[56:59]
  buffer_load_dwordx4 v3, s[12:15], s98 offen offset:0 sc1 lds
  v_mfma_f32_16x16x32_bf16 a[56:59], a[244:247], v[56:59], a[56:59]
  v_accvgpr_read_b32 v18, a18
  v_accvgpr_read_b32 v19, a19
  v_mfma_f32_16x16x32_bf16 a[60:63], a[248:251], v[52:55], a[60:63]
  v_accvgpr_read_b32 v20, a20
  v_accvgpr_read_b32 v21, a21
  v_mfma_f32_16x16x32_bf16 a[60:63], a[252:255], v[56:59], a[60:63]
  s_waitcnt lgkmcnt(0)
  v_accvgpr_read_b32 v22, a22
  v_accvgpr_read_b32 v23, a23
  v_mfma_f32_16x16x32_bf16 a[64:67], a[192:195], v[44:47], a[64:67]
  v_cvt_pk_bf16_f32 v72, v16, v17
  v_cvt_pk_bf16_f32 v73, v18, v19
  v_mfma_f32_16x16x32_bf16 a[64:67], a[196:199], v[48:51], a[64:67]
  ds_read_b128 v[52:55], v32 offset:38912
  v_cvt_pk_bf16_f32 v74, v20, v21
  v_mfma_f32_16x16x32_bf16 a[68:71], a[200:203], v[44:47], a[68:71]
  buffer_load_dwordx4 v3, s[12:15], s98 offen offset:1024 sc1 lds
  v_mfma_f32_16x16x32_bf16 a[68:71], a[204:207], v[48:51], a[68:71]
  ds_read_b128 v[56:59], v33 offset:38912
  v_cvt_pk_bf16_f32 v75, v22, v23
  v_mfma_f32_16x16x32_bf16 a[72:75], a[208:211], v[44:47], a[72:75]
  s_add_u32 s60, s79, 4096
  buffer_load_dwordx4 a[16:19], v1, s[12:15], s60 offen offset:0 sc1
  v_mfma_f32_16x16x32_bf16 a[72:75], a[212:215], v[48:51], a[72:75]
  buffer_load_dwordx4 a[20:23], v1, s[12:15], s60 offen offset:1024 sc1
  v_mfma_f32_16x16x32_bf16 a[76:79], a[216:219], v[44:47], a[76:79]
  buffer_store_dwordx4 v[68:71], v1, s[12:15], s99 offen offset:1024
  v_mfma_f32_16x16x32_bf16 a[76:79], a[220:223], v[48:51], a[76:79]
  buffer_load_dwordx4 v3, s[12:15], s98 offen offset:2048 sc1 lds
  v_mfma_f32_16x16x32_bf16 a[80:83], a[224:227], v[44:47], a[80:83]
  v_accvgpr_read_b32 v24, a24
  v_accvgpr_read_b32 v25, a25
  v_mfma_f32_16x16x32_bf16 a[80:83], a[228:231], v[48:51], a[80:83]
  v_accvgpr_read_b32 v26, a26
  v_accvgpr_read_b32 v27, a27
  v_mfma_f32_16x16x32_bf16 a[84:87], a[232:235], v[44:47], a[84:87]
  v_accvgpr_read_b32 v28, a28
  v_accvgpr_read_b32 v29, a29
  v_mfma_f32_16x16x32_bf16 a[84:87], a[236:239], v[48:51], a[84:87]
  v_accvgpr_read_b32 v30, a30
  v_accvgpr_read_b32 v31, a31
  v_mfma_f32_16x16x32_bf16 a[88:91], a[240:243], v[44:47], a[88:91]
  buffer_load_dwordx4 v3, s[12:15], s98 offen offset:3072 sc1 lds
  v_mfma_f32_16x16x32_bf16 a[88:91], a[244:247], v[48:51], a[88:91]
  v_cvt_pk_bf16_f32 v76, v24, v25
  v_cvt_pk_bf16_f32 v77, v26, v27
  v_mfma_f32_16x16x32_bf16 a[92:95], a[248:251], v[44:47], a[92:95]
  s_waitcnt vmcnt(24) lgkmcnt(0)
  v_cvt_pk_bf16_f32 v78, v28, v29
  v_cvt_pk_bf16_f32 v79, v30, v31
  v_mfma_f32_16x16x32_bf16 a[92:95], a[252:255], v[48:51], a[92:95]
  s_barrier
  s_add_u32 m0, s65, 49152
  s_add_u32 s98, s66, 32768
  v_mfma_f32_16x16x32_bf16 a[96:99], a[192:195], v[52:55], a[96:99]
  buffer_load_dwordx4 a[24:27], v1, s[12:15], s60 offen offset:2048 sc1
  v_mfma_f32_16x16x32_bf16 a[96:99], a[196:199], v[56:59], a[96:99]
  s_add_u32 s60, s79, 57344
  ds_read_b128 v[44:47], v32 offset:16384
  v_mfma_f32_16x16x32_bf16 a[100:103], a[200:203], v[52:55], a[100:103]
  buffer_load_dwordx4 v4, s[12:15], s98 offen offset:0 sc1 lds
  v_mfma_f32_16x16x32_bf16 a[100:103], a[204:207], v[56:59], a[100:103]
  ds_read_b128 v[48:51], v33 offset:16384
  ds_write_b32 v42, v12
  v_mfma_f32_16x16x32_bf16 a[104:107], a[208:211], v[52:55], a[104:107]
  buffer_load_dwordx4 a[28:31], v1, s[12:15], s60 offen offset:0 sc1
  v_mfma_f32_16x16x32_bf16 a[104:107], a[212:215], v[56:59], a[104:107]
  buffer_store_dwordx4 v[72:75], v1, s[12:15], s99 offen offset:2048
  v_mfma_f32_16x16x32_bf16 a[108:111], a[216:219], v[52:55], a[108:111]
  v_accvgpr_read_b32 v16, a32
  v_accvgpr_read_b32 v17, a33
  v_mfma_f32_16x16x32_bf16 a[108:111], a[220:223], v[56:59], a[108:111]
  v_accvgpr_read_b32 v18, a34
  v_accvgpr_read_b32 v19, a35
  v_mfma_f32_16x16x32_bf16 a[112:115], a[224:227], v[52:55], a[112:115]
  v_accvgpr_read_b32 v20, a36
  v_accvgpr_read_b32 v21, a37
  v_mfma_f32_16x16x32_bf16 a[112:115], a[228:231], v[56:59], a[112:115]
  v_accvgpr_read_b32 v22, a38
  v_accvgpr_read_b32 v23, a39
  v_mfma_f32_16x16x32_bf16 a[116:119], a[232:235], v[52:55], a[116:119]
  buffer_load_dwordx4 v4, s[12:15], s98 offen offset:1024 sc1 lds
  v_mfma_f32_16x16x32_bf16 a[116:119], a[236:239], v[56:59], a[116:119]
  v_cvt_pk_bf16_f32 v80, v16, v17
  v_cvt_pk_bf16_f32 v81, v18, v19
  v_mfma_f32_16x16x32_bf16 a[120:123], a[240:243], v[52:55], a[120:123]
  v_cvt_pk_bf16_f32 v82, v20, v21
  v_cvt_pk_bf16_f32 v83, v22, v23
  v_mfma_f32_16x16x32_bf16 a[120:123], a[244:247], v[56:59], a[120:123]
  buffer_load_dwordx4 a[32:35], v1, s[12:15], s60 offen offset:1024 sc1
  v_mfma_f32_16x16x32_bf16 a[124:127], a[248:251], v[52:55], a[124:127]
  buffer_load_dwordx4 a[36:39], v1, s[12:15], s60 offen offset:2048 sc1
  v_mfma_f32_16x16x32_bf16 a[124:127], a[252:255], v[56:59], a[124:127]
  s_waitcnt lgkmcnt(1)
  buffer_store_dwordx4 v[76:79], v1, s[12:15], s99 offen offset:3072
  v_mfma_f32_16x16x32_bf16 v[128:131], a[128:131], v[44:47], v[128:131]
  s_add_u32 s99, s99, 32768
  v_accvgpr_read_b32 v24, a40
  v_accvgpr_read_b32 v25, a41
  v_mfma_f32_16x16x32_bf16 v[128:131], a[132:135], v[48:51], v[128:131]
  ds_read_b128 v[52:55], v32 offset:18432
  v_accvgpr_read_b32 v26, a42
  v_mfma_f32_16x16x32_bf16 v[132:135], a[136:139], v[44:47], v[132:135]
  buffer_load_dwordx4 v4, s[12:15], s98 offen offset:2048 sc1 lds
  v_mfma_f32_16x16x32_bf16 v[132:135], a[140:143], v[48:51], v[132:135]
  ds_read_b128 v[56:59], v33 offset:18432
  v_accvgpr_read_b32 v27, a43
  v_mfma_f32_16x16x32_bf16 v[136:139], a[144:147], v[44:47], v[136:139]
  v_accvgpr_read_b32 v28, a44
  v_accvgpr_read_b32 v29, a45
  v_mfma_f32_16x16x32_bf16 v[136:139], a[148:151], v[48:51], v[136:139]
  v_accvgpr_read_b32 v30, a46
  v_accvgpr_read_b32 v31, a47
  v_mfma_f32_16x16x32_bf16 v[140:143], a[152:155], v[44:47], v[140:143]
  v_cvt_pk_bf16_f32 v84, v24, v25
  v_cvt_pk_bf16_f32 v85, v26, v27
  v_mfma_f32_16x16x32_bf16 v[140:143], a[156:159], v[48:51], v[140:143]
  v_cvt_pk_bf16_f32 v86, v28, v29
  v_cvt_pk_bf16_f32 v87, v30, v31
  v_mfma_f32_16x16x32_bf16 v[144:147], a[160:163], v[44:47], v[144:147]
  buffer_load_dwordx4 a[40:43], v1, s[12:15], s60 offen offset:3072 sc1
  v_mfma_f32_16x16x32_bf16 v[144:147], a[164:167], v[48:51], v[144:147]
  s_add_u32 s60, s79, 61440
  buffer_load_dwordx4 a[44:47], v1, s[12:15], s60 offen offset:0 sc1
  v_mfma_f32_16x16x32_bf16 v[148:151], a[168:171], v[44:47], v[148:151]
  buffer_load_dwordx4 v4, s[12:15], s98 offen offset:3072 sc1 lds
  v_mfma_f32_16x16x32_bf16 v[148:151], a[172:175], v[48:51], v[148:151]
  v_accvgpr_read_b32 v16, a48
  v_accvgpr_read_b32 v17, a49
  v_mfma_f32_16x16x32_bf16 v[152:155], a[176:179], v[44:47], v[152:155]
  v_accvgpr_read_b32 v18, a50
  v_accvgpr_read_b32 v19, a51
  v_mfma_f32_16x16x32_bf16 v[152:155], a[180:183], v[48:51], v[152:155]
  v_accvgpr_read_b32 v20, a52
  v_accvgpr_read_b32 v21, a53
  v_mfma_f32_16x16x32_bf16 v[156:159], a[184:187], v[44:47], v[156:159]
  v_accvgpr_read_b32 v22, a54
  v_accvgpr_read_b32 v23, a55
  v_mfma_f32_16x16x32_bf16 v[156:159], a[188:191], v[48:51], v[156:159]
  s_waitcnt lgkmcnt(0)
  s_add_u32 m0, s65, 98304
  s_add_u32 s98, s66, 98304
  v_mfma_f32_16x16x32_bf16 v[160:163], a[128:131], v[52:55], v[160:163]
  v_cvt_pk_bf16_f32 v88, v16, v17
  v_cvt_pk_bf16_f32 v89, v18, v19
  v_mfma_f32_16x16x32_bf16 v[160:163], a[132:135], v[56:59], v[160:163]
  ds_read_b128 v[44:47], v32 offset:20480
  v_cvt_pk_bf16_f32 v90, v20, v21
  v_mfma_f32_16x16x32_bf16 v[164:167], a[136:139], v[52:55], v[164:167]
  buffer_load_dwordx4 v3, s[12:15], s98 offen offset:0 sc1 lds
  v_mfma_f32_16x16x32_bf16 v[164:167], a[140:143], v[56:59], v[164:167]
  ds_read_b128 v[48:51], v33 offset:20480
  v_cvt_pk_bf16_f32 v91, v22, v23
  v_mfma_f32_16x16x32_bf16 v[168:171], a[144:147], v[52:55], v[168:171]
  buffer_load_dwordx4 a[48:51], v1, s[12:15], s60 offen offset:1024 sc1
  v_mfma_f32_16x16x32_bf16 v[168:171], a[148:151], v[56:59], v[168:171]
  buffer_load_dwordx4 a[52:55], v1, s[12:15], s60 offen offset:2048 sc1
  v_mfma_f32_16x16x32_bf16 v[172:175], a[152:155], v[52:55], v[172:175]
  buffer_store_dwordx4 v[80:83], v1, s[12:15], s100 offen offset:0
  v_mfma_f32_16x16x32_bf16 v[172:175], a[156:159], v[56:59], v[172:175]
  v_accvgpr_read_b32 v24, a56
  v_accvgpr_read_b32 v25, a57
  v_mfma_f32_16x16x32_bf16 v[176:179], a[160:163], v[52:55], v[176:179]
  v_accvgpr_read_b32 v26, a58
  v_accvgpr_read_b32 v27, a59
  v_mfma_f32_16x16x32_bf16 v[176:179], a[164:167], v[56:59], v[176:179]
  v_accvgpr_read_b32 v28, a60
  v_accvgpr_read_b32 v29, a61
  v_mfma_f32_16x16x32_bf16 v[180:183], a[168:171], v[52:55], v[180:183]
  buffer_load_dwordx4 v3, s[12:15], s98 offen offset:1024 sc1 lds
  v_mfma_f32_16x16x32_bf16 v[180:183], a[172:175], v[56:59], v[180:183]
  v_accvgpr_read_b32 v30, a62
  v_accvgpr_read_b32 v31, a63
  v_mfma_f32_16x16x32_bf16 v[184:187], a[176:179], v[52:55], v[184:187]
  v_cvt_pk_bf16_f32 v92, v24, v25
  v_cvt_pk_bf16_f32 v93, v26, v27
  v_mfma_f32_16x16x32_bf16 v[184:187], a[180:183], v[56:59], v[184:187]
  v_cvt_pk_bf16_f32 v94, v28, v29
  v_cvt_pk_bf16_f32 v95, v30, v31
  v_mfma_f32_16x16x32_bf16 v[188:191], a[184:187], v[52:55], v[188:191]
  s_add_u32 s60, s79, 7168
  buffer_load_dwordx4 a[56:59], v1, s[12:15], s60 offen offset:0 sc1
  v_mfma_f32_16x16x32_bf16 v[188:191], a[188:191], v[56:59], v[188:191]
  s_waitcnt lgkmcnt(0)
  buffer_load_dwordx4 a[60:63], v1, s[12:15], s60 offen offset:1024 sc1
  v_mfma_f32_16x16x32_bf16 v[192:195], a[128:131], v[44:47], v[192:195]
  buffer_store_dwordx4 v[84:87], v1, s[12:15], s100 offen offset:1024
  v_mfma_f32_16x16x32_bf16 v[192:195], a[132:135], v[48:51], v[192:195]
  ds_read_b128 v[52:55], v32 offset:22528
  v_accvgpr_read_b32 v16, a64
  v_mfma_f32_16x16x32_bf16 v[196:199], a[136:139], v[44:47], v[196:199]
  buffer_load_dwordx4 v3, s[12:15], s98 offen offset:2048 sc1 lds
  v_mfma_f32_16x16x32_bf16 v[196:199], a[140:143], v[48:51], v[196:199]
  ds_read_b128 v[56:59], v33 offset:22528
  v_accvgpr_read_b32 v17, a65
  v_mfma_f32_16x16x32_bf16 v[200:203], a[144:147], v[44:47], v[200:203]
  v_accvgpr_read_b32 v18, a66
  v_accvgpr_read_b32 v19, a67
  v_mfma_f32_16x16x32_bf16 v[200:203], a[148:151], v[48:51], v[200:203]
  v_accvgpr_read_b32 v20, a68
  v_accvgpr_read_b32 v21, a69
  v_mfma_f32_16x16x32_bf16 v[204:207], a[152:155], v[44:47], v[204:207]
  v_accvgpr_read_b32 v22, a70
  v_accvgpr_read_b32 v23, a71
  v_mfma_f32_16x16x32_bf16 v[204:207], a[156:159], v[48:51], v[204:207]
  v_cvt_pk_bf16_f32 v96, v16, v17
  v_cvt_pk_bf16_f32 v97, v18, v19
  v_mfma_f32_16x16x32_bf16 v[208:211], a[160:163], v[44:47], v[208:211]
  v_cvt_pk_bf16_f32 v98, v20, v21
  v_cvt_pk_bf16_f32 v99, v22, v23
  v_mfma_f32_16x16x32_bf16 v[208:211], a[164:167], v[48:51], v[208:211]
  buffer_load_dwordx4 a[64:67], v1, s[12:15], s60 offen offset:2048 sc1
  v_mfma_f32_16x16x32_bf16 v[212:215], a[168:171], v[44:47], v[212:215]
  buffer_load_dwordx4 v3, s[12:15], s98 offen offset:3072 sc1 lds
  v_mfma_f32_16x16x32_bf16 v[212:215], a[172:175], v[48:51], v[212:215]
  buffer_load_dwordx4 a[68:71], v1, s[12:15], s60 offen offset:3072 sc1
  v_mfma_f32_16x16x32_bf16 v[216:219], a[176:179], v[44:47], v[216:219]
  buffer_store_dwordx4 v[88:91], v1, s[12:15], s100 offen offset:2048
  v_mfma_f32_16x16x32_bf16 v[216:219], a[180:183], v[48:51], v[216:219]
  v_accvgpr_read_b32 v24, a72
  v_accvgpr_read_b32 v25, a73
  v_mfma_f32_16x16x32_bf16 v[220:223], a[184:187], v[44:47], v[220:223]
  s_waitcnt vmcnt(46) lgkmcnt(0)
  v_accvgpr_read_b32 v26, a74
  v_accvgpr_read_b32 v27, a75
  v_mfma_f32_16x16x32_bf16 v[220:223], a[188:191], v[48:51], v[220:223]
  s_barrier
  v_accvgpr_read_b32 v28, a76
  v_accvgpr_read_b32 v29, a77
  v_mfma_f32_16x16x32_bf16 v[224:227], a[128:131], v[52:55], v[224:227]
  v_accvgpr_read_b32 v30, a78
  v_accvgpr_read_b32 v31, a79
  v_mfma_f32_16x16x32_bf16 v[224:227], a[132:135], v[56:59], v[224:227]
  s_add_u32 m0, s65, 81920
  ds_read_b128 v[44:47], v32 offset:49152
  s_add_u32 s98, s66, 65536
  v_mfma_f32_16x16x32_bf16 v[228:231], a[136:139], v[52:55], v[228:231]
  v_cvt_pk_bf16_f32 v100, v24, v25
  v_cvt_pk_bf16_f32 v101, v26, v27
  v_mfma_f32_16x16x32_bf16 v[228:231], a[140:143], v[56:59], v[228:231]
  ds_read_b128 v[48:51], v33 offset:49152
  v_cvt_pk_bf16_f32 v102, v28, v29
  v_mfma_f32_16x16x32_bf16 v[232:235], a[144:147], v[52:55], v[232:235]
  buffer_load_dwordx4 v4, s[12:15], s98 offen offset:0 sc1 lds
  v_mfma_f32_16x16x32_bf16 v[232:235], a[148:151], v[56:59], v[232:235]
  v_cvt_pk_bf16_f32 v103, v30, v31
  v_mfma_f32_16x16x32_bf16 v[236:239], a[152:155], v[52:55], v[236:239]
  s_add_u32 s60, s79, 11264
  buffer_load_dwordx4 a[72:75], v1, s[12:15], s60 offen offset:0 sc1
  v_mfma_f32_16x16x32_bf16 v[236:239], a[156:159], v[56:59], v[236:239]
  buffer_load_dwordx4 a[76:79], v1, s[12:15], s60 offen offset:1024 sc1
  v_mfma_f32_16x16x32_bf16 v[240:243], a[160:163], v[52:55], v[240:243]
  buffer_store_dwordx4 v[92:95], v1, s[12:15], s100 offen offset:3072
  v_mfma_f32_16x16x32_bf16 v[240:243], a[164:167], v[56:59], v[240:243]
  s_add_u32 s100, s100, 32768
  v_accvgpr_read_b32 v16, a80
  v_accvgpr_read_b32 v17, a81
  v_mfma_f32_16x16x32_bf16 v[244:247], a[168:171], v[52:55], v[244:247]
  v_accvgpr_read_b32 v18, a82
  v_accvgpr_read_b32 v19, a83
  v_mfma_f32_16x16x32_bf16 v[244:247], a[172:175], v[56:59], v[244:247]
  v_accvgpr_read_b32 v20, a84
  v_accvgpr_read_b32 v21, a85
  v_mfma_f32_16x16x32_bf16 v[248:251], a[176:179], v[52:55], v[248:251]
  v_accvgpr_read_b32 v22, a86
  v_accvgpr_read_b32 v23, a87
  v_mfma_f32_16x16x32_bf16 v[248:251], a[180:183], v[56:59], v[248:251]
  v_cvt_pk_bf16_f32 v104, v16, v17
  v_cvt_pk_bf16_f32 v105, v18, v19
  v_mfma_f32_16x16x32_bf16 v[252:255], a[184:187], v[52:55], v[252:255]
  v_cvt_pk_bf16_f32 v106, v20, v21
  v_cvt_pk_bf16_f32 v107, v22, v23
  v_mfma_f32_16x16x32_bf16 v[252:255], a[188:191], v[56:59], v[252:255]
  s_waitcnt lgkmcnt(0)
  buffer_load_dwordx4 a[80:83], v1, s[12:15], s60 offen offset:2048 sc1
  v_mfma_f32_16x16x32_bf16 v[128:131], a[192:195], v[44:47], v[128:131]
  v_accvgpr_read_b32 v24, a88
  v_accvgpr_read_b32 v25, a89
  v_mfma_f32_16x16x32_bf16 v[128:131], a[196:199], v[48:51], v[128:131]
  ds_read_b128 v[52:55], v32 offset:51200
  v_accvgpr_read_b32 v26, a90
  v_mfma_f32_16x16x32_bf16 v[132:135], a[200:203], v[44:47], v[132:135]
  v_accvgpr_read_b32 v27, a91
  v_accvgpr_read_b32 v28, a92
  v_mfma_f32_16x16x32_bf16 v[132:135], a[204:207], v[48:51], v[132:135]
  ds_read_b128 v[56:59], v33 offset:51200
  v_accvgpr_read_b32 v29, a93
  v_mfma_f32_16x16x32_bf16 v[136:139], a[208:211], v[44:47], v[136:139]
  buffer_load_dwordx4 v4, s[12:15], s98 offen offset:1024 sc1 lds
  v_mfma_f32_16x16x32_bf16 v[136:139], a[212:215], v[48:51], v[136:139]
  v_accvgpr_read_b32 v30, a94
  v_accvgpr_read_b32 v31, a95
  v_mfma_f32_16x16x32_bf16 v[140:143], a[216:219], v[44:47], v[140:143]
  v_cvt_pk_bf16_f32 v108, v24, v25
  v_cvt_pk_bf16_f32 v109, v26, v27
  v_mfma_f32_16x16x32_bf16 v[140:143], a[220:223], v[48:51], v[140:143]
  v_cvt_pk_bf16_f32 v110, v28, v29
  v_cvt_pk_bf16_f32 v111, v30, v31
  v_mfma_f32_16x16x32_bf16 v[144:147], a[224:227], v[44:47], v[144:147]
  buffer_store_dwordx4 v[96:99], v1, s[12:15], s99 offen offset:0
  v_mfma_f32_16x16x32_bf16 v[144:147], a[228:231], v[48:51], v[144:147]
  v_accvgpr_read_b32 v16, a96
  v_accvgpr_read_b32 v17, a97
  v_mfma_f32_16x16x32_bf16 v[148:151], a[232:235], v[44:47], v[148:151]
  v_accvgpr_read_b32 v18, a98
  v_accvgpr_read_b32 v19, a99
  v_mfma_f32_16x16x32_bf16 v[148:151], a[236:239], v[48:51], v[148:151]
  ds_read_b32 v12, v6
  v_accvgpr_read_b32 v20, a100
  v_mfma_f32_16x16x32_bf16 v[152:155], a[240:243], v[44:47], v[152:155]
  v_accvgpr_read_b32 v21, a101
  v_accvgpr_read_b32 v22, a102
  v_mfma_f32_16x16x32_bf16 v[152:155], a[244:247], v[48:51], v[152:155]
  v_accvgpr_read_b32 v23, a103
  v_cvt_pk_bf16_f32 v112, v16, v17
  v_mfma_f32_16x16x32_bf16 v[156:159], a[248:251], v[44:47], v[156:159]
  v_cvt_pk_bf16_f32 v113, v18, v19
  v_cvt_pk_bf16_f32 v114, v20, v21
  v_mfma_f32_16x16x32_bf16 v[156:159], a[252:255], v[48:51], v[156:159]
  s_waitcnt lgkmcnt(1)
  v_cvt_pk_bf16_f32 v115, v22, v23
  v_cvt_pk_bf16_f32 v128, v128, v129
  v_mfma_f32_16x16x32_bf16 v[160:163], a[192:195], v[52:55], v[160:163]
  buffer_store_dwordx4 v[100:103], v1, s[12:15], s99 offen offset:1024
  v_mfma_f32_16x16x32_bf16 v[160:163], a[196:199], v[56:59], v[160:163]
  ds_read_b128 v[44:47], v32 offset:53248
  v_accvgpr_read_b32 v24, a104
  v_mfma_f32_16x16x32_bf16 v[164:167], a[200:203], v[52:55], v[164:167]
  v_accvgpr_read_b32 v25, a105
  v_cvt_pk_bf16_f32 v129, v130, v131
  v_mfma_f32_16x16x32_bf16 v[164:167], a[204:207], v[56:59], v[164:167]
  ds_read_b128 v[48:51], v33 offset:53248
  v_accvgpr_read_b32 v26, a106
  v_mfma_f32_16x16x32_bf16 v[168:171], a[208:211], v[52:55], v[168:171]
  buffer_load_dwordx4 v4, s[12:15], s98 offen offset:2048 sc1 lds
  v_mfma_f32_16x16x32_bf16 v[168:171], a[212:215], v[56:59], v[168:171]
  v_cvt_pk_bf16_f32 v130, v132, v133
  v_accvgpr_read_b32 v27, a107
  v_mfma_f32_16x16x32_bf16 v[172:175], a[216:219], v[52:55], v[172:175]
  v_cvt_pk_bf16_f32 v131, v134, v135
  v_accvgpr_read_b32 v28, a108
  v_mfma_f32_16x16x32_bf16 v[172:175], a[220:223], v[56:59], v[172:175]
  v_cvt_pk_bf16_f32 v132, v136, v137
  v_accvgpr_read_b32 v29, a109
  v_mfma_f32_16x16x32_bf16 v[176:179], a[224:227], v[52:55], v[176:179]
  v_cvt_pk_bf16_f32 v133, v138, v139
  v_accvgpr_read_b32 v30, a110
  v_mfma_f32_16x16x32_bf16 v[176:179], a[228:231], v[56:59], v[176:179]
  v_cvt_pk_bf16_f32 v134, v140, v141
  v_accvgpr_read_b32 v31, a111
  v_mfma_f32_16x16x32_bf16 v[180:183], a[232:235], v[52:55], v[180:183]
  v_cvt_pk_bf16_f32 v135, v142, v143
  v_cvt_pk_bf16_f32 v116, v24, v25
  v_mfma_f32_16x16x32_bf16 v[180:183], a[236:239], v[56:59], v[180:183]
  v_cvt_pk_bf16_f32 v136, v144, v145
  v_cvt_pk_bf16_f32 v117, v26, v27
  v_mfma_f32_16x16x32_bf16 v[184:187], a[240:243], v[52:55], v[184:187]
  v_cvt_pk_bf16_f32 v137, v146, v147
  v_cvt_pk_bf16_f32 v118, v28, v29
  v_mfma_f32_16x16x32_bf16 v[184:187], a[244:247], v[56:59], v[184:187]
  v_cvt_pk_bf16_f32 v138, v148, v149
  v_cvt_pk_bf16_f32 v119, v30, v31
  v_mfma_f32_16x16x32_bf16 v[188:191], a[248:251], v[52:55], v[188:191]
  v_cvt_pk_bf16_f32 v139, v150, v151
  v_cvt_pk_bf16_f32 v140, v152, v153
  v_mfma_f32_16x16x32_bf16 v[188:191], a[252:255], v[56:59], v[188:191]
  s_waitcnt lgkmcnt(0)
  buffer_store_dwordx4 v[104:107], v1, s[12:15], s99 offen offset:2048
  v_mfma_f32_16x16x32_bf16 v[192:195], a[192:195], v[44:47], v[192:195]
  v_cvt_pk_bf16_f32 v141, v154, v155
  v_accvgpr_read_b32 v16, a112
  v_mfma_f32_16x16x32_bf16 v[192:195], a[196:199], v[48:51], v[192:195]
  s_mov_b32 s67, 0
  ds_read_b128 v[52:55], v32 offset:55296
  v_add_u32 v5, s67, v1
  v_mfma_f32_16x16x32_bf16 v[196:199], a[200:203], v[44:47], v[196:199]
  v_cvt_pk_bf16_f32 v142, v156, v157
  v_accvgpr_read_b32 v17, a113
  v_mfma_f32_16x16x32_bf16 v[196:199], a[204:207], v[48:51], v[196:199]
  ds_read_b128 v[56:59], v33 offset:55296
  v_cvt_pk_bf16_f32 v143, v158, v159
  v_mfma_f32_16x16x32_bf16 v[200:203], a[208:211], v[44:47], v[200:203]
  buffer_load_dwordx4 v4, s[12:15], s98 offen offset:3072 sc1 lds
  v_mfma_f32_16x16x32_bf16 v[200:203], a[212:215], v[48:51], v[200:203]
  v_accvgpr_read_b32 v18, a114
  v_cvt_pk_bf16_f32 v160, v160, v161
  v_mfma_f32_16x16x32_bf16 v[204:207], a[216:219], v[44:47], v[204:207]
  v_accvgpr_read_b32 v19, a115
  v_cvt_pk_bf16_f32 v161, v162, v163
  v_mfma_f32_16x16x32_bf16 v[204:207], a[220:223], v[48:51], v[204:207]
  v_accvgpr_read_b32 v20, a116
  v_cvt_pk_bf16_f32 v162, v164, v165
  v_mfma_f32_16x16x32_bf16 v[208:211], a[224:227], v[44:47], v[208:211]
  v_accvgpr_read_b32 v21, a117
  v_cvt_pk_bf16_f32 v163, v166, v167
  v_mfma_f32_16x16x32_bf16 v[208:211], a[228:231], v[48:51], v[208:211]
  v_accvgpr_read_b32 v22, a118
  v_cvt_pk_bf16_f32 v164, v168, v169
  v_mfma_f32_16x16x32_bf16 v[212:215], a[232:235], v[44:47], v[212:215]
  v_accvgpr_read_b32 v23, a119
  v_cvt_pk_bf16_f32 v165, v170, v171
  v_mfma_f32_16x16x32_bf16 v[212:215], a[236:239], v[48:51], v[212:215]
  v_cvt_pk_bf16_f32 v120, v16, v17
  v_cvt_pk_bf16_f32 v166, v172, v173
  v_mfma_f32_16x16x32_bf16 v[216:219], a[240:243], v[44:47], v[216:219]
  v_cvt_pk_bf16_f32 v121, v18, v19
  v_cvt_pk_bf16_f32 v167, v174, v175
  v_mfma_f32_16x16x32_bf16 v[216:219], a[244:247], v[48:51], v[216:219]
  v_cvt_pk_bf16_f32 v122, v20, v21
  v_cvt_pk_bf16_f32 v168, v176, v177
  v_mfma_f32_16x16x32_bf16 v[220:223], a[248:251], v[44:47], v[220:223]
  s_waitcnt vmcnt(36) lgkmcnt(0)
  v_cvt_pk_bf16_f32 v123, v22, v23
  v_cvt_pk_bf16_f32 v169, v178, v179
  v_mfma_f32_16x16x32_bf16 v[220:223], a[252:255], v[48:51], v[220:223]
  s_barrier
  v_cvt_pk_bf16_f32 v170, v180, v181
  v_cvt_pk_bf16_f32 v171, v182, v183
  v_mfma_f32_16x16x32_bf16 v[224:227], a[192:195], v[52:55], v[224:227]
  s_add_u32 m0, s65, 114688
  s_add_u32 s98, s66, 98304
  ds_read_b128 a[128:131], v5 offset:0
  v_mfma_f32_16x16x32_bf16 v[224:227], a[196:199], v[56:59], v[224:227]
  ds_read_b128 a[132:135], v5 offset:1024
  v_cvt_pk_bf16_f32 v172, v184, v185
  v_mfma_f32_16x16x32_bf16 v[228:231], a[200:203], v[52:55], v[228:231]
  buffer_store_dwordx4 v[108:111], v1, s[12:15], s99 offen offset:3072
  v_mfma_f32_16x16x32_bf16 v[228:231], a[204:207], v[56:59], v[228:231]
  buffer_load_dwordx4 v4, s[12:15], s98 offen offset:0 sc1 lds
  v_mfma_f32_16x16x32_bf16 v[232:235], a[208:211], v[52:55], v[232:235]
  s_add_u32 s99, s99, 1015808
  ds_read_b128 a[136:139], v5 offset:2048
  ds_read_b128 a[140:143], v5 offset:3072
  v_mfma_f32_16x16x32_bf16 v[232:235], a[212:215], v[56:59], v[232:235]
  v_accvgpr_read_b32 v24, a120
  v_readfirstlane_b32 s56, v12
  v_mfma_f32_16x16x32_bf16 v[236:239], a[216:219], v[52:55], v[236:239]
  s_mov_b32 s66, s98
  ds_read_b128 a[144:147], v5 offset:4096
  v_accvgpr_read_b32 v25, a121
  v_mfma_f32_16x16x32_bf16 v[236:239], a[220:223], v[56:59], v[236:239]
  ds_read_b128 a[148:151], v5 offset:5120
  v_cvt_pk_bf16_f32 v173, v186, v187
  v_mfma_f32_16x16x32_bf16 v[240:243], a[224:227], v[52:55], v[240:243]
  v_accvgpr_read_b32 v26, a122
  v_cvt_pk_bf16_f32 v174, v188, v189
  v_mfma_f32_16x16x32_bf16 v[240:243], a[228:231], v[56:59], v[240:243]
  v_accvgpr_read_b32 v27, a123
  v_cvt_pk_bf16_f32 v175, v190, v191
  v_mfma_f32_16x16x32_bf16 v[244:247], a[232:235], v[52:55], v[244:247]
  v_accvgpr_read_b32 v28, a124
  v_cvt_pk_bf16_f32 v192, v192, v193
  v_mfma_f32_16x16x32_bf16 v[244:247], a[236:239], v[56:59], v[244:247]
  buffer_load_dwordx4 v4, s[12:15], s98 offen offset:1024 sc1 lds
  ds_read_b128 a[152:155], v5 offset:6144
  v_mfma_f32_16x16x32_bf16 v[248:251], a[240:243], v[52:55], v[248:251]
  ds_read_b128 a[156:159], v5 offset:7168
  v_accvgpr_read_b32 v29, a125
  v_mfma_f32_16x16x32_bf16 v[248:251], a[244:247], v[56:59], v[248:251]
  v_cvt_pk_bf16_f32 v193, v194, v195
  v_accvgpr_read_b32 v30, a126
  v_mfma_f32_16x16x32_bf16 v[252:255], a[248:251], v[52:55], v[252:255]
  ds_read_b128 a[160:163], v5 offset:8192
  ds_read_b128 a[164:167], v5 offset:9216
  v_cvt_pk_bf16_f32 v194, v196, v197
  v_cvt_pk_bf16_f32 v195, v198, v199
  v_cvt_pk_bf16_f32 v196, v200, v201
  v_cvt_pk_bf16_f32 v197, v202, v203
  v_cvt_pk_bf16_f32 v198, v204, v205
  v_cvt_pk_bf16_f32 v199, v206, v207
  v_mfma_f32_16x16x32_bf16 v[252:255], a[252:255], v[56:59], v[252:255]
  v_accvgpr_read_b32 v31, a127
  v_cvt_pk_bf16_f32 v124, v24, v25
  v_cvt_pk_bf16_f32 v125, v26, v27
  v_cvt_pk_bf16_f32 v126, v28, v29
  v_cvt_pk_bf16_f32 v127, v30, v31
  buffer_store_dwordx4 v[112:115], v1, s[12:15], s100 offen offset:0
  s_branch L_kf_kernel_ip_2
L_kf_kernel_kindV_3:
  s_waitcnt lgkmcnt(15)
  v_mfma_f32_16x16x32_bf16 a[0:3], v[44:47], a[128:131], 0
  s_mov_b32 s76, 0x3db8aa3b
  v_mfma_f32_16x16x32_bf16 a[0:3], v[48:51], a[132:135], a[0:3]
  s_mov_b32 s75, 0x4e800000
  ds_read_b128 v[52:55], v32 offset:2048
  v_mfma_f32_16x16x32_bf16 a[8:11], v[44:47], a[136:139], 0
  s_mov_b32 s73, 6
  v_mfma_f32_16x16x32_bf16 a[8:11], v[48:51], a[140:143], a[8:11]
  ds_read_b128 v[56:59], v33 offset:2048
  v_mfma_f32_16x16x32_bf16 a[16:19], v[44:47], a[144:147], 0
  s_waitcnt lgkmcnt(0)
  v_mfma_f32_16x16x32_bf16 a[16:19], v[48:51], a[148:151], a[16:19]
  s_barrier
  ds_read_b64_tr_b16 a[192:193], v34 offset:32768
  v_mfma_f32_16x16x32_bf16 a[24:27], v[44:47], a[152:155], 0
  s_add_u32 m0, s65, 0
  v_mfma_f32_16x16x32_bf16 a[24:27], v[48:51], a[156:159], a[24:27]
  ds_read_b64_tr_b16 a[194:195], v34 offset:34816
  v_mfma_f32_16x16x32_bf16 a[32:35], v[44:47], a[160:163], 0
  buffer_load_dwordx4 v28, s[8:11], s72 offen offset:0 nt lds
  v_mfma_f32_16x16x32_bf16 a[32:35], v[48:51], a[164:167], a[32:35]
  ds_read_b64_tr_b16 a[200:201], v35 offset:32768
  s_waitcnt vmcnt(14)
  v_lshlrev_b32 v104, 16, v96
  v_mfma_f32_16x16x32_bf16 a[40:43], v[44:47], a[168:171], 0
  buffer_load_dwordx4 v29, s[8:11], s72 offen offset:1024 nt lds
  v_mfma_f32_16x16x32_bf16 a[40:43], v[48:51], a[172:175], a[40:43]
  ds_read_b64_tr_b16 a[202:203], v35 offset:34816
  v_and_b32 v105, 0xffff0000, v96
  v_mfma_f32_16x16x32_bf16 a[48:51], v[44:47], a[176:179], 0
  buffer_load_dwordx4 v30, s[8:11], s72 offen offset:2048 nt lds
  v_mfma_f32_16x16x32_bf16 a[48:51], v[48:51], a[180:183], a[48:51]
  ds_read_b64_tr_b16 a[208:209], v36 offset:32768
  v_lshlrev_b32 v106, 16, v97
  v_mfma_f32_16x16x32_bf16 a[56:59], v[44:47], a[184:187], 0
  buffer_load_dwordx4 v31, s[8:11], s72 offen offset:3072 nt lds
  v_mfma_f32_16x16x32_bf16 a[56:59], v[48:51], a[188:191], a[56:59]
  ds_read_b64_tr_b16 a[210:211], v36 offset:34816
  s_add_u32 s72, s72, 262144
  v_mfma_f32_16x16x32_bf16 a[4:7], v[52:55], a[128:131], 0
  s_and_b32 s72, s72, 0x7fffff
  v_and_b32 v107, 0xffff0000, v97
  v_lshlrev_b32 v108, 16, v98
  v_mfma_f32_16x16x32_bf16 a[4:7], v[56:59], a[132:135], a[4:7]
  s_add_u32 m0, s65, 114688
  ds_read_b128 v[44:47], v32 offset:4096
  v_and_b32 v109, 0xffff0000, v98
  v_mfma_f32_16x16x32_bf16 a[12:15], v[52:55], a[136:139], 0
  v_lshlrev_b32 v110, 16, v99
  v_and_b32 v111, 0xffff0000, v99
  v_mfma_f32_16x16x32_bf16 a[12:15], v[56:59], a[140:143], a[12:15]
  ds_read_b128 v[48:51], v33 offset:4096
  s_waitcnt vmcnt(16)
  v_lshlrev_b32 v112, 16, v100
  v_mfma_f32_16x16x32_bf16 a[20:23], v[52:55], a[144:147], 0
  buffer_load_dwordx4 v24, s[4:7], s71 offen offset:0  lds
  v_mfma_f32_16x16x32_bf16 a[20:23], v[56:59], a[148:151], a[20:23]
  ds_read_b64_tr_b16 a[216:217], v37 offset:32768
  v_and_b32 v113, 0xffff0000, v100
  v_mfma_f32_16x16x32_bf16 a[28:31], v[52:55], a[152:155], 0
  buffer_load_dwordx4 v25, s[4:7], s71 offen offset:1024  lds
  v_mfma_f32_16x16x32_bf16 a[28:31], v[56:59], a[156:159], a[28:31]
  ds_read_b64_tr_b16 a[218:219], v37 offset:34816
  v_lshlrev_b32 v114, 16, v101
  v_mfma_f32_16x16x32_bf16 a[36:39], v[52:55], a[160:163], 0
  buffer_load_dwordx4 v26, s[4:7], s71 offen offset:2048  lds
  v_mfma_f32_16x16x32_bf16 a[36:39], v[56:59], a[164:167], a[36:39]
  ds_read_b64_tr_b16 a[224:225], v38 offset:32768
  v_and_b32 v115, 0xffff0000, v101
  v_mfma_f32_16x16x32_bf16 a[44:47], v[52:55], a[168:171], 0
  buffer_load_dwordx4 v27, s[4:7], s71 offen offset:3072  lds
  v_mfma_f32_16x16x32_bf16 a[44:47], v[56:59], a[172:175], a[44:47]
  ds_read_b64_tr_b16 a[226:227], v38 offset:34816
  s_add_u32 m0, s65, 16384
  v_mfma_f32_16x16x32_bf16 a[52:55], v[52:55], a[176:179], 0
  v_lshlrev_b32 v116, 16, v102
  v_and_b32 v117, 0xffff0000, v102
  v_mfma_f32_16x16x32_bf16 a[52:55], v[56:59], a[180:183], a[52:55]
  ds_read_b64_tr_b16 a[232:233], v39 offset:32768
  v_lshlrev_b32 v118, 16, v103
  v_mfma_f32_16x16x32_bf16 a[60:63], v[52:55], a[184:187], 0
  ds_read_b64_tr_b16 a[234:235], v39 offset:34816
  v_and_b32 v119, 0xffff0000, v103
  v_mfma_f32_16x16x32_bf16 a[60:63], v[56:59], a[188:191], a[60:63]
  s_waitcnt lgkmcnt(6)
  ds_read_b64_tr_b16 a[240:241], v40 offset:32768
  buffer_load_dwordx4 v28, s[8:11], s72 offen offset:0 nt lds
  v_mfma_f32_16x16x32_bf16 a[64:67], v[44:47], a[128:131], 0
  buffer_load_dwordx4 v29, s[8:11], s72 offen offset:1024 nt lds
  v_mfma_f32_16x16x32_bf16 a[64:67], v[48:51], a[132:135], a[64:67]
  ds_read_b128 v[52:55], v32 offset:6144
  v_add_f32 v120, v104, v105
  v_mfma_f32_16x16x32_bf16 a[72:75], v[44:47], a[136:139], 0
  buffer_load_dwordx4 v30, s[8:11], s72 offen offset:2048 nt lds
  v_mfma_f32_16x16x32_bf16 a[72:75], v[48:51], a[140:143], a[72:75]
  ds_read_b128 v[56:59], v33 offset:6144
  v_add_f32 v120, v120, v106
  v_mfma_f32_16x16x32_bf16 a[80:83], v[44:47], a[144:147], 0
  ds_read_b64_tr_b16 a[242:243], v40 offset:34816
  v_add_f32 v120, v120, v107
  v_mfma_f32_16x16x32_bf16 a[80:83], v[48:51], a[148:151], a[80:83]
  ds_read_b64_tr_b16 a[248:249], v41 offset:32768
  buffer_load_dwordx4 v31, s[8:11], s72 offen offset:3072 nt lds
  v_mfma_f32_16x16x32_bf16 a[88:91], v[44:47], a[152:155], 0
  s_add_u32 s72, s72, 262144
  s_and_b32 s72, s72, 0x7fffff
  v_add_f32 v120, v120, v108
  v_mfma_f32_16x16x32_bf16 a[88:91], v[48:51], a[156:159], a[88:91]
  ds_read_b64_tr_b16 a[250:251], v41 offset:34816
  s_add_u32 s70, s70, 128
  v_mfma_f32_16x16x32_bf16 a[96:99], v[44:47], a[160:163], 0
  s_and_b32 s70, s70, 0x7ff
  v_add_f32 v120, v120, v109
  v_add_f32 v120, v120, v110
  v_mfma_f32_16x16x32_bf16 a[96:99], v[48:51], a[164:167], a[96:99]
  s_add_u32 s71, s71, 128
  s_and_b32 s71, s71, 0x2007ff
  v_add_f32 v120, v120, v111
  v_mfma_f32_16x16x32_bf16 a[104:107], v[44:47], a[168:171], 0
  v_add_f32 v121, v112, v113
  v_add_f32 v121, v121, v114
  v_mfma_f32_16x16x32_bf16 a[104:107], v[48:51], a[172:175], a[104:107]
  v_add_f32 v121, v121, v115
  v_add_f32 v121, v121, v116
  v_mfma_f32_16x16x32_bf16 a[112:115], v[44:47], a[176:179], 0
  s_add_u32 m0, s1, 0
  v_add_f32 v121, v121, v117
  v_add_f32 v121, v121, v118
  v_mfma_f32_16x16x32_bf16 a[112:115], v[48:51], a[180:183], a[112:115]
  buffer_load_dwordx4 v42, s[20:23], s36 offen nt lds
  v_mfma_f32_16x16x32_bf16 a[120:123], v[44:47], a[184:187], 0
  s_waitcnt vmcnt(17) lgkmcnt(0)
  v_add_f32 v121, v121, v119
  v_add_f32_dpp v120, v120, v120 row_shr:1 row_mask:0xf bank_mask:0xf bound_ctrl:0
  v_mfma_f32_16x16x32_bf16 a[120:123], v[48:51], a[188:191], a[120:123]
  s_barrier
  v_add_f32_dpp v121, v121, v121 row_shr:1 row_mask:0xf bank_mask:0xf bound_ctrl:0
  v_add_f32_dpp v120, v120, v120 row_shr:2 row_mask:0xf bank_mask:0xf bound_ctrl:0
  v_mfma_f32_16x16x32_bf16 a[68:71], v[52:55], a[128:131], 0
  s_add_u32 m0, s65, 65536
  v_add_f32_dpp v121, v121, v121 row_shr:2 row_mask:0xf bank_mask:0xf bound_ctrl:0
  v_add_f32_dpp v120, v120, v120 row_shr:4 row_mask:0xf bank_mask:0xf bound_ctrl:0
  v_mfma_f32_16x16x32_bf16 a[68:71], v[56:59], a[132:135], a[68:71]
  ds_read_b128 v[44:47], v32 offset:16384
  v_add_f32_dpp v121, v121, v121 row_shr:4 row_mask:0xf bank_mask:0xf bound_ctrl:0
  v_mfma_f32_16x16x32_bf16 a[76:79], v[52:55], a[136:139], 0
  buffer_load_dwordx4 v24, s[4:7], s70 offen offset:0  lds
  v_mfma_f32_16x16x32_bf16 a[76:79], v[56:59], a[140:143], a[76:79]
  ds_read_b128 v[48:51], v33 offset:16384
  v_add_f32_dpp v120, v120, v120 row_shr:8 row_mask:0xf bank_mask:0xf bound_ctrl:0
  v_mfma_f32_16x16x32_bf16 a[84:87], v[52:55], a[144:147], 0
  s_add_u32 s36, s36, s37
  v_add_f32_dpp v121, v121, v121 row_shr:8 row_mask:0xf bank_mask:0xf bound_ctrl:0
  v_add_f32_dpp v120, v120, v120 row_bcast:15 row_mask:0xa bank_mask:0xf
  v_mfma_f32_16x16x32_bf16 a[84:87], v[56:59], a[148:151], a[84:87]
  v_add_f32_dpp v121, v121, v121 row_bcast:15 row_mask:0xa bank_mask:0xf
  v_add_f32_dpp v120, v120, v120 row_bcast:31 row_mask:0xc bank_mask:0xf
  v_mfma_f32_16x16x32_bf16 a[92:95], v[52:55], a[152:155], 0
  v_add_f32_dpp v121, v121, v121 row_bcast:31 row_mask:0xc bank_mask:0xf
  v_mov_b32 v122, 0x3b124925
  v_mfma_f32_16x16x32_bf16 a[92:95], v[56:59], a[156:159], a[92:95]
  v_readlane_b32 s96, v120, 63
  v_readlane_b32 s97, v121, 63
  v_mfma_f32_16x16x32_bf16 a[100:103], v[52:55], a[160:163], 0
  v_mul_f32 v120, s96, v122
  v_mul_f32 v121, s97, v122
  v_mfma_f32_16x16x32_bf16 a[100:103], v[56:59], a[164:167], a[100:103]
  v_sub_f32 v126, v104, v120
  v_mul_f32 v124, v126, v126
  v_mfma_f32_16x16x32_bf16 a[108:111], v[52:55], a[168:171], 0
  buffer_load_dwordx4 v25, s[4:7], s70 offen offset:1024  lds
  v_mfma_f32_16x16x32_bf16 a[108:111], v[56:59], a[172:175], a[108:111]
  v_sub_f32 v126, v105, v120
  v_fmac_f32 v124, v126, v126
  v_mfma_f32_16x16x32_bf16 a[116:119], v[52:55], a[176:179], 0
  v_sub_f32 v126, v106, v120
  v_fmac_f32 v124, v126, v126
  v_mfma_f32_16x16x32_bf16 a[116:119], v[56:59], a[180:183], a[116:119]
  v_sub_f32 v126, v107, v120
  v_fmac_f32 v124, v126, v126
  v_mfma_f32_16x16x32_bf16 a[124:127], v[52:55], a[184:187], 0
  v_sub_f32 v126, v108, v120
  v_fmac_f32 v124, v126, v126
  v_mfma_f32_16x16x32_bf16 a[124:127], v[56:59], a[188:191], a[124:127]
  s_waitcnt lgkmcnt(0)
  v_sub_f32 v126, v109, v120
  v_fmac_f32 v124, v126, v126
  v_mfma_f32_16x16x32_bf16 v[128:131], v[44:47], a[128:131], 0
  v_sub_f32 v126, v110, v120
  v_fmac_f32 v124, v126, v126
  v_mfma_f32_16x16x32_bf16 v[128:131], v[48:51], a[132:135], v[128:131]
  ds_read_b128 v[52:55], v32 offset:18432
  v_sub_f32 v126, v111, v120
  v_mfma_f32_16x16x32_bf16 v[136:139], v[44:47], a[136:139], 0
  buffer_load_dwordx4 v26, s[4:7], s70 offen offset:2048  lds
  v_mfma_f32_16x16x32_bf16 v[136:139], v[48:51], a[140:143], v[136:139]
  ds_read_b128 v[56:59], v33 offset:18432
  v_fmac_f32 v124, v126, v126
  v_mfma_f32_16x16x32_bf16 v[144:147], v[44:47], a[144:147], 0
  v_cndmask_b32 v124, 0, v124, vcc
  v_sub_f32 v126, v112, v121
  v_mfma_f32_16x16x32_bf16 v[144:147], v[48:51], a[148:151], v[144:147]
  ds_read_b64_tr_b16 a[196:197], v34 offset:49152
  v_mul_f32 v125, v126, v126
  v_mfma_f32_16x16x32_bf16 v[152:155], v[44:47], a[152:155], 0
  v_sub_f32 v126, v113, v121
  v_fmac_f32 v125, v126, v126
  v_mfma_f32_16x16x32_bf16 v[152:155], v[48:51], a[156:159], v[152:155]
  ds_read_b64_tr_b16 a[198:199], v34 offset:51200
  v_sub_f32 v126, v114, v121
  v_mfma_f32_16x16x32_bf16 v[160:163], v[44:47], a[160:163], 0
  v_fmac_f32 v125, v126, v126
  v_sub_f32 v126, v115, v121
  v_mfma_f32_16x16x32_bf16 v[160:163], v[48:51], a[164:167], v[160:163]
  ds_read_b64_tr_b16 a[204:205], v35 offset:49152
  v_fmac_f32 v125, v126, v126
  v_mfma_f32_16x16x32_bf16 v[168:171], v[44:47], a[168:171], 0
  buffer_load_dwordx4 v27, s[4:7], s70 offen offset:3072  lds
  v_mfma_f32_16x16x32_bf16 v[168:171], v[48:51], a[172:175], v[168:171]
  ds_read_b64_tr_b16 a[206:207], v35 offset:51200
  v_sub_f32 v126, v116, v121
  v_mfma_f32_16x16x32_bf16 v[176:179], v[44:47], a[176:179], 0
  v_fmac_f32 v125, v126, v126
  v_sub_f32 v126, v117, v121
  v_mfma_f32_16x16x32_bf16 v[176:179], v[48:51], a[180:183], v[176:179]
  ds_read_b64_tr_b16 a[212:213], v36 offset:49152
  v_fmac_f32 v125, v126, v126
  v_mfma_f32_16x16x32_bf16 v[184:187], v[44:47], a[184:187], 0
  v_sub_f32 v126, v118, v121
  v_fmac_f32 v125, v126, v126
  v_mfma_f32_16x16x32_bf16 v[184:187], v[48:51], a[188:191], v[184:187]
  s_waitcnt lgkmcnt(5)
  ds_read_b64_tr_b16 a[214:215], v36 offset:51200
  v_sub_f32 v126, v119, v121
  v_mfma_f32_16x16x32_bf16 v[132:135], v[52:55], a[128:131], 0
  s_add_u32 m0, s65, 32768
  v_fmac_f32 v125, v126, v126
  v_cndmask_b32 v125, 0, v125, vcc
  v_mfma_f32_16x16x32_bf16 v[132:135], v[56:59], a[132:135], v[132:135]
  ds_read_b128 v[44:47], v32 offset:20480
  v_add_f32_dpp v124, v124, v124 row_shr:1 row_mask:0xf bank_mask:0xf bound_ctrl:0
  v_mfma_f32_16x16x32_bf16 v[140:143], v[52:55], a[136:139], 0
  buffer_load_dwordx4 v28, s[8:11], s72 offen offset:0 nt lds
  v_mfma_f32_16x16x32_bf16 v[140:143], v[56:59], a[140:143], v[140:143]
  ds_read_b128 v[48:51], v33 offset:20480
  v_add_f32_dpp v125, v125, v125 row_shr:1 row_mask:0xf bank_mask:0xf bound_ctrl:0
  v_mfma_f32_16x16x32_bf16 v[148:151], v[52:55], a[144:147], 0
  v_add_f32_dpp v124, v124, v124 row_shr:2 row_mask:0xf bank_mask:0xf bound_ctrl:0
  v_add_f32_dpp v125, v125, v125 row_shr:2 row_mask:0xf bank_mask:0xf bound_ctrl:0
  v_mfma_f32_16x16x32_bf16 v[148:151], v[56:59], a[148:151], v[148:151]
  ds_read_b64_tr_b16 a[220:221], v37 offset:49152
  v_add_f32_dpp v124, v124, v124 row_shr:4 row_mask:0xf bank_mask:0xf bound_ctrl:0
  v_mfma_f32_16x16x32_bf16 v[156:159], v[52:55], a[152:155], 0
  v_add_f32_dpp v125, v125, v125 row_shr:4 row_mask:0xf bank_mask:0xf bound_ctrl:0
  v_add_f32_dpp v124, v124, v124 row_shr:8 row_mask:0xf bank_mask:0xf bound_ctrl:0
  v_mfma_f32_16x16x32_bf16 v[156:159], v[56:59], a[156:159], v[156:159]
  ds_read_b64_tr_b16 a[222:223], v37 offset:51200
  v_add_f32_dpp v125, v125, v125 row_shr:8 row_mask:0xf bank_mask:0xf bound_ctrl:0
  v_mfma_f32_16x16x32_bf16 v[164:167], v[52:55], a[160:163], 0
  v_add_f32_dpp v124, v124, v124 row_bcast:15 row_mask:0xa bank_mask:0xf
  v_add_f32_dpp v125, v125, v125 row_bcast:15 row_mask:0xa bank_mask:0xf
  v_mfma_f32_16x16x32_bf16 v[164:167], v[56:59], a[164:167], v[164:167]
  ds_read_b64_tr_b16 a[228:229], v38 offset:49152
  v_add_f32_dpp v124, v124, v124 row_bcast:31 row_mask:0xc bank_mask:0xf
  v_mfma_f32_16x16x32_bf16 v[172:175], v[52:55], a[168:171], 0
  buffer_load_dwordx4 v29, s[8:11], s72 offen offset:1024 nt lds
  v_mfma_f32_16x16x32_bf16 v[172:175], v[56:59], a[172:175], v[172:175]
  ds_read_b64_tr_b16 a[230:231], v38 offset:51200
  v_add_f32_dpp v125, v125, v125 row_bcast:31 row_mask:0xc bank_mask:0xf
  v_mfma_f32_16x16x32_bf16 v[180:183], v[52:55], a[176:179], 0
  v_readlane_b32 s96, v124, 63
  v_readlane_b32 s97, v125, 63
  v_mfma_f32_16x16x32_bf16 v[180:183], v[56:59], a[180:183], v[180:183]
  ds_read_b64_tr_b16 a[236:237], v39 offset:49152
  v_mul_f32 v124, s96, v122
  v_mfma_f32_16x16x32_bf16 v[188:191], v[52:55], a[184:187], 0
  ds_read_b64_tr_b16 a[238:239], v39 offset:51200
  v_mul_f32 v125, s97, v122
  v_mfma_f32_16x16x32_bf16 v[188:191], v[56:59], a[188:191], v[188:191]
  s_waitcnt lgkmcnt(6)
  ds_read_b64_tr_b16 a[244:245], v40 offset:49152
  v_cvt_pk_bf16_f32 v120, v120, v120
  v_mfma_f32_16x16x32_bf16 v[192:195], v[44:47], a[128:131], 0
  v_and_b32 v120, 0xffff0000, v120
  v_cvt_pk_bf16_f32 v124, v124, v124
  v_mfma_f32_16x16x32_bf16 v[192:195], v[48:51], a[132:135], v[192:195]
  ds_read_b128 v[52:55], v32 offset:22528
  v_and_b32 v124, 0xffff0000, v124
  v_mfma_f32_16x16x32_bf16 v[200:203], v[44:47], a[136:139], 0
  buffer_load_dwordx4 v30, s[8:11], s72 offen offset:2048 nt lds
  v_mfma_f32_16x16x32_bf16 v[200:203], v[48:51], a[140:143], v[200:203]
  ds_read_b128 v[56:59], v33 offset:22528
  v_add_f32 v124, 0x3727c5ac, v124
  v_mfma_f32_16x16x32_bf16 v[208:211], v[44:47], a[144:147], 0
  ds_read_b64_tr_b16 a[246:247], v40 offset:51200
  v_cvt_pk_bf16_f32 v124, v124, v124
  v_mfma_f32_16x16x32_bf16 v[208:211], v[48:51], a[148:151], v[208:211]
  ds_read_b64_tr_b16 a[252:253], v41 offset:49152
  v_and_b32 v124, 0xffff0000, v124
  v_mfma_f32_16x16x32_bf16 v[216:219], v[44:47], a[152:155], 0
  v_sqrt_f32 v124, v124
  v_mfma_f32_16x16x32_bf16 v[216:219], v[48:51], a[156:159], v[216:219]
  ds_read_b64_tr_b16 a[254:255], v41 offset:51200
  v_cvt_pk_bf16_f32 v124, v124, v124
  v_mfma_f32_16x16x32_bf16 v[224:227], v[44:47], a[160:163], 0
  v_and_b32 v124, 0xffff0000, v124
  v_mfma_f32_16x16x32_bf16 v[224:227], v[48:51], a[164:167], v[224:227]
  v_rcp_f32 v124, v124
  v_mfma_f32_16x16x32_bf16 v[232:235], v[44:47], a[168:171], 0
  buffer_load_dwordx4 v31, s[8:11], s72 offen offset:3072 nt lds
  v_mfma_f32_16x16x32_bf16 v[232:235], v[48:51], a[172:175], v[232:235]
  v_sub_f32 v104, v104, v120
  v_sub_f32 v105, v105, v120
  v_mfma_f32_16x16x32_bf16 v[240:243], v[44:47], a[176:179], 0
  s_add_u32 s72, s72, 262144
  s_and_b32 s72, s72, 0x7fffff
  s_add_u32 m0, s1, 1024
  v_mfma_f32_16x16x32_bf16 v[240:243], v[48:51], a[180:183], v[240:243]
  buffer_load_dwordx4 v42, s[20:23], s36 offen nt lds
  v_mfma_f32_16x16x32_bf16 v[248:251], v[44:47], a[184:187], 0
  s_waitcnt vmcnt(18) lgkmcnt(0)
  v_cvt_pk_bf16_f32 v126, v104, v105
  v_lshlrev_b32 v104, 16, v126
  v_mfma_f32_16x16x32_bf16 v[248:251], v[48:51], a[188:191], v[248:251]
  s_barrier
  v_and_b32 v105, 0xffff0000, v126
  v_mul_f32 v104, v104, v124
  v_mfma_f32_16x16x32_bf16 v[196:199], v[52:55], a[128:131], 0
  s_add_u32 m0, s65, 81920
  v_mul_f32 v105, v105, v124
  v_cvt_pk_bf16_f32 v96, v104, v105
  v_mfma_f32_16x16x32_bf16 v[196:199], v[56:59], a[132:135], v[196:199]
  ds_read_b128 v[44:47], v32 offset:32768
  v_sub_f32 v106, v106, v120
  v_mfma_f32_16x16x32_bf16 v[204:207], v[52:55], a[136:139], 0
  buffer_load_dwordx4 v24, s[4:7], s71 offen offset:0  lds
  v_mfma_f32_16x16x32_bf16 v[204:207], v[56:59], a[140:143], v[204:207]
  ds_read_b128 v[48:51], v33 offset:32768
  v_sub_f32 v107, v107, v120
  v_mfma_f32_16x16x32_bf16 v[212:215], v[52:55], a[144:147], 0
  s_add_u32 s36, s36, s37
  v_cvt_pk_bf16_f32 v126, v106, v107
  v_lshlrev_b32 v106, 16, v126
  v_mfma_f32_16x16x32_bf16 v[212:215], v[56:59], a[148:151], v[212:215]
  v_and_b32 v107, 0xffff0000, v126
  v_mul_f32 v106, v106, v124
  v_mfma_f32_16x16x32_bf16 v[220:223], v[52:55], a[152:155], 0
  v_mul_f32 v107, v107, v124
  v_cvt_pk_bf16_f32 v97, v106, v107
  v_mfma_f32_16x16x32_bf16 v[220:223], v[56:59], a[156:159], v[220:223]
  v_sub_f32 v108, v108, v120
  v_sub_f32 v109, v109, v120
  v_mfma_f32_16x16x32_bf16 v[228:231], v[52:55], a[160:163], 0
  v_cvt_pk_bf16_f32 v126, v108, v109
  v_lshlrev_b32 v108, 16, v126
  v_mfma_f32_16x16x32_bf16 v[228:231], v[56:59], a[164:167], v[228:231]
  v_and_b32 v109, 0xffff0000, v126
  v_mul_f32 v108, v108, v124
  v_mfma_f32_16x16x32_bf16 v[236:239], v[52:55], a[168:171], 0
  buffer_load_dwordx4 v25, s[4:7], s71 offen offset:1024  lds
  v_mfma_f32_16x16x32_bf16 v[236:239], v[56:59], a[172:175], v[236:239]
  v_mul_f32 v109, v109, v124
  v_cvt_pk_bf16_f32 v98, v108, v109
  v_mfma_f32_16x16x32_bf16 v[244:247], v[52:55], a[176:179], 0
  v_sub_f32 v110, v110, v120
  v_sub_f32 v111, v111, v120
  v_mfma_f32_16x16x32_bf16 v[244:247], v[56:59], a[180:183], v[244:247]
  v_cvt_pk_bf16_f32 v126, v110, v111
  v_lshlrev_b32 v110, 16, v126
  v_mfma_f32_16x16x32_bf16 v[252:255], v[52:55], a[184:187], 0
  v_and_b32 v111, 0xffff0000, v126
  v_mul_f32 v110, v110, v124
  v_mfma_f32_16x16x32_bf16 v[252:255], v[56:59], a[188:191], v[252:255]
  s_waitcnt lgkmcnt(0)
  v_mul_f32 v111, v111, v124
  v_cvt_pk_bf16_f32 v99, v110, v111
  v_mfma_f32_16x16x32_bf16 a[0:3], v[44:47], a[192:195], a[0:3]
  ds_write_b64 v80, v[96:97] offset:0
  ds_write_b64 v80, v[98:99] offset:128
  v_mfma_f32_16x16x32_bf16 a[0:3], v[48:51], a[196:199], a[0:3]
  ds_read_b128 v[52:55], v32 offset:34816
  v_cvt_pk_bf16_f32 v121, v121, v121
  v_mfma_f32_16x16x32_bf16 a[8:11], v[44:47], a[200:203], a[8:11]
  buffer_load_dwordx4 v26, s[4:7], s71 offen offset:2048  lds
  v_mfma_f32_16x16x32_bf16 a[8:11], v[48:51], a[204:207], a[8:11]
  ds_read_b128 v[56:59], v33 offset:34816
  v_and_b32 v121, 0xffff0000, v121
  v_mfma_f32_16x16x32_bf16 a[16:19], v[44:47], a[208:211], a[16:19]
  v_cvt_pk_bf16_f32 v125, v125, v125
  v_and_b32 v125, 0xffff0000, v125
  v_mfma_f32_16x16x32_bf16 a[16:19], v[48:51], a[212:215], a[16:19]
  ds_read_b64_tr_b16 a[128:129], v34 offset:0
  v_add_f32 v125, 0x3727c5ac, v125
  v_mfma_f32_16x16x32_bf16 a[24:27], v[44:47], a[216:219], a[24:27]
  v_cvt_pk_bf16_f32 v125, v125, v125
  v_and_b32 v125, 0xffff0000, v125
  v_mfma_f32_16x16x32_bf16 a[24:27], v[48:51], a[220:223], a[24:27]
  ds_read_b64_tr_b16 a[130:131], v34 offset:2048
  v_mfma_f32_16x16x32_bf16 a[32:35], v[44:47], a[224:227], a[32:35]
  v_sqrt_f32 v125, v125
  v_mfma_f32_16x16x32_bf16 a[32:35], v[48:51], a[228:231], a[32:35]
  ds_read_b64_tr_b16 a[136:137], v35 offset:0
  v_cvt_pk_bf16_f32 v125, v125, v125
  v_mfma_f32_16x16x32_bf16 a[40:43], v[44:47], a[232:235], a[40:43]
  buffer_load_dwordx4 v27, s[4:7], s71 offen offset:3072  lds
  v_mfma_f32_16x16x32_bf16 a[40:43], v[48:51], a[236:239], a[40:43]
  ds_read_b64_tr_b16 a[138:139], v35 offset:2048
  v_and_b32 v125, 0xffff0000, v125
  v_mfma_f32_16x16x32_bf16 a[48:51], v[44:47], a[240:243], a[48:51]
  v_rcp_f32 v125, v125
  v_mfma_f32_16x16x32_bf16 a[48:51], v[48:51], a[244:247], a[48:51]
  ds_read_b64_tr_b16 a[144:145], v36 offset:0
  v_sub_f32 v112, v112, v121
  v_mfma_f32_16x16x32_bf16 a[56:59], v[44:47], a[248:251], a[56:59]
  s_add_u32 s70, s70, 128
  s_and_b32 s70, s70, 0x7ff
  v_sub_f32 v113, v113, v121
  v_mfma_f32_16x16x32_bf16 a[56:59], v[48:51], a[252:255], a[56:59]
  s_waitcnt lgkmcnt(5)
  ds_read_b64_tr_b16 a[146:147], v36 offset:2048
  v_cvt_pk_bf16_f32 v126, v112, v113
  v_mfma_f32_16x16x32_bf16 a[4:7], v[52:55], a[192:195], a[4:7]
  s_add_u32 m0, s65, 49152
  v_lshlrev_b32 v112, 16, v126
  v_and_b32 v113, 0xffff0000, v126
  v_mfma_f32_16x16x32_bf16 a[4:7], v[56:59], a[196:199], a[4:7]
  ds_read_b128 v[44:47], v32 offset:36864
  v_mul_f32 v112, v112, v125
  v_mfma_f32_16x16x32_bf16 a[12:15], v[52:55], a[200:203], a[12:15]
  buffer_load_dwordx4 v28, s[8:11], s72 offen offset:0 nt lds
  v_mfma_f32_16x16x32_bf16 a[12:15], v[56:59], a[204:207], a[12:15]
  ds_read_b128 v[48:51], v33 offset:36864
  v_mul_f32 v113, v113, v125
  v_mfma_f32_16x16x32_bf16 a[20:23], v[52:55], a[208:211], a[20:23]
  s_add_u32 s71, s71, 128
  s_and_b32 s71, s71, 0x2007ff
  v_cvt_pk_bf16_f32 v100, v112, v113
  v_mfma_f32_16x16x32_bf16 a[20:23], v[56:59], a[212:215], a[20:23]
  ds_read_b64_tr_b16 a[152:153], v37 offset:0
  v_sub_f32 v114, v114, v121
  v_mfma_f32_16x16x32_bf16 a[28:31], v[52:55], a[216:219], a[28:31]
  v_sub_f32 v115, v115, v121
  v_cvt_pk_bf16_f32 v126, v114, v115
  v_mfma_f32_16x16x32_bf16 a[28:31], v[56:59], a[220:223], a[28:31]
  ds_read_b64_tr_b16 a[154:155], v37 offset:2048
  v_lshlrev_b32 v114, 16, v126
  v_mfma_f32_16x16x32_bf16 a[36:39], v[52:55], a[224:227], a[36:39]
  v_and_b32 v115, 0xffff0000, v126
  v_mul_f32 v114, v114, v125
  v_mfma_f32_16x16x32_bf16 a[36:39], v[56:59], a[228:231], a[36:39]
  ds_read_b64_tr_b16 a[160:161], v38 offset:0
  v_mul_f32 v115, v115, v125
  v_mfma_f32_16x16x32_bf16 a[44:47], v[52:55], a[232:235], a[44:47]
  buffer_load_dwordx4 v29, s[8:11], s72 offen offset:1024 nt lds
  v_mfma_f32_16x16x32_bf16 a[44:47], v[56:59], a[236:239], a[44:47]
  ds_read_b64_tr_b16 a[162:163], v38 offset:2048
  v_cvt_pk_bf16_f32 v101, v114, v115
  v_mfma_f32_16x16x32_bf16 a[52:55], v[52:55], a[240:243], a[52:55]
  v_sub_f32 v116, v116, v121
  v_sub_f32 v117, v117, v121
  v_mfma_f32_16x16x32_bf16 a[52:55], v[56:59], a[244:247], a[52:55]
  ds_read_b64_tr_b16 a[168:169], v39 offset:0
  v_cvt_pk_bf16_f32 v126, v116, v117
  v_mfma_f32_16x16x32_bf16 a[60:63], v[52:55], a[248:251], a[60:63]
  ds_read_b64_tr_b16 a[170:171], v39 offset:2048
  v_lshlrev_b32 v116, 16, v126
  v_mfma_f32_16x16x32_bf16 a[60:63], v[56:59], a[252:255], a[60:63]
  s_waitcnt lgkmcnt(6)
  ds_read_b64_tr_b16 a[176:177], v40 offset:0
  v_and_b32 v117, 0xffff0000, v126
  v_mfma_f32_16x16x32_bf16 a[64:67], v[44:47], a[192:195], a[64:67]
  v_mul_f32 v116, v116, v125
  v_mul_f32 v117, v117, v125
  v_mfma_f32_16x16x32_bf16 a[64:67], v[48:51], a[196:199], a[64:67]
  ds_read_b128 v[52:55], v32 offset:38912
  v_cvt_pk_bf16_f32 v102, v116, v117
  v_mfma_f32_16x16x32_bf16 a[72:75], v[44:47], a[200:203], a[72:75]
  buffer_load_dwordx4 v30, s[8:11], s72 offen offset:2048 nt lds
  v_mfma_f32_16x16x32_bf16 a[72:75], v[48:51], a[204:207], a[72:75]
  ds_read_b128 v[56:59], v33 offset:38912
  v_sub_f32 v118, v118, v121
  v_mfma_f32_16x16x32_bf16 a[80:83], v[44:47], a[208:211], a[80:83]
  ds_read_b64_tr_b16 a[178:179], v40 offset:2048
  v_sub_f32 v119, v119, v121
  v_mfma_f32_16x16x32_bf16 a[80:83], v[48:51], a[212:215], a[80:83]
  ds_read_b64_tr_b16 a[184:185], v41 offset:0
  v_cvt_pk_bf16_f32 v126, v118, v119
  v_mfma_f32_16x16x32_bf16 a[88:91], v[44:47], a[216:219], a[88:91]
  v_lshlrev_b32 v118, 16, v126
  v_and_b32 v119, 0xffff0000, v126
  v_mfma_f32_16x16x32_bf16 a[88:91], v[48:51], a[220:223], a[88:91]
  ds_read_b64_tr_b16 a[186:187], v41 offset:2048
  v_mul_f32 v118, v118, v125
  v_mfma_f32_16x16x32_bf16 a[96:99], v[44:47], a[224:227], a[96:99]
  v_mul_f32 v119, v119, v125
  v_cvt_pk_bf16_f32 v103, v118, v119
  v_mfma_f32_16x16x32_bf16 a[96:99], v[48:51], a[228:231], a[96:99]
  ds_write_b64 v80, v[100:101] offset:16
  ds_write_b64 v80, v[102:103] offset:144
  v_mfma_f32_16x16x32_bf16 a[104:107], v[44:47], a[232:235], a[104:107]
  buffer_load_dwordx4 v31, s[8:11], s72 offen offset:3072 nt lds
  v_mfma_f32_16x16x32_bf16 a[104:107], v[48:51], a[236:239], a[104:107]
  v_mfma_f32_16x16x32_bf16 a[112:115], v[44:47], a[240:243], a[112:115]
  s_add_u32 s72, s72, 262144
  s_and_b32 s72, s72, 0x7fffff
  s_add_u32 m0, s1, 2048
  v_mfma_f32_16x16x32_bf16 a[112:115], v[48:51], a[244:247], a[112:115]
  buffer_load_dwordx4 v42, s[20:23], s36 offen nt lds
  v_mfma_f32_16x16x32_bf16 a[120:123], v[44:47], a[248:251], a[120:123]
  s_waitcnt vmcnt(19) lgkmcnt(0)
  v_mfma_f32_16x16x32_bf16 a[120:123], v[48:51], a[252:255], a[120:123]
  s_barrier
  v_mfma_f32_16x16x32_bf16 a[68:71], v[52:55], a[192:195], a[68:71]
  s_add_u32 m0, s65, 98304
  ds_read_b128 v[96:99], v81
  ds_read_b128 v[100:103], v81 offset:1088
  v_mfma_f32_16x16x32_bf16 a[68:71], v[56:59], a[196:199], a[68:71]
  ds_read_b128 v[44:47], v32 offset:49152
  v_mfma_f32_16x16x32_bf16 a[76:79], v[52:55], a[200:203], a[76:79]
  buffer_load_dwordx4 v24, s[4:7], s70 offen offset:0  lds
  v_mfma_f32_16x16x32_bf16 a[76:79], v[56:59], a[204:207], a[76:79]
  ds_read_b128 v[48:51], v33 offset:49152
  v_mfma_f32_16x16x32_bf16 a[84:87], v[52:55], a[208:211], a[84:87]
  s_add_u32 s36, s36, s37
  v_mfma_f32_16x16x32_bf16 a[84:87], v[56:59], a[212:215], a[84:87]
  v_mfma_f32_16x16x32_bf16 a[92:95], v[52:55], a[216:219], a[92:95]
  v_mfma_f32_16x16x32_bf16 a[92:95], v[56:59], a[220:223], a[92:95]
  v_mfma_f32_16x16x32_bf16 a[100:103], v[52:55], a[224:227], a[100:103]
  v_mfma_f32_16x16x32_bf16 a[100:103], v[56:59], a[228:231], a[100:103]
  v_mfma_f32_16x16x32_bf16 a[108:111], v[52:55], a[232:235], a[108:111]
  buffer_load_dwordx4 v25, s[4:7], s70 offen offset:1024  lds
  v_mfma_f32_16x16x32_bf16 a[108:111], v[56:59], a[236:239], a[108:111]
  v_mfma_f32_16x16x32_bf16 a[116:119], v[52:55], a[240:243], a[116:119]
  s_waitcnt lgkmcnt(3)
  buffer_store_dwordx4 v[96:99], v82, s[12:15], s19 offen sc1
  v_mfma_f32_16x16x32_bf16 a[116:119], v[56:59], a[244:247], a[116:119]
  v_mfma_f32_16x16x32_bf16 a[124:127], v[52:55], a[248:251], a[124:127]
  s_waitcnt lgkmcnt(2)
  buffer_store_dwordx4 v[100:103], v82, s[12:15], s79 offen offset:2048 sc1
  v_mfma_f32_16x16x32_bf16 a[124:127], v[56:59], a[252:255], a[124:127]
  s_waitcnt lgkmcnt(0)
  v_mfma_f32_16x16x32_bf16 v[128:131], v[44:47], a[192:195], v[128:131]
  v_mfma_f32_16x16x32_bf16 v[128:131], v[48:51], a[196:199], v[128:131]
  ds_read_b128 v[52:55], v32 offset:51200
  v_mfma_f32_16x16x32_bf16 v[136:139], v[44:47], a[200:203], v[136:139]
  buffer_load_dwordx4 v26, s[4:7], s70 offen offset:2048  lds
  v_mfma_f32_16x16x32_bf16 v[136:139], v[48:51], a[204:207], v[136:139]
  ds_read_b128 v[56:59], v33 offset:51200
  v_mfma_f32_16x16x32_bf16 v[144:147], v[44:47], a[208:211], v[144:147]
  v_mfma_f32_16x16x32_bf16 v[144:147], v[48:51], a[212:215], v[144:147]
  ds_read_b64_tr_b16 a[132:133], v34 offset:16384
  v_mfma_f32_16x16x32_bf16 v[152:155], v[44:47], a[216:219], v[152:155]
  v_mfma_f32_16x16x32_bf16 v[152:155], v[48:51], a[220:223], v[152:155]
  ds_read_b64_tr_b16 a[134:135], v34 offset:18432
  v_mfma_f32_16x16x32_bf16 v[160:163], v[44:47], a[224:227], v[160:163]
  buffer_store_dwordx4 v[84:87], v83, s[12:15], s18 offen sc1
  v_mfma_f32_16x16x32_bf16 v[160:163], v[48:51], a[228:231], v[160:163]
  ds_read_b64_tr_b16 a[140:141], v35 offset:16384
  v_mfma_f32_16x16x32_bf16 v[168:171], v[44:47], a[232:235], v[168:171]
  buffer_load_dwordx4 v27, s[4:7], s70 offen offset:3072  lds
  v_mfma_f32_16x16x32_bf16 v[168:171], v[48:51], a[236:239], v[168:171]
  ds_read_b64_tr_b16 a[142:143], v35 offset:18432
  v_mfma_f32_16x16x32_bf16 v[176:179], v[44:47], a[240:243], v[176:179]
  v_mfma_f32_16x16x32_bf16 v[176:179], v[48:51], a[244:247], v[176:179]
  ds_read_b64_tr_b16 a[148:149], v36 offset:16384
  v_mfma_f32_16x16x32_bf16 v[184:187], v[44:47], a[248:251], v[184:187]
  v_mfma_f32_16x16x32_bf16 v[184:187], v[48:51], a[252:255], v[184:187]
  s_waitcnt lgkmcnt(5)
  ds_read_b64_tr_b16 a[150:151], v36 offset:18432
  v_mfma_f32_16x16x32_bf16 v[132:135], v[52:55], a[192:195], v[132:135]
  s_add_u32 m0, s65, 0
  v_mfma_f32_16x16x32_bf16 v[132:135], v[56:59], a[196:199], v[132:135]
  ds_read_b128 v[44:47], v32 offset:53248
  v_mfma_f32_16x16x32_bf16 v[140:143], v[52:55], a[200:203], v[140:143]
  buffer_load_dwordx4 v28, s[8:11], s72 offen offset:0 nt lds
  v_mfma_f32_16x16x32_bf16 v[140:143], v[56:59], a[204:207], v[140:143]
  ds_read_b128 v[48:51], v33 offset:53248
  v_mfma_f32_16x16x32_bf16 v[148:151], v[52:55], a[208:211], v[148:151]
  v_mfma_f32_16x16x32_bf16 v[148:151], v[56:59], a[212:215], v[148:151]
  ds_read_b64_tr_b16 a[156:157], v37 offset:16384
  v_mfma_f32_16x16x32_bf16 v[156:159], v[52:55], a[216:219], v[156:159]
  v_mfma_f32_16x16x32_bf16 v[156:159], v[56:59], a[220:223], v[156:159]
  ds_read_b64_tr_b16 a[158:159], v37 offset:18432
  v_mfma_f32_16x16x32_bf16 v[164:167], v[52:55], a[224:227], v[164:167]
  v_mfma_f32_16x16x32_bf16 v[164:167], v[56:59], a[228:231], v[164:167]
  ds_read_b64_tr_b16 a[164:165], v38 offset:16384
  v_mfma_f32_16x16x32_bf16 v[172:175], v[52:55], a[232:235], v[172:175]
  buffer_load_dwordx4 v29, s[8:11], s72 offen offset:1024 nt lds
  v_mfma_f32_16x16x32_bf16 v[172:175], v[56:59], a[236:239], v[172:175]
  ds_read_b64_tr_b16 a[166:167], v38 offset:18432
  v_mfma_f32_16x16x32_bf16 v[180:183], v[52:55], a[240:243], v[180:183]
  v_mfma_f32_16x16x32_bf16 v[180:183], v[56:59], a[244:247], v[180:183]
  ds_read_b64_tr_b16 a[172:173], v39 offset:16384
  v_mfma_f32_16x16x32_bf16 v[188:191], v[52:55], a[248:251], v[188:191]
  ds_read_b64_tr_b16 a[174:175], v39 offset:18432
  v_mfma_f32_16x16x32_bf16 v[188:191], v[56:59], a[252:255], v[188:191]
  s_waitcnt lgkmcnt(6)
  ds_read_b64_tr_b16 a[180:181], v40 offset:16384
  v_mfma_f32_16x16x32_bf16 v[192:195], v[44:47], a[192:195], v[192:195]
  buffer_load_dword v15, v7, s[28:31], 0 offen
  v_mfma_f32_16x16x32_bf16 v[192:195], v[48:51], a[196:199], v[192:195]
  ds_read_b128 v[52:55], v32 offset:55296
  v_min_u32 v88, 768, v7
  v_mfma_f32_16x16x32_bf16 v[200:203], v[44:47], a[200:203], v[200:203]
  buffer_load_dwordx4 v30, s[8:11], s72 offen offset:2048 nt lds
  v_mfma_f32_16x16x32_bf16 v[200:203], v[48:51], a[204:207], v[200:203]
  ds_read_b128 v[56:59], v33 offset:55296
  v_mfma_f32_16x16x32_bf16 v[208:211], v[44:47], a[208:211], v[208:211]
  ds_read_b64_tr_b16 a[182:183], v40 offset:18432
  v_mfma_f32_16x16x32_bf16 v[208:211], v[48:51], a[212:215], v[208:211]
  ds_read_b64_tr_b16 a[188:189], v41 offset:16384
  v_mfma_f32_16x16x32_bf16 v[216:219], v[44:47], a[216:219], v[216:219]
  global_load_dword v15, v88, s[52:53]
  v_mfma_f32_16x16x32_bf16 v[216:219], v[48:51], a[220:223], v[216:219]
  ds_read_b64_tr_b16 a[190:191], v41 offset:18432
  v_mfma_f32_16x16x32_bf16 v[224:227], v[44:47], a[224:227], v[224:227]
  v_mfma_f32_16x16x32_bf16 v[224:227], v[48:51], a[228:231], v[224:227]
  v_mfma_f32_16x16x32_bf16 v[232:235], v[44:47], a[232:235], v[232:235]
  buffer_load_dwordx4 v31, s[8:11], s72 offen offset:3072 nt lds
  v_mfma_f32_16x16x32_bf16 v[232:235], v[48:51], a[236:239], v[232:235]
  v_mfma_f32_16x16x32_bf16 v[240:243], v[44:47], a[240:243], v[240:243]
  s_add_u32 s72, s72, 262144
  s_and_b32 s72, s72, 0x7fffff
  s_add_u32 m0, s1, 3072
  v_mfma_f32_16x16x32_bf16 v[240:243], v[48:51], a[244:247], v[240:243]
  buffer_load_dwordx4 v42, s[20:23], s36 offen nt lds
  v_mfma_f32_16x16x32_bf16 v[248:251], v[44:47], a[248:251], v[248:251]
  s_waitcnt vmcnt(24) lgkmcnt(0)
  v_mfma_f32_16x16x32_bf16 v[248:251], v[48:51], a[252:255], v[248:251]
  s_barrier
  v_mfma_f32_16x16x32_bf16 v[196:199], v[52:55], a[192:195], v[196:199]
  s_add_u32 m0, s65, 114688
  v_mfma_f32_16x16x32_bf16 v[196:199], v[56:59], a[196:199], v[196:199]
  ds_read_b128 v[44:47], v32 offset:0
  v_mfma_f32_16x16x32_bf16 v[204:207], v[52:55], a[200:203], v[204:207]
  buffer_load_dwordx4 v24, s[4:7], s71 offen offset:0  lds
  v_mfma_f32_16x16x32_bf16 v[204:207], v[56:59], a[204:207], v[204:207]
  ds_read_b128 v[48:51], v33 offset:0
  v_mfma_f32_16x16x32_bf16 v[212:215], v[52:55], a[208:211], v[212:215]
  v_mfma_f32_16x16x32_bf16 v[212:215], v[56:59], a[212:215], v[212:215]
  v_mfma_f32_16x16x32_bf16 v[220:223], v[52:55], a[216:219], v[220:223]
  v_mfma_f32_16x16x32_bf16 v[220:223], v[56:59], a[220:223], v[220:223]
  v_mfma_f32_16x16x32_bf16 v[228:231], v[52:55], a[224:227], v[228:231]
  v_mfma_f32_16x16x32_bf16 v[228:231], v[56:59], a[228:231], v[228:231]
  v_mfma_f32_16x16x32_bf16 v[236:239], v[52:55], a[232:235], v[236:239]
  buffer_load_dwordx4 v25, s[4:7], s71 offen offset:1024  lds
  v_mfma_f32_16x16x32_bf16 v[236:239], v[56:59], a[236:239], v[236:239]
  v_mfma_f32_16x16x32_bf16 v[244:247], v[52:55], a[240:243], v[244:247]
  v_mfma_f32_16x16x32_bf16 v[244:247], v[56:59], a[244:247], v[244:247]
  s_waitcnt lgkmcnt(0)
  v_mfma_f32_16x16x32_bf16 v[252:255], v[52:55], a[248:251], v[252:255]
  v_mfma_f32_16x16x32_bf16 v[252:255], v[56:59], a[252:255], v[252:255]
  .p2align 6
L_kf_kernel_aloop_12:
  v_mfma_f32_16x16x32_bf16 a[0:3], v[44:47], a[128:131], a[0:3]
  s_mov_b32 s20, s60
  v_mfma_f32_16x16x32_bf16 a[0:3], v[48:51], a[132:135], a[0:3]
  s_mov_b32 s21, s61
  ds_read_b128 v[52:55], v32 offset:2048
  v_mfma_f32_16x16x32_bf16 a[8:11], v[44:47], a[136:139], a[8:11]
  s_mov_b32 s22, s41
  buffer_load_dwordx4 v26, s[4:7], s71 offen offset:2048  lds
  v_mfma_f32_16x16x32_bf16 a[8:11], v[48:51], a[140:143], a[8:11]
  ds_read_b128 v[56:59], v33 offset:2048
  v_mfma_f32_16x16x32_bf16 a[16:19], v[44:47], a[144:147], a[16:19]
  s_mov_b32 s36, s63
  v_mfma_f32_16x16x32_bf16 a[16:19], v[48:51], a[148:151], a[16:19]
  s_lshl_b32 s37, s38, 3
  ds_read_b64_tr_b16 a[192:193], v34 offset:32768
  v_mfma_f32_16x16x32_bf16 a[24:27], v[44:47], a[152:155], a[24:27]
  s_xor_b32 s1, s1, 16384
  v_mad_u32_u24 v42, v60, s38, v61
  v_mfma_f32_16x16x32_bf16 a[24:27], v[48:51], a[156:159], a[24:27]
  ds_read_b64_tr_b16 a[194:195], v34 offset:34816
  v_mfma_f32_16x16x32_bf16 a[32:35], v[44:47], a[160:163], a[32:35]
  v_mfma_f32_16x16x32_bf16 a[32:35], v[48:51], a[164:167], a[32:35]
  ds_read_b64_tr_b16 a[200:201], v35 offset:32768
  v_mfma_f32_16x16x32_bf16 a[40:43], v[44:47], a[168:171], a[40:43]
  buffer_load_dwordx4 v27, s[4:7], s71 offen offset:3072  lds
  v_mfma_f32_16x16x32_bf16 a[40:43], v[48:51], a[172:175], a[40:43]
  ds_read_b64_tr_b16 a[202:203], v35 offset:34816
  v_mfma_f32_16x16x32_bf16 a[48:51], v[44:47], a[176:179], a[48:51]
  v_mfma_f32_16x16x32_bf16 a[48:51], v[48:51], a[180:183], a[48:51]
  ds_read_b64_tr_b16 a[208:209], v36 offset:32768
  v_mfma_f32_16x16x32_bf16 a[56:59], v[44:47], a[184:187], a[56:59]
  s_add_u32 s70, s70, 128
  s_and_b32 s70, s70, 0x7ff
  v_mfma_f32_16x16x32_bf16 a[56:59], v[48:51], a[188:191], a[56:59]
  s_waitcnt lgkmcnt(5)
  ds_read_b64_tr_b16 a[210:211], v36 offset:34816
  v_mfma_f32_16x16x32_bf16 a[4:7], v[52:55], a[128:131], a[4:7]
  s_add_u32 m0, s65, 16384
  v_mfma_f32_16x16x32_bf16 a[4:7], v[56:59], a[132:135], a[4:7]
  ds_read_b128 v[44:47], v32 offset:4096
  v_mfma_f32_16x16x32_bf16 a[12:15], v[52:55], a[136:139], a[12:15]
  buffer_load_dwordx4 v28, s[8:11], s72 offen offset:0 nt lds
  v_mfma_f32_16x16x32_bf16 a[12:15], v[56:59], a[140:143], a[12:15]
  ds_read_b128 v[48:51], v33 offset:4096
  v_mfma_f32_16x16x32_bf16 a[20:23], v[52:55], a[144:147], a[20:23]
  s_add_u32 s71, s71, 128
  s_and_b32 s71, s71, 0x2007ff
  v_mfma_f32_16x16x32_bf16 a[20:23], v[56:59], a[148:151], a[20:23]
  s_sub_u32 s73, s73, 1
  ds_read_b64_tr_b16 a[216:217], v37 offset:32768
  v_mfma_f32_16x16x32_bf16 a[28:31], v[52:55], a[152:155], a[28:31]
  v_mfma_f32_16x16x32_bf16 a[28:31], v[56:59], a[156:159], a[28:31]
  ds_read_b64_tr_b16 a[218:219], v37 offset:34816
  v_mfma_f32_16x16x32_bf16 a[36:39], v[52:55], a[160:163], a[36:39]
  v_mfma_f32_16x16x32_bf16 a[36:39], v[56:59], a[164:167], a[36:39]
  ds_read_b64_tr_b16 a[224:225], v38 offset:32768
  v_mfma_f32_16x16x32_bf16 a[44:47], v[52:55], a[168:171], a[44:47]
  buffer_load_dwordx4 v29, s[8:11], s72 offen offset:1024 nt lds
  v_mfma_f32_16x16x32_bf16 a[44:47], v[56:59], a[172:175], a[44:47]
  ds_read_b64_tr_b16 a[226:227], v38 offset:34816
  v_mfma_f32_16x16x32_bf16 a[52:55], v[52:55], a[176:179], a[52:55]
  v_mfma_f32_16x16x32_bf16 a[52:55], v[56:59], a[180:183], a[52:55]
  ds_read_b64_tr_b16 a[232:233], v39 offset:32768
  v_mfma_f32_16x16x32_bf16 a[60:63], v[52:55], a[184:187], a[60:63]
  ds_read_b64_tr_b16 a[234:235], v39 offset:34816
  v_mfma_f32_16x16x32_bf16 a[60:63], v[56:59], a[188:191], a[60:63]
  s_waitcnt lgkmcnt(6)
  ds_read_b64_tr_b16 a[240:241], v40 offset:32768
  v_mfma_f32_16x16x32_bf16 a[64:67], v[44:47], a[128:131], a[64:67]
  v_mfma_f32_16x16x32_bf16 a[64:67], v[48:51], a[132:135], a[64:67]
  ds_read_b128 v[52:55], v32 offset:6144
  v_mfma_f32_16x16x32_bf16 a[72:75], v[44:47], a[136:139], a[72:75]
  buffer_load_dwordx4 v30, s[8:11], s72 offen offset:2048 nt lds
  v_mfma_f32_16x16x32_bf16 a[72:75], v[48:51], a[140:143], a[72:75]
  ds_read_b128 v[56:59], v33 offset:6144
  v_mfma_f32_16x16x32_bf16 a[80:83], v[44:47], a[144:147], a[80:83]
  ds_read_b64_tr_b16 a[242:243], v40 offset:34816
  v_mfma_f32_16x16x32_bf16 a[80:83], v[48:51], a[148:151], a[80:83]
  ds_read_b64_tr_b16 a[248:249], v41 offset:32768
  v_mfma_f32_16x16x32_bf16 a[88:91], v[44:47], a[152:155], a[88:91]
  v_mfma_f32_16x16x32_bf16 a[88:91], v[48:51], a[156:159], a[88:91]
  ds_read_b64_tr_b16 a[250:251], v41 offset:34816
  v_mfma_f32_16x16x32_bf16 a[96:99], v[44:47], a[160:163], a[96:99]
  v_mfma_f32_16x16x32_bf16 a[96:99], v[48:51], a[164:167], a[96:99]
  v_mfma_f32_16x16x32_bf16 a[104:107], v[44:47], a[168:171], a[104:107]
  buffer_load_dwordx4 v31, s[8:11], s72 offen offset:3072 nt lds
  v_mfma_f32_16x16x32_bf16 a[104:107], v[48:51], a[172:175], a[104:107]
  v_mfma_f32_16x16x32_bf16 a[112:115], v[44:47], a[176:179], a[112:115]
  s_add_u32 s72, s72, 262144
  s_add_u32 m0, s1, 0
  s_and_b32 s72, s72, 0x7fffff
  v_mfma_f32_16x16x32_bf16 a[112:115], v[48:51], a[180:183], a[112:115]
  buffer_load_dwordx4 v42, s[20:23], s36 offen nt lds
  v_mfma_f32_16x16x32_bf16 a[120:123], v[44:47], a[184:187], a[120:123]
  s_waitcnt vmcnt(23) lgkmcnt(0)
  v_mfma_f32_16x16x32_bf16 a[120:123], v[48:51], a[188:191], a[120:123]
  s_barrier
  v_mfma_f32_16x16x32_bf16 a[68:71], v[52:55], a[128:131], a[68:71]
  s_add_u32 m0, s65, 65536
  v_mfma_f32_16x16x32_bf16 a[68:71], v[56:59], a[132:135], a[68:71]
  ds_read_b128 v[44:47], v32 offset:16384
  v_mfma_f32_16x16x32_bf16 a[76:79], v[52:55], a[136:139], a[76:79]
  buffer_load_dwordx4 v24, s[4:7], s70 offen offset:0  lds
  v_mfma_f32_16x16x32_bf16 a[76:79], v[56:59], a[140:143], a[76:79]
  ds_read_b128 v[48:51], v33 offset:16384
  v_mfma_f32_16x16x32_bf16 a[84:87], v[52:55], a[144:147], a[84:87]
  s_add_u32 s36, s36, s37
  v_mfma_f32_16x16x32_bf16 a[84:87], v[56:59], a[148:151], a[84:87]
  v_mfma_f32_16x16x32_bf16 a[92:95], v[52:55], a[152:155], a[92:95]
  v_mfma_f32_16x16x32_bf16 a[92:95], v[56:59], a[156:159], a[92:95]
  v_mfma_f32_16x16x32_bf16 a[100:103], v[52:55], a[160:163], a[100:103]
  v_mfma_f32_16x16x32_bf16 a[100:103], v[56:59], a[164:167], a[100:103]
  v_mfma_f32_16x16x32_bf16 a[108:111], v[52:55], a[168:171], a[108:111]
  buffer_load_dwordx4 v25, s[4:7], s70 offen offset:1024  lds
  v_mfma_f32_16x16x32_bf16 a[108:111], v[56:59], a[172:175], a[108:111]
  v_mfma_f32_16x16x32_bf16 a[116:119], v[52:55], a[176:179], a[116:119]
  s_mov_b32 s60, s39
  v_mfma_f32_16x16x32_bf16 a[116:119], v[56:59], a[180:183], a[116:119]
  s_mov_b32 s61, s40
  v_mfma_f32_16x16x32_bf16 a[124:127], v[52:55], a[184:187], a[124:127]
  s_mov_b32 s41, s42
  v_mfma_f32_16x16x32_bf16 a[124:127], v[56:59], a[188:191], a[124:127]
  s_waitcnt lgkmcnt(0)
  v_mfma_f32_16x16x32_bf16 v[128:131], v[44:47], a[128:131], v[128:131]
  s_mov_b32 s63, s43
  v_mfma_f32_16x16x32_bf16 v[128:131], v[48:51], a[132:135], v[128:131]
  s_mov_b32 s43, 2147418112
  ds_read_b128 v[52:55], v32 offset:18432
  v_mfma_f32_16x16x32_bf16 v[136:139], v[44:47], a[136:139], v[136:139]
  s_mov_b32 s38, s0
  buffer_load_dwordx4 v26, s[4:7], s70 offen offset:2048  lds
  v_mfma_f32_16x16x32_bf16 v[136:139], v[48:51], a[140:143], v[136:139]
  ds_read_b128 v[56:59], v33 offset:18432
  v_mfma_f32_16x16x32_bf16 v[144:147], v[44:47], a[144:147], v[144:147]
  v_mfma_f32_16x16x32_bf16 v[144:147], v[48:51], a[148:151], v[144:147]
  ds_read_b64_tr_b16 a[196:197], v34 offset:49152
  v_mfma_f32_16x16x32_bf16 v[152:155], v[44:47], a[152:155], v[152:155]
  v_mfma_f32_16x16x32_bf16 v[152:155], v[48:51], a[156:159], v[152:155]
  ds_read_b64_tr_b16 a[198:199], v34 offset:51200
  v_mfma_f32_16x16x32_bf16 v[160:163], v[44:47], a[160:163], v[160:163]
  v_mfma_f32_16x16x32_bf16 v[160:163], v[48:51], a[164:167], v[160:163]
  ds_read_b64_tr_b16 a[204:205], v35 offset:49152
  v_mfma_f32_16x16x32_bf16 v[168:171], v[44:47], a[168:171], v[168:171]
  buffer_load_dwordx4 v27, s[4:7], s70 offen offset:3072  lds
  v_mfma_f32_16x16x32_bf16 v[168:171], v[48:51], a[172:175], v[168:171]
  ds_read_b64_tr_b16 a[206:207], v35 offset:51200
  v_mfma_f32_16x16x32_bf16 v[176:179], v[44:47], a[176:179], v[176:179]
  v_mfma_f32_16x16x32_bf16 v[176:179], v[48:51], a[180:183], v[176:179]
  ds_read_b64_tr_b16 a[212:213], v36 offset:49152
  v_mfma_f32_16x16x32_bf16 v[184:187], v[44:47], a[184:187], v[184:187]
  v_mfma_f32_16x16x32_bf16 v[184:187], v[48:51], a[188:191], v[184:187]
  s_waitcnt lgkmcnt(5)
  ds_read_b64_tr_b16 a[214:215], v36 offset:51200
  v_mfma_f32_16x16x32_bf16 v[132:135], v[52:55], a[128:131], v[132:135]
  s_add_u32 m0, s65, 32768
  v_mfma_f32_16x16x32_bf16 v[132:135], v[56:59], a[132:135], v[132:135]
  ds_read_b128 v[44:47], v32 offset:20480
  v_mfma_f32_16x16x32_bf16 v[140:143], v[52:55], a[136:139], v[140:143]
  buffer_load_dwordx4 v28, s[8:11], s72 offen offset:0 nt lds
  v_mfma_f32_16x16x32_bf16 v[140:143], v[56:59], a[140:143], v[140:143]
  ds_read_b128 v[48:51], v33 offset:20480
  v_mfma_f32_16x16x32_bf16 v[148:151], v[52:55], a[144:147], v[148:151]
  v_mfma_f32_16x16x32_bf16 v[148:151], v[56:59], a[148:151], v[148:151]
  ds_read_b64_tr_b16 a[220:221], v37 offset:49152
  v_mfma_f32_16x16x32_bf16 v[156:159], v[52:55], a[152:155], v[156:159]
  v_mfma_f32_16x16x32_bf16 v[156:159], v[56:59], a[156:159], v[156:159]
  ds_read_b64_tr_b16 a[222:223], v37 offset:51200
  v_mfma_f32_16x16x32_bf16 v[164:167], v[52:55], a[160:163], v[164:167]
  v_mfma_f32_16x16x32_bf16 v[164:167], v[56:59], a[164:167], v[164:167]
  ds_read_b64_tr_b16 a[228:229], v38 offset:49152
  v_mfma_f32_16x16x32_bf16 v[172:175], v[52:55], a[168:171], v[172:175]
  buffer_load_dwordx4 v29, s[8:11], s72 offen offset:1024 nt lds
  v_mfma_f32_16x16x32_bf16 v[172:175], v[56:59], a[172:175], v[172:175]
  ds_read_b64_tr_b16 a[230:231], v38 offset:51200
  v_mfma_f32_16x16x32_bf16 v[180:183], v[52:55], a[176:179], v[180:183]
  v_mfma_f32_16x16x32_bf16 v[180:183], v[56:59], a[180:183], v[180:183]
  ds_read_b64_tr_b16 a[236:237], v39 offset:49152
  v_mfma_f32_16x16x32_bf16 v[188:191], v[52:55], a[184:187], v[188:191]
  ds_read_b64_tr_b16 a[238:239], v39 offset:51200
  v_mfma_f32_16x16x32_bf16 v[188:191], v[56:59], a[188:191], v[188:191]
  s_waitcnt lgkmcnt(6)
  ds_read_b64_tr_b16 a[244:245], v40 offset:49152
  v_mfma_f32_16x16x32_bf16 v[192:195], v[44:47], a[128:131], v[192:195]
  v_mfma_f32_16x16x32_bf16 v[192:195], v[48:51], a[132:135], v[192:195]
  ds_read_b128 v[52:55], v32 offset:22528
  v_mfma_f32_16x16x32_bf16 v[200:203], v[44:47], a[136:139], v[200:203]
  buffer_load_dwordx4 v30, s[8:11], s72 offen offset:2048 nt lds
  v_mfma_f32_16x16x32_bf16 v[200:203], v[48:51], a[140:143], v[200:203]
  ds_read_b128 v[56:59], v33 offset:22528
  v_mfma_f32_16x16x32_bf16 v[208:211], v[44:47], a[144:147], v[208:211]
  ds_read_b64_tr_b16 a[246:247], v40 offset:51200
  v_mfma_f32_16x16x32_bf16 v[208:211], v[48:51], a[148:151], v[208:211]
  ds_read_b64_tr_b16 a[252:253], v41 offset:49152
  v_mfma_f32_16x16x32_bf16 v[216:219], v[44:47], a[152:155], v[216:219]
  v_mfma_f32_16x16x32_bf16 v[216:219], v[48:51], a[156:159], v[216:219]
  ds_read_b64_tr_b16 a[254:255], v41 offset:51200
  v_mfma_f32_16x16x32_bf16 v[224:227], v[44:47], a[160:163], v[224:227]
  v_mfma_f32_16x16x32_bf16 v[224:227], v[48:51], a[164:167], v[224:227]
  v_mfma_f32_16x16x32_bf16 v[232:235], v[44:47], a[168:171], v[232:235]
  buffer_load_dwordx4 v31, s[8:11], s72 offen offset:3072 nt lds
  v_mfma_f32_16x16x32_bf16 v[232:235], v[48:51], a[172:175], v[232:235]
  v_mfma_f32_16x16x32_bf16 v[240:243], v[44:47], a[176:179], v[240:243]
  s_add_u32 s72, s72, 262144
  s_and_b32 s72, s72, 0x7fffff
  s_add_u32 m0, s1, 1024
  v_mfma_f32_16x16x32_bf16 v[240:243], v[48:51], a[180:183], v[240:243]
  buffer_load_dwordx4 v42, s[20:23], s36 offen nt lds
  v_mfma_f32_16x16x32_bf16 v[248:251], v[44:47], a[184:187], v[248:251]
  s_waitcnt vmcnt(19) lgkmcnt(0)
  v_mfma_f32_16x16x32_bf16 v[248:251], v[48:51], a[188:191], v[248:251]
  s_barrier
  v_mfma_f32_16x16x32_bf16 v[196:199], v[52:55], a[128:131], v[196:199]
  s_add_u32 m0, s65, 81920
  v_mfma_f32_16x16x32_bf16 v[196:199], v[56:59], a[132:135], v[196:199]
  ds_read_b128 v[44:47], v32 offset:32768
  v_mfma_f32_16x16x32_bf16 v[204:207], v[52:55], a[136:139], v[204:207]
  buffer_load_dwordx4 v24, s[4:7], s71 offen offset:0  lds
  v_mfma_f32_16x16x32_bf16 v[204:207], v[56:59], a[140:143], v[204:207]
  ds_read_b128 v[48:51], v33 offset:32768
  v_mfma_f32_16x16x32_bf16 v[212:215], v[52:55], a[144:147], v[212:215]
  s_add_u32 s36, s36, s37
  v_mfma_f32_16x16x32_bf16 v[212:215], v[56:59], a[148:151], v[212:215]
  v_mfma_f32_16x16x32_bf16 v[220:223], v[52:55], a[152:155], v[220:223]
  v_mfma_f32_16x16x32_bf16 v[220:223], v[56:59], a[156:159], v[220:223]
  v_mfma_f32_16x16x32_bf16 v[228:231], v[52:55], a[160:163], v[228:231]
  v_mfma_f32_16x16x32_bf16 v[228:231], v[56:59], a[164:167], v[228:231]
  v_mfma_f32_16x16x32_bf16 v[236:239], v[52:55], a[168:171], v[236:239]
  buffer_load_dwordx4 v25, s[4:7], s71 offen offset:1024  lds
  v_mfma_f32_16x16x32_bf16 v[236:239], v[56:59], a[172:175], v[236:239]
  v_mfma_f32_16x16x32_bf16 v[244:247], v[52:55], a[176:179], v[244:247]
  v_mfma_f32_16x16x32_bf16 v[244:247], v[56:59], a[180:183], v[244:247]
  s_mov_b32 s44, s45
  v_mfma_f32_16x16x32_bf16 v[252:255], v[52:55], a[184:187], v[252:255]
  s_mov_b32 s45, s46
  v_mfma_f32_16x16x32_bf16 v[252:255], v[56:59], a[188:191], v[252:255]
  s_waitcnt lgkmcnt(0)
  v_mfma_f32_16x16x32_bf16 a[0:3], v[44:47], a[192:195], a[0:3]
  s_mov_b32 s46, s47
  v_mfma_f32_16x16x32_bf16 a[0:3], v[48:51], a[196:199], a[0:3]
  s_mov_b32 s47, 2147418112
  ds_read_b128 v[52:55], v32 offset:34816
  v_mfma_f32_16x16x32_bf16 a[8:11], v[44:47], a[200:203], a[8:11]
  s_mov_b32 s48, s49
  buffer_load_dwordx4 v26, s[4:7], s71 offen offset:2048  lds
  v_mfma_f32_16x16x32_bf16 a[8:11], v[48:51], a[204:207], a[8:11]
  ds_read_b128 v[56:59], v33 offset:34816
  v_mfma_f32_16x16x32_bf16 a[16:19], v[44:47], a[208:211], a[16:19]
  s_mov_b32 s49, s50
  v_mfma_f32_16x16x32_bf16 a[16:19], v[48:51], a[212:215], a[16:19]
  s_mov_b32 s50, s51
  ds_read_b64_tr_b16 a[128:129], v34 offset:0
  v_mfma_f32_16x16x32_bf16 a[24:27], v[44:47], a[216:219], a[24:27]
  v_mfma_f32_16x16x32_bf16 a[24:27], v[48:51], a[220:223], a[24:27]
  ds_read_b64_tr_b16 a[130:131], v34 offset:2048
  v_mfma_f32_16x16x32_bf16 a[32:35], v[44:47], a[224:227], a[32:35]
  v_mfma_f32_16x16x32_bf16 a[32:35], v[48:51], a[228:231], a[32:35]
  ds_read_b64_tr_b16 a[136:137], v35 offset:0
  v_mfma_f32_16x16x32_bf16 a[40:43], v[44:47], a[232:235], a[40:43]
  buffer_load_dwordx4 v27, s[4:7], s71 offen offset:3072  lds
  v_mfma_f32_16x16x32_bf16 a[40:43], v[48:51], a[236:239], a[40:43]
  ds_read_b64_tr_b16 a[138:139], v35 offset:2048
  v_mfma_f32_16x16x32_bf16 a[48:51], v[44:47], a[240:243], a[48:51]
  v_mfma_f32_16x16x32_bf16 a[48:51], v[48:51], a[244:247], a[48:51]
  ds_read_b64_tr_b16 a[144:145], v36 offset:0
  v_mfma_f32_16x16x32_bf16 a[56:59], v[44:47], a[248:251], a[56:59]
  s_add_u32 s70, s70, 128
  s_and_b32 s70, s70, 0x7ff
  v_mfma_f32_16x16x32_bf16 a[56:59], v[48:51], a[252:255], a[56:59]
  s_waitcnt lgkmcnt(5)
  ds_read_b64_tr_b16 a[146:147], v36 offset:2048
  v_mfma_f32_16x16x32_bf16 a[4:7], v[52:55], a[192:195], a[4:7]
  s_add_u32 m0, s65, 49152
  v_mfma_f32_16x16x32_bf16 a[4:7], v[56:59], a[196:199], a[4:7]
  ds_read_b128 v[44:47], v32 offset:36864
  v_mfma_f32_16x16x32_bf16 a[12:15], v[52:55], a[200:203], a[12:15]
  buffer_load_dwordx4 v28, s[8:11], s72 offen offset:0 nt lds
  v_mfma_f32_16x16x32_bf16 a[12:15], v[56:59], a[204:207], a[12:15]
  ds_read_b128 v[48:51], v33 offset:36864
  v_mfma_f32_16x16x32_bf16 a[20:23], v[52:55], a[208:211], a[20:23]
  s_add_u32 s71, s71, 128
  s_and_b32 s71, s71, 0x2007ff
  v_mfma_f32_16x16x32_bf16 a[20:23], v[56:59], a[212:215], a[20:23]
  ds_read_b64_tr_b16 a[152:153], v37 offset:0
  v_mfma_f32_16x16x32_bf16 a[28:31], v[52:55], a[216:219], a[28:31]
  v_mfma_f32_16x16x32_bf16 a[28:31], v[56:59], a[220:223], a[28:31]
  ds_read_b64_tr_b16 a[154:155], v37 offset:2048
  v_mfma_f32_16x16x32_bf16 a[36:39], v[52:55], a[224:227], a[36:39]
  v_mfma_f32_16x16x32_bf16 a[36:39], v[56:59], a[228:231], a[36:39]
  ds_read_b64_tr_b16 a[160:161], v38 offset:0
  v_mfma_f32_16x16x32_bf16 a[44:47], v[52:55], a[232:235], a[44:47]
  buffer_load_dwordx4 v29, s[8:11], s72 offen offset:1024 nt lds
  v_mfma_f32_16x16x32_bf16 a[44:47], v[56:59], a[236:239], a[44:47]
  ds_read_b64_tr_b16 a[162:163], v38 offset:2048
  v_mfma_f32_16x16x32_bf16 a[52:55], v[52:55], a[240:243], a[52:55]
  v_mfma_f32_16x16x32_bf16 a[52:55], v[56:59], a[244:247], a[52:55]
  ds_read_b64_tr_b16 a[168:169], v39 offset:0
  v_mfma_f32_16x16x32_bf16 a[60:63], v[52:55], a[248:251], a[60:63]
  ds_read_b64_tr_b16 a[170:171], v39 offset:2048
  v_mfma_f32_16x16x32_bf16 a[60:63], v[56:59], a[252:255], a[60:63]
  s_waitcnt lgkmcnt(6)
  ds_read_b64_tr_b16 a[176:177], v40 offset:0
  v_mfma_f32_16x16x32_bf16 a[64:67], v[44:47], a[192:195], a[64:67]
  v_mfma_f32_16x16x32_bf16 a[64:67], v[48:51], a[196:199], a[64:67]
  ds_read_b128 v[52:55], v32 offset:38912
  v_mfma_f32_16x16x32_bf16 a[72:75], v[44:47], a[200:203], a[72:75]
  buffer_load_dwordx4 v30, s[8:11], s72 offen offset:2048 nt lds
  v_mfma_f32_16x16x32_bf16 a[72:75], v[48:51], a[204:207], a[72:75]
  ds_read_b128 v[56:59], v33 offset:38912
  v_mfma_f32_16x16x32_bf16 a[80:83], v[44:47], a[208:211], a[80:83]
  ds_read_b64_tr_b16 a[178:179], v40 offset:2048
  v_xor_b32 v17, 32, v43
  v_mfma_f32_16x16x32_bf16 a[80:83], v[48:51], a[212:215], a[80:83]
  ds_read_b64_tr_b16 a[184:185], v41 offset:0
  v_xor_b32 v18, 64, v43
  v_mfma_f32_16x16x32_bf16 a[88:91], v[44:47], a[216:219], a[88:91]
  v_xor_b32 v19, 96, v43
  v_mfma_f32_16x16x32_bf16 a[88:91], v[48:51], a[220:223], a[88:91]
  ds_read_b64_tr_b16 a[186:187], v41 offset:2048
  v_mfma_f32_16x16x32_bf16 a[96:99], v[44:47], a[224:227], a[96:99]
  v_mfma_f32_16x16x32_bf16 a[96:99], v[48:51], a[228:231], a[96:99]
  v_mfma_f32_16x16x32_bf16 a[104:107], v[44:47], a[232:235], a[104:107]
  buffer_load_dwordx4 v31, s[8:11], s72 offen offset:3072 nt lds
  v_mfma_f32_16x16x32_bf16 a[104:107], v[48:51], a[236:239], a[104:107]
  v_mfma_f32_16x16x32_bf16 a[112:115], v[44:47], a[240:243], a[112:115]
  s_add_u32 s72, s72, 262144
  s_and_b32 s72, s72, 0x7fffff
  s_add_u32 m0, s1, 2048
  v_mfma_f32_16x16x32_bf16 a[112:115], v[48:51], a[244:247], a[112:115]
  buffer_load_dwordx4 v42, s[20:23], s36 offen nt lds
  v_mfma_f32_16x16x32_bf16 a[120:123], v[44:47], a[248:251], a[120:123]
  s_waitcnt vmcnt(19) lgkmcnt(0)
  v_mfma_f32_16x16x32_bf16 a[120:123], v[48:51], a[252:255], a[120:123]
  s_barrier
  v_mfma_f32_16x16x32_bf16 a[68:71], v[52:55], a[192:195], a[68:71]
  s_add_u32 m0, s65, 98304
  v_mfma_f32_16x16x32_bf16 a[68:71], v[56:59], a[196:199], a[68:71]
  ds_read_b128 v[44:47], v32 offset:49152
  v_mfma_f32_16x16x32_bf16 a[76:79], v[52:55], a[200:203], a[76:79]
  buffer_load_dwordx4 v24, s[4:7], s70 offen offset:0  lds
  v_mfma_f32_16x16x32_bf16 a[76:79], v[56:59], a[204:207], a[76:79]
  ds_read_b128 v[48:51], v33 offset:49152
  v_mfma_f32_16x16x32_bf16 a[84:87], v[52:55], a[208:211], a[84:87]
  s_add_u32 s36, s36, s37
  ds_read_b64_tr_b16 v[64:65], v43 offset:0
  v_mfma_f32_16x16x32_bf16 a[84:87], v[56:59], a[212:215], a[84:87]
  ds_read_b64_tr_b16 v[66:67], v43 offset:2048
  v_mfma_f32_16x16x32_bf16 a[92:95], v[52:55], a[216:219], a[92:95]
  v_mfma_f32_16x16x32_bf16 a[92:95], v[56:59], a[220:223], a[92:95]
  ds_read_b64_tr_b16 v[68:69], v17 offset:0
  v_mfma_f32_16x16x32_bf16 a[100:103], v[52:55], a[224:227], a[100:103]
  ds_read_b64_tr_b16 v[70:71], v17 offset:2048
  v_mfma_f32_16x16x32_bf16 a[100:103], v[56:59], a[228:231], a[100:103]
  ds_read_b64_tr_b16 v[72:73], v18 offset:0
  v_mfma_f32_16x16x32_bf16 a[108:111], v[52:55], a[232:235], a[108:111]
  buffer_load_dwordx4 v25, s[4:7], s70 offen offset:1024  lds
  v_mfma_f32_16x16x32_bf16 a[108:111], v[56:59], a[236:239], a[108:111]
  ds_read_b64_tr_b16 v[74:75], v18 offset:2048
  v_mfma_f32_16x16x32_bf16 a[116:119], v[52:55], a[240:243], a[116:119]
  ds_read_b64_tr_b16 v[76:77], v19 offset:0
  v_mfma_f32_16x16x32_bf16 a[116:119], v[56:59], a[244:247], a[116:119]
  ds_read_b64_tr_b16 v[78:79], v19 offset:2048
  v_mfma_f32_16x16x32_bf16 a[124:127], v[52:55], a[248:251], a[124:127]
  v_xor_b32 v43, s54, v43
  v_mfma_f32_16x16x32_bf16 a[124:127], v[56:59], a[252:255], a[124:127]
  s_waitcnt lgkmcnt(8)
  v_mfma_f32_16x16x32_bf16 v[128:131], v[44:47], a[192:195], v[128:131]
  s_mov_b32 s54, s55
  v_mfma_f32_16x16x32_bf16 v[128:131], v[48:51], a[196:199], v[128:131]
  ds_read_b128 v[52:55], v32 offset:51200
  v_mfma_f32_16x16x32_bf16 v[136:139], v[44:47], a[200:203], v[136:139]
  buffer_load_dwordx4 v26, s[4:7], s70 offen offset:2048  lds
  v_mfma_f32_16x16x32_bf16 v[136:139], v[48:51], a[204:207], v[136:139]
  ds_read_b128 v[56:59], v33 offset:51200
  v_mfma_f32_16x16x32_bf16 v[144:147], v[44:47], a[208:211], v[144:147]
  v_mfma_f32_16x16x32_bf16 v[144:147], v[48:51], a[212:215], v[144:147]
  ds_read_b64_tr_b16 a[132:133], v34 offset:16384
  v_mfma_f32_16x16x32_bf16 v[152:155], v[44:47], a[216:219], v[152:155]
  s_waitcnt lgkmcnt(9)
  buffer_store_dwordx4 v[64:67], v1, s[12:15], s44 offen sc1
  v_mfma_f32_16x16x32_bf16 v[152:155], v[48:51], a[220:223], v[152:155]
  ds_read_b64_tr_b16 a[134:135], v34 offset:18432
  s_add_u32 s44, s44, s48
  v_mfma_f32_16x16x32_bf16 v[160:163], v[44:47], a[224:227], v[160:163]
  v_mfma_f32_16x16x32_bf16 v[160:163], v[48:51], a[228:231], v[160:163]
  ds_read_b64_tr_b16 a[140:141], v35 offset:16384
  v_mfma_f32_16x16x32_bf16 v[168:171], v[44:47], a[232:235], v[168:171]
  buffer_load_dwordx4 v27, s[4:7], s70 offen offset:3072  lds
  v_mfma_f32_16x16x32_bf16 v[168:171], v[48:51], a[236:239], v[168:171]
  ds_read_b64_tr_b16 a[142:143], v35 offset:18432
  v_mfma_f32_16x16x32_bf16 v[176:179], v[44:47], a[240:243], v[176:179]
  v_mfma_f32_16x16x32_bf16 v[176:179], v[48:51], a[244:247], v[176:179]
  ds_read_b64_tr_b16 a[148:149], v36 offset:16384
  v_mfma_f32_16x16x32_bf16 v[184:187], v[44:47], a[248:251], v[184:187]
  s_waitcnt lgkmcnt(11)
  buffer_store_dwordx4 v[68:71], v1, s[12:15], s44 offen sc1
  v_mfma_f32_16x16x32_bf16 v[184:187], v[48:51], a[252:255], v[184:187]
  s_waitcnt lgkmcnt(5)
  ds_read_b64_tr_b16 a[150:151], v36 offset:18432
  s_add_u32 s44, s44, s48
  v_mfma_f32_16x16x32_bf16 v[132:135], v[52:55], a[192:195], v[132:135]
  s_add_u32 m0, s65, 0
  v_mfma_f32_16x16x32_bf16 v[132:135], v[56:59], a[196:199], v[132:135]
  ds_read_b128 v[44:47], v32 offset:53248
  v_mfma_f32_16x16x32_bf16 v[140:143], v[52:55], a[200:203], v[140:143]
  buffer_load_dwordx4 v28, s[8:11], s72 offen offset:0 nt lds
  v_mfma_f32_16x16x32_bf16 v[140:143], v[56:59], a[204:207], v[140:143]
  ds_read_b128 v[48:51], v33 offset:53248
  v_mfma_f32_16x16x32_bf16 v[148:151], v[52:55], a[208:211], v[148:151]
  v_mfma_f32_16x16x32_bf16 v[148:151], v[56:59], a[212:215], v[148:151]
  ds_read_b64_tr_b16 a[156:157], v37 offset:16384
  v_mfma_f32_16x16x32_bf16 v[156:159], v[52:55], a[216:219], v[156:159]
  buffer_store_dwordx4 v[72:75], v1, s[12:15], s44 offen sc1
  v_mfma_f32_16x16x32_bf16 v[156:159], v[56:59], a[220:223], v[156:159]
  ds_read_b64_tr_b16 a[158:159], v37 offset:18432
  s_add_u32 s44, s44, s48
  v_mfma_f32_16x16x32_bf16 v[164:167], v[52:55], a[224:227], v[164:167]
  v_mfma_f32_16x16x32_bf16 v[164:167], v[56:59], a[228:231], v[164:167]
  ds_read_b64_tr_b16 a[164:165], v38 offset:16384
  v_mfma_f32_16x16x32_bf16 v[172:175], v[52:55], a[232:235], v[172:175]
  buffer_load_dwordx4 v29, s[8:11], s72 offen offset:1024 nt lds
  v_mfma_f32_16x16x32_bf16 v[172:175], v[56:59], a[236:239], v[172:175]
  ds_read_b64_tr_b16 a[166:167], v38 offset:18432
  v_mfma_f32_16x16x32_bf16 v[180:183], v[52:55], a[240:243], v[180:183]
  v_mfma_f32_16x16x32_bf16 v[180:183], v[56:59], a[244:247], v[180:183]
  ds_read_b64_tr_b16 a[172:173], v39 offset:16384
  v_mfma_f32_16x16x32_bf16 v[188:191], v[52:55], a[248:251], v[188:191]
  ds_read_b64_tr_b16 a[174:175], v39 offset:18432
  buffer_store_dwordx4 v[76:79], v1, s[12:15], s44 offen sc1
  v_mfma_f32_16x16x32_bf16 v[188:191], v[56:59], a[252:255], v[188:191]
  s_waitcnt lgkmcnt(6)
  ds_read_b64_tr_b16 a[180:181], v40 offset:16384
  v_mfma_f32_16x16x32_bf16 v[192:195], v[44:47], a[192:195], v[192:195]
  v_mfma_f32_16x16x32_bf16 v[192:195], v[48:51], a[196:199], v[192:195]
  ds_read_b128 v[52:55], v32 offset:55296
  v_mfma_f32_16x16x32_bf16 v[200:203], v[44:47], a[200:203], v[200:203]
  buffer_load_dwordx4 v30, s[8:11], s72 offen offset:2048 nt lds
  v_mfma_f32_16x16x32_bf16 v[200:203], v[48:51], a[204:207], v[200:203]
  ds_read_b128 v[56:59], v33 offset:55296
  v_mfma_f32_16x16x32_bf16 v[208:211], v[44:47], a[208:211], v[208:211]
  ds_read_b64_tr_b16 a[182:183], v40 offset:18432
  v_mfma_f32_16x16x32_bf16 v[208:211], v[48:51], a[212:215], v[208:211]
  ds_read_b64_tr_b16 a[188:189], v41 offset:16384
  v_mfma_f32_16x16x32_bf16 v[216:219], v[44:47], a[216:219], v[216:219]
  v_mfma_f32_16x16x32_bf16 v[216:219], v[48:51], a[220:223], v[216:219]
  ds_read_b64_tr_b16 a[190:191], v41 offset:18432
  v_mfma_f32_16x16x32_bf16 v[224:227], v[44:47], a[224:227], v[224:227]
  v_mfma_f32_16x16x32_bf16 v[224:227], v[48:51], a[228:231], v[224:227]
  v_mfma_f32_16x16x32_bf16 v[232:235], v[44:47], a[232:235], v[232:235]
  buffer_load_dwordx4 v31, s[8:11], s72 offen offset:3072 nt lds
  v_mfma_f32_16x16x32_bf16 v[232:235], v[48:51], a[236:239], v[232:235]
  v_mfma_f32_16x16x32_bf16 v[240:243], v[44:47], a[240:243], v[240:243]
  s_add_u32 s72, s72, 262144
  s_and_b32 s72, s72, 0x7fffff
  s_add_u32 m0, s1, 3072
  v_mfma_f32_16x16x32_bf16 v[240:243], v[48:51], a[244:247], v[240:243]
  buffer_load_dwordx4 v42, s[20:23], s36 offen nt lds
  v_mfma_f32_16x16x32_bf16 v[248:251], v[44:47], a[248:251], v[248:251]
  s_waitcnt vmcnt(23) lgkmcnt(0)
  v_mfma_f32_16x16x32_bf16 v[248:251], v[48:51], a[252:255], v[248:251]
  s_barrier
  v_mfma_f32_16x16x32_bf16 v[196:199], v[52:55], a[192:195], v[196:199]
  s_add_u32 m0, s65, 114688
  v_mfma_f32_16x16x32_bf16 v[196:199], v[56:59], a[196:199], v[196:199]
  ds_read_b128 v[44:47], v32 offset:0
  v_mfma_f32_16x16x32_bf16 v[204:207], v[52:55], a[200:203], v[204:207]
  buffer_load_dwordx4 v24, s[4:7], s71 offen offset:0  lds
  v_mfma_f32_16x16x32_bf16 v[204:207], v[56:59], a[204:207], v[204:207]
  ds_read_b128 v[48:51], v33 offset:0
  v_mfma_f32_16x16x32_bf16 v[212:215], v[52:55], a[208:211], v[212:215]
  v_mfma_f32_16x16x32_bf16 v[212:215], v[56:59], a[212:215], v[212:215]
  v_mfma_f32_16x16x32_bf16 v[220:223], v[52:55], a[216:219], v[220:223]
  v_mfma_f32_16x16x32_bf16 v[220:223], v[56:59], a[220:223], v[220:223]
  v_mfma_f32_16x16x32_bf16 v[228:231], v[52:55], a[224:227], v[228:231]
  v_mfma_f32_16x16x32_bf16 v[228:231], v[56:59], a[228:231], v[228:231]
  v_mfma_f32_16x16x32_bf16 v[236:239], v[52:55], a[232:235], v[236:239]
  buffer_load_dwordx4 v25, s[4:7], s71 offen offset:1024  lds
  v_mfma_f32_16x16x32_bf16 v[236:239], v[56:59], a[236:239], v[236:239]
  v_mfma_f32_16x16x32_bf16 v[244:247], v[52:55], a[240:243], v[244:247]
  v_mfma_f32_16x16x32_bf16 v[244:247], v[56:59], a[244:247], v[244:247]
  s_waitcnt lgkmcnt(0)
  v_mfma_f32_16x16x32_bf16 v[252:255], v[52:55], a[248:251], v[252:255]
  s_cmp_lg_u32 s73, 3
  v_mfma_f32_16x16x32_bf16 v[252:255], v[56:59], a[252:255], v[252:255]
  s_cbranch_scc1 L_kf_kernel_aloop_12
  .p2align 6
L_kf_kernel_aloop_13:
  v_mfma_f32_16x16x32_bf16 a[0:3], v[44:47], a[128:131], a[0:3]
  v_mfma_f32_16x16x32_bf16 a[0:3], v[48:51], a[132:135], a[0:3]
  ds_read_b128 v[52:55], v32 offset:2048
  v_mfma_f32_16x16x32_bf16 a[8:11], v[44:47], a[136:139], a[8:11]
  buffer_load_dwordx4 v26, s[4:7], s71 offen offset:2048  lds
  v_mfma_f32_16x16x32_bf16 a[8:11], v[48:51], a[140:143], a[8:11]
  ds_read_b128 v[56:59], v33 offset:2048
  v_mfma_f32_16x16x32_bf16 a[16:19], v[44:47], a[144:147], a[16:19]
  v_mfma_f32_16x16x32_bf16 a[16:19], v[48:51], a[148:151], a[16:19]
  ds_read_b64_tr_b16 a[192:193], v34 offset:32768
  v_mfma_f32_16x16x32_bf16 a[24:27], v[44:47], a[152:155], a[24:27]
  v_mfma_f32_16x16x32_bf16 a[24:27], v[48:51], a[156:159], a[24:27]
  ds_read_b64_tr_b16 a[194:195], v34 offset:34816
  v_mfma_f32_16x16x32_bf16 a[32:35], v[44:47], a[160:163], a[32:35]
  v_mfma_f32_16x16x32_bf16 a[32:35], v[48:51], a[164:167], a[32:35]
  ds_read_b64_tr_b16 a[200:201], v35 offset:32768
  v_mfma_f32_16x16x32_bf16 a[40:43], v[44:47], a[168:171], a[40:43]
  buffer_load_dwordx4 v27, s[4:7], s71 offen offset:3072  lds
  v_mfma_f32_16x16x32_bf16 a[40:43], v[48:51], a[172:175], a[40:43]
  ds_read_b64_tr_b16 a[202:203], v35 offset:34816
  v_mfma_f32_16x16x32_bf16 a[48:51], v[44:47], a[176:179], a[48:51]
  v_mfma_f32_16x16x32_bf16 a[48:51], v[48:51], a[180:183], a[48:51]
  ds_read_b64_tr_b16 a[208:209], v36 offset:32768
  v_mfma_f32_16x16x32_bf16 a[56:59], v[44:47], a[184:187], a[56:59]
  s_add_u32 s70, s70, 128
  s_and_b32 s70, s70, 0x7ff
  v_mfma_f32_16x16x32_bf16 a[56:59], v[48:51], a[188:191], a[56:59]
  s_waitcnt lgkmcnt(5)
  ds_read_b64_tr_b16 a[210:211], v36 offset:34816
  v_mfma_f32_16x16x32_bf16 a[4:7], v[52:55], a[128:131], a[4:7]
  s_add_u32 m0, s65, 16384
  v_mfma_f32_16x16x32_bf16 a[4:7], v[56:59], a[132:135], a[4:7]
  ds_read_b128 v[44:47], v32 offset:4096
  v_mfma_f32_16x16x32_bf16 a[12:15], v[52:55], a[136:139], a[12:15]
  buffer_load_dwordx4 v28, s[8:11], s72 offen offset:0 nt lds
  v_mfma_f32_16x16x32_bf16 a[12:15], v[56:59], a[140:143], a[12:15]
  ds_read_b128 v[48:51], v33 offset:4096
  v_mfma_f32_16x16x32_bf16 a[20:23], v[52:55], a[144:147], a[20:23]
  s_add_u32 s71, s71, 128
  s_and_b32 s71, s71, 0x2007ff
  v_mfma_f32_16x16x32_bf16 a[20:23], v[56:59], a[148:151], a[20:23]
  s_sub_u32 s73, s73, 1
  ds_read_b64_tr_b16 a[216:217], v37 offset:32768
  v_mfma_f32_16x16x32_bf16 a[28:31], v[52:55], a[152:155], a[28:31]
  s_or_b32 s17, s73, s64
  v_mfma_f32_16x16x32_bf16 a[28:31], v[56:59], a[156:159], a[28:31]
  ds_read_b64_tr_b16 a[218:219], v37 offset:34816
  v_mfma_f32_16x16x32_bf16 a[36:39], v[52:55], a[160:163], a[36:39]
  s_cselect_b32 s17, 2147418112, 0
  v_mfma_f32_16x16x32_bf16 a[36:39], v[56:59], a[164:167], a[36:39]
  s_cmp_eq_u32 s73, 2
  ds_read_b64_tr_b16 a[224:225], v38 offset:32768
  v_mfma_f32_16x16x32_bf16 a[44:47], v[52:55], a[168:171], a[44:47]
  s_cselect_b32 s101, s62, 2147418112
  buffer_load_dwordx4 v29, s[8:11], s72 offen offset:1024 nt lds
  v_mfma_f32_16x16x32_bf16 a[44:47], v[56:59], a[172:175], a[44:47]
  ds_read_b64_tr_b16 a[226:227], v38 offset:34816
  v_mfma_f32_16x16x32_bf16 a[52:55], v[52:55], a[176:179], a[52:55]
  v_mfma_f32_16x16x32_bf16 a[52:55], v[56:59], a[180:183], a[52:55]
  ds_read_b64_tr_b16 a[232:233], v39 offset:32768
  v_mfma_f32_16x16x32_bf16 a[60:63], v[52:55], a[184:187], a[60:63]
  ds_read_b64_tr_b16 a[234:235], v39 offset:34816
  v_mfma_f32_16x16x32_bf16 a[60:63], v[56:59], a[188:191], a[60:63]
  s_waitcnt lgkmcnt(6)
  ds_read_b64_tr_b16 a[240:241], v40 offset:32768
  v_mfma_f32_16x16x32_bf16 a[64:67], v[44:47], a[128:131], a[64:67]
  v_mfma_f32_16x16x32_bf16 a[64:67], v[48:51], a[132:135], a[64:67]
  ds_read_b128 v[52:55], v32 offset:6144
  v_mfma_f32_16x16x32_bf16 a[72:75], v[44:47], a[136:139], a[72:75]
  buffer_load_dwordx4 v30, s[8:11], s72 offen offset:2048 nt lds
  v_mfma_f32_16x16x32_bf16 a[72:75], v[48:51], a[140:143], a[72:75]
  ds_read_b128 v[56:59], v33 offset:6144
  v_mfma_f32_16x16x32_bf16 a[80:83], v[44:47], a[144:147], a[80:83]
  ds_read_b64_tr_b16 a[242:243], v40 offset:34816
  v_mfma_f32_16x16x32_bf16 a[80:83], v[48:51], a[148:151], a[80:83]
  ds_read_b64_tr_b16 a[248:249], v41 offset:32768
  v_mfma_f32_16x16x32_bf16 a[88:91], v[44:47], a[152:155], a[88:91]
  v_mfma_f32_16x16x32_bf16 a[88:91], v[48:51], a[156:159], a[88:91]
  ds_read_b64_tr_b16 a[250:251], v41 offset:34816
  v_mfma_f32_16x16x32_bf16 a[96:99], v[44:47], a[160:163], a[96:99]
  v_mfma_f32_16x16x32_bf16 a[96:99], v[48:51], a[164:167], a[96:99]
  v_mfma_f32_16x16x32_bf16 a[104:107], v[44:47], a[168:171], a[104:107]
  buffer_load_dwordx4 v31, s[8:11], s72 offen offset:3072 nt lds
  v_mfma_f32_16x16x32_bf16 a[104:107], v[48:51], a[172:175], a[104:107]
  v_mfma_f32_16x16x32_bf16 a[112:115], v[44:47], a[176:179], a[112:115]
  s_add_u32 s72, s72, 262144
  s_and_b32 s72, s72, 0x7fffff
  v_mfma_f32_16x16x32_bf16 a[112:115], v[48:51], a[180:183], a[112:115]
  v_mfma_f32_16x16x32_bf16 a[120:123], v[44:47], a[184:187], a[120:123]
  s_waitcnt vmcnt(16) lgkmcnt(0)
  v_mfma_f32_16x16x32_bf16 a[120:123], v[48:51], a[188:191], a[120:123]
  s_barrier
  v_mfma_f32_16x16x32_bf16 a[68:71], v[52:55], a[128:131], a[68:71]
  s_add_u32 m0, s65, 65536
  v_mfma_f32_16x16x32_bf16 a[68:71], v[56:59], a[132:135], a[68:71]
  ds_read_b128 v[44:47], v32 offset:16384
  v_mfma_f32_16x16x32_bf16 a[76:79], v[52:55], a[136:139], a[76:79]
  buffer_load_dwordx4 v24, s[4:7], s70 offen offset:0  lds
  v_mfma_f32_16x16x32_bf16 a[76:79], v[56:59], a[140:143], a[76:79]
  ds_read_b128 v[48:51], v33 offset:16384
  v_mfma_f32_16x16x32_bf16 a[84:87], v[52:55], a[144:147], a[84:87]
  v_mfma_f32_16x16x32_bf16 a[84:87], v[56:59], a[148:151], a[84:87]
  v_mfma_f32_16x16x32_bf16 a[92:95], v[52:55], a[152:155], a[92:95]
  v_mfma_f32_16x16x32_bf16 a[92:95], v[56:59], a[156:159], a[92:95]
  v_mfma_f32_16x16x32_bf16 a[100:103], v[52:55], a[160:163], a[100:103]
  v_mfma_f32_16x16x32_bf16 a[100:103], v[56:59], a[164:167], a[100:103]
  v_mfma_f32_16x16x32_bf16 a[108:111], v[52:55], a[168:171], a[108:111]
  buffer_load_dwordx4 v25, s[4:7], s70 offen offset:1024  lds
  v_mfma_f32_16x16x32_bf16 a[108:111], v[56:59], a[172:175], a[108:111]
  v_mfma_f32_16x16x32_bf16 a[116:119], v[52:55], a[176:179], a[116:119]
  v_mfma_f32_16x16x32_bf16 a[116:119], v[56:59], a[180:183], a[116:119]
  v_mfma_f32_16x16x32_bf16 a[124:127], v[52:55], a[184:187], a[124:127]
  v_mfma_f32_16x16x32_bf16 a[124:127], v[56:59], a[188:191], a[124:127]
  s_waitcnt lgkmcnt(0)
  v_mfma_f32_16x16x32_bf16 v[128:131], v[44:47], a[128:131], v[128:131]
  v_mfma_f32_16x16x32_bf16 v[128:131], v[48:51], a[132:135], v[128:131]
  ds_read_b128 v[52:55], v32 offset:18432
  v_mfma_f32_16x16x32_bf16 v[136:139], v[44:47], a[136:139], v[136:139]
  buffer_load_dwordx4 v26, s[4:7], s70 offen offset:2048  lds
  v_mfma_f32_16x16x32_bf16 v[136:139], v[48:51], a[140:143], v[136:139]
  ds_read_b128 v[56:59], v33 offset:18432
  v_mfma_f32_16x16x32_bf16 v[144:147], v[44:47], a[144:147], v[144:147]
  v_mfma_f32_16x16x32_bf16 v[144:147], v[48:51], a[148:151], v[144:147]
  ds_read_b64_tr_b16 a[196:197], v34 offset:49152
  v_mfma_f32_16x16x32_bf16 v[152:155], v[44:47], a[152:155], v[152:155]
  v_mfma_f32_16x16x32_bf16 v[152:155], v[48:51], a[156:159], v[152:155]
  ds_read_b64_tr_b16 a[198:199], v34 offset:51200
  v_mfma_f32_16x16x32_bf16 v[160:163], v[44:47], a[160:163], v[160:163]
  v_mfma_f32_16x16x32_bf16 v[160:163], v[48:51], a[164:167], v[160:163]
  ds_read_b64_tr_b16 a[204:205], v35 offset:49152
  v_mfma_f32_16x16x32_bf16 v[168:171], v[44:47], a[168:171], v[168:171]
  buffer_load_dwordx4 v27, s[4:7], s70 offen offset:3072  lds
  v_mfma_f32_16x16x32_bf16 v[168:171], v[48:51], a[172:175], v[168:171]
  ds_read_b64_tr_b16 a[206:207], v35 offset:51200
  v_mfma_f32_16x16x32_bf16 v[176:179], v[44:47], a[176:179], v[176:179]
  v_mfma_f32_16x16x32_bf16 v[176:179], v[48:51], a[180:183], v[176:179]
  ds_read_b64_tr_b16 a[212:213], v36 offset:49152
  v_mfma_f32_16x16x32_bf16 v[184:187], v[44:47], a[184:187], v[184:187]
  v_mfma_f32_16x16x32_bf16 v[184:187], v[48:51], a[188:191], v[184:187]
  s_waitcnt lgkmcnt(5)
  ds_read_b64_tr_b16 a[214:215], v36 offset:51200
  v_mfma_f32_16x16x32_bf16 v[132:135], v[52:55], a[128:131], v[132:135]
  s_add_u32 m0, s65, 32768
  v_mfma_f32_16x16x32_bf16 v[132:135], v[56:59], a[132:135], v[132:135]
  ds_read_b128 v[44:47], v32 offset:20480
  v_mfma_f32_16x16x32_bf16 v[140:143], v[52:55], a[136:139], v[140:143]
  buffer_load_dwordx4 v28, s[8:11], s72 offen offset:0 nt lds
  v_mfma_f32_16x16x32_bf16 v[140:143], v[56:59], a[140:143], v[140:143]
  ds_read_b128 v[48:51], v33 offset:20480
  v_mfma_f32_16x16x32_bf16 v[148:151], v[52:55], a[144:147], v[148:151]
  v_mfma_f32_16x16x32_bf16 v[148:151], v[56:59], a[148:151], v[148:151]
  ds_read_b64_tr_b16 a[220:221], v37 offset:49152
  v_mfma_f32_16x16x32_bf16 v[156:159], v[52:55], a[152:155], v[156:159]
  v_mfma_f32_16x16x32_bf16 v[156:159], v[56:59], a[156:159], v[156:159]
  ds_read_b64_tr_b16 a[222:223], v37 offset:51200
  v_mfma_f32_16x16x32_bf16 v[164:167], v[52:55], a[160:163], v[164:167]
  v_mfma_f32_16x16x32_bf16 v[164:167], v[56:59], a[164:167], v[164:167]
  ds_read_b64_tr_b16 a[228:229], v38 offset:49152
  v_mfma_f32_16x16x32_bf16 v[172:175], v[52:55], a[168:171], v[172:175]
  buffer_load_dwordx4 v29, s[8:11], s72 offen offset:1024 nt lds
  v_mfma_f32_16x16x32_bf16 v[172:175], v[56:59], a[172:175], v[172:175]
  ds_read_b64_tr_b16 a[230:231], v38 offset:51200
  v_mfma_f32_16x16x32_bf16 v[180:183], v[52:55], a[176:179], v[180:183]
  v_mfma_f32_16x16x32_bf16 v[180:183], v[56:59], a[180:183], v[180:183]
  ds_read_b64_tr_b16 a[236:237], v39 offset:49152
  v_mfma_f32_16x16x32_bf16 v[188:191], v[52:55], a[184:187], v[188:191]
  ds_read_b64_tr_b16 a[238:239], v39 offset:51200
  v_mfma_f32_16x16x32_bf16 v[188:191], v[56:59], a[188:191], v[188:191]
  s_waitcnt lgkmcnt(6)
  ds_read_b64_tr_b16 a[244:245], v40 offset:49152
  v_mfma_f32_16x16x32_bf16 v[192:195], v[44:47], a[128:131], v[192:195]
  v_mfma_f32_16x16x32_bf16 v[192:195], v[48:51], a[132:135], v[192:195]
  ds_read_b128 v[52:55], v32 offset:22528
  v_mfma_f32_16x16x32_bf16 v[200:203], v[44:47], a[136:139], v[200:203]
  buffer_load_dwordx4 v30, s[8:11], s72 offen offset:2048 nt lds
  v_mfma_f32_16x16x32_bf16 v[200:203], v[48:51], a[140:143], v[200:203]
  ds_read_b128 v[56:59], v33 offset:22528
  v_mfma_f32_16x16x32_bf16 v[208:211], v[44:47], a[144:147], v[208:211]
  ds_read_b64_tr_b16 a[246:247], v40 offset:51200
  v_mfma_f32_16x16x32_bf16 v[208:211], v[48:51], a[148:151], v[208:211]
  ds_read_b64_tr_b16 a[252:253], v41 offset:49152
  v_mfma_f32_16x16x32_bf16 v[216:219], v[44:47], a[152:155], v[216:219]
  v_mfma_f32_16x16x32_bf16 v[216:219], v[48:51], a[156:159], v[216:219]
  ds_read_b64_tr_b16 a[254:255], v41 offset:51200
  v_mfma_f32_16x16x32_bf16 v[224:227], v[44:47], a[160:163], v[224:227]
  v_mfma_f32_16x16x32_bf16 v[224:227], v[48:51], a[164:167], v[224:227]
  v_mfma_f32_16x16x32_bf16 v[232:235], v[44:47], a[168:171], v[232:235]
  buffer_load_dwordx4 v31, s[8:11], s72 offen offset:3072 nt lds
  v_mfma_f32_16x16x32_bf16 v[232:235], v[48:51], a[172:175], v[232:235]
  v_mfma_f32_16x16x32_bf16 v[240:243], v[44:47], a[176:179], v[240:243]
  s_add_u32 s72, s72, 262144
  s_and_b32 s72, s72, 0x7fffff
  v_mfma_f32_16x16x32_bf16 v[240:243], v[48:51], a[180:183], v[240:243]
  v_mfma_f32_16x16x32_bf16 v[248:251], v[44:47], a[184:187], v[248:251]
  s_waitcnt vmcnt(16) lgkmcnt(0)
  v_mfma_f32_16x16x32_bf16 v[248:251], v[48:51], a[188:191], v[248:251]
  s_barrier
  v_mfma_f32_16x16x32_bf16 v[196:199], v[52:55], a[128:131], v[196:199]
  s_add_u32 m0, s65, 81920
  v_mfma_f32_16x16x32_bf16 v[196:199], v[56:59], a[132:135], v[196:199]
  ds_read_b128 v[44:47], v32 offset:32768
  v_mfma_f32_16x16x32_bf16 v[204:207], v[52:55], a[136:139], v[204:207]
  buffer_load_dwordx4 v24, s[4:7], s71 offen offset:0  lds
  v_mfma_f32_16x16x32_bf16 v[204:207], v[56:59], a[140:143], v[204:207]
  ds_read_b128 v[48:51], v33 offset:32768
  v_mfma_f32_16x16x32_bf16 v[212:215], v[52:55], a[144:147], v[212:215]
  v_mfma_f32_16x16x32_bf16 v[212:215], v[56:59], a[148:151], v[212:215]
  v_mfma_f32_16x16x32_bf16 v[220:223], v[52:55], a[152:155], v[220:223]
  v_mfma_f32_16x16x32_bf16 v[220:223], v[56:59], a[156:159], v[220:223]
  v_mfma_f32_16x16x32_bf16 v[228:231], v[52:55], a[160:163], v[228:231]
  v_mfma_f32_16x16x32_bf16 v[228:231], v[56:59], a[164:167], v[228:231]
  v_mfma_f32_16x16x32_bf16 v[236:239], v[52:55], a[168:171], v[236:239]
  buffer_load_dwordx4 v25, s[4:7], s71 offen offset:1024  lds
  v_mfma_f32_16x16x32_bf16 v[236:239], v[56:59], a[172:175], v[236:239]
  v_mfma_f32_16x16x32_bf16 v[244:247], v[52:55], a[176:179], v[244:247]
  v_mfma_f32_16x16x32_bf16 v[244:247], v[56:59], a[180:183], v[244:247]
  v_mfma_f32_16x16x32_bf16 v[252:255], v[52:55], a[184:187], v[252:255]
  buffer_atomic_add v11, v10, s[24:27], s101 offen sc1
  v_mfma_f32_16x16x32_bf16 v[252:255], v[56:59], a[188:191], v[252:255]
  s_waitcnt lgkmcnt(0)
  v_mfma_f32_16x16x32_bf16 a[0:3], v[44:47], a[192:195], a[0:3]
  v_mfma_f32_16x16x32_bf16 a[0:3], v[48:51], a[196:199], a[0:3]
  ds_read_b128 v[52:55], v32 offset:34816
  v_mfma_f32_16x16x32_bf16 a[8:11], v[44:47], a[200:203], a[8:11]
  buffer_load_dwordx4 v26, s[4:7], s71 offen offset:2048  lds
  v_mfma_f32_16x16x32_bf16 a[8:11], v[48:51], a[204:207], a[8:11]
  ds_read_b128 v[56:59], v33 offset:34816
  v_mfma_f32_16x16x32_bf16 a[16:19], v[44:47], a[208:211], a[16:19]
  v_mfma_f32_16x16x32_bf16 a[16:19], v[48:51], a[212:215], a[16:19]
  ds_read_b64_tr_b16 a[128:129], v34 offset:0
  v_mfma_f32_16x16x32_bf16 a[24:27], v[44:47], a[216:219], a[24:27]
  v_mfma_f32_16x16x32_bf16 a[24:27], v[48:51], a[220:223], a[24:27]
  ds_read_b64_tr_b16 a[130:131], v34 offset:2048
  v_mfma_f32_16x16x32_bf16 a[32:35], v[44:47], a[224:227], a[32:35]
  v_mfma_f32_16x16x32_bf16 a[32:35], v[48:51], a[228:231], a[32:35]
  ds_read_b64_tr_b16 a[136:137], v35 offset:0
  v_mfma_f32_16x16x32_bf16 a[40:43], v[44:47], a[232:235], a[40:43]
  buffer_load_dwordx4 v27, s[4:7], s71 offen offset:3072  lds
  v_mfma_f32_16x16x32_bf16 a[40:43], v[48:51], a[236:239], a[40:43]
  ds_read_b64_tr_b16 a[138:139], v35 offset:2048
  v_mfma_f32_16x16x32_bf16 a[48:51], v[44:47], a[240:243], a[48:51]
  v_mfma_f32_16x16x32_bf16 a[48:51], v[48:51], a[244:247], a[48:51]
  ds_read_b64_tr_b16 a[144:145], v36 offset:0
  v_mfma_f32_16x16x32_bf16 a[56:59], v[44:47], a[248:251], a[56:59]
  s_add_u32 s70, s70, 128
  s_and_b32 s70, s70, 0x7ff
  v_mfma_f32_16x16x32_bf16 a[56:59], v[48:51], a[252:255], a[56:59]
  s_waitcnt lgkmcnt(5)
  ds_read_b64_tr_b16 a[146:147], v36 offset:2048
  v_mfma_f32_16x16x32_bf16 a[4:7], v[52:55], a[192:195], a[4:7]
  s_add_u32 m0, s65, 49152
  v_mfma_f32_16x16x32_bf16 a[4:7], v[56:59], a[196:199], a[4:7]
  ds_read_b128 v[44:47], v32 offset:36864
  v_mfma_f32_16x16x32_bf16 a[12:15], v[52:55], a[200:203], a[12:15]
  buffer_load_dwordx4 v28, s[8:11], s72 offen offset:0 nt lds
  v_mfma_f32_16x16x32_bf16 a[12:15], v[56:59], a[204:207], a[12:15]
  ds_read_b128 v[48:51], v33 offset:36864
  v_mfma_f32_16x16x32_bf16 a[20:23], v[52:55], a[208:211], a[20:23]
  s_add_u32 s71, s71, 128
  s_and_b32 s71, s71, 0x2007ff
  v_mfma_f32_16x16x32_bf16 a[20:23], v[56:59], a[212:215], a[20:23]
  ds_read_b64_tr_b16 a[152:153], v37 offset:0
  v_mfma_f32_16x16x32_bf16 a[28:31], v[52:55], a[216:219], a[28:31]
  buffer_load_dword v12, v13, s[24:27], s17 offen sc1
  v_mfma_f32_16x16x32_bf16 a[28:31], v[56:59], a[220:223], a[28:31]
  ds_read_b64_tr_b16 a[154:155], v37 offset:2048
  v_mfma_f32_16x16x32_bf16 a[36:39], v[52:55], a[224:227], a[36:39]
  v_mfma_f32_16x16x32_bf16 a[36:39], v[56:59], a[228:231], a[36:39]
  ds_read_b64_tr_b16 a[160:161], v38 offset:0
  v_mfma_f32_16x16x32_bf16 a[44:47], v[52:55], a[232:235], a[44:47]
  buffer_load_dwordx4 v29, s[8:11], s72 offen offset:1024 nt lds
  v_mfma_f32_16x16x32_bf16 a[44:47], v[56:59], a[236:239], a[44:47]
  ds_read_b64_tr_b16 a[162:163], v38 offset:2048
  v_mfma_f32_16x16x32_bf16 a[52:55], v[52:55], a[240:243], a[52:55]
  v_mfma_f32_16x16x32_bf16 a[52:55], v[56:59], a[244:247], a[52:55]
  ds_read_b64_tr_b16 a[168:169], v39 offset:0
  v_mfma_f32_16x16x32_bf16 a[60:63], v[52:55], a[248:251], a[60:63]
  ds_read_b64_tr_b16 a[170:171], v39 offset:2048
  v_mfma_f32_16x16x32_bf16 a[60:63], v[56:59], a[252:255], a[60:63]
  s_waitcnt lgkmcnt(6)
  ds_read_b64_tr_b16 a[176:177], v40 offset:0
  v_mfma_f32_16x16x32_bf16 a[64:67], v[44:47], a[192:195], a[64:67]
  v_mfma_f32_16x16x32_bf16 a[64:67], v[48:51], a[196:199], a[64:67]
  ds_read_b128 v[52:55], v32 offset:38912
  v_mfma_f32_16x16x32_bf16 a[72:75], v[44:47], a[200:203], a[72:75]
  buffer_load_dwordx4 v30, s[8:11], s72 offen offset:2048 nt lds
  v_mfma_f32_16x16x32_bf16 a[72:75], v[48:51], a[204:207], a[72:75]
  ds_read_b128 v[56:59], v33 offset:38912
  v_mfma_f32_16x16x32_bf16 a[80:83], v[44:47], a[208:211], a[80:83]
  ds_read_b64_tr_b16 a[178:179], v40 offset:2048
  v_mfma_f32_16x16x32_bf16 a[80:83], v[48:51], a[212:215], a[80:83]
  ds_read_b64_tr_b16 a[184:185], v41 offset:0
  v_mfma_f32_16x16x32_bf16 a[88:91], v[44:47], a[216:219], a[88:91]
  v_mfma_f32_16x16x32_bf16 a[88:91], v[48:51], a[220:223], a[88:91]
  ds_read_b64_tr_b16 a[186:187], v41 offset:2048
  v_mfma_f32_16x16x32_bf16 a[96:99], v[44:47], a[224:227], a[96:99]
  v_mfma_f32_16x16x32_bf16 a[96:99], v[48:51], a[228:231], a[96:99]
  v_mfma_f32_16x16x32_bf16 a[104:107], v[44:47], a[232:235], a[104:107]
  buffer_load_dwordx4 v31, s[8:11], s72 offen offset:3072 nt lds
  v_mfma_f32_16x16x32_bf16 a[104:107], v[48:51], a[236:239], a[104:107]
  v_mfma_f32_16x16x32_bf16 a[112:115], v[44:47], a[240:243], a[112:115]
  s_add_u32 s72, s72, 262144
  s_and_b32 s72, s72, 0x7fffff
  v_mfma_f32_16x16x32_bf16 a[112:115], v[48:51], a[244:247], a[112:115]
  v_mfma_f32_16x16x32_bf16 a[120:123], v[44:47], a[248:251], a[120:123]
  s_waitcnt vmcnt(18) lgkmcnt(0)
  v_mfma_f32_16x16x32_bf16 a[120:123], v[48:51], a[252:255], a[120:123]
  s_barrier
  v_mfma_f32_16x16x32_bf16 a[68:71], v[52:55], a[192:195], a[68:71]
  s_add_u32 m0, s65, 98304
  v_mfma_f32_16x16x32_bf16 a[68:71], v[56:59], a[196:199], a[68:71]
  ds_read_b128 v[44:47], v32 offset:49152
  v_mfma_f32_16x16x32_bf16 a[76:79], v[52:55], a[200:203], a[76:79]
  buffer_load_dwordx4 v24, s[4:7], s70 offen offset:0  lds
  v_mfma_f32_16x16x32_bf16 a[76:79], v[56:59], a[204:207], a[76:79]
  ds_read_b128 v[48:51], v33 offset:49152
  v_mfma_f32_16x16x32_bf16 a[84:87], v[52:55], a[208:211], a[84:87]
  v_mfma_f32_16x16x32_bf16 a[84:87], v[56:59], a[212:215], a[84:87]
  v_mfma_f32_16x16x32_bf16 a[92:95], v[52:55], a[216:219], a[92:95]
  v_mfma_f32_16x16x32_bf16 a[92:95], v[56:59], a[220:223], a[92:95]
  v_mfma_f32_16x16x32_bf16 a[100:103], v[52:55], a[224:227], a[100:103]
  v_mfma_f32_16x16x32_bf16 a[100:103], v[56:59], a[228:231], a[100:103]
  v_mfma_f32_16x16x32_bf16 a[108:111], v[52:55], a[232:235], a[108:111]
  buffer_load_dwordx4 v25, s[4:7], s70 offen offset:1024  lds
  v_mfma_f32_16x16x32_bf16 a[108:111], v[56:59], a[236:239], a[108:111]
  v_mfma_f32_16x16x32_bf16 a[116:119], v[52:55], a[240:243], a[116:119]
  v_mfma_f32_16x16x32_bf16 a[116:119], v[56:59], a[244:247], a[116:119]
  v_mfma_f32_16x16x32_bf16 a[124:127], v[52:55], a[248:251], a[124:127]
  v_mfma_f32_16x16x32_bf16 a[124:127], v[56:59], a[252:255], a[124:127]
  s_waitcnt lgkmcnt(0)
  v_mfma_f32_16x16x32_bf16 v[128:131], v[44:47], a[192:195], v[128:131]
  v_mfma_f32_16x16x32_bf16 v[128:131], v[48:51], a[196:199], v[128:131]
  ds_read_b128 v[52:55], v32 offset:51200
  v_mfma_f32_16x16x32_bf16 v[136:139], v[44:47], a[200:203], v[136:139]
  buffer_load_dwordx4 v26, s[4:7], s70 offen offset:2048  lds
  v_mfma_f32_16x16x32_bf16 v[136:139], v[48:51], a[204:207], v[136:139]
  ds_read_b128 v[56:59], v33 offset:51200
  v_mfma_f32_16x16x32_bf16 v[144:147], v[44:47], a[208:211], v[144:147]
  v_mfma_f32_16x16x32_bf16 v[144:147], v[48:51], a[212:215], v[144:147]
  ds_read_b64_tr_b16 a[132:133], v34 offset:16384
  v_mfma_f32_16x16x32_bf16 v[152:155], v[44:47], a[216:219], v[152:155]
  v_mfma_f32_16x16x32_bf16 v[152:155], v[48:51], a[220:223], v[152:155]
  ds_read_b64_tr_b16 a[134:135], v34 offset:18432
  v_mfma_f32_16x16x32_bf16 v[160:163], v[44:47], a[224:227], v[160:163]
  v_mfma_f32_16x16x32_bf16 v[160:163], v[48:51], a[228:231], v[160:163]
  ds_read_b64_tr_b16 a[140:141], v35 offset:16384
  v_mfma_f32_16x16x32_bf16 v[168:171], v[44:47], a[232:235], v[168:171]
  buffer_load_dwordx4 v27, s[4:7], s70 offen offset:3072  lds
  v_mfma_f32_16x16x32_bf16 v[168:171], v[48:51], a[236:239], v[168:171]
  ds_read_b64_tr_b16 a[142:143], v35 offset:18432
  v_mfma_f32_16x16x32_bf16 v[176:179], v[44:47], a[240:243], v[176:179]
  v_mfma_f32_16x16x32_bf16 v[176:179], v[48:51], a[244:247], v[176:179]
  ds_read_b64_tr_b16 a[148:149], v36 offset:16384
  v_mfma_f32_16x16x32_bf16 v[184:187], v[44:47], a[248:251], v[184:187]
  v_mfma_f32_16x16x32_bf16 v[184:187], v[48:51], a[252:255], v[184:187]
  s_waitcnt lgkmcnt(5)
  ds_read_b64_tr_b16 a[150:151], v36 offset:18432
  v_mfma_f32_16x16x32_bf16 v[132:135], v[52:55], a[192:195], v[132:135]
  s_add_u32 m0, s65, 0
  v_mfma_f32_16x16x32_bf16 v[132:135], v[56:59], a[196:199], v[132:135]
  ds_read_b128 v[44:47], v32 offset:53248
  v_mfma_f32_16x16x32_bf16 v[140:143], v[52:55], a[200:203], v[140:143]
  buffer_load_dwordx4 v28, s[8:11], s72 offen offset:0 nt lds
  v_mfma_f32_16x16x32_bf16 v[140:143], v[56:59], a[204:207], v[140:143]
  ds_read_b128 v[48:51], v33 offset:53248
  v_mfma_f32_16x16x32_bf16 v[148:151], v[52:55], a[208:211], v[148:151]
  v_mfma_f32_16x16x32_bf16 v[148:151], v[56:59], a[212:215], v[148:151]
  ds_read_b64_tr_b16 a[156:157], v37 offset:16384
  v_mfma_f32_16x16x32_bf16 v[156:159], v[52:55], a[216:219], v[156:159]
  v_mfma_f32_16x16x32_bf16 v[156:159], v[56:59], a[220:223], v[156:159]
  ds_read_b64_tr_b16 a[158:159], v37 offset:18432
  v_mfma_f32_16x16x32_bf16 v[164:167], v[52:55], a[224:227], v[164:167]
  v_mfma_f32_16x16x32_bf16 v[164:167], v[56:59], a[228:231], v[164:167]
  ds_read_b64_tr_b16 a[164:165], v38 offset:16384
  v_mfma_f32_16x16x32_bf16 v[172:175], v[52:55], a[232:235], v[172:175]
  buffer_load_dwordx4 v29, s[8:11], s72 offen offset:1024 nt lds
  v_mfma_f32_16x16x32_bf16 v[172:175], v[56:59], a[236:239], v[172:175]
  ds_read_b64_tr_b16 a[166:167], v38 offset:18432
  v_mfma_f32_16x16x32_bf16 v[180:183], v[52:55], a[240:243], v[180:183]
  v_mfma_f32_16x16x32_bf16 v[180:183], v[56:59], a[244:247], v[180:183]
  ds_read_b64_tr_b16 a[172:173], v39 offset:16384
  v_mfma_f32_16x16x32_bf16 v[188:191], v[52:55], a[248:251], v[188:191]
  ds_read_b64_tr_b16 a[174:175], v39 offset:18432
  v_mfma_f32_16x16x32_bf16 v[188:191], v[56:59], a[252:255], v[188:191]
  s_waitcnt lgkmcnt(6)
  ds_read_b64_tr_b16 a[180:181], v40 offset:16384
  v_mfma_f32_16x16x32_bf16 v[192:195], v[44:47], a[192:195], v[192:195]
  v_mfma_f32_16x16x32_bf16 v[192:195], v[48:51], a[196:199], v[192:195]
  ds_read_b128 v[52:55], v32 offset:55296
  v_mfma_f32_16x16x32_bf16 v[200:203], v[44:47], a[200:203], v[200:203]
  buffer_load_dwordx4 v30, s[8:11], s72 offen offset:2048 nt lds
  v_mfma_f32_16x16x32_bf16 v[200:203], v[48:51], a[204:207], v[200:203]
  ds_read_b128 v[56:59], v33 offset:55296
  v_mfma_f32_16x16x32_bf16 v[208:211], v[44:47], a[208:211], v[208:211]
  ds_read_b64_tr_b16 a[182:183], v40 offset:18432
  v_mfma_f32_16x16x32_bf16 v[208:211], v[48:51], a[212:215], v[208:211]
  ds_read_b64_tr_b16 a[188:189], v41 offset:16384
  v_mfma_f32_16x16x32_bf16 v[216:219], v[44:47], a[216:219], v[216:219]
  v_mfma_f32_16x16x32_bf16 v[216:219], v[48:51], a[220:223], v[216:219]
  ds_read_b64_tr_b16 a[190:191], v41 offset:18432
  v_mfma_f32_16x16x32_bf16 v[224:227], v[44:47], a[224:227], v[224:227]
  v_mfma_f32_16x16x32_bf16 v[224:227], v[48:51], a[228:231], v[224:227]
  v_mfma_f32_16x16x32_bf16 v[232:235], v[44:47], a[232:235], v[232:235]
  buffer_load_dwordx4 v31, s[8:11], s72 offen offset:3072 nt lds
  v_mfma_f32_16x16x32_bf16 v[232:235], v[48:51], a[236:239], v[232:235]
  v_mfma_f32_16x16x32_bf16 v[240:243], v[44:47], a[240:243], v[240:243]
  s_add_u32 s72, s72, 262144
  s_and_b32 s72, s72, 0x7fffff
  v_mfma_f32_16x16x32_bf16 v[240:243], v[48:51], a[244:247], v[240:243]
  v_mfma_f32_16x16x32_bf16 v[248:251], v[44:47], a[248:251], v[248:251]
  s_waitcnt vmcnt(18) lgkmcnt(0)
  v_mfma_f32_16x16x32_bf16 v[248:251], v[48:51], a[252:255], v[248:251]
  s_barrier
  v_mfma_f32_16x16x32_bf16 v[196:199], v[52:55], a[192:195], v[196:199]
  s_add_u32 m0, s65, 114688
  v_mfma_f32_16x16x32_bf16 v[196:199], v[56:59], a[196:199], v[196:199]
  ds_read_b128 v[44:47], v32 offset:0
  v_mfma_f32_16x16x32_bf16 v[204:207], v[52:55], a[200:203], v[204:207]
  buffer_load_dwordx4 v24, s[4:7], s71 offen offset:0  lds
  v_mfma_f32_16x16x32_bf16 v[204:207], v[56:59], a[204:207], v[204:207]
  ds_read_b128 v[48:51], v33 offset:0
  v_mfma_f32_16x16x32_bf16 v[212:215], v[52:55], a[208:211], v[212:215]
  v_mfma_f32_16x16x32_bf16 v[212:215], v[56:59], a[212:215], v[212:215]
  v_mfma_f32_16x16x32_bf16 v[220:223], v[52:55], a[216:219], v[220:223]
  v_mfma_f32_16x16x32_bf16 v[220:223], v[56:59], a[220:223], v[220:223]
  v_mfma_f32_16x16x32_bf16 v[228:231], v[52:55], a[224:227], v[228:231]
  v_mfma_f32_16x16x32_bf16 v[228:231], v[56:59], a[228:231], v[228:231]
  v_mfma_f32_16x16x32_bf16 v[236:239], v[52:55], a[232:235], v[236:239]
  buffer_load_dwordx4 v25, s[4:7], s71 offen offset:1024  lds
  v_mfma_f32_16x16x32_bf16 v[236:239], v[56:59], a[236:239], v[236:239]
  v_mfma_f32_16x16x32_bf16 v[244:247], v[52:55], a[240:243], v[244:247]
  v_mfma_f32_16x16x32_bf16 v[244:247], v[56:59], a[244:247], v[244:247]
  s_waitcnt lgkmcnt(0)
  v_mfma_f32_16x16x32_bf16 v[252:255], v[52:55], a[248:251], v[252:255]
  s_cmp_lg_u32 s73, 0
  v_mfma_f32_16x16x32_bf16 v[252:255], v[56:59], a[252:255], v[252:255]
  s_cbranch_scc1 L_kf_kernel_aloop_13
  v_mfma_f32_16x16x32_bf16 a[0:3], v[44:47], a[128:131], a[0:3]
  s_getreg_b32 s51, hwreg(HW_REG_XCC_ID, 0, 4)
  ds_read_b64_tr_b16 a[192:193], v34 offset:32768
  v_mfma_f32_16x16x32_bf16 a[0:3], v[48:51], a[132:135], a[0:3]
  s_add_u32 s51, s51, 1
  ds_read_b128 v[52:55], v32 offset:2048
  v_mfma_f32_16x16x32_bf16 a[8:11], v[44:47], a[136:139], a[8:11]
  s_mul_i32 s51, s51, 0x1010101
  buffer_load_dwordx4 v26, s[4:7], s71 offen offset:2048  lds
  v_mfma_f32_16x16x32_bf16 a[8:11], v[48:51], a[140:143], a[8:11]
  ds_read_b128 v[56:59], v33 offset:2048
  v_mfma_f32_16x16x32_bf16 a[16:19], v[44:47], a[144:147], a[16:19]
  s_and_b32 s69, s32, 255
  ds_read_b64_tr_b16 a[194:195], v34 offset:34816
  v_mfma_f32_16x16x32_bf16 a[16:19], v[48:51], a[148:151], a[16:19]
  s_lshl_b32 s96, s69, 3
  ds_read_b64_tr_b16 a[200:201], v35 offset:32768
  v_mfma_f32_16x16x32_bf16 a[24:27], v[44:47], a[152:155], a[24:27]
  s_add_u32 s96, s96, s64
  ds_read_b64_tr_b16 a[202:203], v35 offset:34816
  v_mfma_f32_16x16x32_bf16 a[24:27], v[48:51], a[156:159], a[24:27]
  ds_read_b64_tr_b16 a[208:209], v36 offset:32768
  v_mfma_f32_16x16x32_bf16 a[32:35], v[44:47], a[160:163], a[32:35]
  s_mul_i32 s79, s96, 14336
  ds_read_b64_tr_b16 a[210:211], v36 offset:34816
  v_mfma_f32_16x16x32_bf16 a[32:35], v[48:51], a[164:167], a[32:35]
  s_add_u32 s79, s79, 35651584
  ds_read_b64_tr_b16 a[216:217], v37 offset:32768
  v_mfma_f32_16x16x32_bf16 a[40:43], v[44:47], a[168:171], a[40:43]
  s_mul_i32 s66, s68, 229376
  buffer_load_dwordx4 v27, s[4:7], s71 offen offset:3072  lds
  v_mfma_f32_16x16x32_bf16 a[40:43], v[48:51], a[172:175], a[40:43]
  ds_read_b64_tr_b16 a[218:219], v37 offset:34816
  s_add_u32 s66, s66, 38797312
  v_mfma_f32_16x16x32_bf16 a[48:51], v[44:47], a[176:179], a[48:51]
  s_mov_b32 s67, 0
  ds_read_b64_tr_b16 a[224:225], v38 offset:32768
  v_mov_b32 v11, 1
  v_mfma_f32_16x16x32_bf16 a[48:51], v[48:51], a[180:183], a[48:51]
  ds_read_b64_tr_b16 a[226:227], v38 offset:34816
  s_waitcnt vmcnt(15)
  v_cmp_ne_u32 s[56:57], s51, v12
  v_mfma_f32_16x16x32_bf16 a[56:59], v[44:47], a[184:187], a[56:59]
  s_add_u32 m0, s67, s65
  ds_read_b64_tr_b16 a[232:233], v39 offset:32768
  v_add_u32 v12, 0xfefefeff, v12
  v_mfma_f32_16x16x32_bf16 a[56:59], v[48:51], a[188:191], a[56:59]
  s_waitcnt lgkmcnt(10)
  ds_read_b64_tr_b16 a[234:235], v39 offset:34816
  v_and_b32 v12, 0x80808080, v12
  v_mfma_f32_16x16x32_bf16 a[4:7], v[52:55], a[128:131], a[4:7]
  s_add_u32 s67, s67, 0x8000
  ds_read_b64_tr_b16 a[240:241], v40 offset:32768
  v_and_b32 v12, s16, v12
  v_mfma_f32_16x16x32_bf16 a[4:7], v[56:59], a[132:135], a[4:7]
  s_and_b32 s67, s67, 0x1ffff
  ds_read_b128 v[44:47], v32 offset:4096
  v_cmp_ne_u32 vcc, 0, v12
  v_mfma_f32_16x16x32_bf16 a[12:15], v[52:55], a[136:139], a[12:15]
  s_cbranch_vccnz L_kf_kernel_spin_15
L_kf_kernel_spinr_16:
  ds_read_b64_tr_b16 a[242:243], v40 offset:34816
  v_mfma_f32_16x16x32_bf16 a[12:15], v[56:59], a[140:143], a[12:15]
  ds_read_b128 v[48:51], v33 offset:4096
  v_mfma_f32_16x16x32_bf16 a[20:23], v[52:55], a[144:147], a[20:23]
  ds_read_b64_tr_b16 a[248:249], v41 offset:32768
  v_mfma_f32_16x16x32_bf16 a[20:23], v[56:59], a[148:151], a[20:23]
  ds_read_b64_tr_b16 a[250:251], v41 offset:34816
  v_mfma_f32_16x16x32_bf16 a[28:31], v[52:55], a[152:155], a[28:31]
  v_mfma_f32_16x16x32_bf16 a[28:31], v[56:59], a[156:159], a[28:31]
  v_mfma_f32_16x16x32_bf16 a[36:39], v[52:55], a[160:163], a[36:39]
  s_waitcnt vmcnt(12)
  v_mfma_f32_16x16x32_bf16 a[36:39], v[56:59], a[164:167], a[36:39]
  s_barrier
  v_mfma_f32_16x16x32_bf16 a[44:47], v[52:55], a[168:171], a[44:47]
  s_lshl_b32 s51, s68, 2
  ds_read_b64_tr_b16 a[196:197], v34 offset:49152
  v_mfma_f32_16x16x32_bf16 a[44:47], v[56:59], a[172:175], a[44:47]
  ds_read_b64_tr_b16 a[198:199], v34 offset:51200
  v_mfma_f32_16x16x32_bf16 a[52:55], v[52:55], a[176:179], a[52:55]
  s_lshr_b64 s[56:57], s[56:57], s51
  buffer_load_dwordx4 v3, s[12:15], s66 offen offset:0 sc1 lds
  v_mfma_f32_16x16x32_bf16 a[52:55], v[56:59], a[180:183], a[52:55]
  s_and_b32 s56, s56, 15
  ds_read_b64_tr_b16 a[204:205], v35 offset:49152
  v_mov_b32 v12, s56
  v_mfma_f32_16x16x32_bf16 a[60:63], v[52:55], a[184:187], a[60:63]
  ds_read_b64_tr_b16 a[206:207], v35 offset:51200
  v_add_u32 v42, 131072, v3
  v_mfma_f32_16x16x32_bf16 a[60:63], v[56:59], a[188:191], a[60:63]
  s_waitcnt lgkmcnt(6)
  ds_read_b64_tr_b16 a[212:213], v36 offset:49152
  v_mfma_f32_16x16x32_bf16 a[64:67], v[44:47], a[128:131], a[64:67]
  ds_read_b64_tr_b16 a[214:215], v36 offset:51200
  v_mfma_f32_16x16x32_bf16 a[64:67], v[48:51], a[132:135], a[64:67]
  ds_read_b128 v[52:55], v32 offset:6144
  v_mfma_f32_16x16x32_bf16 a[72:75], v[44:47], a[136:139], a[72:75]
  ds_read_b64_tr_b16 a[220:221], v37 offset:49152
  v_mfma_f32_16x16x32_bf16 a[72:75], v[48:51], a[140:143], a[72:75]
  ds_read_b128 v[56:59], v33 offset:6144
  v_mfma_f32_16x16x32_bf16 a[80:83], v[44:47], a[144:147], a[80:83]
  buffer_load_dwordx4 v3, s[12:15], s66 offen offset:1024 sc1 lds
  v_mfma_f32_16x16x32_bf16 a[80:83], v[48:51], a[148:151], a[80:83]
  ds_read_b64_tr_b16 a[222:223], v37 offset:51200
  v_mfma_f32_16x16x32_bf16 a[88:91], v[44:47], a[152:155], a[88:91]
  ds_read_b64_tr_b16 a[228:229], v38 offset:49152
  v_mfma_f32_16x16x32_bf16 a[88:91], v[48:51], a[156:159], a[88:91]
  ds_read_b64_tr_b16 a[230:231], v38 offset:51200
  v_mfma_f32_16x16x32_bf16 a[96:99], v[44:47], a[160:163], a[96:99]
  ds_read_b64_tr_b16 a[236:237], v39 offset:49152
  v_mfma_f32_16x16x32_bf16 a[96:99], v[48:51], a[164:167], a[96:99]
  ds_read_b64_tr_b16 a[238:239], v39 offset:51200
  v_mfma_f32_16x16x32_bf16 a[104:107], v[44:47], a[168:171], a[104:107]
  ds_read_b64_tr_b16 a[244:245], v40 offset:49152
  v_mfma_f32_16x16x32_bf16 a[104:107], v[48:51], a[172:175], a[104:107]
  ds_read_b64_tr_b16 a[246:247], v40 offset:51200
  v_mfma_f32_16x16x32_bf16 a[112:115], v[44:47], a[176:179], a[112:115]
  buffer_load_dwordx4 v3, s[12:15], s66 offen offset:2048 sc1 lds
  v_mfma_f32_16x16x32_bf16 a[112:115], v[48:51], a[180:183], a[112:115]
  v_mfma_f32_16x16x32_bf16 a[120:123], v[44:47], a[184:187], a[120:123]
  s_waitcnt vmcnt(7) lgkmcnt(7)
  v_mfma_f32_16x16x32_bf16 a[120:123], v[48:51], a[188:191], a[120:123]
  s_barrier
  v_mfma_f32_16x16x32_bf16 a[68:71], v[52:55], a[128:131], a[68:71]
  buffer_load_dwordx4 v3, s[12:15], s66 offen offset:3072 sc1 lds
  v_mfma_f32_16x16x32_bf16 a[68:71], v[56:59], a[132:135], a[68:71]
  s_add_u32 m0, m0, 0x4000
  ds_read_b128 v[44:47], v32 offset:32768
  v_mfma_f32_16x16x32_bf16 a[76:79], v[52:55], a[136:139], a[76:79]
  v_mfma_f32_16x16x32_bf16 a[76:79], v[56:59], a[140:143], a[76:79]
  ds_read_b128 v[48:51], v33 offset:32768
  v_mfma_f32_16x16x32_bf16 a[84:87], v[52:55], a[144:147], a[84:87]
  buffer_load_dwordx4 v4, s[12:15], s66 offen offset:0 sc1 lds
  v_mfma_f32_16x16x32_bf16 a[84:87], v[56:59], a[148:151], a[84:87]
  ds_read_b64_tr_b16 a[252:253], v41 offset:49152
  v_mfma_f32_16x16x32_bf16 a[92:95], v[52:55], a[152:155], a[92:95]
  ds_read_b64_tr_b16 a[254:255], v41 offset:51200
  v_mfma_f32_16x16x32_bf16 a[92:95], v[56:59], a[156:159], a[92:95]
  v_mfma_f32_16x16x32_bf16 a[100:103], v[52:55], a[160:163], a[100:103]
  buffer_load_dwordx4 v4, s[12:15], s66 offen offset:1024 sc1 lds
  v_mfma_f32_16x16x32_bf16 a[100:103], v[56:59], a[164:167], a[100:103]
  v_mfma_f32_16x16x32_bf16 a[108:111], v[52:55], a[168:171], a[108:111]
  v_mfma_f32_16x16x32_bf16 a[108:111], v[56:59], a[172:175], a[108:111]
  v_mfma_f32_16x16x32_bf16 a[116:119], v[52:55], a[176:179], a[116:119]
  buffer_load_dwordx4 v4, s[12:15], s66 offen offset:2048 sc1 lds
  v_mfma_f32_16x16x32_bf16 a[116:119], v[56:59], a[180:183], a[116:119]
  v_mfma_f32_16x16x32_bf16 a[124:127], v[52:55], a[184:187], a[124:127]
  v_mfma_f32_16x16x32_bf16 a[124:127], v[56:59], a[188:191], a[124:127]
  s_waitcnt lgkmcnt(2)
  v_mfma_f32_16x16x32_bf16 a[0:3], v[44:47], a[192:195], a[0:3]
  buffer_load_dwordx4 v4, s[12:15], s66 offen offset:3072 sc1 lds
  v_mfma_f32_16x16x32_bf16 a[0:3], v[48:51], a[196:199], a[0:3]
  s_add_u32 m0, s65, 32768
  ds_read_b128 v[52:55], v32 offset:34816
  s_add_u32 s98, s66, 32768
  v_mfma_f32_16x16x32_bf16 a[8:11], v[44:47], a[200:203], a[8:11]
  v_mfma_f32_16x16x32_bf16 a[8:11], v[48:51], a[204:207], a[8:11]
  ds_read_b128 v[56:59], v33 offset:34816
  v_mfma_f32_16x16x32_bf16 a[16:19], v[44:47], a[208:211], a[16:19]
  buffer_load_dwordx4 v3, s[12:15], s98 offen offset:0 sc1 lds
  v_mfma_f32_16x16x32_bf16 a[16:19], v[48:51], a[212:215], a[16:19]
  v_mfma_f32_16x16x32_bf16 a[24:27], v[44:47], a[216:219], a[24:27]
  v_mfma_f32_16x16x32_bf16 a[24:27], v[48:51], a[220:223], a[24:27]
  v_mfma_f32_16x16x32_bf16 a[32:35], v[44:47], a[224:227], a[32:35]
  v_mfma_f32_16x16x32_bf16 a[32:35], v[48:51], a[228:231], a[32:35]
  v_mfma_f32_16x16x32_bf16 a[40:43], v[44:47], a[232:235], a[40:43]
  buffer_load_dwordx4 v3, s[12:15], s98 offen offset:1024 sc1 lds
  v_mfma_f32_16x16x32_bf16 a[40:43], v[48:51], a[236:239], a[40:43]
  s_waitcnt lgkmcnt(2)
  v_mfma_f32_16x16x32_bf16 a[48:51], v[44:47], a[240:243], a[48:51]
  v_mfma_f32_16x16x32_bf16 a[48:51], v[48:51], a[244:247], a[48:51]
  v_mfma_f32_16x16x32_bf16 a[56:59], v[44:47], a[248:251], a[56:59]
  v_mfma_f32_16x16x32_bf16 a[56:59], v[48:51], a[252:255], a[56:59]
  s_waitcnt lgkmcnt(0)
  v_mfma_f32_16x16x32_bf16 a[4:7], v[52:55], a[192:195], a[4:7]
  buffer_load_dwordx4 v3, s[12:15], s98 offen offset:2048 sc1 lds
  v_mfma_f32_16x16x32_bf16 a[4:7], v[56:59], a[196:199], a[4:7]
  ds_read_b128 v[44:47], v32 offset:36864
  v_mfma_f32_16x16x32_bf16 a[12:15], v[52:55], a[200:203], a[12:15]
  v_mfma_f32_16x16x32_bf16 a[12:15], v[56:59], a[204:207], a[12:15]
  ds_read_b128 v[48:51], v33 offset:36864
  v_accvgpr_read_b32 v16, a0
  v_mfma_f32_16x16x32_bf16 a[20:23], v[52:55], a[208:211], a[20:23]
  v_accvgpr_read_b32 v17, a1
  v_accvgpr_read_b32 v18, a2
  v_mfma_f32_16x16x32_bf16 a[20:23], v[56:59], a[212:215], a[20:23]
  v_accvgpr_read_b32 v19, a3
  v_accvgpr_read_b32 v20, a4
  v_mfma_f32_16x16x32_bf16 a[28:31], v[52:55], a[216:219], a[28:31]
  buffer_load_dwordx4 v3, s[12:15], s98 offen offset:3072 sc1 lds
  v_mfma_f32_16x16x32_bf16 a[28:31], v[56:59], a[220:223], a[28:31]
  v_accvgpr_read_b32 v21, a5
  v_accvgpr_read_b32 v22, a6
  v_mfma_f32_16x16x32_bf16 a[36:39], v[52:55], a[224:227], a[36:39]
  v_accvgpr_read_b32 v23, a7
  v_cvt_pk_bf16_f32 v64, v16, v17
  v_mfma_f32_16x16x32_bf16 a[36:39], v[56:59], a[228:231], a[36:39]
  s_add_u32 m0, s65, 65536
  s_add_u32 s98, s66, 65536
  v_cvt_pk_bf16_f32 v65, v18, v19
  v_mfma_f32_16x16x32_bf16 a[44:47], v[52:55], a[232:235], a[44:47]
  v_cvt_pk_bf16_f32 v66, v20, v21
  v_cvt_pk_bf16_f32 v67, v22, v23
  v_mfma_f32_16x16x32_bf16 a[44:47], v[56:59], a[236:239], a[44:47]
  v_mfma_f32_16x16x32_bf16 a[52:55], v[52:55], a[240:243], a[52:55]
  s_add_u32 s60, s79, 0
  buffer_load_dwordx4 v3, s[12:15], s98 offen offset:0 sc1 lds
  v_mfma_f32_16x16x32_bf16 a[52:55], v[56:59], a[244:247], a[52:55]
  buffer_load_dwordx4 a[0:3], v1, s[12:15], s60 offen offset:0 sc1
  v_mfma_f32_16x16x32_bf16 a[60:63], v[52:55], a[248:251], a[60:63]
  buffer_load_dwordx4 a[4:7], v1, s[12:15], s60 offen offset:1024 sc1
  v_mfma_f32_16x16x32_bf16 a[60:63], v[56:59], a[252:255], a[60:63]
  s_waitcnt lgkmcnt(0)
  v_accvgpr_read_b32 v24, a8
  v_accvgpr_read_b32 v25, a9
  v_mfma_f32_16x16x32_bf16 a[64:67], v[44:47], a[192:195], a[64:67]
  v_accvgpr_read_b32 v26, a10
  v_accvgpr_read_b32 v27, a11
  v_mfma_f32_16x16x32_bf16 a[64:67], v[48:51], a[196:199], a[64:67]
  ds_read_b128 v[52:55], v32 offset:38912
  v_accvgpr_read_b32 v28, a12
  v_mfma_f32_16x16x32_bf16 a[72:75], v[44:47], a[200:203], a[72:75]
  buffer_load_dwordx4 v3, s[12:15], s98 offen offset:1024 sc1 lds
  v_mfma_f32_16x16x32_bf16 a[72:75], v[48:51], a[204:207], a[72:75]
  ds_read_b128 v[56:59], v33 offset:38912
  v_accvgpr_read_b32 v29, a13
  v_mfma_f32_16x16x32_bf16 a[80:83], v[44:47], a[208:211], a[80:83]
  v_accvgpr_read_b32 v30, a14
  v_accvgpr_read_b32 v31, a15
  v_mfma_f32_16x16x32_bf16 a[80:83], v[48:51], a[212:215], a[80:83]
  v_cvt_pk_bf16_f32 v68, v24, v25
  v_cvt_pk_bf16_f32 v69, v26, v27
  v_mfma_f32_16x16x32_bf16 a[88:91], v[44:47], a[216:219], a[88:91]
  v_cvt_pk_bf16_f32 v70, v28, v29
  v_cvt_pk_bf16_f32 v71, v30, v31
  v_mfma_f32_16x16x32_bf16 a[88:91], v[48:51], a[220:223], a[88:91]
  buffer_load_dwordx4 v3, s[12:15], s98 offen offset:2048 sc1 lds
  v_mfma_f32_16x16x32_bf16 a[96:99], v[44:47], a[224:227], a[96:99]
  buffer_load_dwordx4 a[8:11], v1, s[12:15], s60 offen offset:2048 sc1
  v_mfma_f32_16x16x32_bf16 a[96:99], v[48:51], a[228:231], a[96:99]
  buffer_load_dwordx4 a[12:15], v1, s[12:15], s60 offen offset:3072 sc1
  v_mfma_f32_16x16x32_bf16 a[104:107], v[44:47], a[232:235], a[104:107]
  buffer_store_dwordx4 v[64:67], v1, s[12:15], s99 offen offset:0
  v_mfma_f32_16x16x32_bf16 a[104:107], v[48:51], a[236:239], a[104:107]
  v_accvgpr_read_b32 v16, a16
  v_accvgpr_read_b32 v17, a17
  v_mfma_f32_16x16x32_bf16 a[112:115], v[44:47], a[240:243], a[112:115]
  buffer_load_dwordx4 v3, s[12:15], s98 offen offset:3072 sc1 lds
  v_mfma_f32_16x16x32_bf16 a[112:115], v[48:51], a[244:247], a[112:115]
  v_accvgpr_read_b32 v18, a18
  v_accvgpr_read_b32 v19, a19
  v_mfma_f32_16x16x32_bf16 a[120:123], v[44:47], a[248:251], a[120:123]
  s_waitcnt vmcnt(21) lgkmcnt(0)
  v_accvgpr_read_b32 v20, a20
  v_accvgpr_read_b32 v21, a21
  v_mfma_f32_16x16x32_bf16 a[120:123], v[48:51], a[252:255], a[120:123]
  s_barrier
  s_add_u32 m0, s65, 49152
  s_add_u32 s98, s66, 32768
  v_mfma_f32_16x16x32_bf16 a[68:71], v[52:55], a[192:195], a[68:71]
  v_accvgpr_read_b32 v22, a22
  v_accvgpr_read_b32 v23, a23
  v_mfma_f32_16x16x32_bf16 a[68:71], v[56:59], a[196:199], a[68:71]
  ds_read_b128 v[44:47], v32 offset:16384
  v_cvt_pk_bf16_f32 v72, v16, v17
  v_mfma_f32_16x16x32_bf16 a[76:79], v[52:55], a[200:203], a[76:79]
  buffer_load_dwordx4 v4, s[12:15], s98 offen offset:0 sc1 lds
  v_mfma_f32_16x16x32_bf16 a[76:79], v[56:59], a[204:207], a[76:79]
  ds_read_b128 v[48:51], v33 offset:16384
  v_cvt_pk_bf16_f32 v73, v18, v19
  v_mfma_f32_16x16x32_bf16 a[84:87], v[52:55], a[208:211], a[84:87]
  v_cvt_pk_bf16_f32 v74, v20, v21
  v_cvt_pk_bf16_f32 v75, v22, v23
  v_mfma_f32_16x16x32_bf16 a[84:87], v[56:59], a[212:215], a[84:87]
  s_add_u32 s60, s79, 4096
  buffer_load_dwordx4 a[16:19], v1, s[12:15], s60 offen offset:0 sc1
  v_mfma_f32_16x16x32_bf16 a[92:95], v[52:55], a[216:219], a[92:95]
  buffer_load_dwordx4 a[20:23], v1, s[12:15], s60 offen offset:1024 sc1
  v_mfma_f32_16x16x32_bf16 a[92:95], v[56:59], a[220:223], a[92:95]
  buffer_store_dwordx4 v[68:71], v1, s[12:15], s99 offen offset:1024
  v_mfma_f32_16x16x32_bf16 a[100:103], v[52:55], a[224:227], a[100:103]
  v_accvgpr_read_b32 v24, a24
  v_accvgpr_read_b32 v25, a25
  v_mfma_f32_16x16x32_bf16 a[100:103], v[56:59], a[228:231], a[100:103]
  v_accvgpr_read_b32 v26, a26
  v_accvgpr_read_b32 v27, a27
  v_mfma_f32_16x16x32_bf16 a[108:111], v[52:55], a[232:235], a[108:111]
  buffer_load_dwordx4 v4, s[12:15], s98 offen offset:1024 sc1 lds
  v_mfma_f32_16x16x32_bf16 a[108:111], v[56:59], a[236:239], a[108:111]
  v_accvgpr_read_b32 v28, a28
  v_accvgpr_read_b32 v29, a29
  v_mfma_f32_16x16x32_bf16 a[116:119], v[52:55], a[240:243], a[116:119]
  v_accvgpr_read_b32 v30, a30
  v_accvgpr_read_b32 v31, a31
  v_mfma_f32_16x16x32_bf16 a[116:119], v[56:59], a[244:247], a[116:119]
  v_cvt_pk_bf16_f32 v76, v24, v25
  v_cvt_pk_bf16_f32 v77, v26, v27
  v_mfma_f32_16x16x32_bf16 a[124:127], v[52:55], a[248:251], a[124:127]
  v_cvt_pk_bf16_f32 v78, v28, v29
  v_cvt_pk_bf16_f32 v79, v30, v31
  v_mfma_f32_16x16x32_bf16 a[124:127], v[56:59], a[252:255], a[124:127]
  s_waitcnt lgkmcnt(0)
  buffer_load_dwordx4 a[24:27], v1, s[12:15], s60 offen offset:2048 sc1
  v_mfma_f32_16x16x32_bf16 v[128:131], v[44:47], a[128:131], v[128:131]
  s_add_u32 s60, s79, 57344
  buffer_load_dwordx4 a[28:31], v1, s[12:15], s60 offen offset:0 sc1
  v_mfma_f32_16x16x32_bf16 v[128:131], v[48:51], a[132:135], v[128:131]
  ds_read_b128 v[52:55], v32 offset:18432
  ds_write_b32 v42, v12
  v_mfma_f32_16x16x32_bf16 v[136:139], v[44:47], a[136:139], v[136:139]
  buffer_load_dwordx4 v4, s[12:15], s98 offen offset:2048 sc1 lds
  v_mfma_f32_16x16x32_bf16 v[136:139], v[48:51], a[140:143], v[136:139]
  ds_read_b128 v[56:59], v33 offset:18432
  v_mfma_f32_16x16x32_bf16 v[144:147], v[44:47], a[144:147], v[144:147]
  buffer_store_dwordx4 v[72:75], v1, s[12:15], s99 offen offset:2048
  v_mfma_f32_16x16x32_bf16 v[144:147], v[48:51], a[148:151], v[144:147]
  v_accvgpr_read_b32 v16, a32
  v_accvgpr_read_b32 v17, a33
  v_mfma_f32_16x16x32_bf16 v[152:155], v[44:47], a[152:155], v[152:155]
  v_accvgpr_read_b32 v18, a34
  v_accvgpr_read_b32 v19, a35
  v_mfma_f32_16x16x32_bf16 v[152:155], v[48:51], a[156:159], v[152:155]
  v_accvgpr_read_b32 v20, a36
  v_accvgpr_read_b32 v21, a37
  v_mfma_f32_16x16x32_bf16 v[160:163], v[44:47], a[160:163], v[160:163]
  v_accvgpr_read_b32 v22, a38
  v_accvgpr_read_b32 v23, a39
  v_mfma_f32_16x16x32_bf16 v[160:163], v[48:51], a[164:167], v[160:163]
  v_cvt_pk_bf16_f32 v80, v16, v17
  v_cvt_pk_bf16_f32 v81, v18, v19
  v_mfma_f32_16x16x32_bf16 v[168:171], v[44:47], a[168:171], v[168:171]
  buffer_load_dwordx4 v4, s[12:15], s98 offen offset:3072 sc1 lds
  v_mfma_f32_16x16x32_bf16 v[168:171], v[48:51], a[172:175], v[168:171]
  v_cvt_pk_bf16_f32 v82, v20, v21
  v_cvt_pk_bf16_f32 v83, v22, v23
  v_mfma_f32_16x16x32_bf16 v[176:179], v[44:47], a[176:179], v[176:179]
  buffer_load_dwordx4 a[32:35], v1, s[12:15], s60 offen offset:1024 sc1
  v_mfma_f32_16x16x32_bf16 v[176:179], v[48:51], a[180:183], v[176:179]
  buffer_load_dwordx4 a[36:39], v1, s[12:15], s60 offen offset:2048 sc1
  v_mfma_f32_16x16x32_bf16 v[184:187], v[44:47], a[184:187], v[184:187]
  buffer_store_dwordx4 v[76:79], v1, s[12:15], s99 offen offset:3072
  v_mfma_f32_16x16x32_bf16 v[184:187], v[48:51], a[188:191], v[184:187]
  s_waitcnt lgkmcnt(0)
  s_add_u32 m0, s65, 98304
  s_add_u32 s98, s66, 98304
  v_mfma_f32_16x16x32_bf16 v[132:135], v[52:55], a[128:131], v[132:135]
  s_add_u32 s99, s99, 32768
  v_accvgpr_read_b32 v24, a40
  v_accvgpr_read_b32 v25, a41
  v_mfma_f32_16x16x32_bf16 v[132:135], v[56:59], a[132:135], v[132:135]
  ds_read_b128 v[44:47], v32 offset:20480
  v_accvgpr_read_b32 v26, a42
  v_mfma_f32_16x16x32_bf16 v[140:143], v[52:55], a[136:139], v[140:143]
  buffer_load_dwordx4 v3, s[12:15], s98 offen offset:0 sc1 lds
  v_mfma_f32_16x16x32_bf16 v[140:143], v[56:59], a[140:143], v[140:143]
  ds_read_b128 v[48:51], v33 offset:20480
  v_accvgpr_read_b32 v27, a43
  v_mfma_f32_16x16x32_bf16 v[148:151], v[52:55], a[144:147], v[148:151]
  v_accvgpr_read_b32 v28, a44
  v_accvgpr_read_b32 v29, a45
  v_mfma_f32_16x16x32_bf16 v[148:151], v[56:59], a[148:151], v[148:151]
  v_accvgpr_read_b32 v30, a46
  v_accvgpr_read_b32 v31, a47
  v_mfma_f32_16x16x32_bf16 v[156:159], v[52:55], a[152:155], v[156:159]
  v_cvt_pk_bf16_f32 v84, v24, v25
  v_cvt_pk_bf16_f32 v85, v26, v27
  v_mfma_f32_16x16x32_bf16 v[156:159], v[56:59], a[156:159], v[156:159]
  v_cvt_pk_bf16_f32 v86, v28, v29
  v_cvt_pk_bf16_f32 v87, v30, v31
  v_mfma_f32_16x16x32_bf16 v[164:167], v[52:55], a[160:163], v[164:167]
  buffer_load_dwordx4 a[40:43], v1, s[12:15], s60 offen offset:3072 sc1
  v_mfma_f32_16x16x32_bf16 v[164:167], v[56:59], a[164:167], v[164:167]
  s_add_u32 s60, s79, 61440
  buffer_load_dwordx4 a[44:47], v1, s[12:15], s60 offen offset:0 sc1
  v_mfma_f32_16x16x32_bf16 v[172:175], v[52:55], a[168:171], v[172:175]
  buffer_load_dwordx4 v3, s[12:15], s98 offen offset:1024 sc1 lds
  v_mfma_f32_16x16x32_bf16 v[172:175], v[56:59], a[172:175], v[172:175]
  v_accvgpr_read_b32 v16, a48
  v_accvgpr_read_b32 v17, a49
  v_mfma_f32_16x16x32_bf16 v[180:183], v[52:55], a[176:179], v[180:183]
  v_accvgpr_read_b32 v18, a50
  v_accvgpr_read_b32 v19, a51
  v_mfma_f32_16x16x32_bf16 v[180:183], v[56:59], a[180:183], v[180:183]
  v_accvgpr_read_b32 v20, a52
  v_accvgpr_read_b32 v21, a53
  v_mfma_f32_16x16x32_bf16 v[188:191], v[52:55], a[184:187], v[188:191]
  v_accvgpr_read_b32 v22, a54
  v_accvgpr_read_b32 v23, a55
  v_mfma_f32_16x16x32_bf16 v[188:191], v[56:59], a[188:191], v[188:191]
  s_waitcnt lgkmcnt(0)
  v_cvt_pk_bf16_f32 v88, v16, v17
  v_cvt_pk_bf16_f32 v89, v18, v19
  v_mfma_f32_16x16x32_bf16 v[192:195], v[44:47], a[128:131], v[192:195]
  v_cvt_pk_bf16_f32 v90, v20, v21
  v_cvt_pk_bf16_f32 v91, v22, v23
  v_mfma_f32_16x16x32_bf16 v[192:195], v[48:51], a[132:135], v[192:195]
  ds_read_b128 v[52:55], v32 offset:22528
  v_mfma_f32_16x16x32_bf16 v[200:203], v[44:47], a[136:139], v[200:203]
  buffer_load_dwordx4 v3, s[12:15], s98 offen offset:2048 sc1 lds
  v_mfma_f32_16x16x32_bf16 v[200:203], v[48:51], a[140:143], v[200:203]
  ds_read_b128 v[56:59], v33 offset:22528
  v_mfma_f32_16x16x32_bf16 v[208:211], v[44:47], a[144:147], v[208:211]
  buffer_load_dwordx4 a[48:51], v1, s[12:15], s60 offen offset:1024 sc1
  v_mfma_f32_16x16x32_bf16 v[208:211], v[48:51], a[148:151], v[208:211]
  buffer_load_dwordx4 a[52:55], v1, s[12:15], s60 offen offset:2048 sc1
  v_mfma_f32_16x16x32_bf16 v[216:219], v[44:47], a[152:155], v[216:219]
  buffer_store_dwordx4 v[80:83], v1, s[12:15], s100 offen offset:0
  v_mfma_f32_16x16x32_bf16 v[216:219], v[48:51], a[156:159], v[216:219]
  v_accvgpr_read_b32 v24, a56
  v_accvgpr_read_b32 v25, a57
  v_mfma_f32_16x16x32_bf16 v[224:227], v[44:47], a[160:163], v[224:227]
  v_accvgpr_read_b32 v26, a58
  v_accvgpr_read_b32 v27, a59
  v_mfma_f32_16x16x32_bf16 v[224:227], v[48:51], a[164:167], v[224:227]
  v_accvgpr_read_b32 v28, a60
  v_accvgpr_read_b32 v29, a61
  v_mfma_f32_16x16x32_bf16 v[232:235], v[44:47], a[168:171], v[232:235]
  buffer_load_dwordx4 v3, s[12:15], s98 offen offset:3072 sc1 lds
  v_mfma_f32_16x16x32_bf16 v[232:235], v[48:51], a[172:175], v[232:235]
  v_accvgpr_read_b32 v30, a62
  v_accvgpr_read_b32 v31, a63
  v_mfma_f32_16x16x32_bf16 v[240:243], v[44:47], a[176:179], v[240:243]
  v_cvt_pk_bf16_f32 v92, v24, v25
  v_cvt_pk_bf16_f32 v93, v26, v27
  v_mfma_f32_16x16x32_bf16 v[240:243], v[48:51], a[180:183], v[240:243]
  v_cvt_pk_bf16_f32 v94, v28, v29
  v_cvt_pk_bf16_f32 v95, v30, v31
  v_mfma_f32_16x16x32_bf16 v[248:251], v[44:47], a[184:187], v[248:251]
  s_waitcnt vmcnt(40) lgkmcnt(0)
  v_mfma_f32_16x16x32_bf16 v[248:251], v[48:51], a[188:191], v[248:251]
  s_barrier
  v_mfma_f32_16x16x32_bf16 v[196:199], v[52:55], a[128:131], v[196:199]
  s_add_u32 s60, s79, 7168
  buffer_load_dwordx4 a[56:59], v1, s[12:15], s60 offen offset:0 sc1
  v_mfma_f32_16x16x32_bf16 v[196:199], v[56:59], a[132:135], v[196:199]
  s_add_u32 m0, s65, 81920
  ds_read_b128 v[44:47], v32 offset:49152
  s_add_u32 s98, s66, 65536
  v_mfma_f32_16x16x32_bf16 v[204:207], v[52:55], a[136:139], v[204:207]
  buffer_load_dwordx4 a[60:63], v1, s[12:15], s60 offen offset:1024 sc1
  v_mfma_f32_16x16x32_bf16 v[204:207], v[56:59], a[140:143], v[204:207]
  ds_read_b128 v[48:51], v33 offset:49152
  ds_read_b32 v12, v6
  v_mfma_f32_16x16x32_bf16 v[212:215], v[52:55], a[144:147], v[212:215]
  buffer_load_dwordx4 v4, s[12:15], s98 offen offset:0 sc1 lds
  v_mfma_f32_16x16x32_bf16 v[212:215], v[56:59], a[148:151], v[212:215]
  buffer_store_dwordx4 v[84:87], v1, s[12:15], s100 offen offset:1024
  v_mfma_f32_16x16x32_bf16 v[220:223], v[52:55], a[152:155], v[220:223]
  v_accvgpr_read_b32 v16, a64
  v_accvgpr_read_b32 v17, a65
  v_mfma_f32_16x16x32_bf16 v[220:223], v[56:59], a[156:159], v[220:223]
  v_accvgpr_read_b32 v18, a66
  v_accvgpr_read_b32 v19, a67
  v_mfma_f32_16x16x32_bf16 v[228:231], v[52:55], a[160:163], v[228:231]
  v_accvgpr_read_b32 v20, a68
  v_accvgpr_read_b32 v21, a69
  v_mfma_f32_16x16x32_bf16 v[228:231], v[56:59], a[164:167], v[228:231]
  v_accvgpr_read_b32 v22, a70
  v_accvgpr_read_b32 v23, a71
  v_mfma_f32_16x16x32_bf16 v[236:239], v[52:55], a[168:171], v[236:239]
  v_cvt_pk_bf16_f32 v96, v16, v17
  v_cvt_pk_bf16_f32 v97, v18, v19
  v_mfma_f32_16x16x32_bf16 v[236:239], v[56:59], a[172:175], v[236:239]
  v_cvt_pk_bf16_f32 v98, v20, v21
  v_cvt_pk_bf16_f32 v99, v22, v23
  v_mfma_f32_16x16x32_bf16 v[244:247], v[52:55], a[176:179], v[244:247]
  buffer_load_dwordx4 a[64:67], v1, s[12:15], s60 offen offset:2048 sc1
  v_mfma_f32_16x16x32_bf16 v[244:247], v[56:59], a[180:183], v[244:247]
  buffer_load_dwordx4 a[68:71], v1, s[12:15], s60 offen offset:3072 sc1
  v_mfma_f32_16x16x32_bf16 v[252:255], v[52:55], a[184:187], v[252:255]
  buffer_store_dwordx4 v[88:91], v1, s[12:15], s100 offen offset:2048
  v_mfma_f32_16x16x32_bf16 v[252:255], v[56:59], a[188:191], v[252:255]
  s_waitcnt lgkmcnt(1)
  v_accvgpr_read_b32 v24, a72
  v_accvgpr_read_b32 v25, a73
  v_mfma_f32_16x16x32_bf16 v[128:131], v[44:47], a[192:195], v[128:131]
  v_accvgpr_read_b32 v26, a74
  v_accvgpr_read_b32 v27, a75
  v_mfma_f32_16x16x32_bf16 v[128:131], v[48:51], a[196:199], v[128:131]
  ds_read_b128 v[52:55], v32 offset:51200
  v_accvgpr_read_b32 v28, a76
  v_mfma_f32_16x16x32_bf16 v[136:139], v[44:47], a[200:203], v[136:139]
  v_accvgpr_read_b32 v29, a77
  v_accvgpr_read_b32 v30, a78
  v_mfma_f32_16x16x32_bf16 v[136:139], v[48:51], a[204:207], v[136:139]
  ds_read_b128 v[56:59], v33 offset:51200
  v_accvgpr_read_b32 v31, a79
  v_mfma_f32_16x16x32_bf16 v[144:147], v[44:47], a[208:211], v[144:147]
  buffer_load_dwordx4 v4, s[12:15], s98 offen offset:1024 sc1 lds
  v_mfma_f32_16x16x32_bf16 v[144:147], v[48:51], a[212:215], v[144:147]
  v_cvt_pk_bf16_f32 v100, v24, v25
  v_cvt_pk_bf16_f32 v101, v26, v27
  v_mfma_f32_16x16x32_bf16 v[152:155], v[44:47], a[216:219], v[152:155]
  v_cvt_pk_bf16_f32 v102, v28, v29
  v_cvt_pk_bf16_f32 v103, v30, v31
  v_mfma_f32_16x16x32_bf16 v[152:155], v[48:51], a[220:223], v[152:155]
  v_mfma_f32_16x16x32_bf16 v[160:163], v[44:47], a[224:227], v[160:163]
  s_add_u32 s60, s79, 11264
  buffer_load_dwordx4 a[72:75], v1, s[12:15], s60 offen offset:0 sc1
  v_mfma_f32_16x16x32_bf16 v[160:163], v[48:51], a[228:231], v[160:163]
  buffer_load_dwordx4 a[76:79], v1, s[12:15], s60 offen offset:1024 sc1
  v_mfma_f32_16x16x32_bf16 v[168:171], v[44:47], a[232:235], v[168:171]
  buffer_store_dwordx4 v[92:95], v1, s[12:15], s100 offen offset:3072
  v_mfma_f32_16x16x32_bf16 v[168:171], v[48:51], a[236:239], v[168:171]
  v_mfma_f32_16x16x32_bf16 v[176:179], v[44:47], a[240:243], v[176:179]
  s_add_u32 s100, s100, 32768
  v_accvgpr_read_b32 v16, a80
  v_accvgpr_read_b32 v17, a81
  v_mfma_f32_16x16x32_bf16 v[176:179], v[48:51], a[244:247], v[176:179]
  v_accvgpr_read_b32 v18, a82
  v_accvgpr_read_b32 v19, a83
  v_mfma_f32_16x16x32_bf16 v[184:187], v[44:47], a[248:251], v[184:187]
  v_accvgpr_read_b32 v20, a84
  v_accvgpr_read_b32 v21, a85
  v_mfma_f32_16x16x32_bf16 v[184:187], v[48:51], a[252:255], v[184:187]
  s_waitcnt lgkmcnt(0)
  v_accvgpr_read_b32 v22, a86
  v_accvgpr_read_b32 v23, a87
  v_mfma_f32_16x16x32_bf16 v[132:135], v[52:55], a[192:195], v[132:135]
  v_cvt_pk_bf16_f32 v104, v16, v17
  v_cvt_pk_bf16_f32 v105, v18, v19
  v_mfma_f32_16x16x32_bf16 v[132:135], v[56:59], a[196:199], v[132:135]
  ds_read_b128 v[44:47], v32 offset:53248
  v_cvt_pk_bf16_f32 v106, v20, v21
  v_mfma_f32_16x16x32_bf16 v[140:143], v[52:55], a[200:203], v[140:143]
  v_cvt_pk_bf16_f32 v107, v22, v23
  v_mfma_f32_16x16x32_bf16 v[140:143], v[56:59], a[204:207], v[140:143]
  ds_read_b128 v[48:51], v33 offset:53248
  v_cvt_pk_bf16_f32 v128, v128, v129
  v_mfma_f32_16x16x32_bf16 v[148:151], v[52:55], a[208:211], v[148:151]
  buffer_load_dwordx4 v4, s[12:15], s98 offen offset:2048 sc1 lds
  v_mfma_f32_16x16x32_bf16 v[148:151], v[56:59], a[212:215], v[148:151]
  buffer_load_dwordx4 a[80:83], v1, s[12:15], s60 offen offset:2048 sc1
  v_mfma_f32_16x16x32_bf16 v[156:159], v[52:55], a[216:219], v[156:159]
  v_accvgpr_read_b32 v24, a88
  v_accvgpr_read_b32 v25, a89
  v_mfma_f32_16x16x32_bf16 v[156:159], v[56:59], a[220:223], v[156:159]
  v_accvgpr_read_b32 v26, a90
  v_accvgpr_read_b32 v27, a91
  v_mfma_f32_16x16x32_bf16 v[164:167], v[52:55], a[224:227], v[164:167]
  v_accvgpr_read_b32 v28, a92
  v_accvgpr_read_b32 v29, a93
  v_mfma_f32_16x16x32_bf16 v[164:167], v[56:59], a[228:231], v[164:167]
  v_accvgpr_read_b32 v30, a94
  v_accvgpr_read_b32 v31, a95
  v_mfma_f32_16x16x32_bf16 v[172:175], v[52:55], a[232:235], v[172:175]
  v_cvt_pk_bf16_f32 v108, v24, v25
  v_cvt_pk_bf16_f32 v109, v26, v27
  v_mfma_f32_16x16x32_bf16 v[172:175], v[56:59], a[236:239], v[172:175]
  v_cvt_pk_bf16_f32 v110, v28, v29
  v_cvt_pk_bf16_f32 v111, v30, v31
  v_mfma_f32_16x16x32_bf16 v[180:183], v[52:55], a[240:243], v[180:183]
  buffer_store_dwordx4 v[96:99], v1, s[12:15], s99 offen offset:0
  v_mfma_f32_16x16x32_bf16 v[180:183], v[56:59], a[244:247], v[180:183]
  v_accvgpr_read_b32 v16, a96
  v_accvgpr_read_b32 v17, a97
  v_mfma_f32_16x16x32_bf16 v[188:191], v[52:55], a[248:251], v[188:191]
  v_accvgpr_read_b32 v18, a98
  v_accvgpr_read_b32 v19, a99
  v_mfma_f32_16x16x32_bf16 v[188:191], v[56:59], a[252:255], v[188:191]
  s_waitcnt lgkmcnt(0)
  v_accvgpr_read_b32 v20, a100
  v_accvgpr_read_b32 v21, a101
  v_mfma_f32_16x16x32_bf16 v[192:195], v[44:47], a[192:195], v[192:195]
  v_accvgpr_read_b32 v22, a102
  v_accvgpr_read_b32 v23, a103
  v_mfma_f32_16x16x32_bf16 v[192:195], v[48:51], a[196:199], v[192:195]
  s_mov_b32 s67, 0
  ds_read_b128 v[52:55], v32 offset:55296
  v_cvt_pk_bf16_f32 v112, v16, v17
  v_mfma_f32_16x16x32_bf16 v[200:203], v[44:47], a[200:203], v[200:203]
  v_cvt_pk_bf16_f32 v113, v18, v19
  v_cvt_pk_bf16_f32 v114, v20, v21
  v_mfma_f32_16x16x32_bf16 v[200:203], v[48:51], a[204:207], v[200:203]
  ds_read_b128 v[56:59], v33 offset:55296
  v_cvt_pk_bf16_f32 v115, v22, v23
  v_mfma_f32_16x16x32_bf16 v[208:211], v[44:47], a[208:211], v[208:211]
  buffer_load_dwordx4 v4, s[12:15], s98 offen offset:3072 sc1 lds
  v_mfma_f32_16x16x32_bf16 v[208:211], v[48:51], a[212:215], v[208:211]
  buffer_store_dwordx4 v[100:103], v1, s[12:15], s99 offen offset:1024
  v_mfma_f32_16x16x32_bf16 v[216:219], v[44:47], a[216:219], v[216:219]
  v_accvgpr_read_b32 v24, a104
  v_accvgpr_read_b32 v25, a105
  v_mfma_f32_16x16x32_bf16 v[216:219], v[48:51], a[220:223], v[216:219]
  v_cvt_pk_bf16_f32 v129, v130, v131
  v_accvgpr_read_b32 v26, a106
  v_mfma_f32_16x16x32_bf16 v[224:227], v[44:47], a[224:227], v[224:227]
  v_cvt_pk_bf16_f32 v130, v132, v133
  v_accvgpr_read_b32 v27, a107
  v_mfma_f32_16x16x32_bf16 v[224:227], v[48:51], a[228:231], v[224:227]
  v_cvt_pk_bf16_f32 v131, v134, v135
  v_accvgpr_read_b32 v28, a108
  v_mfma_f32_16x16x32_bf16 v[232:235], v[44:47], a[232:235], v[232:235]
  v_cvt_pk_bf16_f32 v132, v136, v137
  v_accvgpr_read_b32 v29, a109
  v_mfma_f32_16x16x32_bf16 v[232:235], v[48:51], a[236:239], v[232:235]
  v_cvt_pk_bf16_f32 v133, v138, v139
  v_accvgpr_read_b32 v30, a110
  v_mfma_f32_16x16x32_bf16 v[240:243], v[44:47], a[240:243], v[240:243]
  v_cvt_pk_bf16_f32 v134, v140, v141
  v_accvgpr_read_b32 v31, a111
  v_mfma_f32_16x16x32_bf16 v[240:243], v[48:51], a[244:247], v[240:243]
  v_cvt_pk_bf16_f32 v135, v142, v143
  v_cvt_pk_bf16_f32 v116, v24, v25
  v_mfma_f32_16x16x32_bf16 v[248:251], v[44:47], a[248:251], v[248:251]
  s_waitcnt vmcnt(38) lgkmcnt(0)
  v_cvt_pk_bf16_f32 v136, v144, v145
  v_cvt_pk_bf16_f32 v117, v26, v27
  v_mfma_f32_16x16x32_bf16 v[248:251], v[48:51], a[252:255], v[248:251]
  s_barrier
  v_add_u32 v5, s67, v1
  v_cvt_pk_bf16_f32 v137, v146, v147
  v_mfma_f32_16x16x32_bf16 v[196:199], v[52:55], a[192:195], v[196:199]
  s_add_u32 m0, s65, 114688
  v_cvt_pk_bf16_f32 v118, v28, v29
  v_cvt_pk_bf16_f32 v138, v148, v149
  v_mfma_f32_16x16x32_bf16 v[196:199], v[56:59], a[196:199], v[196:199]
  s_add_u32 s98, s66, 98304
  v_cvt_pk_bf16_f32 v119, v30, v31
  v_cvt_pk_bf16_f32 v139, v150, v151
  v_mfma_f32_16x16x32_bf16 v[204:207], v[52:55], a[200:203], v[204:207]
  ds_read_b128 a[128:131], v5 offset:0
  v_cvt_pk_bf16_f32 v140, v152, v153
  v_mfma_f32_16x16x32_bf16 v[204:207], v[56:59], a[204:207], v[204:207]
  buffer_load_dwordx4 v4, s[12:15], s98 offen offset:0 sc1 lds
  ds_read_b128 a[132:135], v5 offset:1024
  v_mfma_f32_16x16x32_bf16 v[212:215], v[52:55], a[208:211], v[212:215]
  buffer_store_dwordx4 v[104:107], v1, s[12:15], s99 offen offset:2048
  v_mfma_f32_16x16x32_bf16 v[212:215], v[56:59], a[212:215], v[212:215]
  ds_read_b128 a[136:139], v5 offset:2048
  v_cvt_pk_bf16_f32 v141, v154, v155
  v_mfma_f32_16x16x32_bf16 v[220:223], v[52:55], a[216:219], v[220:223]
  s_mov_b32 s66, s98
  ds_read_b128 a[140:143], v5 offset:3072
  v_accvgpr_read_b32 v16, a112
  v_mfma_f32_16x16x32_bf16 v[220:223], v[56:59], a[220:223], v[220:223]
  v_cvt_pk_bf16_f32 v142, v156, v157
  v_accvgpr_read_b32 v17, a113
  v_mfma_f32_16x16x32_bf16 v[228:231], v[52:55], a[224:227], v[228:231]
  ds_read_b128 a[144:147], v5 offset:4096
  v_cvt_pk_bf16_f32 v143, v158, v159
  v_mfma_f32_16x16x32_bf16 v[228:231], v[56:59], a[228:231], v[228:231]
  ds_read_b128 a[148:151], v5 offset:5120
  v_accvgpr_read_b32 v18, a114
  v_readfirstlane_b32 s56, v12
  v_mfma_f32_16x16x32_bf16 v[236:239], v[52:55], a[232:235], v[236:239]
  v_cvt_pk_bf16_f32 v160, v160, v161
  v_accvgpr_read_b32 v19, a115
  v_mfma_f32_16x16x32_bf16 v[236:239], v[56:59], a[236:239], v[236:239]
  buffer_load_dwordx4 v4, s[12:15], s98 offen offset:1024 sc1 lds
  ds_read_b128 a[152:155], v5 offset:6144
  v_mfma_f32_16x16x32_bf16 v[244:247], v[52:55], a[240:243], v[244:247]
  ds_read_b128 a[156:159], v5 offset:7168
  v_cvt_pk_bf16_f32 v161, v162, v163
  v_mfma_f32_16x16x32_bf16 v[244:247], v[56:59], a[244:247], v[244:247]
  v_accvgpr_read_b32 v20, a116
  v_cvt_pk_bf16_f32 v162, v164, v165
  v_mfma_f32_16x16x32_bf16 v[252:255], v[52:55], a[248:251], v[252:255]
  ds_read_b128 a[160:163], v5 offset:8192
  ds_read_b128 a[164:167], v5 offset:9216
  v_cvt_pk_bf16_f32 v163, v166, v167
  v_cvt_pk_bf16_f32 v164, v168, v169
  v_cvt_pk_bf16_f32 v165, v170, v171
  v_cvt_pk_bf16_f32 v166, v172, v173
  v_cvt_pk_bf16_f32 v167, v174, v175
  v_cvt_pk_bf16_f32 v168, v176, v177
  v_cvt_pk_bf16_f32 v169, v178, v179
  v_cvt_pk_bf16_f32 v170, v180, v181
  v_cvt_pk_bf16_f32 v171, v182, v183
  v_cvt_pk_bf16_f32 v172, v184, v185
  v_cvt_pk_bf16_f32 v173, v186, v187
  v_cvt_pk_bf16_f32 v174, v188, v189
  v_cvt_pk_bf16_f32 v175, v190, v191
  v_cvt_pk_bf16_f32 v192, v192, v193
  v_cvt_pk_bf16_f32 v193, v194, v195
  v_cvt_pk_bf16_f32 v194, v196, v197
  v_cvt_pk_bf16_f32 v195, v198, v199
  v_cvt_pk_bf16_f32 v196, v200, v201
  v_cvt_pk_bf16_f32 v197, v202, v203
  v_cvt_pk_bf16_f32 v198, v204, v205
  v_cvt_pk_bf16_f32 v199, v206, v207
  v_mfma_f32_16x16x32_bf16 v[252:255], v[56:59], a[252:255], v[252:255]
  v_accvgpr_read_b32 v21, a117
  v_accvgpr_read_b32 v22, a118
  v_accvgpr_read_b32 v23, a119
  v_cvt_pk_bf16_f32 v120, v16, v17
  v_cvt_pk_bf16_f32 v121, v18, v19
  v_cvt_pk_bf16_f32 v122, v20, v21
  v_cvt_pk_bf16_f32 v123, v22, v23
  buffer_store_dwordx4 v[108:111], v1, s[12:15], s99 offen offset:3072
  s_add_u32 s99, s99, 1015808
  v_accvgpr_read_b32 v24, a120
  v_accvgpr_read_b32 v25, a121
  v_accvgpr_read_b32 v26, a122
  v_accvgpr_read_b32 v27, a123
  v_accvgpr_read_b32 v28, a124
  v_accvgpr_read_b32 v29, a125
  v_accvgpr_read_b32 v30, a126
  v_accvgpr_read_b32 v31, a127
  v_cvt_pk_bf16_f32 v124, v24, v25
  v_cvt_pk_bf16_f32 v125, v26, v27
  v_cvt_pk_bf16_f32 v126, v28, v29
  v_cvt_pk_bf16_f32 v127, v30, v31
  buffer_store_dwordx4 v[112:115], v1, s[12:15], s100 offen offset:0
L_kf_kernel_ip_2:
  s_waitcnt lgkmcnt(9)
  v_mfma_f32_16x16x32_bf16 v[144:147], a[128:131], a[0:3], 0
  s_mov_b32 s4, s74
  ds_read_b128 a[168:171], v5 offset:10240
  s_waitcnt lgkmcnt(9)
  v_mfma_f32_16x16x32_bf16 v[144:147], a[132:135], a[4:7], v[144:147]
  s_mov_b32 s5, s3
  s_waitcnt lgkmcnt(8)
  v_mfma_f32_16x16x32_bf16 v[144:147], a[136:139], a[8:11], v[144:147]
  s_add_u32 s60, s79, 64512
  ds_read_b128 a[172:175], v5 offset:11264
  v_cvt_pk_bf16_f32 v200, v208, v209
  s_waitcnt lgkmcnt(8)
  v_mfma_f32_16x16x32_bf16 v[144:147], a[140:143], a[12:15], v[144:147]
  s_waitcnt vmcnt(36) lgkmcnt(5)
  buffer_load_dwordx4 a[84:87], v1, s[12:15], s60 offen offset:0 sc1
  v_mfma_f32_16x16x32_bf16 v[144:147], a[144:147], a[16:19], v[144:147]
  s_mov_b32 s6, 1835008
  ds_read_b128 a[176:179], v5 offset:12288
  v_cvt_pk_bf16_f32 v201, v210, v211
  v_mfma_f32_16x16x32_bf16 v[144:147], a[148:151], a[20:23], v[144:147]
  s_mov_b32 s8, s58
  v_cvt_pk_bf16_f32 v202, v212, v213
  v_cvt_pk_bf16_f32 v203, v214, v215
  v_mfma_f32_16x16x32_bf16 v[144:147], a[152:155], a[24:27], v[144:147]
  s_mov_b32 s9, s59
  ds_read_b128 a[180:183], v5 offset:13312
  v_cvt_pk_bf16_f32 v204, v216, v217
  v_mfma_f32_16x16x32_bf16 v[148:151], a[128:131], a[28:31], 0
  s_waitcnt vmcnt(28)
  buffer_load_dwordx4 a[88:91], v1, s[12:15], s60 offen offset:1024 sc1
  v_mfma_f32_16x16x32_bf16 v[148:151], a[132:135], a[32:35], v[148:151]
  s_mov_b32 s10, 1835008
  ds_read_b128 a[184:187], v5 offset:14336
  v_cvt_pk_bf16_f32 v205, v218, v219
  v_mfma_f32_16x16x32_bf16 v[148:151], a[136:139], a[36:39], v[148:151]
  s_mov_b32 s20, s52
  buffer_load_dwordx4 v4, s[12:15], s66 offen offset:2048 sc1 lds
  v_mfma_f32_16x16x32_bf16 v[148:151], a[140:143], a[40:43], v[148:151]
  s_mov_b32 s21, s53
  ds_read_b128 a[188:191], v5 offset:15360
  v_cvt_pk_bf16_f32 v206, v220, v221
  v_mfma_f32_16x16x32_bf16 v[148:151], a[144:147], a[44:47], v[148:151]
  s_waitcnt vmcnt(26) lgkmcnt(7)
  buffer_store_dwordx4 v[116:119], v1, s[12:15], s100 offen offset:1024
  v_mfma_f32_16x16x32_bf16 v[148:151], a[148:151], a[48:51], v[148:151]
  s_mov_b32 s22, 896
  ds_read_b128 a[128:131], v5 offset:16384
  v_cvt_pk_bf16_f32 v207, v222, v223
  v_mfma_f32_16x16x32_bf16 v[148:151], a[152:155], a[52:55], v[148:151]
  s_bfe_u32 s70, s32, 0x80008
  buffer_load_dwordx4 a[92:95], v1, s[12:15], s60 offen offset:2048 sc1
  v_mfma_f32_16x16x32_bf16 v[152:155], a[156:159], a[0:3], 0
  s_lshr_b32 s71, s32, 16
  ds_read_b128 a[132:135], v5 offset:17408
  v_cvt_pk_bf16_f32 v224, v224, v225
  v_mfma_f32_16x16x32_bf16 v[152:155], a[160:163], a[4:7], v[152:155]
  s_waitcnt lgkmcnt(5)
  v_cvt_pk_bf16_f32 v225, v226, v227
  v_cvt_pk_bf16_f32 v226, v228, v229
  v_mfma_f32_16x16x32_bf16 v[152:155], a[164:167], a[8:11], v[152:155]
  s_mul_i32 s73, s68, 4096
  ds_read_b128 a[136:139], v5 offset:18432
  v_cvt_pk_bf16_f32 v227, v230, v231
  v_mfma_f32_16x16x32_bf16 v[152:155], a[168:171], a[12:15], v[152:155]
  s_mul_i32 s96, s69, 2637824
  v_cvt_pk_bf16_f32 v228, v232, v233
  v_cvt_pk_bf16_f32 v229, v234, v235
  v_mfma_f32_16x16x32_bf16 v[152:155], a[172:175], a[16:19], v[152:155]
  s_add_u32 s73, s73, s96
  ds_read_b128 a[140:143], v5 offset:19456
  v_cvt_pk_bf16_f32 v230, v236, v237
  v_mfma_f32_16x16x32_bf16 v[152:155], a[176:179], a[20:23], v[152:155]
  s_waitcnt lgkmcnt(6)
  buffer_load_dwordx4 a[96:99], v1, s[12:15], s60 offen offset:3072 sc1
  v_mfma_f32_16x16x32_bf16 v[152:155], a[180:183], a[24:27], v[152:155]
  s_add_u32 s73, s73, 51380224
  ds_read_b128 a[144:147], v5 offset:20480
  v_cvt_pk_bf16_f32 v231, v238, v239
  v_mfma_f32_16x16x32_bf16 v[156:159], a[156:159], a[28:31], 0
  s_lshl_b32 s74, s69, 6
  v_cvt_pk_bf16_f32 v232, v240, v241
  v_cvt_pk_bf16_f32 v233, v242, v243
  v_mfma_f32_16x16x32_bf16 v[156:159], a[160:163], a[32:35], v[156:159]
  s_add_u32 s74, s74, s64
  ds_read_b128 a[148:151], v5 offset:21504
  v_cvt_pk_bf16_f32 v234, v244, v245
  v_mfma_f32_16x16x32_bf16 v[156:159], a[164:167], a[36:39], v[156:159]
  v_cvt_pk_bf16_f32 v235, v246, v247
  v_cvt_pk_bf16_f32 v236, v248, v249
  v_mfma_f32_16x16x32_bf16 v[156:159], a[168:171], a[40:43], v[156:159]
  s_add_u32 s60, s79, 68608
  ds_read_b128 a[152:155], v5 offset:22528
  v_cvt_pk_bf16_f32 v237, v250, v251
  v_mfma_f32_16x16x32_bf16 v[156:159], a[172:175], a[44:47], v[156:159]
  s_lshl_b32 s74, s74, 5
  buffer_load_dwordx4 v4, s[12:15], s66 offen offset:3072 sc1 lds
  buffer_store_dwordx4 v[120:123], v1, s[12:15], s100 offen offset:2048
  buffer_store_dwordx4 v[124:127], v1, s[12:15], s100 offen offset:3072
  s_add_u32 s100, s100, 1015808
  buffer_store_dwordx4 v[128:131], v1, s[12:15], s99 offen offset:0
  v_mfma_f32_16x16x32_bf16 v[156:159], a[176:179], a[48:51], v[156:159]
  s_add_u32 s74, s74, s68
  ds_read_b128 a[156:159], v5 offset:23552
  v_cvt_pk_bf16_f32 v238, v252, v253
  v_mfma_f32_16x16x32_bf16 v[156:159], a[180:183], a[52:55], v[156:159]
  s_waitcnt lgkmcnt(6)
  buffer_load_dwordx4 a[100:103], v1, s[12:15], s60 offen offset:0 sc1
  v_mfma_f32_16x16x32_bf16 v[176:179], a[184:187], a[0:3], 0
  s_lshl_b32 s74, s74, 2
  ds_read_b128 a[160:163], v5 offset:24576
  v_cvt_pk_bf16_f32 v239, v254, v255
  v_mfma_f32_16x16x32_bf16 v[176:179], a[188:191], a[4:7], v[176:179]
  s_add_u32 s74, s74, 38666240
  buffer_load_dwordx4 a[104:107], v1, s[12:15], s60 offen offset:1024 sc1
  v_mfma_f32_16x16x32_bf16 v[176:179], a[128:131], a[8:11], v[176:179]
  s_lshl_b32 s40, s68, 13
  ds_read_b128 a[164:167], v5 offset:25600
  v_mfma_f32_16x16x32_bf16 v[176:179], a[132:135], a[12:15], v[176:179]
  s_waitcnt lgkmcnt(5)
  v_mfma_f32_16x16x32_bf16 v[176:179], a[136:139], a[16:19], v[176:179]
  s_add_u32 s40, s40, 38535168
  ds_read_b128 a[168:171], v5 offset:26624
  v_mfma_f32_16x16x32_bf16 v[176:179], a[140:143], a[20:23], v[176:179]
  s_add_u32 s61, s40, s62
  v_mfma_f32_16x16x32_bf16 v[176:179], a[144:147], a[24:27], v[176:179]
  s_and_b32 s17, s16, 0xffff
  ds_read_b128 a[172:175], v5 offset:27648
  v_mfma_f32_16x16x32_bf16 v[180:183], a[184:187], a[28:31], 0
  buffer_load_dwordx4 a[108:111], v1, s[12:15], s60 offen offset:2048 sc1
  v_mfma_f32_16x16x32_bf16 v[180:183], a[188:191], a[32:35], v[180:183]
  s_lshl_b32 s0, s69, 7
  ds_read_b128 a[176:179], v5 offset:28672
  v_mfma_f32_16x16x32_bf16 v[180:183], a[128:131], a[36:39], v[180:183]
  s_add_u32 s0, s0, s64
  v_mfma_f32_16x16x32_bf16 v[180:183], a[132:135], a[40:43], v[180:183]
  s_lshl2_add_u32 s0, s0, s40
  ds_read_b128 a[180:183], v5 offset:29696
  v_mfma_f32_16x16x32_bf16 v[180:183], a[136:139], a[44:47], v[180:183]
  s_waitcnt lgkmcnt(7)
  buffer_store_dwordx4 v[132:135], v1, s[12:15], s99 offen offset:1024
  v_mfma_f32_16x16x32_bf16 v[180:183], a[140:143], a[48:51], v[180:183]
  s_lshr_b32 s1, s33, 8
  ds_read_b128 a[184:187], v5 offset:30720
  v_mfma_f32_16x16x32_bf16 v[180:183], a[144:147], a[52:55], v[180:183]
  s_mov_b32 s36, s1
  v_mfma_f32_16x16x32_bf16 v[184:187], a[148:151], a[0:3], 0
  s_cmp_lg_u32 s70, 0
  ds_read_b128 a[188:191], v5 offset:31744
  v_mfma_f32_16x16x32_bf16 v[184:187], a[152:155], a[4:7], v[184:187]
  s_waitcnt lgkmcnt(5)
  v_mfma_f32_16x16x32_bf16 v[184:187], a[156:159], a[8:11], v[184:187]
  s_cselect_b32 s49, 1, 0
  v_mfma_f32_16x16x32_bf16 v[184:187], a[160:163], a[12:15], v[184:187]
  s_cselect_b32 s96, s69, s33
  v_mfma_f32_16x16x32_bf16 v[184:187], a[164:167], a[16:19], v[184:187]
  s_cselect_b32 s41, 0, 2147418112
  s_add_u32 s66, s66, 0x8000
  s_add_u32 m0, s67, s65
  v_mfma_f32_16x16x32_bf16 v[184:187], a[168:171], a[20:23], v[184:187]
  s_waitcnt lgkmcnt(4)
  s_add_u32 s67, s67, 0x8000
  s_and_b32 s67, s67, 0x1ffff
  v_mfma_f32_16x16x32_bf16 v[184:187], a[172:175], a[24:27], v[184:187]
  s_waitcnt vmcnt(31) lgkmcnt(0)
  v_add_u32 v5, s67, v1
  v_mfma_f32_16x16x32_bf16 v[188:191], a[148:151], a[28:31], 0
  s_barrier
  v_mfma_f32_16x16x32_bf16 v[188:191], a[152:155], a[32:35], v[188:191]
  s_and_b32 s96, s96, 255
  ds_read_b128 a[128:131], v5 offset:0
  ds_read_b128 a[132:135], v5 offset:1024
  v_mfma_f32_16x16x32_bf16 v[188:191], a[156:159], a[36:39], v[188:191]
  buffer_load_dwordx4 v3, s[12:15], s66 offen offset:0 sc1 lds
  v_mfma_f32_16x16x32_bf16 v[188:191], a[160:163], a[40:43], v[188:191]
  s_lshl_b32 s98, s96, 9
  ds_read_b128 a[136:139], v5 offset:2048
  ds_read_b128 a[140:143], v5 offset:3072
  v_mfma_f32_16x16x32_bf16 v[188:191], a[164:167], a[44:47], v[188:191]
  s_add_u32 s40, s40, s98
  ds_read_b128 a[144:147], v5 offset:4096
  v_mfma_f32_16x16x32_bf16 v[188:191], a[168:171], a[48:51], v[188:191]
  s_lshl_b32 s98, s64, 2
  ds_read_b128 a[148:151], v5 offset:5120
  v_mfma_f32_16x16x32_bf16 v[188:191], a[172:175], a[52:55], v[188:191]
  v_mfma_f32_16x16x32_bf16 v[208:211], a[176:179], a[0:3], 0
  s_add_u32 s40, s40, s98
  ds_read_b128 a[152:155], v5 offset:6144
  v_mfma_f32_16x16x32_bf16 v[208:211], a[180:183], a[4:7], v[208:211]
  s_and_b32 s96, s96, 7
  buffer_store_dwordx4 v[136:139], v1, s[12:15], s99 offen offset:2048
  v_mfma_f32_16x16x32_bf16 v[208:211], a[184:187], a[8:11], v[208:211]
  s_lshl_b32 s98, s68, 3
  ds_read_b128 a[156:159], v5 offset:7168
  v_mfma_f32_16x16x32_bf16 v[208:211], a[188:191], a[12:15], v[208:211]
  s_waitcnt lgkmcnt(5)
  buffer_load_dwordx4 v3, s[12:15], s66 offen offset:1024 sc1 lds
  v_mfma_f32_16x16x32_bf16 v[208:211], a[128:131], a[16:19], v[208:211]
  s_add_u32 s96, s96, s98
  ds_read_b128 a[160:163], v5 offset:8192
  v_mfma_f32_16x16x32_bf16 v[208:211], a[132:135], a[20:23], v[208:211]
  s_lshl_b32 s96, s96, 2
  v_mfma_f32_16x16x32_bf16 v[208:211], a[136:139], a[24:27], v[208:211]
  s_add_u32 s96, s96, s64
  ds_read_b128 a[164:167], v5 offset:9216
  v_mfma_f32_16x16x32_bf16 v[212:215], a[176:179], a[28:31], 0
  v_mfma_f32_16x16x32_bf16 v[212:215], a[180:183], a[32:35], v[212:215]
  s_mul_i32 s39, s96, 33792
  ds_read_b128 a[168:171], v5 offset:10240
  v_mfma_f32_16x16x32_bf16 v[212:215], a[184:187], a[36:39], v[212:215]
  s_add_u32 s39, s39, 96468992
  v_mfma_f32_16x16x32_bf16 v[212:215], a[188:191], a[40:43], v[212:215]
  s_add_u32 s41, s41, s39
  ds_read_b128 a[172:175], v5 offset:11264
  v_mfma_f32_16x16x32_bf16 v[212:215], a[128:131], a[44:47], v[212:215]
  s_waitcnt lgkmcnt(7)
  buffer_load_dwordx4 v3, s[12:15], s66 offen offset:2048 sc1 lds
  v_mfma_f32_16x16x32_bf16 v[212:215], a[132:135], a[48:51], v[212:215]
  s_and_b32 s96, 15, s16
  ds_read_b128 a[176:179], v5 offset:12288
  v_mfma_f32_16x16x32_bf16 v[212:215], a[136:139], a[52:55], v[212:215]
  s_lshl_b32 s77, s70, 15
  v_mfma_f32_16x16x32_bf16 v[216:219], a[140:143], a[0:3], 0
  s_lshl_b32 s78, s69, 2
  ds_read_b128 a[180:183], v5 offset:13312
  v_and_b32 v16, 15, v2
  v_mfma_f32_16x16x32_bf16 v[216:219], a[144:147], a[4:7], v[216:219]
  s_waitcnt lgkmcnt(5)
  v_lshrrev_b32 v17, 1, v9
  v_sub_u32 v16, v16, v17
  v_mfma_f32_16x16x32_bf16 v[216:219], a[148:151], a[8:11], v[216:219]
  s_sub_u32 s78, s78, 24
  ds_read_b128 a[184:187], v5 offset:14336
  v_mov_b32 v17, 0x97800000
  v_mfma_f32_16x16x32_bf16 v[216:219], a[152:155], a[12:15], v[216:219]
  s_mul_i32 s63, s68, 229376
  v_cmp_le_i32 vcc, 0, v16
  v_mfma_f32_16x16x32_bf16 v[216:219], a[156:159], a[16:19], v[216:219]
  s_add_u32 s63, s63, 45088768
  ds_read_b128 a[188:191], v5 offset:15360
  v_mov_b32 v30, v62
  v_mfma_f32_16x16x32_bf16 v[216:219], a[160:163], a[20:23], v[216:219]
  s_waitcnt lgkmcnt(6)
  buffer_load_dwordx4 v3, s[12:15], s66 offen offset:3072 sc1 lds
  v_mfma_f32_16x16x32_bf16 v[216:219], a[164:167], a[24:27], v[216:219]
  s_add_u32 m0, m0, 0x4000
  ds_read_b128 a[128:131], v5 offset:16384
  v_mov_b32 v31, v63
  v_mfma_f32_16x16x32_bf16 v[220:223], a[140:143], a[28:31], 0
  buffer_store_dwordx4 v[140:143], v1, s[12:15], s99 offen offset:3072
  v_mfma_f32_16x16x32_bf16 v[220:223], a[144:147], a[32:35], v[220:223]
  s_add_u32 s99, s99, 32768
  ds_read_b128 a[132:135], v5 offset:17408
  v_mov_b32 v48, 0
  v_mfma_f32_16x16x32_bf16 v[220:223], a[148:151], a[36:39], v[220:223]
  v_mov_b32 v49, 0
  v_mov_b32 v50, 0
  v_mfma_f32_16x16x32_bf16 v[220:223], a[152:155], a[40:43], v[220:223]
  ds_read_b128 a[136:139], v5 offset:18432
  v_mov_b32 v51, 0
  v_mfma_f32_16x16x32_bf16 v[220:223], a[156:159], a[44:47], v[220:223]
  v_mov_b32 v52, 0
  v_mov_b32 v53, 0
  v_mfma_f32_16x16x32_bf16 v[220:223], a[160:163], a[48:51], v[220:223]
  ds_read_b128 a[140:143], v5 offset:19456
  v_mov_b32 v54, 0
  v_mfma_f32_16x16x32_bf16 v[220:223], a[164:167], a[52:55], v[220:223]
  s_waitcnt lgkmcnt(6)
  buffer_load_dwordx4 v4, s[12:15], s66 offen offset:0 sc1 lds
  v_mfma_f32_16x16x32_bf16 v[240:243], a[168:171], a[0:3], 0
  ds_read_b128 a[144:147], v5 offset:20480
  v_mov_b32 v55, 0
  v_mfma_f32_16x16x32_bf16 v[240:243], a[172:175], a[4:7], v[240:243]
  v_mov_b32 v56, 0
  v_mov_b32 v57, 0
  v_mfma_f32_16x16x32_bf16 v[240:243], a[176:179], a[8:11], v[240:243]
  ds_read_b128 a[148:151], v5 offset:21504
  v_mov_b32 v58, 0
  v_mfma_f32_16x16x32_bf16 v[240:243], a[180:183], a[12:15], v[240:243]
  s_waitcnt lgkmcnt(5)
  v_mov_b32 v59, 0
  v_mov_b32 v60, 0
  v_mfma_f32_16x16x32_bf16 v[240:243], a[184:187], a[16:19], v[240:243]
  ds_read_b128 a[152:155], v5 offset:22528
  v_mov_b32 v61, 0
  v_mfma_f32_16x16x32_bf16 v[240:243], a[188:191], a[20:23], v[240:243]
  v_mov_b32 v62, 0
  v_mov_b32 v63, 0
  v_mfma_f32_16x16x32_bf16 v[240:243], a[128:131], a[24:27], v[240:243]
  ds_read_b128 a[156:159], v5 offset:23552
  v_mov_b32 v24, 0
  v_mfma_f32_16x16x32_bf16 v[244:247], a[168:171], a[28:31], 0
  buffer_load_dwordx4 v4, s[12:15], s66 offen offset:1024 sc1 lds
  v_mfma_f32_16x16x32_bf16 v[244:247], a[172:175], a[32:35], v[244:247]
  ds_read_b128 a[160:163], v5 offset:24576
  v_mov_b32 v25, 0
  v_mfma_f32_16x16x32_bf16 v[244:247], a[176:179], a[36:39], v[244:247]
  v_mov_b32 v26, 0
  v_mov_b32 v27, 0
  v_mfma_f32_16x16x32_bf16 v[244:247], a[180:183], a[40:43], v[244:247]
  ds_read_b128 a[164:167], v5 offset:25600
  v_cndmask_b32 v112, -1.0, v17, vcc
  v_mfma_f32_16x16x32_bf16 v[244:247], a[184:187], a[44:47], v[244:247]
  s_waitcnt lgkmcnt(7)
  buffer_store_dwordx4 v[160:163], v1, s[12:15], s100 offen offset:0
  v_mfma_f32_16x16x32_bf16 v[244:247], a[188:191], a[48:51], v[244:247]
  ds_read_b128 a[168:171], v5 offset:26624
  v_cmp_le_i32 vcc, 1, v16
  v_mfma_f32_16x16x32_bf16 v[244:247], a[128:131], a[52:55], v[244:247]
  v_mfma_f32_16x16x32_bf16 v[248:251], a[132:135], a[0:3], 0
  ds_read_b128 a[172:175], v5 offset:27648
  v_cndmask_b32 v113, -1.0, v17, vcc
  v_mfma_f32_16x16x32_bf16 v[248:251], a[136:139], a[4:7], v[248:251]
  s_waitcnt lgkmcnt(5)
  buffer_load_dwordx4 v4, s[12:15], s66 offen offset:2048 sc1 lds
  v_mfma_f32_16x16x32_bf16 v[248:251], a[140:143], a[8:11], v[248:251]
  ds_read_b128 a[176:179], v5 offset:28672
  v_cmp_le_i32 vcc, 2, v16
  v_mfma_f32_16x16x32_bf16 v[248:251], a[144:147], a[12:15], v[248:251]
  v_mfma_f32_16x16x32_bf16 v[248:251], a[148:151], a[16:19], v[248:251]
  ds_read_b128 a[180:183], v5 offset:29696
  v_cndmask_b32 v114, -1.0, v17, vcc
  v_mfma_f32_16x16x32_bf16 v[248:251], a[152:155], a[20:23], v[248:251]
  s_waitcnt lgkmcnt(6)
  v_cmp_le_i32 vcc, 3, v16
  v_mfma_f32_16x16x32_bf16 v[248:251], a[156:159], a[24:27], v[248:251]
  ds_read_b128 a[184:187], v5 offset:30720
  v_cndmask_b32 v115, -1.0, v17, vcc
  v_mfma_f32_16x16x32_bf16 v[252:255], a[132:135], a[28:31], 0
  v_mfma_f32_16x16x32_bf16 v[252:255], a[136:139], a[32:35], v[252:255]
  ds_read_b128 a[188:191], v5 offset:31744
  v_mfma_f32_16x16x32_bf16 v[252:255], a[140:143], a[36:39], v[252:255]
  buffer_load_dwordx4 v4, s[12:15], s66 offen offset:3072 sc1 lds
  v_mfma_f32_16x16x32_bf16 v[252:255], a[144:147], a[40:43], v[252:255]
  s_add_u32 s66, s66, 0x8000
  v_mfma_f32_16x16x32_bf16 v[252:255], a[148:151], a[44:47], v[252:255]
  s_add_u32 m0, s67, s65
  v_mfma_f32_16x16x32_bf16 v[252:255], a[152:155], a[48:51], v[252:255]
  s_add_u32 s67, s67, 0x8000
  v_mfma_f32_16x16x32_bf16 v[252:255], a[156:159], a[52:55], v[252:255]
  s_waitcnt vmcnt(40) lgkmcnt(4)
  s_and_b32 s67, s67, 0x1ffff
  v_add_u32 v5, s67, v1
  v_mfma_f32_16x16x32_bf16 v[144:147], a[160:163], a[56:59], v[144:147]
  s_waitcnt vmcnt(16) lgkmcnt(0)
  v_mfma_f32_16x16x32_bf16 v[144:147], a[164:167], a[60:63], v[144:147]
  s_barrier
  buffer_store_dwordx4 v[164:167], v1, s[12:15], s100 offen offset:1024
  v_mfma_f32_16x16x32_bf16 v[144:147], a[168:171], a[64:67], v[144:147]
  s_cmp_lg_u32 s56, 0
  ds_read_b128 a[128:131], v5 offset:0
  ds_read_b128 a[132:135], v5 offset:1024
  v_mfma_f32_16x16x32_bf16 v[144:147], a[172:175], a[68:71], v[144:147]
  buffer_load_dwordx4 v3, s[12:15], s66 offen offset:0 sc1 lds
  v_mfma_f32_16x16x32_bf16 v[144:147], a[176:179], a[72:75], v[144:147]
  s_cbranch_scc1 L_kf_kernel_wb_32
L_kf_kernel_wbr_33:
  ds_read_b128 a[136:139], v5 offset:2048
  ds_read_b128 a[140:143], v5 offset:3072
  buffer_store_dword v11, v0, s[12:15], s18 offen sc1
  v_mfma_f32_16x16x32_bf16 v[144:147], a[180:183], a[76:79], v[144:147]
  ds_read_b128 a[144:147], v5 offset:4096
  v_mfma_f32_16x16x32_bf16 v[144:147], a[184:187], a[80:83], v[144:147]
  ds_read_b128 a[148:151], v5 offset:5120
  v_mfma_f32_16x16x32_bf16 v[148:151], a[160:163], a[84:87], v[148:151]
  s_waitcnt vmcnt(17)
  v_mfma_f32_16x16x32_bf16 v[148:151], a[164:167], a[88:91], v[148:151]
  ds_read_b128 a[152:155], v5 offset:6144
  v_mfma_f32_16x16x32_bf16 v[148:151], a[168:171], a[92:95], v[148:151]
  s_cmp_eq_u32 s64, 0
  v_mfma_f32_16x16x32_bf16 v[148:151], a[172:175], a[96:99], v[148:151]
  s_cselect_b32 s52, 0x56000000, 0
  ds_read_b128 a[156:159], v5 offset:7168
  v_mul_f32 v144, s76, v144
  v_mfma_f32_16x16x32_bf16 v[148:151], a[176:179], a[100:103], v[148:151]
  s_waitcnt vmcnt(15) lgkmcnt(7)
  buffer_load_dwordx4 v3, s[12:15], s66 offen offset:1024 sc1 lds
  v_mfma_f32_16x16x32_bf16 v[148:151], a[180:183], a[104:107], v[148:151]
  s_cmp_lt_u32 s64, 0
  ds_read_b128 a[160:163], v5 offset:8192
  v_mul_f32 v145, s76, v145
  v_mfma_f32_16x16x32_bf16 v[148:151], a[184:187], a[108:111], v[148:151]
  s_cselect_b32 s52, 0x7e000000, s52
  v_cvt_pk_bf16_f32 v144, v144, v145
  v_accvgpr_write_b32 a192, v144
  v_mfma_f32_16x16x32_bf16 v[152:155], a[188:191], a[56:59], v[152:155]
  s_cmp_eq_u32 s64, 1
  ds_read_b128 a[164:167], v5 offset:9216
  v_mul_f32 v146, s76, v146
  v_mfma_f32_16x16x32_bf16 v[152:155], a[128:131], a[60:63], v[152:155]
  s_waitcnt lgkmcnt(5)
  v_mul_f32 v147, s76, v147
  v_cvt_pk_bf16_f32 v146, v146, v147
  v_mfma_f32_16x16x32_bf16 v[152:155], a[132:135], a[64:67], v[152:155]
  s_cselect_b32 s53, 0x56000000, 0
  ds_read_b128 a[168:171], v5 offset:10240
  v_accvgpr_write_b32 a193, v146
  v_mfma_f32_16x16x32_bf16 v[152:155], a[136:139], a[68:71], v[152:155]
  s_cmp_lt_u32 s64, 1
  v_mul_f32 v148, s76, v148
  v_mul_f32 v149, s76, v149
  v_mfma_f32_16x16x32_bf16 v[152:155], a[140:143], a[72:75], v[152:155]
  s_cselect_b32 s53, 0x7e000000, s53
  ds_read_b128 a[172:175], v5 offset:11264
  v_cvt_pk_bf16_f32 v148, v148, v149
  v_mfma_f32_16x16x32_bf16 v[152:155], a[144:147], a[76:79], v[152:155]
  s_waitcnt lgkmcnt(6)
  buffer_load_dwordx4 v3, s[12:15], s66 offen offset:2048 sc1 lds
  v_mfma_f32_16x16x32_bf16 v[152:155], a[148:151], a[80:83], v[152:155]
  s_cmp_eq_u32 s64, 2
  ds_read_b128 a[176:179], v5 offset:12288
  v_accvgpr_write_b32 a224, v148
  v_mfma_f32_16x16x32_bf16 v[156:159], a[188:191], a[84:87], v[156:159]
  s_cselect_b32 s58, 0x56000000, 0
  buffer_store_dwordx4 v[168:171], v1, s[12:15], s100 offen offset:2048
  v_mfma_f32_16x16x32_bf16 v[156:159], a[128:131], a[88:91], v[156:159]
  s_cmp_lt_u32 s64, 2
  ds_read_b128 a[180:183], v5 offset:13312
  v_mul_f32 v150, s76, v150
  v_mfma_f32_16x16x32_bf16 v[156:159], a[132:135], a[92:95], v[156:159]
  v_mul_f32 v151, s76, v151
  v_cvt_pk_bf16_f32 v150, v150, v151
  v_mfma_f32_16x16x32_bf16 v[156:159], a[136:139], a[96:99], v[156:159]
  s_cselect_b32 s58, 0x7e000000, s58
  ds_read_b128 a[184:187], v5 offset:14336
  v_accvgpr_write_b32 a225, v150
  v_mfma_f32_16x16x32_bf16 v[156:159], a[140:143], a[100:103], v[156:159]
  s_cmp_eq_u32 s64, 3
  v_mul_f32 v152, s76, v152
  v_mul_f32 v153, s76, v153
  v_mfma_f32_16x16x32_bf16 v[156:159], a[144:147], a[104:107], v[156:159]
  s_cselect_b32 s59, 0x56000000, 0
  ds_read_b128 a[188:191], v5 offset:15360
  v_cvt_pk_bf16_f32 v152, v152, v153
  v_mfma_f32_16x16x32_bf16 v[156:159], a[148:151], a[108:111], v[156:159]
  s_waitcnt lgkmcnt(6)
  buffer_load_dwordx4 v3, s[12:15], s66 offen offset:3072 sc1 lds
  v_mfma_f32_16x16x32_bf16 v[176:179], a[152:155], a[56:59], v[176:179]
  s_add_u32 m0, m0, 0x4000
  ds_read_b128 a[128:131], v5 offset:16384
  v_accvgpr_write_b32 a194, v152
  v_mfma_f32_16x16x32_bf16 v[176:179], a[156:159], a[60:63], v[176:179]
  s_cmp_lt_u32 s64, 3
  v_mul_f32 v154, s76, v154
  v_mul_f32 v155, s76, v155
  v_mfma_f32_16x16x32_bf16 v[176:179], a[160:163], a[64:67], v[176:179]
  s_cselect_b32 s59, 0x7e000000, s59
  ds_read_b128 a[132:135], v5 offset:17408
  v_cvt_pk_bf16_f32 v154, v154, v155
  v_mfma_f32_16x16x32_bf16 v[176:179], a[164:167], a[68:71], v[176:179]
  s_waitcnt lgkmcnt(5)
  v_accvgpr_write_b32 a195, v154
  v_mul_f32 v156, s76, v156
  v_mfma_f32_16x16x32_bf16 v[176:179], a[168:171], a[72:75], v[176:179]
  s_cmp_eq_u32 s69, 0
  ds_read_b128 a[136:139], v5 offset:18432
  v_mul_f32 v157, s76, v157
  v_mfma_f32_16x16x32_bf16 v[176:179], a[172:175], a[76:79], v[176:179]
  s_cbranch_scc1 L_kf_kernel_mask_29
L_kf_kernel_maskr_30:
  v_cvt_pk_bf16_f32 v156, v156, v157
  v_mfma_f32_16x16x32_bf16 v[176:179], a[176:179], a[80:83], v[176:179]
  ds_read_b128 a[140:143], v5 offset:19456
  v_accvgpr_write_b32 a226, v156
  v_mfma_f32_16x16x32_bf16 v[180:183], a[152:155], a[84:87], v[180:183]
  buffer_load_dwordx4 v4, s[12:15], s66 offen offset:0 sc1 lds
  v_mfma_f32_16x16x32_bf16 v[180:183], a[156:159], a[88:91], v[180:183]
  ds_read_b128 a[144:147], v5 offset:20480
  v_mul_f32 v158, s76, v158
  v_mfma_f32_16x16x32_bf16 v[180:183], a[160:163], a[92:95], v[180:183]
  v_mul_f32 v159, s76, v159
  v_cvt_pk_bf16_f32 v158, v158, v159
  v_mfma_f32_16x16x32_bf16 v[180:183], a[164:167], a[96:99], v[180:183]
  ds_read_b128 a[148:151], v5 offset:21504
  v_accvgpr_write_b32 a227, v158
  v_mfma_f32_16x16x32_bf16 v[180:183], a[168:171], a[100:103], v[180:183]
  s_waitcnt lgkmcnt(7)
  buffer_store_dwordx4 v[172:175], v1, s[12:15], s100 offen offset:3072
  v_mfma_f32_16x16x32_bf16 v[180:183], a[172:175], a[104:107], v[180:183]
  s_add_u32 s100, s100, 32768
  ds_read_b128 a[152:155], v5 offset:22528
  v_mul_f32 v176, s76, v176
  v_mfma_f32_16x16x32_bf16 v[180:183], a[176:179], a[108:111], v[180:183]
  v_mul_f32 v177, s76, v177
  v_cvt_pk_bf16_f32 v176, v176, v177
  v_mfma_f32_16x16x32_bf16 v[184:187], a[180:183], a[56:59], v[184:187]
  ds_read_b128 a[156:159], v5 offset:23552
  v_accvgpr_write_b32 a196, v176
  v_mfma_f32_16x16x32_bf16 v[184:187], a[184:187], a[60:63], v[184:187]
  s_waitcnt lgkmcnt(5)
  buffer_load_dwordx4 v4, s[12:15], s66 offen offset:1024 sc1 lds
  v_mfma_f32_16x16x32_bf16 v[184:187], a[188:191], a[64:67], v[184:187]
  ds_read_b128 a[160:163], v5 offset:24576
  v_mul_f32 v178, s76, v178
  v_mfma_f32_16x16x32_bf16 v[184:187], a[128:131], a[68:71], v[184:187]
  v_mul_f32 v179, s76, v179
  v_cvt_pk_bf16_f32 v178, v178, v179
  v_mfma_f32_16x16x32_bf16 v[184:187], a[132:135], a[72:75], v[184:187]
  ds_read_b128 a[164:167], v5 offset:25600
  v_accvgpr_write_b32 a197, v178
  v_mfma_f32_16x16x32_bf16 v[184:187], a[136:139], a[76:79], v[184:187]
  s_waitcnt lgkmcnt(6)
  v_mul_f32 v180, s76, v180
  v_mul_f32 v181, s76, v181
  v_mfma_f32_16x16x32_bf16 v[184:187], a[140:143], a[80:83], v[184:187]
  ds_read_b128 a[168:171], v5 offset:26624
  v_cvt_pk_bf16_f32 v180, v180, v181
  v_mfma_f32_16x16x32_bf16 v[188:191], a[180:183], a[84:87], v[188:191]
  v_accvgpr_write_b32 a228, v180
  v_mul_f32 v182, s76, v182
  v_mfma_f32_16x16x32_bf16 v[188:191], a[184:187], a[88:91], v[188:191]
  ds_read_b128 a[172:175], v5 offset:27648
  v_mul_f32 v183, s76, v183
  v_mfma_f32_16x16x32_bf16 v[188:191], a[188:191], a[92:95], v[188:191]
  buffer_load_dwordx4 v4, s[12:15], s66 offen offset:2048 sc1 lds
  v_mfma_f32_16x16x32_bf16 v[188:191], a[128:131], a[96:99], v[188:191]
  ds_read_b128 a[176:179], v5 offset:28672
  v_cvt_pk_bf16_f32 v182, v182, v183
  v_mfma_f32_16x16x32_bf16 v[188:191], a[132:135], a[100:103], v[188:191]
  v_accvgpr_write_b32 a229, v182
  v_mul_f32 v184, s76, v184
  v_mfma_f32_16x16x32_bf16 v[188:191], a[136:139], a[104:107], v[188:191]
  ds_read_b128 a[180:183], v5 offset:29696
  v_mul_f32 v185, s76, v185
  v_mfma_f32_16x16x32_bf16 v[188:191], a[140:143], a[108:111], v[188:191]
  s_waitcnt lgkmcnt(6)
  v_cvt_pk_bf16_f32 v184, v184, v185
  v_accvgpr_write_b32 a198, v184
  v_mfma_f32_16x16x32_bf16 v[208:211], a[144:147], a[56:59], v[208:211]
  ds_read_b128 a[184:187], v5 offset:30720
  v_mul_f32 v186, s76, v186
  v_mfma_f32_16x16x32_bf16 v[208:211], a[148:151], a[60:63], v[208:211]
  buffer_store_dwordx4 v[192:195], v1, s[12:15], s99 offen offset:0
  v_mfma_f32_16x16x32_bf16 v[208:211], a[152:155], a[64:67], v[208:211]
  ds_read_b128 a[188:191], v5 offset:31744
  v_mul_f32 v187, s76, v187
  v_mfma_f32_16x16x32_bf16 v[208:211], a[156:159], a[68:71], v[208:211]
  s_waitcnt lgkmcnt(5)
  buffer_load_dwordx4 v4, s[12:15], s66 offen offset:3072 sc1 lds
  v_mfma_f32_16x16x32_bf16 v[208:211], a[160:163], a[72:75], v[208:211]
  s_add_u32 s66, s66, 0x8000
  v_cvt_pk_bf16_f32 v186, v186, v187
  v_accvgpr_write_b32 a199, v186
  v_mfma_f32_16x16x32_bf16 v[208:211], a[164:167], a[76:79], v[208:211]
  s_add_u32 m0, s67, s65
  v_mul_f32 v188, s76, v188
  v_mul_f32 v189, s76, v189
  v_mfma_f32_16x16x32_bf16 v[208:211], a[168:171], a[80:83], v[208:211]
  s_add_u32 s67, s67, 0x8000
  v_cvt_pk_bf16_f32 v188, v188, v189
  v_accvgpr_write_b32 a230, v188
  v_mfma_f32_16x16x32_bf16 v[212:215], a[144:147], a[84:87], v[212:215]
  s_and_b32 s67, s67, 0x1ffff
  v_add_u32 v5, s67, v1
  v_mfma_f32_16x16x32_bf16 v[212:215], a[148:151], a[88:91], v[212:215]
  s_waitcnt lgkmcnt(0)
  v_mul_f32 v190, s76, v190
  v_mul_f32 v191, s76, v191
  v_mfma_f32_16x16x32_bf16 v[212:215], a[152:155], a[92:95], v[212:215]
  s_barrier
  v_cvt_pk_bf16_f32 v190, v190, v191
  v_accvgpr_write_b32 a231, v190
  v_mfma_f32_16x16x32_bf16 v[212:215], a[156:159], a[96:99], v[212:215]
  ds_read_b128 a[128:131], v5 offset:0
  ds_read_b128 a[132:135], v5 offset:1024
  v_mfma_f32_16x16x32_bf16 v[212:215], a[160:163], a[100:103], v[212:215]
  buffer_load_dwordx4 v3, s[12:15], s66 offen offset:0 sc1 lds
  v_mfma_f32_16x16x32_bf16 v[212:215], a[164:167], a[104:107], v[212:215]
  ds_read_b128 a[136:139], v5 offset:2048
  ds_read_b128 a[140:143], v5 offset:3072
  v_mfma_f32_16x16x32_bf16 v[212:215], a[168:171], a[108:111], v[212:215]
  ds_read_b128 a[144:147], v5 offset:4096
  v_mul_f32 v208, s76, v208
  v_mfma_f32_16x16x32_bf16 v[216:219], a[172:175], a[56:59], v[216:219]
  ds_read_b128 a[148:151], v5 offset:5120
  v_mul_f32 v209, s76, v209
  v_mfma_f32_16x16x32_bf16 v[216:219], a[176:179], a[60:63], v[216:219]
  s_waitcnt lgkmcnt(5)
  v_cvt_pk_bf16_f32 v208, v208, v209
  v_accvgpr_write_b32 a200, v208
  v_mfma_f32_16x16x32_bf16 v[216:219], a[180:183], a[64:67], v[216:219]
  ds_read_b128 a[152:155], v5 offset:6144
  v_mul_f32 v210, s76, v210
  v_mfma_f32_16x16x32_bf16 v[216:219], a[184:187], a[68:71], v[216:219]
  v_mul_f32 v211, s76, v211
  v_cvt_pk_bf16_f32 v210, v210, v211
  v_mfma_f32_16x16x32_bf16 v[216:219], a[188:191], a[72:75], v[216:219]
  ds_read_b128 a[156:159], v5 offset:7168
  v_accvgpr_write_b32 a201, v210
  v_mfma_f32_16x16x32_bf16 v[216:219], a[128:131], a[76:79], v[216:219]
  s_waitcnt lgkmcnt(6)
  buffer_load_dwordx4 v3, s[12:15], s66 offen offset:1024 sc1 lds
  v_mfma_f32_16x16x32_bf16 v[216:219], a[132:135], a[80:83], v[216:219]
  ds_read_b128 a[160:163], v5 offset:8192
  v_mul_f32 v212, s76, v212
  v_mfma_f32_16x16x32_bf16 v[220:223], a[172:175], a[84:87], v[220:223]
  buffer_store_dwordx4 v[196:199], v1, s[12:15], s99 offen offset:1024
  v_mfma_f32_16x16x32_bf16 v[220:223], a[176:179], a[88:91], v[220:223]
  ds_read_b128 a[164:167], v5 offset:9216
  v_mul_f32 v213, s76, v213
  v_mfma_f32_16x16x32_bf16 v[220:223], a[180:183], a[92:95], v[220:223]
  v_cvt_pk_bf16_f32 v212, v212, v213
  v_accvgpr_write_b32 a232, v212
  v_mfma_f32_16x16x32_bf16 v[220:223], a[184:187], a[96:99], v[220:223]
  ds_read_b128 a[168:171], v5 offset:10240
  v_mul_f32 v214, s76, v214
  v_mfma_f32_16x16x32_bf16 v[220:223], a[188:191], a[100:103], v[220:223]
  v_mul_f32 v215, s76, v215
  v_cvt_pk_bf16_f32 v214, v214, v215
  v_mfma_f32_16x16x32_bf16 v[220:223], a[128:131], a[104:107], v[220:223]
  buffer_load_dword v12, v14, s[12:15], s61 offen sc1
  v_mfma_f32_16x16x32_bf16 v[220:223], a[132:135], a[108:111], v[220:223]
  s_waitcnt lgkmcnt(5)
  buffer_load_dwordx4 v3, s[12:15], s66 offen offset:2048 sc1 lds
  v_mfma_f32_16x16x32_bf16 v[240:243], a[136:139], a[56:59], v[240:243]
  ds_read_b128 a[172:175], v5 offset:11264
  ds_read_b128 a[176:179], v5 offset:12288
  v_mfma_f32_16x16x32_bf16 v[240:243], a[140:143], a[60:63], v[240:243]
  v_accvgpr_write_b32 a233, v214
  v_mul_f32 v216, s76, v216
  v_mfma_f32_16x16x32_bf16 v[240:243], a[144:147], a[64:67], v[240:243]
  ds_read_b128 a[180:183], v5 offset:13312
  v_mul_f32 v217, s76, v217
  v_mfma_f32_16x16x32_bf16 v[240:243], a[148:151], a[68:71], v[240:243]
  s_waitcnt lgkmcnt(5)
  v_cvt_pk_bf16_f32 v216, v216, v217
  v_accvgpr_write_b32 a202, v216
  v_mfma_f32_16x16x32_bf16 v[240:243], a[152:155], a[72:75], v[240:243]
  ds_read_b128 a[184:187], v5 offset:14336
  v_mul_f32 v218, s76, v218
  v_mfma_f32_16x16x32_bf16 v[240:243], a[156:159], a[76:79], v[240:243]
  v_mul_f32 v219, s76, v219
  v_cvt_pk_bf16_f32 v218, v218, v219
  v_mfma_f32_16x16x32_bf16 v[240:243], a[160:163], a[80:83], v[240:243]
  ds_read_b128 a[188:191], v5 offset:15360
  v_accvgpr_write_b32 a203, v218
  v_mfma_f32_16x16x32_bf16 v[244:247], a[136:139], a[84:87], v[244:247]
  buffer_load_dwordx4 v3, s[12:15], s66 offen offset:3072 sc1 lds
  v_mfma_f32_16x16x32_bf16 v[244:247], a[140:143], a[88:91], v[244:247]
  s_add_u32 m0, m0, 0x4000
  ds_read_b128 a[128:131], v5 offset:16384
  v_mul_f32 v220, s76, v220
  v_mfma_f32_16x16x32_bf16 v[244:247], a[144:147], a[92:95], v[244:247]
  s_mul_i32 s98, s68, 7
  v_mul_f32 v221, s76, v221
  v_cvt_pk_bf16_f32 v220, v220, v221
  v_mfma_f32_16x16x32_bf16 v[244:247], a[148:151], a[96:99], v[244:247]
  s_add_u32 s98, s98, s35
  ds_read_b128 a[132:135], v5 offset:17408
  v_accvgpr_write_b32 a234, v220
  v_mfma_f32_16x16x32_bf16 v[244:247], a[152:155], a[100:103], v[244:247]
  s_waitcnt lgkmcnt(7)
  buffer_store_dwordx4 v[200:203], v1, s[12:15], s99 offen offset:2048
  v_mfma_f32_16x16x32_bf16 v[244:247], a[156:159], a[104:107], v[244:247]
  s_lshr_b32 s43, s98, 4
  ds_read_b128 a[136:139], v5 offset:18432
  v_mul_f32 v222, s76, v222
  v_mfma_f32_16x16x32_bf16 v[244:247], a[160:163], a[108:111], v[244:247]
  s_and_b32 s50, s98, 15
  v_mul_f32 v223, s76, v223
  v_cvt_pk_bf16_f32 v222, v222, v223
  v_mfma_f32_16x16x32_bf16 v[248:251], a[164:167], a[56:59], v[248:251]
  s_lshl_b32 s3, s43, 9
  ds_read_b128 a[140:143], v5 offset:19456
  v_accvgpr_write_b32 a235, v222
  v_mfma_f32_16x16x32_bf16 v[248:251], a[168:171], a[60:63], v[248:251]
  s_waitcnt lgkmcnt(5)
  buffer_load_dwordx4 v4, s[12:15], s66 offen offset:0 sc1 lds
  v_mfma_f32_16x16x32_bf16 v[248:251], a[172:175], a[64:67], v[248:251]
  s_lshl_b32 s98, s50, 3
  ds_read_b128 a[144:147], v5 offset:20480
  v_mul_f32 v240, s76, v240
  v_mfma_f32_16x16x32_bf16 v[248:251], a[176:179], a[68:71], v[248:251]
  s_add_u32 s98, s98, s64
  v_mul_f32 v241, s76, v241
  v_cvt_pk_bf16_f32 v240, v240, v241
  v_mfma_f32_16x16x32_bf16 v[248:251], a[180:183], a[72:75], v[248:251]
  s_mul_i32 s79, s98, 14336
  ds_read_b128 a[148:151], v5 offset:21504
  v_accvgpr_write_b32 a204, v240
  v_mfma_f32_16x16x32_bf16 v[248:251], a[184:187], a[76:79], v[248:251]
  s_waitcnt lgkmcnt(6)
  v_mul_f32 v242, s76, v242
  v_mul_f32 v243, s76, v243
  v_mfma_f32_16x16x32_bf16 v[248:251], a[188:191], a[80:83], v[248:251]
  s_add_u32 s79, s79, 35651584
  ds_read_b128 a[152:155], v5 offset:22528
  v_cvt_pk_bf16_f32 v242, v242, v243
  v_mfma_f32_16x16x32_bf16 v[252:255], a[164:167], a[84:87], v[252:255]
  s_mul_i32 s44, s43, 229376
  v_accvgpr_write_b32 a205, v242
  v_mul_f32 v244, s76, v244
  v_mfma_f32_16x16x32_bf16 v[252:255], a[168:171], a[88:91], v[252:255]
  s_add_u32 s44, s44, 42467328
  ds_read_b128 a[156:159], v5 offset:23552
  v_mul_f32 v245, s76, v245
  v_mfma_f32_16x16x32_bf16 v[252:255], a[172:175], a[92:95], v[252:255]
  buffer_load_dwordx4 v4, s[12:15], s66 offen offset:1024 sc1 lds
  v_mfma_f32_16x16x32_bf16 v[252:255], a[176:179], a[96:99], v[252:255]
  s_mul_i32 s42, s68, 2162688
  ds_read_b128 a[160:163], v5 offset:24576
  v_cvt_pk_bf16_f32 v244, v244, v245
  v_mfma_f32_16x16x32_bf16 v[252:255], a[180:183], a[100:103], v[252:255]
  s_sub_u32 s98, 31, s34
  v_accvgpr_write_b32 a236, v244
  v_mul_f32 v246, s76, v246
  v_mfma_f32_16x16x32_bf16 v[252:255], a[184:187], a[104:107], v[252:255]
  s_lshl_b32 s98, s98, 15
  ds_read_b128 a[164:167], v5 offset:25600
  v_mul_f32 v247, s76, v247
  v_mfma_f32_16x16x32_bf16 v[252:255], a[188:191], a[108:111], v[252:255]
  s_waitcnt lgkmcnt(6)
  v_cvt_pk_bf16_f32 v246, v246, v247
  v_accvgpr_write_b32 a237, v246
  v_mfma_f32_16x16x32_bf16 v[144:147], a[128:131], a[0:3], 0
  s_add_u32 s42, s42, s98
  ds_read_b128 a[168:171], v5 offset:26624
  v_mul_f32 v248, s76, v248
  v_mfma_f32_16x16x32_bf16 v[144:147], a[132:135], a[4:7], v[144:147]
  s_cmp_eq_u32 s34, 0
  buffer_store_dwordx4 v[204:207], v1, s[12:15], s99 offen offset:3072
  v_mfma_f32_16x16x32_bf16 v[144:147], a[136:139], a[8:11], v[144:147]
  s_cselect_b32 s42, 2147418112, s42
  ds_read_b128 a[172:175], v5 offset:27648
  v_mul_f32 v249, s76, v249
  v_mfma_f32_16x16x32_bf16 v[144:147], a[140:143], a[12:15], v[144:147]
  s_waitcnt lgkmcnt(5)
  buffer_load_dwordx4 v4, s[12:15], s66 offen offset:2048 sc1 lds
  v_mfma_f32_16x16x32_bf16 v[144:147], a[144:147], a[16:19], v[144:147]
  s_cselect_b32 s45, 1, 0
  ds_read_b128 a[176:179], v5 offset:28672
  v_cvt_pk_bf16_f32 v248, v248, v249
  v_mfma_f32_16x16x32_bf16 v[144:147], a[148:151], a[20:23], v[144:147]
  s_cselect_b32 s46, 2147418112, s40
  s_add_u32 s99, s99, 32768
  s_waitcnt vmcnt(7)
  v_cmp_eq_u32 vcc, 0, v12
  v_mfma_f32_16x16x32_bf16 v[144:147], a[152:155], a[24:27], v[144:147]
  s_and_b32 s97, vcc_lo, s96
  ds_read_b128 a[180:183], v5 offset:29696
  v_accvgpr_write_b32 a206, v248
  v_mfma_f32_16x16x32_bf16 v[148:151], a[128:131], a[28:31], 0
  v_mul_f32 v250, s76, v250
  v_mul_f32 v251, s76, v251
  v_mfma_f32_16x16x32_bf16 v[148:151], a[132:135], a[32:35], v[148:151]
  s_cbranch_scc1 L_kf_kernel_spin_34
L_kf_kernel_spinr_35:
  ds_read_b128 a[184:187], v5 offset:30720
  v_mfma_f32_16x16x32_bf16 v[148:151], a[136:139], a[36:39], v[148:151]
  s_add_u32 s47, s39, 16384
  v_cvt_pk_bf16_f32 v250, v250, v251
  v_accvgpr_write_b32 a207, v250
  v_mfma_f32_16x16x32_bf16 v[148:151], a[140:143], a[40:43], v[148:151]
  s_add_u32 s48, s39, 32768
  ds_read_b128 a[188:191], v5 offset:31744
  v_mul_f32 v252, s76, v252
  v_mfma_f32_16x16x32_bf16 v[148:151], a[144:147], a[44:47], v[148:151]
  s_waitcnt lgkmcnt(7)
  buffer_load_dwordx4 v4, s[12:15], s66 offen offset:3072 sc1 lds
  v_mfma_f32_16x16x32_bf16 v[148:151], a[148:151], a[48:51], v[148:151]
  s_add_u32 s67, s67, 0x8000
  v_mul_f32 v253, s76, v253
  v_cvt_pk_bf16_f32 v252, v252, v253
  v_mfma_f32_16x16x32_bf16 v[148:151], a[152:155], a[52:55], v[148:151]
  s_and_b32 s67, s67, 0x1ffff
  v_add_u32 v5, s67, v1
  v_accvgpr_write_b32 a238, v252
  v_mfma_f32_16x16x32_bf16 v[152:155], a[156:159], a[0:3], 0
  s_mul_i32 s66, s68, 2162688
  v_mul_f32 v254, s76, v254
  v_mul_f32 v255, s76, v255
  v_mfma_f32_16x16x32_bf16 v[152:155], a[160:163], a[4:7], v[152:155]
  s_waitcnt lgkmcnt(3)
  v_cvt_pk_bf16_f32 v254, v254, v255
  v_accvgpr_write_b32 a239, v254
  v_mfma_f32_16x16x32_bf16 v[152:155], a[164:167], a[8:11], v[152:155]
  s_waitcnt lgkmcnt(0)
  v_mfma_f32_16x16x32_bf16 v[152:155], a[168:171], a[12:15], v[152:155]
  s_barrier
  v_mfma_f32_16x16x32_bf16 v[152:155], a[172:175], a[16:19], v[152:155]
  s_add_u32 m0, s65, 131072
  ds_read_b128 a[128:131], v5 offset:0
  ds_read_b128 a[132:135], v5 offset:1024
  v_mfma_f32_16x16x32_bf16 v[152:155], a[176:179], a[20:23], v[152:155]
  ds_read_b128 a[136:139], v5 offset:2048
  ds_read_b128 a[140:143], v5 offset:3072
  v_mfma_f32_16x16x32_bf16 v[152:155], a[180:183], a[24:27], v[152:155]
  ds_read_b128 a[144:147], v5 offset:4096
  v_mfma_f32_16x16x32_bf16 v[156:159], a[156:159], a[28:31], 0
  buffer_load_dwordx4 v3, s[12:15], s66 offen offset:0 sc1 lds
  v_mfma_f32_16x16x32_bf16 v[156:159], a[160:163], a[32:35], v[156:159]
  ds_read_b128 a[148:151], v5 offset:5120
  v_mfma_f32_16x16x32_bf16 v[156:159], a[164:167], a[36:39], v[156:159]
  buffer_store_dwordx4 v[224:227], v1, s[12:15], s100 offen offset:0
  v_mfma_f32_16x16x32_bf16 v[156:159], a[168:171], a[40:43], v[156:159]
  ds_read_b128 a[152:155], v5 offset:6144
  v_mfma_f32_16x16x32_bf16 v[156:159], a[172:175], a[44:47], v[156:159]
  buffer_load_dwordx4 v3, s[12:15], s66 offen offset:1024 sc1 lds
  v_mfma_f32_16x16x32_bf16 v[156:159], a[176:179], a[48:51], v[156:159]
  ds_read_b128 a[156:159], v5 offset:7168
  v_mfma_f32_16x16x32_bf16 v[156:159], a[180:183], a[52:55], v[156:159]
  s_waitcnt lgkmcnt(6)
  buffer_load_dwordx4 v3, s[12:15], s66 offen offset:2048 sc1 lds
  v_mfma_f32_16x16x32_bf16 v[176:179], a[184:187], a[0:3], 0
  ds_read_b128 a[160:163], v5 offset:8192
  v_mfma_f32_16x16x32_bf16 v[176:179], a[188:191], a[4:7], v[176:179]
  v_mfma_f32_16x16x32_bf16 v[176:179], a[128:131], a[8:11], v[176:179]
  ds_read_b128 a[164:167], v5 offset:9216
  v_mfma_f32_16x16x32_bf16 v[176:179], a[132:135], a[12:15], v[176:179]
  s_waitcnt lgkmcnt(5)
  buffer_load_dwordx4 v3, s[12:15], s66 offen offset:3072 sc1 lds
  v_mfma_f32_16x16x32_bf16 v[176:179], a[136:139], a[16:19], v[176:179]
  ds_read_b128 a[168:171], v5 offset:10240
  v_mfma_f32_16x16x32_bf16 v[176:179], a[140:143], a[20:23], v[176:179]
  s_add_u32 s66, s66, 0x4000
  v_mfma_f32_16x16x32_bf16 v[176:179], a[144:147], a[24:27], v[176:179]
  ds_read_b128 a[172:175], v5 offset:11264
  v_mfma_f32_16x16x32_bf16 v[180:183], a[184:187], a[28:31], 0
  v_mfma_f32_16x16x32_bf16 v[180:183], a[188:191], a[32:35], v[180:183]
  ds_read_b128 a[176:179], v5 offset:12288
  v_mfma_f32_16x16x32_bf16 v[180:183], a[128:131], a[36:39], v[180:183]
  s_sub_u32 s97, s67, 32768
  v_mfma_f32_16x16x32_bf16 v[180:183], a[132:135], a[40:43], v[180:183]
  ds_read_b128 a[180:183], v5 offset:13312
  v_mfma_f32_16x16x32_bf16 v[180:183], a[136:139], a[44:47], v[180:183]
  s_waitcnt lgkmcnt(7)
  buffer_store_dwordx4 v[228:231], v1, s[12:15], s100 offen offset:1024
  v_mfma_f32_16x16x32_bf16 v[180:183], a[140:143], a[48:51], v[180:183]
  s_and_b32 s97, s97, 0x1ffff
  ds_read_b128 a[184:187], v5 offset:14336
  v_mfma_f32_16x16x32_bf16 v[180:183], a[144:147], a[52:55], v[180:183]
  v_mfma_f32_16x16x32_bf16 v[184:187], a[148:151], a[0:3], 0
  ds_read_b128 a[188:191], v5 offset:15360
  v_mfma_f32_16x16x32_bf16 v[184:187], a[152:155], a[4:7], v[184:187]
  s_waitcnt lgkmcnt(5)
  s_add_u32 m0, s97, s65
  v_mfma_f32_16x16x32_bf16 v[184:187], a[156:159], a[8:11], v[184:187]
  ds_read_b128 a[128:131], v5 offset:16384
  v_mfma_f32_16x16x32_bf16 v[184:187], a[160:163], a[12:15], v[184:187]
  v_mfma_f32_16x16x32_bf16 v[184:187], a[164:167], a[16:19], v[184:187]
  ds_read_b128 a[132:135], v5 offset:17408
  v_mfma_f32_16x16x32_bf16 v[184:187], a[168:171], a[20:23], v[184:187]
  s_waitcnt lgkmcnt(6)
  buffer_load_dwordx4 v3, s[12:15], s66 offen offset:0 sc1 lds
  v_mfma_f32_16x16x32_bf16 v[184:187], a[172:175], a[24:27], v[184:187]
  ds_read_b128 a[136:139], v5 offset:18432
  v_mfma_f32_16x16x32_bf16 v[188:191], a[148:151], a[28:31], 0
  buffer_load_dwordx4 v3, s[12:15], s66 offen offset:1024 sc1 lds
  v_mfma_f32_16x16x32_bf16 v[188:191], a[152:155], a[32:35], v[188:191]
  ds_read_b128 a[140:143], v5 offset:19456
  v_mfma_f32_16x16x32_bf16 v[188:191], a[156:159], a[36:39], v[188:191]
  v_mfma_f32_16x16x32_bf16 v[188:191], a[160:163], a[40:43], v[188:191]
  ds_read_b128 a[144:147], v5 offset:20480
  v_mfma_f32_16x16x32_bf16 v[188:191], a[164:167], a[44:47], v[188:191]
  buffer_load_dwordx4 v3, s[12:15], s66 offen offset:2048 sc1 lds
  v_mfma_f32_16x16x32_bf16 v[188:191], a[168:171], a[48:51], v[188:191]
  ds_read_b128 a[148:151], v5 offset:21504
  v_mfma_f32_16x16x32_bf16 v[188:191], a[172:175], a[52:55], v[188:191]
  s_waitcnt lgkmcnt(6)
  v_mfma_f32_16x16x32_bf16 v[208:211], a[176:179], a[0:3], 0
  ds_read_b128 a[152:155], v5 offset:22528
  v_mfma_f32_16x16x32_bf16 v[208:211], a[180:183], a[4:7], v[208:211]
  buffer_load_dwordx4 v3, s[12:15], s66 offen offset:3072 sc1 lds
  v_mfma_f32_16x16x32_bf16 v[208:211], a[184:187], a[8:11], v[208:211]
  ds_read_b128 a[156:159], v5 offset:23552
  v_mfma_f32_16x16x32_bf16 v[208:211], a[188:191], a[12:15], v[208:211]
  s_waitcnt lgkmcnt(5)
  s_add_u32 m0, m0, 0x4000
  v_mfma_f32_16x16x32_bf16 v[208:211], a[128:131], a[16:19], v[208:211]
  ds_read_b128 a[160:163], v5 offset:24576
  v_mfma_f32_16x16x32_bf16 v[208:211], a[132:135], a[20:23], v[208:211]
  buffer_store_dwordx4 v[232:235], v1, s[12:15], s100 offen offset:2048
  v_mfma_f32_16x16x32_bf16 v[208:211], a[136:139], a[24:27], v[208:211]
  ds_read_b128 a[164:167], v5 offset:25600
  v_mfma_f32_16x16x32_bf16 v[212:215], a[176:179], a[28:31], 0
  buffer_load_dwordx4 v4, s[12:15], s66 offen offset:0 sc1 lds
  v_mfma_f32_16x16x32_bf16 v[212:215], a[180:183], a[32:35], v[212:215]
  ds_read_b128 a[168:171], v5 offset:26624
  v_mfma_f32_16x16x32_bf16 v[212:215], a[184:187], a[36:39], v[212:215]
  buffer_load_dwordx4 v4, s[12:15], s66 offen offset:1024 sc1 lds
  v_mfma_f32_16x16x32_bf16 v[212:215], a[188:191], a[40:43], v[212:215]
  ds_read_b128 a[172:175], v5 offset:27648
  v_mfma_f32_16x16x32_bf16 v[212:215], a[128:131], a[44:47], v[212:215]
  s_waitcnt lgkmcnt(7)
  v_mfma_f32_16x16x32_bf16 v[212:215], a[132:135], a[48:51], v[212:215]
  ds_read_b128 a[176:179], v5 offset:28672
  v_mfma_f32_16x16x32_bf16 v[212:215], a[136:139], a[52:55], v[212:215]
  buffer_load_dwordx4 v4, s[12:15], s66 offen offset:2048 sc1 lds
  v_mfma_f32_16x16x32_bf16 v[216:219], a[140:143], a[0:3], 0
  ds_read_b128 a[180:183], v5 offset:29696
  v_mfma_f32_16x16x32_bf16 v[216:219], a[144:147], a[4:7], v[216:219]
  s_waitcnt lgkmcnt(5)
  buffer_load_dwordx4 v4, s[12:15], s66 offen offset:3072 sc1 lds
  v_mfma_f32_16x16x32_bf16 v[216:219], a[148:151], a[8:11], v[216:219]
  ds_read_b128 a[184:187], v5 offset:30720
  v_mfma_f32_16x16x32_bf16 v[216:219], a[152:155], a[12:15], v[216:219]
  v_mfma_f32_16x16x32_bf16 v[216:219], a[156:159], a[16:19], v[216:219]
  ds_read_b128 a[188:191], v5 offset:31744
  v_mfma_f32_16x16x32_bf16 v[216:219], a[160:163], a[20:23], v[216:219]
  s_waitcnt lgkmcnt(6)
  v_mfma_f32_16x16x32_bf16 v[216:219], a[164:167], a[24:27], v[216:219]
  s_add_u32 s66, s66, 0x8000
  buffer_store_dwordx4 v[236:239], v1, s[12:15], s100 offen offset:3072
  v_mfma_f32_16x16x32_bf16 v[220:223], a[140:143], a[28:31], 0
  s_add_u32 m0, s67, s65
  v_mfma_f32_16x16x32_bf16 v[220:223], a[144:147], a[32:35], v[220:223]
  s_add_u32 s67, s67, 0x8000
  v_mfma_f32_16x16x32_bf16 v[220:223], a[148:151], a[36:39], v[220:223]
  s_and_b32 s67, s67, 0x1ffff
  v_add_u32 v5, s67, v1
  v_mfma_f32_16x16x32_bf16 v[220:223], a[152:155], a[40:43], v[220:223]
  s_waitcnt lgkmcnt(0)
  s_add_u32 s100, s100, 32768
  v_mfma_f32_16x16x32_bf16 v[220:223], a[156:159], a[44:47], v[220:223]
  s_barrier
  v_mfma_f32_16x16x32_bf16 v[220:223], a[160:163], a[48:51], v[220:223]
  ds_read_b128 a[128:131], v5 offset:0
  ds_read_b128 a[132:135], v5 offset:1024
  v_mfma_f32_16x16x32_bf16 v[220:223], a[164:167], a[52:55], v[220:223]
  buffer_load_dwordx4 v3, s[12:15], s66 offen offset:0 sc1 lds
  v_mfma_f32_16x16x32_bf16 v[240:243], a[168:171], a[0:3], 0
  ds_read_b128 a[136:139], v5 offset:2048
  ds_read_b128 a[140:143], v5 offset:3072
  v_mfma_f32_16x16x32_bf16 v[240:243], a[172:175], a[4:7], v[240:243]
  ds_read_b128 a[144:147], v5 offset:4096
  v_mfma_f32_16x16x32_bf16 v[240:243], a[176:179], a[8:11], v[240:243]
  ds_read_b128 a[148:151], v5 offset:5120
  v_lshlrev_b32 v7, 1, v13
  v_mfma_f32_16x16x32_bf16 v[240:243], a[180:183], a[12:15], v[240:243]
  s_waitcnt lgkmcnt(5)
  v_mfma_f32_16x16x32_bf16 v[240:243], a[184:187], a[16:19], v[240:243]
  s_getpc_b64 s[96:97]
L_kf_kernel_pc_31:
  ds_read_b128 a[152:155], v5 offset:6144
  v_mfma_f32_16x16x32_bf16 v[240:243], a[188:191], a[20:23], v[240:243]
  s_add_u32 s96, s96, kf_kernel_tab+4096-L_kf_kernel_pc_31
  v_mfma_f32_16x16x32_bf16 v[240:243], a[128:131], a[24:27], v[240:243]
  s_addc_u32 s97, s97, 0
  ds_read_b128 a[156:159], v5 offset:7168
  v_mfma_f32_16x16x32_bf16 v[244:247], a[168:171], a[28:31], 0
  buffer_load_dwordx4 v3, s[12:15], s66 offen offset:1024 sc1 lds
  v_mfma_f32_16x16x32_bf16 v[244:247], a[172:175], a[32:35], v[244:247]
  ds_read_b128 a[160:163], v5 offset:8192
  v_mfma_f32_16x16x32_bf16 v[244:247], a[176:179], a[36:39], v[244:247]
  global_load_dword v10, v7, s[96:97] offset:4
  v_mfma_f32_16x16x32_bf16 v[244:247], a[180:183], a[40:43], v[244:247]
  ds_read_b128 a[164:167], v5 offset:9216
  v_mfma_f32_16x16x32_bf16 v[244:247], a[184:187], a[44:47], v[244:247]
  s_waitcnt lgkmcnt(7)
  global_load_dword v7, v7, s[96:97]
  v_mfma_f32_16x16x32_bf16 v[244:247], a[188:191], a[48:51], v[244:247]
  ds_read_b128 a[168:171], v5 offset:10240
  v_mfma_f32_16x16x32_bf16 v[244:247], a[128:131], a[52:55], v[244:247]
  v_mfma_f32_16x16x32_bf16 v[248:251], a[132:135], a[0:3], 0
  ds_read_b128 a[172:175], v5 offset:11264
  v_mfma_f32_16x16x32_bf16 v[248:251], a[136:139], a[4:7], v[248:251]
  s_waitcnt lgkmcnt(5)
  buffer_load_dwordx4 v3, s[12:15], s66 offen offset:2048 sc1 lds
  v_mfma_f32_16x16x32_bf16 v[248:251], a[140:143], a[8:11], v[248:251]
  ds_read_b128 a[176:179], v5 offset:12288
  v_mfma_f32_16x16x32_bf16 v[248:251], a[144:147], a[12:15], v[248:251]
  v_mfma_f32_16x16x32_bf16 v[248:251], a[148:151], a[16:19], v[248:251]
  ds_read_b128 a[180:183], v5 offset:13312
  v_mfma_f32_16x16x32_bf16 v[248:251], a[152:155], a[20:23], v[248:251]
  s_waitcnt lgkmcnt(6)
  v_mfma_f32_16x16x32_bf16 v[248:251], a[156:159], a[24:27], v[248:251]
  ds_read_b128 a[184:187], v5 offset:14336
  v_mfma_f32_16x16x32_bf16 v[252:255], a[132:135], a[28:31], 0
  v_mfma_f32_16x16x32_bf16 v[252:255], a[136:139], a[32:35], v[252:255]
  ds_read_b128 a[188:191], v5 offset:15360
  v_mfma_f32_16x16x32_bf16 v[252:255], a[140:143], a[36:39], v[252:255]
  buffer_load_dwordx4 v3, s[12:15], s66 offen offset:3072 sc1 lds
  v_mfma_f32_16x16x32_bf16 v[252:255], a[144:147], a[40:43], v[252:255]
  s_add_u32 m0, m0, 0x4000
  ds_read_b128 a[128:131], v5 offset:16384
  v_mfma_f32_16x16x32_bf16 v[252:255], a[148:151], a[44:47], v[252:255]
  v_mfma_f32_16x16x32_bf16 v[252:255], a[152:155], a[48:51], v[252:255]
  ds_read_b128 a[132:135], v5 offset:17408
  v_mfma_f32_16x16x32_bf16 v[252:255], a[156:159], a[52:55], v[252:255]
  s_waitcnt lgkmcnt(6)
  v_mfma_f32_16x16x32_bf16 v[144:147], a[160:163], a[56:59], v[144:147]
  ds_read_b128 a[136:139], v5 offset:18432
  v_mfma_f32_16x16x32_bf16 v[144:147], a[164:167], a[60:63], v[144:147]
  v_mfma_f32_16x16x32_bf16 v[144:147], a[168:171], a[64:67], v[144:147]
  ds_read_b128 a[140:143], v5 offset:19456
  v_mfma_f32_16x16x32_bf16 v[144:147], a[172:175], a[68:71], v[144:147]
  s_waitcnt lgkmcnt(5)
  buffer_load_dwordx4 v4, s[12:15], s66 offen offset:0 sc1 lds
  v_mfma_f32_16x16x32_bf16 v[144:147], a[176:179], a[72:75], v[144:147]
  ds_read_b128 a[144:147], v5 offset:20480
  v_mfma_f32_16x16x32_bf16 v[144:147], a[180:183], a[76:79], v[144:147]
  v_mfma_f32_16x16x32_bf16 v[144:147], a[184:187], a[80:83], v[144:147]
  ds_read_b128 a[148:151], v5 offset:21504
  v_mfma_f32_16x16x32_bf16 v[148:151], a[160:163], a[84:87], v[148:151]
  v_mfma_f32_16x16x32_bf16 v[148:151], a[164:167], a[88:91], v[148:151]
  ds_read_b128 a[152:155], v5 offset:22528
  v_mfma_f32_16x16x32_bf16 v[148:151], a[168:171], a[92:95], v[148:151]
  v_mfma_f32_16x16x32_bf16 v[148:151], a[172:175], a[96:99], v[148:151]
  ds_read_b128 a[156:159], v5 offset:23552
  v_mfma_f32_16x16x32_bf16 v[148:151], a[176:179], a[100:103], v[148:151]
  s_waitcnt lgkmcnt(7)
  buffer_load_dwordx4 v4, s[12:15], s66 offen offset:1024 sc1 lds
  v_mfma_f32_16x16x32_bf16 v[148:151], a[180:183], a[104:107], v[148:151]
  ds_read_b128 a[160:163], v5 offset:24576
  v_mul_f32 v144, s76, v144
  v_mfma_f32_16x16x32_bf16 v[148:151], a[184:187], a[108:111], v[148:151]
  v_mul_f32 v145, s76, v145
  v_cvt_pk_bf16_f32 v144, v144, v145
  v_mfma_f32_16x16x32_bf16 v[152:155], a[188:191], a[56:59], v[152:155]
  ds_read_b128 a[164:167], v5 offset:25600
  v_accvgpr_write_b32 a208, v144
  v_mfma_f32_16x16x32_bf16 v[152:155], a[128:131], a[60:63], v[152:155]
  s_waitcnt lgkmcnt(5)
  v_mul_f32 v146, s76, v146
  v_mul_f32 v147, s76, v147
  v_mfma_f32_16x16x32_bf16 v[152:155], a[132:135], a[64:67], v[152:155]
  ds_read_b128 a[168:171], v5 offset:26624
  v_mul_f32 v148, s76, v148
  v_mfma_f32_16x16x32_bf16 v[152:155], a[136:139], a[68:71], v[152:155]
  v_mul_f32 v149, s76, v149
  v_cvt_pk_bf16_f32 v148, v148, v149
  v_mfma_f32_16x16x32_bf16 v[152:155], a[140:143], a[72:75], v[152:155]
  ds_read_b128 a[172:175], v5 offset:27648
  v_accvgpr_write_b32 a240, v148
  v_mfma_f32_16x16x32_bf16 v[152:155], a[144:147], a[76:79], v[152:155]
  s_waitcnt lgkmcnt(6)
  buffer_load_dwordx4 v4, s[12:15], s66 offen offset:2048 sc1 lds
  v_mfma_f32_16x16x32_bf16 v[152:155], a[148:151], a[80:83], v[152:155]
  ds_read_b128 a[176:179], v5 offset:28672
  v_mul_f32 v150, s76, v150
  v_mfma_f32_16x16x32_bf16 v[156:159], a[188:191], a[84:87], v[156:159]
  v_mul_f32 v151, s76, v151
  v_cvt_pk_bf16_f32 v146, v146, v147
  v_mfma_f32_16x16x32_bf16 v[156:159], a[128:131], a[88:91], v[156:159]
  ds_read_b128 a[180:183], v5 offset:29696
  v_cvt_pk_bf16_f32 v150, v150, v151
  v_mfma_f32_16x16x32_bf16 v[156:159], a[132:135], a[92:95], v[156:159]
  v_accvgpr_write_b32 a209, v146
  v_accvgpr_write_b32 a241, v150
  v_mfma_f32_16x16x32_bf16 v[156:159], a[136:139], a[96:99], v[156:159]
  ds_read_b128 a[184:187], v5 offset:30720
  v_mul_f32 v152, s76, v152
  v_mfma_f32_16x16x32_bf16 v[156:159], a[140:143], a[100:103], v[156:159]
  v_mul_f32 v153, s76, v153
  v_cvt_pk_bf16_f32 v152, v152, v153
  v_mfma_f32_16x16x32_bf16 v[156:159], a[144:147], a[104:107], v[156:159]
  ds_read_b128 a[188:191], v5 offset:31744
  v_accvgpr_write_b32 a210, v152
  v_mfma_f32_16x16x32_bf16 v[156:159], a[148:151], a[108:111], v[156:159]
  s_waitcnt lgkmcnt(6)
  buffer_load_dwordx4 v4, s[12:15], s66 offen offset:3072 sc1 lds
  v_mfma_f32_16x16x32_bf16 v[176:179], a[152:155], a[56:59], v[176:179]
  s_add_u32 s66, s66, 0x8000
  v_mul_f32 v154, s76, v154
  v_mul_f32 v155, s76, v155
  v_mfma_f32_16x16x32_bf16 v[176:179], a[156:159], a[60:63], v[176:179]
  s_add_u32 m0, s67, s65
  v_cvt_pk_bf16_f32 v154, v154, v155
  v_mul_f32 v156, s76, v156
  v_mfma_f32_16x16x32_bf16 v[176:179], a[160:163], a[64:67], v[176:179]
  s_add_u32 s67, s67, 0x8000
  v_mul_f32 v157, s76, v157
  v_cvt_pk_bf16_f32 v156, v156, v157
  v_mfma_f32_16x16x32_bf16 v[176:179], a[164:167], a[68:71], v[176:179]
  s_waitcnt lgkmcnt(3)
  s_and_b32 s67, s67, 0x1ffff
  v_add_u32 v5, s67, v1
  v_mfma_f32_16x16x32_bf16 v[176:179], a[168:171], a[72:75], v[176:179]
  s_waitcnt vmcnt(26) lgkmcnt(0)
  v_accvgpr_write_b32 a242, v156
  v_mul_f32 v158, s76, v158
  v_mfma_f32_16x16x32_bf16 v[176:179], a[172:175], a[76:79], v[176:179]
  s_barrier
  v_mul_f32 v159, s76, v159
  v_cvt_pk_bf16_f32 v158, v158, v159
  v_mfma_f32_16x16x32_bf16 v[176:179], a[176:179], a[80:83], v[176:179]
  ds_read_b128 a[128:131], v5 offset:0
  ds_read_b128 a[132:135], v5 offset:1024
  v_mfma_f32_16x16x32_bf16 v[180:183], a[152:155], a[84:87], v[180:183]
  buffer_load_dwordx4 v3, s[12:15], s66 offen offset:0 sc1 lds
  v_mfma_f32_16x16x32_bf16 v[180:183], a[156:159], a[88:91], v[180:183]
  ds_read_b128 a[136:139], v5 offset:2048
  ds_read_b128 a[140:143], v5 offset:3072
  v_mfma_f32_16x16x32_bf16 v[180:183], a[160:163], a[92:95], v[180:183]
  ds_read_b128 a[144:147], v5 offset:4096
  v_mul_f32 v176, s76, v176
  v_mfma_f32_16x16x32_bf16 v[180:183], a[164:167], a[96:99], v[180:183]
  ds_read_b128 a[148:151], v5 offset:5120
  v_mul_f32 v177, s76, v177
  v_mfma_f32_16x16x32_bf16 v[180:183], a[168:171], a[100:103], v[180:183]
  v_cvt_pk_bf16_f32 v176, v176, v177
  v_accvgpr_write_b32 a212, v176
  v_mfma_f32_16x16x32_bf16 v[180:183], a[172:175], a[104:107], v[180:183]
  ds_read_b128 a[152:155], v5 offset:6144
  v_mul_f32 v178, s76, v178
  v_mfma_f32_16x16x32_bf16 v[180:183], a[176:179], a[108:111], v[180:183]
  v_mul_f32 v179, s76, v179
  v_cvt_pk_bf16_f32 v178, v178, v179
  v_mfma_f32_16x16x32_bf16 v[184:187], a[180:183], a[56:59], v[184:187]
  ds_read_b128 a[156:159], v5 offset:7168
  v_accvgpr_write_b32 a213, v178
  v_mfma_f32_16x16x32_bf16 v[184:187], a[184:187], a[60:63], v[184:187]
  s_waitcnt lgkmcnt(5)
  buffer_load_dwordx4 v3, s[12:15], s66 offen offset:1024 sc1 lds
  v_mfma_f32_16x16x32_bf16 v[184:187], a[188:191], a[64:67], v[184:187]
  ds_read_b128 a[160:163], v5 offset:8192
  v_mul_f32 v180, s76, v180
  v_mfma_f32_16x16x32_bf16 v[184:187], a[128:131], a[68:71], v[184:187]
  v_mul_f32 v181, s76, v181
  v_cvt_pk_bf16_f32 v180, v180, v181
  v_mfma_f32_16x16x32_bf16 v[184:187], a[132:135], a[72:75], v[184:187]
  ds_read_b128 a[164:167], v5 offset:9216
  v_accvgpr_write_b32 a244, v180
  v_mfma_f32_16x16x32_bf16 v[184:187], a[136:139], a[76:79], v[184:187]
  s_waitcnt lgkmcnt(6)
  v_mul_f32 v182, s76, v182
  v_mul_f32 v183, s76, v183
  v_mfma_f32_16x16x32_bf16 v[184:187], a[140:143], a[80:83], v[184:187]
  ds_read_b128 a[168:171], v5 offset:10240
  v_cvt_pk_bf16_f32 v182, v182, v183
  v_mfma_f32_16x16x32_bf16 v[188:191], a[180:183], a[84:87], v[188:191]
  v_accvgpr_write_b32 a245, v182
  v_accvgpr_write_b32 a211, v154
  v_mfma_f32_16x16x32_bf16 v[188:191], a[184:187], a[88:91], v[188:191]
  ds_read_b128 a[172:175], v5 offset:11264
  v_accvgpr_write_b32 a243, v158
  v_mfma_f32_16x16x32_bf16 v[188:191], a[188:191], a[92:95], v[188:191]
  buffer_load_dwordx4 v3, s[12:15], s66 offen offset:2048 sc1 lds
  v_mfma_f32_16x16x32_bf16 v[188:191], a[128:131], a[96:99], v[188:191]
  ds_read_b128 a[176:179], v5 offset:12288
  v_mul_f32 v184, s76, v184
  v_mfma_f32_16x16x32_bf16 v[188:191], a[132:135], a[100:103], v[188:191]
  v_mul_f32 v185, s76, v185
  v_cvt_pk_bf16_f32 v184, v184, v185
  v_mfma_f32_16x16x32_bf16 v[188:191], a[136:139], a[104:107], v[188:191]
  ds_read_b128 a[180:183], v5 offset:13312
  v_accvgpr_write_b32 a214, v184
  v_mfma_f32_16x16x32_bf16 v[188:191], a[140:143], a[108:111], v[188:191]
  s_waitcnt lgkmcnt(6)
  v_mul_f32 v186, s76, v186
  v_mul_f32 v187, s76, v187
  v_mfma_f32_16x16x32_bf16 v[208:211], a[144:147], a[56:59], v[208:211]
  ds_read_b128 a[184:187], v5 offset:14336
  v_cvt_pk_bf16_f32 v186, v186, v187
  v_mfma_f32_16x16x32_bf16 v[208:211], a[148:151], a[60:63], v[208:211]
  v_accvgpr_write_b32 a215, v186
  v_mfma_f32_16x16x32_bf16 v[208:211], a[152:155], a[64:67], v[208:211]
  ds_read_b128 a[188:191], v5 offset:15360
  v_mul_f32 v188, s76, v188
  v_mfma_f32_16x16x32_bf16 v[208:211], a[156:159], a[68:71], v[208:211]
  s_waitcnt lgkmcnt(5)
  buffer_load_dwordx4 v3, s[12:15], s66 offen offset:3072 sc1 lds
  v_mfma_f32_16x16x32_bf16 v[208:211], a[160:163], a[72:75], v[208:211]
  s_add_u32 m0, m0, 0x4000
  ds_read_b128 a[128:131], v5 offset:16384
  v_mul_f32 v189, s76, v189
  v_mfma_f32_16x16x32_bf16 v[208:211], a[164:167], a[76:79], v[208:211]
  v_cvt_pk_bf16_f32 v188, v188, v189
  v_accvgpr_write_b32 a246, v188
  v_mfma_f32_16x16x32_bf16 v[208:211], a[168:171], a[80:83], v[208:211]
  ds_read_b128 a[132:135], v5 offset:17408
  v_mul_f32 v190, s76, v190
  v_mfma_f32_16x16x32_bf16 v[212:215], a[144:147], a[84:87], v[212:215]
  v_mul_f32 v191, s76, v191
  v_cvt_pk_bf16_f32 v190, v190, v191
  v_mfma_f32_16x16x32_bf16 v[212:215], a[148:151], a[88:91], v[212:215]
  ds_read_b128 a[136:139], v5 offset:18432
  v_accvgpr_write_b32 a247, v190
  v_mfma_f32_16x16x32_bf16 v[212:215], a[152:155], a[92:95], v[212:215]
  v_mul_f32 v208, s76, v208
  v_mul_f32 v209, s76, v209
  v_mfma_f32_16x16x32_bf16 v[212:215], a[156:159], a[96:99], v[212:215]
  ds_read_b128 a[140:143], v5 offset:19456
  v_cvt_pk_bf16_f32 v208, v208, v209
  v_mfma_f32_16x16x32_bf16 v[212:215], a[160:163], a[100:103], v[212:215]
  s_waitcnt lgkmcnt(7)
  buffer_load_dwordx4 v4, s[12:15], s66 offen offset:0 sc1 lds
  v_mfma_f32_16x16x32_bf16 v[212:215], a[164:167], a[104:107], v[212:215]
  ds_read_b128 a[144:147], v5 offset:20480
  v_accvgpr_write_b32 a216, v208
  v_mfma_f32_16x16x32_bf16 v[212:215], a[168:171], a[108:111], v[212:215]
  v_mul_f32 v210, s76, v210
  v_mul_f32 v211, s76, v211
  v_mfma_f32_16x16x32_bf16 v[216:219], a[172:175], a[56:59], v[216:219]
  ds_read_b128 a[148:151], v5 offset:21504
  v_cvt_pk_bf16_f32 v210, v210, v211
  v_mfma_f32_16x16x32_bf16 v[216:219], a[176:179], a[60:63], v[216:219]
  s_waitcnt lgkmcnt(5)
  v_accvgpr_write_b32 a217, v210
  v_mfma_f32_16x16x32_bf16 v[216:219], a[180:183], a[64:67], v[216:219]
  ds_read_b128 a[152:155], v5 offset:22528
  v_mul_f32 v212, s76, v212
  v_mfma_f32_16x16x32_bf16 v[216:219], a[184:187], a[68:71], v[216:219]
  v_mul_f32 v213, s76, v213
  v_cvt_pk_bf16_f32 v212, v212, v213
  v_mfma_f32_16x16x32_bf16 v[216:219], a[188:191], a[72:75], v[216:219]
  ds_read_b128 a[156:159], v5 offset:23552
  v_accvgpr_write_b32 a248, v212
  v_mfma_f32_16x16x32_bf16 v[216:219], a[128:131], a[76:79], v[216:219]
  s_waitcnt lgkmcnt(6)
  buffer_load_dwordx4 v4, s[12:15], s66 offen offset:1024 sc1 lds
  v_mfma_f32_16x16x32_bf16 v[216:219], a[132:135], a[80:83], v[216:219]
  ds_read_b128 a[160:163], v5 offset:24576
  v_mul_f32 v214, s76, v214
  v_mfma_f32_16x16x32_bf16 v[220:223], a[172:175], a[84:87], v[220:223]
  v_mul_f32 v215, s76, v215
  v_cvt_pk_bf16_f32 v214, v214, v215
  v_mfma_f32_16x16x32_bf16 v[220:223], a[176:179], a[88:91], v[220:223]
  ds_read_b128 a[164:167], v5 offset:25600
  v_accvgpr_write_b32 a249, v214
  v_mfma_f32_16x16x32_bf16 v[220:223], a[180:183], a[92:95], v[220:223]
  v_mul_f32 v216, s76, v216
  v_mul_f32 v217, s76, v217
  v_mfma_f32_16x16x32_bf16 v[220:223], a[184:187], a[96:99], v[220:223]
  ds_read_b128 a[168:171], v5 offset:26624
  v_cvt_pk_bf16_f32 v216, v216, v217
  v_mfma_f32_16x16x32_bf16 v[220:223], a[188:191], a[100:103], v[220:223]
  v_accvgpr_write_b32 a218, v216
  v_mul_f32 v218, s76, v218
  v_mfma_f32_16x16x32_bf16 v[220:223], a[128:131], a[104:107], v[220:223]
  ds_read_b128 a[172:175], v5 offset:27648
  v_mul_f32 v219, s76, v219
  v_mfma_f32_16x16x32_bf16 v[220:223], a[132:135], a[108:111], v[220:223]
  s_waitcnt lgkmcnt(6)
  buffer_load_dwordx4 v4, s[12:15], s66 offen offset:2048 sc1 lds
  v_mfma_f32_16x16x32_bf16 v[240:243], a[136:139], a[56:59], v[240:243]
  ds_read_b128 a[176:179], v5 offset:28672
  v_cvt_pk_bf16_f32 v218, v218, v219
  v_mfma_f32_16x16x32_bf16 v[240:243], a[140:143], a[60:63], v[240:243]
  v_accvgpr_write_b32 a219, v218
  v_mfma_f32_16x16x32_bf16 v[240:243], a[144:147], a[64:67], v[240:243]
  ds_read_b128 a[180:183], v5 offset:29696
  v_mul_f32 v220, s76, v220
  v_mfma_f32_16x16x32_bf16 v[240:243], a[148:151], a[68:71], v[240:243]
  s_waitcnt lgkmcnt(5)
  v_mul_f32 v221, s76, v221
  v_cvt_pk_bf16_f32 v220, v220, v221
  v_mfma_f32_16x16x32_bf16 v[240:243], a[152:155], a[72:75], v[240:243]
  ds_read_b128 a[184:187], v5 offset:30720
  v_accvgpr_write_b32 a250, v220
  v_mfma_f32_16x16x32_bf16 v[240:243], a[156:159], a[76:79], v[240:243]
  v_mul_f32 v222, s76, v222
  v_mul_f32 v223, s76, v223
  v_mfma_f32_16x16x32_bf16 v[240:243], a[160:163], a[80:83], v[240:243]
  ds_read_b128 a[188:191], v5 offset:31744
  v_cvt_pk_bf16_f32 v222, v222, v223
  v_mfma_f32_16x16x32_bf16 v[244:247], a[136:139], a[84:87], v[244:247]
  buffer_load_dwordx4 v4, s[12:15], s66 offen offset:3072 sc1 lds
  v_mfma_f32_16x16x32_bf16 v[244:247], a[140:143], a[88:91], v[244:247]
  s_add_u32 s66, s66, 0x8000
  v_accvgpr_write_b32 a251, v222
  v_mfma_f32_16x16x32_bf16 v[244:247], a[144:147], a[92:95], v[244:247]
  s_add_u32 m0, s67, s65
  v_mul_f32 v240, s76, v240
  v_mul_f32 v241, s76, v241
  v_mfma_f32_16x16x32_bf16 v[244:247], a[148:151], a[96:99], v[244:247]
  s_add_u32 s67, s67, 0x8000
  v_cvt_pk_bf16_f32 v240, v240, v241
  v_accvgpr_write_b32 a220, v240
  v_mfma_f32_16x16x32_bf16 v[244:247], a[152:155], a[100:103], v[244:247]
  s_waitcnt lgkmcnt(5)
  s_and_b32 s67, s67, 0x1ffff
  v_add_u32 v5, s67, v1
  v_mfma_f32_16x16x32_bf16 v[244:247], a[156:159], a[104:107], v[244:247]
  s_waitcnt vmcnt(19) lgkmcnt(0)
  v_mul_f32 v242, s76, v242
  v_mul_f32 v243, s76, v243
  v_mfma_f32_16x16x32_bf16 v[244:247], a[160:163], a[108:111], v[244:247]
  s_barrier
  v_cvt_pk_bf16_f32 v242, v242, v243
  v_accvgpr_write_b32 a221, v242
  v_mfma_f32_16x16x32_bf16 v[248:251], a[164:167], a[56:59], v[248:251]
  ds_read_b128 a[0:3], v6 offset:0
  v_mfma_f32_16x16x32_bf16 v[248:251], a[168:171], a[60:63], v[248:251]
  ds_read_b128 a[4:7], v6 offset:1024
  v_mfma_f32_16x16x32_bf16 v[248:251], a[172:175], a[64:67], v[248:251]
  buffer_load_dwordx4 v3, s[12:15], s66 offen offset:0 sc1 lds
  v_mfma_f32_16x16x32_bf16 v[248:251], a[176:179], a[68:71], v[248:251]
  ds_read_b128 a[8:11], v6 offset:2048
  ds_read_b128 a[12:15], v6 offset:3072
  v_mfma_f32_16x16x32_bf16 v[248:251], a[180:183], a[72:75], v[248:251]
  ds_read_b128 a[16:19], v6 offset:4096
  v_mul_f32 v244, s76, v244
  v_mfma_f32_16x16x32_bf16 v[248:251], a[184:187], a[76:79], v[248:251]
  ds_read_b128 a[20:23], v6 offset:5120
  v_mul_f32 v245, s76, v245
  v_mfma_f32_16x16x32_bf16 v[248:251], a[188:191], a[80:83], v[248:251]
  ds_read_b128 a[24:27], v6 offset:6144
  v_cvt_pk_bf16_f32 v244, v244, v245
  v_mfma_f32_16x16x32_bf16 v[252:255], a[164:167], a[84:87], v[252:255]
  ds_read_b128 a[28:31], v6 offset:7168
  v_accvgpr_write_b32 a252, v244
  v_mfma_f32_16x16x32_bf16 v[252:255], a[168:171], a[88:91], v[252:255]
  ds_read_b128 a[128:131], v6 offset:8192
  v_mul_f32 v246, s76, v246
  v_mfma_f32_16x16x32_bf16 v[252:255], a[172:175], a[92:95], v[252:255]
  ds_read_b128 a[132:135], v6 offset:9216
  v_mul_f32 v248, s76, v248
  v_mfma_f32_16x16x32_bf16 v[252:255], a[176:179], a[96:99], v[252:255]
  ds_read_b128 a[136:139], v6 offset:10240
  v_mul_f32 v249, s76, v249
  v_mfma_f32_16x16x32_bf16 v[252:255], a[180:183], a[100:103], v[252:255]
  buffer_load_dwordx4 v3, s[12:15], s66 offen offset:1024 sc1 lds
  v_mfma_f32_16x16x32_bf16 v[252:255], a[184:187], a[104:107], v[252:255]
  ds_read_b128 a[140:143], v6 offset:11264
  ds_read_b128 a[144:147], v6 offset:12288
  v_mfma_f32_16x16x32_bf16 v[252:255], a[188:191], a[108:111], v[252:255]
  s_waitcnt lgkmcnt(9)
  ds_read_b128 a[148:151], v6 offset:13312
  v_cvt_pk_bf16_f32 v248, v248, v249
  v_mfma_f32_16x16x32_bf16 v[32:35], a[0:3], a[192:195], v[48:51]
  ds_read_b128 a[152:155], v6 offset:14336
  v_accvgpr_write_b32 a222, v248
  v_mfma_f32_16x16x32_bf16 v[32:35], a[4:7], a[196:199], v[32:35]
  ds_read_b128 a[156:159], v6 offset:15360
  v_mul_f32 v250, s76, v250
  v_mfma_f32_16x16x32_bf16 v[32:35], a[8:11], a[200:203], v[32:35]
  buffer_load_dword v12, v14, s[12:15], s61 offen sc1
  v_mfma_f32_16x16x32_bf16 v[32:35], a[12:15], a[204:207], v[32:35]
  s_waitcnt lgkmcnt(8)
  v_mul_f32 v251, s76, v251
  v_cvt_pk_bf16_f32 v250, v250, v251
  v_mfma_f32_16x16x32_bf16 v[32:35], a[16:19], a[208:211], v[32:35]
  ds_read_b128 a[160:163], v5 offset:0
  v_accvgpr_write_b32 a223, v250
  v_mfma_f32_16x16x32_bf16 v[32:35], a[20:23], a[212:215], v[32:35]
  ds_read_b128 a[164:167], v5 offset:1024
  v_mul_f32 v247, s76, v247
  v_mfma_f32_16x16x32_bf16 v[32:35], a[24:27], a[216:219], v[32:35]
  ds_read_b128 a[168:171], v5 offset:2048
  v_cvt_pk_bf16_f32 v246, v246, v247
  v_mfma_f32_16x16x32_bf16 v[32:35], a[28:31], a[220:223], v[32:35]
  s_waitcnt lgkmcnt(7)
  buffer_load_dwordx4 v3, s[12:15], s66 offen offset:2048 sc1 lds
  v_mfma_f32_16x16x32_bf16 v[40:43], a[128:131], a[192:195], v[56:59]
  ds_read_b128 a[172:175], v5 offset:3072
  v_accvgpr_write_b32 a253, v246
  v_mfma_f32_16x16x32_bf16 v[40:43], a[132:135], a[196:199], v[40:43]
  ds_read_b128 a[176:179], v5 offset:4096
  v_mul_f32 v252, s76, v252
  v_mfma_f32_16x16x32_bf16 v[40:43], a[136:139], a[200:203], v[40:43]
  s_sub_u32 s71, s71, 1
  v_max3_f32 v94, v32, v33, v34
  v_mul_f32 v253, s76, v253
  v_mfma_f32_16x16x32_bf16 v[40:43], a[140:143], a[204:207], v[40:43]
  s_waitcnt lgkmcnt(5)
  ds_read_b128 a[180:183], v5 offset:5120
  v_cvt_pk_bf16_f32 v252, v252, v253
  v_mfma_f32_16x16x32_bf16 v[40:43], a[144:147], a[208:211], v[40:43]
  ds_read_b128 a[184:187], v5 offset:6144
  v_accvgpr_write_b32 a254, v252
  v_mfma_f32_16x16x32_bf16 v[40:43], a[148:151], a[212:215], v[40:43]
  v_mul_f32 v254, s76, v254
  v_mul_f32 v255, s76, v255
  v_mfma_f32_16x16x32_bf16 v[40:43], a[152:155], a[216:219], v[40:43]
  ds_read_b128 a[188:191], v5 offset:7168
  v_cvt_pk_bf16_f32 v254, v254, v255
  v_mfma_f32_16x16x32_bf16 v[40:43], a[156:159], a[220:223], v[40:43]
  v_accvgpr_write_b32 a255, v254
  v_mfma_f32_16x16x32_bf16 v[36:39], a[0:3], a[224:227], v[52:55]
  ds_read_b128 a[32:35], v5 offset:8192
  v_mfma_f32_16x16x32_bf16 v[36:39], a[4:7], a[228:231], v[36:39]
  buffer_load_dwordx4 v3, s[12:15], s66 offen offset:3072 sc1 lds
  v_mfma_f32_16x16x32_bf16 v[36:39], a[8:11], a[232:235], v[36:39]
  s_add_u32 m0, m0, 0x4000
  ds_read_b128 a[36:39], v5 offset:9216
  v_max3_f32 v94, v94, v35, v40
  v_mfma_f32_16x16x32_bf16 v[36:39], a[12:15], a[236:239], v[36:39]
  v_max3_f32 v94, v94, v41, v42
  v_max_f32 v94, v94, v43
  v_mfma_f32_16x16x32_bf16 v[36:39], a[16:19], a[240:243], v[36:39]
  v_mov_b32 v18, v94
  v_mov_b32 v19, v94
  v_mfma_f32_16x16x32_bf16 v[36:39], a[20:23], a[244:247], v[36:39]
  ds_read_b128 a[40:43], v5 offset:10240
  v_permlane32_swap_b32 v18, v19
  v_mfma_f32_16x16x32_bf16 v[36:39], a[24:27], a[248:251], v[36:39]
  ds_read_b128 a[44:47], v5 offset:11264
  v_max_f32 v94, v18, v19
  v_mfma_f32_16x16x32_bf16 v[36:39], a[28:31], a[252:255], v[36:39]
  v_mov_b32 v18, v94
  v_mov_b32 v19, v94
  v_mfma_f32_16x16x32_bf16 v[44:47], a[128:131], a[224:227], v[60:63]
  ds_read_b128 a[112:115], v5 offset:12288
  v_permlane16_swap_b32 v18, v19
  v_mfma_f32_16x16x32_bf16 v[44:47], a[132:135], a[228:231], v[44:47]
  v_max_f32 v94, v18, v19
  v_ceil_f32 v90, v94
  v_mfma_f32_16x16x32_bf16 v[44:47], a[136:139], a[232:235], v[44:47]
  ds_read_b128 a[116:119], v5 offset:13312
  v_sub_f32 v32, v32, v90
  v_mfma_f32_16x16x32_bf16 v[44:47], a[140:143], a[236:239], v[44:47]
  buffer_load_dwordx4 v4, s[12:15], s66 offen offset:0 sc1 lds
  ds_read_b128 a[120:123], v5 offset:14336
  v_mfma_f32_16x16x32_bf16 v[44:47], a[144:147], a[240:243], v[44:47]
  ds_read_b128 a[124:127], v5 offset:15360
  v_sub_f32 v33, v33, v90
  v_mfma_f32_16x16x32_bf16 v[44:47], a[148:151], a[244:247], v[44:47]
  v_sub_f32 v34, v34, v90
  v_sub_f32 v35, v35, v90
  v_mfma_f32_16x16x32_bf16 v[44:47], a[152:155], a[248:251], v[44:47]
  v_sub_f32 v40, v40, v90
  v_sub_f32 v41, v41, v90
  v_mfma_f32_16x16x32_bf16 v[44:47], a[156:159], a[252:255], v[44:47]
  v_sub_f32 v42, v42, v90
  v_sub_f32 v43, v43, v90
  v_mfma_f32_32x32x16_bf16 v[192:207], v[24:27], v[24:27], 0
  ds_read_b128 a[0:3], v5 offset:16384
  v_exp_f32 v72, v32
  v_exp_f32 v73, v33
  v_max3_f32 v95, v36, v37, v38
  v_mfma_f32_32x32x16_bf16 v[208:223], v[24:27], v[24:27], 0
  ds_read_b128 a[4:7], v5 offset:17408
  v_exp_f32 v74, v34
  v_exp_f32 v75, v35
  v_max3_f32 v95, v95, v39, v44
  v_mfma_f32_32x32x16_bf16 v[224:239], v[24:27], v[24:27], 0
  v_max3_f32 v95, v95, v45, v46
  v_exp_f32 v76, v40
  v_max_f32 v95, v95, v47
  v_mov_b32 v20, v95
  v_mov_b32 v21, v95
  v_exp_f32 v77, v41
  v_exp_f32 v78, v42
  v_exp_f32 v79, v43
  v_cvt_pk_bf16_f32 v64, v72, v73
  v_cvt_pk_bf16_f32 v65, v74, v75
  v_cvt_pk_bf16_f32 v66, v76, v77
  v_cvt_pk_bf16_f32 v67, v78, v79
  v_mfma_f32_32x32x16_bf16 v[240:255], v[24:27], v[24:27], 0
  s_waitcnt lgkmcnt(14)
  ds_read_b128 a[8:11], v5 offset:18432
  v_permlane32_swap_b32 v20, v21
  v_max_f32 v95, v20, v21
  v_mov_b32 v20, v95
  v_mov_b32 v21, v95
  v_sub_f32 v48, v48, v90
  v_mfma_f32_16x16x32_bf16 v[128:131], a[160:163], v[64:67], 0
  v_permlane16_swap_b32 v20, v21
  v_max_f32 v95, v20, v21
  v_mfma_f32_16x16x32_bf16 v[132:135], a[164:167], v[64:67], 0
  buffer_load_dwordx4 v4, s[12:15], s66 offen offset:1024 sc1 lds
  ds_read_b128 a[12:15], v5 offset:19456
  v_mfma_f32_16x16x32_bf16 v[136:139], a[168:171], v[64:67], 0
  v_ceil_f32 v91, v95
  v_sub_f32 v36, v36, v91
  v_mfma_f32_16x16x32_bf16 v[140:143], a[172:175], v[64:67], 0
  s_waitcnt lgkmcnt(12)
  ds_read_b128 a[16:19], v5 offset:20480
  v_sub_f32 v37, v37, v91
  v_mfma_f32_16x16x32_bf16 v[144:147], a[176:179], v[64:67], 0
  ds_read_b128 a[20:23], v5 offset:21504
  v_sub_f32 v38, v38, v91
  v_mfma_f32_16x16x32_bf16 v[148:151], a[180:183], v[64:67], 0
  v_sub_f32 v39, v39, v91
  v_sub_f32 v44, v44, v91
  v_mfma_f32_16x16x32_bf16 v[152:155], a[184:187], v[64:67], 0
  ds_read_b128 a[24:27], v5 offset:22528
  v_sub_f32 v45, v45, v91
  v_mfma_f32_16x16x32_bf16 v[156:159], a[188:191], v[64:67], 0
  s_waitcnt lgkmcnt(11)
  v_sub_f32 v46, v46, v91
  v_sub_f32 v47, v47, v91
  v_mfma_f32_16x16x32_bf16 v[160:163], a[32:35], v[64:67], 0
  ds_read_b128 a[28:31], v5 offset:23552
  v_sub_f32 v52, v52, v91
  v_mfma_f32_16x16x32_bf16 v[164:167], a[36:39], v[64:67], 0
  v_sub_f32 v53, v53, v91
  v_sub_f32 v54, v54, v91
  v_mfma_f32_16x16x32_bf16 v[168:171], a[40:43], v[64:67], 0
  ds_read_b128 a[128:131], v5 offset:24576
  v_sub_f32 v55, v55, v91
  v_mfma_f32_16x16x32_bf16 v[172:175], a[44:47], v[64:67], 0
  s_waitcnt lgkmcnt(9)
  ds_read_b128 a[132:135], v5 offset:25600
  v_sub_f32 v60, v60, v91
  v_sub_f32 v49, v49, v90
  v_sub_f32 v61, v61, v91
  v_sub_f32 v50, v50, v90
  v_sub_f32 v62, v62, v91
  v_sub_f32 v51, v51, v90
  v_sub_f32 v63, v63, v91
  v_sub_f32 v56, v56, v90
  v_mov_b32 v89, 0
  v_sub_f32 v57, v57, v90
  v_sub_f32 v58, v58, v90
  v_sub_f32 v59, v59, v90
  v_add_f32 v88, v72, v73
  v_add_f32 v88, v88, v74
  v_add_f32 v88, v88, v75
  v_add_f32 v88, v88, v76
  v_add_f32 v88, v88, v77
  v_add_f32 v88, v88, v78
  v_add_f32 v88, v88, v79
  v_mfma_f32_16x16x32_bf16 v[176:179], a[112:115], v[64:67], 0
  v_exp_f32 v80, v36
  v_mfma_f32_16x16x32_bf16 v[180:183], a[116:119], v[64:67], 0
  ds_read_b128 a[136:139], v5 offset:26624
  s_waitcnt vmcnt(4)
  v_cmp_eq_u32 vcc, 0, v12
  v_mfma_f32_16x16x32_bf16 v[184:187], a[120:123], v[64:67], 0
  s_and_b32 s97, vcc_lo, s17
  ds_read_b128 a[140:143], v5 offset:27648
  s_cbranch_scc1 L_kf_kernel_spin_37
L_kf_kernel_spinr_38:
  s_nop 0
  s_cmp_lg_u32 s56, 0
  s_cbranch_scc1 L_kf_kernel_wb_40
L_kf_kernel_wbr_41:
  buffer_store_dword v11, v0, s[12:15], s0 offen offset:16 sc1
  v_mfma_f32_16x16x32_bf16 v[188:191], a[124:127], v[64:67], 0
  s_waitcnt lgkmcnt(8)
  v_exp_f32 v81, v37
  v_exp_f32 v82, v38
  v_exp_f32 v83, v39
  v_exp_f32 v84, v44
  v_exp_f32 v85, v45
  v_add_f32 v93, v80, v81
  v_add_f32 v93, v93, v82
  v_add_f32 v93, v93, v83
  v_cvt_pk_bf16_f32 v68, v80, v81
  v_cvt_pk_bf16_f32 v69, v82, v83
  v_add_f32 v93, v93, v84
  s_cmp_lg_u32 s49, 0
  s_cbranch_scc1 L_kf_kernel_qst_27
  s_cmp_eq_u32 s69, 0
  s_cbranch_scc1 L_kf_kernel_at0_19
  .p2align 6
L_kf_kernel_aloop_18:
  v_mfma_f32_16x16x32_bf16 v[32:35], a[0:3], a[192:195], v[48:51]
  s_add_u32 s97, s67, s65
  v_exp_f32 v86, v46
  v_mfma_f32_16x16x32_bf16 v[32:35], a[4:7], a[196:199], v[32:35]
  s_add_u32 s67, s67, 0x8000
  ds_read_b128 a[144:147], v5 offset:28672
  v_add_f32 v93, v93, v85
  v_mfma_f32_16x16x32_bf16 v[32:35], a[8:11], a[200:203], v[32:35]
  s_and_b32 s67, s67, 0x1ffff
  buffer_load_dwordx4 v4, s[12:15], s66 offen offset:2048 sc1 lds
  v_mfma_f32_16x16x32_bf16 v[32:35], a[12:15], a[204:207], v[32:35]
  s_waitcnt lgkmcnt(5)
  ds_read_b128 a[148:151], v5 offset:29696
  v_add_f32 v93, v93, v86
  v_mfma_f32_16x16x32_bf16 v[32:35], a[16:19], a[208:211], v[32:35]
  s_add_u32 s98, s66, 0x8000
  ds_read_b128 a[152:155], v5 offset:30720
  v_cvt_pk_bf16_f32 v70, v84, v85
  v_mfma_f32_16x16x32_bf16 v[32:35], a[20:23], a[212:215], v[32:35]
  s_cmp_eq_u32 s71, 3
  v_exp_f32 v87, v47
  v_mfma_f32_16x16x32_bf16 v[32:35], a[24:27], a[216:219], v[32:35]
  s_cselect_b32 s98, s63, s98
  ds_read_b128 a[156:159], v5 offset:31744
  v_add_f32 v93, v93, v87
  v_mfma_f32_16x16x32_bf16 v[32:35], a[28:31], a[220:223], v[32:35]
  s_waitcnt lgkmcnt(4)
  v_cvt_pk_bf16_f32 v71, v86, v87
  v_cmp_lt_f32 vcc, s75, v93
  v_mfma_f32_16x16x32_bf16 v[40:43], a[128:131], a[192:195], v[56:59]
  buffer_load_dwordx4 v4, s[12:15], s66 offen offset:3072 sc1 lds
  v_mfma_f32_16x16x32_bf16 v[40:43], a[132:135], a[196:199], v[40:43]
  s_cbranch_vccnz L_kf_kernel_rare_46
L_kf_kernel_rarer_47:
  v_add_f32 v89, v89, v93
  v_mfma_f32_16x16x32_bf16 v[40:43], a[136:139], a[200:203], v[40:43]
  s_mov_b32 m0, s97
  v_exp_f32 v72, v32
  v_mfma_f32_16x16x32_bf16 v[40:43], a[140:143], a[204:207], v[40:43]
  s_waitcnt lgkmcnt(0)
  v_exp_f32 v73, v33
  v_mfma_f32_16x16x32_bf16 v[40:43], a[144:147], a[208:211], v[40:43]
  s_waitcnt vmcnt(16)
  v_add_u32 v5, s67, v1
  s_mov_b32 s66, s98
  v_mfma_f32_16x16x32_bf16 v[40:43], a[148:151], a[212:215], v[40:43]
  s_barrier
  v_mfma_f32_16x16x32_bf16 v[40:43], a[152:155], a[216:219], v[40:43]
  v_exp_f32 v74, v34
  v_mfma_f32_16x16x32_bf16 v[40:43], a[156:159], a[220:223], v[40:43]
  v_exp_f32 v75, v35
  v_mfma_f32_16x16x32_bf16 v[192:195], a[160:163], v[68:71], v[192:195]
  buffer_load_dwordx4 v3, s[12:15], s66 offen offset:0 sc1 lds
  v_mfma_f32_16x16x32_bf16 v[196:199], a[164:167], v[68:71], v[196:199]
  s_sub_u32 s71, s71, 1
  ds_read_b128 a[160:163], v5 offset:0
  v_add_f32 v92, v72, v73
  v_mfma_f32_16x16x32_bf16 v[200:203], a[168:171], v[68:71], v[200:203]
  v_exp_f32 v76, v40
  v_mfma_f32_16x16x32_bf16 v[204:207], a[172:175], v[68:71], v[204:207]
  ds_read_b128 a[164:167], v5 offset:1024
  v_add_f32 v92, v92, v74
  v_mfma_f32_16x16x32_bf16 v[208:211], a[176:179], v[68:71], v[208:211]
  ds_read_b128 a[168:171], v5 offset:2048
  v_add_f32 v92, v92, v75
  v_mfma_f32_16x16x32_bf16 v[212:215], a[180:183], v[68:71], v[212:215]
  v_exp_f32 v77, v41
  v_mfma_f32_16x16x32_bf16 v[216:219], a[184:187], v[68:71], v[216:219]
  ds_read_b128 a[172:175], v5 offset:3072
  v_cvt_pk_bf16_f32 v64, v72, v73
  v_mfma_f32_16x16x32_bf16 v[220:223], a[188:191], v[68:71], v[220:223]
  v_exp_f32 v78, v42
  v_mfma_f32_16x16x32_bf16 v[224:227], a[32:35], v[68:71], v[224:227]
  ds_read_b128 a[176:179], v5 offset:4096
  v_cvt_pk_bf16_f32 v65, v74, v75
  v_mfma_f32_16x16x32_bf16 v[228:231], a[36:39], v[68:71], v[228:231]
  ds_read_b128 a[180:183], v5 offset:5120
  v_add_f32 v92, v92, v76
  v_mfma_f32_16x16x32_bf16 v[232:235], a[40:43], v[68:71], v[232:235]
  v_exp_f32 v79, v43
  v_mfma_f32_16x16x32_bf16 v[236:239], a[44:47], v[68:71], v[236:239]
  ds_read_b128 a[184:187], v5 offset:6144
  v_add_f32 v92, v92, v77
  v_mfma_f32_16x16x32_bf16 v[240:243], a[112:115], v[68:71], v[240:243]
  buffer_load_dwordx4 v3, s[12:15], s66 offen offset:1024 sc1 lds
  v_mfma_f32_16x16x32_bf16 v[244:247], a[116:119], v[68:71], v[244:247]
  ds_read_b128 a[188:191], v5 offset:7168
  v_add_f32 v92, v92, v78
  v_mfma_f32_16x16x32_bf16 v[248:251], a[120:123], v[68:71], v[248:251]
  v_add_f32 v92, v92, v79
  v_cvt_pk_bf16_f32 v66, v76, v77
  v_mfma_f32_16x16x32_bf16 v[252:255], a[124:127], v[68:71], v[252:255]
  ds_read_b128 a[32:35], v5 offset:8192
  v_cvt_pk_bf16_f32 v67, v78, v79
  v_mfma_f32_16x16x32_bf16 v[36:39], a[0:3], a[224:227], v[52:55]
  ds_read_b128 a[36:39], v5 offset:9216
  v_cmp_lt_f32 vcc, s75, v92
  v_mfma_f32_16x16x32_bf16 v[36:39], a[4:7], a[228:231], v[36:39]
  s_cbranch_vccnz L_kf_kernel_rare_49
L_kf_kernel_rarer_50:
  v_mfma_f32_16x16x32_bf16 v[36:39], a[8:11], a[232:235], v[36:39]
  ds_read_b128 a[40:43], v5 offset:10240
  v_add_f32 v88, v88, v92
  v_mfma_f32_16x16x32_bf16 v[36:39], a[12:15], a[236:239], v[36:39]
  buffer_load_dwordx4 v3, s[12:15], s66 offen offset:2048 sc1 lds
  v_mfma_f32_16x16x32_bf16 v[36:39], a[16:19], a[240:243], v[36:39]
  ds_read_b128 a[44:47], v5 offset:11264
  v_mfma_f32_16x16x32_bf16 v[36:39], a[20:23], a[244:247], v[36:39]
  ds_read_b128 a[112:115], v5 offset:12288
  v_mfma_f32_16x16x32_bf16 v[36:39], a[24:27], a[248:251], v[36:39]
  v_mfma_f32_16x16x32_bf16 v[36:39], a[28:31], a[252:255], v[36:39]
  ds_read_b128 a[116:119], v5 offset:13312
  v_mfma_f32_16x16x32_bf16 v[44:47], a[128:131], a[224:227], v[60:63]
  buffer_load_dwordx4 v3, s[12:15], s66 offen offset:3072 sc1 lds
  v_mfma_f32_16x16x32_bf16 v[44:47], a[132:135], a[228:231], v[44:47]
  s_cmp_eq_u32 s71, s78
  ds_read_b128 a[120:123], v5 offset:14336
  v_mfma_f32_16x16x32_bf16 v[44:47], a[136:139], a[232:235], v[44:47]
  s_cselect_b32 s98, s77, 0
  v_exp_f32 v80, v36
  v_mfma_f32_16x16x32_bf16 v[44:47], a[140:143], a[236:239], v[44:47]
  ds_read_b128 a[124:127], v5 offset:15360
  v_mfma_f32_16x16x32_bf16 v[44:47], a[144:147], a[240:243], v[44:47]
  s_add_u32 m0, m0, 0x4000
  ds_read_b128 a[0:3], v5 offset:16384
  v_mfma_f32_16x16x32_bf16 v[44:47], a[148:151], a[244:247], v[44:47]
  s_add_u32 s66, s66, s98
  v_exp_f32 v81, v37
  v_mfma_f32_16x16x32_bf16 v[44:47], a[152:155], a[248:251], v[44:47]
  ds_read_b128 a[4:7], v5 offset:17408
  v_add_f32 v93, v80, v81
  v_mfma_f32_16x16x32_bf16 v[44:47], a[156:159], a[252:255], v[44:47]
  s_waitcnt lgkmcnt(14)
  v_exp_f32 v82, v38
  v_mfma_f32_16x16x32_bf16 v[128:131], a[160:163], v[64:67], v[128:131]
  ds_read_b128 a[8:11], v5 offset:18432
  v_add_f32 v93, v93, v82
  v_mfma_f32_16x16x32_bf16 v[132:135], a[164:167], v[64:67], v[132:135]
  ds_read_b128 a[12:15], v5 offset:19456
  v_mfma_f32_16x16x32_bf16 v[136:139], a[168:171], v[64:67], v[136:139]
  v_exp_f32 v83, v39
  v_mfma_f32_16x16x32_bf16 v[140:143], a[172:175], v[64:67], v[140:143]
  s_waitcnt lgkmcnt(12)
  ds_read_b128 a[16:19], v5 offset:20480
  v_add_f32 v93, v93, v83
  v_mfma_f32_16x16x32_bf16 v[144:147], a[176:179], v[64:67], v[144:147]
  buffer_load_dwordx4 v4, s[12:15], s66 offen offset:0 sc1 lds
  v_mfma_f32_16x16x32_bf16 v[148:151], a[180:183], v[64:67], v[148:151]
  ds_read_b128 a[20:23], v5 offset:21504
  v_cvt_pk_bf16_f32 v68, v80, v81
  v_mfma_f32_16x16x32_bf16 v[152:155], a[184:187], v[64:67], v[152:155]
  v_exp_f32 v84, v44
  v_mfma_f32_16x16x32_bf16 v[156:159], a[188:191], v[64:67], v[156:159]
  s_waitcnt lgkmcnt(10)
  ds_read_b128 a[24:27], v5 offset:22528
  v_cvt_pk_bf16_f32 v69, v82, v83
  v_mfma_f32_16x16x32_bf16 v[160:163], a[32:35], v[64:67], v[160:163]
  ds_read_b128 a[28:31], v5 offset:23552
  v_add_f32 v93, v93, v84
  v_mfma_f32_16x16x32_bf16 v[164:167], a[36:39], v[64:67], v[164:167]
  buffer_load_dwordx4 v4, s[12:15], s66 offen offset:1024 sc1 lds
  v_mfma_f32_16x16x32_bf16 v[168:171], a[40:43], v[64:67], v[168:171]
  ds_read_b128 a[128:131], v5 offset:24576
  v_mfma_f32_16x16x32_bf16 v[172:175], a[44:47], v[64:67], v[172:175]
  s_waitcnt lgkmcnt(9)
  v_exp_f32 v85, v45
  v_mfma_f32_16x16x32_bf16 v[176:179], a[112:115], v[64:67], v[176:179]
  ds_read_b128 a[132:135], v5 offset:25600
  v_mfma_f32_16x16x32_bf16 v[180:183], a[116:119], v[64:67], v[180:183]
  s_waitcnt lgkmcnt(6)
  ds_read_b128 a[136:139], v5 offset:26624
  v_mfma_f32_16x16x32_bf16 v[184:187], a[120:123], v[64:67], v[184:187]
  s_cmp_gt_u32 s71, s36
  ds_read_b128 a[140:143], v5 offset:27648
  v_mfma_f32_16x16x32_bf16 v[188:191], a[124:127], v[64:67], v[188:191]
  s_cbranch_scc1 L_kf_kernel_aloop_18
  s_cmp_lg_u32 s36, 4
  s_cbranch_scc1 L_kf_kernel_e1_28
  s_cmp_eq_u32 s35, 255
  v_fma_f32 v48, v112, s52, v48
  v_fma_f32 v49, v113, s52, v49
  v_fma_f32 v50, v114, s52, v50
  v_fma_f32 v51, v115, s52, v51
  v_fma_f32 v56, v112, s53, v56
  v_fma_f32 v57, v113, s53, v57
  v_fma_f32 v58, v114, s53, v58
  v_fma_f32 v59, v115, s53, v59
  s_cbranch_scc1 L_kf_kernel_alastm_22
  v_mfma_f32_16x16x32_bf16 v[32:35], a[0:3], a[192:195], v[48:51]
  s_add_u32 s97, s67, s65
  v_exp_f32 v86, v46
  v_mfma_f32_16x16x32_bf16 v[32:35], a[4:7], a[196:199], v[32:35]
  s_add_u32 s67, s67, 0x8000
  ds_read_b128 a[144:147], v5 offset:28672
  v_add_f32 v93, v93, v85
  v_mfma_f32_16x16x32_bf16 v[32:35], a[8:11], a[200:203], v[32:35]
  s_and_b32 s67, s67, 0x1ffff
  buffer_load_dwordx4 v4, s[12:15], s66 offen offset:2048 sc1 lds
  v_mfma_f32_16x16x32_bf16 v[32:35], a[12:15], a[204:207], v[32:35]
  s_waitcnt lgkmcnt(5)
  ds_read_b128 a[148:151], v5 offset:29696
  v_add_f32 v93, v93, v86
  v_mfma_f32_16x16x32_bf16 v[32:35], a[16:19], a[208:211], v[32:35]
  s_add_u32 s60, s79, 0
  ds_read_b128 a[152:155], v5 offset:30720
  v_cvt_pk_bf16_f32 v70, v84, v85
  v_mfma_f32_16x16x32_bf16 v[32:35], a[20:23], a[212:215], v[32:35]
  s_add_u32 s98, s66, 0x8000
  v_exp_f32 v87, v47
  v_mfma_f32_16x16x32_bf16 v[32:35], a[24:27], a[216:219], v[32:35]
  s_cmp_eq_u32 s71, 3
  ds_read_b128 a[156:159], v5 offset:31744
  v_add_f32 v93, v93, v87
  v_mfma_f32_16x16x32_bf16 v[32:35], a[28:31], a[220:223], v[32:35]
  s_waitcnt lgkmcnt(4)
  buffer_load_dwordx4 a[48:51], v1, s[12:15], s60 offen offset:0 sc1
  s_cselect_b32 s98, s63, s98
  v_cvt_pk_bf16_f32 v71, v86, v87
  v_cmp_lt_f32 vcc, s75, v93
  v_mfma_f32_16x16x32_bf16 v[40:43], a[128:131], a[192:195], v[56:59]
  buffer_load_dwordx4 v4, s[12:15], s66 offen offset:3072 sc1 lds
  v_mfma_f32_16x16x32_bf16 v[40:43], a[132:135], a[196:199], v[40:43]
  s_cbranch_vccnz L_kf_kernel_rare_53
L_kf_kernel_rarer_54:
  v_add_f32 v89, v89, v93
  v_mfma_f32_16x16x32_bf16 v[40:43], a[136:139], a[200:203], v[40:43]
  s_mov_b32 m0, s97
  v_exp_f32 v72, v32
  v_mfma_f32_16x16x32_bf16 v[40:43], a[140:143], a[204:207], v[40:43]
  s_waitcnt lgkmcnt(0)
  buffer_load_dwordx4 a[52:55], v1, s[12:15], s60 offen offset:1024 sc1
  v_exp_f32 v73, v33
  v_mfma_f32_16x16x32_bf16 v[40:43], a[144:147], a[208:211], v[40:43]
  s_waitcnt vmcnt(18)
  v_add_u32 v5, s67, v1
  s_mov_b32 s66, s98
  v_mfma_f32_16x16x32_bf16 v[40:43], a[148:151], a[212:215], v[40:43]
  s_barrier
  buffer_load_dwordx2 v[96:97], v9, s[28:31], s3 offen offset:0
  v_mfma_f32_16x16x32_bf16 v[40:43], a[152:155], a[216:219], v[40:43]
  v_exp_f32 v74, v34
  v_mfma_f32_16x16x32_bf16 v[40:43], a[156:159], a[220:223], v[40:43]
  v_exp_f32 v75, v35
  v_mfma_f32_16x16x32_bf16 v[192:195], a[160:163], v[68:71], v[192:195]
  buffer_load_dwordx4 v3, s[12:15], s66 offen offset:0 sc1 lds
  v_mfma_f32_16x16x32_bf16 v[196:199], a[164:167], v[68:71], v[196:199]
  s_sub_u32 s71, s71, 1
  ds_read_b128 a[160:163], v5 offset:0
  v_add_f32 v92, v72, v73
  v_mfma_f32_16x16x32_bf16 v[200:203], a[168:171], v[68:71], v[200:203]
  v_exp_f32 v76, v40
  v_mfma_f32_16x16x32_bf16 v[204:207], a[172:175], v[68:71], v[204:207]
  ds_read_b128 a[164:167], v5 offset:1024
  v_add_f32 v92, v92, v74
  v_mfma_f32_16x16x32_bf16 v[208:211], a[176:179], v[68:71], v[208:211]
  ds_read_b128 a[168:171], v5 offset:2048
  v_add_f32 v92, v92, v75
  v_mfma_f32_16x16x32_bf16 v[212:215], a[180:183], v[68:71], v[212:215]
  buffer_load_dwordx4 a[56:59], v1, s[12:15], s60 offen offset:2048 sc1
  v_exp_f32 v77, v41
  v_mfma_f32_16x16x32_bf16 v[216:219], a[184:187], v[68:71], v[216:219]
  ds_read_b128 a[172:175], v5 offset:3072
  v_cvt_pk_bf16_f32 v64, v72, v73
  v_mfma_f32_16x16x32_bf16 v[220:223], a[188:191], v[68:71], v[220:223]
  v_exp_f32 v78, v42
  v_mfma_f32_16x16x32_bf16 v[224:227], a[32:35], v[68:71], v[224:227]
  ds_read_b128 a[176:179], v5 offset:4096
  v_cvt_pk_bf16_f32 v65, v74, v75
  v_mfma_f32_16x16x32_bf16 v[228:231], a[36:39], v[68:71], v[228:231]
  ds_read_b128 a[180:183], v5 offset:5120
  v_add_f32 v92, v92, v76
  v_mfma_f32_16x16x32_bf16 v[232:235], a[40:43], v[68:71], v[232:235]
  buffer_load_dwordx4 a[60:63], v1, s[12:15], s60 offen offset:3072 sc1
  v_exp_f32 v79, v43
  v_mfma_f32_16x16x32_bf16 v[236:239], a[44:47], v[68:71], v[236:239]
  ds_read_b128 a[184:187], v5 offset:6144
  v_add_f32 v92, v92, v77
  v_mfma_f32_16x16x32_bf16 v[240:243], a[112:115], v[68:71], v[240:243]
  buffer_load_dwordx4 v3, s[12:15], s66 offen offset:1024 sc1 lds
  v_mfma_f32_16x16x32_bf16 v[244:247], a[116:119], v[68:71], v[244:247]
  ds_read_b128 a[188:191], v5 offset:7168
  v_add_f32 v92, v92, v78
  v_mfma_f32_16x16x32_bf16 v[248:251], a[120:123], v[68:71], v[248:251]
  buffer_load_dwordx2 v[98:99], v9, s[28:31], s3 offen offset:32
  v_add_f32 v92, v92, v79
  v_cvt_pk_bf16_f32 v66, v76, v77
  v_mfma_f32_16x16x32_bf16 v[252:255], a[124:127], v[68:71], v[252:255]
  ds_read_b128 a[32:35], v5 offset:8192
  v_cvt_pk_bf16_f32 v67, v78, v79
  v_mfma_f32_16x16x32_bf16 v[36:39], a[0:3], a[224:227], v[52:55]
  s_add_u32 s60, s79, 4096
  ds_read_b128 a[36:39], v5 offset:9216
  v_cmp_lt_f32 vcc, s75, v92
  v_mfma_f32_16x16x32_bf16 v[36:39], a[4:7], a[228:231], v[36:39]
  s_cbranch_vccnz L_kf_kernel_rare_55
L_kf_kernel_rarer_56:
  v_fma_f32 v48, v112, s58, v48
  v_mfma_f32_16x16x32_bf16 v[36:39], a[8:11], a[232:235], v[36:39]
  ds_read_b128 a[40:43], v5 offset:10240
  v_add_f32 v88, v88, v92
  v_mfma_f32_16x16x32_bf16 v[36:39], a[12:15], a[236:239], v[36:39]
  buffer_load_dwordx4 v3, s[12:15], s66 offen offset:2048 sc1 lds
  buffer_load_dwordx4 a[64:67], v1, s[12:15], s60 offen offset:0 sc1
  v_mfma_f32_16x16x32_bf16 v[36:39], a[16:19], a[240:243], v[36:39]
  ds_read_b128 a[44:47], v5 offset:11264
  v_fma_f32 v49, v113, s58, v49
  v_mfma_f32_16x16x32_bf16 v[36:39], a[20:23], a[244:247], v[36:39]
  ds_read_b128 a[112:115], v5 offset:12288
  v_fma_f32 v50, v114, s58, v50
  v_mfma_f32_16x16x32_bf16 v[36:39], a[24:27], a[248:251], v[36:39]
  buffer_load_dwordx4 a[68:71], v1, s[12:15], s60 offen offset:1024 sc1
  v_mfma_f32_16x16x32_bf16 v[36:39], a[28:31], a[252:255], v[36:39]
  ds_read_b128 a[116:119], v5 offset:13312
  v_fma_f32 v51, v115, s58, v51
  v_mfma_f32_16x16x32_bf16 v[44:47], a[128:131], a[224:227], v[60:63]
  buffer_load_dwordx4 v3, s[12:15], s66 offen offset:3072 sc1 lds
  v_mfma_f32_16x16x32_bf16 v[44:47], a[132:135], a[228:231], v[44:47]
  ds_read_b128 a[120:123], v5 offset:14336
  v_fma_f32 v56, v112, s59, v56
  v_mfma_f32_16x16x32_bf16 v[44:47], a[136:139], a[232:235], v[44:47]
  v_exp_f32 v80, v36
  v_mfma_f32_16x16x32_bf16 v[44:47], a[140:143], a[236:239], v[44:47]
  ds_read_b128 a[124:127], v5 offset:15360
  v_fma_f32 v57, v113, s59, v57
  v_mfma_f32_16x16x32_bf16 v[44:47], a[144:147], a[240:243], v[44:47]
  ds_read_b128 a[0:3], v5 offset:16384
  v_fma_f32 v58, v114, s59, v58
  v_mfma_f32_16x16x32_bf16 v[44:47], a[148:151], a[244:247], v[44:47]
  buffer_load_dwordx2 v[100:101], v9, s[28:31], s3 offen offset:64
  v_exp_f32 v81, v37
  v_mfma_f32_16x16x32_bf16 v[44:47], a[152:155], a[248:251], v[44:47]
  ds_read_b128 a[4:7], v5 offset:17408
  v_add_f32 v93, v80, v81
  v_mfma_f32_16x16x32_bf16 v[44:47], a[156:159], a[252:255], v[44:47]
  s_waitcnt lgkmcnt(14)
  v_exp_f32 v82, v38
  v_mfma_f32_16x16x32_bf16 v[128:131], a[160:163], v[64:67], v[128:131]
  ds_read_b128 a[8:11], v5 offset:18432
  v_add_f32 v93, v93, v82
  v_mfma_f32_16x16x32_bf16 v[132:135], a[164:167], v[64:67], v[132:135]
  ds_read_b128 a[12:15], v5 offset:19456
  buffer_load_dwordx4 a[72:75], v1, s[12:15], s60 offen offset:2048 sc1
  v_mfma_f32_16x16x32_bf16 v[136:139], a[168:171], v[64:67], v[136:139]
  v_exp_f32 v83, v39
  v_mfma_f32_16x16x32_bf16 v[140:143], a[172:175], v[64:67], v[140:143]
  s_waitcnt lgkmcnt(12)
  ds_read_b128 a[16:19], v5 offset:20480
  v_add_f32 v93, v93, v83
  v_mfma_f32_16x16x32_bf16 v[144:147], a[176:179], v[64:67], v[144:147]
  buffer_load_dwordx4 a[76:79], v1, s[12:15], s60 offen offset:3072 sc1
  v_mfma_f32_16x16x32_bf16 v[148:151], a[180:183], v[64:67], v[148:151]
  ds_read_b128 a[20:23], v5 offset:21504
  v_cvt_pk_bf16_f32 v68, v80, v81
  v_mfma_f32_16x16x32_bf16 v[152:155], a[184:187], v[64:67], v[152:155]
  v_exp_f32 v84, v44
  v_mfma_f32_16x16x32_bf16 v[156:159], a[188:191], v[64:67], v[156:159]
  s_waitcnt lgkmcnt(10)
  ds_read_b128 a[24:27], v5 offset:22528
  v_cvt_pk_bf16_f32 v69, v82, v83
  v_mfma_f32_16x16x32_bf16 v[160:163], a[32:35], v[64:67], v[160:163]
  ds_read_b128 a[28:31], v5 offset:23552
  v_add_f32 v93, v93, v84
  v_mfma_f32_16x16x32_bf16 v[164:167], a[36:39], v[64:67], v[164:167]
  buffer_load_dwordx2 v[102:103], v9, s[28:31], s3 offen offset:96
  v_mfma_f32_16x16x32_bf16 v[168:171], a[40:43], v[64:67], v[168:171]
  ds_read_b128 a[128:131], v5 offset:24576
  v_fma_f32 v59, v115, s59, v59
  v_mfma_f32_16x16x32_bf16 v[172:175], a[44:47], v[64:67], v[172:175]
  s_waitcnt lgkmcnt(9)
  v_exp_f32 v85, v45
  v_mfma_f32_16x16x32_bf16 v[176:179], a[112:115], v[64:67], v[176:179]
  ds_read_b128 a[132:135], v5 offset:25600
  v_mfma_f32_16x16x32_bf16 v[180:183], a[116:119], v[64:67], v[180:183]
  s_waitcnt lgkmcnt(6)
  ds_read_b128 a[136:139], v5 offset:26624
  v_mfma_f32_16x16x32_bf16 v[184:187], a[120:123], v[64:67], v[184:187]
  ds_read_b128 a[140:143], v5 offset:27648
  v_mfma_f32_16x16x32_bf16 v[188:191], a[124:127], v[64:67], v[188:191]
L_kf_kernel_at2_20:
  v_mfma_f32_16x16x32_bf16 v[32:35], a[0:3], a[192:195], v[48:51]
  s_add_u32 s97, s67, s65
  v_exp_f32 v86, v46
  v_mfma_f32_16x16x32_bf16 v[32:35], a[4:7], a[196:199], v[32:35]
  s_add_u32 s67, s67, 0x8000
  ds_read_b128 a[144:147], v5 offset:28672
  v_add_f32 v93, v93, v85
  v_mfma_f32_16x16x32_bf16 v[32:35], a[8:11], a[200:203], v[32:35]
  s_add_u32 s60, s79, 57344
  buffer_load_dwordx4 a[80:83], v1, s[12:15], s60 offen offset:0 sc1
  v_mfma_f32_16x16x32_bf16 v[32:35], a[12:15], a[204:207], v[32:35]
  s_waitcnt lgkmcnt(5)
  ds_read_b128 a[148:151], v5 offset:29696
  v_add_f32 v93, v93, v86
  v_mfma_f32_16x16x32_bf16 v[32:35], a[16:19], a[208:211], v[32:35]
  s_and_b32 s67, s67, 0x1ffff
  ds_read_b128 a[152:155], v5 offset:30720
  v_cvt_pk_bf16_f32 v70, v84, v85
  v_mfma_f32_16x16x32_bf16 v[32:35], a[20:23], a[212:215], v[32:35]
  s_add_u32 s98, s66, 0x8000
  v_exp_f32 v87, v47
  v_mfma_f32_16x16x32_bf16 v[32:35], a[24:27], a[216:219], v[32:35]
  s_cmp_eq_u32 s71, 3
  ds_read_b128 a[156:159], v5 offset:31744
  v_add_f32 v93, v93, v87
  v_mfma_f32_16x16x32_bf16 v[32:35], a[28:31], a[220:223], v[32:35]
  s_waitcnt lgkmcnt(4)
  v_cvt_pk_bf16_f32 v71, v86, v87
  v_cmp_lt_f32 vcc, s75, v93
  v_mfma_f32_16x16x32_bf16 v[40:43], a[128:131], a[192:195], v[56:59]
  s_cselect_b32 s98, s63, s98
  buffer_load_dwordx4 a[84:87], v1, s[12:15], s60 offen offset:1024 sc1
  v_mfma_f32_16x16x32_bf16 v[40:43], a[132:135], a[196:199], v[40:43]
  s_cbranch_vccnz L_kf_kernel_rare_57
L_kf_kernel_rarer_58:
  v_add_f32 v89, v89, v93
  v_mfma_f32_16x16x32_bf16 v[40:43], a[136:139], a[200:203], v[40:43]
  s_mov_b32 m0, s97
  v_exp_f32 v72, v32
  v_mfma_f32_16x16x32_bf16 v[40:43], a[140:143], a[204:207], v[40:43]
  s_waitcnt lgkmcnt(0)
  v_exp_f32 v73, v33
  v_mfma_f32_16x16x32_bf16 v[40:43], a[144:147], a[208:211], v[40:43]
  s_waitcnt vmcnt(26)
  v_add_u32 v5, s67, v1
  s_mov_b32 s66, s98
  v_mfma_f32_16x16x32_bf16 v[40:43], a[148:151], a[212:215], v[40:43]
  s_barrier
  buffer_load_dwordx2 v[104:105], v9, s[28:31], s3 offen offset:128
  v_mfma_f32_16x16x32_bf16 v[40:43], a[152:155], a[216:219], v[40:43]
  v_exp_f32 v74, v34
  v_mfma_f32_16x16x32_bf16 v[40:43], a[156:159], a[220:223], v[40:43]
  v_exp_f32 v75, v35
  v_mfma_f32_16x16x32_bf16 v[192:195], a[160:163], v[68:71], v[192:195]
  buffer_load_dwordx4 v3, s[12:15], s66 offen offset:0 sc1 lds
  v_mfma_f32_16x16x32_bf16 v[196:199], a[164:167], v[68:71], v[196:199]
  s_mov_b32 s96, m0
  ds_read_b128 a[160:163], v5 offset:0
  v_add_f32 v92, v72, v73
  s_add_u32 m0, s65, 131072
  v_mfma_f32_16x16x32_bf16 v[200:203], a[168:171], v[68:71], v[200:203]
  s_sub_u32 s71, s71, 1
  buffer_load_dwordx4 v3, s[12:15], s42 offen offset:0 sc1 lds
  v_exp_f32 v76, v40
  v_mfma_f32_16x16x32_bf16 v[204:207], a[172:175], v[68:71], v[204:207]
  ds_read_b128 a[164:167], v5 offset:1024
  buffer_load_dwordx4 a[88:91], v1, s[12:15], s60 offen offset:2048 sc1
  v_add_f32 v92, v92, v74
  v_mfma_f32_16x16x32_bf16 v[208:211], a[176:179], v[68:71], v[208:211]
  ds_read_b128 a[168:171], v5 offset:2048
  v_add_f32 v92, v92, v75
  v_mfma_f32_16x16x32_bf16 v[212:215], a[180:183], v[68:71], v[212:215]
  buffer_load_dwordx4 v3, s[12:15], s42 offen offset:1024 sc1 lds
  v_exp_f32 v77, v41
  v_mfma_f32_16x16x32_bf16 v[216:219], a[184:187], v[68:71], v[216:219]
  ds_read_b128 a[172:175], v5 offset:3072
  v_cvt_pk_bf16_f32 v64, v72, v73
  v_mfma_f32_16x16x32_bf16 v[220:223], a[188:191], v[68:71], v[220:223]
  buffer_load_dwordx4 v3, s[12:15], s42 offen offset:2048 sc1 lds
  v_exp_f32 v78, v42
  v_mfma_f32_16x16x32_bf16 v[224:227], a[32:35], v[68:71], v[224:227]
  ds_read_b128 a[176:179], v5 offset:4096
  buffer_load_dwordx4 a[92:95], v1, s[12:15], s60 offen offset:3072 sc1
  v_cvt_pk_bf16_f32 v65, v74, v75
  v_mfma_f32_16x16x32_bf16 v[228:231], a[36:39], v[68:71], v[228:231]
  ds_read_b128 a[180:183], v5 offset:5120
  v_add_f32 v92, v92, v76
  v_mfma_f32_16x16x32_bf16 v[232:235], a[40:43], v[68:71], v[232:235]
  buffer_load_dwordx4 v3, s[12:15], s42 offen offset:3072 sc1 lds
  v_exp_f32 v79, v43
  v_mfma_f32_16x16x32_bf16 v[236:239], a[44:47], v[68:71], v[236:239]
  ds_read_b128 a[184:187], v5 offset:6144
  v_add_f32 v92, v92, v77
  s_mov_b32 m0, s96
  v_mfma_f32_16x16x32_bf16 v[240:243], a[112:115], v[68:71], v[240:243]
  buffer_load_dwordx4 v3, s[12:15], s66 offen offset:1024 sc1 lds
  v_mfma_f32_16x16x32_bf16 v[244:247], a[116:119], v[68:71], v[244:247]
  ds_read_b128 a[188:191], v5 offset:7168
  buffer_load_dwordx2 v[106:107], v9, s[28:31], s3 offen offset:160
  v_add_f32 v92, v92, v78
  v_mfma_f32_16x16x32_bf16 v[248:251], a[120:123], v[68:71], v[248:251]
  v_add_f32 v92, v92, v79
  v_cvt_pk_bf16_f32 v66, v76, v77
  v_mfma_f32_16x16x32_bf16 v[252:255], a[124:127], v[68:71], v[252:255]
  ds_read_b128 a[32:35], v5 offset:8192
  v_cvt_pk_bf16_f32 v67, v78, v79
  v_mfma_f32_16x16x32_bf16 v[36:39], a[0:3], a[224:227], v[52:55]
  s_add_u32 s60, s79, 61440
  ds_read_b128 a[36:39], v5 offset:9216
  v_cmp_lt_f32 vcc, s75, v92
  v_mfma_f32_16x16x32_bf16 v[36:39], a[4:7], a[228:231], v[36:39]
  s_cbranch_vccnz L_kf_kernel_rare_59
L_kf_kernel_rarer_60:
  v_mfma_f32_16x16x32_bf16 v[36:39], a[8:11], a[232:235], v[36:39]
  ds_read_b128 a[40:43], v5 offset:10240
  buffer_load_dwordx4 a[96:99], v1, s[12:15], s60 offen offset:0 sc1
  v_add_f32 v88, v88, v92
  v_mfma_f32_16x16x32_bf16 v[36:39], a[12:15], a[236:239], v[36:39]
  buffer_load_dwordx4 v3, s[12:15], s66 offen offset:2048 sc1 lds
  v_mfma_f32_16x16x32_bf16 v[36:39], a[16:19], a[240:243], v[36:39]
  ds_read_b128 a[44:47], v5 offset:11264
  v_fma_f32 v48, v112, s52, v52
  v_mfma_f32_16x16x32_bf16 v[36:39], a[20:23], a[244:247], v[36:39]
  ds_read_b128 a[112:115], v5 offset:12288
  v_fma_f32 v49, v113, s52, v53
  v_mfma_f32_16x16x32_bf16 v[36:39], a[24:27], a[248:251], v[36:39]
  buffer_load_dwordx4 a[100:103], v1, s[12:15], s60 offen offset:1024 sc1
  v_mfma_f32_16x16x32_bf16 v[36:39], a[28:31], a[252:255], v[36:39]
  ds_read_b128 a[116:119], v5 offset:13312
  v_fma_f32 v50, v114, s52, v54
  v_mfma_f32_16x16x32_bf16 v[44:47], a[128:131], a[224:227], v[60:63]
  buffer_load_dwordx4 v3, s[12:15], s66 offen offset:3072 sc1 lds
  v_mfma_f32_16x16x32_bf16 v[44:47], a[132:135], a[228:231], v[44:47]
  s_add_u32 m0, m0, 0x4000
  ds_read_b128 a[120:123], v5 offset:14336
  v_fma_f32 v51, v115, s52, v55
  v_mfma_f32_16x16x32_bf16 v[44:47], a[136:139], a[232:235], v[44:47]
  v_exp_f32 v80, v36
  v_mfma_f32_16x16x32_bf16 v[44:47], a[140:143], a[236:239], v[44:47]
  ds_read_b128 a[124:127], v5 offset:15360
  v_fma_f32 v56, v112, s53, v60
  v_mfma_f32_16x16x32_bf16 v[44:47], a[144:147], a[240:243], v[44:47]
  ds_read_b128 a[0:3], v5 offset:16384
  buffer_load_dwordx2 v[108:109], v9, s[28:31], s3 offen offset:192
  v_mfma_f32_16x16x32_bf16 v[44:47], a[148:151], a[244:247], v[44:47]
  v_exp_f32 v81, v37
  v_mfma_f32_16x16x32_bf16 v[44:47], a[152:155], a[248:251], v[44:47]
  ds_read_b128 a[4:7], v5 offset:17408
  v_add_f32 v93, v80, v81
  v_mfma_f32_16x16x32_bf16 v[44:47], a[156:159], a[252:255], v[44:47]
  s_waitcnt lgkmcnt(14)
  v_exp_f32 v82, v38
  v_mfma_f32_16x16x32_bf16 v[128:131], a[160:163], v[64:67], v[128:131]
  ds_read_b128 a[8:11], v5 offset:18432
  v_add_f32 v93, v93, v82
  v_mfma_f32_16x16x32_bf16 v[132:135], a[164:167], v[64:67], v[132:135]
  ds_read_b128 a[12:15], v5 offset:19456
  buffer_load_dwordx4 a[104:107], v1, s[12:15], s60 offen offset:2048 sc1
  v_mfma_f32_16x16x32_bf16 v[136:139], a[168:171], v[64:67], v[136:139]
  v_exp_f32 v83, v39
  v_mfma_f32_16x16x32_bf16 v[140:143], a[172:175], v[64:67], v[140:143]
  s_waitcnt lgkmcnt(12)
  ds_read_b128 a[16:19], v5 offset:20480
  v_add_f32 v93, v93, v83
  v_mfma_f32_16x16x32_bf16 v[144:147], a[176:179], v[64:67], v[144:147]
  buffer_load_dwordx4 v4, s[12:15], s66 offen offset:0 sc1 lds
  v_mfma_f32_16x16x32_bf16 v[148:151], a[180:183], v[64:67], v[148:151]
  ds_read_b128 a[20:23], v5 offset:21504
  v_cvt_pk_bf16_f32 v68, v80, v81
  v_mfma_f32_16x16x32_bf16 v[152:155], a[184:187], v[64:67], v[152:155]
  buffer_load_dwordx4 a[108:111], v1, s[12:15], s60 offen offset:3072 sc1
  v_exp_f32 v84, v44
  v_mfma_f32_16x16x32_bf16 v[156:159], a[188:191], v[64:67], v[156:159]
  s_waitcnt lgkmcnt(10)
  ds_read_b128 a[24:27], v5 offset:22528
  v_cvt_pk_bf16_f32 v69, v82, v83
  v_mfma_f32_16x16x32_bf16 v[160:163], a[32:35], v[64:67], v[160:163]
  ds_read_b128 a[28:31], v5 offset:23552
  v_add_f32 v93, v93, v84
  v_mfma_f32_16x16x32_bf16 v[164:167], a[36:39], v[64:67], v[164:167]
  buffer_load_dwordx4 v4, s[12:15], s66 offen offset:1024 sc1 lds
  v_mfma_f32_16x16x32_bf16 v[168:171], a[40:43], v[64:67], v[168:171]
  ds_read_b128 a[128:131], v5 offset:24576
  v_fma_f32 v57, v113, s53, v61
  v_mfma_f32_16x16x32_bf16 v[172:175], a[44:47], v[64:67], v[172:175]
  s_waitcnt lgkmcnt(9)
  buffer_load_dwordx2 v[110:111], v9, s[28:31], s3 offen offset:224
  v_exp_f32 v85, v45
  v_mfma_f32_16x16x32_bf16 v[176:179], a[112:115], v[64:67], v[176:179]
  ds_read_b128 a[132:135], v5 offset:25600
  v_fma_f32 v58, v114, s53, v62
  v_mfma_f32_16x16x32_bf16 v[180:183], a[116:119], v[64:67], v[180:183]
  s_waitcnt lgkmcnt(6)
  ds_read_b128 a[136:139], v5 offset:26624
  v_fma_f32 v59, v115, s53, v63
  v_mfma_f32_16x16x32_bf16 v[184:187], a[120:123], v[64:67], v[184:187]
  ds_read_b128 a[140:143], v5 offset:27648
  v_mfma_f32_16x16x32_bf16 v[188:191], a[124:127], v[64:67], v[188:191]
  v_mfma_f32_16x16x32_bf16 v[32:35], a[0:3], a[224:227], v[48:51]
  s_add_u32 s97, s67, s65
  v_exp_f32 v86, v46
  v_mfma_f32_16x16x32_bf16 v[32:35], a[4:7], a[228:231], v[32:35]
  s_add_u32 s67, s67, 0x8000
  ds_read_b128 a[144:147], v5 offset:28672
  v_add_f32 v93, v93, v85
  v_mfma_f32_16x16x32_bf16 v[32:35], a[8:11], a[232:235], v[32:35]
  s_and_b32 s67, s67, 0x1ffff
  buffer_load_dwordx4 v4, s[12:15], s66 offen offset:2048 sc1 lds
  v_mfma_f32_16x16x32_bf16 v[32:35], a[12:15], a[236:239], v[32:35]
  s_waitcnt lgkmcnt(5)
  ds_read_b128 a[148:151], v5 offset:29696
  v_add_f32 v93, v93, v86
  v_mfma_f32_16x16x32_bf16 v[32:35], a[16:19], a[240:243], v[32:35]
  s_add_u32 s98, s66, 0x8000
  ds_read_b128 a[152:155], v5 offset:30720
  v_cvt_pk_bf16_f32 v70, v84, v85
  v_mfma_f32_16x16x32_bf16 v[32:35], a[20:23], a[244:247], v[32:35]
  s_cmp_eq_u32 s71, 3
  v_exp_f32 v87, v47
  v_mfma_f32_16x16x32_bf16 v[32:35], a[24:27], a[248:251], v[32:35]
  s_cselect_b32 s98, s63, s98
  ds_read_b128 a[156:159], v5 offset:31744
  v_add_f32 v93, v93, v87
  v_mfma_f32_16x16x32_bf16 v[32:35], a[28:31], a[252:255], v[32:35]
  s_waitcnt lgkmcnt(4)
  v_cvt_pk_bf16_f32 v71, v86, v87
  v_cmp_lt_f32 vcc, s75, v93
  v_mfma_f32_16x16x32_bf16 v[40:43], a[128:131], a[224:227], v[56:59]
  buffer_load_dwordx4 v4, s[12:15], s66 offen offset:3072 sc1 lds
  v_mfma_f32_16x16x32_bf16 v[40:43], a[132:135], a[228:231], v[40:43]
  s_cbranch_vccnz L_kf_kernel_rare_62
L_kf_kernel_rarer_63:
  v_add_f32 v89, v89, v93
  v_mfma_f32_16x16x32_bf16 v[40:43], a[136:139], a[232:235], v[40:43]
  s_mov_b32 m0, s97
  v_fma_f32 v52, v112, s58, v52
  v_fma_f32 v53, v113, s58, v53
  v_mfma_f32_16x16x32_bf16 v[40:43], a[140:143], a[236:239], v[40:43]
  s_waitcnt lgkmcnt(0)
  v_fma_f32 v54, v114, s58, v54
  v_fma_f32 v55, v115, s58, v55
  v_mfma_f32_16x16x32_bf16 v[40:43], a[144:147], a[240:243], v[40:43]
  s_waitcnt vmcnt(39)
  v_add_u32 v5, s67, v1
  s_mov_b32 s66, s98
  v_mfma_f32_16x16x32_bf16 v[40:43], a[148:151], a[244:247], v[40:43]
  s_barrier
  v_exp_f32 v72, v32
  v_mfma_f32_16x16x32_bf16 v[40:43], a[152:155], a[248:251], v[40:43]
  ds_read_b128 a[0:3], v5 offset:16384
  ds_read_b128 a[4:7], v5 offset:17408
  v_mfma_f32_16x16x32_bf16 v[40:43], a[156:159], a[252:255], v[40:43]
  buffer_load_dwordx4 v3, s[12:15], s66 offen offset:0 sc1 lds
  v_mfma_f32_16x16x32_bf16 v[192:195], a[160:163], v[68:71], v[192:195]
  ds_read_b128 a[8:11], v5 offset:18432
  ds_read_b128 a[12:15], v5 offset:19456
  v_mfma_f32_16x16x32_bf16 v[196:199], a[164:167], v[68:71], v[196:199]
  ds_read_b128 a[16:19], v5 offset:20480
  ds_read_b128 a[20:23], v5 offset:21504
  v_mfma_f32_16x16x32_bf16 v[200:203], a[168:171], v[68:71], v[200:203]
  buffer_load_dwordx4 v3, s[12:15], s66 offen offset:1024 sc1 lds
  v_mfma_f32_16x16x32_bf16 v[204:207], a[172:175], v[68:71], v[204:207]
  ds_read_b128 a[24:27], v5 offset:22528
  ds_read_b128 a[28:31], v5 offset:23552
  v_mfma_f32_16x16x32_bf16 v[208:211], a[176:179], v[68:71], v[208:211]
  v_exp_f32 v73, v33
  v_mfma_f32_16x16x32_bf16 v[212:215], a[180:183], v[68:71], v[212:215]
  ds_read_b128 a[128:131], v5 offset:24576
  ds_read_b128 a[132:135], v5 offset:25600
  v_mfma_f32_16x16x32_bf16 v[216:219], a[184:187], v[68:71], v[216:219]
  buffer_load_dwordx4 v3, s[12:15], s66 offen offset:2048 sc1 lds
  v_mfma_f32_16x16x32_bf16 v[220:223], a[188:191], v[68:71], v[220:223]
  v_exp_f32 v74, v34
  v_mfma_f32_16x16x32_bf16 v[224:227], a[32:35], v[68:71], v[224:227]
  v_exp_f32 v75, v35
  v_mfma_f32_16x16x32_bf16 v[228:231], a[36:39], v[68:71], v[228:231]
  ds_read_b128 a[136:139], v5 offset:26624
  ds_read_b128 a[160:163], v5 offset:0
  v_mfma_f32_16x16x32_bf16 v[232:235], a[40:43], v[68:71], v[232:235]
  buffer_load_dwordx4 v3, s[12:15], s66 offen offset:3072 sc1 lds
  v_mfma_f32_16x16x32_bf16 v[236:239], a[44:47], v[68:71], v[236:239]
  s_add_u32 m0, m0, 0x4000
  ds_read_b128 a[140:143], v5 offset:27648
  v_mfma_f32_16x16x32_bf16 v[240:243], a[112:115], v[68:71], v[240:243]
  v_exp_f32 v76, v40
  v_mfma_f32_16x16x32_bf16 v[244:247], a[116:119], v[68:71], v[244:247]
  buffer_load_dwordx4 v4, s[12:15], s66 offen offset:0 sc1 lds
  v_mfma_f32_16x16x32_bf16 v[248:251], a[120:123], v[68:71], v[248:251]
  ds_read_b128 a[164:167], v5 offset:1024
  v_fma_f32 v60, v112, s59, v60
  v_mfma_f32_16x16x32_bf16 v[252:255], a[124:127], v[68:71], v[252:255]
  s_waitcnt lgkmcnt(10)
  v_exp_f32 v77, v41
  v_mfma_f32_16x16x32_bf16 v[36:39], a[0:3], a[224:227], v[52:55]
  ds_read_b128 a[168:171], v5 offset:2048
  v_fma_f32 v61, v113, s59, v61
  v_mfma_f32_16x16x32_bf16 v[36:39], a[4:7], a[228:231], v[36:39]
  buffer_load_dwordx4 v4, s[12:15], s66 offen offset:1024 sc1 lds
  v_mfma_f32_16x16x32_bf16 v[36:39], a[8:11], a[232:235], v[36:39]
  ds_read_b128 a[144:147], v5 offset:28672
  ds_read_b128 a[172:175], v5 offset:3072
  v_mfma_f32_16x16x32_bf16 v[36:39], a[12:15], a[236:239], v[36:39]
  s_waitcnt lgkmcnt(9)
  v_exp_f32 v78, v42
  v_mfma_f32_16x16x32_bf16 v[36:39], a[16:19], a[240:243], v[36:39]
  ds_read_b128 a[148:151], v5 offset:29696
  v_fma_f32 v62, v114, s59, v62
  v_fma_f32 v63, v115, s59, v63
  v_mfma_f32_16x16x32_bf16 v[36:39], a[20:23], a[244:247], v[36:39]
  ds_read_b128 a[152:155], v5 offset:30720
  buffer_load_dwordx4 v4, s[12:15], s66 offen offset:2048 sc1 lds
  v_mfma_f32_16x16x32_bf16 v[36:39], a[24:27], a[248:251], v[36:39]
  ds_read_b128 a[156:159], v5 offset:31744
  ds_read_b128 a[176:179], v5 offset:4096
  v_mfma_f32_16x16x32_bf16 v[36:39], a[28:31], a[252:255], v[36:39]
  s_waitcnt lgkmcnt(8)
  ds_read_b128 a[180:183], v5 offset:5120
  ds_read_b128 a[184:187], v5 offset:6144
  v_mfma_f32_16x16x32_bf16 v[44:47], a[128:131], a[224:227], v[60:63]
  v_exp_f32 v79, v43
  v_mfma_f32_16x16x32_bf16 v[44:47], a[132:135], a[228:231], v[44:47]
  ds_read_b128 a[188:191], v5 offset:7168
  ds_read_b128 a[32:35], v5 offset:8192
  ds_read_b128 a[36:39], v5 offset:9216
  ds_read_b128 a[40:43], v5 offset:10240
  ds_read_b128 a[44:47], v5 offset:11264
  ds_read_b128 a[112:115], v5 offset:12288
  ds_read_b128 a[116:119], v5 offset:13312
  ds_read_b128 a[120:123], v5 offset:14336
  ds_read_b128 a[124:127], v5 offset:15360
  buffer_load_dwordx4 v4, s[12:15], s66 offen offset:3072 sc1 lds
  v_mfma_f32_16x16x32_bf16 v[44:47], a[136:139], a[232:235], v[44:47]
  s_add_u32 s66, s66, 0x8000
  v_add_f32 v92, v72, v73
  v_add_f32 v92, v92, v74
  v_mfma_f32_16x16x32_bf16 v[44:47], a[140:143], a[236:239], v[44:47]
  s_waitcnt lgkmcnt(12)
  v_add_f32 v92, v92, v75
  v_add_f32 v92, v92, v76
  v_add_f32 v92, v92, v77
  v_add_f32 v92, v92, v78
  v_add_f32 v92, v92, v79
  v_cmp_lt_f32 vcc, s75, v92
  v_cvt_pk_bf16_f32 v64, v72, v73
  v_cvt_pk_bf16_f32 v65, v74, v75
  v_cvt_pk_bf16_f32 v66, v76, v77
  v_cvt_pk_bf16_f32 v67, v78, v79
  s_cbranch_vccnz L_kf_kernel_rare_65
L_kf_kernel_rarer_66:
  v_add_f32 v89, v89, v92
  v_mfma_f32_16x16x32_bf16 v[44:47], a[144:147], a[240:243], v[44:47]
  s_waitcnt vmcnt(36) lgkmcnt(0)
  s_add_u32 m0, s67, s65
  s_add_u32 s67, s67, 0x8000
  v_mfma_f32_16x16x32_bf16 v[44:47], a[148:151], a[244:247], v[44:47]
  s_barrier
  s_and_b32 s67, s67, 0x1ffff
  v_add_u32 v5, s67, v1
  v_mfma_f32_16x16x32_bf16 v[44:47], a[152:155], a[248:251], v[44:47]
  buffer_load_dwordx4 v3, s[12:15], s66 offen offset:0 sc1 lds
  v_mfma_f32_16x16x32_bf16 v[44:47], a[156:159], a[252:255], v[44:47]
  v_exp_f32 v80, v36
  v_mfma_f32_16x16x32_bf16 v[192:195], a[160:163], v[64:67], v[192:195]
  buffer_load_dwordx4 v3, s[12:15], s66 offen offset:1024 sc1 lds
  v_mfma_f32_16x16x32_bf16 v[196:199], a[164:167], v[64:67], v[196:199]
  v_exp_f32 v81, v37
  v_mfma_f32_16x16x32_bf16 v[200:203], a[168:171], v[64:67], v[200:203]
  ds_read_b128 a[160:163], v5 offset:0
  ds_read_b128 a[164:167], v5 offset:1024
  v_mfma_f32_16x16x32_bf16 v[204:207], a[172:175], v[64:67], v[204:207]
  buffer_load_dwordx4 v3, s[12:15], s66 offen offset:2048 sc1 lds
  v_mfma_f32_16x16x32_bf16 v[208:211], a[176:179], v[64:67], v[208:211]
  v_exp_f32 v82, v38
  v_mfma_f32_16x16x32_bf16 v[212:215], a[180:183], v[64:67], v[212:215]
  ds_read_b128 a[168:171], v5 offset:2048
  ds_read_b128 a[172:175], v5 offset:3072
  v_mfma_f32_16x16x32_bf16 v[216:219], a[184:187], v[64:67], v[216:219]
  buffer_load_dwordx4 v3, s[12:15], s66 offen offset:3072 sc1 lds
  v_mfma_f32_16x16x32_bf16 v[220:223], a[188:191], v[64:67], v[220:223]
  ds_read_b128 a[176:179], v5 offset:4096
  s_add_u32 m0, m0, 0x4000
  v_mfma_f32_16x16x32_bf16 v[224:227], a[32:35], v[64:67], v[224:227]
  ds_read_b128 a[180:183], v5 offset:5120
  buffer_load_dwordx4 v4, s[12:15], s66 offen offset:0 sc1 lds
  v_mfma_f32_16x16x32_bf16 v[228:231], a[36:39], v[64:67], v[228:231]
  ds_read_b128 a[184:187], v5 offset:6144
  ds_read_b128 a[188:191], v5 offset:7168
  v_mfma_f32_16x16x32_bf16 v[232:235], a[40:43], v[64:67], v[232:235]
  v_exp_f32 v83, v39
  v_mfma_f32_16x16x32_bf16 v[236:239], a[44:47], v[64:67], v[236:239]
  ds_read_b128 a[32:35], v5 offset:8192
  buffer_load_dwordx4 v4, s[12:15], s66 offen offset:1024 sc1 lds
  v_mfma_f32_16x16x32_bf16 v[240:243], a[112:115], v[64:67], v[240:243]
  ds_read_b128 a[36:39], v5 offset:9216
  ds_read_b128 a[40:43], v5 offset:10240
  v_mfma_f32_16x16x32_bf16 v[244:247], a[116:119], v[64:67], v[244:247]
  v_exp_f32 v84, v44
  v_mfma_f32_16x16x32_bf16 v[248:251], a[120:123], v[64:67], v[248:251]
  ds_read_b128 a[44:47], v5 offset:11264
  buffer_load_dwordx4 v4, s[12:15], s66 offen offset:2048 sc1 lds
  v_exp_f32 v85, v45
  v_exp_f32 v86, v46
  v_exp_f32 v87, v47
  v_add_f32 v93, v80, v81
  v_add_f32 v93, v93, v82
  v_add_f32 v93, v93, v83
  v_add_f32 v93, v93, v84
  v_add_f32 v93, v93, v85
  v_add_f32 v93, v93, v86
  v_add_f32 v93, v93, v87
  v_cmp_lt_f32 vcc, s75, v93
  v_cvt_pk_bf16_f32 v68, v80, v81
  v_cvt_pk_bf16_f32 v69, v82, v83
  v_cvt_pk_bf16_f32 v70, v84, v85
  v_cvt_pk_bf16_f32 v71, v86, v87
  v_mfma_f32_16x16x32_bf16 v[252:255], a[124:127], v[64:67], v[252:255]
  s_cbranch_vccnz L_kf_kernel_rare_67
L_kf_kernel_rarer_68:
  ds_read_b128 a[112:115], v5 offset:12288
  s_waitcnt lgkmcnt(12)
  v_mfma_f32_16x16x32_bf16 v[192:195], a[160:163], v[68:71], v[192:195]
  ds_read_b128 a[116:119], v5 offset:13312
  ds_read_b128 a[120:123], v5 offset:14336
  s_waitcnt lgkmcnt(13)
  v_mfma_f32_16x16x32_bf16 v[196:199], a[164:167], v[68:71], v[196:199]
  buffer_load_dwordx4 v4, s[12:15], s66 offen offset:3072 sc1 lds
  s_waitcnt lgkmcnt(12)
  v_mfma_f32_16x16x32_bf16 v[200:203], a[168:171], v[68:71], v[200:203]
  s_add_u32 s66, s66, 0x8000
  ds_read_b128 a[124:127], v5 offset:15360
  v_cvt_pk_bf16_f32 v128, v128, v129
  s_waitcnt lgkmcnt(12)
  v_mfma_f32_16x16x32_bf16 v[204:207], a[172:175], v[68:71], v[204:207]
  s_waitcnt lgkmcnt(8)
  v_cvt_pk_bf16_f32 v129, v130, v131
  v_cvt_pk_bf16_f32 v130, v132, v133
  v_mfma_f32_16x16x32_bf16 v[208:211], a[176:179], v[68:71], v[208:211]
  s_waitcnt vmcnt(16) lgkmcnt(0)
  s_add_u32 m0, s67, s65
  v_cvt_pk_bf16_f32 v131, v134, v135
  v_mfma_f32_16x16x32_bf16 v[212:215], a[180:183], v[68:71], v[212:215]
  s_barrier
  s_add_u32 s67, s67, 0x8000
  s_and_b32 s67, s67, 0x1ffff
  v_add_u32 v5, s67, v1
  v_add_f32 v89, v89, v93
  v_mfma_f32_16x16x32_bf16 v[216:219], a[184:187], v[68:71], v[216:219]
  ds_read_b128 a[128:131], v5 offset:0
  ds_read_b128 a[132:135], v5 offset:1024
  v_mfma_f32_16x16x32_bf16 v[220:223], a[188:191], v[68:71], v[220:223]
  ds_read_b128 a[136:139], v5 offset:2048
  v_cvt_pk_bf16_f32 v132, v136, v137
  v_mfma_f32_16x16x32_bf16 v[224:227], a[32:35], v[68:71], v[224:227]
  buffer_load_dwordx4 v3, s[12:15], s66 offen offset:0 sc1 lds
  ds_read_b128 a[140:143], v5 offset:3072
  v_mfma_f32_16x16x32_bf16 v[228:231], a[36:39], v[68:71], v[228:231]
  ds_read_b128 a[144:147], v5 offset:4096
  v_cvt_pk_bf16_f32 v133, v138, v139
  v_mfma_f32_16x16x32_bf16 v[232:235], a[40:43], v[68:71], v[232:235]
  ds_read_b128 a[148:151], v5 offset:5120
  v_cvt_pk_bf16_f32 v134, v140, v141
  v_mfma_f32_16x16x32_bf16 v[236:239], a[44:47], v[68:71], v[236:239]
  ds_read_b128 a[152:155], v5 offset:6144
  v_cvt_pk_bf16_f32 v135, v142, v143
  v_mfma_f32_16x16x32_bf16 v[240:243], a[112:115], v[68:71], v[240:243]
  ds_read_b128 a[156:159], v5 offset:7168
  v_cvt_pk_bf16_f32 v136, v144, v145
  v_mfma_f32_16x16x32_bf16 v[244:247], a[116:119], v[68:71], v[244:247]
  ds_read_b128 a[160:163], v5 offset:8192
  v_cvt_pk_bf16_f32 v137, v146, v147
  v_cvt_pk_bf16_f32 v138, v148, v149
  v_cvt_pk_bf16_f32 v139, v150, v151
  v_mfma_f32_16x16x32_bf16 v[248:251], a[120:123], v[68:71], v[248:251]
  ds_read_b128 a[164:167], v5 offset:9216
  v_cvt_pk_bf16_f32 v140, v152, v153
  v_cvt_pk_bf16_f32 v141, v154, v155
  v_cvt_pk_bf16_f32 v142, v156, v157
  v_cvt_pk_bf16_f32 v143, v158, v159
  v_mfma_f32_16x16x32_bf16 v[252:255], a[124:127], v[68:71], v[252:255]
  s_waitcnt lgkmcnt(6)
  ds_read_b128 a[168:171], v5 offset:10240
  v_cvt_pk_bf16_f32 v160, v160, v161
  v_cvt_pk_bf16_f32 v161, v162, v163
  v_cvt_pk_bf16_f32 v162, v164, v165
  v_cvt_pk_bf16_f32 v163, v166, v167
  v_mfma_f32_16x16x32_bf16 v[144:147], a[128:131], v[128:131], 0
  ds_read_b128 a[172:175], v5 offset:11264
  v_cvt_pk_bf16_f32 v164, v168, v169
  v_cvt_pk_bf16_f32 v165, v170, v171
  v_cvt_pk_bf16_f32 v166, v172, v173
  v_cvt_pk_bf16_f32 v167, v174, v175
  v_mfma_f32_16x16x32_bf16 v[144:147], a[132:135], v[132:135], v[144:147]
  ds_read_b128 a[176:179], v5 offset:12288
  v_cvt_pk_bf16_f32 v168, v176, v177
  v_cvt_pk_bf16_f32 v169, v178, v179
  v_cvt_pk_bf16_f32 v170, v180, v181
  v_cvt_pk_bf16_f32 v171, v182, v183
  v_mfma_f32_16x16x32_bf16 v[144:147], a[136:139], v[136:139], v[144:147]
  buffer_load_dwordx4 v3, s[12:15], s66 offen offset:1024 sc1 lds
  ds_read_b128 a[180:183], v5 offset:13312
  v_cvt_pk_bf16_f32 v172, v184, v185
  v_cvt_pk_bf16_f32 v173, v186, v187
  v_cvt_pk_bf16_f32 v174, v188, v189
  v_cvt_pk_bf16_f32 v175, v190, v191
  v_mfma_f32_16x16x32_bf16 v[144:147], a[140:143], v[140:143], v[144:147]
  s_waitcnt lgkmcnt(6)
  ds_read_b128 a[184:187], v5 offset:14336
  ds_read_b128 a[188:191], v5 offset:15360
  v_mfma_f32_16x16x32_bf16 v[144:147], a[144:147], v[160:163], v[144:147]
  v_cvt_pk_bf16_f32 v192, v192, v193
  v_cvt_pk_bf16_f32 v193, v194, v195
  v_mfma_f32_16x16x32_bf16 v[144:147], a[148:151], v[164:167], v[144:147]
  v_cvt_pk_bf16_f32 v194, v196, v197
  v_cvt_pk_bf16_f32 v195, v198, v199
  v_mfma_f32_16x16x32_bf16 v[144:147], a[152:155], v[168:171], v[144:147]
  v_cvt_pk_bf16_f32 v196, v200, v201
  v_cvt_pk_bf16_f32 v197, v202, v203
  v_mfma_f32_16x16x32_bf16 v[144:147], a[156:159], v[172:175], v[144:147]
  s_waitcnt lgkmcnt(4)
  v_cvt_pk_bf16_f32 v198, v204, v205
  v_cvt_pk_bf16_f32 v199, v206, v207
  v_mfma_f32_16x16x32_bf16 v[152:155], a[160:163], v[128:131], 0
  v_cvt_pk_bf16_f32 v200, v208, v209
  v_cvt_pk_bf16_f32 v201, v210, v211
  v_mfma_f32_16x16x32_bf16 v[152:155], a[164:167], v[132:135], v[152:155]
  v_cvt_pk_bf16_f32 v202, v212, v213
  v_cvt_pk_bf16_f32 v203, v214, v215
  v_mfma_f32_16x16x32_bf16 v[152:155], a[168:171], v[136:139], v[152:155]
  v_cvt_pk_bf16_f32 v204, v216, v217
  v_cvt_pk_bf16_f32 v205, v218, v219
  v_mfma_f32_16x16x32_bf16 v[152:155], a[172:175], v[140:143], v[152:155]
  s_waitcnt lgkmcnt(0)
  v_cvt_pk_bf16_f32 v206, v220, v221
  v_cvt_pk_bf16_f32 v207, v222, v223
  v_mfma_f32_16x16x32_bf16 v[152:155], a[176:179], v[160:163], v[152:155]
  v_cvt_pk_bf16_f32 v224, v224, v225
  v_cvt_pk_bf16_f32 v225, v226, v227
  v_mfma_f32_16x16x32_bf16 v[152:155], a[180:183], v[164:167], v[152:155]
  v_cvt_pk_bf16_f32 v226, v228, v229
  v_cvt_pk_bf16_f32 v227, v230, v231
  v_mfma_f32_16x16x32_bf16 v[152:155], a[184:187], v[168:171], v[152:155]
  v_cvt_pk_bf16_f32 v228, v232, v233
  v_cvt_pk_bf16_f32 v229, v234, v235
  v_mfma_f32_16x16x32_bf16 v[152:155], a[188:191], v[172:175], v[152:155]
  v_cvt_pk_bf16_f32 v230, v236, v237
  v_cvt_pk_bf16_f32 v231, v238, v239
  v_cvt_pk_bf16_f32 v232, v240, v241
  v_cvt_pk_bf16_f32 v233, v242, v243
  v_cvt_pk_bf16_f32 v234, v244, v245
  v_cvt_pk_bf16_f32 v235, v246, v247
  v_cvt_pk_bf16_f32 v236, v248, v249
  v_cvt_pk_bf16_f32 v237, v250, v251
  v_cvt_pk_bf16_f32 v238, v252, v253
  v_cvt_pk_bf16_f32 v239, v254, v255
  v_mfma_f32_16x16x32_bf16 v[148:151], a[128:131], v[192:195], 0
  s_mul_i32 s97, s64, 659456
  v_mov_b32 v18, v88
  v_mov_b32 v19, v88
  v_mfma_f32_16x16x32_bf16 v[148:151], a[132:135], v[196:199], v[148:151]
  s_add_u32 s73, s73, s97
  buffer_load_dwordx4 v3, s[12:15], s66 offen offset:2048 sc1 lds
  v_mfma_f32_16x16x32_bf16 v[148:151], a[136:139], v[200:203], v[148:151]
  ds_read_b128 a[128:131], v5 offset:16384
  ds_read_b128 a[132:135], v5 offset:17408
  v_mfma_f32_16x16x32_bf16 v[148:151], a[140:143], v[204:207], v[148:151]
  ds_read_b128 a[136:139], v5 offset:18432
  v_permlane32_swap_b32 v18, v19
  v_mfma_f32_16x16x32_bf16 v[148:151], a[144:147], v[224:227], v[148:151]
  ds_read_b128 a[140:143], v5 offset:19456
  v_add_f32 v88, v18, v19
  v_mfma_f32_16x16x32_bf16 v[148:151], a[148:151], v[228:231], v[148:151]
  buffer_load_dwordx4 v3, s[12:15], s66 offen offset:3072 sc1 lds
  v_mfma_f32_16x16x32_bf16 v[148:151], a[152:155], v[232:235], v[148:151]
  s_add_u32 m0, m0, 0x4000
  ds_read_b128 a[144:147], v5 offset:20480
  ds_read_b128 a[148:151], v5 offset:21504
  v_mfma_f32_16x16x32_bf16 v[148:151], a[156:159], v[236:239], v[148:151]
  ds_read_b128 a[152:155], v5 offset:22528
  v_mov_b32 v18, v88
  v_mfma_f32_16x16x32_bf16 v[156:159], a[160:163], v[192:195], 0
  ds_read_b128 a[156:159], v5 offset:23552
  v_mov_b32 v19, v88
  v_mfma_f32_16x16x32_bf16 v[156:159], a[164:167], v[196:199], v[156:159]
  v_mov_b32 v20, v89
  v_permlane16_swap_b32 v18, v19
  v_mfma_f32_16x16x32_bf16 v[156:159], a[168:171], v[200:203], v[156:159]
  buffer_load_dwordx4 v4, s[12:15], s66 offen offset:0 sc1 lds
  v_mfma_f32_16x16x32_bf16 v[156:159], a[172:175], v[204:207], v[156:159]
  ds_read_b128 a[160:163], v5 offset:24576
  v_add_f32 v88, v18, v19
  v_mfma_f32_16x16x32_bf16 v[156:159], a[176:179], v[224:227], v[156:159]
  s_add_u32 s63, s42, 0x4000
  ds_read_b128 a[164:167], v5 offset:25600
  v_mov_b32 v21, v89
  v_mfma_f32_16x16x32_bf16 v[156:159], a[180:183], v[228:231], v[156:159]
  s_cmp_lg_u32 s45, 0
  v_rcp_f32 v88, v88
  v_mfma_f32_16x16x32_bf16 v[156:159], a[184:187], v[232:235], v[156:159]
  s_cselect_b32 s63, s44, s63
  buffer_load_dwordx4 v4, s[12:15], s66 offen offset:1024 sc1 lds
  v_mfma_f32_16x16x32_bf16 v[156:159], a[188:191], v[236:239], v[156:159]
  s_waitcnt lgkmcnt(6)
  ds_read_b128 a[168:171], v5 offset:26624
  v_permlane32_swap_b32 v20, v21
  v_mfma_f32_16x16x32_bf16 v[176:179], a[128:131], v[128:131], 0
  s_cselect_b32 s41, 2147418112, s39
  ds_read_b128 a[172:175], v5 offset:27648
  v_add_f32 v89, v20, v21
  v_mfma_f32_16x16x32_bf16 v[176:179], a[132:135], v[132:135], v[176:179]
  s_mov_b32 s71, s34
  v_mov_b32 v20, v89
  v_mov_b32 v21, v89
  v_mfma_f32_16x16x32_bf16 v[176:179], a[136:139], v[136:139], v[176:179]
  s_sub_u32 s36, s34, 2
  ds_read_b128 a[176:179], v5 offset:28672
  v_permlane16_swap_b32 v20, v21
  v_mfma_f32_16x16x32_bf16 v[176:179], a[140:143], v[140:143], v[176:179]
  s_waitcnt lgkmcnt(5)
  buffer_load_dwordx4 v4, s[12:15], s66 offen offset:2048 sc1 lds
  v_mfma_f32_16x16x32_bf16 v[176:179], a[144:147], v[160:163], v[176:179]
  s_mov_b32 s1, 255
  ds_read_b128 a[180:183], v5 offset:29696
  v_add_f32 v89, v20, v21
  v_mfma_f32_16x16x32_bf16 v[176:179], a[148:151], v[164:167], v[176:179]
  s_lshl_b32 s96, s65, 1
  v_rcp_f32 v89, v89
  v_mfma_f32_16x16x32_bf16 v[176:179], a[152:155], v[168:171], v[176:179]
  ds_read_b128 a[184:187], v5 offset:30720
  v_mul_f32 v144, v88, v144
  v_mfma_f32_16x16x32_bf16 v[176:179], a[156:159], v[172:175], v[176:179]
  v_mul_f32 v145, v88, v145
  v_cvt_pk_bf16_f32 v72, v144, v145
  v_mfma_f32_16x16x32_bf16 v[180:183], a[128:131], v[192:195], 0
  buffer_load_dwordx4 v4, s[12:15], s66 offen offset:3072 sc1 lds
  v_mfma_f32_16x16x32_bf16 v[180:183], a[132:135], v[196:199], v[180:183]
  s_add_u32 s66, s66, 0x8000
  ds_read_b128 a[188:191], v5 offset:31744
  v_mul_f32 v146, v88, v146
  v_mfma_f32_16x16x32_bf16 v[180:183], a[136:139], v[200:203], v[180:183]
  s_add_u32 m0, s67, s65
  v_mul_f32 v147, v88, v147
  v_cvt_pk_bf16_f32 v73, v146, v147
  v_mfma_f32_16x16x32_bf16 v[180:183], a[140:143], v[204:207], v[180:183]
  v_mul_f32 v152, v88, v152
  v_mul_f32 v153, v88, v153
  v_mfma_f32_16x16x32_bf16 v[180:183], a[144:147], v[224:227], v[180:183]
  s_add_u32 s67, s67, 0x8000
  v_cvt_pk_bf16_f32 v74, v152, v153
  v_mul_f32 v154, v88, v154
  v_mfma_f32_16x16x32_bf16 v[180:183], a[148:151], v[228:231], v[180:183]
  s_and_b32 s67, s67, 0x1ffff
  v_add_u32 v5, s67, v1
  v_add_u32 v16, s96, v6
  v_mfma_f32_16x16x32_bf16 v[180:183], a[152:155], v[232:235], v[180:183]
  s_waitcnt vmcnt(16) lgkmcnt(0)
  v_mul_f32 v155, v88, v155
  v_cvt_pk_bf16_f32 v75, v154, v155
  v_mfma_f32_16x16x32_bf16 v[180:183], a[156:159], v[236:239], v[180:183]
  s_barrier
  v_mul_f32 v148, v89, v148
  v_mul_f32 v149, v89, v149
  v_mfma_f32_16x16x32_bf16 v[184:187], a[160:163], v[128:131], 0
  s_add_u32 s16, s73, 0
  ds_read_b128 a[128:131], v5 offset:0
  ds_read_b128 a[132:135], v5 offset:1024
  v_mfma_f32_16x16x32_bf16 v[184:187], a[164:167], v[132:135], v[184:187]
  buffer_load_dwordx4 v3, s[12:15], s66 offen offset:0 sc1 lds
  v_mfma_f32_16x16x32_bf16 v[184:187], a[168:171], v[136:139], v[184:187]
  ds_read_b128 a[136:139], v5 offset:2048
  ds_read_b128 a[140:143], v5 offset:3072
  v_mfma_f32_16x16x32_bf16 v[184:187], a[172:175], v[140:143], v[184:187]
  ds_read_b128 a[0:3], v6 offset:0
  ds_read_b128 a[144:147], v5 offset:4096
  v_mfma_f32_16x16x32_bf16 v[184:187], a[176:179], v[160:163], v[184:187]
  ds_read_b128 a[148:151], v5 offset:5120
  ds_read_b128 a[4:7], v6 offset:1024
  v_mfma_f32_16x16x32_bf16 v[184:187], a[180:183], v[164:167], v[184:187]
  buffer_store_dwordx4 v[72:75], v1, s[12:15], s16 offen sc1
  v_mfma_f32_16x16x32_bf16 v[184:187], a[184:187], v[168:171], v[184:187]
  ds_read_b128 a[152:155], v5 offset:6144
  v_cvt_pk_bf16_f32 v76, v148, v149
  v_mfma_f32_16x16x32_bf16 v[184:187], a[188:191], v[172:175], v[184:187]
  ds_read_b128 a[8:11], v6 offset:2048
  v_mul_f32 v150, v89, v150
  v_mfma_f32_16x16x32_bf16 v[188:191], a[160:163], v[192:195], 0
  ds_read_b128 a[156:159], v5 offset:7168
  v_mul_f32 v151, v89, v151
  v_mfma_f32_16x16x32_bf16 v[188:191], a[164:167], v[196:199], v[188:191]
  buffer_load_dwordx4 v3, s[12:15], s66 offen offset:1024 sc1 lds
  v_mfma_f32_16x16x32_bf16 v[188:191], a[168:171], v[200:203], v[188:191]
  ds_read_b128 a[160:163], v5 offset:8192
  v_cvt_pk_bf16_f32 v77, v150, v151
  v_mfma_f32_16x16x32_bf16 v[188:191], a[172:175], v[204:207], v[188:191]
  ds_read_b128 a[12:15], v6 offset:3072
  v_mul_f32 v156, v89, v156
  v_mfma_f32_16x16x32_bf16 v[188:191], a[176:179], v[224:227], v[188:191]
  ds_read_b128 a[164:167], v5 offset:9216
  v_mul_f32 v157, v89, v157
  v_mfma_f32_16x16x32_bf16 v[188:191], a[180:183], v[228:231], v[188:191]
  v_cvt_pk_bf16_f32 v78, v156, v157
  v_mul_f32 v158, v89, v158
  v_mfma_f32_16x16x32_bf16 v[188:191], a[184:187], v[232:235], v[188:191]
  ds_read_b128 a[168:171], v5 offset:10240
  ds_read_b128 a[16:19], v6 offset:4096
  v_mfma_f32_16x16x32_bf16 v[188:191], a[188:191], v[236:239], v[188:191]
  s_waitcnt lgkmcnt(12)
  v_mul_f32 v159, v89, v159
  v_cvt_pk_bf16_f32 v79, v158, v159
  v_mfma_f32_16x16x32_bf16 v[144:147], a[128:131], v[128:131], 0
  s_add_u32 s17, s73, 2048
  ds_read_b128 a[172:175], v5 offset:11264
  v_mul_f32 v176, v88, v176
  v_mfma_f32_16x16x32_bf16 v[144:147], a[132:135], v[132:135], v[144:147]
  buffer_load_dwordx4 v3, s[12:15], s66 offen offset:2048 sc1 lds
  v_mfma_f32_16x16x32_bf16 v[144:147], a[136:139], v[136:139], v[144:147]
  ds_read_b128 a[176:179], v5 offset:12288
  ds_read_b128 a[20:23], v6 offset:5120
  v_mfma_f32_16x16x32_bf16 v[144:147], a[140:143], v[140:143], v[144:147]
  s_waitcnt lgkmcnt(8)
  buffer_store_dwordx4 v[76:79], v1, s[12:15], s17 offen sc1
  v_mfma_f32_16x16x32_bf16 v[144:147], a[144:147], v[160:163], v[144:147]
  ds_read_b128 a[180:183], v5 offset:13312
  v_mul_f32 v177, v88, v177
  v_mfma_f32_16x16x32_bf16 v[144:147], a[148:151], v[164:167], v[144:147]
  ds_read_b128 a[24:27], v6 offset:6144
  v_cvt_pk_bf16_f32 v80, v176, v177
  v_mfma_f32_16x16x32_bf16 v[144:147], a[152:155], v[168:171], v[144:147]
  buffer_load_dword v12, v0, s[12:15], s40 offen offset:128 sc1
  v_mfma_f32_16x16x32_bf16 v[144:147], a[156:159], v[172:175], v[144:147]
  ds_read_b128 a[184:187], v5 offset:14336
  v_mul_f32 v178, v88, v178
  v_mfma_f32_16x16x32_bf16 v[148:151], a[128:131], v[192:195], 0
  ds_read_b128 a[188:191], v5 offset:15360
  v_mul_f32 v179, v88, v179
  v_mfma_f32_16x16x32_bf16 v[148:151], a[132:135], v[196:199], v[148:151]
  buffer_load_dwordx4 v3, s[12:15], s66 offen offset:3072 sc1 lds
  v_mfma_f32_16x16x32_bf16 v[148:151], a[136:139], v[200:203], v[148:151]
  s_add_u32 m0, m0, 0x4000
  ds_read_b128 a[28:31], v6 offset:7168
  ds_read_b128 a[128:131], v5 offset:16384
  v_mfma_f32_16x16x32_bf16 v[148:151], a[140:143], v[204:207], v[148:151]
  v_cvt_pk_bf16_f32 v81, v178, v179
  v_mul_f32 v184, v88, v184
  v_mfma_f32_16x16x32_bf16 v[148:151], a[144:147], v[224:227], v[148:151]
  ds_read_b128 a[132:135], v5 offset:17408
  ds_read_b128 a[32:35], v6 offset:8192
  v_mfma_f32_16x16x32_bf16 v[148:151], a[148:151], v[228:231], v[148:151]
  v_mul_f32 v185, v88, v185
  v_cvt_pk_bf16_f32 v82, v184, v185
  v_mfma_f32_16x16x32_bf16 v[148:151], a[152:155], v[232:235], v[148:151]
  ds_read_b128 a[136:139], v5 offset:18432
  v_mul_f32 v186, v88, v186
  v_mfma_f32_16x16x32_bf16 v[148:151], a[156:159], v[236:239], v[148:151]
  s_waitcnt lgkmcnt(11)
  ds_read_b128 a[36:39], v6 offset:9216
  v_mul_f32 v187, v88, v187
  v_mfma_f32_16x16x32_bf16 v[152:155], a[160:163], v[128:131], 0
  ds_read_b128 a[140:143], v5 offset:19456
  v_cvt_pk_bf16_f32 v83, v186, v187
  v_mfma_f32_16x16x32_bf16 v[152:155], a[164:167], v[132:135], v[152:155]
  s_add_u32 s18, s73, 1024
  buffer_load_dwordx4 v4, s[12:15], s66 offen offset:0 sc1 lds
  v_mfma_f32_16x16x32_bf16 v[152:155], a[168:171], v[136:139], v[152:155]
  ds_read_b128 a[144:147], v5 offset:20480
  v_mul_f32 v180, v89, v180
  v_mfma_f32_16x16x32_bf16 v[152:155], a[172:175], v[140:143], v[152:155]
  s_waitcnt lgkmcnt(8)
  ds_read_b128 a[40:43], v6 offset:10240
  v_mul_f32 v181, v89, v181
  v_mfma_f32_16x16x32_bf16 v[152:155], a[176:179], v[160:163], v[152:155]
  ds_read_b128 a[148:151], v5 offset:21504
  v_cvt_pk_bf16_f32 v84, v180, v181
  v_mfma_f32_16x16x32_bf16 v[152:155], a[180:183], v[164:167], v[152:155]
  buffer_store_dwordx4 v[80:83], v1, s[12:15], s18 offen sc1
  v_mfma_f32_16x16x32_bf16 v[152:155], a[184:187], v[168:171], v[152:155]
  ds_read_b128 a[152:155], v5 offset:22528
  ds_read_b128 a[44:47], v6 offset:11264
  v_mfma_f32_16x16x32_bf16 v[152:155], a[188:191], v[172:175], v[152:155]
  v_mul_f32 v182, v89, v182
  v_mul_f32 v183, v89, v183
  v_mfma_f32_16x16x32_bf16 v[156:159], a[160:163], v[192:195], 0
  ds_read_b128 a[156:159], v5 offset:23552
  v_cvt_pk_bf16_f32 v85, v182, v183
  v_mfma_f32_16x16x32_bf16 v[156:159], a[164:167], v[196:199], v[156:159]
  buffer_load_dwordx4 v4, s[12:15], s66 offen offset:1024 sc1 lds
  v_mfma_f32_16x16x32_bf16 v[156:159], a[168:171], v[200:203], v[156:159]
  ds_read_b128 a[160:163], v5 offset:24576
  ds_read_b128 a[112:115], v6 offset:12288
  v_mfma_f32_16x16x32_bf16 v[156:159], a[172:175], v[204:207], v[156:159]
  v_mul_f32 v188, v89, v188
  v_mul_f32 v189, v89, v189
  v_mfma_f32_16x16x32_bf16 v[156:159], a[176:179], v[224:227], v[156:159]
  ds_read_b128 a[164:167], v5 offset:25600
  v_cvt_pk_bf16_f32 v86, v188, v189
  v_mfma_f32_16x16x32_bf16 v[156:159], a[180:183], v[228:231], v[156:159]
  ds_read_b128 a[116:119], v6 offset:13312
  v_mul_f32 v190, v89, v190
  v_mfma_f32_16x16x32_bf16 v[156:159], a[184:187], v[232:235], v[156:159]
  ds_read_b128 a[168:171], v5 offset:26624
  v_mul_f32 v191, v89, v191
  v_mfma_f32_16x16x32_bf16 v[156:159], a[188:191], v[236:239], v[156:159]
  s_waitcnt lgkmcnt(11)
  v_cvt_pk_bf16_f32 v87, v190, v191
  v_mul_f32 v144, v88, v144
  v_mfma_f32_16x16x32_bf16 v[176:179], a[128:131], v[128:131], 0
  s_add_u32 s19, s73, 3072
  ds_read_b128 a[172:175], v5 offset:27648
  v_mul_f32 v145, v88, v145
  v_mfma_f32_16x16x32_bf16 v[176:179], a[132:135], v[132:135], v[176:179]
  buffer_load_dwordx4 v4, s[12:15], s66 offen offset:2048 sc1 lds
  v_mfma_f32_16x16x32_bf16 v[176:179], a[136:139], v[136:139], v[176:179]
  ds_read_b128 a[120:123], v6 offset:14336
  ds_read_b128 a[176:179], v5 offset:28672
  v_mfma_f32_16x16x32_bf16 v[176:179], a[140:143], v[140:143], v[176:179]
  s_waitcnt lgkmcnt(8)
  buffer_store_dwordx4 v[84:87], v1, s[12:15], s19 offen sc1
  v_mfma_f32_16x16x32_bf16 v[176:179], a[144:147], v[160:163], v[176:179]
  v_cvt_pk_bf16_f32 v72, v144, v145
  v_mul_f32 v146, v88, v146
  v_mfma_f32_16x16x32_bf16 v[176:179], a[148:151], v[164:167], v[176:179]
  ds_read_b128 a[180:183], v5 offset:29696
  ds_read_b128 a[124:127], v6 offset:15360
  v_mfma_f32_16x16x32_bf16 v[176:179], a[152:155], v[168:171], v[176:179]
  v_mul_f32 v147, v88, v147
  v_cvt_pk_bf16_f32 v73, v146, v147
  v_mfma_f32_16x16x32_bf16 v[176:179], a[156:159], v[172:175], v[176:179]
  v_mul_f32 v152, v88, v152
  v_mul_f32 v153, v88, v153
  v_mfma_f32_16x16x32_bf16 v[180:183], a[128:131], v[192:195], 0
  ds_read_b128 a[184:187], v5 offset:30720
  buffer_load_dwordx4 v4, s[12:15], s66 offen offset:3072 sc1 lds
  v_mfma_f32_16x16x32_bf16 v[180:183], a[132:135], v[196:199], v[180:183]
  s_add_u32 s66, s66, 0x8000
  ds_read_b128 a[188:191], v5 offset:31744
  v_cvt_pk_bf16_f32 v74, v152, v153
  v_mfma_f32_16x16x32_bf16 v[180:183], a[136:139], v[200:203], v[180:183]
  s_add_u32 m0, s67, s65
  v_mul_f32 v154, v88, v154
  v_mul_f32 v155, v88, v155
  v_mfma_f32_16x16x32_bf16 v[180:183], a[140:143], v[204:207], v[180:183]
  v_cvt_pk_bf16_f32 v75, v154, v155
  s_add_u32 s16, s73, 94208
  buffer_store_dwordx4 v[72:75], v1, s[12:15], s16 offen sc1
  v_mfma_f32_16x16x32_bf16 v[180:183], a[144:147], v[224:227], v[180:183]
  s_add_u32 s67, s67, 0x8000
  v_mul_f32 v148, v89, v148
  v_mul_f32 v149, v89, v149
  v_mfma_f32_16x16x32_bf16 v[180:183], a[148:151], v[228:231], v[180:183]
  s_and_b32 s67, s67, 0x1ffff
  v_cvt_pk_bf16_f32 v76, v148, v149
  v_mul_f32 v150, v89, v150
  v_mfma_f32_16x16x32_bf16 v[180:183], a[152:155], v[232:235], v[180:183]
  s_waitcnt vmcnt(22) lgkmcnt(0)
  v_mul_f32 v151, v89, v151
  v_cvt_pk_bf16_f32 v77, v150, v151
  v_mfma_f32_16x16x32_bf16 v[180:183], a[156:159], v[236:239], v[180:183]
  s_barrier
  v_add_u32 v5, s67, v1
  v_mul_f32 v156, v89, v156
  v_mfma_f32_16x16x32_bf16 v[184:187], a[160:163], v[128:131], 0
  v_mul_f32 v157, v89, v157
  v_cvt_pk_bf16_f32 v78, v156, v157
  v_mfma_f32_16x16x32_bf16 v[184:187], a[164:167], v[132:135], v[184:187]
  buffer_load_dwordx4 v3, s[12:15], s66 offen offset:0 sc1 lds
  v_mfma_f32_16x16x32_bf16 v[184:187], a[168:171], v[136:139], v[184:187]
  ds_read_b128 a[128:131], v5 offset:0
  ds_read_b128 a[132:135], v5 offset:1024
  ds_read_b128 a[136:139], v5 offset:2048
  ds_read_b128 a[140:143], v5 offset:3072
  v_mfma_f32_16x16x32_bf16 v[184:187], a[172:175], v[140:143], v[184:187]
  v_mul_f32 v158, v89, v158
  v_mul_f32 v159, v89, v159
  v_cvt_pk_bf16_f32 v79, v158, v159
  s_add_u32 s17, s73, 96256
  buffer_store_dwordx4 v[76:79], v1, s[12:15], s17 offen sc1
  v_mfma_f32_16x16x32_bf16 v[184:187], a[176:179], v[160:163], v[184:187]
  ds_read_b128 a[144:147], v5 offset:4096
  ds_read_b128 a[148:151], v5 offset:5120
  v_mfma_f32_16x16x32_bf16 v[184:187], a[180:183], v[164:167], v[184:187]
  buffer_load_dwordx4 v3, s[12:15], s66 offen offset:1024 sc1 lds
  v_mfma_f32_16x16x32_bf16 v[184:187], a[184:187], v[168:171], v[184:187]
  ds_read_b128 a[152:155], v5 offset:6144
  v_mul_f32 v176, v88, v176
  v_mfma_f32_16x16x32_bf16 v[184:187], a[188:191], v[172:175], v[184:187]
  v_mul_f32 v177, v88, v177
  v_cvt_pk_bf16_f32 v80, v176, v177
  v_mfma_f32_16x16x32_bf16 v[188:191], a[160:163], v[192:195], 0
  ds_read_b128 a[156:159], v5 offset:7168
  v_mul_f32 v178, v88, v178
  v_mfma_f32_16x16x32_bf16 v[188:191], a[164:167], v[196:199], v[188:191]
  buffer_load_dwordx4 v3, s[12:15], s66 offen offset:2048 sc1 lds
  v_mfma_f32_16x16x32_bf16 v[188:191], a[168:171], v[200:203], v[188:191]
  ds_read_b128 a[160:163], v5 offset:8192
  v_mul_f32 v179, v88, v179
  v_mfma_f32_16x16x32_bf16 v[188:191], a[172:175], v[204:207], v[188:191]
  v_cvt_pk_bf16_f32 v81, v178, v179
  v_mul_f32 v184, v88, v184
  v_mfma_f32_16x16x32_bf16 v[188:191], a[176:179], v[224:227], v[188:191]
  ds_read_b128 a[164:167], v5 offset:9216
  v_mul_f32 v185, v88, v185
  v_mfma_f32_16x16x32_bf16 v[188:191], a[180:183], v[228:231], v[188:191]
  buffer_load_dwordx4 v3, s[12:15], s66 offen offset:3072 sc1 lds
  v_mfma_f32_16x16x32_bf16 v[188:191], a[184:187], v[232:235], v[188:191]
  s_add_u32 m0, m0, 0x4000
  ds_read_b128 a[168:171], v5 offset:10240
  v_cvt_pk_bf16_f32 v82, v184, v185
  v_mfma_f32_16x16x32_bf16 v[188:191], a[188:191], v[236:239], v[188:191]
  s_waitcnt lgkmcnt(7)
  v_mul_f32 v186, v88, v186
  v_mul_f32 v187, v88, v187
  v_mfma_f32_16x16x32_bf16 v[144:147], a[128:131], v[128:131], 0
  ds_read_b128 a[172:175], v5 offset:11264
  v_cvt_pk_bf16_f32 v83, v186, v187
  v_mfma_f32_16x16x32_bf16 v[144:147], a[132:135], v[132:135], v[144:147]
  s_add_u32 s18, s73, 95232
  buffer_load_dwordx4 v4, s[12:15], s66 offen offset:0 sc1 lds
  v_mfma_f32_16x16x32_bf16 v[144:147], a[136:139], v[136:139], v[144:147]
  ds_read_b128 a[176:179], v5 offset:12288
  s_waitcnt vmcnt(14)
  v_readfirstlane_b32 s97, v12
  v_mfma_f32_16x16x32_bf16 v[144:147], a[140:143], v[140:143], v[144:147]
  s_waitcnt lgkmcnt(5)
  buffer_store_dwordx4 v[80:83], v1, s[12:15], s18 offen sc1
  v_mfma_f32_16x16x32_bf16 v[144:147], a[144:147], v[160:163], v[144:147]
  s_or_b32 s97, s97, s45
  ds_read_b128 a[180:183], v5 offset:13312
  v_mul_f32 v180, v89, v180
  v_mfma_f32_16x16x32_bf16 v[144:147], a[148:151], v[164:167], v[144:147]
  buffer_load_dwordx4 v4, s[12:15], s66 offen offset:1024 sc1 lds
  v_mfma_f32_16x16x32_bf16 v[144:147], a[152:155], v[168:171], v[144:147]
  s_cbranch_scc0 L_kf_kernel_spin_70
L_kf_kernel_spinr_71:
  ds_read_b128 a[184:187], v5 offset:14336
  v_mfma_f32_16x16x32_bf16 v[144:147], a[156:159], v[172:175], v[144:147]
  v_mul_f32 v181, v89, v181
  v_cvt_pk_bf16_f32 v84, v180, v181
  v_mfma_f32_16x16x32_bf16 v[148:151], a[128:131], v[192:195], 0
  ds_read_b128 a[188:191], v5 offset:15360
  v_mul_f32 v182, v89, v182
  v_mfma_f32_16x16x32_bf16 v[148:151], a[132:135], v[196:199], v[148:151]
  buffer_load_dwordx4 v4, s[12:15], s66 offen offset:2048 sc1 lds
  v_mfma_f32_16x16x32_bf16 v[148:151], a[136:139], v[200:203], v[148:151]
  ds_read_b128 a[128:131], v5 offset:16384
  v_mul_f32 v183, v89, v183
  v_mfma_f32_16x16x32_bf16 v[148:151], a[140:143], v[204:207], v[148:151]
  v_cvt_pk_bf16_f32 v85, v182, v183
  v_mul_f32 v188, v89, v188
  v_mfma_f32_16x16x32_bf16 v[148:151], a[144:147], v[224:227], v[148:151]
  ds_read_b128 a[132:135], v5 offset:17408
  v_mul_f32 v189, v89, v189
  v_mfma_f32_16x16x32_bf16 v[148:151], a[148:151], v[228:231], v[148:151]
  buffer_load_dwordx4 v4, s[12:15], s66 offen offset:3072 sc1 lds
  v_mfma_f32_16x16x32_bf16 v[148:151], a[152:155], v[232:235], v[148:151]
  ds_read_b128 a[136:139], v5 offset:18432
  v_cvt_pk_bf16_f32 v86, v188, v189
  v_mfma_f32_16x16x32_bf16 v[148:151], a[156:159], v[236:239], v[148:151]
  s_waitcnt lgkmcnt(7)
  s_lshl_b32 m0, s65, 1
  s_add_u32 m0, m0, 131072
  v_mfma_f32_16x16x32_bf16 v[152:155], a[160:163], v[128:131], 0
  v_mul_f32 v190, v89, v190
  v_mul_f32 v191, v89, v191
  v_mfma_f32_16x16x32_bf16 v[152:155], a[164:167], v[132:135], v[152:155]
  buffer_load_dwordx4 v1, s[12:15], s41 offen offset:0 sc1 lds
  v_mfma_f32_16x16x32_bf16 v[152:155], a[168:171], v[136:139], v[152:155]
  ds_read_b128 a[140:143], v5 offset:19456
  v_cvt_pk_bf16_f32 v87, v190, v191
  v_mfma_f32_16x16x32_bf16 v[152:155], a[172:175], v[140:143], v[152:155]
  s_waitcnt lgkmcnt(4)
  s_add_u32 s19, s73, 97280
  ds_read_b128 a[144:147], v5 offset:20480
  buffer_store_dwordx4 v[84:87], v1, s[12:15], s19 offen sc1
  v_mfma_f32_16x16x32_bf16 v[152:155], a[176:179], v[160:163], v[152:155]
  buffer_load_dwordx4 v1, s[12:15], s41 offen offset:1024 sc1 lds
  v_mfma_f32_16x16x32_bf16 v[152:155], a[180:183], v[164:167], v[152:155]
  ds_read_b128 a[148:151], v5 offset:21504
  v_mul_f32 v144, v88, v144
  v_mfma_f32_16x16x32_bf16 v[152:155], a[184:187], v[168:171], v[152:155]
  ds_read_b128 a[152:155], v5 offset:22528
  v_mul_f32 v145, v88, v145
  v_mfma_f32_16x16x32_bf16 v[152:155], a[188:191], v[172:175], v[152:155]
  buffer_load_dwordx4 v1, s[12:15], s41 offen offset:2048 sc1 lds
  v_mfma_f32_16x16x32_bf16 v[156:159], a[160:163], v[192:195], 0
  ds_read_b128 a[156:159], v5 offset:23552
  v_cvt_pk_bf16_f32 v72, v144, v145
  v_mfma_f32_16x16x32_bf16 v[156:159], a[164:167], v[196:199], v[156:159]
  v_mul_f32 v146, v88, v146
  v_mul_f32 v147, v88, v147
  v_mfma_f32_16x16x32_bf16 v[156:159], a[168:171], v[200:203], v[156:159]
  buffer_load_dwordx4 v1, s[12:15], s41 offen offset:3072 sc1 lds
  v_mfma_f32_16x16x32_bf16 v[156:159], a[172:175], v[204:207], v[156:159]
  s_add_u32 m0, m0, 4096
  s_add_u32 s41, s41, 4096
  v_mfma_f32_16x16x32_bf16 v[156:159], a[176:179], v[224:227], v[156:159]
  ds_read_b128 a[160:163], v5 offset:24576
  ds_read_b128 a[164:167], v5 offset:25600
  v_mfma_f32_16x16x32_bf16 v[156:159], a[180:183], v[228:231], v[156:159]
  buffer_load_dwordx4 v1, s[12:15], s41 offen offset:0 sc1 lds
  v_mfma_f32_16x16x32_bf16 v[156:159], a[184:187], v[232:235], v[156:159]
  ds_read_b128 a[168:171], v5 offset:26624
  v_cvt_pk_bf16_f32 v73, v146, v147
  v_mfma_f32_16x16x32_bf16 v[156:159], a[188:191], v[236:239], v[156:159]
  s_waitcnt lgkmcnt(7)
  v_mul_f32 v152, v88, v152
  v_mul_f32 v153, v88, v153
  v_mfma_f32_16x16x32_bf16 v[176:179], a[128:131], v[128:131], 0
  buffer_load_dwordx4 v1, s[12:15], s41 offen offset:1024 sc1 lds
  v_mfma_f32_16x16x32_bf16 v[176:179], a[132:135], v[132:135], v[176:179]
  ds_read_b128 a[172:175], v5 offset:27648
  v_cvt_pk_bf16_f32 v74, v152, v153
  v_mfma_f32_16x16x32_bf16 v[176:179], a[136:139], v[136:139], v[176:179]
  ds_read_b128 a[176:179], v5 offset:28672
  v_mul_f32 v154, v88, v154
  v_mfma_f32_16x16x32_bf16 v[176:179], a[140:143], v[140:143], v[176:179]
  s_waitcnt lgkmcnt(5)
  v_mul_f32 v155, v88, v155
  v_cvt_pk_bf16_f32 v75, v154, v155
  v_mfma_f32_16x16x32_bf16 v[176:179], a[144:147], v[160:163], v[176:179]
  s_add_u32 s16, s73, 188416
  buffer_load_dwordx4 v1, s[12:15], s41 offen offset:2048 sc1 lds
  v_mfma_f32_16x16x32_bf16 v[176:179], a[148:151], v[164:167], v[176:179]
  ds_read_b128 a[180:183], v5 offset:29696
  v_mul_f32 v148, v89, v148
  v_mfma_f32_16x16x32_bf16 v[176:179], a[152:155], v[168:171], v[176:179]
  ds_read_b128 a[184:187], v5 offset:30720
  v_mul_f32 v149, v89, v149
  v_mfma_f32_16x16x32_bf16 v[176:179], a[156:159], v[172:175], v[176:179]
  buffer_store_dwordx4 v[72:75], v1, s[12:15], s16 offen sc1
  v_mfma_f32_16x16x32_bf16 v[180:183], a[128:131], v[192:195], 0
  buffer_load_dwordx4 v1, s[12:15], s41 offen offset:3072 sc1 lds
  v_mfma_f32_16x16x32_bf16 v[180:183], a[132:135], v[196:199], v[180:183]
  s_add_u32 s41, s41, 4096
  ds_read_b128 a[188:191], v5 offset:31744
  v_cvt_pk_bf16_f32 v76, v148, v149
  v_mfma_f32_16x16x32_bf16 v[180:183], a[136:139], v[200:203], v[180:183]
  s_add_u32 s66, s66, 0x8000
  v_mul_f32 v150, v89, v150
  v_mul_f32 v151, v89, v151
  v_mfma_f32_16x16x32_bf16 v[180:183], a[140:143], v[204:207], v[180:183]
  v_cvt_pk_bf16_f32 v77, v150, v151
  v_mul_f32 v156, v89, v156
  v_mfma_f32_16x16x32_bf16 v[180:183], a[144:147], v[224:227], v[180:183]
  s_add_u32 m0, s67, s65
  v_mul_f32 v157, v89, v157
  v_cvt_pk_bf16_f32 v78, v156, v157
  v_mfma_f32_16x16x32_bf16 v[180:183], a[148:151], v[228:231], v[180:183]
  s_add_u32 s67, s67, 0x8000
  s_and_b32 s67, s67, 0x1ffff
  v_add_u32 v5, s67, v1
  v_mfma_f32_16x16x32_bf16 v[180:183], a[152:155], v[232:235], v[180:183]
  s_waitcnt lgkmcnt(0)
  v_mul_f32 v158, v89, v158
  v_mul_f32 v159, v89, v159
  v_mfma_f32_16x16x32_bf16 v[180:183], a[156:159], v[236:239], v[180:183]
  s_barrier
  v_cvt_pk_bf16_f32 v79, v158, v159
  v_mul_f32 v176, v88, v176
  v_mfma_f32_16x16x32_bf16 v[184:187], a[160:163], v[128:131], 0
  s_add_u32 s17, s73, 190464
  ds_read_b128 a[128:131], v5 offset:0
  ds_read_b128 a[132:135], v5 offset:1024
  v_mfma_f32_16x16x32_bf16 v[184:187], a[164:167], v[132:135], v[184:187]
  buffer_load_dwordx4 v3, s[12:15], s66 offen offset:0 sc1 lds
  v_mfma_f32_16x16x32_bf16 v[184:187], a[168:171], v[136:139], v[184:187]
  ds_read_b128 a[136:139], v5 offset:2048
  ds_read_b128 a[140:143], v5 offset:3072
  v_mfma_f32_16x16x32_bf16 v[184:187], a[172:175], v[140:143], v[184:187]
  buffer_store_dwordx4 v[76:79], v1, s[12:15], s17 offen sc1
  v_mfma_f32_16x16x32_bf16 v[184:187], a[176:179], v[160:163], v[184:187]
  ds_read_b128 a[144:147], v5 offset:4096
  ds_read_b128 a[148:151], v5 offset:5120
  v_mfma_f32_16x16x32_bf16 v[184:187], a[180:183], v[164:167], v[184:187]
  v_mul_f32 v177, v88, v177
  v_cvt_pk_bf16_f32 v80, v176, v177
  v_mfma_f32_16x16x32_bf16 v[184:187], a[184:187], v[168:171], v[184:187]
  ds_read_b128 a[152:155], v5 offset:6144
  v_mul_f32 v178, v88, v178
  v_mfma_f32_16x16x32_bf16 v[184:187], a[188:191], v[172:175], v[184:187]
  v_mul_f32 v179, v88, v179
  v_cvt_pk_bf16_f32 v81, v178, v179
  v_mfma_f32_16x16x32_bf16 v[188:191], a[160:163], v[192:195], 0
  ds_read_b128 a[156:159], v5 offset:7168
  v_mul_f32 v180, v89, v180
  v_mfma_f32_16x16x32_bf16 v[188:191], a[164:167], v[196:199], v[188:191]
  buffer_load_dwordx4 v3, s[12:15], s66 offen offset:1024 sc1 lds
  v_mfma_f32_16x16x32_bf16 v[188:191], a[168:171], v[200:203], v[188:191]
  ds_read_b128 a[160:163], v5 offset:8192
  v_mul_f32 v184, v88, v184
  v_mfma_f32_16x16x32_bf16 v[188:191], a[172:175], v[204:207], v[188:191]
  v_mul_f32 v185, v88, v185
  v_cvt_pk_bf16_f32 v82, v184, v185
  v_mfma_f32_16x16x32_bf16 v[188:191], a[176:179], v[224:227], v[188:191]
  ds_read_b128 a[164:167], v5 offset:9216
  v_mul_f32 v186, v88, v186
  v_mfma_f32_16x16x32_bf16 v[188:191], a[180:183], v[228:231], v[188:191]
  v_mul_f32 v187, v88, v187
  v_cvt_pk_bf16_f32 v83, v186, v187
  v_mfma_f32_16x16x32_bf16 v[188:191], a[184:187], v[232:235], v[188:191]
  s_add_u32 s18, s73, 189440
  ds_read_b128 a[168:171], v5 offset:10240
  v_mul_f32 v181, v89, v181
  v_mfma_f32_16x16x32_bf16 v[188:191], a[188:191], v[236:239], v[188:191]
  s_waitcnt lgkmcnt(7)
  buffer_store_dwordx4 v[80:83], v1, s[12:15], s18 offen sc1
  v_mfma_f32_16x16x32_bf16 v[144:147], a[128:131], v[128:131], 0
  ds_read_b128 a[172:175], v5 offset:11264
  v_cvt_pk_bf16_f32 v84, v180, v181
  v_mfma_f32_16x16x32_bf16 v[144:147], a[132:135], v[132:135], v[144:147]
  buffer_load_dwordx4 v3, s[12:15], s66 offen offset:2048 sc1 lds
  v_mfma_f32_16x16x32_bf16 v[144:147], a[136:139], v[136:139], v[144:147]
  ds_read_b128 a[176:179], v5 offset:12288
  v_mul_f32 v182, v89, v182
  v_mfma_f32_16x16x32_bf16 v[144:147], a[140:143], v[140:143], v[144:147]
  s_waitcnt lgkmcnt(5)
  v_mul_f32 v183, v89, v183
  v_cvt_pk_bf16_f32 v85, v182, v183
  v_mfma_f32_16x16x32_bf16 v[144:147], a[144:147], v[160:163], v[144:147]
  ds_read_b128 a[180:183], v5 offset:13312
  v_mul_f32 v188, v89, v188
  v_mfma_f32_16x16x32_bf16 v[144:147], a[148:151], v[164:167], v[144:147]
  v_mul_f32 v189, v89, v189
  v_cvt_pk_bf16_f32 v86, v188, v189
  v_mfma_f32_16x16x32_bf16 v[144:147], a[152:155], v[168:171], v[144:147]
  ds_read_b128 a[184:187], v5 offset:14336
  v_mul_f32 v190, v89, v190
  v_mfma_f32_16x16x32_bf16 v[144:147], a[156:159], v[172:175], v[144:147]
  v_mul_f32 v191, v89, v191
  v_cvt_pk_bf16_f32 v87, v190, v191
  v_mfma_f32_16x16x32_bf16 v[148:151], a[128:131], v[192:195], 0
  s_add_u32 s19, s73, 191488
  ds_read_b128 a[188:191], v5 offset:15360
  v_mfma_f32_16x16x32_bf16 v[148:151], a[132:135], v[196:199], v[148:151]
  buffer_load_dwordx4 v3, s[12:15], s66 offen offset:3072 sc1 lds
  v_mfma_f32_16x16x32_bf16 v[148:151], a[136:139], v[200:203], v[148:151]
  s_add_u32 m0, m0, 0x4000
  ds_read_b128 a[128:131], v5 offset:16384
  v_mul_f32 v144, v88, v144
  v_mfma_f32_16x16x32_bf16 v[148:151], a[140:143], v[204:207], v[148:151]
  buffer_store_dwordx4 v[84:87], v1, s[12:15], s19 offen sc1
  v_mfma_f32_16x16x32_bf16 v[148:151], a[144:147], v[224:227], v[148:151]
  ds_read_b128 a[132:135], v5 offset:17408
  v_mul_f32 v145, v88, v145
  v_mfma_f32_16x16x32_bf16 v[148:151], a[148:151], v[228:231], v[148:151]
  v_cvt_pk_bf16_f32 v72, v144, v145
  v_mul_f32 v146, v88, v146
  v_mfma_f32_16x16x32_bf16 v[148:151], a[152:155], v[232:235], v[148:151]
  ds_read_b128 a[136:139], v5 offset:18432
  v_mul_f32 v147, v88, v147
  v_mfma_f32_16x16x32_bf16 v[148:151], a[156:159], v[236:239], v[148:151]
  s_waitcnt lgkmcnt(7)
  v_cvt_pk_bf16_f32 v73, v146, v147
  v_mfma_f32_16x16x32_bf16 v[152:155], a[160:163], v[128:131], 0
  ds_read_b128 a[140:143], v5 offset:19456
  v_mfma_f32_16x16x32_bf16 v[152:155], a[164:167], v[132:135], v[152:155]
  buffer_load_dwordx4 v4, s[12:15], s66 offen offset:0 sc1 lds
  v_mfma_f32_16x16x32_bf16 v[152:155], a[168:171], v[136:139], v[152:155]
  ds_read_b128 a[144:147], v5 offset:20480
  v_mfma_f32_16x16x32_bf16 v[152:155], a[172:175], v[140:143], v[152:155]
  s_waitcnt lgkmcnt(5)
  v_mul_f32 v148, v89, v148
  v_mul_f32 v149, v89, v149
  v_mfma_f32_16x16x32_bf16 v[152:155], a[176:179], v[160:163], v[152:155]
  ds_read_b128 a[148:151], v5 offset:21504
  v_cvt_pk_bf16_f32 v76, v148, v149
  v_mfma_f32_16x16x32_bf16 v[152:155], a[180:183], v[164:167], v[152:155]
  v_mul_f32 v150, v89, v150
  v_mul_f32 v151, v89, v151
  v_mfma_f32_16x16x32_bf16 v[152:155], a[184:187], v[168:171], v[152:155]
  ds_read_b128 a[152:155], v5 offset:22528
  v_cvt_pk_bf16_f32 v77, v150, v151
  v_mfma_f32_16x16x32_bf16 v[152:155], a[188:191], v[172:175], v[152:155]
  v_mfma_f32_16x16x32_bf16 v[156:159], a[160:163], v[192:195], 0
  ds_read_b128 a[156:159], v5 offset:23552
  v_mfma_f32_16x16x32_bf16 v[156:159], a[164:167], v[196:199], v[156:159]
  buffer_load_dwordx4 v4, s[12:15], s66 offen offset:1024 sc1 lds
  v_mfma_f32_16x16x32_bf16 v[156:159], a[168:171], v[200:203], v[156:159]
  ds_read_b128 a[160:163], v5 offset:24576
  v_mfma_f32_16x16x32_bf16 v[156:159], a[172:175], v[204:207], v[156:159]
  v_mfma_f32_16x16x32_bf16 v[156:159], a[176:179], v[224:227], v[156:159]
  ds_read_b128 a[164:167], v5 offset:25600
  v_mul_f32 v152, v88, v152
  v_mfma_f32_16x16x32_bf16 v[156:159], a[180:183], v[228:231], v[156:159]
  v_mul_f32 v153, v88, v153
  v_cvt_pk_bf16_f32 v74, v152, v153
  v_mfma_f32_16x16x32_bf16 v[156:159], a[184:187], v[232:235], v[156:159]
  ds_read_b128 a[168:171], v5 offset:26624
  v_mul_f32 v154, v88, v154
  v_mfma_f32_16x16x32_bf16 v[156:159], a[188:191], v[236:239], v[156:159]
  s_waitcnt lgkmcnt(7)
  v_mul_f32 v155, v88, v155
  v_cvt_pk_bf16_f32 v75, v154, v155
  v_mfma_f32_16x16x32_bf16 v[176:179], a[128:131], v[128:131], 0
  s_add_u32 s16, s73, 282624
  ds_read_b128 a[172:175], v5 offset:27648
  v_mfma_f32_16x16x32_bf16 v[176:179], a[132:135], v[132:135], v[176:179]
  buffer_load_dwordx4 v4, s[12:15], s66 offen offset:2048 sc1 lds
  v_mfma_f32_16x16x32_bf16 v[176:179], a[136:139], v[136:139], v[176:179]
  ds_read_b128 a[176:179], v5 offset:28672
  v_mul_f32 v156, v89, v156
  v_mfma_f32_16x16x32_bf16 v[176:179], a[140:143], v[140:143], v[176:179]
  s_waitcnt lgkmcnt(5)
  buffer_store_dwordx4 v[72:75], v1, s[12:15], s16 offen sc1
  v_mfma_f32_16x16x32_bf16 v[176:179], a[144:147], v[160:163], v[176:179]
  ds_read_b128 a[180:183], v5 offset:29696
  v_mul_f32 v157, v89, v157
  v_mfma_f32_16x16x32_bf16 v[176:179], a[148:151], v[164:167], v[176:179]
  v_cvt_pk_bf16_f32 v78, v156, v157
  v_mul_f32 v158, v89, v158
  v_mfma_f32_16x16x32_bf16 v[176:179], a[152:155], v[168:171], v[176:179]
  ds_read_b128 a[184:187], v5 offset:30720
  v_mul_f32 v159, v89, v159
  v_mfma_f32_16x16x32_bf16 v[176:179], a[156:159], v[172:175], v[176:179]
  v_cvt_pk_bf16_f32 v79, v158, v159
  v_mfma_f32_16x16x32_bf16 v[180:183], a[128:131], v[192:195], 0
  s_add_u32 s17, s73, 284672
  buffer_load_dwordx4 v4, s[12:15], s66 offen offset:3072 sc1 lds
  v_mfma_f32_16x16x32_bf16 v[180:183], a[132:135], v[196:199], v[180:183]
  s_mov_b32 s66, s63
  ds_read_b128 a[188:191], v5 offset:31744
  v_mfma_f32_16x16x32_bf16 v[180:183], a[136:139], v[200:203], v[180:183]
  s_add_u32 m0, s67, s65
  buffer_store_dwordx4 v[76:79], v1, s[12:15], s17 offen sc1
  v_mfma_f32_16x16x32_bf16 v[180:183], a[140:143], v[204:207], v[180:183]
  v_mul_f32 v176, v88, v176
  v_mul_f32 v177, v88, v177
  v_mfma_f32_16x16x32_bf16 v[180:183], a[144:147], v[224:227], v[180:183]
  s_add_u32 s67, s67, 0x8000
  v_cvt_pk_bf16_f32 v80, v176, v177
  v_mul_f32 v178, v88, v178
  v_mfma_f32_16x16x32_bf16 v[180:183], a[148:151], v[228:231], v[180:183]
  s_and_b32 s67, s67, 0x1ffff
  v_add_u32 v5, s67, v1
  v_mul_f32 v179, v88, v179
  v_mfma_f32_16x16x32_bf16 v[180:183], a[152:155], v[232:235], v[180:183]
  s_waitcnt vmcnt(13) lgkmcnt(0)
  v_cvt_pk_bf16_f32 v81, v178, v179
  v_mfma_f32_16x16x32_bf16 v[180:183], a[156:159], v[236:239], v[180:183]
  s_barrier
  v_mfma_f32_16x16x32_bf16 v[184:187], a[160:163], v[128:131], 0
  ds_read_b128 a[128:131], v5 offset:0
  ds_read_b128 a[132:135], v5 offset:1024
  v_mfma_f32_16x16x32_bf16 v[184:187], a[164:167], v[132:135], v[184:187]
  buffer_load_dwordx4 v3, s[12:15], s66 offen offset:0 sc1 lds
  v_mfma_f32_16x16x32_bf16 v[184:187], a[168:171], v[136:139], v[184:187]
  ds_read_b128 a[136:139], v5 offset:2048
  ds_read_b128 a[140:143], v5 offset:3072
  ds_read_b128 a[192:195], v16 offset:0
  v_mfma_f32_16x16x32_bf16 v[184:187], a[172:175], v[140:143], v[184:187]
  ds_read_b128 a[144:147], v5 offset:4096
  ds_read_b128 a[196:199], v16 offset:1024
  v_mfma_f32_16x16x32_bf16 v[184:187], a[176:179], v[160:163], v[184:187]
  ds_read_b128 a[148:151], v5 offset:5120
  v_mul_f32 v180, v89, v180
  v_mfma_f32_16x16x32_bf16 v[184:187], a[180:183], v[164:167], v[184:187]
  buffer_load_dwordx4 v3, s[12:15], s66 offen offset:1024 sc1 lds
  v_mfma_f32_16x16x32_bf16 v[184:187], a[184:187], v[168:171], v[184:187]
  ds_read_b128 a[152:155], v5 offset:6144
  ds_read_b128 a[224:227], v16 offset:2048
  v_mfma_f32_16x16x32_bf16 v[184:187], a[188:191], v[172:175], v[184:187]
  v_mul_f32 v181, v89, v181
  v_cvt_pk_bf16_f32 v84, v180, v181
  v_mfma_f32_16x16x32_bf16 v[188:191], a[160:163], v[192:195], 0
  ds_read_b128 a[156:159], v5 offset:7168
  v_mul_f32 v182, v89, v182
  v_mfma_f32_16x16x32_bf16 v[188:191], a[164:167], v[196:199], v[188:191]
  buffer_load_dwordx4 v3, s[12:15], s66 offen offset:2048 sc1 lds
  v_mfma_f32_16x16x32_bf16 v[188:191], a[168:171], v[200:203], v[188:191]
  ds_read_b128 a[228:231], v16 offset:3072
  ds_read_b128 a[160:163], v5 offset:8192
  v_mfma_f32_16x16x32_bf16 v[188:191], a[172:175], v[204:207], v[188:191]
  v_mul_f32 v184, v88, v184
  v_mul_f32 v185, v88, v185
  v_mfma_f32_16x16x32_bf16 v[188:191], a[176:179], v[224:227], v[188:191]
  ds_read_b128 a[164:167], v5 offset:9216
  ds_read_b128 a[200:203], v16 offset:4096
  v_mfma_f32_16x16x32_bf16 v[188:191], a[180:183], v[228:231], v[188:191]
  buffer_load_dwordx4 v3, s[12:15], s66 offen offset:3072 sc1 lds
  v_mfma_f32_16x16x32_bf16 v[188:191], a[184:187], v[232:235], v[188:191]
  s_add_u32 m0, m0, 0x4000
  ds_read_b128 a[168:171], v5 offset:10240
  v_cvt_pk_bf16_f32 v82, v184, v185
  v_mfma_f32_16x16x32_bf16 v[188:191], a[188:191], v[236:239], v[188:191]
  s_waitcnt lgkmcnt(12)
  ds_read_b128 a[204:207], v16 offset:5120
  v_mul_f32 v186, v88, v186
  v_mfma_f32_16x16x32_bf16 v[144:147], a[128:131], v[128:131], 0
  ds_read_b128 a[172:175], v5 offset:11264
  v_mul_f32 v187, v88, v187
  v_mfma_f32_16x16x32_bf16 v[144:147], a[132:135], v[132:135], v[144:147]
  buffer_load_dwordx4 v4, s[12:15], s66 offen offset:0 sc1 lds
  v_mfma_f32_16x16x32_bf16 v[144:147], a[136:139], v[136:139], v[144:147]
  ds_read_b128 a[176:179], v5 offset:12288
  ds_read_b128 a[232:235], v16 offset:6144
  v_mfma_f32_16x16x32_bf16 v[144:147], a[140:143], v[140:143], v[144:147]
  s_waitcnt lgkmcnt(9)
  v_cvt_pk_bf16_f32 v83, v186, v187
  v_mul_f32 v183, v89, v183
  v_mfma_f32_16x16x32_bf16 v[144:147], a[144:147], v[160:163], v[144:147]
  s_add_u32 s18, s73, 283648
  ds_read_b128 a[180:183], v5 offset:13312
  v_cvt_pk_bf16_f32 v85, v182, v183
  v_mfma_f32_16x16x32_bf16 v[144:147], a[148:151], v[164:167], v[144:147]
  s_mov_b32 s63, s44
  buffer_load_dwordx4 v4, s[12:15], s66 offen offset:1024 sc1 lds
  v_mfma_f32_16x16x32_bf16 v[144:147], a[152:155], v[168:171], v[144:147]
  ds_read_b128 a[236:239], v16 offset:7168
  ds_read_b128 a[184:187], v5 offset:14336
  v_mfma_f32_16x16x32_bf16 v[144:147], a[156:159], v[172:175], v[144:147]
  buffer_store_dwordx4 v[80:83], v1, s[12:15], s18 offen sc1
  v_mfma_f32_16x16x32_bf16 v[148:151], a[128:131], v[192:195], 0
  ds_read_b128 a[188:191], v5 offset:15360
  v_mul_f32 v188, v89, v188
  v_mfma_f32_16x16x32_bf16 v[148:151], a[132:135], v[196:199], v[148:151]
  buffer_load_dwordx4 v4, s[12:15], s66 offen offset:2048 sc1 lds
  v_mfma_f32_16x16x32_bf16 v[148:151], a[136:139], v[200:203], v[148:151]
  ds_read_b128 a[128:131], v5 offset:16384
  v_mul_f32 v189, v89, v189
  v_mfma_f32_16x16x32_bf16 v[148:151], a[140:143], v[204:207], v[148:151]
  v_cvt_pk_bf16_f32 v86, v188, v189
  v_mul_f32 v190, v89, v190
  v_mfma_f32_16x16x32_bf16 v[148:151], a[144:147], v[224:227], v[148:151]
  ds_read_b128 a[132:135], v5 offset:17408
  v_mul_f32 v191, v89, v191
  v_mfma_f32_16x16x32_bf16 v[148:151], a[148:151], v[228:231], v[148:151]
  buffer_load_dwordx4 v4, s[12:15], s66 offen offset:3072 sc1 lds
  v_mfma_f32_16x16x32_bf16 v[148:151], a[152:155], v[232:235], v[148:151]
  s_waitcnt lgkmcnt(4)
  ds_read_b128 a[136:139], v5 offset:18432
  v_cvt_pk_bf16_f32 v87, v190, v191
  v_mfma_f32_16x16x32_bf16 v[148:151], a[156:159], v[236:239], v[148:151]
  s_lshl_b32 m0, s65, 1
  s_add_u32 m0, m0, 131072
  v_mfma_f32_16x16x32_bf16 v[152:155], a[160:163], v[128:131], 0
  s_add_u32 s19, s73, 285696
  ds_read_b128 a[140:143], v5 offset:19456
  v_mul_f32 v144, v88, v144
  v_mfma_f32_16x16x32_bf16 v[152:155], a[164:167], v[132:135], v[152:155]
  buffer_load_dwordx4 v1, s[12:15], s41 offen offset:0 sc1 lds
  v_mfma_f32_16x16x32_bf16 v[152:155], a[168:171], v[136:139], v[152:155]
  buffer_store_dwordx4 v[84:87], v1, s[12:15], s19 offen sc1
  v_mfma_f32_16x16x32_bf16 v[152:155], a[172:175], v[140:143], v[152:155]
  s_waitcnt lgkmcnt(4)
  ds_read_b128 a[144:147], v5 offset:20480
  v_mul_f32 v145, v88, v145
  v_mfma_f32_16x16x32_bf16 v[152:155], a[176:179], v[160:163], v[152:155]
  buffer_load_dwordx4 v1, s[12:15], s41 offen offset:1024 sc1 lds
  v_mfma_f32_16x16x32_bf16 v[152:155], a[180:183], v[164:167], v[152:155]
  ds_read_b128 a[148:151], v5 offset:21504
  v_cvt_pk_bf16_f32 v72, v144, v145
  v_mfma_f32_16x16x32_bf16 v[152:155], a[184:187], v[168:171], v[152:155]
  ds_read_b128 a[152:155], v5 offset:22528
  v_mul_f32 v146, v88, v146
  v_mfma_f32_16x16x32_bf16 v[152:155], a[188:191], v[172:175], v[152:155]
  buffer_load_dwordx4 v1, s[12:15], s41 offen offset:2048 sc1 lds
  v_mfma_f32_16x16x32_bf16 v[156:159], a[160:163], v[192:195], 0
  ds_read_b128 a[156:159], v5 offset:23552
  v_mul_f32 v147, v88, v147
  v_mfma_f32_16x16x32_bf16 v[156:159], a[164:167], v[196:199], v[156:159]
  v_cvt_pk_bf16_f32 v73, v146, v147
  v_mul_f32 v148, v89, v148
  v_mfma_f32_16x16x32_bf16 v[156:159], a[168:171], v[200:203], v[156:159]
  buffer_load_dwordx4 v1, s[12:15], s41 offen offset:3072 sc1 lds
  v_mfma_f32_16x16x32_bf16 v[156:159], a[172:175], v[204:207], v[156:159]
  s_add_u32 m0, m0, 4096
  s_add_u32 s41, s41, 4096
  v_mfma_f32_16x16x32_bf16 v[156:159], a[176:179], v[224:227], v[156:159]
  ds_read_b128 a[160:163], v5 offset:24576
  ds_read_b128 a[164:167], v5 offset:25600
  v_mfma_f32_16x16x32_bf16 v[156:159], a[180:183], v[228:231], v[156:159]
  buffer_load_dwordx4 v1, s[12:15], s41 offen offset:0 sc1 lds
  v_mfma_f32_16x16x32_bf16 v[156:159], a[184:187], v[232:235], v[156:159]
  ds_read_b128 a[168:171], v5 offset:26624
  v_mul_f32 v152, v88, v152
  v_mfma_f32_16x16x32_bf16 v[156:159], a[188:191], v[236:239], v[156:159]
  s_waitcnt lgkmcnt(7)
  v_mul_f32 v153, v88, v153
  v_cvt_pk_bf16_f32 v74, v152, v153
  v_mfma_f32_16x16x32_bf16 v[176:179], a[128:131], v[128:131], 0
  buffer_load_dwordx4 v1, s[12:15], s41 offen offset:1024 sc1 lds
  v_mfma_f32_16x16x32_bf16 v[176:179], a[132:135], v[132:135], v[176:179]
  ds_read_b128 a[172:175], v5 offset:27648
  v_mul_f32 v154, v88, v154
  v_mfma_f32_16x16x32_bf16 v[176:179], a[136:139], v[136:139], v[176:179]
  ds_read_b128 a[176:179], v5 offset:28672
  v_mul_f32 v155, v88, v155
  v_mfma_f32_16x16x32_bf16 v[176:179], a[140:143], v[140:143], v[176:179]
  s_waitcnt lgkmcnt(5)
  v_cvt_pk_bf16_f32 v75, v154, v155
  v_mul_f32 v149, v89, v149
  v_mfma_f32_16x16x32_bf16 v[176:179], a[144:147], v[160:163], v[176:179]
  s_add_u32 s16, s73, 376832
  buffer_load_dwordx4 v1, s[12:15], s41 offen offset:2048 sc1 lds
  v_mfma_f32_16x16x32_bf16 v[176:179], a[148:151], v[164:167], v[176:179]
  ds_read_b128 a[180:183], v5 offset:29696
  v_cvt_pk_bf16_f32 v76, v148, v149
  v_mfma_f32_16x16x32_bf16 v[176:179], a[152:155], v[168:171], v[176:179]
  ds_read_b128 a[184:187], v5 offset:30720
  v_mul_f32 v150, v89, v150
  v_mfma_f32_16x16x32_bf16 v[176:179], a[156:159], v[172:175], v[176:179]
  buffer_store_dwordx4 v[72:75], v1, s[12:15], s16 offen sc1
  v_mfma_f32_16x16x32_bf16 v[180:183], a[128:131], v[192:195], 0
  buffer_load_dwordx4 v1, s[12:15], s41 offen offset:3072 sc1 lds
  v_mfma_f32_16x16x32_bf16 v[180:183], a[132:135], v[196:199], v[180:183]
  s_add_u32 s41, s41, 4096
  ds_read_b128 a[188:191], v5 offset:31744
  v_mul_f32 v151, v89, v151
  v_mfma_f32_16x16x32_bf16 v[180:183], a[136:139], v[200:203], v[180:183]
  s_add_u32 s66, s66, 0x8000
  v_cvt_pk_bf16_f32 v77, v150, v151
  v_mul_f32 v156, v89, v156
  v_mfma_f32_16x16x32_bf16 v[180:183], a[140:143], v[204:207], v[180:183]
  v_mul_f32 v157, v89, v157
  v_cvt_pk_bf16_f32 v78, v156, v157
  v_mfma_f32_16x16x32_bf16 v[180:183], a[144:147], v[224:227], v[180:183]
  s_add_u32 m0, s67, s65
  v_mul_f32 v158, v89, v158
  v_mul_f32 v159, v89, v159
  v_mfma_f32_16x16x32_bf16 v[180:183], a[148:151], v[228:231], v[180:183]
  s_add_u32 s67, s67, 0x8000
  s_and_b32 s67, s67, 0x1ffff
  v_add_u32 v5, s67, v1
  v_mfma_f32_16x16x32_bf16 v[180:183], a[152:155], v[232:235], v[180:183]
  s_waitcnt lgkmcnt(0)
  v_cvt_pk_bf16_f32 v79, v158, v159
  v_mul_f32 v176, v88, v176
  v_mfma_f32_16x16x32_bf16 v[180:183], a[156:159], v[236:239], v[180:183]
  s_barrier
  v_mul_f32 v177, v88, v177
  v_cvt_pk_bf16_f32 v80, v176, v177
  v_mfma_f32_16x16x32_bf16 v[184:187], a[160:163], v[128:131], 0
  s_add_u32 s17, s73, 378880
  ds_read_b128 a[128:131], v5 offset:0
  ds_read_b128 a[132:135], v5 offset:1024
  v_mfma_f32_16x16x32_bf16 v[184:187], a[164:167], v[132:135], v[184:187]
  buffer_load_dwordx4 v3, s[12:15], s66 offen offset:0 sc1 lds
  v_mfma_f32_16x16x32_bf16 v[184:187], a[168:171], v[136:139], v[184:187]
  ds_read_b128 a[136:139], v5 offset:2048
  ds_read_b128 a[140:143], v5 offset:3072
  v_mfma_f32_16x16x32_bf16 v[184:187], a[172:175], v[140:143], v[184:187]
  buffer_store_dwordx4 v[76:79], v1, s[12:15], s17 offen sc1
  v_mfma_f32_16x16x32_bf16 v[184:187], a[176:179], v[160:163], v[184:187]
  ds_read_b128 a[144:147], v5 offset:4096
  ds_read_b128 a[148:151], v5 offset:5120
  v_mfma_f32_16x16x32_bf16 v[184:187], a[180:183], v[164:167], v[184:187]
  v_mul_f32 v178, v88, v178
  v_mul_f32 v179, v88, v179
  v_mfma_f32_16x16x32_bf16 v[184:187], a[184:187], v[168:171], v[184:187]
  ds_read_b128 a[152:155], v5 offset:6144
  v_cvt_pk_bf16_f32 v81, v178, v179
  v_mfma_f32_16x16x32_bf16 v[184:187], a[188:191], v[172:175], v[184:187]
  v_mul_f32 v180, v89, v180
  v_mul_f32 v181, v89, v181
  v_mfma_f32_16x16x32_bf16 v[188:191], a[160:163], v[192:195], 0
  ds_read_b128 a[156:159], v5 offset:7168
  v_cvt_pk_bf16_f32 v84, v180, v181
  v_mfma_f32_16x16x32_bf16 v[188:191], a[164:167], v[196:199], v[188:191]
  buffer_load_dwordx4 v3, s[12:15], s66 offen offset:1024 sc1 lds
  v_mfma_f32_16x16x32_bf16 v[188:191], a[168:171], v[200:203], v[188:191]
  ds_read_b128 a[160:163], v5 offset:8192
  v_mul_f32 v184, v88, v184
  v_mfma_f32_16x16x32_bf16 v[188:191], a[172:175], v[204:207], v[188:191]
  v_mul_f32 v185, v88, v185
  v_cvt_pk_bf16_f32 v82, v184, v185
  v_mfma_f32_16x16x32_bf16 v[188:191], a[176:179], v[224:227], v[188:191]
  ds_read_b128 a[164:167], v5 offset:9216
  v_mul_f32 v186, v88, v186
  v_mfma_f32_16x16x32_bf16 v[188:191], a[180:183], v[228:231], v[188:191]
  v_mul_f32 v187, v88, v187
  v_cvt_pk_bf16_f32 v83, v186, v187
  v_mfma_f32_16x16x32_bf16 v[188:191], a[184:187], v[232:235], v[188:191]
  s_add_u32 s18, s73, 377856
  ds_read_b128 a[168:171], v5 offset:10240
  v_mul_f32 v182, v89, v182
  v_mfma_f32_16x16x32_bf16 v[188:191], a[188:191], v[236:239], v[188:191]
  s_waitcnt lgkmcnt(7)
  buffer_store_dwordx4 v[80:83], v1, s[12:15], s18 offen sc1
  v_mfma_f32_16x16x32_bf16 v[144:147], a[128:131], v[128:131], 0
  ds_read_b128 a[172:175], v5 offset:11264
  v_mul_f32 v183, v89, v183
  v_mfma_f32_16x16x32_bf16 v[144:147], a[132:135], v[132:135], v[144:147]
  buffer_load_dwordx4 v3, s[12:15], s66 offen offset:2048 sc1 lds
  v_mfma_f32_16x16x32_bf16 v[144:147], a[136:139], v[136:139], v[144:147]
  ds_read_b128 a[176:179], v5 offset:12288
  v_cvt_pk_bf16_f32 v85, v182, v183
  v_mfma_f32_16x16x32_bf16 v[144:147], a[140:143], v[140:143], v[144:147]
  s_waitcnt lgkmcnt(5)
  v_mul_f32 v188, v89, v188
  v_mul_f32 v189, v89, v189
  v_mfma_f32_16x16x32_bf16 v[144:147], a[144:147], v[160:163], v[144:147]
  ds_read_b128 a[180:183], v5 offset:13312
  v_cvt_pk_bf16_f32 v86, v188, v189
  v_mfma_f32_16x16x32_bf16 v[144:147], a[148:151], v[164:167], v[144:147]
  v_mul_f32 v190, v89, v190
  v_mul_f32 v191, v89, v191
  v_mfma_f32_16x16x32_bf16 v[144:147], a[152:155], v[168:171], v[144:147]
  ds_read_b128 a[184:187], v5 offset:14336
  v_cvt_pk_bf16_f32 v87, v190, v191
  v_mfma_f32_16x16x32_bf16 v[144:147], a[156:159], v[172:175], v[144:147]
  v_mfma_f32_16x16x32_bf16 v[148:151], a[128:131], v[192:195], 0
  s_add_u32 s19, s73, 379904
  ds_read_b128 a[188:191], v5 offset:15360
  v_mfma_f32_16x16x32_bf16 v[148:151], a[132:135], v[196:199], v[148:151]
  buffer_load_dwordx4 v3, s[12:15], s66 offen offset:3072 sc1 lds
  v_mfma_f32_16x16x32_bf16 v[148:151], a[136:139], v[200:203], v[148:151]
  s_add_u32 m0, m0, 0x4000
  ds_read_b128 a[128:131], v5 offset:16384
  v_mul_f32 v144, v88, v144
  v_mfma_f32_16x16x32_bf16 v[148:151], a[140:143], v[204:207], v[148:151]
  buffer_store_dwordx4 v[84:87], v1, s[12:15], s19 offen sc1
  v_mfma_f32_16x16x32_bf16 v[148:151], a[144:147], v[224:227], v[148:151]
  ds_read_b128 a[132:135], v5 offset:17408
  v_mul_f32 v145, v88, v145
  v_mfma_f32_16x16x32_bf16 v[148:151], a[148:151], v[228:231], v[148:151]
  v_cvt_pk_bf16_f32 v72, v144, v145
  v_mul_f32 v146, v88, v146
  v_mfma_f32_16x16x32_bf16 v[148:151], a[152:155], v[232:235], v[148:151]
  ds_read_b128 a[136:139], v5 offset:18432
  v_mul_f32 v147, v88, v147
  v_mfma_f32_16x16x32_bf16 v[148:151], a[156:159], v[236:239], v[148:151]
  s_waitcnt lgkmcnt(7)
  v_cvt_pk_bf16_f32 v73, v146, v147
  v_mfma_f32_16x16x32_bf16 v[152:155], a[160:163], v[128:131], 0
  ds_read_b128 a[140:143], v5 offset:19456
  v_mfma_f32_16x16x32_bf16 v[152:155], a[164:167], v[132:135], v[152:155]
  buffer_load_dwordx4 v4, s[12:15], s66 offen offset:0 sc1 lds
  v_mfma_f32_16x16x32_bf16 v[152:155], a[168:171], v[136:139], v[152:155]
  ds_read_b128 a[144:147], v5 offset:20480
  v_mfma_f32_16x16x32_bf16 v[152:155], a[172:175], v[140:143], v[152:155]
  s_waitcnt lgkmcnt(5)
  v_mul_f32 v148, v89, v148
  v_mul_f32 v149, v89, v149
  v_mfma_f32_16x16x32_bf16 v[152:155], a[176:179], v[160:163], v[152:155]
  ds_read_b128 a[148:151], v5 offset:21504
  v_cvt_pk_bf16_f32 v76, v148, v149
  v_mfma_f32_16x16x32_bf16 v[152:155], a[180:183], v[164:167], v[152:155]
  v_mul_f32 v150, v89, v150
  v_mul_f32 v151, v89, v151
  v_mfma_f32_16x16x32_bf16 v[152:155], a[184:187], v[168:171], v[152:155]
  ds_read_b128 a[152:155], v5 offset:22528
  v_cvt_pk_bf16_f32 v77, v150, v151
  v_mfma_f32_16x16x32_bf16 v[152:155], a[188:191], v[172:175], v[152:155]
  v_mfma_f32_16x16x32_bf16 v[156:159], a[160:163], v[192:195], 0
  ds_read_b128 a[156:159], v5 offset:23552
  v_mfma_f32_16x16x32_bf16 v[156:159], a[164:167], v[196:199], v[156:159]
  buffer_load_dwordx4 v4, s[12:15], s66 offen offset:1024 sc1 lds
  v_mfma_f32_16x16x32_bf16 v[156:159], a[168:171], v[200:203], v[156:159]
  ds_read_b128 a[160:163], v5 offset:24576
  v_mfma_f32_16x16x32_bf16 v[156:159], a[172:175], v[204:207], v[156:159]
  v_mfma_f32_16x16x32_bf16 v[156:159], a[176:179], v[224:227], v[156:159]
  ds_read_b128 a[164:167], v5 offset:25600
  v_mul_f32 v152, v88, v152
  v_mfma_f32_16x16x32_bf16 v[156:159], a[180:183], v[228:231], v[156:159]
  v_mul_f32 v153, v88, v153
  v_cvt_pk_bf16_f32 v74, v152, v153
  v_mfma_f32_16x16x32_bf16 v[156:159], a[184:187], v[232:235], v[156:159]
  ds_read_b128 a[168:171], v5 offset:26624
  v_mul_f32 v154, v88, v154
  v_mfma_f32_16x16x32_bf16 v[156:159], a[188:191], v[236:239], v[156:159]
  s_waitcnt lgkmcnt(7)
  v_mul_f32 v155, v88, v155
  v_cvt_pk_bf16_f32 v75, v154, v155
  v_mfma_f32_16x16x32_bf16 v[176:179], a[128:131], v[128:131], 0
  s_add_u32 s16, s73, 471040
  ds_read_b128 a[172:175], v5 offset:27648
  v_mfma_f32_16x16x32_bf16 v[176:179], a[132:135], v[132:135], v[176:179]
  buffer_load_dwordx4 v4, s[12:15], s66 offen offset:2048 sc1 lds
  v_mfma_f32_16x16x32_bf16 v[176:179], a[136:139], v[136:139], v[176:179]
  ds_read_b128 a[176:179], v5 offset:28672
  v_mul_f32 v156, v89, v156
  v_mfma_f32_16x16x32_bf16 v[176:179], a[140:143], v[140:143], v[176:179]
  s_waitcnt lgkmcnt(5)
  buffer_store_dwordx4 v[72:75], v1, s[12:15], s16 offen sc1
  v_mfma_f32_16x16x32_bf16 v[176:179], a[144:147], v[160:163], v[176:179]
  ds_read_b128 a[180:183], v5 offset:29696
  v_mul_f32 v157, v89, v157
  v_mfma_f32_16x16x32_bf16 v[176:179], a[148:151], v[164:167], v[176:179]
  v_cvt_pk_bf16_f32 v78, v156, v157
  v_mul_f32 v158, v89, v158
  v_mfma_f32_16x16x32_bf16 v[176:179], a[152:155], v[168:171], v[176:179]
  ds_read_b128 a[184:187], v5 offset:30720
  v_mul_f32 v159, v89, v159
  v_mfma_f32_16x16x32_bf16 v[176:179], a[156:159], v[172:175], v[176:179]
  v_cvt_pk_bf16_f32 v79, v158, v159
  v_mfma_f32_16x16x32_bf16 v[180:183], a[128:131], v[192:195], 0
  s_add_u32 s17, s73, 473088
  buffer_load_dwordx4 v4, s[12:15], s66 offen offset:3072 sc1 lds
  v_mfma_f32_16x16x32_bf16 v[180:183], a[132:135], v[196:199], v[180:183]
  s_add_u32 s66, s66, 0x8000
  ds_read_b128 a[188:191], v5 offset:31744
  v_mfma_f32_16x16x32_bf16 v[180:183], a[136:139], v[200:203], v[180:183]
  s_add_u32 m0, s67, s65
  buffer_store_dwordx4 v[76:79], v1, s[12:15], s17 offen sc1
  v_mfma_f32_16x16x32_bf16 v[180:183], a[140:143], v[204:207], v[180:183]
  v_mul_f32 v176, v88, v176
  v_mul_f32 v177, v88, v177
  v_mfma_f32_16x16x32_bf16 v[180:183], a[144:147], v[224:227], v[180:183]
  s_add_u32 s67, s67, 0x8000
  v_cvt_pk_bf16_f32 v80, v176, v177
  v_mul_f32 v178, v88, v178
  v_mfma_f32_16x16x32_bf16 v[180:183], a[148:151], v[228:231], v[180:183]
  s_and_b32 s67, s67, 0x1ffff
  v_add_u32 v5, s67, v1
  v_mul_f32 v179, v88, v179
  v_mfma_f32_16x16x32_bf16 v[180:183], a[152:155], v[232:235], v[180:183]
  s_waitcnt vmcnt(13) lgkmcnt(0)
  v_cvt_pk_bf16_f32 v81, v178, v179
  v_mfma_f32_16x16x32_bf16 v[180:183], a[156:159], v[236:239], v[180:183]
  s_barrier
  v_mfma_f32_16x16x32_bf16 v[184:187], a[160:163], v[128:131], 0
  ds_read_b128 a[128:131], v5 offset:0
  ds_read_b128 a[132:135], v5 offset:1024
  v_mfma_f32_16x16x32_bf16 v[184:187], a[164:167], v[132:135], v[184:187]
  buffer_load_dwordx4 v3, s[12:15], s66 offen offset:0 sc1 lds
  v_mfma_f32_16x16x32_bf16 v[184:187], a[168:171], v[136:139], v[184:187]
  ds_read_b128 a[136:139], v5 offset:2048
  ds_read_b128 a[140:143], v5 offset:3072
  ds_read_b128 a[208:211], v16 offset:0
  v_mfma_f32_16x16x32_bf16 v[184:187], a[172:175], v[140:143], v[184:187]
  ds_read_b128 a[144:147], v5 offset:4096
  v_mul_f32 v180, v89, v180
  v_mfma_f32_16x16x32_bf16 v[184:187], a[176:179], v[160:163], v[184:187]
  ds_read_b128 a[148:151], v5 offset:5120
  v_mul_f32 v181, v89, v181
  v_mfma_f32_16x16x32_bf16 v[184:187], a[180:183], v[164:167], v[184:187]
  v_cvt_pk_bf16_f32 v84, v180, v181
  v_mul_f32 v182, v89, v182
  v_mfma_f32_16x16x32_bf16 v[184:187], a[184:187], v[168:171], v[184:187]
  ds_read_b128 a[152:155], v5 offset:6144
  ds_read_b128 a[212:215], v16 offset:1024
  v_mfma_f32_16x16x32_bf16 v[184:187], a[188:191], v[172:175], v[184:187]
  v_mul_f32 v183, v89, v183
  v_cvt_pk_bf16_f32 v85, v182, v183
  v_mfma_f32_16x16x32_bf16 v[188:191], a[160:163], v[192:195], 0
  ds_read_b128 a[156:159], v5 offset:7168
  v_mfma_f32_16x16x32_bf16 v[188:191], a[164:167], v[196:199], v[188:191]
  buffer_load_dwordx4 v3, s[12:15], s66 offen offset:1024 sc1 lds
  v_mfma_f32_16x16x32_bf16 v[188:191], a[168:171], v[200:203], v[188:191]
  ds_read_b128 a[160:163], v5 offset:8192
  v_mul_f32 v184, v88, v184
  v_mfma_f32_16x16x32_bf16 v[188:191], a[172:175], v[204:207], v[188:191]
  v_mul_f32 v185, v88, v185
  v_cvt_pk_bf16_f32 v82, v184, v185
  v_mfma_f32_16x16x32_bf16 v[188:191], a[176:179], v[224:227], v[188:191]
  ds_read_b128 a[164:167], v5 offset:9216
  ds_read_b128 a[240:243], v16 offset:2048
  v_mfma_f32_16x16x32_bf16 v[188:191], a[180:183], v[228:231], v[188:191]
  v_mul_f32 v186, v88, v186
  v_mul_f32 v187, v88, v187
  v_mfma_f32_16x16x32_bf16 v[188:191], a[184:187], v[232:235], v[188:191]
  ds_read_b128 a[168:171], v5 offset:10240
  v_cvt_pk_bf16_f32 v83, v186, v187
  v_mfma_f32_16x16x32_bf16 v[188:191], a[188:191], v[236:239], v[188:191]
  s_waitcnt lgkmcnt(10)
  v_mfma_f32_16x16x32_bf16 v[144:147], a[128:131], v[128:131], 0
  s_add_u32 s18, s73, 472064
  ds_read_b128 a[172:175], v5 offset:11264
  v_mfma_f32_16x16x32_bf16 v[144:147], a[132:135], v[132:135], v[144:147]
  buffer_load_dwordx4 v3, s[12:15], s66 offen offset:2048 sc1 lds
  v_mfma_f32_16x16x32_bf16 v[144:147], a[136:139], v[136:139], v[144:147]
  ds_read_b128 a[176:179], v5 offset:12288
  ds_read_b128 a[244:247], v16 offset:3072
  v_mfma_f32_16x16x32_bf16 v[144:147], a[140:143], v[140:143], v[144:147]
  s_waitcnt lgkmcnt(7)
  buffer_store_dwordx4 v[80:83], v1, s[12:15], s18 offen sc1
  v_mfma_f32_16x16x32_bf16 v[144:147], a[144:147], v[160:163], v[144:147]
  ds_read_b128 a[180:183], v5 offset:13312
  v_mul_f32 v188, v89, v188
  v_mfma_f32_16x16x32_bf16 v[144:147], a[148:151], v[164:167], v[144:147]
  v_mul_f32 v189, v89, v189
  v_cvt_pk_bf16_f32 v86, v188, v189
  v_mfma_f32_16x16x32_bf16 v[144:147], a[152:155], v[168:171], v[144:147]
  ds_read_b128 a[184:187], v5 offset:14336
  v_mul_f32 v190, v89, v190
  v_mfma_f32_16x16x32_bf16 v[144:147], a[156:159], v[172:175], v[144:147]
  v_mul_f32 v191, v89, v191
  v_cvt_pk_bf16_f32 v87, v190, v191
  v_mfma_f32_16x16x32_bf16 v[148:151], a[128:131], v[192:195], 0
  s_add_u32 s19, s73, 474112
  ds_read_b128 a[188:191], v5 offset:15360
  v_mfma_f32_16x16x32_bf16 v[148:151], a[132:135], v[196:199], v[148:151]
  buffer_load_dwordx4 v3, s[12:15], s66 offen offset:3072 sc1 lds
  v_mfma_f32_16x16x32_bf16 v[148:151], a[136:139], v[200:203], v[148:151]
  s_add_u32 m0, m0, 0x4000
  ds_read_b128 a[216:219], v16 offset:4096
  ds_read_b128 a[128:131], v5 offset:16384
  v_mfma_f32_16x16x32_bf16 v[148:151], a[140:143], v[204:207], v[148:151]
  buffer_store_dwordx4 v[84:87], v1, s[12:15], s19 offen sc1
  v_mfma_f32_16x16x32_bf16 v[148:151], a[144:147], v[224:227], v[148:151]
  ds_read_b128 a[132:135], v5 offset:17408
  v_mul_f32 v144, v88, v144
  v_mfma_f32_16x16x32_bf16 v[148:151], a[148:151], v[228:231], v[148:151]
  v_mul_f32 v145, v88, v145
  v_cvt_pk_bf16_f32 v72, v144, v145
  v_mfma_f32_16x16x32_bf16 v[148:151], a[152:155], v[232:235], v[148:151]
  ds_read_b128 a[136:139], v5 offset:18432
  v_mul_f32 v146, v88, v146
  v_mfma_f32_16x16x32_bf16 v[148:151], a[156:159], v[236:239], v[148:151]
  s_waitcnt lgkmcnt(9)
  ds_read_b128 a[220:223], v16 offset:5120
  v_mul_f32 v147, v88, v147
  v_mfma_f32_16x16x32_bf16 v[152:155], a[160:163], v[128:131], 0
  ds_read_b128 a[140:143], v5 offset:19456
  v_cvt_pk_bf16_f32 v73, v146, v147
  v_mfma_f32_16x16x32_bf16 v[152:155], a[164:167], v[132:135], v[152:155]
  buffer_load_dwordx4 v4, s[12:15], s66 offen offset:0 sc1 lds
  v_mfma_f32_16x16x32_bf16 v[152:155], a[168:171], v[136:139], v[152:155]
  ds_read_b128 a[144:147], v5 offset:20480
  v_mul_f32 v148, v89, v148
  v_mfma_f32_16x16x32_bf16 v[152:155], a[172:175], v[140:143], v[152:155]
  s_waitcnt lgkmcnt(7)
  v_mul_f32 v149, v89, v149
  v_cvt_pk_bf16_f32 v76, v148, v149
  v_mfma_f32_16x16x32_bf16 v[152:155], a[176:179], v[160:163], v[152:155]
  ds_read_b128 a[148:151], v5 offset:21504
  v_mul_f32 v150, v89, v150
  v_mfma_f32_16x16x32_bf16 v[152:155], a[180:183], v[164:167], v[152:155]
  ds_read_b128 a[248:251], v16 offset:6144
  v_mul_f32 v151, v89, v151
  v_mfma_f32_16x16x32_bf16 v[152:155], a[184:187], v[168:171], v[152:155]
  ds_read_b128 a[152:155], v5 offset:22528
  v_cvt_pk_bf16_f32 v77, v150, v151
  v_mfma_f32_16x16x32_bf16 v[152:155], a[188:191], v[172:175], v[152:155]
  v_mfma_f32_16x16x32_bf16 v[156:159], a[160:163], v[192:195], 0
  ds_read_b128 a[156:159], v5 offset:23552
  v_mfma_f32_16x16x32_bf16 v[156:159], a[164:167], v[196:199], v[156:159]
  buffer_load_dwordx4 v4, s[12:15], s66 offen offset:1024 sc1 lds
  v_mfma_f32_16x16x32_bf16 v[156:159], a[168:171], v[200:203], v[156:159]
  ds_read_b128 a[160:163], v5 offset:24576
  v_mfma_f32_16x16x32_bf16 v[156:159], a[172:175], v[204:207], v[156:159]
  ds_read_b128 a[252:255], v16 offset:7168
  v_mul_f32 v152, v88, v152
  v_mfma_f32_16x16x32_bf16 v[156:159], a[176:179], v[224:227], v[156:159]
  ds_read_b128 a[164:167], v5 offset:25600
  v_mul_f32 v153, v88, v153
  v_mfma_f32_16x16x32_bf16 v[156:159], a[180:183], v[228:231], v[156:159]
  v_cvt_pk_bf16_f32 v74, v152, v153
  v_mul_f32 v154, v88, v154
  v_mfma_f32_16x16x32_bf16 v[156:159], a[184:187], v[232:235], v[156:159]
  ds_read_b128 a[168:171], v5 offset:26624
  v_mul_f32 v155, v88, v155
  v_mfma_f32_16x16x32_bf16 v[156:159], a[188:191], v[236:239], v[156:159]
  s_waitcnt lgkmcnt(9)
  v_cvt_pk_bf16_f32 v75, v154, v155
  v_mfma_f32_16x16x32_bf16 v[176:179], a[128:131], v[128:131], 0
  s_add_u32 s16, s73, 565248
  ds_read_b128 a[172:175], v5 offset:27648
  v_mfma_f32_16x16x32_bf16 v[176:179], a[132:135], v[132:135], v[176:179]
  buffer_load_dwordx4 v4, s[12:15], s66 offen offset:2048 sc1 lds
  v_mfma_f32_16x16x32_bf16 v[176:179], a[136:139], v[136:139], v[176:179]
  ds_read_b128 a[176:179], v5 offset:28672
  v_mul_f32 v156, v89, v156
  v_mfma_f32_16x16x32_bf16 v[176:179], a[140:143], v[140:143], v[176:179]
  s_waitcnt lgkmcnt(6)
  buffer_store_dwordx4 v[72:75], v1, s[12:15], s16 offen sc1
  v_mfma_f32_16x16x32_bf16 v[176:179], a[144:147], v[160:163], v[176:179]
  ds_read_b128 a[180:183], v5 offset:29696
  v_mul_f32 v157, v89, v157
  v_mfma_f32_16x16x32_bf16 v[176:179], a[148:151], v[164:167], v[176:179]
  v_cvt_pk_bf16_f32 v78, v156, v157
  v_mul_f32 v158, v89, v158
  v_mfma_f32_16x16x32_bf16 v[176:179], a[152:155], v[168:171], v[176:179]
  ds_read_b128 a[184:187], v5 offset:30720
  v_mul_f32 v159, v89, v159
  v_mfma_f32_16x16x32_bf16 v[176:179], a[156:159], v[172:175], v[176:179]
  v_cvt_pk_bf16_f32 v79, v158, v159
  v_mfma_f32_16x16x32_bf16 v[180:183], a[128:131], v[192:195], 0
  s_add_u32 s17, s73, 567296
  buffer_load_dwordx4 v4, s[12:15], s66 offen offset:3072 sc1 lds
  v_mfma_f32_16x16x32_bf16 v[180:183], a[132:135], v[196:199], v[180:183]
  s_add_u32 s66, s66, 0x8000
  ds_read_b128 a[188:191], v5 offset:31744
  v_mfma_f32_16x16x32_bf16 v[180:183], a[136:139], v[200:203], v[180:183]
  s_add_u32 m0, s67, s65
  buffer_store_dwordx4 v[76:79], v1, s[12:15], s17 offen sc1
  v_mfma_f32_16x16x32_bf16 v[180:183], a[140:143], v[204:207], v[180:183]
  v_mul_f32 v176, v88, v176
  v_mul_f32 v177, v88, v177
  v_mfma_f32_16x16x32_bf16 v[180:183], a[144:147], v[224:227], v[180:183]
  s_add_u32 s67, s67, 0x8000
  v_cvt_pk_bf16_f32 v80, v176, v177
  v_mul_f32 v178, v88, v178
  v_mfma_f32_16x16x32_bf16 v[180:183], a[148:151], v[228:231], v[180:183]
  s_and_b32 s67, s67, 0x1ffff
  v_add_u32 v5, s67, v1
  v_mul_f32 v179, v88, v179
  v_mfma_f32_16x16x32_bf16 v[180:183], a[152:155], v[232:235], v[180:183]
  s_waitcnt lgkmcnt(0)
  v_cvt_pk_bf16_f32 v81, v178, v179
  v_mfma_f32_16x16x32_bf16 v[180:183], a[156:159], v[236:239], v[180:183]
  s_barrier
  v_mfma_f32_16x16x32_bf16 v[184:187], a[160:163], v[128:131], 0
  ds_read_b128 a[128:131], v5 offset:0
  v_mfma_f32_16x16x32_bf16 v[184:187], a[164:167], v[132:135], v[184:187]
  buffer_load_dwordx4 v3, s[12:15], s66 offen offset:0 sc1 lds
  v_mfma_f32_16x16x32_bf16 v[184:187], a[168:171], v[136:139], v[184:187]
  ds_read_b128 a[132:135], v5 offset:1024
  v_mfma_f32_16x16x32_bf16 v[184:187], a[172:175], v[140:143], v[184:187]
  ds_read_b128 a[136:139], v5 offset:2048
  v_mul_f32 v180, v89, v180
  v_mfma_f32_16x16x32_bf16 v[184:187], a[176:179], v[160:163], v[184:187]
  ds_read_b128 a[140:143], v5 offset:3072
  v_mul_f32 v181, v89, v181
  v_mfma_f32_16x16x32_bf16 v[184:187], a[180:183], v[164:167], v[184:187]
  v_cvt_pk_bf16_f32 v84, v180, v181
  v_mul_f32 v182, v89, v182
  v_mfma_f32_16x16x32_bf16 v[184:187], a[184:187], v[168:171], v[184:187]
  ds_read_b128 a[144:147], v5 offset:4096
  v_mul_f32 v183, v89, v183
  v_mfma_f32_16x16x32_bf16 v[184:187], a[188:191], v[172:175], v[184:187]
  v_cvt_pk_bf16_f32 v85, v182, v183
  v_mfma_f32_16x16x32_bf16 v[188:191], a[160:163], v[192:195], 0
  ds_read_b128 a[148:151], v5 offset:5120
  v_mfma_f32_16x16x32_bf16 v[188:191], a[164:167], v[196:199], v[188:191]
  buffer_load_dwordx4 v3, s[12:15], s66 offen offset:1024 sc1 lds
  v_mfma_f32_16x16x32_bf16 v[188:191], a[168:171], v[200:203], v[188:191]
  ds_read_b128 a[152:155], v5 offset:6144
  v_mfma_f32_16x16x32_bf16 v[188:191], a[172:175], v[204:207], v[188:191]
  ds_read_b128 a[156:159], v5 offset:7168
  v_mul_f32 v184, v88, v184
  v_mfma_f32_16x16x32_bf16 v[188:191], a[176:179], v[224:227], v[188:191]
  ds_read_b128 a[160:163], v5 offset:8192
  v_mul_f32 v185, v88, v185
  v_mfma_f32_16x16x32_bf16 v[188:191], a[180:183], v[228:231], v[188:191]
  v_cvt_pk_bf16_f32 v82, v184, v185
  v_mul_f32 v186, v88, v186
  v_mfma_f32_16x16x32_bf16 v[188:191], a[184:187], v[232:235], v[188:191]
  ds_read_b128 a[164:167], v5 offset:9216
  v_mul_f32 v187, v88, v187
  v_mfma_f32_16x16x32_bf16 v[188:191], a[188:191], v[236:239], v[188:191]
  v_cvt_pk_bf16_f32 v83, v186, v187
  s_add_u32 s18, s73, 566272
  buffer_store_dwordx4 v[80:83], v1, s[12:15], s18 offen sc1
  s_nop 4
  v_mul_f32 v188, v89, v188
  v_mul_f32 v189, v89, v189
  v_cvt_pk_bf16_f32 v86, v188, v189
  v_mul_f32 v190, v89, v190
  v_mul_f32 v191, v89, v191
  v_cvt_pk_bf16_f32 v87, v190, v191
  s_add_u32 s19, s73, 568320
  buffer_store_dwordx4 v[84:87], v1, s[12:15], s19 offen sc1
  s_cmp_lg_u32 s45, 0
  s_cbranch_scc1 L_kf_kernel_ffn_23
  v_mfma_f32_16x16x32_bf16 v[32:35], a[0:3], a[192:195], 0
  ds_read_b128 a[160:163], v5 offset:0
  v_mfma_f32_16x16x32_bf16 v[32:35], a[4:7], a[196:199], v[32:35]
  buffer_load_dwordx4 v3, s[12:15], s66 offen offset:2048 sc1 lds
  v_mfma_f32_16x16x32_bf16 v[32:35], a[8:11], a[200:203], v[32:35]
  v_mfma_f32_16x16x32_bf16 v[32:35], a[12:15], a[204:207], v[32:35]
  ds_read_b128 a[164:167], v5 offset:1024
  v_mfma_f32_16x16x32_bf16 v[32:35], a[16:19], a[208:211], v[32:35]
  v_mfma_f32_16x16x32_bf16 v[32:35], a[20:23], a[212:215], v[32:35]
  buffer_load_dwordx4 v3, s[12:15], s66 offen offset:3072 sc1 lds
  v_mfma_f32_16x16x32_bf16 v[32:35], a[24:27], a[216:219], v[32:35]
  s_add_u32 m0, m0, 0x4000
  ds_read_b128 a[168:171], v5 offset:2048
  v_mfma_f32_16x16x32_bf16 v[32:35], a[28:31], a[220:223], v[32:35]
  v_mfma_f32_16x16x32_bf16 v[40:43], a[32:35], a[192:195], 0
  v_mfma_f32_16x16x32_bf16 v[40:43], a[36:39], a[196:199], v[40:43]
  ds_read_b128 a[172:175], v5 offset:3072
  v_mfma_f32_16x16x32_bf16 v[40:43], a[40:43], a[200:203], v[40:43]
  s_sub_u32 s71, s71, 1
  v_mfma_f32_16x16x32_bf16 v[40:43], a[44:47], a[204:207], v[40:43]
  v_mfma_f32_16x16x32_bf16 v[40:43], a[112:115], a[208:211], v[40:43]
  ds_read_b128 a[176:179], v5 offset:4096
  v_max3_f32 v94, v32, v33, v34
  v_mfma_f32_16x16x32_bf16 v[40:43], a[116:119], a[212:215], v[40:43]
  v_mfma_f32_16x16x32_bf16 v[40:43], a[120:123], a[216:219], v[40:43]
  v_mfma_f32_16x16x32_bf16 v[40:43], a[124:127], a[220:223], v[40:43]
  ds_read_b128 a[180:183], v5 offset:5120
  v_mfma_f32_16x16x32_bf16 v[36:39], a[0:3], a[224:227], 0
  v_mfma_f32_16x16x32_bf16 v[36:39], a[4:7], a[228:231], v[36:39]
  v_mfma_f32_16x16x32_bf16 v[36:39], a[8:11], a[232:235], v[36:39]
  buffer_load_dwordx4 v4, s[12:15], s66 offen offset:0 sc1 lds
  v_mfma_f32_16x16x32_bf16 v[36:39], a[12:15], a[236:239], v[36:39]
  ds_read_b128 a[184:187], v5 offset:6144
  v_mfma_f32_16x16x32_bf16 v[36:39], a[16:19], a[240:243], v[36:39]
  v_max3_f32 v94, v94, v35, v40
  v_max3_f32 v94, v94, v41, v42
  v_mfma_f32_16x16x32_bf16 v[36:39], a[20:23], a[244:247], v[36:39]
  v_max_f32 v94, v94, v43
  v_mov_b32 v18, v94
  v_mfma_f32_16x16x32_bf16 v[36:39], a[24:27], a[248:251], v[36:39]
  v_mov_b32 v19, v94
  v_mfma_f32_16x16x32_bf16 v[36:39], a[28:31], a[252:255], v[36:39]
  ds_read_b128 a[188:191], v5 offset:7168
  v_permlane32_swap_b32 v18, v19
  v_mfma_f32_16x16x32_bf16 v[44:47], a[32:35], a[224:227], 0
  v_max_f32 v94, v18, v19
  v_mov_b32 v18, v94
  v_mfma_f32_16x16x32_bf16 v[44:47], a[36:39], a[228:231], v[44:47]
  v_mov_b32 v19, v94
  v_mfma_f32_16x16x32_bf16 v[44:47], a[40:43], a[232:235], v[44:47]
  ds_read_b128 a[32:35], v5 offset:8192
  v_permlane16_swap_b32 v18, v19
  v_mfma_f32_16x16x32_bf16 v[44:47], a[44:47], a[236:239], v[44:47]
  v_max_f32 v94, v18, v19
  v_ceil_f32 v90, v94
  v_mfma_f32_16x16x32_bf16 v[44:47], a[112:115], a[240:243], v[44:47]
  v_sub_f32 v32, v32, v90
  v_sub_f32 v33, v33, v90
  v_mfma_f32_16x16x32_bf16 v[44:47], a[116:119], a[244:247], v[44:47]
  v_sub_f32 v34, v34, v90
  v_sub_f32 v35, v35, v90
  v_mfma_f32_16x16x32_bf16 v[44:47], a[120:123], a[248:251], v[44:47]
  v_sub_f32 v40, v40, v90
  v_sub_f32 v41, v41, v90
  v_mfma_f32_16x16x32_bf16 v[44:47], a[124:127], a[252:255], v[44:47]
  v_sub_f32 v42, v42, v90
  v_sub_f32 v43, v43, v90
  v_mfma_f32_32x32x16_bf16 v[192:207], v[24:27], v[24:27], 0
  ds_read_b128 a[0:3], v5 offset:16384
  v_exp_f32 v72, v32
  v_exp_f32 v73, v33
  v_max3_f32 v95, v36, v37, v38
  v_mfma_f32_32x32x16_bf16 v[208:223], v[24:27], v[24:27], 0
  ds_read_b128 a[4:7], v5 offset:17408
  v_exp_f32 v74, v34
  v_exp_f32 v75, v35
  v_max3_f32 v95, v95, v39, v44
  v_mfma_f32_32x32x16_bf16 v[224:239], v[24:27], v[24:27], 0
  v_max3_f32 v95, v95, v45, v46
  v_exp_f32 v76, v40
  v_max_f32 v95, v95, v47
  v_mov_b32 v20, v95
  v_mov_b32 v21, v95
  v_exp_f32 v77, v41
  v_exp_f32 v78, v42
  v_exp_f32 v79, v43
  v_cvt_pk_bf16_f32 v64, v72, v73
  v_cvt_pk_bf16_f32 v65, v74, v75
  v_cvt_pk_bf16_f32 v66, v76, v77
  v_cvt_pk_bf16_f32 v67, v78, v79
  v_mfma_f32_32x32x16_bf16 v[240:255], v[24:27], v[24:27], 0
  s_waitcnt lgkmcnt(7)
  ds_read_b128 a[8:11], v5 offset:18432
  v_permlane32_swap_b32 v20, v21
  v_max_f32 v95, v20, v21
  v_mov_b32 v20, v95
  v_mov_b32 v21, v95
  v_sub_f32 v48, 0, v90
  v_mfma_f32_16x16x32_bf16 v[128:131], a[160:163], v[64:67], 0
  ds_read_b128 a[36:39], v5 offset:9216
  v_permlane16_swap_b32 v20, v21
  v_mfma_f32_16x16x32_bf16 v[132:135], a[164:167], v[64:67], 0
  ds_read_b128 a[40:43], v5 offset:10240
  ds_read_b128 a[12:15], v5 offset:19456
  v_mfma_f32_16x16x32_bf16 v[136:139], a[168:171], v[64:67], 0
  ds_read_b128 a[44:47], v5 offset:11264
  v_max_f32 v95, v20, v21
  v_mfma_f32_16x16x32_bf16 v[140:143], a[172:175], v[64:67], 0
  s_waitcnt lgkmcnt(8)
  ds_read_b128 a[112:115], v5 offset:12288
  ds_read_b128 a[16:19], v5 offset:20480
  v_mfma_f32_16x16x32_bf16 v[144:147], a[176:179], v[64:67], 0
  ds_read_b128 a[116:119], v5 offset:13312
  ds_read_b128 a[20:23], v5 offset:21504
  v_mfma_f32_16x16x32_bf16 v[148:151], a[180:183], v[64:67], 0
  ds_read_b128 a[120:123], v5 offset:14336
  v_ceil_f32 v91, v95
  v_mfma_f32_16x16x32_bf16 v[152:155], a[184:187], v[64:67], 0
  ds_read_b128 a[124:127], v5 offset:15360
  ds_read_b128 a[24:27], v5 offset:22528
  v_mfma_f32_16x16x32_bf16 v[156:159], a[188:191], v[64:67], 0
  s_waitcnt lgkmcnt(7)
  v_sub_f32 v36, v36, v91
  v_sub_f32 v37, v37, v91
  v_mfma_f32_16x16x32_bf16 v[160:163], a[32:35], v[64:67], 0
  buffer_load_dwordx4 v4, s[12:15], s66 offen offset:1024 sc1 lds
  ds_read_b128 a[28:31], v5 offset:23552
  v_mfma_f32_16x16x32_bf16 v[164:167], a[36:39], v[64:67], 0
  v_sub_f32 v38, v38, v91
  v_sub_f32 v39, v39, v91
  v_mfma_f32_16x16x32_bf16 v[168:171], a[40:43], v[64:67], 0
  ds_read_b128 a[128:131], v5 offset:24576
  v_sub_f32 v44, v44, v91
  v_mfma_f32_16x16x32_bf16 v[172:175], a[44:47], v[64:67], 0
  s_waitcnt lgkmcnt(3)
  ds_read_b128 a[132:135], v5 offset:25600
  v_sub_f32 v45, v45, v91
  v_sub_f32 v46, v46, v91
  v_sub_f32 v47, v47, v91
  v_sub_f32 v52, 0, v91
  v_sub_f32 v53, 0, v91
  v_sub_f32 v54, 0, v91
  v_sub_f32 v55, 0, v91
  v_sub_f32 v60, 0, v91
  v_sub_f32 v49, 0, v90
  v_sub_f32 v61, 0, v91
  v_sub_f32 v50, 0, v90
  v_sub_f32 v62, 0, v91
  v_sub_f32 v51, 0, v90
  v_sub_f32 v63, 0, v91
  v_sub_f32 v56, 0, v90
  v_mov_b32 v89, 0
  v_sub_f32 v57, 0, v90
  v_sub_f32 v58, 0, v90
  v_sub_f32 v59, 0, v90
  v_add_f32 v88, v72, v73
  v_add_f32 v88, v88, v74
  v_add_f32 v88, v88, v75
  v_add_f32 v88, v88, v76
  v_add_f32 v88, v88, v77
  v_add_f32 v88, v88, v78
  v_add_f32 v88, v88, v79
  v_mfma_f32_16x16x32_bf16 v[176:179], a[112:115], v[64:67], 0
  v_exp_f32 v80, v36
  v_mfma_f32_16x16x32_bf16 v[180:183], a[116:119], v[64:67], 0
  ds_read_b128 a[136:139], v5 offset:26624
  ds_read_b128 a[140:143], v5 offset:27648
  v_mfma_f32_16x16x32_bf16 v[184:187], a[120:123], v[64:67], 0
  v_exp_f32 v81, v37
  v_mfma_f32_16x16x32_bf16 v[188:191], a[124:127], v[64:67], 0
  v_exp_f32 v82, v38
  v_exp_f32 v83, v39
  v_exp_f32 v84, v44
  v_exp_f32 v85, v45
  v_add_f32 v93, v80, v81
  v_add_f32 v93, v93, v82
  v_add_f32 v93, v93, v83
  v_cvt_pk_bf16_f32 v68, v80, v81
  v_cvt_pk_bf16_f32 v69, v82, v83
  v_add_f32 v93, v93, v84
  s_branch L_kf_kernel_aloop_18
L_kf_kernel_alastm_22:
  v_mfma_f32_16x16x32_bf16 v[32:35], a[0:3], a[192:195], v[48:51]
  s_add_u32 s97, s67, s65
  v_exp_f32 v86, v46
  v_mfma_f32_16x16x32_bf16 v[32:35], a[4:7], a[196:199], v[32:35]
  s_add_u32 s67, s67, 0x8000
  ds_read_b128 a[144:147], v5 offset:28672
  v_add_f32 v93, v93, v85
  v_mfma_f32_16x16x32_bf16 v[32:35], a[8:11], a[200:203], v[32:35]
  s_and_b32 s67, s67, 0x1ffff
  buffer_load_dwordx4 v4, s[12:15], s66 offen offset:2048 sc1 lds
  v_mfma_f32_16x16x32_bf16 v[32:35], a[12:15], a[204:207], v[32:35]
  s_waitcnt lgkmcnt(5)
  ds_read_b128 a[148:151], v5 offset:29696
  v_add_f32 v93, v93, v86
  v_mfma_f32_16x16x32_bf16 v[32:35], a[16:19], a[208:211], v[32:35]
  s_add_u32 s98, s66, 0x8000
  ds_read_b128 a[152:155], v5 offset:30720
  v_cvt_pk_bf16_f32 v70, v84, v85
  v_mfma_f32_16x16x32_bf16 v[32:35], a[20:23], a[212:215], v[32:35]
  s_cmp_eq_u32 s71, 3
  v_exp_f32 v87, v47
  v_mfma_f32_16x16x32_bf16 v[32:35], a[24:27], a[216:219], v[32:35]
  s_cselect_b32 s98, s63, s98
  ds_read_b128 a[156:159], v5 offset:31744
  v_add_f32 v93, v93, v87
  v_mfma_f32_16x16x32_bf16 v[32:35], a[28:31], a[220:223], v[32:35]
  s_waitcnt lgkmcnt(4)
  v_cvt_pk_bf16_f32 v71, v86, v87
  v_cmp_lt_f32 vcc, s75, v93
  v_mfma_f32_16x16x32_bf16 v[40:43], a[128:131], a[192:195], v[56:59]
  buffer_load_dwordx4 v4, s[12:15], s66 offen offset:3072 sc1 lds
  v_mfma_f32_16x16x32_bf16 v[40:43], a[132:135], a[196:199], v[40:43]
  s_cbranch_vccnz L_kf_kernel_rare_73
L_kf_kernel_rarer_74:
  v_add_f32 v89, v89, v93
  v_mfma_f32_16x16x32_bf16 v[40:43], a[136:139], a[200:203], v[40:43]
  s_mov_b32 m0, s97
  v_exp_f32 v72, v32
  v_mfma_f32_16x16x32_bf16 v[40:43], a[140:143], a[204:207], v[40:43]
  s_waitcnt lgkmcnt(0)
  v_exp_f32 v73, v33
  v_mfma_f32_16x16x32_bf16 v[40:43], a[144:147], a[208:211], v[40:43]
  s_waitcnt vmcnt(16)
  v_add_u32 v5, s67, v1
  s_mov_b32 s66, s98
  v_mfma_f32_16x16x32_bf16 v[40:43], a[148:151], a[212:215], v[40:43]
  s_barrier
  buffer_load_dword v12, v0, s[12:15], s40 offen offset:256 sc1
  v_mfma_f32_16x16x32_bf16 v[40:43], a[152:155], a[216:219], v[40:43]
  v_exp_f32 v74, v34
  v_mfma_f32_16x16x32_bf16 v[40:43], a[156:159], a[220:223], v[40:43]
  v_exp_f32 v75, v35
  v_mfma_f32_16x16x32_bf16 v[192:195], a[160:163], v[68:71], v[192:195]
  buffer_load_dwordx4 v3, s[12:15], s66 offen offset:0 sc1 lds
  v_mfma_f32_16x16x32_bf16 v[196:199], a[164:167], v[68:71], v[196:199]
  s_sub_u32 s71, s71, 1
  ds_read_b128 a[160:163], v5 offset:0
  v_add_f32 v92, v72, v73
  v_mfma_f32_16x16x32_bf16 v[200:203], a[168:171], v[68:71], v[200:203]
  v_exp_f32 v76, v40
  v_mfma_f32_16x16x32_bf16 v[204:207], a[172:175], v[68:71], v[204:207]
  ds_read_b128 a[164:167], v5 offset:1024
  v_add_f32 v92, v92, v74
  v_mfma_f32_16x16x32_bf16 v[208:211], a[176:179], v[68:71], v[208:211]
  ds_read_b128 a[168:171], v5 offset:2048
  v_add_f32 v92, v92, v75
  v_mfma_f32_16x16x32_bf16 v[212:215], a[180:183], v[68:71], v[212:215]
  v_exp_f32 v77, v41
  v_mfma_f32_16x16x32_bf16 v[216:219], a[184:187], v[68:71], v[216:219]
  ds_read_b128 a[172:175], v5 offset:3072
  v_cvt_pk_bf16_f32 v64, v72, v73
  v_mfma_f32_16x16x32_bf16 v[220:223], a[188:191], v[68:71], v[220:223]
  v_exp_f32 v78, v42
  v_mfma_f32_16x16x32_bf16 v[224:227], a[32:35], v[68:71], v[224:227]
  ds_read_b128 a[176:179], v5 offset:4096
  v_cvt_pk_bf16_f32 v65, v74, v75
  v_mfma_f32_16x16x32_bf16 v[228:231], a[36:39], v[68:71], v[228:231]
  ds_read_b128 a[180:183], v5 offset:5120
  v_add_f32 v92, v92, v76
  v_mfma_f32_16x16x32_bf16 v[232:235], a[40:43], v[68:71], v[232:235]
  v_exp_f32 v79, v43
  v_mfma_f32_16x16x32_bf16 v[236:239], a[44:47], v[68:71], v[236:239]
  ds_read_b128 a[184:187], v5 offset:6144
  v_add_f32 v92, v92, v77
  v_mfma_f32_16x16x32_bf16 v[240:243], a[112:115], v[68:71], v[240:243]
  buffer_load_dwordx4 v3, s[12:15], s66 offen offset:1024 sc1 lds
  v_mfma_f32_16x16x32_bf16 v[244:247], a[116:119], v[68:71], v[244:247]
  ds_read_b128 a[188:191], v5 offset:7168
  v_add_f32 v92, v92, v78
  v_mfma_f32_16x16x32_bf16 v[248:251], a[120:123], v[68:71], v[248:251]
  v_add_f32 v92, v92, v79
  v_cvt_pk_bf16_f32 v66, v76, v77
  v_mfma_f32_16x16x32_bf16 v[252:255], a[124:127], v[68:71], v[252:255]
  ds_read_b128 a[32:35], v5 offset:8192
  v_cvt_pk_bf16_f32 v67, v78, v79
  v_mfma_f32_16x16x32_bf16 v[36:39], a[0:3], a[224:227], v[52:55]
  ds_read_b128 a[36:39], v5 offset:9216
  v_cmp_lt_f32 vcc, s75, v92
  v_mfma_f32_16x16x32_bf16 v[36:39], a[4:7], a[228:231], v[36:39]
  s_cbranch_vccnz L_kf_kernel_rare_75
L_kf_kernel_rarer_76:
  v_fma_f32 v48, v112, s58, v48
  v_mfma_f32_16x16x32_bf16 v[36:39], a[8:11], a[232:235], v[36:39]
  ds_read_b128 a[40:43], v5 offset:10240
  v_add_f32 v88, v88, v92
  v_mfma_f32_16x16x32_bf16 v[36:39], a[12:15], a[236:239], v[36:39]
  buffer_load_dwordx4 v3, s[12:15], s66 offen offset:2048 sc1 lds
  v_mfma_f32_16x16x32_bf16 v[36:39], a[16:19], a[240:243], v[36:39]
  ds_read_b128 a[44:47], v5 offset:11264
  v_fma_f32 v49, v113, s58, v49
  v_mfma_f32_16x16x32_bf16 v[36:39], a[20:23], a[244:247], v[36:39]
  ds_read_b128 a[112:115], v5 offset:12288
  v_fma_f32 v50, v114, s58, v50
  v_mfma_f32_16x16x32_bf16 v[36:39], a[24:27], a[248:251], v[36:39]
  v_fma_f32 v51, v115, s58, v51
  v_fma_f32 v56, v112, s59, v56
  v_mfma_f32_16x16x32_bf16 v[36:39], a[28:31], a[252:255], v[36:39]
  ds_read_b128 a[116:119], v5 offset:13312
  v_fma_f32 v57, v113, s59, v57
  v_mfma_f32_16x16x32_bf16 v[44:47], a[128:131], a[224:227], v[60:63]
  buffer_load_dwordx4 v3, s[12:15], s66 offen offset:3072 sc1 lds
  v_mfma_f32_16x16x32_bf16 v[44:47], a[132:135], a[228:231], v[44:47]
  ds_read_b128 a[120:123], v5 offset:14336
  v_fma_f32 v58, v114, s59, v58
  v_mfma_f32_16x16x32_bf16 v[44:47], a[136:139], a[232:235], v[44:47]
  v_exp_f32 v80, v36
  v_mfma_f32_16x16x32_bf16 v[44:47], a[140:143], a[236:239], v[44:47]
  ds_read_b128 a[124:127], v5 offset:15360
  v_fma_f32 v59, v115, s59, v59
  v_mfma_f32_16x16x32_bf16 v[44:47], a[144:147], a[240:243], v[44:47]
  ds_read_b128 a[0:3], v5 offset:16384
  v_mfma_f32_16x16x32_bf16 v[44:47], a[148:151], a[244:247], v[44:47]
  v_exp_f32 v81, v37
  v_mfma_f32_16x16x32_bf16 v[44:47], a[152:155], a[248:251], v[44:47]
  ds_read_b128 a[4:7], v5 offset:17408
  v_add_f32 v93, v80, v81
  v_mfma_f32_16x16x32_bf16 v[44:47], a[156:159], a[252:255], v[44:47]
  s_waitcnt lgkmcnt(14)
  v_exp_f32 v82, v38
  v_mfma_f32_16x16x32_bf16 v[128:131], a[160:163], v[64:67], v[128:131]
  ds_read_b128 a[8:11], v5 offset:18432
  v_add_f32 v93, v93, v82
  v_mfma_f32_16x16x32_bf16 v[132:135], a[164:167], v[64:67], v[132:135]
  ds_read_b128 a[12:15], v5 offset:19456
  v_mfma_f32_16x16x32_bf16 v[136:139], a[168:171], v[64:67], v[136:139]
  v_exp_f32 v83, v39
  v_mfma_f32_16x16x32_bf16 v[140:143], a[172:175], v[64:67], v[140:143]
  s_waitcnt lgkmcnt(12)
  ds_read_b128 a[16:19], v5 offset:20480
  v_add_f32 v93, v93, v83
  v_mfma_f32_16x16x32_bf16 v[144:147], a[176:179], v[64:67], v[144:147]
  v_mfma_f32_16x16x32_bf16 v[148:151], a[180:183], v[64:67], v[148:151]
  ds_read_b128 a[20:23], v5 offset:21504
  v_cvt_pk_bf16_f32 v68, v80, v81
  v_mfma_f32_16x16x32_bf16 v[152:155], a[184:187], v[64:67], v[152:155]
  v_exp_f32 v84, v44
  v_mfma_f32_16x16x32_bf16 v[156:159], a[188:191], v[64:67], v[156:159]
  s_waitcnt lgkmcnt(10)
  ds_read_b128 a[24:27], v5 offset:22528
  v_cvt_pk_bf16_f32 v69, v82, v83
  v_mfma_f32_16x16x32_bf16 v[160:163], a[32:35], v[64:67], v[160:163]
  ds_read_b128 a[28:31], v5 offset:23552
  v_add_f32 v93, v93, v84
  v_mfma_f32_16x16x32_bf16 v[164:167], a[36:39], v[64:67], v[164:167]
  v_mfma_f32_16x16x32_bf16 v[168:171], a[40:43], v[64:67], v[168:171]
  ds_read_b128 a[128:131], v5 offset:24576
  v_mfma_f32_16x16x32_bf16 v[172:175], a[44:47], v[64:67], v[172:175]
  s_waitcnt lgkmcnt(9)
  v_exp_f32 v85, v45
  v_mfma_f32_16x16x32_bf16 v[176:179], a[112:115], v[64:67], v[176:179]
  ds_read_b128 a[132:135], v5 offset:25600
  v_mfma_f32_16x16x32_bf16 v[180:183], a[116:119], v[64:67], v[180:183]
  s_waitcnt lgkmcnt(6)
  ds_read_b128 a[136:139], v5 offset:26624
  v_mfma_f32_16x16x32_bf16 v[184:187], a[120:123], v[64:67], v[184:187]
  s_cmp_eq_u32 s49, 0
  ds_read_b128 a[140:143], v5 offset:27648
  v_mfma_f32_16x16x32_bf16 v[188:191], a[124:127], v[64:67], v[188:191]
  s_cbranch_scc1 L_kf_kernel_mid_52
L_kf_kernel_t2m_51:
  s_waitcnt vmcnt(4)
  v_readfirstlane_b32 s97, v12
  s_nop 0
  s_or_b32 s97, s97, 0
  s_cbranch_scc0 L_kf_kernel_spin_42
L_kf_kernel_spinr_43:
  v_mfma_f32_16x16x32_bf16 v[32:35], a[0:3], a[192:195], v[48:51]
  s_add_u32 s97, s67, s65
  v_exp_f32 v86, v46
  v_mfma_f32_16x16x32_bf16 v[32:35], a[4:7], a[196:199], v[32:35]
  s_add_u32 s67, s67, 0x8000
  ds_read_b128 a[144:147], v5 offset:28672
  v_add_f32 v93, v93, v85
  v_mfma_f32_16x16x32_bf16 v[32:35], a[8:11], a[200:203], v[32:35]
  s_and_b32 s67, s67, 0x1ffff
  buffer_load_dwordx4 v[124:127], v1, s[12:15], s48 offen sc1
  v_mfma_f32_16x16x32_bf16 v[32:35], a[12:15], a[204:207], v[32:35]
  s_waitcnt lgkmcnt(5)
  ds_read_b128 a[148:151], v5 offset:29696
  v_add_f32 v93, v93, v86
  v_mfma_f32_16x16x32_bf16 v[32:35], a[16:19], a[208:211], v[32:35]
  s_add_u32 s98, s66, 0x8000
  ds_read_b128 a[152:155], v5 offset:30720
  v_cvt_pk_bf16_f32 v70, v84, v85
  v_mfma_f32_16x16x32_bf16 v[32:35], a[20:23], a[212:215], v[32:35]
  s_cmp_eq_u32 s71, 3
  v_exp_f32 v87, v47
  v_mfma_f32_16x16x32_bf16 v[32:35], a[24:27], a[216:219], v[32:35]
  s_cselect_b32 s98, s63, s98
  ds_read_b128 a[156:159], v5 offset:31744
  v_add_f32 v93, v93, v87
  v_mfma_f32_16x16x32_bf16 v[32:35], a[28:31], a[220:223], v[32:35]
  s_waitcnt lgkmcnt(4)
  v_cvt_pk_bf16_f32 v71, v86, v87
  v_cmp_lt_f32 vcc, s75, v93
  v_mfma_f32_16x16x32_bf16 v[40:43], a[128:131], a[192:195], v[56:59]
  buffer_load_dwordx4 a[48:51], v1, s[12:15], s47 offen offset:0 sc1
  v_mfma_f32_16x16x32_bf16 v[40:43], a[132:135], a[196:199], v[40:43]
  s_cbranch_vccnz L_kf_kernel_rare_77
L_kf_kernel_rarer_78:
  v_add_f32 v89, v89, v93
  v_mfma_f32_16x16x32_bf16 v[40:43], a[136:139], a[200:203], v[40:43]
  s_mov_b32 m0, s97
  v_exp_f32 v72, v32
  v_mfma_f32_16x16x32_bf16 v[40:43], a[140:143], a[204:207], v[40:43]
  s_waitcnt lgkmcnt(0)
  v_exp_f32 v73, v33
  v_mfma_f32_16x16x32_bf16 v[40:43], a[144:147], a[208:211], v[40:43]
  v_add_u32 v5, s67, v1
  s_mov_b32 s66, s98
  v_mfma_f32_16x16x32_bf16 v[40:43], a[148:151], a[212:215], v[40:43]
  s_barrier
  buffer_load_dwordx4 a[52:55], v1, s[12:15], s47 offen offset:1024 sc1
  v_mfma_f32_16x16x32_bf16 v[40:43], a[152:155], a[216:219], v[40:43]
  v_exp_f32 v74, v34
  v_mfma_f32_16x16x32_bf16 v[40:43], a[156:159], a[220:223], v[40:43]
  v_exp_f32 v75, v35
  v_mfma_f32_16x16x32_bf16 v[192:195], a[160:163], v[68:71], v[192:195]
  buffer_load_dwordx4 v3, s[12:15], s66 offen offset:0 sc1 lds
  v_mfma_f32_16x16x32_bf16 v[196:199], a[164:167], v[68:71], v[196:199]
  s_sub_u32 s71, s71, 1
  ds_read_b128 a[160:163], v5 offset:0
  v_add_f32 v92, v72, v73
  v_mfma_f32_16x16x32_bf16 v[200:203], a[168:171], v[68:71], v[200:203]
  v_exp_f32 v76, v40
  v_mfma_f32_16x16x32_bf16 v[204:207], a[172:175], v[68:71], v[204:207]
  ds_read_b128 a[164:167], v5 offset:1024
  buffer_load_dwordx4 a[56:59], v1, s[12:15], s47 offen offset:2048 sc1
  v_add_f32 v92, v92, v74
  v_mfma_f32_16x16x32_bf16 v[208:211], a[176:179], v[68:71], v[208:211]
  ds_read_b128 a[168:171], v5 offset:2048
  v_add_f32 v92, v92, v75
  v_mfma_f32_16x16x32_bf16 v[212:215], a[180:183], v[68:71], v[212:215]
  v_exp_f32 v77, v41
  v_mfma_f32_16x16x32_bf16 v[216:219], a[184:187], v[68:71], v[216:219]
  ds_read_b128 a[172:175], v5 offset:3072
  v_cvt_pk_bf16_f32 v64, v72, v73
  v_mfma_f32_16x16x32_bf16 v[220:223], a[188:191], v[68:71], v[220:223]
  v_exp_f32 v78, v42
  v_mfma_f32_16x16x32_bf16 v[224:227], a[32:35], v[68:71], v[224:227]
  buffer_load_dwordx4 a[60:63], v1, s[12:15], s47 offen offset:3072 sc1
  ds_read_b128 a[176:179], v5 offset:4096
  v_cvt_pk_bf16_f32 v65, v74, v75
  s_add_u32 s47, s47, 4096
  v_mfma_f32_16x16x32_bf16 v[228:231], a[36:39], v[68:71], v[228:231]
  ds_read_b128 a[180:183], v5 offset:5120
  v_add_f32 v92, v92, v76
  v_mfma_f32_16x16x32_bf16 v[232:235], a[40:43], v[68:71], v[232:235]
  v_exp_f32 v79, v43
  v_mfma_f32_16x16x32_bf16 v[236:239], a[44:47], v[68:71], v[236:239]
  ds_read_b128 a[184:187], v5 offset:6144
  v_add_f32 v92, v92, v77
  v_mfma_f32_16x16x32_bf16 v[240:243], a[112:115], v[68:71], v[240:243]
  buffer_load_dwordx4 v3, s[12:15], s66 offen offset:1024 sc1 lds
  v_mfma_f32_16x16x32_bf16 v[244:247], a[116:119], v[68:71], v[244:247]
  ds_read_b128 a[188:191], v5 offset:7168
  buffer_load_dwordx4 a[64:67], v1, s[12:15], s47 offen offset:0 sc1
  v_add_f32 v92, v92, v78
  v_mfma_f32_16x16x32_bf16 v[248:251], a[120:123], v[68:71], v[248:251]
  v_add_f32 v92, v92, v79
  v_cvt_pk_bf16_f32 v66, v76, v77
  v_mfma_f32_16x16x32_bf16 v[252:255], a[124:127], v[68:71], v[252:255]
  ds_read_b128 a[32:35], v5 offset:8192
  v_cvt_pk_bf16_f32 v67, v78, v79
  v_mfma_f32_16x16x32_bf16 v[36:39], a[0:3], a[224:227], v[52:55]
  ds_read_b128 a[36:39], v5 offset:9216
  v_cmp_lt_f32 vcc, s75, v92
  v_mfma_f32_16x16x32_bf16 v[36:39], a[4:7], a[228:231], v[36:39]
  s_cbranch_vccnz L_kf_kernel_rare_79
L_kf_kernel_rarer_80:
  v_mfma_f32_16x16x32_bf16 v[36:39], a[8:11], a[232:235], v[36:39]
  ds_read_b128 a[40:43], v5 offset:10240
  buffer_load_dwordx4 a[68:71], v1, s[12:15], s47 offen offset:1024 sc1
  v_add_f32 v88, v88, v92
  v_mfma_f32_16x16x32_bf16 v[36:39], a[12:15], a[236:239], v[36:39]
  buffer_load_dwordx4 v3, s[12:15], s66 offen offset:2048 sc1 lds
  v_mfma_f32_16x16x32_bf16 v[36:39], a[16:19], a[240:243], v[36:39]
  ds_read_b128 a[44:47], v5 offset:11264
  v_fma_f32 v48, v112, s52, v52
  v_mfma_f32_16x16x32_bf16 v[36:39], a[20:23], a[244:247], v[36:39]
  ds_read_b128 a[112:115], v5 offset:12288
  v_fma_f32 v49, v113, s52, v53
  v_mfma_f32_16x16x32_bf16 v[36:39], a[24:27], a[248:251], v[36:39]
  buffer_load_dwordx4 a[72:75], v1, s[12:15], s47 offen offset:2048 sc1
  v_mfma_f32_16x16x32_bf16 v[36:39], a[28:31], a[252:255], v[36:39]
  ds_read_b128 a[116:119], v5 offset:13312
  v_fma_f32 v50, v114, s52, v54
  v_mfma_f32_16x16x32_bf16 v[44:47], a[128:131], a[224:227], v[60:63]
  buffer_load_dwordx4 v3, s[12:15], s66 offen offset:3072 sc1 lds
  v_mfma_f32_16x16x32_bf16 v[44:47], a[132:135], a[228:231], v[44:47]
  s_add_u32 m0, m0, 0x4000
  ds_read_b128 a[120:123], v5 offset:14336
  v_fma_f32 v51, v115, s52, v55
  v_mfma_f32_16x16x32_bf16 v[44:47], a[136:139], a[232:235], v[44:47]
  v_exp_f32 v80, v36
  v_mfma_f32_16x16x32_bf16 v[44:47], a[140:143], a[236:239], v[44:47]
  ds_read_b128 a[124:127], v5 offset:15360
  v_mov_b32 v12, 1
  v_mfma_f32_16x16x32_bf16 v[44:47], a[144:147], a[240:243], v[44:47]
  s_lshl_b32 s96, s64, 9
  buffer_load_dwordx4 a[76:79], v1, s[12:15], s47 offen offset:3072 sc1
  ds_read_b128 a[0:3], v5 offset:16384
  s_add_u32 s47, s47, 4096
  v_mfma_f32_16x16x32_bf16 v[44:47], a[148:151], a[244:247], v[44:47]
  s_add_u32 s96, s96, 38567936
  v_exp_f32 v81, v37
  v_mfma_f32_16x16x32_bf16 v[44:47], a[152:155], a[248:251], v[44:47]
  ds_read_b128 a[4:7], v5 offset:17408
  v_add_f32 v93, v80, v81
  v_mfma_f32_16x16x32_bf16 v[44:47], a[156:159], a[252:255], v[44:47]
  s_waitcnt lgkmcnt(14)
  v_exp_f32 v82, v38
  v_mfma_f32_16x16x32_bf16 v[128:131], a[160:163], v[64:67], v[128:131]
  ds_read_b128 a[8:11], v5 offset:18432
  v_add_f32 v93, v93, v82
  v_mfma_f32_16x16x32_bf16 v[132:135], a[164:167], v[64:67], v[132:135]
  ds_read_b128 a[12:15], v5 offset:19456
  buffer_load_dwordx4 a[80:83], v1, s[12:15], s47 offen offset:0 sc1
  v_mfma_f32_16x16x32_bf16 v[136:139], a[168:171], v[64:67], v[136:139]
  v_exp_f32 v83, v39
  v_mfma_f32_16x16x32_bf16 v[140:143], a[172:175], v[64:67], v[140:143]
  s_waitcnt lgkmcnt(12)
  ds_read_b128 a[16:19], v5 offset:20480
  v_add_f32 v93, v93, v83
  v_mfma_f32_16x16x32_bf16 v[144:147], a[176:179], v[64:67], v[144:147]
  buffer_load_dwordx4 v4, s[12:15], s66 offen offset:0 sc1 lds
  v_mfma_f32_16x16x32_bf16 v[148:151], a[180:183], v[64:67], v[148:151]
  ds_read_b128 a[20:23], v5 offset:21504
  v_cvt_pk_bf16_f32 v68, v80, v81
  v_mfma_f32_16x16x32_bf16 v[152:155], a[184:187], v[64:67], v[152:155]
  buffer_load_dwordx4 a[84:87], v1, s[12:15], s47 offen offset:1024 sc1
  v_exp_f32 v84, v44
  v_mfma_f32_16x16x32_bf16 v[156:159], a[188:191], v[64:67], v[156:159]
  s_waitcnt lgkmcnt(10)
  ds_read_b128 a[24:27], v5 offset:22528
  v_cvt_pk_bf16_f32 v69, v82, v83
  v_mfma_f32_16x16x32_bf16 v[160:163], a[32:35], v[64:67], v[160:163]
  ds_read_b128 a[28:31], v5 offset:23552
  v_add_f32 v93, v93, v84
  v_mfma_f32_16x16x32_bf16 v[164:167], a[36:39], v[64:67], v[164:167]
  buffer_load_dwordx4 v4, s[12:15], s66 offen offset:1024 sc1 lds
  v_mfma_f32_16x16x32_bf16 v[168:171], a[40:43], v[64:67], v[168:171]
  ds_read_b128 a[128:131], v5 offset:24576
  v_fma_f32 v56, v112, s53, v60
  v_mfma_f32_16x16x32_bf16 v[172:175], a[44:47], v[64:67], v[172:175]
  s_waitcnt lgkmcnt(9)
  buffer_load_dwordx4 a[88:91], v1, s[12:15], s47 offen offset:2048 sc1
  v_exp_f32 v85, v45
  v_mfma_f32_16x16x32_bf16 v[176:179], a[112:115], v[64:67], v[176:179]
  ds_read_b128 a[132:135], v5 offset:25600
  v_fma_f32 v57, v113, s53, v61
  v_mfma_f32_16x16x32_bf16 v[180:183], a[116:119], v[64:67], v[180:183]
  s_waitcnt lgkmcnt(6)
  ds_read_b128 a[136:139], v5 offset:26624
  buffer_atomic_add v12, v0, s[12:15], s96 offen offset:384 sc0 sc1
  v_fma_f32 v58, v114, s53, v62
  v_fma_f32 v59, v115, s53, v63
  v_mfma_f32_16x16x32_bf16 v[184:187], a[120:123], v[64:67], v[184:187]
  ds_read_b128 a[140:143], v5 offset:27648
  v_mfma_f32_16x16x32_bf16 v[188:191], a[124:127], v[64:67], v[188:191]
  v_mfma_f32_16x16x32_bf16 v[32:35], a[0:3], a[224:227], v[48:51]
  s_add_u32 s97, s67, s65
  v_exp_f32 v86, v46
  v_mfma_f32_16x16x32_bf16 v[32:35], a[4:7], a[228:231], v[32:35]
  s_add_u32 s67, s67, 0x8000
  ds_read_b128 a[144:147], v5 offset:28672
  v_add_f32 v93, v93, v85
  v_mfma_f32_16x16x32_bf16 v[32:35], a[8:11], a[232:235], v[32:35]
  s_and_b32 s67, s67, 0x1ffff
  buffer_load_dwordx4 v4, s[12:15], s66 offen offset:2048 sc1 lds
  v_mfma_f32_16x16x32_bf16 v[32:35], a[12:15], a[236:239], v[32:35]
  s_waitcnt lgkmcnt(5)
  ds_read_b128 a[148:151], v5 offset:29696
  v_add_f32 v93, v93, v86
  v_mfma_f32_16x16x32_bf16 v[32:35], a[16:19], a[240:243], v[32:35]
  s_add_u32 s98, s66, 0x8000
  ds_read_b128 a[152:155], v5 offset:30720
  v_cvt_pk_bf16_f32 v70, v84, v85
  v_mfma_f32_16x16x32_bf16 v[32:35], a[20:23], a[244:247], v[32:35]
  s_cmp_eq_u32 s71, 3
  v_exp_f32 v87, v47
  v_mfma_f32_16x16x32_bf16 v[32:35], a[24:27], a[248:251], v[32:35]
  s_cselect_b32 s98, s63, s98
  buffer_load_dwordx4 a[92:95], v1, s[12:15], s47 offen offset:3072 sc1
  ds_read_b128 a[156:159], v5 offset:31744
  v_add_f32 v93, v93, v87
  s_add_u32 s47, s47, 4096
  v_mfma_f32_16x16x32_bf16 v[32:35], a[28:31], a[252:255], v[32:35]
  s_waitcnt lgkmcnt(4)
  v_cvt_pk_bf16_f32 v71, v86, v87
  v_cmp_lt_f32 vcc, s75, v93
  v_mfma_f32_16x16x32_bf16 v[40:43], a[128:131], a[224:227], v[56:59]
  buffer_load_dwordx4 v4, s[12:15], s66 offen offset:3072 sc1 lds
  v_mfma_f32_16x16x32_bf16 v[40:43], a[132:135], a[228:231], v[40:43]
  s_cbranch_vccnz L_kf_kernel_rare_81
L_kf_kernel_rarer_82:
  v_add_f32 v89, v89, v93
  v_mfma_f32_16x16x32_bf16 v[40:43], a[136:139], a[232:235], v[40:43]
  s_mov_b32 m0, s97
  buffer_load_dwordx4 a[96:99], v1, s[12:15], s47 offen offset:0 sc1
  v_mfma_f32_16x16x32_bf16 v[40:43], a[140:143], a[236:239], v[40:43]
  s_waitcnt lgkmcnt(0)
  v_fma_f32 v52, v112, s58, v52
  v_fma_f32 v53, v113, s58, v53
  v_mfma_f32_16x16x32_bf16 v[40:43], a[144:147], a[240:243], v[40:43]
  v_add_u32 v5, s67, v1
  s_mov_b32 s66, s98
  v_mfma_f32_16x16x32_bf16 v[40:43], a[148:151], a[244:247], v[40:43]
  s_barrier
  v_fma_f32 v54, v114, s58, v54
  v_fma_f32 v55, v115, s58, v55
  v_mfma_f32_16x16x32_bf16 v[40:43], a[152:155], a[248:251], v[40:43]
  ds_read_b128 a[0:3], v5 offset:16384
  ds_read_b128 a[4:7], v5 offset:17408
  v_mfma_f32_16x16x32_bf16 v[40:43], a[156:159], a[252:255], v[40:43]
  buffer_load_dwordx4 v3, s[12:15], s66 offen offset:0 sc1 lds
  v_mfma_f32_16x16x32_bf16 v[192:195], a[160:163], v[68:71], v[192:195]
  ds_read_b128 a[8:11], v5 offset:18432
  ds_read_b128 a[12:15], v5 offset:19456
  v_mfma_f32_16x16x32_bf16 v[196:199], a[164:167], v[68:71], v[196:199]
  ds_read_b128 a[16:19], v5 offset:20480
  ds_read_b128 a[20:23], v5 offset:21504
  v_mfma_f32_16x16x32_bf16 v[200:203], a[168:171], v[68:71], v[200:203]
  buffer_load_dwordx4 a[100:103], v1, s[12:15], s47 offen offset:1024 sc1
  v_mfma_f32_16x16x32_bf16 v[204:207], a[172:175], v[68:71], v[204:207]
  buffer_load_dwordx4 v3, s[12:15], s66 offen offset:1024 sc1 lds
  v_mfma_f32_16x16x32_bf16 v[208:211], a[176:179], v[68:71], v[208:211]
  ds_read_b128 a[24:27], v5 offset:22528
  ds_read_b128 a[28:31], v5 offset:23552
  v_mfma_f32_16x16x32_bf16 v[212:215], a[180:183], v[68:71], v[212:215]
  v_exp_f32 v72, v32
  v_mfma_f32_16x16x32_bf16 v[216:219], a[184:187], v[68:71], v[216:219]
  v_exp_f32 v73, v33
  v_mfma_f32_16x16x32_bf16 v[220:223], a[188:191], v[68:71], v[220:223]
  buffer_load_dwordx4 v3, s[12:15], s66 offen offset:2048 sc1 lds
  v_mfma_f32_16x16x32_bf16 v[224:227], a[32:35], v[68:71], v[224:227]
  ds_read_b128 a[128:131], v5 offset:24576
  ds_read_b128 a[132:135], v5 offset:25600
  v_mfma_f32_16x16x32_bf16 v[228:231], a[36:39], v[68:71], v[228:231]
  buffer_load_dwordx4 a[104:107], v1, s[12:15], s47 offen offset:2048 sc1
  v_mfma_f32_16x16x32_bf16 v[232:235], a[40:43], v[68:71], v[232:235]
  v_exp_f32 v74, v34
  v_mfma_f32_16x16x32_bf16 v[236:239], a[44:47], v[68:71], v[236:239]
  buffer_load_dwordx4 v3, s[12:15], s66 offen offset:3072 sc1 lds
  v_mfma_f32_16x16x32_bf16 v[240:243], a[112:115], v[68:71], v[240:243]
  s_add_u32 m0, m0, 0x4000
  v_exp_f32 v75, v35
  v_mfma_f32_16x16x32_bf16 v[244:247], a[116:119], v[68:71], v[244:247]
  ds_read_b128 a[136:139], v5 offset:26624
  ds_read_b128 a[140:143], v5 offset:27648
  v_mfma_f32_16x16x32_bf16 v[248:251], a[120:123], v[68:71], v[248:251]
  v_exp_f32 v76, v40
  v_mfma_f32_16x16x32_bf16 v[252:255], a[124:127], v[68:71], v[252:255]
  s_waitcnt lgkmcnt(8)
  buffer_load_dwordx4 v4, s[12:15], s66 offen offset:0 sc1 lds
  v_mfma_f32_16x16x32_bf16 v[36:39], a[0:3], a[224:227], v[52:55]
  v_exp_f32 v77, v41
  v_mfma_f32_16x16x32_bf16 v[36:39], a[4:7], a[228:231], v[36:39]
  ds_read_b128 a[144:147], v5 offset:28672
  v_fma_f32 v60, v112, s59, v60
  v_mfma_f32_16x16x32_bf16 v[36:39], a[8:11], a[232:235], v[36:39]
  ds_read_b128 a[160:163], v5 offset:0
  v_fma_f32 v61, v113, s59, v61
  v_mfma_f32_16x16x32_bf16 v[36:39], a[12:15], a[236:239], v[36:39]
  s_waitcnt lgkmcnt(6)
  buffer_load_dwordx4 v4, s[12:15], s66 offen offset:1024 sc1 lds
  v_mfma_f32_16x16x32_bf16 v[36:39], a[16:19], a[240:243], v[36:39]
  ds_read_b128 a[148:151], v5 offset:29696
  ds_read_b128 a[164:167], v5 offset:1024
  buffer_load_dwordx4 a[108:111], v1, s[12:15], s47 offen offset:3072 sc1
  v_fma_f32 v62, v114, s59, v62
  v_fma_f32 v63, v115, s59, v63
  v_mfma_f32_16x16x32_bf16 v[36:39], a[20:23], a[244:247], v[36:39]
  ds_read_b128 a[168:171], v5 offset:2048
  ds_read_b128 a[152:155], v5 offset:30720
  v_mfma_f32_16x16x32_bf16 v[36:39], a[24:27], a[248:251], v[36:39]
  ds_read_b128 a[172:175], v5 offset:3072
  ds_read_b128 a[156:159], v5 offset:31744
  v_mfma_f32_16x16x32_bf16 v[36:39], a[28:31], a[252:255], v[36:39]
  s_waitcnt lgkmcnt(8)
  ds_read_b128 a[176:179], v5 offset:4096
  buffer_load_dwordx4 v4, s[12:15], s66 offen offset:2048 sc1 lds
  v_mfma_f32_16x16x32_bf16 v[44:47], a[128:131], a[224:227], v[60:63]
  ds_read_b128 a[180:183], v5 offset:5120
  ds_read_b128 a[184:187], v5 offset:6144
  v_mfma_f32_16x16x32_bf16 v[44:47], a[132:135], a[228:231], v[44:47]
  v_exp_f32 v78, v42
  v_mfma_f32_16x16x32_bf16 v[44:47], a[136:139], a[232:235], v[44:47]
  ds_read_b128 a[188:191], v5 offset:7168
  ds_read_b128 a[32:35], v5 offset:8192
  v_mfma_f32_16x16x32_bf16 v[44:47], a[140:143], a[236:239], v[44:47]
  s_waitcnt lgkmcnt(5)
  ds_read_b128 a[36:39], v5 offset:9216
  ds_read_b128 a[40:43], v5 offset:10240
  ds_read_b128 a[44:47], v5 offset:11264
  ds_read_b128 a[112:115], v5 offset:12288
  ds_read_b128 a[116:119], v5 offset:13312
  ds_read_b128 a[120:123], v5 offset:14336
  ds_read_b128 a[124:127], v5 offset:15360
  buffer_load_dwordx4 v4, s[12:15], s66 offen offset:3072 sc1 lds
  v_exp_f32 v79, v43
  v_add_f32 v92, v72, v73
  v_add_f32 v92, v92, v74
  v_add_f32 v92, v92, v75
  v_add_f32 v92, v92, v76
  v_add_f32 v92, v92, v77
  v_add_f32 v92, v92, v78
  v_add_f32 v92, v92, v79
  v_cmp_lt_f32 vcc, s75, v92
  v_cvt_pk_bf16_f32 v64, v72, v73
  v_cvt_pk_bf16_f32 v65, v74, v75
  v_cvt_pk_bf16_f32 v66, v76, v77
  v_cvt_pk_bf16_f32 v67, v78, v79
  s_cbranch_vccnz L_kf_kernel_rare_83
L_kf_kernel_rarer_84:
  v_add_f32 v89, v89, v92
  v_mfma_f32_16x16x32_bf16 v[44:47], a[144:147], a[240:243], v[44:47]
  s_add_u32 s66, s66, 0x8000
  s_add_u32 m0, s67, s65
  s_waitcnt vmcnt(33)
  v_sub_f32 v18, v126, v90
  v_mfma_f32_16x16x32_bf16 v[44:47], a[148:151], a[244:247], v[44:47]
  s_add_u32 s67, s67, 0x8000
  s_and_b32 s67, s67, 0x1ffff
  v_cmp_lt_f32 vcc, 0x41800000, v18
  v_mfma_f32_16x16x32_bf16 v[44:47], a[152:155], a[248:251], v[44:47]
  s_waitcnt lgkmcnt(0)
  v_add_u32 v5, s67, v1
  v_mfma_f32_16x16x32_bf16 v[44:47], a[156:159], a[252:255], v[44:47]
  s_barrier
  v_exp_f32 v19, v18
  v_mfma_f32_16x16x32_bf16 v[192:195], a[160:163], v[64:67], v[192:195]
  buffer_load_dwordx4 v3, s[12:15], s66 offen offset:0 sc1 lds
  v_mfma_f32_16x16x32_bf16 v[196:199], a[164:167], v[64:67], v[196:199]
  v_cvt_pk_bf16_f32 v20, v19, v19
  v_and_b32 v22, v20, v30
  v_mfma_f32_16x16x32_bf16 v[200:203], a[168:171], v[64:67], v[200:203]
  v_and_b32 v23, v20, v31
  v_and_b32 v28, v20, v30
  v_mfma_f32_16x16x32_bf16 v[204:207], a[172:175], v[64:67], v[204:207]
  ds_read_b128 a[160:163], v5 offset:0
  v_and_b32 v29, v20, v31
  v_mfma_f32_16x16x32_bf16 v[208:211], a[176:179], v[64:67], v[208:211]
  buffer_load_dwordx4 v3, s[12:15], s66 offen offset:1024 sc1 lds
  v_mfma_f32_16x16x32_bf16 v[212:215], a[180:183], v[64:67], v[212:215]
  s_cbranch_vccnz L_kf_kernel_mrare_87
L_kf_kernel_mrarer_88:
  v_fmac_f32 v88, v124, v19
  v_mfma_f32_16x16x32_bf16 v[216:219], a[184:187], v[64:67], v[216:219]
  v_exp_f32 v80, v36
  v_mfma_f32_16x16x32_bf16 v[220:223], a[188:191], v[64:67], v[220:223]
  v_exp_f32 v81, v37
  v_mfma_f32_16x16x32_bf16 v[224:227], a[32:35], v[64:67], v[224:227]
  v_exp_f32 v82, v38
  v_mfma_f32_16x16x32_bf16 v[228:231], a[36:39], v[64:67], v[228:231]
  buffer_load_dwordx4 v3, s[12:15], s66 offen offset:2048 sc1 lds
  v_mfma_f32_16x16x32_bf16 v[232:235], a[40:43], v[64:67], v[232:235]
  v_exp_f32 v83, v39
  v_mfma_f32_16x16x32_bf16 v[236:239], a[44:47], v[64:67], v[236:239]
  ds_read_b128 a[164:167], v5 offset:1024
  ds_read_b128 a[168:171], v5 offset:2048
  v_mfma_f32_16x16x32_bf16 v[240:243], a[112:115], v[64:67], v[240:243]
  v_exp_f32 v84, v44
  v_mfma_f32_16x16x32_bf16 v[244:247], a[116:119], v[64:67], v[244:247]
  v_exp_f32 v85, v45
  v_mfma_f32_16x16x32_bf16 v[248:251], a[120:123], v[64:67], v[248:251]
  buffer_load_dwordx4 v3, s[12:15], s66 offen offset:3072 sc1 lds
  v_mfma_f32_16x16x32_bf16 v[252:255], a[124:127], v[64:67], v[252:255]
  s_waitcnt vmcnt(35)
  s_add_u32 m0, m0, 0x4000
  ds_read_b128 a[172:175], v5 offset:3072
  v_mfma_f32_16x16x32_bf16 v[128:131], a[48:51], v[22:25], v[128:131]
  v_exp_f32 v86, v46
  v_mfma_f32_16x16x32_bf16 v[132:135], a[48:51], v[26:29], v[132:135]
  ds_read_b128 a[176:179], v5 offset:4096
  ds_read_b128 a[180:183], v5 offset:5120
  v_mfma_f32_16x16x32_bf16 v[136:139], a[52:55], v[22:25], v[136:139]
  buffer_load_dwordx4 v4, s[12:15], s66 offen offset:0 sc1 lds
  v_mfma_f32_16x16x32_bf16 v[140:143], a[52:55], v[26:29], v[140:143]
  s_waitcnt vmcnt(33)
  v_exp_f32 v87, v47
  v_mfma_f32_16x16x32_bf16 v[144:147], a[56:59], v[22:25], v[144:147]
  v_add_f32 v93, v80, v81
  v_add_f32 v93, v93, v82
  v_mfma_f32_16x16x32_bf16 v[148:151], a[56:59], v[26:29], v[148:151]
  ds_read_b128 a[184:187], v5 offset:6144
  v_add_f32 v93, v93, v83
  v_mfma_f32_16x16x32_bf16 v[152:155], a[60:63], v[22:25], v[152:155]
  ds_read_b128 a[188:191], v5 offset:7168
  v_add_f32 v93, v93, v84
  v_mfma_f32_16x16x32_bf16 v[156:159], a[60:63], v[26:29], v[156:159]
  s_waitcnt vmcnt(30)
  buffer_load_dwordx4 v4, s[12:15], s66 offen offset:1024 sc1 lds
  v_mfma_f32_16x16x32_bf16 v[160:163], a[64:67], v[22:25], v[160:163]
  v_add_f32 v93, v93, v85
  v_add_f32 v93, v93, v86
  v_mfma_f32_16x16x32_bf16 v[164:167], a[64:67], v[26:29], v[164:167]
  ds_read_b128 a[32:35], v5 offset:8192
  v_add_f32 v93, v93, v87
  v_mfma_f32_16x16x32_bf16 v[168:171], a[68:71], v[22:25], v[168:171]
  ds_read_b128 a[36:39], v5 offset:9216
  v_cmp_lt_f32 vcc, s75, v93
  v_mfma_f32_16x16x32_bf16 v[172:175], a[68:71], v[26:29], v[172:175]
  s_waitcnt vmcnt(27)
  v_cvt_pk_bf16_f32 v68, v80, v81
  v_cvt_pk_bf16_f32 v69, v82, v83
  v_mfma_f32_16x16x32_bf16 v[176:179], a[72:75], v[22:25], v[176:179]
  buffer_load_dwordx4 v4, s[12:15], s66 offen offset:2048 sc1 lds
  v_mfma_f32_16x16x32_bf16 v[180:183], a[72:75], v[26:29], v[180:183]
  ds_read_b128 a[40:43], v5 offset:10240
  v_cvt_pk_bf16_f32 v70, v84, v85
  v_mfma_f32_16x16x32_bf16 v[184:187], a[76:79], v[22:25], v[184:187]
  ds_read_b128 a[44:47], v5 offset:11264
  v_cvt_pk_bf16_f32 v71, v86, v87
  s_cbranch_vccnz L_kf_kernel_rare_85
L_kf_kernel_rarer_86:
  v_mfma_f32_16x16x32_bf16 v[188:191], a[76:79], v[26:29], v[188:191]
  s_waitcnt lgkmcnt(8)
  ds_read_b128 a[112:115], v5 offset:12288
  ds_read_b128 a[116:119], v5 offset:13312
  v_mfma_f32_16x16x32_bf16 v[192:195], a[160:163], v[68:71], v[192:195]
  ds_read_b128 a[120:123], v5 offset:14336
  ds_read_b128 a[124:127], v5 offset:15360
  v_mfma_f32_16x16x32_bf16 v[196:199], a[164:167], v[68:71], v[196:199]
  buffer_load_dwordx4 v4, s[12:15], s66 offen offset:3072 sc1 lds
  v_mfma_f32_16x16x32_bf16 v[200:203], a[168:171], v[68:71], v[200:203]
  s_add_u32 s66, s66, 0x8000
  s_add_u32 m0, s67, s65
  v_add_f32 v89, v89, v93
  v_mfma_f32_16x16x32_bf16 v[204:207], a[172:175], v[68:71], v[204:207]
  s_waitcnt lgkmcnt(8)
  s_add_u32 s67, s67, 0x8000
  s_and_b32 s67, s67, 0x1ffff
  v_mfma_f32_16x16x32_bf16 v[208:211], a[176:179], v[68:71], v[208:211]
  s_waitcnt vmcnt(20) lgkmcnt(0)
  v_add_u32 v5, s67, v1
  v_sub_f32 v18, v127, v91
  v_mfma_f32_16x16x32_bf16 v[212:215], a[180:183], v[68:71], v[212:215]
  s_barrier
  v_cmp_lt_f32 vcc, 0x41800000, v18
  v_cvt_pk_bf16_f32 v128, v128, v129
  v_mfma_f32_16x16x32_bf16 v[216:219], a[184:187], v[68:71], v[216:219]
  v_exp_f32 v19, v18
  v_mfma_f32_16x16x32_bf16 v[220:223], a[188:191], v[68:71], v[220:223]
  v_cvt_pk_bf16_f32 v20, v19, v19
  v_and_b32 v22, v20, v30
  v_mfma_f32_16x16x32_bf16 v[224:227], a[32:35], v[68:71], v[224:227]
  buffer_load_dwordx4 v3, s[12:15], s66 offen offset:0 sc1 lds
  v_mfma_f32_16x16x32_bf16 v[228:231], a[36:39], v[68:71], v[228:231]
  v_and_b32 v23, v20, v31
  v_and_b32 v28, v20, v30
  v_mfma_f32_16x16x32_bf16 v[232:235], a[40:43], v[68:71], v[232:235]
  v_and_b32 v29, v20, v31
  v_cvt_pk_bf16_f32 v129, v130, v131
  v_mfma_f32_16x16x32_bf16 v[236:239], a[44:47], v[68:71], v[236:239]
  v_cvt_pk_bf16_f32 v130, v132, v133
  v_cvt_pk_bf16_f32 v131, v134, v135
  v_mfma_f32_16x16x32_bf16 v[240:243], a[112:115], v[68:71], v[240:243]
  ds_read_b128 a[128:131], v5 offset:0
  v_cvt_pk_bf16_f32 v132, v136, v137
  v_mfma_f32_16x16x32_bf16 v[244:247], a[116:119], v[68:71], v[244:247]
  v_cvt_pk_bf16_f32 v133, v138, v139
  v_cvt_pk_bf16_f32 v134, v140, v141
  v_mfma_f32_16x16x32_bf16 v[248:251], a[120:123], v[68:71], v[248:251]
  ds_read_b128 a[132:135], v5 offset:1024
  v_cvt_pk_bf16_f32 v135, v142, v143
  v_mfma_f32_16x16x32_bf16 v[252:255], a[124:127], v[68:71], v[252:255]
  s_cbranch_vccnz L_kf_kernel_mrare_89
L_kf_kernel_mrarer_90:
  v_fmac_f32 v89, v125, v19
  v_mfma_f32_16x16x32_bf16 v[192:195], a[80:83], v[22:25], v[192:195]
  ds_read_b128 a[136:139], v5 offset:2048
  v_cvt_pk_bf16_f32 v136, v144, v145
  v_mfma_f32_16x16x32_bf16 v[196:199], a[80:83], v[26:29], v[196:199]
  v_cvt_pk_bf16_f32 v137, v146, v147
  v_cvt_pk_bf16_f32 v138, v148, v149
  v_mfma_f32_16x16x32_bf16 v[200:203], a[84:87], v[22:25], v[200:203]
  ds_read_b128 a[140:143], v5 offset:3072
  v_cvt_pk_bf16_f32 v139, v150, v151
  v_mfma_f32_16x16x32_bf16 v[204:207], a[84:87], v[26:29], v[204:207]
  ds_read_b128 a[144:147], v5 offset:4096
  v_cvt_pk_bf16_f32 v140, v152, v153
  v_mfma_f32_16x16x32_bf16 v[208:211], a[88:91], v[22:25], v[208:211]
  v_cvt_pk_bf16_f32 v141, v154, v155
  v_cvt_pk_bf16_f32 v142, v156, v157
  v_mfma_f32_16x16x32_bf16 v[212:215], a[88:91], v[26:29], v[212:215]
  ds_read_b128 a[148:151], v5 offset:5120
  v_cvt_pk_bf16_f32 v143, v158, v159
  v_mfma_f32_16x16x32_bf16 v[216:219], a[92:95], v[22:25], v[216:219]
  ds_read_b128 a[152:155], v5 offset:6144
  v_cvt_pk_bf16_f32 v160, v160, v161
  v_mfma_f32_16x16x32_bf16 v[220:223], a[92:95], v[26:29], v[220:223]
  s_waitcnt vmcnt(18)
  v_cvt_pk_bf16_f32 v161, v162, v163
  v_cvt_pk_bf16_f32 v162, v164, v165
  v_mfma_f32_16x16x32_bf16 v[224:227], a[96:99], v[22:25], v[224:227]
  ds_read_b128 a[156:159], v5 offset:7168
  v_cvt_pk_bf16_f32 v163, v166, v167
  v_mfma_f32_16x16x32_bf16 v[228:231], a[96:99], v[26:29], v[228:231]
  ds_read_b128 a[160:163], v5 offset:8192
  v_cvt_pk_bf16_f32 v164, v168, v169
  v_mfma_f32_16x16x32_bf16 v[232:235], a[100:103], v[22:25], v[232:235]
  buffer_load_dwordx4 v3, s[12:15], s66 offen offset:1024 sc1 lds
  v_mfma_f32_16x16x32_bf16 v[236:239], a[100:103], v[26:29], v[236:239]
  s_waitcnt vmcnt(12)
  v_cvt_pk_bf16_f32 v165, v170, v171
  v_cvt_pk_bf16_f32 v166, v172, v173
  v_mfma_f32_16x16x32_bf16 v[240:243], a[104:107], v[22:25], v[240:243]
  ds_read_b128 a[164:167], v5 offset:9216
  v_cvt_pk_bf16_f32 v167, v174, v175
  v_mfma_f32_16x16x32_bf16 v[244:247], a[104:107], v[26:29], v[244:247]
  ds_read_b128 a[168:171], v5 offset:10240
  v_cvt_pk_bf16_f32 v168, v176, v177
  v_mfma_f32_16x16x32_bf16 v[248:251], a[108:111], v[22:25], v[248:251]
  v_cvt_pk_bf16_f32 v169, v178, v179
  v_cvt_pk_bf16_f32 v170, v180, v181
  v_mfma_f32_16x16x32_bf16 v[252:255], a[108:111], v[26:29], v[252:255]
  s_waitcnt lgkmcnt(7)
  ds_read_b128 a[172:175], v5 offset:11264
  v_cvt_pk_bf16_f32 v171, v182, v183
  v_mfma_f32_16x16x32_bf16 v[144:147], a[128:131], v[128:131], 0
  ds_read_b128 a[176:179], v5 offset:12288
  v_cvt_pk_bf16_f32 v172, v184, v185
  v_mfma_f32_16x16x32_bf16 v[144:147], a[132:135], v[132:135], v[144:147]
  v_cvt_pk_bf16_f32 v173, v186, v187
  v_cvt_pk_bf16_f32 v174, v188, v189
  v_mfma_f32_16x16x32_bf16 v[144:147], a[136:139], v[136:139], v[144:147]
  ds_read_b128 a[180:183], v5 offset:13312
  v_cvt_pk_bf16_f32 v175, v190, v191
  v_mfma_f32_16x16x32_bf16 v[144:147], a[140:143], v[140:143], v[144:147]
  s_waitcnt lgkmcnt(6)
  ds_read_b128 a[184:187], v5 offset:14336
  ds_read_b128 a[188:191], v5 offset:15360
  v_mfma_f32_16x16x32_bf16 v[144:147], a[144:147], v[160:163], v[144:147]
  v_cvt_pk_bf16_f32 v192, v192, v193
  v_cvt_pk_bf16_f32 v193, v194, v195
  v_mfma_f32_16x16x32_bf16 v[144:147], a[148:151], v[164:167], v[144:147]
  v_cvt_pk_bf16_f32 v194, v196, v197
  v_cvt_pk_bf16_f32 v195, v198, v199
  v_mfma_f32_16x16x32_bf16 v[144:147], a[152:155], v[168:171], v[144:147]
  v_cvt_pk_bf16_f32 v196, v200, v201
  v_cvt_pk_bf16_f32 v197, v202, v203
  v_mfma_f32_16x16x32_bf16 v[144:147], a[156:159], v[172:175], v[144:147]
  s_waitcnt lgkmcnt(4)
  v_cvt_pk_bf16_f32 v198, v204, v205
  v_cvt_pk_bf16_f32 v199, v206, v207
  v_mfma_f32_16x16x32_bf16 v[152:155], a[160:163], v[128:131], 0
  v_cvt_pk_bf16_f32 v200, v208, v209
  v_cvt_pk_bf16_f32 v201, v210, v211
  v_mfma_f32_16x16x32_bf16 v[152:155], a[164:167], v[132:135], v[152:155]
  v_cvt_pk_bf16_f32 v202, v212, v213
  v_cvt_pk_bf16_f32 v203, v214, v215
  v_mfma_f32_16x16x32_bf16 v[152:155], a[168:171], v[136:139], v[152:155]
  v_cvt_pk_bf16_f32 v204, v216, v217
  v_cvt_pk_bf16_f32 v205, v218, v219
  v_mfma_f32_16x16x32_bf16 v[152:155], a[172:175], v[140:143], v[152:155]
  s_waitcnt lgkmcnt(0)
  v_cvt_pk_bf16_f32 v206, v220, v221
  v_cvt_pk_bf16_f32 v207, v222, v223
  v_mfma_f32_16x16x32_bf16 v[152:155], a[176:179], v[160:163], v[152:155]
  v_cvt_pk_bf16_f32 v224, v224, v225
  v_cvt_pk_bf16_f32 v225, v226, v227
  v_mfma_f32_16x16x32_bf16 v[152:155], a[180:183], v[164:167], v[152:155]
  v_cvt_pk_bf16_f32 v226, v228, v229
  v_cvt_pk_bf16_f32 v227, v230, v231
  v_mfma_f32_16x16x32_bf16 v[152:155], a[184:187], v[168:171], v[152:155]
  v_cvt_pk_bf16_f32 v228, v232, v233
  v_cvt_pk_bf16_f32 v229, v234, v235
  v_mfma_f32_16x16x32_bf16 v[152:155], a[188:191], v[172:175], v[152:155]
  v_cvt_pk_bf16_f32 v230, v236, v237
  v_cvt_pk_bf16_f32 v231, v238, v239
  v_cvt_pk_bf16_f32 v232, v240, v241
  v_cvt_pk_bf16_f32 v233, v242, v243
  v_cvt_pk_bf16_f32 v234, v244, v245
  v_cvt_pk_bf16_f32 v235, v246, v247
  v_cvt_pk_bf16_f32 v236, v248, v249
  v_cvt_pk_bf16_f32 v237, v250, v251
  v_cvt_pk_bf16_f32 v238, v252, v253
  v_cvt_pk_bf16_f32 v239, v254, v255
  s_branch L_kf_kernel_opl_24
L_kf_kernel_alast_21:
  v_mfma_f32_16x16x32_bf16 v[32:35], a[0:3], a[192:195], v[48:51]
  s_add_u32 s97, s67, s65
  v_exp_f32 v86, v46
  v_mfma_f32_16x16x32_bf16 v[32:35], a[4:7], a[196:199], v[32:35]
  s_add_u32 s67, s67, 0x8000
  ds_read_b128 a[144:147], v5 offset:28672
  v_add_f32 v93, v93, v85
  v_mfma_f32_16x16x32_bf16 v[32:35], a[8:11], a[200:203], v[32:35]
  s_and_b32 s67, s67, 0x1ffff
  buffer_load_dwordx4 v4, s[12:15], s66 offen offset:2048 sc1 lds
  v_mfma_f32_16x16x32_bf16 v[32:35], a[12:15], a[204:207], v[32:35]
  s_waitcnt lgkmcnt(5)
  ds_read_b128 a[148:151], v5 offset:29696
  v_add_f32 v93, v93, v86
  v_mfma_f32_16x16x32_bf16 v[32:35], a[16:19], a[208:211], v[32:35]
  s_add_u32 s98, s66, 0x8000
  ds_read_b128 a[152:155], v5 offset:30720
  v_cvt_pk_bf16_f32 v70, v84, v85
  v_mfma_f32_16x16x32_bf16 v[32:35], a[20:23], a[212:215], v[32:35]
  s_cmp_eq_u32 s71, 3
  v_exp_f32 v87, v47
  v_mfma_f32_16x16x32_bf16 v[32:35], a[24:27], a[216:219], v[32:35]
  s_cselect_b32 s98, s63, s98
  ds_read_b128 a[156:159], v5 offset:31744
  v_add_f32 v93, v93, v87
  v_mfma_f32_16x16x32_bf16 v[32:35], a[28:31], a[220:223], v[32:35]
  s_waitcnt lgkmcnt(4)
  v_cvt_pk_bf16_f32 v71, v86, v87
  v_cmp_lt_f32 vcc, s75, v93
  v_mfma_f32_16x16x32_bf16 v[40:43], a[128:131], a[192:195], v[56:59]
  buffer_load_dwordx4 v4, s[12:15], s66 offen offset:3072 sc1 lds
  v_mfma_f32_16x16x32_bf16 v[40:43], a[132:135], a[196:199], v[40:43]
  s_cbranch_vccnz L_kf_kernel_rare_91
L_kf_kernel_rarer_92:
  v_add_f32 v89, v89, v93
  v_mfma_f32_16x16x32_bf16 v[40:43], a[136:139], a[200:203], v[40:43]
  s_mov_b32 m0, s97
  v_exp_f32 v72, v32
  v_mfma_f32_16x16x32_bf16 v[40:43], a[140:143], a[204:207], v[40:43]
  s_waitcnt lgkmcnt(0)
  v_exp_f32 v73, v33
  v_mfma_f32_16x16x32_bf16 v[40:43], a[144:147], a[208:211], v[40:43]
  s_waitcnt vmcnt(16)
  v_add_u32 v5, s67, v1
  s_mov_b32 s66, s98
  v_mfma_f32_16x16x32_bf16 v[40:43], a[148:151], a[212:215], v[40:43]
  s_barrier
  v_mfma_f32_16x16x32_bf16 v[40:43], a[152:155], a[216:219], v[40:43]
  v_exp_f32 v74, v34
  v_mfma_f32_16x16x32_bf16 v[40:43], a[156:159], a[220:223], v[40:43]
  v_exp_f32 v75, v35
  v_mfma_f32_16x16x32_bf16 v[192:195], a[160:163], v[68:71], v[192:195]
  buffer_load_dwordx4 v3, s[12:15], s66 offen offset:0 sc1 lds
  v_mfma_f32_16x16x32_bf16 v[196:199], a[164:167], v[68:71], v[196:199]
  s_sub_u32 s71, s71, 1
  ds_read_b128 a[160:163], v5 offset:0
  v_add_f32 v92, v72, v73
  v_mfma_f32_16x16x32_bf16 v[200:203], a[168:171], v[68:71], v[200:203]
  v_exp_f32 v76, v40
  v_mfma_f32_16x16x32_bf16 v[204:207], a[172:175], v[68:71], v[204:207]
  ds_read_b128 a[164:167], v5 offset:1024
  v_add_f32 v92, v92, v74
  v_mfma_f32_16x16x32_bf16 v[208:211], a[176:179], v[68:71], v[208:211]
  ds_read_b128 a[168:171], v5 offset:2048
  v_add_f32 v92, v92, v75
  v_mfma_f32_16x16x32_bf16 v[212:215], a[180:183], v[68:71], v[212:215]
  v_exp_f32 v77, v41
  v_mfma_f32_16x16x32_bf16 v[216:219], a[184:187], v[68:71], v[216:219]
  ds_read_b128 a[172:175], v5 offset:3072
  v_cvt_pk_bf16_f32 v64, v72, v73
  v_mfma_f32_16x16x32_bf16 v[220:223], a[188:191], v[68:71], v[220:223]
  v_exp_f32 v78, v42
  v_mfma_f32_16x16x32_bf16 v[224:227], a[32:35], v[68:71], v[224:227]
  ds_read_b128 a[176:179], v5 offset:4096
  v_cvt_pk_bf16_f32 v65, v74, v75
  v_mfma_f32_16x16x32_bf16 v[228:231], a[36:39], v[68:71], v[228:231]
  ds_read_b128 a[180:183], v5 offset:5120
  v_add_f32 v92, v92, v76
  v_mfma_f32_16x16x32_bf16 v[232:235], a[40:43], v[68:71], v[232:235]
  v_exp_f32 v79, v43
  v_mfma_f32_16x16x32_bf16 v[236:239], a[44:47], v[68:71], v[236:239]
  ds_read_b128 a[184:187], v5 offset:6144
  v_add_f32 v92, v92, v77
  v_mfma_f32_16x16x32_bf16 v[240:243], a[112:115], v[68:71], v[240:243]
  buffer_load_dwordx4 v3, s[12:15], s66 offen offset:1024 sc1 lds
  v_mfma_f32_16x16x32_bf16 v[244:247], a[116:119], v[68:71], v[244:247]
  ds_read_b128 a[188:191], v5 offset:7168
  v_add_f32 v92, v92, v78
  v_mfma_f32_16x16x32_bf16 v[248:251], a[120:123], v[68:71], v[248:251]
  v_add_f32 v92, v92, v79
  v_cvt_pk_bf16_f32 v66, v76, v77
  v_mfma_f32_16x16x32_bf16 v[252:255], a[124:127], v[68:71], v[252:255]
  ds_read_b128 a[32:35], v5 offset:8192
  v_cvt_pk_bf16_f32 v67, v78, v79
  v_mfma_f32_16x16x32_bf16 v[36:39], a[0:3], a[224:227], v[52:55]
  ds_read_b128 a[36:39], v5 offset:9216
  v_cmp_lt_f32 vcc, s75, v92
  v_mfma_f32_16x16x32_bf16 v[36:39], a[4:7], a[228:231], v[36:39]
  s_cbranch_vccnz L_kf_kernel_rare_93
L_kf_kernel_rarer_94:
  v_mfma_f32_16x16x32_bf16 v[36:39], a[8:11], a[232:235], v[36:39]
  ds_read_b128 a[40:43], v5 offset:10240
  v_add_f32 v88, v88, v92
  v_mfma_f32_16x16x32_bf16 v[36:39], a[12:15], a[236:239], v[36:39]
  buffer_load_dwordx4 v3, s[12:15], s66 offen offset:2048 sc1 lds
  v_mfma_f32_16x16x32_bf16 v[36:39], a[16:19], a[240:243], v[36:39]
  ds_read_b128 a[44:47], v5 offset:11264
  v_mfma_f32_16x16x32_bf16 v[36:39], a[20:23], a[244:247], v[36:39]
  ds_read_b128 a[112:115], v5 offset:12288
  v_mfma_f32_16x16x32_bf16 v[36:39], a[24:27], a[248:251], v[36:39]
  v_mfma_f32_16x16x32_bf16 v[36:39], a[28:31], a[252:255], v[36:39]
  ds_read_b128 a[116:119], v5 offset:13312
  v_mfma_f32_16x16x32_bf16 v[44:47], a[128:131], a[224:227], v[60:63]
  buffer_load_dwordx4 v3, s[12:15], s66 offen offset:3072 sc1 lds
  v_mfma_f32_16x16x32_bf16 v[44:47], a[132:135], a[228:231], v[44:47]
  s_add_u32 m0, m0, 0x4000
  ds_read_b128 a[120:123], v5 offset:14336
  v_mfma_f32_16x16x32_bf16 v[44:47], a[136:139], a[232:235], v[44:47]
  s_nop 0
  v_exp_f32 v80, v36
  v_mfma_f32_16x16x32_bf16 v[44:47], a[140:143], a[236:239], v[44:47]
  ds_read_b128 a[124:127], v5 offset:15360
  v_mfma_f32_16x16x32_bf16 v[44:47], a[144:147], a[240:243], v[44:47]
  buffer_load_dwordx4 v4, s[12:15], s66 offen offset:0 sc1 lds
  v_mfma_f32_16x16x32_bf16 v[44:47], a[148:151], a[244:247], v[44:47]
  v_exp_f32 v81, v37
  v_mfma_f32_16x16x32_bf16 v[44:47], a[152:155], a[248:251], v[44:47]
  buffer_load_dwordx4 v4, s[12:15], s66 offen offset:1024 sc1 lds
  v_mfma_f32_16x16x32_bf16 v[44:47], a[156:159], a[252:255], v[44:47]
  s_waitcnt lgkmcnt(12)
  v_exp_f32 v82, v38
  v_mfma_f32_16x16x32_bf16 v[128:131], a[160:163], v[64:67], v[128:131]
  buffer_load_dwordx4 v4, s[12:15], s66 offen offset:2048 sc1 lds
  v_mfma_f32_16x16x32_bf16 v[132:135], a[164:167], v[64:67], v[132:135]
  buffer_load_dwordx4 v4, s[12:15], s66 offen offset:3072 sc1 lds
  v_mfma_f32_16x16x32_bf16 v[136:139], a[168:171], v[64:67], v[136:139]
  s_add_u32 s66, s66, 0x8000
  v_exp_f32 v83, v39
  v_mfma_f32_16x16x32_bf16 v[140:143], a[172:175], v[64:67], v[140:143]
  s_waitcnt lgkmcnt(8)
  s_add_u32 m0, s67, s65
  s_add_u32 s67, s67, 0x8000
  v_mfma_f32_16x16x32_bf16 v[144:147], a[176:179], v[64:67], v[144:147]
  s_waitcnt vmcnt(16) lgkmcnt(0)
  s_and_b32 s67, s67, 0x1ffff
  v_add_u32 v5, s67, v1
  v_mfma_f32_16x16x32_bf16 v[148:151], a[180:183], v[64:67], v[148:151]
  s_barrier
  v_exp_f32 v84, v44
  v_mfma_f32_16x16x32_bf16 v[152:155], a[184:187], v[64:67], v[152:155]
  v_exp_f32 v85, v45
  v_mfma_f32_16x16x32_bf16 v[156:159], a[188:191], v[64:67], v[156:159]
  v_exp_f32 v86, v46
  v_mfma_f32_16x16x32_bf16 v[160:163], a[32:35], v[64:67], v[160:163]
  v_exp_f32 v87, v47
  v_mfma_f32_16x16x32_bf16 v[164:167], a[36:39], v[64:67], v[164:167]
  v_add_f32 v93, v80, v81
  v_add_f32 v93, v93, v82
  v_mfma_f32_16x16x32_bf16 v[168:171], a[40:43], v[64:67], v[168:171]
  v_add_f32 v93, v93, v83
  v_add_f32 v93, v93, v84
  v_mfma_f32_16x16x32_bf16 v[172:175], a[44:47], v[64:67], v[172:175]
  v_add_f32 v93, v93, v85
  v_add_f32 v93, v93, v86
  v_mfma_f32_16x16x32_bf16 v[176:179], a[112:115], v[64:67], v[176:179]
  v_add_f32 v93, v93, v87
  v_cmp_lt_f32 vcc, s75, v93
  v_mfma_f32_16x16x32_bf16 v[180:183], a[116:119], v[64:67], v[180:183]
  v_cvt_pk_bf16_f32 v68, v80, v81
  v_cvt_pk_bf16_f32 v69, v82, v83
  v_mfma_f32_16x16x32_bf16 v[184:187], a[120:123], v[64:67], v[184:187]
  v_cvt_pk_bf16_f32 v70, v84, v85
  v_cvt_pk_bf16_f32 v71, v86, v87
  s_cbranch_vccnz L_kf_kernel_rare_95
L_kf_kernel_rarer_96:
  v_mfma_f32_16x16x32_bf16 v[188:191], a[124:127], v[64:67], v[188:191]
  v_cvt_pk_bf16_f32 v128, v128, v129
  v_cvt_pk_bf16_f32 v129, v130, v131
  v_mfma_f32_16x16x32_bf16 v[192:195], a[160:163], v[68:71], v[192:195]
  ds_read_b128 a[128:131], v5 offset:0
  v_cvt_pk_bf16_f32 v130, v132, v133
  v_mfma_f32_16x16x32_bf16 v[196:199], a[164:167], v[68:71], v[196:199]
  ds_read_b128 a[132:135], v5 offset:1024
  v_cvt_pk_bf16_f32 v131, v134, v135
  v_mfma_f32_16x16x32_bf16 v[200:203], a[168:171], v[68:71], v[200:203]
  buffer_load_dwordx4 v3, s[12:15], s66 offen offset:0 sc1 lds
  v_mfma_f32_16x16x32_bf16 v[204:207], a[172:175], v[68:71], v[204:207]
  ds_read_b128 a[136:139], v5 offset:2048
  v_cvt_pk_bf16_f32 v132, v136, v137
  v_mfma_f32_16x16x32_bf16 v[208:211], a[176:179], v[68:71], v[208:211]
  v_cvt_pk_bf16_f32 v133, v138, v139
  v_cvt_pk_bf16_f32 v134, v140, v141
  v_mfma_f32_16x16x32_bf16 v[212:215], a[180:183], v[68:71], v[212:215]
  ds_read_b128 a[140:143], v5 offset:3072
  v_cvt_pk_bf16_f32 v135, v142, v143
  v_add_f32 v89, v89, v93
  v_mfma_f32_16x16x32_bf16 v[216:219], a[184:187], v[68:71], v[216:219]
  ds_read_b128 a[144:147], v5 offset:4096
  v_cvt_pk_bf16_f32 v136, v144, v145
  v_mfma_f32_16x16x32_bf16 v[220:223], a[188:191], v[68:71], v[220:223]
  v_cvt_pk_bf16_f32 v137, v146, v147
  v_cvt_pk_bf16_f32 v138, v148, v149
  v_mfma_f32_16x16x32_bf16 v[224:227], a[32:35], v[68:71], v[224:227]
  ds_read_b128 a[148:151], v5 offset:5120
  v_cvt_pk_bf16_f32 v139, v150, v151
  v_mfma_f32_16x16x32_bf16 v[228:231], a[36:39], v[68:71], v[228:231]
  v_cvt_pk_bf16_f32 v140, v152, v153
  v_cvt_pk_bf16_f32 v141, v154, v155
  v_mfma_f32_16x16x32_bf16 v[232:235], a[40:43], v[68:71], v[232:235]
  buffer_load_dwordx4 v3, s[12:15], s66 offen offset:1024 sc1 lds
  ds_read_b128 a[152:155], v5 offset:6144
  v_mfma_f32_16x16x32_bf16 v[236:239], a[44:47], v[68:71], v[236:239]
  ds_read_b128 a[156:159], v5 offset:7168
  v_cvt_pk_bf16_f32 v142, v156, v157
  v_mfma_f32_16x16x32_bf16 v[240:243], a[112:115], v[68:71], v[240:243]
  v_cvt_pk_bf16_f32 v143, v158, v159
  v_cvt_pk_bf16_f32 v160, v160, v161
  v_mfma_f32_16x16x32_bf16 v[244:247], a[116:119], v[68:71], v[244:247]
  ds_read_b128 a[160:163], v5 offset:8192
  v_cvt_pk_bf16_f32 v161, v162, v163
  v_cvt_pk_bf16_f32 v162, v164, v165
  v_cvt_pk_bf16_f32 v163, v166, v167
  v_cvt_pk_bf16_f32 v164, v168, v169
  v_cvt_pk_bf16_f32 v165, v170, v171
  v_cvt_pk_bf16_f32 v166, v172, v173
  v_cvt_pk_bf16_f32 v167, v174, v175
  v_cvt_pk_bf16_f32 v168, v176, v177
  v_cvt_pk_bf16_f32 v169, v178, v179
  v_cvt_pk_bf16_f32 v170, v180, v181
  v_cvt_pk_bf16_f32 v171, v182, v183
  v_and_b32 v22, 0x3f803f80, v30
  v_cvt_pk_bf16_f32 v172, v184, v185
  v_and_b32 v23, 0x3f803f80, v31
  v_cvt_pk_bf16_f32 v173, v186, v187
  v_and_b32 v28, 0x3f803f80, v30
  v_cvt_pk_bf16_f32 v174, v188, v189
  v_and_b32 v29, 0x3f803f80, v31
  v_cvt_pk_bf16_f32 v175, v190, v191
  v_mfma_f32_16x16x32_bf16 v[248:251], a[120:123], v[68:71], v[248:251]
  ds_read_b128 a[164:167], v5 offset:9216
  v_cvt_pk_bf16_f32 v192, v192, v193
  v_mfma_f32_16x16x32_bf16 v[252:255], a[124:127], v[68:71], v[252:255]
  buffer_store_dwordx4 v[88:91], v1, s[12:15], s48 offen sc1
  v_mfma_f32_16x16x32_bf16 v[144:147], v[128:131], v[22:25], 0
  v_cvt_pk_bf16_f32 v193, v194, v195
  v_cvt_pk_bf16_f32 v194, v196, v197
  v_mfma_f32_16x16x32_bf16 v[148:151], v[128:131], v[26:29], 0
  v_cvt_pk_bf16_f32 v195, v198, v199
  v_cvt_pk_bf16_f32 v196, v200, v201
  v_mfma_f32_16x16x32_bf16 v[152:155], v[132:135], v[22:25], 0
  v_cvt_pk_bf16_f32 v197, v202, v203
  v_cvt_pk_bf16_f32 v198, v204, v205
  v_mfma_f32_16x16x32_bf16 v[156:159], v[132:135], v[26:29], 0
  v_cvt_pk_bf16_f32 v199, v206, v207
  v_cvt_pk_bf16_f32 v200, v208, v209
  v_mfma_f32_16x16x32_bf16 v[176:179], v[136:139], v[22:25], 0
  v_cvt_pk_bf16_f32 v201, v210, v211
  v_cvt_pk_bf16_f32 v202, v212, v213
  v_mfma_f32_16x16x32_bf16 v[180:183], v[136:139], v[26:29], 0
  v_cvt_pk_bf16_f32 v203, v214, v215
  v_cvt_pk_bf16_f32 v204, v216, v217
  v_mfma_f32_16x16x32_bf16 v[184:187], v[140:143], v[22:25], 0
  v_cvt_pk_bf16_f32 v205, v218, v219
  v_cvt_pk_bf16_f32 v206, v220, v221
  v_mfma_f32_16x16x32_bf16 v[188:191], v[140:143], v[26:29], 0
  v_cvt_pk_bf16_f32 v207, v222, v223
  v_cvt_pk_bf16_f32 v224, v224, v225
  v_mfma_f32_16x16x32_bf16 v[32:35], v[160:163], v[22:25], 0
  v_cvt_pk_bf16_f32 v225, v226, v227
  v_cvt_pk_bf16_f32 v144, v144, v145
  v_mfma_f32_16x16x32_bf16 v[36:39], v[160:163], v[26:29], 0
  v_cvt_pk_bf16_f32 v226, v228, v229
  v_cvt_pk_bf16_f32 v145, v146, v147
  v_mfma_f32_16x16x32_bf16 v[40:43], v[164:167], v[22:25], 0
  v_cvt_pk_bf16_f32 v227, v230, v231
  v_cvt_pk_bf16_f32 v146, v148, v149
  v_mfma_f32_16x16x32_bf16 v[44:47], v[164:167], v[26:29], 0
  v_cvt_pk_bf16_f32 v228, v232, v233
  v_cvt_pk_bf16_f32 v147, v150, v151
  v_mfma_f32_16x16x32_bf16 v[48:51], v[168:171], v[22:25], 0
  v_cvt_pk_bf16_f32 v229, v234, v235
  v_cvt_pk_bf16_f32 v230, v236, v237
  v_mfma_f32_16x16x32_bf16 v[52:55], v[168:171], v[26:29], 0
  buffer_store_dwordx4 v[144:147], v1, s[12:15], s47 offen offset:0 sc1
  v_cvt_pk_bf16_f32 v231, v238, v239
  v_cvt_pk_bf16_f32 v232, v240, v241
  v_cvt_pk_bf16_f32 v233, v242, v243
  v_cvt_pk_bf16_f32 v234, v244, v245
  v_cvt_pk_bf16_f32 v235, v246, v247
  v_cvt_pk_bf16_f32 v236, v248, v249
  v_cvt_pk_bf16_f32 v237, v250, v251
  v_cvt_pk_bf16_f32 v238, v252, v253
  v_cvt_pk_bf16_f32 v239, v254, v255
  v_mfma_f32_16x16x32_bf16 v[56:59], v[172:175], v[22:25], 0
  v_cvt_pk_bf16_f32 v152, v152, v153
  v_cvt_pk_bf16_f32 v153, v154, v155
  v_mfma_f32_16x16x32_bf16 v[60:63], v[172:175], v[26:29], 0
  v_cvt_pk_bf16_f32 v154, v156, v157
  v_cvt_pk_bf16_f32 v155, v158, v159
  v_mfma_f32_16x16x32_bf16 v[208:211], v[192:195], v[22:25], 0
  buffer_store_dwordx4 v[152:155], v1, s[12:15], s47 offen offset:1024 sc1
  v_mfma_f32_16x16x32_bf16 v[212:215], v[192:195], v[26:29], 0
  v_cvt_pk_bf16_f32 v176, v176, v177
  v_cvt_pk_bf16_f32 v177, v178, v179
  v_mfma_f32_16x16x32_bf16 v[216:219], v[196:199], v[22:25], 0
  v_cvt_pk_bf16_f32 v178, v180, v181
  v_cvt_pk_bf16_f32 v179, v182, v183
  v_mfma_f32_16x16x32_bf16 v[220:223], v[196:199], v[26:29], 0
  buffer_store_dwordx4 v[176:179], v1, s[12:15], s47 offen offset:2048 sc1
  v_mfma_f32_16x16x32_bf16 v[240:243], v[200:203], v[22:25], 0
  v_cvt_pk_bf16_f32 v184, v184, v185
  v_cvt_pk_bf16_f32 v185, v186, v187
  v_mfma_f32_16x16x32_bf16 v[244:247], v[200:203], v[26:29], 0
  v_cvt_pk_bf16_f32 v186, v188, v189
  v_cvt_pk_bf16_f32 v187, v190, v191
  v_mfma_f32_16x16x32_bf16 v[248:251], v[204:207], v[22:25], 0
  buffer_store_dwordx4 v[184:187], v1, s[12:15], s47 offen offset:3072 sc1
  v_mfma_f32_16x16x32_bf16 v[252:255], v[204:207], v[26:29], 0
  s_add_u32 s47, s47, 4096
  v_cvt_pk_bf16_f32 v32, v32, v33
  v_mfma_f32_16x16x32_bf16 v[148:151], v[224:227], v[22:25], 0
  v_cvt_pk_bf16_f32 v33, v34, v35
  v_cvt_pk_bf16_f32 v34, v36, v37
  v_mfma_f32_16x16x32_bf16 v[156:159], v[224:227], v[26:29], 0
  v_cvt_pk_bf16_f32 v35, v38, v39
  v_mfma_f32_16x16x32_bf16 v[180:183], v[228:231], v[22:25], 0
  buffer_store_dwordx4 v[32:35], v1, s[12:15], s47 offen offset:0 sc1
  v_mfma_f32_16x16x32_bf16 v[188:191], v[228:231], v[26:29], 0
  v_cvt_pk_bf16_f32 v40, v40, v41
  v_cvt_pk_bf16_f32 v41, v42, v43
  v_cvt_pk_bf16_f32 v42, v44, v45
  v_cvt_pk_bf16_f32 v43, v46, v47
  v_mfma_f32_16x16x32_bf16 v[36:39], v[232:235], v[22:25], 0
  buffer_store_dwordx4 v[40:43], v1, s[12:15], s47 offen offset:1024 sc1
  v_cvt_pk_bf16_f32 v48, v48, v49
  v_cvt_pk_bf16_f32 v49, v50, v51
  v_cvt_pk_bf16_f32 v50, v52, v53
  v_cvt_pk_bf16_f32 v51, v54, v55
  v_mfma_f32_16x16x32_bf16 v[44:47], v[232:235], v[26:29], 0
  buffer_store_dwordx4 v[48:51], v1, s[12:15], s47 offen offset:2048 sc1
  v_cvt_pk_bf16_f32 v56, v56, v57
  v_cvt_pk_bf16_f32 v57, v58, v59
  v_cvt_pk_bf16_f32 v58, v60, v61
  v_cvt_pk_bf16_f32 v59, v62, v63
  v_mfma_f32_16x16x32_bf16 v[52:55], v[236:239], v[22:25], 0
  buffer_store_dwordx4 v[56:59], v1, s[12:15], s47 offen offset:3072 sc1
  v_mfma_f32_16x16x32_bf16 v[60:63], v[236:239], v[26:29], 0
  s_add_u32 s47, s47, 4096
  v_cvt_pk_bf16_f32 v208, v208, v209
  v_cvt_pk_bf16_f32 v209, v210, v211
  v_cvt_pk_bf16_f32 v210, v212, v213
  v_cvt_pk_bf16_f32 v211, v214, v215
  buffer_store_dwordx4 v[208:211], v1, s[12:15], s47 offen offset:0 sc1
  v_cvt_pk_bf16_f32 v216, v216, v217
  v_cvt_pk_bf16_f32 v217, v218, v219
  v_cvt_pk_bf16_f32 v218, v220, v221
  v_cvt_pk_bf16_f32 v219, v222, v223
  buffer_store_dwordx4 v[216:219], v1, s[12:15], s47 offen offset:1024 sc1
  v_cvt_pk_bf16_f32 v240, v240, v241
  v_cvt_pk_bf16_f32 v241, v242, v243
  v_cvt_pk_bf16_f32 v242, v244, v245
  v_cvt_pk_bf16_f32 v243, v246, v247
  buffer_store_dwordx4 v[240:243], v1, s[12:15], s47 offen offset:2048 sc1
  v_cvt_pk_bf16_f32 v248, v248, v249
  v_cvt_pk_bf16_f32 v249, v250, v251
  v_cvt_pk_bf16_f32 v250, v252, v253
  v_cvt_pk_bf16_f32 v251, v254, v255
  buffer_store_dwordx4 v[248:251], v1, s[12:15], s47 offen offset:3072 sc1
  s_add_u32 s47, s47, 4096
  v_cvt_pk_bf16_f32 v148, v148, v149
  v_cvt_pk_bf16_f32 v149, v150, v151
  v_cvt_pk_bf16_f32 v150, v156, v157
  v_cvt_pk_bf16_f32 v151, v158, v159
  buffer_store_dwordx4 v[148:151], v1, s[12:15], s47 offen offset:0 sc1
  v_cvt_pk_bf16_f32 v180, v180, v181
  v_cvt_pk_bf16_f32 v181, v182, v183
  v_cvt_pk_bf16_f32 v182, v188, v189
  v_cvt_pk_bf16_f32 v183, v190, v191
  buffer_store_dwordx4 v[180:183], v1, s[12:15], s47 offen offset:1024 sc1
  v_cvt_pk_bf16_f32 v36, v36, v37
  v_cvt_pk_bf16_f32 v37, v38, v39
  v_cvt_pk_bf16_f32 v38, v44, v45
  v_cvt_pk_bf16_f32 v39, v46, v47
  buffer_store_dwordx4 v[36:39], v1, s[12:15], s47 offen offset:2048 sc1
  v_cvt_pk_bf16_f32 v52, v52, v53
  v_cvt_pk_bf16_f32 v53, v54, v55
  v_cvt_pk_bf16_f32 v54, v60, v61
  v_cvt_pk_bf16_f32 v55, v62, v63
  buffer_store_dwordx4 v[52:55], v1, s[12:15], s47 offen offset:3072 sc1
  s_add_u32 s47, s47, 4096
L_kf_kernel_ffn_23:
  v_lshlrev_b32 v32, 16, v96
  v_and_b32 v33, 0xffff0000, v96
  v_lshlrev_b32 v34, 16, v97
  v_and_b32 v35, 0xffff0000, v97
  s_waitcnt lgkmcnt(9)
  s_nop 0
  v_mfma_f32_16x16x32_bf16 v[144:147], a[128:131], a[48:51], v[32:35]
  s_add_u32 s60, s79, 7168
  ds_read_b128 a[168:171], v5 offset:10240
  v_lshlrev_b32 v36, 16, v98
  s_waitcnt lgkmcnt(9)
  v_mfma_f32_16x16x32_bf16 v[144:147], a[132:135], a[52:55], v[144:147]
  buffer_load_dwordx4 v3, s[12:15], s66 offen offset:2048 sc1 lds
  s_waitcnt lgkmcnt(8)
  v_mfma_f32_16x16x32_bf16 v[144:147], a[136:139], a[56:59], v[144:147]
  ds_read_b128 a[172:175], v5 offset:11264
  v_and_b32 v37, 0xffff0000, v98
  s_waitcnt lgkmcnt(8)
  v_mfma_f32_16x16x32_bf16 v[144:147], a[140:143], a[60:63], v[144:147]
  s_waitcnt lgkmcnt(5)
  buffer_load_dwordx4 a[0:3], v1, s[12:15], s60 offen offset:1024 sc1
  v_mfma_f32_16x16x32_bf16 v[144:147], a[144:147], a[64:67], v[144:147]
  s_mul_i32 s73, s43, 4096
  ds_read_b128 a[176:179], v5 offset:12288
  v_lshlrev_b32 v38, 16, v99
  v_mfma_f32_16x16x32_bf16 v[144:147], a[148:151], a[68:71], v[144:147]
  s_mul_i32 s63, s50, 2637824
  buffer_load_dwordx4 a[4:7], v1, s[12:15], s60 offen offset:2048 sc1
  v_mfma_f32_16x16x32_bf16 v[144:147], a[152:155], a[72:75], v[144:147]
  s_add_u32 s73, s73, s63
  ds_read_b128 a[180:183], v5 offset:13312
  v_and_b32 v39, 0xffff0000, v99
  v_mfma_f32_16x16x32_bf16 v[148:151], a[128:131], a[80:83], v[32:35]
  v_mfma_f32_16x16x32_bf16 v[148:151], a[132:135], a[84:87], v[148:151]
  s_add_u32 s73, s73, 51445760
  ds_read_b128 a[184:187], v5 offset:14336
  v_mfma_f32_16x16x32_bf16 v[148:151], a[136:139], a[88:91], v[148:151]
  s_add_u32 s63, s44, 6291456
  buffer_load_dwordx4 v3, s[12:15], s66 offen offset:3072 sc1 lds
  v_mfma_f32_16x16x32_bf16 v[148:151], a[140:143], a[92:95], v[148:151]
  s_add_u32 m0, m0, 0x4000
  ds_read_b128 a[188:191], v5 offset:15360
  v_lshlrev_b32 v32, 16, v100
  v_mfma_f32_16x16x32_bf16 v[148:151], a[144:147], a[96:99], v[148:151]
  s_waitcnt lgkmcnt(7)
  buffer_load_dwordx4 a[8:11], v1, s[12:15], s60 offen offset:3072 sc1
  v_mfma_f32_16x16x32_bf16 v[148:151], a[148:151], a[100:103], v[148:151]
  s_add_u32 s60, s79, 11264
  ds_read_b128 a[128:131], v5 offset:16384
  v_and_b32 v33, 0xffff0000, v100
  v_mfma_f32_16x16x32_bf16 v[148:151], a[152:155], a[104:107], v[148:151]
  buffer_load_dwordx4 a[12:15], v1, s[12:15], s60 offen offset:0 sc1
  v_mfma_f32_16x16x32_bf16 v[152:155], a[156:159], a[48:51], v[36:39]
  ds_read_b128 a[132:135], v5 offset:17408
  v_lshlrev_b32 v34, 16, v101
  v_mfma_f32_16x16x32_bf16 v[152:155], a[160:163], a[52:55], v[152:155]
  s_waitcnt lgkmcnt(5)
  v_and_b32 v35, 0xffff0000, v101
  v_mov_b32 v88, 0x3e800000
  v_mfma_f32_16x16x32_bf16 v[152:155], a[164:167], a[56:59], v[152:155]
  ds_read_b128 a[136:139], v5 offset:18432
  v_mov_b32 v89, 0x3e800000
  v_mfma_f32_16x16x32_bf16 v[152:155], a[168:171], a[60:63], v[152:155]
  buffer_load_dwordx4 v4, s[12:15], s66 offen offset:0 sc1 lds
  v_mfma_f32_16x16x32_bf16 v[152:155], a[172:175], a[64:67], v[152:155]
  ds_read_b128 a[140:143], v5 offset:19456
  v_mfma_f32_16x16x32_bf16 v[152:155], a[176:179], a[68:71], v[152:155]
  s_waitcnt lgkmcnt(6)
  buffer_load_dwordx4 a[16:19], v1, s[12:15], s60 offen offset:1024 sc1
  v_mfma_f32_16x16x32_bf16 v[152:155], a[180:183], a[72:75], v[152:155]
  ds_read_b128 a[144:147], v5 offset:20480
  v_mfma_f32_16x16x32_bf16 v[156:159], a[156:159], a[80:83], v[36:39]
  buffer_load_dwordx4 a[20:23], v1, s[12:15], s60 offen offset:2048 sc1
  v_mfma_f32_16x16x32_bf16 v[156:159], a[160:163], a[84:87], v[156:159]
  ds_read_b128 a[148:151], v5 offset:21504
  v_mfma_f32_16x16x32_bf16 v[156:159], a[164:167], a[88:91], v[156:159]
  v_mfma_f32_16x16x32_bf16 v[156:159], a[168:171], a[92:95], v[156:159]
  ds_read_b128 a[152:155], v5 offset:22528
  v_lshlrev_b32 v36, 16, v102
  v_mfma_f32_16x16x32_bf16 v[156:159], a[172:175], a[96:99], v[156:159]
  s_add_u32 s60, s79, 64512
  buffer_load_dwordx4 v4, s[12:15], s66 offen offset:1024 sc1 lds
  v_mfma_f32_16x16x32_bf16 v[156:159], a[176:179], a[100:103], v[156:159]
  ds_read_b128 a[156:159], v5 offset:23552
  v_and_b32 v37, 0xffff0000, v102
  v_mfma_f32_16x16x32_bf16 v[156:159], a[180:183], a[104:107], v[156:159]
  s_waitcnt lgkmcnt(6)
  buffer_load_dwordx4 a[24:27], v1, s[12:15], s60 offen offset:1024 sc1
  v_mfma_f32_16x16x32_bf16 v[176:179], a[184:187], a[48:51], v[32:35]
  ds_read_b128 a[160:163], v5 offset:24576
  v_lshlrev_b32 v38, 16, v103
  v_mfma_f32_16x16x32_bf16 v[176:179], a[188:191], a[52:55], v[176:179]
  buffer_load_dwordx4 a[28:31], v1, s[12:15], s60 offen offset:2048 sc1
  v_mfma_f32_16x16x32_bf16 v[176:179], a[128:131], a[56:59], v[176:179]
  ds_read_b128 a[164:167], v5 offset:25600
  v_and_b32 v39, 0xffff0000, v103
  v_mfma_f32_16x16x32_bf16 v[176:179], a[132:135], a[60:63], v[176:179]
  s_waitcnt lgkmcnt(5)
  v_mfma_f32_16x16x32_bf16 v[176:179], a[136:139], a[64:67], v[176:179]
  ds_read_b128 a[168:171], v5 offset:26624
  v_mfma_f32_16x16x32_bf16 v[176:179], a[140:143], a[68:71], v[176:179]
  buffer_load_dwordx4 v4, s[12:15], s66 offen offset:2048 sc1 lds
  v_mfma_f32_16x16x32_bf16 v[176:179], a[144:147], a[72:75], v[176:179]
  ds_read_b128 a[172:175], v5 offset:27648
  v_mfma_f32_16x16x32_bf16 v[180:183], a[184:187], a[80:83], v[32:35]
  buffer_load_dwordx4 a[32:35], v1, s[12:15], s60 offen offset:3072 sc1
  v_mfma_f32_16x16x32_bf16 v[180:183], a[188:191], a[84:87], v[180:183]
  ds_read_b128 a[176:179], v5 offset:28672
  v_mfma_f32_16x16x32_bf16 v[180:183], a[128:131], a[88:91], v[180:183]
  v_mfma_f32_16x16x32_bf16 v[180:183], a[132:135], a[92:95], v[180:183]
  s_add_u32 s60, s79, 68608
  ds_read_b128 a[180:183], v5 offset:29696
  v_lshlrev_b32 v32, 16, v104
  v_mfma_f32_16x16x32_bf16 v[180:183], a[136:139], a[96:99], v[180:183]
  s_waitcnt lgkmcnt(7)
  buffer_load_dwordx4 a[36:39], v1, s[12:15], s60 offen offset:0 sc1
  v_mfma_f32_16x16x32_bf16 v[180:183], a[140:143], a[100:103], v[180:183]
  ds_read_b128 a[184:187], v5 offset:30720
  v_and_b32 v33, 0xffff0000, v104
  v_mfma_f32_16x16x32_bf16 v[180:183], a[144:147], a[104:107], v[180:183]
  buffer_load_dwordx4 v4, s[12:15], s66 offen offset:3072 sc1 lds
  v_mfma_f32_16x16x32_bf16 v[184:187], a[148:151], a[48:51], v[36:39]
  ds_read_b128 a[188:191], v5 offset:31744
  v_lshlrev_b32 v34, 16, v105
  v_mfma_f32_16x16x32_bf16 v[184:187], a[152:155], a[52:55], v[184:187]
  s_waitcnt lgkmcnt(5)
  buffer_load_dwordx4 a[40:43], v1, s[12:15], s60 offen offset:1024 sc1
  v_mfma_f32_16x16x32_bf16 v[184:187], a[156:159], a[56:59], v[184:187]
  s_add_u32 s66, s66, 0x8000
  v_and_b32 v35, 0xffff0000, v105
  v_mfma_f32_16x16x32_bf16 v[184:187], a[160:163], a[60:63], v[184:187]
  s_add_u32 m0, s67, s65
  v_mfma_f32_16x16x32_bf16 v[184:187], a[164:167], a[64:67], v[184:187]
  s_add_u32 s67, s67, 0x8000
  buffer_load_dwordx4 a[44:47], v1, s[12:15], s60 offen offset:2048 sc1
  v_mfma_f32_16x16x32_bf16 v[184:187], a[168:171], a[68:71], v[184:187]
  s_waitcnt lgkmcnt(4)
  s_and_b32 s67, s67, 0x1ffff
  v_add_u32 v5, s67, v1
  v_mfma_f32_16x16x32_bf16 v[184:187], a[172:175], a[72:75], v[184:187]
  s_waitcnt vmcnt(35) lgkmcnt(0)
  v_mfma_f32_16x16x32_bf16 v[188:191], a[148:151], a[80:83], v[36:39]
  s_barrier
  v_mfma_f32_16x16x32_bf16 v[188:191], a[152:155], a[84:87], v[188:191]
  ds_read_b128 a[128:131], v5 offset:0
  ds_read_b128 a[132:135], v5 offset:1024
  v_mfma_f32_16x16x32_bf16 v[188:191], a[156:159], a[88:91], v[188:191]
  buffer_load_dwordx4 v3, s[12:15], s66 offen offset:0 sc1 lds
  v_mfma_f32_16x16x32_bf16 v[188:191], a[160:163], a[92:95], v[188:191]
  ds_read_b128 a[136:139], v5 offset:2048
  ds_read_b128 a[140:143], v5 offset:3072
  v_mfma_f32_16x16x32_bf16 v[188:191], a[164:167], a[96:99], v[188:191]
  ds_read_b128 a[144:147], v5 offset:4096
  v_lshlrev_b32 v36, 16, v106
  v_mfma_f32_16x16x32_bf16 v[188:191], a[168:171], a[100:103], v[188:191]
  ds_read_b128 a[148:151], v5 offset:5120
  v_and_b32 v37, 0xffff0000, v106
  v_mfma_f32_16x16x32_bf16 v[188:191], a[172:175], a[104:107], v[188:191]
  v_lshlrev_b32 v38, 16, v107
  v_and_b32 v39, 0xffff0000, v107
  v_mfma_f32_16x16x32_bf16 v[208:211], a[176:179], a[48:51], v[32:35]
  ds_read_b128 a[152:155], v5 offset:6144
  v_mfma_f32_16x16x32_bf16 v[208:211], a[180:183], a[52:55], v[208:211]
  v_mfma_f32_16x16x32_bf16 v[208:211], a[184:187], a[56:59], v[208:211]
  ds_read_b128 a[156:159], v5 offset:7168
  v_mfma_f32_16x16x32_bf16 v[208:211], a[188:191], a[60:63], v[208:211]
  s_waitcnt lgkmcnt(5)
  buffer_load_dwordx4 v3, s[12:15], s66 offen offset:1024 sc1 lds
  v_mfma_f32_16x16x32_bf16 v[208:211], a[128:131], a[64:67], v[208:211]
  ds_read_b128 a[160:163], v5 offset:8192
  v_mfma_f32_16x16x32_bf16 v[208:211], a[132:135], a[68:71], v[208:211]
  v_mfma_f32_16x16x32_bf16 v[208:211], a[136:139], a[72:75], v[208:211]
  ds_read_b128 a[164:167], v5 offset:9216
  v_mfma_f32_16x16x32_bf16 v[212:215], a[176:179], a[80:83], v[32:35]
  v_mfma_f32_16x16x32_bf16 v[212:215], a[180:183], a[84:87], v[212:215]
  ds_read_b128 a[168:171], v5 offset:10240
  v_mfma_f32_16x16x32_bf16 v[212:215], a[184:187], a[88:91], v[212:215]
  v_mfma_f32_16x16x32_bf16 v[212:215], a[188:191], a[92:95], v[212:215]
  ds_read_b128 a[172:175], v5 offset:11264
  v_lshlrev_b32 v32, 16, v108
  v_mfma_f32_16x16x32_bf16 v[212:215], a[128:131], a[96:99], v[212:215]
  s_waitcnt lgkmcnt(7)
  buffer_load_dwordx4 v3, s[12:15], s66 offen offset:2048 sc1 lds
  v_mfma_f32_16x16x32_bf16 v[212:215], a[132:135], a[100:103], v[212:215]
  ds_read_b128 a[176:179], v5 offset:12288
  v_and_b32 v33, 0xffff0000, v108
  v_mfma_f32_16x16x32_bf16 v[212:215], a[136:139], a[104:107], v[212:215]
  v_lshlrev_b32 v34, 16, v109
  v_and_b32 v35, 0xffff0000, v109
  v_mfma_f32_16x16x32_bf16 v[216:219], a[140:143], a[48:51], v[36:39]
  s_nop 0
  s_waitcnt vmcnt(21)
  ds_read_b128 a[180:183], v5 offset:13312
  v_mfma_f32_16x16x32_bf16 v[216:219], a[144:147], a[52:55], v[216:219]
  s_waitcnt lgkmcnt(5)
  buffer_store_dword v11, v0, s[12:15], s46 offen offset:256 sc1
  v_mfma_f32_16x16x32_bf16 v[216:219], a[148:151], a[56:59], v[216:219]
  ds_read_b128 a[184:187], v5 offset:14336
  v_mfma_f32_16x16x32_bf16 v[216:219], a[152:155], a[60:63], v[216:219]
  buffer_store_dword v11, v14, s[12:15], s74 offen sc1
  v_mfma_f32_16x16x32_bf16 v[216:219], a[156:159], a[64:67], v[216:219]
  s_lshl_b32 s74, s50, 6
  ds_read_b128 a[188:191], v5 offset:15360
  v_mfma_f32_16x16x32_bf16 v[216:219], a[160:163], a[68:71], v[216:219]
  s_waitcnt lgkmcnt(6)
  buffer_load_dwordx4 v3, s[12:15], s66 offen offset:3072 sc1 lds
  v_mfma_f32_16x16x32_bf16 v[216:219], a[164:167], a[72:75], v[216:219]
  s_add_u32 m0, m0, 0x4000
  ds_read_b128 a[128:131], v5 offset:16384
  v_mfma_f32_16x16x32_bf16 v[220:223], a[140:143], a[80:83], v[36:39]
  s_add_u32 s74, s74, s64
  v_mfma_f32_16x16x32_bf16 v[220:223], a[144:147], a[84:87], v[220:223]
  s_lshl_b32 s74, s74, 5
  ds_read_b128 a[132:135], v5 offset:17408
  v_mfma_f32_16x16x32_bf16 v[220:223], a[148:151], a[88:91], v[220:223]
  v_mfma_f32_16x16x32_bf16 v[220:223], a[152:155], a[92:95], v[220:223]
  s_add_u32 s74, s74, s43
  ds_read_b128 a[136:139], v5 offset:18432
  v_lshlrev_b32 v36, 16, v110
  v_mfma_f32_16x16x32_bf16 v[220:223], a[156:159], a[96:99], v[220:223]
  s_lshl_b32 s74, s74, 2
  v_and_b32 v37, 0xffff0000, v110
  v_lshlrev_b32 v38, 16, v111
  v_mfma_f32_16x16x32_bf16 v[220:223], a[160:163], a[100:103], v[220:223]
  s_add_u32 s74, s74, 38666304
  ds_read_b128 a[140:143], v5 offset:19456
  v_and_b32 v39, 0xffff0000, v111
  v_mfma_f32_16x16x32_bf16 v[220:223], a[164:167], a[104:107], v[220:223]
  s_waitcnt lgkmcnt(6)
  buffer_load_dwordx4 v4, s[12:15], s66 offen offset:0 sc1 lds
  v_mfma_f32_16x16x32_bf16 v[240:243], a[168:171], a[48:51], v[32:35]
  ds_read_b128 a[144:147], v5 offset:20480
  v_mfma_f32_16x16x32_bf16 v[240:243], a[172:175], a[52:55], v[240:243]
  v_mfma_f32_16x16x32_bf16 v[240:243], a[176:179], a[56:59], v[240:243]
  ds_read_b128 a[148:151], v5 offset:21504
  v_mfma_f32_16x16x32_bf16 v[240:243], a[180:183], a[60:63], v[240:243]
  s_waitcnt lgkmcnt(5)
  v_mfma_f32_16x16x32_bf16 v[240:243], a[184:187], a[64:67], v[240:243]
  ds_read_b128 a[152:155], v5 offset:22528
  v_mfma_f32_16x16x32_bf16 v[240:243], a[188:191], a[68:71], v[240:243]
  v_mfma_f32_16x16x32_bf16 v[240:243], a[128:131], a[72:75], v[240:243]
  ds_read_b128 a[156:159], v5 offset:23552
  v_mfma_f32_16x16x32_bf16 v[244:247], a[168:171], a[80:83], v[32:35]
  buffer_load_dwordx4 v4, s[12:15], s66 offen offset:1024 sc1 lds
  v_mfma_f32_16x16x32_bf16 v[244:247], a[172:175], a[84:87], v[244:247]
  ds_read_b128 a[160:163], v5 offset:24576
  v_mfma_f32_16x16x32_bf16 v[244:247], a[176:179], a[88:91], v[244:247]
  v_mfma_f32_16x16x32_bf16 v[244:247], a[180:183], a[92:95], v[244:247]
  ds_read_b128 a[164:167], v5 offset:25600
  v_mfma_f32_16x16x32_bf16 v[244:247], a[184:187], a[96:99], v[244:247]
  s_waitcnt lgkmcnt(7)
  v_mfma_f32_16x16x32_bf16 v[244:247], a[188:191], a[100:103], v[244:247]
  ds_read_b128 a[168:171], v5 offset:26624
  v_mfma_f32_16x16x32_bf16 v[244:247], a[128:131], a[104:107], v[244:247]
  v_mfma_f32_16x16x32_bf16 v[248:251], a[132:135], a[48:51], v[36:39]
  ds_read_b128 a[172:175], v5 offset:27648
  v_mfma_f32_16x16x32_bf16 v[248:251], a[136:139], a[52:55], v[248:251]
  s_waitcnt lgkmcnt(5)
  buffer_load_dwordx4 v4, s[12:15], s66 offen offset:2048 sc1 lds
  v_mfma_f32_16x16x32_bf16 v[248:251], a[140:143], a[56:59], v[248:251]
  ds_read_b128 a[176:179], v5 offset:28672
  v_mfma_f32_16x16x32_bf16 v[248:251], a[144:147], a[60:63], v[248:251]
  v_mfma_f32_16x16x32_bf16 v[248:251], a[148:151], a[64:67], v[248:251]
  ds_read_b128 a[180:183], v5 offset:29696
  v_mfma_f32_16x16x32_bf16 v[248:251], a[152:155], a[68:71], v[248:251]
  s_waitcnt lgkmcnt(6)
  v_mfma_f32_16x16x32_bf16 v[248:251], a[156:159], a[72:75], v[248:251]
  ds_read_b128 a[184:187], v5 offset:30720
  v_mfma_f32_16x16x32_bf16 v[252:255], a[132:135], a[80:83], v[36:39]
  v_mfma_f32_16x16x32_bf16 v[252:255], a[136:139], a[84:87], v[252:255]
  ds_read_b128 a[188:191], v5 offset:31744
  v_mfma_f32_16x16x32_bf16 v[252:255], a[140:143], a[88:91], v[252:255]
  buffer_load_dwordx4 v4, s[12:15], s66 offen offset:3072 sc1 lds
  v_mfma_f32_16x16x32_bf16 v[252:255], a[144:147], a[92:95], v[252:255]
  s_add_u32 s66, s66, 0x8000
  v_mfma_f32_16x16x32_bf16 v[252:255], a[148:151], a[96:99], v[252:255]
  s_add_u32 m0, s67, s65
  v_mfma_f32_16x16x32_bf16 v[252:255], a[152:155], a[100:103], v[252:255]
  s_add_u32 s67, s67, 0x8000
  v_mfma_f32_16x16x32_bf16 v[252:255], a[156:159], a[104:107], v[252:255]
  s_waitcnt vmcnt(23) lgkmcnt(4)
  s_and_b32 s67, s67, 0x1ffff
  v_add_u32 v5, s67, v1
  v_mfma_f32_16x16x32_bf16 v[144:147], a[160:163], a[76:79], v[144:147]
  s_waitcnt lgkmcnt(0)
  v_mfma_f32_16x16x32_bf16 v[144:147], a[164:167], a[0:3], v[144:147]
  s_barrier
  v_mfma_f32_16x16x32_bf16 v[144:147], a[168:171], a[4:7], v[144:147]
  ds_read_b128 a[128:131], v5 offset:0
  ds_read_b128 a[132:135], v5 offset:1024
  v_mfma_f32_16x16x32_bf16 v[144:147], a[172:175], a[8:11], v[144:147]
  s_waitcnt vmcnt(19)
  buffer_load_dwordx4 v3, s[12:15], s66 offen offset:0 sc1 lds
  v_mfma_f32_16x16x32_bf16 v[144:147], a[176:179], a[12:15], v[144:147]
  ds_read_b128 a[136:139], v5 offset:2048
  ds_read_b128 a[140:143], v5 offset:3072
  v_mfma_f32_16x16x32_bf16 v[144:147], a[180:183], a[16:19], v[144:147]
  ds_read_b128 a[144:147], v5 offset:4096
  v_mfma_f32_16x16x32_bf16 v[144:147], a[184:187], a[20:23], v[144:147]
  ds_read_b128 a[148:151], v5 offset:5120
  v_mfma_f32_16x16x32_bf16 v[148:151], a[160:163], a[108:111], v[148:151]
  s_waitcnt vmcnt(14)
  v_mfma_f32_16x16x32_bf16 v[148:151], a[164:167], a[24:27], v[148:151]
  ds_read_b128 a[152:155], v5 offset:6144
  v_mfma_f32_16x16x32_bf16 v[148:151], a[168:171], a[28:31], v[148:151]
  buffer_load_dwordx2 v[112:113], v9, s[28:31], s3 offen offset:256
  v_mfma_f32_16x16x32_bf16 v[148:151], a[172:175], a[32:35], v[148:151]
  ds_read_b128 a[156:159], v5 offset:7168
  v_mul_f32 v144, v144, abs(v144)
  v_mfma_f32_16x16x32_bf16 v[148:151], a[176:179], a[36:39], v[148:151]
  s_waitcnt vmcnt(12) lgkmcnt(7)
  buffer_load_dwordx4 v3, s[12:15], s66 offen offset:1024 sc1 lds
  v_mfma_f32_16x16x32_bf16 v[148:151], a[180:183], a[40:43], v[148:151]
  ds_read_b128 a[160:163], v5 offset:8192
  v_mul_f32 v145, v145, abs(v145)
  v_mfma_f32_16x16x32_bf16 v[148:151], a[184:187], a[44:47], v[148:151]
  v_cvt_pk_bf16_f32 v144, v144, v145
  v_pk_max_i16 v128, v144, 0
  v_mfma_f32_16x16x32_bf16 v[152:155], a[188:191], a[76:79], v[152:155]
  ds_read_b128 a[164:167], v5 offset:9216
  v_mul_f32 v146, v146, abs(v146)
  v_mfma_f32_16x16x32_bf16 v[152:155], a[128:131], a[0:3], v[152:155]
  s_waitcnt lgkmcnt(5)
  v_mul_f32 v147, v147, abs(v147)
  v_cvt_pk_bf16_f32 v146, v146, v147
  v_mfma_f32_16x16x32_bf16 v[152:155], a[132:135], a[4:7], v[152:155]
  ds_read_b128 a[168:171], v5 offset:10240
  v_pk_max_i16 v129, v146, 0
  v_mfma_f32_16x16x32_bf16 v[152:155], a[136:139], a[8:11], v[152:155]
  buffer_load_dwordx2 v[114:115], v9, s[28:31], s3 offen offset:288
  v_mfma_f32_16x16x32_bf16 v[152:155], a[140:143], a[12:15], v[152:155]
  ds_read_b128 a[172:175], v5 offset:11264
  v_mul_f32 v148, v148, abs(v148)
  v_mfma_f32_16x16x32_bf16 v[152:155], a[144:147], a[16:19], v[152:155]
  s_waitcnt lgkmcnt(6)
  buffer_load_dwordx4 v3, s[12:15], s66 offen offset:2048 sc1 lds
  v_mfma_f32_16x16x32_bf16 v[152:155], a[148:151], a[20:23], v[152:155]
  ds_read_b128 a[176:179], v5 offset:12288
  v_mul_f32 v149, v149, abs(v149)
  v_mfma_f32_16x16x32_bf16 v[156:159], a[188:191], a[108:111], v[156:159]
  v_cvt_pk_bf16_f32 v148, v148, v149
  v_pk_max_i16 v192, v148, 0
  v_mfma_f32_16x16x32_bf16 v[156:159], a[128:131], a[24:27], v[156:159]
  ds_read_b128 a[180:183], v5 offset:13312
  v_mul_f32 v150, v150, abs(v150)
  v_mfma_f32_16x16x32_bf16 v[156:159], a[132:135], a[28:31], v[156:159]
  v_mul_f32 v151, v151, abs(v151)
  v_cvt_pk_bf16_f32 v150, v150, v151
  v_mfma_f32_16x16x32_bf16 v[156:159], a[136:139], a[32:35], v[156:159]
  ds_read_b128 a[184:187], v5 offset:14336
  v_pk_max_i16 v193, v150, 0
  v_mfma_f32_16x16x32_bf16 v[156:159], a[140:143], a[36:39], v[156:159]
  buffer_load_dwordx2 v[116:117], v9, s[28:31], s3 offen offset:320
  v_mfma_f32_16x16x32_bf16 v[156:159], a[144:147], a[40:43], v[156:159]
  ds_read_b128 a[188:191], v5 offset:15360
  v_mul_f32 v152, v152, abs(v152)
  v_mfma_f32_16x16x32_bf16 v[156:159], a[148:151], a[44:47], v[156:159]
  s_waitcnt lgkmcnt(6)
  buffer_load_dwordx4 v3, s[12:15], s66 offen offset:3072 sc1 lds
  v_mfma_f32_16x16x32_bf16 v[176:179], a[152:155], a[76:79], v[176:179]
  s_add_u32 m0, m0, 0x4000
  ds_read_b128 a[128:131], v5 offset:16384
  v_mul_f32 v153, v153, abs(v153)
  v_mfma_f32_16x16x32_bf16 v[176:179], a[156:159], a[0:3], v[176:179]
  v_cvt_pk_bf16_f32 v152, v152, v153
  v_pk_max_i16 v130, v152, 0
  v_mfma_f32_16x16x32_bf16 v[176:179], a[160:163], a[4:7], v[176:179]
  ds_read_b128 a[132:135], v5 offset:17408
  v_mul_f32 v154, v154, abs(v154)
  v_mfma_f32_16x16x32_bf16 v[176:179], a[164:167], a[8:11], v[176:179]
  s_waitcnt lgkmcnt(5)
  v_mul_f32 v155, v155, abs(v155)
  v_cvt_pk_bf16_f32 v154, v154, v155
  v_mfma_f32_16x16x32_bf16 v[176:179], a[168:171], a[12:15], v[176:179]
  ds_read_b128 a[136:139], v5 offset:18432
  v_pk_max_i16 v131, v154, 0
  v_mfma_f32_16x16x32_bf16 v[176:179], a[172:175], a[16:19], v[176:179]
  v_mul_f32 v156, v156, abs(v156)
  v_mul_f32 v157, v157, abs(v157)
  v_mfma_f32_16x16x32_bf16 v[176:179], a[176:179], a[20:23], v[176:179]
  ds_read_b128 a[140:143], v5 offset:19456
  v_cvt_pk_bf16_f32 v156, v156, v157
  v_mfma_f32_16x16x32_bf16 v[180:183], a[152:155], a[108:111], v[180:183]
  buffer_load_dwordx4 v4, s[12:15], s66 offen offset:0 sc1 lds
  v_mfma_f32_16x16x32_bf16 v[180:183], a[156:159], a[24:27], v[180:183]
  ds_read_b128 a[144:147], v5 offset:20480
  v_pk_max_i16 v194, v156, 0
  v_mfma_f32_16x16x32_bf16 v[180:183], a[160:163], a[28:31], v[180:183]
  buffer_load_dwordx2 v[118:119], v9, s[28:31], s3 offen offset:352
  v_mfma_f32_16x16x32_bf16 v[180:183], a[164:167], a[32:35], v[180:183]
  ds_read_b128 a[148:151], v5 offset:21504
  v_mul_f32 v158, v158, abs(v158)
  v_mfma_f32_16x16x32_bf16 v[180:183], a[168:171], a[36:39], v[180:183]
  s_waitcnt lgkmcnt(7)
  v_mul_f32 v159, v159, abs(v159)
  v_cvt_pk_bf16_f32 v158, v158, v159
  v_mfma_f32_16x16x32_bf16 v[180:183], a[172:175], a[40:43], v[180:183]
  ds_read_b128 a[152:155], v5 offset:22528
  v_pk_max_i16 v195, v158, 0
  v_mfma_f32_16x16x32_bf16 v[180:183], a[176:179], a[44:47], v[180:183]
  v_mul_f32 v176, v176, abs(v176)
  v_mul_f32 v177, v177, abs(v177)
  v_mfma_f32_16x16x32_bf16 v[184:187], a[180:183], a[76:79], v[184:187]
  ds_read_b128 a[156:159], v5 offset:23552
  v_cvt_pk_bf16_f32 v176, v176, v177
  v_mfma_f32_16x16x32_bf16 v[184:187], a[184:187], a[0:3], v[184:187]
  s_waitcnt lgkmcnt(5)
  buffer_load_dwordx4 v4, s[12:15], s66 offen offset:1024 sc1 lds
  v_mfma_f32_16x16x32_bf16 v[184:187], a[188:191], a[4:7], v[184:187]
  ds_read_b128 a[160:163], v5 offset:24576
  v_pk_max_i16 v132, v176, 0
  v_mfma_f32_16x16x32_bf16 v[184:187], a[128:131], a[8:11], v[184:187]
  buffer_load_dwordx2 v[120:121], v9, s[28:31], s3 offen offset:384
  v_mfma_f32_16x16x32_bf16 v[184:187], a[132:135], a[12:15], v[184:187]
  ds_read_b128 a[164:167], v5 offset:25600
  v_mul_f32 v178, v178, abs(v178)
  v_mfma_f32_16x16x32_bf16 v[184:187], a[136:139], a[16:19], v[184:187]
  s_waitcnt lgkmcnt(6)
  v_mul_f32 v179, v179, abs(v179)
  v_cvt_pk_bf16_f32 v178, v178, v179
  v_mfma_f32_16x16x32_bf16 v[184:187], a[140:143], a[20:23], v[184:187]
  ds_read_b128 a[168:171], v5 offset:26624
  v_pk_max_i16 v133, v178, 0
  v_mfma_f32_16x16x32_bf16 v[188:191], a[180:183], a[108:111], v[188:191]
  v_mul_f32 v180, v180, abs(v180)
  v_mul_f32 v181, v181, abs(v181)
  v_mfma_f32_16x16x32_bf16 v[188:191], a[184:187], a[24:27], v[188:191]
  ds_read_b128 a[172:175], v5 offset:27648
  v_cvt_pk_bf16_f32 v180, v180, v181
  v_mfma_f32_16x16x32_bf16 v[188:191], a[188:191], a[28:31], v[188:191]
  buffer_load_dwordx4 v4, s[12:15], s66 offen offset:2048 sc1 lds
  v_mfma_f32_16x16x32_bf16 v[188:191], a[128:131], a[32:35], v[188:191]
  ds_read_b128 a[176:179], v5 offset:28672
  v_pk_max_i16 v196, v180, 0
  v_mfma_f32_16x16x32_bf16 v[188:191], a[132:135], a[36:39], v[188:191]
  buffer_load_dwordx2 v[122:123], v9, s[28:31], s3 offen offset:416
  v_mfma_f32_16x16x32_bf16 v[188:191], a[136:139], a[40:43], v[188:191]
  ds_read_b128 a[180:183], v5 offset:29696
  v_mul_f32 v182, v182, abs(v182)
  v_mfma_f32_16x16x32_bf16 v[188:191], a[140:143], a[44:47], v[188:191]
  s_waitcnt lgkmcnt(6)
  v_mul_f32 v183, v183, abs(v183)
  v_cvt_pk_bf16_f32 v182, v182, v183
  v_mfma_f32_16x16x32_bf16 v[208:211], a[144:147], a[76:79], v[208:211]
  ds_read_b128 a[184:187], v5 offset:30720
  v_pk_max_i16 v197, v182, 0
  v_mfma_f32_16x16x32_bf16 v[208:211], a[148:151], a[0:3], v[208:211]
  v_mul_f32 v184, v184, abs(v184)
  v_mul_f32 v185, v185, abs(v185)
  v_mfma_f32_16x16x32_bf16 v[208:211], a[152:155], a[4:7], v[208:211]
  ds_read_b128 a[188:191], v5 offset:31744
  v_cvt_pk_bf16_f32 v184, v184, v185
  v_mfma_f32_16x16x32_bf16 v[208:211], a[156:159], a[8:11], v[208:211]
  s_waitcnt lgkmcnt(5)
  buffer_load_dwordx4 v4, s[12:15], s66 offen offset:3072 sc1 lds
  v_mfma_f32_16x16x32_bf16 v[208:211], a[160:163], a[12:15], v[208:211]
  s_add_u32 s66, s66, 0x8000
  v_pk_max_i16 v134, v184, 0
  v_mul_f32 v186, v186, abs(v186)
  v_mfma_f32_16x16x32_bf16 v[208:211], a[164:167], a[16:19], v[208:211]
  s_add_u32 m0, s67, s65
  buffer_load_dwordx2 v[124:125], v9, s[28:31], s3 offen offset:448
  v_mfma_f32_16x16x32_bf16 v[208:211], a[168:171], a[20:23], v[208:211]
  s_add_u32 s67, s67, 0x8000
  v_mul_f32 v187, v187, abs(v187)
  v_cvt_pk_bf16_f32 v186, v186, v187
  v_mfma_f32_16x16x32_bf16 v[212:215], a[144:147], a[108:111], v[212:215]
  s_and_b32 s67, s67, 0x1ffff
  v_add_u32 v5, s67, v1
  v_mfma_f32_16x16x32_bf16 v[212:215], a[148:151], a[24:27], v[212:215]
  s_waitcnt lgkmcnt(0)
  v_pk_max_i16 v135, v186, 0
  v_mul_f32 v188, v188, abs(v188)
  v_mfma_f32_16x16x32_bf16 v[212:215], a[152:155], a[28:31], v[212:215]
  s_barrier
  v_mul_f32 v189, v189, abs(v189)
  v_cvt_pk_bf16_f32 v188, v188, v189
  v_mfma_f32_16x16x32_bf16 v[212:215], a[156:159], a[32:35], v[212:215]
  ds_read_b128 a[128:131], v5 offset:0
  ds_read_b128 a[132:135], v5 offset:1024
  v_mfma_f32_16x16x32_bf16 v[212:215], a[160:163], a[36:39], v[212:215]
  buffer_load_dwordx4 v3, s[12:15], s66 offen offset:0 sc1 lds
  v_mfma_f32_16x16x32_bf16 v[212:215], a[164:167], a[40:43], v[212:215]
  ds_read_b128 a[136:139], v5 offset:2048
  ds_read_b128 a[140:143], v5 offset:3072
  v_mfma_f32_16x16x32_bf16 v[212:215], a[168:171], a[44:47], v[212:215]
  ds_read_b128 a[144:147], v5 offset:4096
  v_pk_max_i16 v198, v188, 0
  v_mfma_f32_16x16x32_bf16 v[216:219], a[172:175], a[76:79], v[216:219]
  ds_read_b128 a[148:151], v5 offset:5120
  v_mul_f32 v190, v190, abs(v190)
  v_mfma_f32_16x16x32_bf16 v[216:219], a[176:179], a[0:3], v[216:219]
  s_waitcnt lgkmcnt(5)
  buffer_load_dwordx2 v[126:127], v9, s[28:31], s3 offen offset:480
  v_mfma_f32_16x16x32_bf16 v[216:219], a[180:183], a[4:7], v[216:219]
  ds_read_b128 a[152:155], v5 offset:6144
  v_mul_f32 v191, v191, abs(v191)
  v_mfma_f32_16x16x32_bf16 v[216:219], a[184:187], a[8:11], v[216:219]
  v_cvt_pk_bf16_f32 v190, v190, v191
  v_pk_max_i16 v199, v190, 0
  v_mfma_f32_16x16x32_bf16 v[216:219], a[188:191], a[12:15], v[216:219]
  ds_read_b128 a[156:159], v5 offset:7168
  v_mul_f32 v208, v208, abs(v208)
  v_mfma_f32_16x16x32_bf16 v[216:219], a[128:131], a[16:19], v[216:219]
  s_waitcnt lgkmcnt(6)
  buffer_load_dwordx4 v3, s[12:15], s66 offen offset:1024 sc1 lds
  v_mfma_f32_16x16x32_bf16 v[216:219], a[132:135], a[20:23], v[216:219]
  ds_read_b128 a[160:163], v5 offset:8192
  v_mul_f32 v209, v209, abs(v209)
  v_mfma_f32_16x16x32_bf16 v[220:223], a[172:175], a[108:111], v[220:223]
  v_cvt_pk_bf16_f32 v208, v208, v209
  v_pk_max_i16 v136, v208, 0
  v_mfma_f32_16x16x32_bf16 v[220:223], a[176:179], a[24:27], v[220:223]
  ds_read_b128 a[164:167], v5 offset:9216
  v_mul_f32 v210, v210, abs(v210)
  v_mfma_f32_16x16x32_bf16 v[220:223], a[180:183], a[28:31], v[220:223]
  v_mul_f32 v211, v211, abs(v211)
  v_cvt_pk_bf16_f32 v210, v210, v211
  v_mfma_f32_16x16x32_bf16 v[220:223], a[184:187], a[32:35], v[220:223]
  ds_read_b128 a[168:171], v5 offset:10240
  v_pk_max_i16 v137, v210, 0
  v_mfma_f32_16x16x32_bf16 v[220:223], a[188:191], a[36:39], v[220:223]
  v_mul_f32 v212, v212, abs(v212)
  v_mul_f32 v213, v213, abs(v213)
  v_mfma_f32_16x16x32_bf16 v[220:223], a[128:131], a[40:43], v[220:223]
  ds_read_b128 a[172:175], v5 offset:11264
  v_cvt_pk_bf16_f32 v212, v212, v213
  v_mfma_f32_16x16x32_bf16 v[220:223], a[132:135], a[44:47], v[220:223]
  s_waitcnt lgkmcnt(6)
  buffer_load_dwordx4 v3, s[12:15], s66 offen offset:2048 sc1 lds
  v_mfma_f32_16x16x32_bf16 v[240:243], a[136:139], a[76:79], v[240:243]
  ds_read_b128 a[176:179], v5 offset:12288
  v_pk_max_i16 v200, v212, 0
  v_mfma_f32_16x16x32_bf16 v[240:243], a[140:143], a[0:3], v[240:243]
  v_mul_f32 v214, v214, abs(v214)
  v_mul_f32 v215, v215, abs(v215)
  v_mfma_f32_16x16x32_bf16 v[240:243], a[144:147], a[4:7], v[240:243]
  ds_read_b128 a[180:183], v5 offset:13312
  v_cvt_pk_bf16_f32 v214, v214, v215
  v_mfma_f32_16x16x32_bf16 v[240:243], a[148:151], a[8:11], v[240:243]
  s_waitcnt lgkmcnt(5)
  v_pk_max_i16 v201, v214, 0
  v_mul_f32 v216, v216, abs(v216)
  v_mfma_f32_16x16x32_bf16 v[240:243], a[152:155], a[12:15], v[240:243]
  ds_read_b128 a[184:187], v5 offset:14336
  v_mul_f32 v217, v217, abs(v217)
  v_mfma_f32_16x16x32_bf16 v[240:243], a[156:159], a[16:19], v[240:243]
  v_cvt_pk_bf16_f32 v216, v216, v217
  v_pk_max_i16 v138, v216, 0
  v_mfma_f32_16x16x32_bf16 v[240:243], a[160:163], a[20:23], v[240:243]
  ds_read_b128 a[188:191], v5 offset:15360
  v_mul_f32 v218, v218, abs(v218)
  v_mfma_f32_16x16x32_bf16 v[244:247], a[136:139], a[108:111], v[244:247]
  buffer_load_dwordx4 v3, s[12:15], s66 offen offset:3072 sc1 lds
  v_mfma_f32_16x16x32_bf16 v[244:247], a[140:143], a[24:27], v[244:247]
  s_add_u32 m0, m0, 0x4000
  ds_read_b128 a[128:131], v5 offset:16384
  v_mul_f32 v219, v219, abs(v219)
  v_mfma_f32_16x16x32_bf16 v[244:247], a[144:147], a[28:31], v[244:247]
  v_cvt_pk_bf16_f32 v218, v218, v219
  v_pk_max_i16 v139, v218, 0
  v_mfma_f32_16x16x32_bf16 v[244:247], a[148:151], a[32:35], v[244:247]
  ds_read_b128 a[132:135], v5 offset:17408
  s_waitcnt vmcnt(18)
  v_lshlrev_b32 v32, 16, v112
  v_mfma_f32_16x16x32_bf16 v[244:247], a[152:155], a[36:39], v[244:247]
  s_waitcnt lgkmcnt(7)
  v_and_b32 v33, 0xffff0000, v112
  v_lshlrev_b32 v34, 16, v113
  v_mfma_f32_16x16x32_bf16 v[244:247], a[156:159], a[40:43], v[244:247]
  ds_read_b128 a[136:139], v5 offset:18432
  v_and_b32 v35, 0xffff0000, v113
  v_mfma_f32_16x16x32_bf16 v[244:247], a[160:163], a[44:47], v[244:247]
  v_mul_f32 v220, v220, abs(v220)
  v_mul_f32 v221, v221, abs(v221)
  v_mfma_f32_16x16x32_bf16 v[248:251], a[164:167], a[76:79], v[248:251]
  ds_read_b128 a[140:143], v5 offset:19456
  v_cvt_pk_bf16_f32 v220, v220, v221
  v_mfma_f32_16x16x32_bf16 v[248:251], a[168:171], a[0:3], v[248:251]
  s_waitcnt lgkmcnt(5)
  buffer_load_dwordx4 v4, s[12:15], s66 offen offset:0 sc1 lds
  v_mfma_f32_16x16x32_bf16 v[248:251], a[172:175], a[4:7], v[248:251]
  ds_read_b128 a[144:147], v5 offset:20480
  v_pk_max_i16 v202, v220, 0
  v_mfma_f32_16x16x32_bf16 v[248:251], a[176:179], a[8:11], v[248:251]
  v_mul_f32 v222, v222, abs(v222)
  v_mul_f32 v223, v223, abs(v223)
  v_mfma_f32_16x16x32_bf16 v[248:251], a[180:183], a[12:15], v[248:251]
  ds_read_b128 a[148:151], v5 offset:21504
  v_cvt_pk_bf16_f32 v222, v222, v223
  v_mfma_f32_16x16x32_bf16 v[248:251], a[184:187], a[16:19], v[248:251]
  s_waitcnt lgkmcnt(6)
  v_pk_max_i16 v203, v222, 0
  v_mul_f32 v240, v240, abs(v240)
  v_mfma_f32_16x16x32_bf16 v[248:251], a[188:191], a[20:23], v[248:251]
  ds_read_b128 a[152:155], v5 offset:22528
  v_mul_f32 v241, v241, abs(v241)
  v_mfma_f32_16x16x32_bf16 v[252:255], a[164:167], a[108:111], v[252:255]
  v_cvt_pk_bf16_f32 v240, v240, v241
  v_pk_max_i16 v140, v240, 0
  v_mfma_f32_16x16x32_bf16 v[252:255], a[168:171], a[24:27], v[252:255]
  ds_read_b128 a[156:159], v5 offset:23552
  v_mul_f32 v242, v242, abs(v242)
  v_mfma_f32_16x16x32_bf16 v[252:255], a[172:175], a[28:31], v[252:255]
  buffer_load_dwordx4 v4, s[12:15], s66 offen offset:1024 sc1 lds
  v_mfma_f32_16x16x32_bf16 v[252:255], a[176:179], a[32:35], v[252:255]
  ds_read_b128 a[160:163], v5 offset:24576
  s_waitcnt vmcnt(18)
  v_lshlrev_b32 v36, 16, v114
  v_mfma_f32_16x16x32_bf16 v[252:255], a[180:183], a[36:39], v[252:255]
  v_and_b32 v37, 0xffff0000, v114
  v_lshlrev_b32 v38, 16, v115
  v_mfma_f32_16x16x32_bf16 v[252:255], a[184:187], a[40:43], v[252:255]
  ds_read_b128 a[164:167], v5 offset:25600
  v_and_b32 v39, 0xffff0000, v115
  v_mfma_f32_16x16x32_bf16 v[252:255], a[188:191], a[44:47], v[252:255]
  s_waitcnt lgkmcnt(6)
  v_mul_f32 v243, v243, abs(v243)
  v_cvt_pk_bf16_f32 v242, v242, v243
  v_mfma_f32_16x16x32_bf16 v[144:147], a[128:131], a[48:51], v[32:35]
  ds_read_b128 a[168:171], v5 offset:26624
  v_pk_max_i16 v141, v242, 0
  v_mfma_f32_16x16x32_bf16 v[144:147], a[132:135], a[52:55], v[144:147]
  v_mul_f32 v244, v244, abs(v244)
  v_mul_f32 v245, v245, abs(v245)
  v_mfma_f32_16x16x32_bf16 v[144:147], a[136:139], a[56:59], v[144:147]
  ds_read_b128 a[172:175], v5 offset:27648
  v_cvt_pk_bf16_f32 v244, v244, v245
  v_mfma_f32_16x16x32_bf16 v[144:147], a[140:143], a[60:63], v[144:147]
  s_waitcnt lgkmcnt(5)
  buffer_load_dwordx4 v4, s[12:15], s66 offen offset:2048 sc1 lds
  v_mfma_f32_16x16x32_bf16 v[144:147], a[144:147], a[64:67], v[144:147]
  ds_read_b128 a[176:179], v5 offset:28672
  v_pk_max_i16 v204, v244, 0
  v_mfma_f32_16x16x32_bf16 v[144:147], a[148:151], a[68:71], v[144:147]
  v_mul_f32 v246, v246, abs(v246)
  v_mul_f32 v247, v247, abs(v247)
  v_mfma_f32_16x16x32_bf16 v[144:147], a[152:155], a[72:75], v[144:147]
  ds_read_b128 a[180:183], v5 offset:29696
  v_cvt_pk_bf16_f32 v246, v246, v247
  v_mfma_f32_16x16x32_bf16 v[148:151], a[128:131], a[80:83], v[32:35]
  v_pk_max_i16 v205, v246, 0
  v_mul_f32 v248, v248, abs(v248)
  v_mfma_f32_16x16x32_bf16 v[148:151], a[132:135], a[84:87], v[148:151]
  ds_read_b128 a[184:187], v5 offset:30720
  v_mul_f32 v249, v249, abs(v249)
  v_mfma_f32_16x16x32_bf16 v[148:151], a[136:139], a[88:91], v[148:151]
  v_cvt_pk_bf16_f32 v248, v248, v249
  v_pk_max_i16 v142, v248, 0
  v_mfma_f32_16x16x32_bf16 v[148:151], a[140:143], a[92:95], v[148:151]
  ds_read_b128 a[188:191], v5 offset:31744
  s_waitcnt vmcnt(17)
  v_lshlrev_b32 v32, 16, v116
  v_mfma_f32_16x16x32_bf16 v[148:151], a[144:147], a[96:99], v[148:151]
  s_waitcnt lgkmcnt(7)
  buffer_load_dwordx4 v4, s[12:15], s66 offen offset:3072 sc1 lds
  v_mfma_f32_16x16x32_bf16 v[148:151], a[148:151], a[100:103], v[148:151]
  s_mov_b32 s66, s63
  v_and_b32 v33, 0xffff0000, v116
  v_lshlrev_b32 v34, 16, v117
  v_mfma_f32_16x16x32_bf16 v[148:151], a[152:155], a[104:107], v[148:151]
  s_add_u32 m0, s67, s65
  v_and_b32 v35, 0xffff0000, v117
  v_mul_f32 v250, v250, abs(v250)
  v_mfma_f32_16x16x32_bf16 v[152:155], a[156:159], a[48:51], v[36:39]
  s_add_u32 s67, s67, 0x8000
  v_mul_f32 v251, v251, abs(v251)
  v_cvt_pk_bf16_f32 v250, v250, v251
  v_mfma_f32_16x16x32_bf16 v[152:155], a[160:163], a[52:55], v[152:155]
  s_waitcnt lgkmcnt(3)
  s_and_b32 s67, s67, 0x1ffff
  v_add_u32 v5, s67, v1
  v_mfma_f32_16x16x32_bf16 v[152:155], a[164:167], a[56:59], v[152:155]
  s_waitcnt lgkmcnt(0)
  v_pk_max_i16 v143, v250, 0
  v_mul_f32 v252, v252, abs(v252)
  v_mfma_f32_16x16x32_bf16 v[152:155], a[168:171], a[60:63], v[152:155]
  s_barrier
  v_mul_f32 v253, v253, abs(v253)
  v_cvt_pk_bf16_f32 v252, v252, v253
  v_mfma_f32_16x16x32_bf16 v[152:155], a[172:175], a[64:67], v[152:155]
  ds_read_b128 a[128:131], v5 offset:0
  ds_read_b128 a[132:135], v5 offset:1024
  v_mfma_f32_16x16x32_bf16 v[152:155], a[176:179], a[68:71], v[152:155]
  buffer_load_dwordx4 v3, s[12:15], s66 offen offset:0 sc1 lds
  v_mfma_f32_16x16x32_bf16 v[152:155], a[180:183], a[72:75], v[152:155]
  ds_read_b128 a[136:139], v5 offset:2048
  ds_read_b128 a[140:143], v5 offset:3072
  v_mfma_f32_16x16x32_bf16 v[156:159], a[156:159], a[80:83], v[36:39]
  ds_read_b128 a[144:147], v5 offset:4096
  v_pk_max_i16 v206, v252, 0
  v_mfma_f32_16x16x32_bf16 v[156:159], a[160:163], a[84:87], v[156:159]
  ds_read_b128 a[148:151], v5 offset:5120
  v_mul_f32 v254, v254, abs(v254)
  v_mfma_f32_16x16x32_bf16 v[156:159], a[164:167], a[88:91], v[156:159]
  v_mul_f32 v255, v255, abs(v255)
  v_cvt_pk_bf16_f32 v254, v254, v255
  v_mfma_f32_16x16x32_bf16 v[156:159], a[168:171], a[92:95], v[156:159]
  ds_read_b128 a[152:155], v5 offset:6144
  s_waitcnt vmcnt(16)
  v_lshlrev_b32 v36, 16, v118
  v_mfma_f32_16x16x32_bf16 v[156:159], a[172:175], a[96:99], v[156:159]
  v_and_b32 v37, 0xffff0000, v118
  v_lshlrev_b32 v38, 16, v119
  v_mfma_f32_16x16x32_bf16 v[156:159], a[176:179], a[100:103], v[156:159]
  ds_read_b128 a[156:159], v5 offset:7168
  v_and_b32 v39, 0xffff0000, v119
  v_mfma_f32_16x16x32_bf16 v[156:159], a[180:183], a[104:107], v[156:159]
  s_waitcnt lgkmcnt(6)
  buffer_load_dwordx4 v3, s[12:15], s66 offen offset:1024 sc1 lds
  v_mfma_f32_16x16x32_bf16 v[176:179], a[184:187], a[48:51], v[32:35]
  ds_read_b128 a[160:163], v5 offset:8192
  v_pk_max_i16 v207, v254, 0
  v_mfma_f32_16x16x32_bf16 v[176:179], a[188:191], a[52:55], v[176:179]
  v_mfma_f32_16x16x32_bf16 v[176:179], a[128:131], a[56:59], v[176:179]
  ds_read_b128 a[164:167], v5 offset:9216
  v_mfma_f32_16x16x32_bf16 v[176:179], a[132:135], a[60:63], v[176:179]
  s_waitcnt lgkmcnt(5)
  v_mfma_f32_16x16x32_bf16 v[176:179], a[136:139], a[64:67], v[176:179]
  ds_read_b128 a[168:171], v5 offset:10240
  v_mfma_f32_16x16x32_bf16 v[176:179], a[140:143], a[68:71], v[176:179]
  v_mfma_f32_16x16x32_bf16 v[176:179], a[144:147], a[72:75], v[176:179]
  ds_read_b128 a[172:175], v5 offset:11264
  v_mfma_f32_16x16x32_bf16 v[180:183], a[184:187], a[80:83], v[32:35]
  buffer_load_dwordx4 v3, s[12:15], s66 offen offset:2048 sc1 lds
  v_mfma_f32_16x16x32_bf16 v[180:183], a[188:191], a[84:87], v[180:183]
  ds_read_b128 a[176:179], v5 offset:12288
  v_mfma_f32_16x16x32_bf16 v[180:183], a[128:131], a[88:91], v[180:183]
  v_mfma_f32_16x16x32_bf16 v[180:183], a[132:135], a[92:95], v[180:183]
  ds_read_b128 a[180:183], v5 offset:13312
  s_waitcnt vmcnt(16)
  v_lshlrev_b32 v32, 16, v120
  v_mfma_f32_16x16x32_bf16 v[180:183], a[136:139], a[96:99], v[180:183]
  s_waitcnt lgkmcnt(7)
  v_and_b32 v33, 0xffff0000, v120
  v_lshlrev_b32 v34, 16, v121
  v_mfma_f32_16x16x32_bf16 v[180:183], a[140:143], a[100:103], v[180:183]
  ds_read_b128 a[184:187], v5 offset:14336
  v_and_b32 v35, 0xffff0000, v121
  v_mfma_f32_16x16x32_bf16 v[180:183], a[144:147], a[104:107], v[180:183]
  v_mfma_f32_16x16x32_bf16 v[184:187], a[148:151], a[48:51], v[36:39]
  ds_read_b128 a[188:191], v5 offset:15360
  v_mfma_f32_16x16x32_bf16 v[184:187], a[152:155], a[52:55], v[184:187]
  s_waitcnt lgkmcnt(5)
  buffer_load_dwordx4 v3, s[12:15], s66 offen offset:3072 sc1 lds
  v_mfma_f32_16x16x32_bf16 v[184:187], a[156:159], a[56:59], v[184:187]
  s_add_u32 m0, m0, 0x4000
  ds_read_b128 a[128:131], v5 offset:16384
  v_mfma_f32_16x16x32_bf16 v[184:187], a[160:163], a[60:63], v[184:187]
  v_mfma_f32_16x16x32_bf16 v[184:187], a[164:167], a[64:67], v[184:187]
  ds_read_b128 a[132:135], v5 offset:17408
  v_mfma_f32_16x16x32_bf16 v[184:187], a[168:171], a[68:71], v[184:187]
  s_waitcnt lgkmcnt(6)
  v_mfma_f32_16x16x32_bf16 v[184:187], a[172:175], a[72:75], v[184:187]
  ds_read_b128 a[136:139], v5 offset:18432
  v_mfma_f32_16x16x32_bf16 v[188:191], a[148:151], a[80:83], v[36:39]
  v_mfma_f32_16x16x32_bf16 v[188:191], a[152:155], a[84:87], v[188:191]
  ds_read_b128 a[140:143], v5 offset:19456
  v_mfma_f32_16x16x32_bf16 v[188:191], a[156:159], a[88:91], v[188:191]
  buffer_load_dwordx4 v4, s[12:15], s66 offen offset:0 sc1 lds
  v_mfma_f32_16x16x32_bf16 v[188:191], a[160:163], a[92:95], v[188:191]
  ds_read_b128 a[144:147], v5 offset:20480
  s_waitcnt vmcnt(16)
  v_lshlrev_b32 v36, 16, v122
  v_mfma_f32_16x16x32_bf16 v[188:191], a[164:167], a[96:99], v[188:191]
  v_and_b32 v37, 0xffff0000, v122
  v_lshlrev_b32 v38, 16, v123
  v_mfma_f32_16x16x32_bf16 v[188:191], a[168:171], a[100:103], v[188:191]
  ds_read_b128 a[148:151], v5 offset:21504
  v_and_b32 v39, 0xffff0000, v123
  v_mfma_f32_16x16x32_bf16 v[188:191], a[172:175], a[104:107], v[188:191]
  s_waitcnt lgkmcnt(6)
  v_mfma_f32_16x16x32_bf16 v[208:211], a[176:179], a[48:51], v[32:35]
  ds_read_b128 a[152:155], v5 offset:22528
  v_mfma_f32_16x16x32_bf16 v[208:211], a[180:183], a[52:55], v[208:211]
  v_mfma_f32_16x16x32_bf16 v[208:211], a[184:187], a[56:59], v[208:211]
  ds_read_b128 a[156:159], v5 offset:23552
  v_mfma_f32_16x16x32_bf16 v[208:211], a[188:191], a[60:63], v[208:211]
  s_waitcnt lgkmcnt(5)
  buffer_load_dwordx4 v4, s[12:15], s66 offen offset:1024 sc1 lds
  v_mfma_f32_16x16x32_bf16 v[208:211], a[128:131], a[64:67], v[208:211]
  ds_read_b128 a[160:163], v5 offset:24576
  v_mfma_f32_16x16x32_bf16 v[208:211], a[132:135], a[68:71], v[208:211]
  v_mfma_f32_16x16x32_bf16 v[208:211], a[136:139], a[72:75], v[208:211]
  ds_read_b128 a[164:167], v5 offset:25600
  v_mfma_f32_16x16x32_bf16 v[212:215], a[176:179], a[80:83], v[32:35]
  v_mfma_f32_16x16x32_bf16 v[212:215], a[180:183], a[84:87], v[212:215]
  ds_read_b128 a[168:171], v5 offset:26624
  v_mfma_f32_16x16x32_bf16 v[212:215], a[184:187], a[88:91], v[212:215]
  v_mfma_f32_16x16x32_bf16 v[212:215], a[188:191], a[92:95], v[212:215]
  ds_read_b128 a[172:175], v5 offset:27648
  s_waitcnt vmcnt(15)
  v_lshlrev_b32 v32, 16, v124
  v_mfma_f32_16x16x32_bf16 v[212:215], a[128:131], a[96:99], v[212:215]
  s_waitcnt lgkmcnt(7)
  buffer_load_dwordx4 v4, s[12:15], s66 offen offset:2048 sc1 lds
  v_mfma_f32_16x16x32_bf16 v[212:215], a[132:135], a[100:103], v[212:215]
  ds_read_b128 a[176:179], v5 offset:28672
  v_and_b32 v33, 0xffff0000, v124
  v_mfma_f32_16x16x32_bf16 v[212:215], a[136:139], a[104:107], v[212:215]
  v_lshlrev_b32 v34, 16, v125
  v_and_b32 v35, 0xffff0000, v125
  v_mfma_f32_16x16x32_bf16 v[216:219], a[140:143], a[48:51], v[36:39]
  ds_read_b128 a[180:183], v5 offset:29696
  v_mfma_f32_16x16x32_bf16 v[216:219], a[144:147], a[52:55], v[216:219]
  s_waitcnt lgkmcnt(5)
  v_mfma_f32_16x16x32_bf16 v[216:219], a[148:151], a[56:59], v[216:219]
  ds_read_b128 a[184:187], v5 offset:30720
  v_mfma_f32_16x16x32_bf16 v[216:219], a[152:155], a[60:63], v[216:219]
  v_mfma_f32_16x16x32_bf16 v[216:219], a[156:159], a[64:67], v[216:219]
  ds_read_b128 a[188:191], v5 offset:31744
  v_mfma_f32_16x16x32_bf16 v[216:219], a[160:163], a[68:71], v[216:219]
  s_waitcnt lgkmcnt(6)
  buffer_load_dwordx4 v4, s[12:15], s66 offen offset:3072 sc1 lds
  v_mfma_f32_16x16x32_bf16 v[216:219], a[164:167], a[72:75], v[216:219]
  s_add_u32 s66, s66, 0x8000
  v_mfma_f32_16x16x32_bf16 v[220:223], a[140:143], a[80:83], v[36:39]
  s_add_u32 m0, s67, s65
  v_mfma_f32_16x16x32_bf16 v[220:223], a[144:147], a[84:87], v[220:223]
  s_add_u32 s67, s67, 0x8000
  v_mfma_f32_16x16x32_bf16 v[220:223], a[148:151], a[88:91], v[220:223]
  s_and_b32 s67, s67, 0x1ffff
  v_add_u32 v5, s67, v1
  v_mfma_f32_16x16x32_bf16 v[220:223], a[152:155], a[92:95], v[220:223]
  s_waitcnt vmcnt(15) lgkmcnt(0)
  v_lshlrev_b32 v36, 16, v126
  v_and_b32 v37, 0xffff0000, v126
  v_mfma_f32_16x16x32_bf16 v[220:223], a[156:159], a[96:99], v[220:223]
  s_barrier
  v_lshlrev_b32 v38, 16, v127
  v_and_b32 v39, 0xffff0000, v127
  v_mfma_f32_16x16x32_bf16 v[220:223], a[160:163], a[100:103], v[220:223]
  ds_read_b128 a[128:131], v5 offset:0
  ds_read_b128 a[132:135], v5 offset:1024
  v_mfma_f32_16x16x32_bf16 v[220:223], a[164:167], a[104:107], v[220:223]
  buffer_load_dwordx4 v3, s[12:15], s66 offen offset:0 sc1 lds
  v_mfma_f32_16x16x32_bf16 v[240:243], a[168:171], a[48:51], v[32:35]
  ds_read_b128 a[136:139], v5 offset:2048
  ds_read_b128 a[140:143], v5 offset:3072
  v_mfma_f32_16x16x32_bf16 v[240:243], a[172:175], a[52:55], v[240:243]
  ds_read_b128 a[144:147], v5 offset:4096
  v_mfma_f32_16x16x32_bf16 v[240:243], a[176:179], a[56:59], v[240:243]
  ds_read_b128 a[148:151], v5 offset:5120
  v_mfma_f32_16x16x32_bf16 v[240:243], a[180:183], a[60:63], v[240:243]
  s_waitcnt lgkmcnt(5)
  v_mfma_f32_16x16x32_bf16 v[240:243], a[184:187], a[64:67], v[240:243]
  ds_read_b128 a[152:155], v5 offset:6144
  v_mfma_f32_16x16x32_bf16 v[240:243], a[188:191], a[68:71], v[240:243]
  v_mfma_f32_16x16x32_bf16 v[240:243], a[128:131], a[72:75], v[240:243]
  ds_read_b128 a[156:159], v5 offset:7168
  v_mfma_f32_16x16x32_bf16 v[244:247], a[168:171], a[80:83], v[32:35]
  buffer_load_dwordx4 v3, s[12:15], s66 offen offset:1024 sc1 lds
  v_mfma_f32_16x16x32_bf16 v[244:247], a[172:175], a[84:87], v[244:247]
  ds_read_b128 a[160:163], v5 offset:8192
  v_mfma_f32_16x16x32_bf16 v[244:247], a[176:179], a[88:91], v[244:247]
  v_mfma_f32_16x16x32_bf16 v[244:247], a[180:183], a[92:95], v[244:247]
  ds_read_b128 a[164:167], v5 offset:9216
  v_mfma_f32_16x16x32_bf16 v[244:247], a[184:187], a[96:99], v[244:247]
  s_waitcnt lgkmcnt(7)
  v_mfma_f32_16x16x32_bf16 v[244:247], a[188:191], a[100:103], v[244:247]
  ds_read_b128 a[168:171], v5 offset:10240
  v_mfma_f32_16x16x32_bf16 v[244:247], a[128:131], a[104:107], v[244:247]
  v_mfma_f32_16x16x32_bf16 v[248:251], a[132:135], a[48:51], v[36:39]
  ds_read_b128 a[172:175], v5 offset:11264
  v_mfma_f32_16x16x32_bf16 v[248:251], a[136:139], a[52:55], v[248:251]
  s_waitcnt lgkmcnt(5)
  buffer_load_dwordx4 v3, s[12:15], s66 offen offset:2048 sc1 lds
  v_mfma_f32_16x16x32_bf16 v[248:251], a[140:143], a[56:59], v[248:251]
  ds_read_b128 a[176:179], v5 offset:12288
  v_mfma_f32_16x16x32_bf16 v[248:251], a[144:147], a[60:63], v[248:251]
  v_mfma_f32_16x16x32_bf16 v[248:251], a[148:151], a[64:67], v[248:251]
  ds_read_b128 a[180:183], v5 offset:13312
  v_mfma_f32_16x16x32_bf16 v[248:251], a[152:155], a[68:71], v[248:251]
  s_waitcnt lgkmcnt(6)
  v_mfma_f32_16x16x32_bf16 v[248:251], a[156:159], a[72:75], v[248:251]
  ds_read_b128 a[184:187], v5 offset:14336
  v_mfma_f32_16x16x32_bf16 v[252:255], a[132:135], a[80:83], v[36:39]
  v_mfma_f32_16x16x32_bf16 v[252:255], a[136:139], a[84:87], v[252:255]
  ds_read_b128 a[188:191], v5 offset:15360
  v_mov_b32 v12, 1
  v_mfma_f32_16x16x32_bf16 v[252:255], a[140:143], a[88:91], v[252:255]
  buffer_load_dwordx4 v3, s[12:15], s66 offen offset:3072 sc1 lds
  v_mfma_f32_16x16x32_bf16 v[252:255], a[144:147], a[92:95], v[252:255]
  s_lshl_b32 s96, s64, 9
  ds_read_b128 a[128:131], v5 offset:16384
  v_mfma_f32_16x16x32_bf16 v[252:255], a[148:151], a[96:99], v[252:255]
  s_add_u32 s96, s96, 38567936
  buffer_atomic_add v12, v0, s[12:15], s96 offen offset:384 sc0 sc1
  v_mfma_f32_16x16x32_bf16 v[252:255], a[152:155], a[100:103], v[252:255]
  s_add_u32 m0, m0, 0x4000
  ds_read_b128 a[132:135], v5 offset:17408
  v_mfma_f32_16x16x32_bf16 v[252:255], a[156:159], a[104:107], v[252:255]
  s_waitcnt lgkmcnt(6)
  v_mfma_f32_16x16x32_bf16 v[144:147], a[160:163], a[76:79], v[144:147]
  ds_read_b128 a[136:139], v5 offset:18432
  v_mfma_f32_16x16x32_bf16 v[144:147], a[164:167], a[0:3], v[144:147]
  v_mfma_f32_16x16x32_bf16 v[144:147], a[168:171], a[4:7], v[144:147]
  ds_read_b128 a[140:143], v5 offset:19456
  v_mfma_f32_16x16x32_bf16 v[144:147], a[172:175], a[8:11], v[144:147]
  s_waitcnt lgkmcnt(5)
  buffer_load_dwordx4 v4, s[12:15], s66 offen offset:0 sc1 lds
  v_mfma_f32_16x16x32_bf16 v[144:147], a[176:179], a[12:15], v[144:147]
  ds_read_b128 a[144:147], v5 offset:20480
  v_mfma_f32_16x16x32_bf16 v[144:147], a[180:183], a[16:19], v[144:147]
  v_mfma_f32_16x16x32_bf16 v[144:147], a[184:187], a[20:23], v[144:147]
  ds_read_b128 a[148:151], v5 offset:21504
  v_mfma_f32_16x16x32_bf16 v[148:151], a[160:163], a[108:111], v[148:151]
  v_mfma_f32_16x16x32_bf16 v[148:151], a[164:167], a[24:27], v[148:151]
  ds_read_b128 a[152:155], v5 offset:22528
  v_mfma_f32_16x16x32_bf16 v[148:151], a[168:171], a[28:31], v[148:151]
  v_mfma_f32_16x16x32_bf16 v[148:151], a[172:175], a[32:35], v[148:151]
  ds_read_b128 a[156:159], v5 offset:23552
  v_mfma_f32_16x16x32_bf16 v[148:151], a[176:179], a[36:39], v[148:151]
  s_waitcnt lgkmcnt(7)
  buffer_load_dwordx4 v4, s[12:15], s66 offen offset:1024 sc1 lds
  v_mfma_f32_16x16x32_bf16 v[148:151], a[180:183], a[40:43], v[148:151]
  ds_read_b128 a[160:163], v5 offset:24576
  v_mul_f32 v144, v144, abs(v144)
  v_mfma_f32_16x16x32_bf16 v[148:151], a[184:187], a[44:47], v[148:151]
  v_mul_f32 v145, v145, abs(v145)
  v_cvt_pk_bf16_f32 v144, v144, v145
  v_mfma_f32_16x16x32_bf16 v[152:155], a[188:191], a[76:79], v[152:155]
  ds_read_b128 a[164:167], v5 offset:25600
  v_pk_max_i16 v160, v144, 0
  v_mfma_f32_16x16x32_bf16 v[152:155], a[128:131], a[0:3], v[152:155]
  s_waitcnt lgkmcnt(5)
  v_mul_f32 v146, v146, abs(v146)
  v_mul_f32 v147, v147, abs(v147)
  v_mfma_f32_16x16x32_bf16 v[152:155], a[132:135], a[4:7], v[152:155]
  ds_read_b128 a[168:171], v5 offset:26624
  v_mul_f32 v148, v148, abs(v148)
  v_mfma_f32_16x16x32_bf16 v[152:155], a[136:139], a[8:11], v[152:155]
  v_mul_f32 v149, v149, abs(v149)
  v_cvt_pk_bf16_f32 v148, v148, v149
  v_mfma_f32_16x16x32_bf16 v[152:155], a[140:143], a[12:15], v[152:155]
  ds_read_b128 a[172:175], v5 offset:27648
  v_pk_max_i16 v224, v148, 0
  v_mfma_f32_16x16x32_bf16 v[152:155], a[144:147], a[16:19], v[152:155]
  s_waitcnt lgkmcnt(6)
  buffer_load_dwordx4 v4, s[12:15], s66 offen offset:2048 sc1 lds
  v_mfma_f32_16x16x32_bf16 v[152:155], a[148:151], a[20:23], v[152:155]
  ds_read_b128 a[176:179], v5 offset:28672
  v_mul_f32 v150, v150, abs(v150)
  v_mfma_f32_16x16x32_bf16 v[156:159], a[188:191], a[108:111], v[156:159]
  v_mul_f32 v151, v151, abs(v151)
  v_cvt_pk_bf16_f32 v146, v146, v147
  v_mfma_f32_16x16x32_bf16 v[156:159], a[128:131], a[24:27], v[156:159]
  ds_read_b128 a[180:183], v5 offset:29696
  v_cvt_pk_bf16_f32 v150, v150, v151
  v_mfma_f32_16x16x32_bf16 v[156:159], a[132:135], a[28:31], v[156:159]
  v_pk_max_i16 v161, v146, 0
  v_pk_max_i16 v225, v150, 0
  v_mfma_f32_16x16x32_bf16 v[156:159], a[136:139], a[32:35], v[156:159]
  ds_read_b128 a[184:187], v5 offset:30720
  v_mul_f32 v152, v152, abs(v152)
  v_mfma_f32_16x16x32_bf16 v[156:159], a[140:143], a[36:39], v[156:159]
  v_mul_f32 v153, v153, abs(v153)
  v_cvt_pk_bf16_f32 v152, v152, v153
  v_mfma_f32_16x16x32_bf16 v[156:159], a[144:147], a[40:43], v[156:159]
  ds_read_b128 a[188:191], v5 offset:31744
  v_pk_max_i16 v162, v152, 0
  v_mfma_f32_16x16x32_bf16 v[156:159], a[148:151], a[44:47], v[156:159]
  s_waitcnt lgkmcnt(6)
  buffer_load_dwordx4 v4, s[12:15], s66 offen offset:3072 sc1 lds
  v_mfma_f32_16x16x32_bf16 v[176:179], a[152:155], a[76:79], v[176:179]
  s_add_u32 s66, s66, 0x8000
  v_mul_f32 v154, v154, abs(v154)
  v_mul_f32 v155, v155, abs(v155)
  v_mfma_f32_16x16x32_bf16 v[176:179], a[156:159], a[0:3], v[176:179]
  s_add_u32 m0, s67, s65
  v_cvt_pk_bf16_f32 v154, v154, v155
  v_mul_f32 v156, v156, abs(v156)
  v_mfma_f32_16x16x32_bf16 v[176:179], a[160:163], a[4:7], v[176:179]
  s_add_u32 s67, s67, 0x8000
  v_mul_f32 v157, v157, abs(v157)
  v_cvt_pk_bf16_f32 v156, v156, v157
  v_mfma_f32_16x16x32_bf16 v[176:179], a[164:167], a[8:11], v[176:179]
  s_waitcnt lgkmcnt(3)
  s_and_b32 s67, s67, 0x1ffff
  v_add_u32 v5, s67, v1
  v_mfma_f32_16x16x32_bf16 v[176:179], a[168:171], a[12:15], v[176:179]
  s_waitcnt vmcnt(17) lgkmcnt(0)
  v_pk_max_i16 v226, v156, 0
  v_mul_f32 v158, v158, abs(v158)
  v_mfma_f32_16x16x32_bf16 v[176:179], a[172:175], a[16:19], v[176:179]
  s_barrier
  v_mul_f32 v159, v159, abs(v159)
  v_cvt_pk_bf16_f32 v158, v158, v159
  v_mfma_f32_16x16x32_bf16 v[176:179], a[176:179], a[20:23], v[176:179]
  ds_read_b128 a[128:131], v5 offset:0
  ds_read_b128 a[132:135], v5 offset:1024
  v_mfma_f32_16x16x32_bf16 v[180:183], a[152:155], a[108:111], v[180:183]
  buffer_load_dwordx4 v3, s[12:15], s66 offen offset:0 sc1 lds
  v_mfma_f32_16x16x32_bf16 v[180:183], a[156:159], a[24:27], v[180:183]
  ds_read_b128 a[136:139], v5 offset:2048
  ds_read_b128 a[140:143], v5 offset:3072
  v_mfma_f32_16x16x32_bf16 v[180:183], a[160:163], a[28:31], v[180:183]
  ds_read_b128 a[144:147], v5 offset:4096
  v_mul_f32 v176, v176, abs(v176)
  v_mfma_f32_16x16x32_bf16 v[180:183], a[164:167], a[32:35], v[180:183]
  ds_read_b128 a[148:151], v5 offset:5120
  v_mul_f32 v177, v177, abs(v177)
  v_mfma_f32_16x16x32_bf16 v[180:183], a[168:171], a[36:39], v[180:183]
  v_cvt_pk_bf16_f32 v176, v176, v177
  v_pk_max_i16 v164, v176, 0
  v_mfma_f32_16x16x32_bf16 v[180:183], a[172:175], a[40:43], v[180:183]
  ds_read_b128 a[152:155], v5 offset:6144
  v_mul_f32 v178, v178, abs(v178)
  v_mfma_f32_16x16x32_bf16 v[180:183], a[176:179], a[44:47], v[180:183]
  v_mul_f32 v179, v179, abs(v179)
  v_cvt_pk_bf16_f32 v178, v178, v179
  v_mfma_f32_16x16x32_bf16 v[184:187], a[180:183], a[76:79], v[184:187]
  ds_read_b128 a[156:159], v5 offset:7168
  v_pk_max_i16 v165, v178, 0
  v_mfma_f32_16x16x32_bf16 v[184:187], a[184:187], a[0:3], v[184:187]
  s_waitcnt lgkmcnt(5)
  buffer_load_dwordx4 v3, s[12:15], s66 offen offset:1024 sc1 lds
  v_mfma_f32_16x16x32_bf16 v[184:187], a[188:191], a[4:7], v[184:187]
  ds_read_b128 a[160:163], v5 offset:8192
  v_mul_f32 v180, v180, abs(v180)
  v_mfma_f32_16x16x32_bf16 v[184:187], a[128:131], a[8:11], v[184:187]
  v_mul_f32 v181, v181, abs(v181)
  v_cvt_pk_bf16_f32 v180, v180, v181
  v_mfma_f32_16x16x32_bf16 v[184:187], a[132:135], a[12:15], v[184:187]
  ds_read_b128 a[164:167], v5 offset:9216
  v_pk_max_i16 v228, v180, 0
  v_mfma_f32_16x16x32_bf16 v[184:187], a[136:139], a[16:19], v[184:187]
  s_waitcnt lgkmcnt(6)
  v_mul_f32 v182, v182, abs(v182)
  v_mul_f32 v183, v183, abs(v183)
  v_mfma_f32_16x16x32_bf16 v[184:187], a[140:143], a[20:23], v[184:187]
  ds_read_b128 a[168:171], v5 offset:10240
  v_cvt_pk_bf16_f32 v182, v182, v183
  v_mfma_f32_16x16x32_bf16 v[188:191], a[180:183], a[108:111], v[188:191]
  v_pk_max_i16 v229, v182, 0
  v_pk_max_i16 v163, v154, 0
  v_mfma_f32_16x16x32_bf16 v[188:191], a[184:187], a[24:27], v[188:191]
  ds_read_b128 a[172:175], v5 offset:11264
  v_pk_max_i16 v227, v158, 0
  v_mfma_f32_16x16x32_bf16 v[188:191], a[188:191], a[28:31], v[188:191]
  buffer_load_dwordx4 v3, s[12:15], s66 offen offset:2048 sc1 lds
  v_mfma_f32_16x16x32_bf16 v[188:191], a[128:131], a[32:35], v[188:191]
  ds_read_b128 a[176:179], v5 offset:12288
  v_mul_f32 v184, v184, abs(v184)
  v_mfma_f32_16x16x32_bf16 v[188:191], a[132:135], a[36:39], v[188:191]
  v_mul_f32 v185, v185, abs(v185)
  v_cvt_pk_bf16_f32 v184, v184, v185
  v_mfma_f32_16x16x32_bf16 v[188:191], a[136:139], a[40:43], v[188:191]
  ds_read_b128 a[180:183], v5 offset:13312
  v_pk_max_i16 v166, v184, 0
  v_mfma_f32_16x16x32_bf16 v[188:191], a[140:143], a[44:47], v[188:191]
  s_waitcnt lgkmcnt(6)
  v_mul_f32 v186, v186, abs(v186)
  v_mul_f32 v187, v187, abs(v187)
  v_mfma_f32_16x16x32_bf16 v[208:211], a[144:147], a[76:79], v[208:211]
  ds_read_b128 a[184:187], v5 offset:14336
  v_cvt_pk_bf16_f32 v186, v186, v187
  v_mfma_f32_16x16x32_bf16 v[208:211], a[148:151], a[0:3], v[208:211]
  v_pk_max_i16 v167, v186, 0
  v_mfma_f32_16x16x32_bf16 v[208:211], a[152:155], a[4:7], v[208:211]
  ds_read_b128 a[188:191], v5 offset:15360
  v_mul_f32 v188, v188, abs(v188)
  v_mfma_f32_16x16x32_bf16 v[208:211], a[156:159], a[8:11], v[208:211]
  s_waitcnt lgkmcnt(5)
  buffer_load_dwordx4 v3, s[12:15], s66 offen offset:3072 sc1 lds
  v_mfma_f32_16x16x32_bf16 v[208:211], a[160:163], a[12:15], v[208:211]
  s_add_u32 m0, m0, 0x4000
  ds_read_b128 a[128:131], v5 offset:16384
  v_mul_f32 v189, v189, abs(v189)
  v_mfma_f32_16x16x32_bf16 v[208:211], a[164:167], a[16:19], v[208:211]
  v_cvt_pk_bf16_f32 v188, v188, v189
  v_pk_max_i16 v230, v188, 0
  v_mfma_f32_16x16x32_bf16 v[208:211], a[168:171], a[20:23], v[208:211]
  ds_read_b128 a[132:135], v5 offset:17408
  v_mul_f32 v190, v190, abs(v190)
  v_mfma_f32_16x16x32_bf16 v[212:215], a[144:147], a[108:111], v[212:215]
  v_mul_f32 v191, v191, abs(v191)
  v_cvt_pk_bf16_f32 v190, v190, v191
  v_mfma_f32_16x16x32_bf16 v[212:215], a[148:151], a[24:27], v[212:215]
  ds_read_b128 a[136:139], v5 offset:18432
  v_pk_max_i16 v231, v190, 0
  v_mfma_f32_16x16x32_bf16 v[212:215], a[152:155], a[28:31], v[212:215]
  v_mul_f32 v208, v208, abs(v208)
  v_mul_f32 v209, v209, abs(v209)
  v_mfma_f32_16x16x32_bf16 v[212:215], a[156:159], a[32:35], v[212:215]
  ds_read_b128 a[140:143], v5 offset:19456
  v_cvt_pk_bf16_f32 v208, v208, v209
  v_mfma_f32_16x16x32_bf16 v[212:215], a[160:163], a[36:39], v[212:215]
  s_waitcnt lgkmcnt(7)
  buffer_load_dwordx4 v4, s[12:15], s66 offen offset:0 sc1 lds
  v_mfma_f32_16x16x32_bf16 v[212:215], a[164:167], a[40:43], v[212:215]
  ds_read_b128 a[144:147], v5 offset:20480
  v_pk_max_i16 v168, v208, 0
  v_mfma_f32_16x16x32_bf16 v[212:215], a[168:171], a[44:47], v[212:215]
  v_mul_f32 v210, v210, abs(v210)
  v_mul_f32 v211, v211, abs(v211)
  v_mfma_f32_16x16x32_bf16 v[216:219], a[172:175], a[76:79], v[216:219]
  ds_read_b128 a[148:151], v5 offset:21504
  v_cvt_pk_bf16_f32 v210, v210, v211
  v_mfma_f32_16x16x32_bf16 v[216:219], a[176:179], a[0:3], v[216:219]
  s_waitcnt lgkmcnt(5)
  v_pk_max_i16 v169, v210, 0
  v_mfma_f32_16x16x32_bf16 v[216:219], a[180:183], a[4:7], v[216:219]
  ds_read_b128 a[152:155], v5 offset:22528
  v_mul_f32 v212, v212, abs(v212)
  v_mfma_f32_16x16x32_bf16 v[216:219], a[184:187], a[8:11], v[216:219]
  v_mul_f32 v213, v213, abs(v213)
  v_cvt_pk_bf16_f32 v212, v212, v213
  v_mfma_f32_16x16x32_bf16 v[216:219], a[188:191], a[12:15], v[216:219]
  ds_read_b128 a[156:159], v5 offset:23552
  v_pk_max_i16 v232, v212, 0
  v_mfma_f32_16x16x32_bf16 v[216:219], a[128:131], a[16:19], v[216:219]
  s_waitcnt lgkmcnt(6)
  buffer_load_dwordx4 v4, s[12:15], s66 offen offset:1024 sc1 lds
  v_mfma_f32_16x16x32_bf16 v[216:219], a[132:135], a[20:23], v[216:219]
  ds_read_b128 a[160:163], v5 offset:24576
  v_mul_f32 v214, v214, abs(v214)
  v_mfma_f32_16x16x32_bf16 v[220:223], a[172:175], a[108:111], v[220:223]
  v_mul_f32 v215, v215, abs(v215)
  v_cvt_pk_bf16_f32 v214, v214, v215
  v_mfma_f32_16x16x32_bf16 v[220:223], a[176:179], a[24:27], v[220:223]
  ds_read_b128 a[164:167], v5 offset:25600
  v_pk_max_i16 v233, v214, 0
  v_mfma_f32_16x16x32_bf16 v[220:223], a[180:183], a[28:31], v[220:223]
  v_mul_f32 v216, v216, abs(v216)
  v_mul_f32 v217, v217, abs(v217)
  v_mfma_f32_16x16x32_bf16 v[220:223], a[184:187], a[32:35], v[220:223]
  ds_read_b128 a[168:171], v5 offset:26624
  v_cvt_pk_bf16_f32 v216, v216, v217
  v_mfma_f32_16x16x32_bf16 v[220:223], a[188:191], a[36:39], v[220:223]
  v_pk_max_i16 v170, v216, 0
  v_mul_f32 v218, v218, abs(v218)
  v_mfma_f32_16x16x32_bf16 v[220:223], a[128:131], a[40:43], v[220:223]
  ds_read_b128 a[172:175], v5 offset:27648
  v_mul_f32 v219, v219, abs(v219)
  v_mfma_f32_16x16x32_bf16 v[220:223], a[132:135], a[44:47], v[220:223]
  s_waitcnt lgkmcnt(6)
  buffer_load_dwordx4 v4, s[12:15], s66 offen offset:2048 sc1 lds
  v_mfma_f32_16x16x32_bf16 v[240:243], a[136:139], a[76:79], v[240:243]
  ds_read_b128 a[176:179], v5 offset:28672
  v_cvt_pk_bf16_f32 v218, v218, v219
  v_mfma_f32_16x16x32_bf16 v[240:243], a[140:143], a[0:3], v[240:243]
  v_pk_max_i16 v171, v218, 0
  v_mfma_f32_16x16x32_bf16 v[240:243], a[144:147], a[4:7], v[240:243]
  ds_read_b128 a[180:183], v5 offset:29696
  v_mul_f32 v220, v220, abs(v220)
  v_mfma_f32_16x16x32_bf16 v[240:243], a[148:151], a[8:11], v[240:243]
  s_waitcnt lgkmcnt(5)
  v_mul_f32 v221, v221, abs(v221)
  v_cvt_pk_bf16_f32 v220, v220, v221
  v_mfma_f32_16x16x32_bf16 v[240:243], a[152:155], a[12:15], v[240:243]
  ds_read_b128 a[184:187], v5 offset:30720
  v_pk_max_i16 v234, v220, 0
  v_mfma_f32_16x16x32_bf16 v[240:243], a[156:159], a[16:19], v[240:243]
  v_mul_f32 v222, v222, abs(v222)
  v_mul_f32 v223, v223, abs(v223)
  v_mfma_f32_16x16x32_bf16 v[240:243], a[160:163], a[20:23], v[240:243]
  ds_read_b128 a[188:191], v5 offset:31744
  v_cvt_pk_bf16_f32 v222, v222, v223
  v_mfma_f32_16x16x32_bf16 v[244:247], a[136:139], a[108:111], v[244:247]
  buffer_load_dwordx4 v4, s[12:15], s66 offen offset:3072 sc1 lds
  v_mfma_f32_16x16x32_bf16 v[244:247], a[140:143], a[24:27], v[244:247]
  s_add_u32 s66, s66, 0x8000
  v_pk_max_i16 v235, v222, 0
  v_mfma_f32_16x16x32_bf16 v[244:247], a[144:147], a[28:31], v[244:247]
  s_add_u32 m0, s67, s65
  v_mul_f32 v240, v240, abs(v240)
  v_mul_f32 v241, v241, abs(v241)
  v_mfma_f32_16x16x32_bf16 v[244:247], a[148:151], a[32:35], v[244:247]
  s_add_u32 s67, s67, 0x8000
  v_cvt_pk_bf16_f32 v240, v240, v241
  v_pk_max_i16 v172, v240, 0
  v_mfma_f32_16x16x32_bf16 v[244:247], a[152:155], a[36:39], v[244:247]
  s_waitcnt lgkmcnt(5)
  s_and_b32 s67, s67, 0x1ffff
  v_add_u32 v5, s67, v1
  v_mfma_f32_16x16x32_bf16 v[244:247], a[156:159], a[40:43], v[244:247]
  s_waitcnt vmcnt(17) lgkmcnt(0)
  v_mul_f32 v242, v242, abs(v242)
  v_mul_f32 v243, v243, abs(v243)
  v_mfma_f32_16x16x32_bf16 v[244:247], a[160:163], a[44:47], v[244:247]
  s_barrier
  v_cvt_pk_bf16_f32 v242, v242, v243
  v_pk_max_i16 v173, v242, 0
  v_mfma_f32_16x16x32_bf16 v[248:251], a[164:167], a[76:79], v[248:251]
  ds_read_b128 a[128:131], v5 offset:0
  v_mfma_f32_16x16x32_bf16 v[248:251], a[168:171], a[0:3], v[248:251]
  buffer_load_dwordx4 v3, s[12:15], s66 offen offset:0 sc1 lds
  v_mfma_f32_16x16x32_bf16 v[248:251], a[172:175], a[4:7], v[248:251]
  ds_read_b128 a[132:135], v5 offset:1024
  ds_read_b128 a[136:139], v5 offset:2048
  v_mfma_f32_16x16x32_bf16 v[248:251], a[176:179], a[8:11], v[248:251]
  v_mul_f32 v244, v244, abs(v244)
  v_mul_f32 v245, v245, abs(v245)
  v_mfma_f32_16x16x32_bf16 v[248:251], a[180:183], a[12:15], v[248:251]
  ds_read_b128 a[140:143], v5 offset:3072
  v_cvt_pk_bf16_f32 v244, v244, v245
  v_mfma_f32_16x16x32_bf16 v[248:251], a[184:187], a[16:19], v[248:251]
  ds_read_b128 a[144:147], v5 offset:4096
  v_pk_max_i16 v236, v244, 0
  v_mfma_f32_16x16x32_bf16 v[248:251], a[188:191], a[20:23], v[248:251]
  ds_read_b128 a[148:151], v5 offset:5120
  v_mul_f32 v246, v246, abs(v246)
  v_mfma_f32_16x16x32_bf16 v[252:255], a[164:167], a[108:111], v[252:255]
  v_mul_f32 v247, v247, abs(v247)
  v_cvt_pk_bf16_f32 v246, v246, v247
  v_mfma_f32_16x16x32_bf16 v[252:255], a[168:171], a[24:27], v[252:255]
  ds_read_b128 a[152:155], v5 offset:6144
  v_pk_max_i16 v237, v246, 0
  v_mfma_f32_16x16x32_bf16 v[252:255], a[172:175], a[28:31], v[252:255]
  buffer_load_dwordx4 v3, s[12:15], s66 offen offset:1024 sc1 lds
  v_mfma_f32_16x16x32_bf16 v[252:255], a[176:179], a[32:35], v[252:255]
  ds_read_b128 a[156:159], v5 offset:7168
  v_mul_f32 v248, v248, abs(v248)
  v_mfma_f32_16x16x32_bf16 v[252:255], a[180:183], a[36:39], v[252:255]
  ds_read_b128 a[160:163], v5 offset:8192
  v_mul_f32 v249, v249, abs(v249)
  v_mfma_f32_16x16x32_bf16 v[252:255], a[184:187], a[40:43], v[252:255]
  ds_read_b128 a[164:167], v5 offset:9216
  v_cvt_pk_bf16_f32 v248, v248, v249
  v_mfma_f32_16x16x32_bf16 v[252:255], a[188:191], a[44:47], v[252:255]
  s_waitcnt lgkmcnt(6)
  ds_read_b128 a[168:171], v5 offset:10240
  v_pk_max_i16 v174, v248, 0
  v_mfma_f32_16x16x32_bf16 v[144:147], a[128:131], v[128:131], 0
  v_mul_f32 v250, v250, abs(v250)
  v_mul_f32 v251, v251, abs(v251)
  v_mfma_f32_16x16x32_bf16 v[144:147], a[132:135], v[132:135], v[144:147]
  ds_read_b128 a[172:175], v5 offset:11264
  v_cvt_pk_bf16_f32 v250, v250, v251
  v_mfma_f32_16x16x32_bf16 v[144:147], a[136:139], v[136:139], v[144:147]
  ds_read_b128 a[176:179], v5 offset:12288
  v_pk_max_i16 v175, v250, 0
  v_mfma_f32_16x16x32_bf16 v[144:147], a[140:143], v[140:143], v[144:147]
  s_waitcnt lgkmcnt(5)
  ds_read_b128 a[180:183], v5 offset:13312
  v_mul_f32 v252, v252, abs(v252)
  v_mfma_f32_16x16x32_bf16 v[144:147], a[144:147], v[160:163], v[144:147]
  v_mul_f32 v253, v253, abs(v253)
  v_cvt_pk_bf16_f32 v252, v252, v253
  v_mfma_f32_16x16x32_bf16 v[144:147], a[148:151], v[164:167], v[144:147]
  ds_read_b128 a[184:187], v5 offset:14336
  v_pk_max_i16 v238, v252, 0
  v_mfma_f32_16x16x32_bf16 v[144:147], a[152:155], v[168:171], v[144:147]
  ds_read_b128 a[188:191], v5 offset:15360
  v_mul_f32 v254, v254, abs(v254)
  v_mfma_f32_16x16x32_bf16 v[144:147], a[156:159], v[172:175], v[144:147]
  s_waitcnt lgkmcnt(4)
  v_mul_f32 v255, v255, abs(v255)
  v_cvt_pk_bf16_f32 v254, v254, v255
  v_mfma_f32_16x16x32_bf16 v[152:155], a[160:163], v[128:131], 0
  v_pk_max_i16 v239, v254, 0
  v_mfma_f32_16x16x32_bf16 v[152:155], a[164:167], v[132:135], v[152:155]
  v_mfma_f32_16x16x32_bf16 v[152:155], a[168:171], v[136:139], v[152:155]
  v_mfma_f32_16x16x32_bf16 v[152:155], a[172:175], v[140:143], v[152:155]
  s_waitcnt lgkmcnt(0)
  v_mfma_f32_16x16x32_bf16 v[152:155], a[176:179], v[160:163], v[152:155]
  v_mfma_f32_16x16x32_bf16 v[152:155], a[180:183], v[164:167], v[152:155]
  v_mfma_f32_16x16x32_bf16 v[152:155], a[184:187], v[168:171], v[152:155]
  v_mfma_f32_16x16x32_bf16 v[152:155], a[188:191], v[172:175], v[152:155]
L_kf_kernel_opl_24:
  s_waitcnt vmcnt(14)
  v_readfirstlane_b32 s96, v12
  s_nop 0
  s_cmp_lt_u32 s96, 32
  s_cbranch_scc1 L_kf_kernel_pre_97
L_kf_kernel_opl2_98:
  v_mfma_f32_16x16x32_bf16 v[148:151], a[128:131], v[192:195], 0
  s_mul_i32 s97, s64, 659456
  v_mov_b32 v18, v88
  v_mov_b32 v19, v88
  v_mfma_f32_16x16x32_bf16 v[148:151], a[132:135], v[196:199], v[148:151]
  s_add_u32 s73, s73, s97
  buffer_load_dwordx4 v3, s[12:15], s66 offen offset:2048 sc1 lds
  v_mfma_f32_16x16x32_bf16 v[148:151], a[136:139], v[200:203], v[148:151]
  ds_read_b128 a[128:131], v5 offset:16384
  ds_read_b128 a[132:135], v5 offset:17408
  v_mfma_f32_16x16x32_bf16 v[148:151], a[140:143], v[204:207], v[148:151]
  ds_read_b128 a[136:139], v5 offset:18432
  v_permlane32_swap_b32 v18, v19
  v_mfma_f32_16x16x32_bf16 v[148:151], a[144:147], v[224:227], v[148:151]
  ds_read_b128 a[140:143], v5 offset:19456
  v_add_f32 v88, v18, v19
  v_mfma_f32_16x16x32_bf16 v[148:151], a[148:151], v[228:231], v[148:151]
  buffer_load_dwordx4 v3, s[12:15], s66 offen offset:3072 sc1 lds
  v_mfma_f32_16x16x32_bf16 v[148:151], a[152:155], v[232:235], v[148:151]
  s_add_u32 m0, m0, 0x4000
  ds_read_b128 a[144:147], v5 offset:20480
  ds_read_b128 a[148:151], v5 offset:21504
  v_mfma_f32_16x16x32_bf16 v[148:151], a[156:159], v[236:239], v[148:151]
  ds_read_b128 a[152:155], v5 offset:22528
  v_mov_b32 v18, v88
  v_mfma_f32_16x16x32_bf16 v[156:159], a[160:163], v[192:195], 0
  ds_read_b128 a[156:159], v5 offset:23552
  v_mov_b32 v19, v88
  v_mfma_f32_16x16x32_bf16 v[156:159], a[164:167], v[196:199], v[156:159]
  v_mov_b32 v20, v89
  v_permlane16_swap_b32 v18, v19
  v_mfma_f32_16x16x32_bf16 v[156:159], a[168:171], v[200:203], v[156:159]
  buffer_load_dwordx4 v4, s[12:15], s66 offen offset:0 sc1 lds
  v_mfma_f32_16x16x32_bf16 v[156:159], a[172:175], v[204:207], v[156:159]
  ds_read_b128 a[160:163], v5 offset:24576
  v_add_f32 v88, v18, v19
  v_mfma_f32_16x16x32_bf16 v[156:159], a[176:179], v[224:227], v[156:159]
  ds_read_b128 a[164:167], v5 offset:25600
  v_mov_b32 v21, v89
  v_mfma_f32_16x16x32_bf16 v[156:159], a[180:183], v[228:231], v[156:159]
  v_rcp_f32 v88, v88
  v_mfma_f32_16x16x32_bf16 v[156:159], a[184:187], v[232:235], v[156:159]
  buffer_load_dwordx4 v4, s[12:15], s66 offen offset:1024 sc1 lds
  v_mfma_f32_16x16x32_bf16 v[156:159], a[188:191], v[236:239], v[156:159]
  s_waitcnt lgkmcnt(6)
  ds_read_b128 a[168:171], v5 offset:26624
  v_permlane32_swap_b32 v20, v21
  v_mfma_f32_16x16x32_bf16 v[176:179], a[128:131], v[128:131], 0
  ds_read_b128 a[172:175], v5 offset:27648
  v_add_f32 v89, v20, v21
  v_mfma_f32_16x16x32_bf16 v[176:179], a[132:135], v[132:135], v[176:179]
  v_mov_b32 v20, v89
  v_mov_b32 v21, v89
  v_mfma_f32_16x16x32_bf16 v[176:179], a[136:139], v[136:139], v[176:179]
  ds_read_b128 a[176:179], v5 offset:28672
  v_permlane16_swap_b32 v20, v21
  v_mfma_f32_16x16x32_bf16 v[176:179], a[140:143], v[140:143], v[176:179]
  s_waitcnt lgkmcnt(5)
  buffer_load_dwordx4 v4, s[12:15], s66 offen offset:2048 sc1 lds
  v_mfma_f32_16x16x32_bf16 v[176:179], a[144:147], v[160:163], v[176:179]
  ds_read_b128 a[180:183], v5 offset:29696
  v_add_f32 v89, v20, v21
  v_mfma_f32_16x16x32_bf16 v[176:179], a[148:151], v[164:167], v[176:179]
  v_rcp_f32 v89, v89
  v_mfma_f32_16x16x32_bf16 v[176:179], a[152:155], v[168:171], v[176:179]
  ds_read_b128 a[184:187], v5 offset:30720
  v_mul_f32 v144, v88, v144
  v_mfma_f32_16x16x32_bf16 v[176:179], a[156:159], v[172:175], v[176:179]
  v_mul_f32 v145, v88, v145
  v_cvt_pk_bf16_f32 v72, v144, v145
  v_mfma_f32_16x16x32_bf16 v[180:183], a[128:131], v[192:195], 0
  buffer_load_dwordx4 v4, s[12:15], s66 offen offset:3072 sc1 lds
  v_mfma_f32_16x16x32_bf16 v[180:183], a[132:135], v[196:199], v[180:183]
  s_add_u32 s66, s66, 0x8000
  ds_read_b128 a[188:191], v5 offset:31744
  v_mul_f32 v146, v88, v146
  v_mfma_f32_16x16x32_bf16 v[180:183], a[136:139], v[200:203], v[180:183]
  s_add_u32 m0, s67, s65
  v_mul_f32 v147, v88, v147
  v_cvt_pk_bf16_f32 v73, v146, v147
  v_mfma_f32_16x16x32_bf16 v[180:183], a[140:143], v[204:207], v[180:183]
  v_mul_f32 v152, v88, v152
  v_mul_f32 v153, v88, v153
  v_mfma_f32_16x16x32_bf16 v[180:183], a[144:147], v[224:227], v[180:183]
  s_add_u32 s67, s67, 0x8000
  v_cvt_pk_bf16_f32 v74, v152, v153
  v_mul_f32 v154, v88, v154
  v_mfma_f32_16x16x32_bf16 v[180:183], a[148:151], v[228:231], v[180:183]
  s_and_b32 s67, s67, 0x1ffff
  v_add_u32 v5, s67, v1
  v_mul_f32 v155, v88, v155
  v_mfma_f32_16x16x32_bf16 v[180:183], a[152:155], v[232:235], v[180:183]
  s_waitcnt vmcnt(16) lgkmcnt(0)
  v_cvt_pk_bf16_f32 v75, v154, v155
  v_mul_f32 v148, v89, v148
  v_mfma_f32_16x16x32_bf16 v[180:183], a[156:159], v[236:239], v[180:183]
  s_barrier
  v_mul_f32 v149, v89, v149
  v_cvt_pk_bf16_f32 v76, v148, v149
  v_mfma_f32_16x16x32_bf16 v[184:187], a[160:163], v[128:131], 0
  s_add_u32 s16, s73, 0
  ds_read_b128 a[128:131], v5 offset:0
  ds_read_b128 a[132:135], v5 offset:1024
  v_mfma_f32_16x16x32_bf16 v[184:187], a[164:167], v[132:135], v[184:187]
  buffer_load_dwordx4 v3, s[12:15], s66 offen offset:0 sc1 lds
  v_mfma_f32_16x16x32_bf16 v[184:187], a[168:171], v[136:139], v[184:187]
  ds_read_b128 a[136:139], v5 offset:2048
  ds_read_b128 a[140:143], v5 offset:3072
  v_mfma_f32_16x16x32_bf16 v[184:187], a[172:175], v[140:143], v[184:187]
  ds_read_b128 a[144:147], v5 offset:4096
  v_mul_f32 v150, v89, v150
  v_mfma_f32_16x16x32_bf16 v[184:187], a[176:179], v[160:163], v[184:187]
  ds_read_b128 a[148:151], v5 offset:5120
  v_mul_f32 v151, v89, v151
  v_mfma_f32_16x16x32_bf16 v[184:187], a[180:183], v[164:167], v[184:187]
  buffer_store_dwordx4 v[72:75], v1, s[12:15], s16 offen sc1
  v_mfma_f32_16x16x32_bf16 v[184:187], a[184:187], v[168:171], v[184:187]
  ds_read_b128 a[152:155], v5 offset:6144
  v_cvt_pk_bf16_f32 v77, v150, v151
  v_mfma_f32_16x16x32_bf16 v[184:187], a[188:191], v[172:175], v[184:187]
  v_mul_f32 v156, v89, v156
  v_mul_f32 v157, v89, v157
  v_mfma_f32_16x16x32_bf16 v[188:191], a[160:163], v[192:195], 0
  ds_read_b128 a[156:159], v5 offset:7168
  v_cvt_pk_bf16_f32 v78, v156, v157
  v_mfma_f32_16x16x32_bf16 v[188:191], a[164:167], v[196:199], v[188:191]
  buffer_load_dwordx4 v3, s[12:15], s66 offen offset:1024 sc1 lds
  v_mfma_f32_16x16x32_bf16 v[188:191], a[168:171], v[200:203], v[188:191]
  ds_read_b128 a[160:163], v5 offset:8192
  v_mul_f32 v158, v89, v158
  v_mfma_f32_16x16x32_bf16 v[188:191], a[172:175], v[204:207], v[188:191]
  v_mul_f32 v159, v89, v159
  v_cvt_pk_bf16_f32 v79, v158, v159
  v_mfma_f32_16x16x32_bf16 v[188:191], a[176:179], v[224:227], v[188:191]
  s_add_u32 s17, s73, 2048
  ds_read_b128 a[164:167], v5 offset:9216
  v_and_b32 v13, 127, v13
  v_mfma_f32_16x16x32_bf16 v[188:191], a[180:183], v[228:231], v[188:191]
  buffer_store_dwordx4 v[76:79], v1, s[12:15], s17 offen sc1
  v_mfma_f32_16x16x32_bf16 v[188:191], a[184:187], v[232:235], v[188:191]
  ds_read_b128 a[168:171], v5 offset:10240
  v_readfirstlane_b32 s96, v12
  v_mfma_f32_16x16x32_bf16 v[188:191], a[188:191], v[236:239], v[188:191]
  s_waitcnt lgkmcnt(7)
  v_mul_f32 v176, v88, v176
  v_mul_f32 v177, v88, v177
  v_mfma_f32_16x16x32_bf16 v[144:147], a[128:131], v[128:131], 0
  s_lshr_b32 s97, s96, 2
  ds_read_b128 a[172:175], v5 offset:11264
  v_readlane_b32 s98, v7, s97
  v_mfma_f32_16x16x32_bf16 v[144:147], a[132:135], v[132:135], v[144:147]
  buffer_load_dwordx4 v3, s[12:15], s66 offen offset:2048 sc1 lds
  v_mfma_f32_16x16x32_bf16 v[144:147], a[136:139], v[136:139], v[144:147]
  ds_read_b128 a[176:179], v5 offset:12288
  v_readlane_b32 s97, v10, s97
  v_mfma_f32_16x16x32_bf16 v[144:147], a[140:143], v[140:143], v[144:147]
  s_waitcnt lgkmcnt(5)
  v_cvt_pk_bf16_f32 v80, v176, v177
  v_mul_f32 v178, v88, v178
  v_mfma_f32_16x16x32_bf16 v[144:147], a[144:147], v[160:163], v[144:147]
  s_bitcmp1_b32 s96, 1
  ds_read_b128 a[180:183], v5 offset:13312
  v_mul_f32 v179, v88, v179
  v_mfma_f32_16x16x32_bf16 v[144:147], a[148:151], v[164:167], v[144:147]
  s_cselect_b32 s98, s97, s98
  v_cvt_pk_bf16_f32 v81, v178, v179
  v_mul_f32 v184, v88, v184
  v_mfma_f32_16x16x32_bf16 v[144:147], a[152:155], v[168:171], v[144:147]
  s_lshl_b32 s96, s96, 4
  ds_read_b128 a[184:187], v5 offset:14336
  v_mul_f32 v185, v88, v185
  v_mfma_f32_16x16x32_bf16 v[144:147], a[156:159], v[172:175], v[144:147]
  v_cvt_pk_bf16_f32 v82, v184, v185
  v_mul_f32 v186, v88, v186
  v_mfma_f32_16x16x32_bf16 v[148:151], a[128:131], v[192:195], 0
  s_lshr_b32 s98, s98, s96
  ds_read_b128 a[188:191], v5 offset:15360
  v_mul_f32 v187, v88, v187
  v_mfma_f32_16x16x32_bf16 v[148:151], a[132:135], v[196:199], v[148:151]
  s_and_b32 s96, s98, 15
  buffer_load_dwordx4 v3, s[12:15], s66 offen offset:3072 sc1 lds
  v_mfma_f32_16x16x32_bf16 v[148:151], a[136:139], v[200:203], v[148:151]
  s_bfe_u32 s39, s98, 0x50004
  ds_read_b128 a[128:131], v5 offset:16384
  v_cvt_pk_bf16_f32 v83, v186, v187
  v_mfma_f32_16x16x32_bf16 v[148:151], a[140:143], v[204:207], v[148:151]
  v_mul_f32 v180, v89, v180
  v_mul_f32 v181, v89, v181
  v_mfma_f32_16x16x32_bf16 v[148:151], a[144:147], v[224:227], v[148:151]
  s_bfe_u32 s41, s98, 0x30009
  ds_read_b128 a[132:135], v5 offset:17408
  v_cvt_pk_bf16_f32 v84, v180, v181
  v_mfma_f32_16x16x32_bf16 v[148:151], a[148:151], v[228:231], v[148:151]
  s_lshl_b32 s40, s96, 6
  s_add_u32 s40, s40, s39
  s_andn2_b32 s40, s40, 3
  v_mfma_f32_16x16x32_bf16 v[148:151], a[152:155], v[232:235], v[148:151]
  s_add_u32 s40, s40, s64
  s_lshl_b32 s40, s40, 7
  s_add_u32 s40, s40, 38666240
  v_mfma_f32_16x16x32_bf16 v[148:151], a[156:159], v[236:239], v[148:151]
  s_waitcnt lgkmcnt(6)
  ds_read_b128 a[136:139], v5 offset:18432
  s_add_u32 m0, m0, 0x4000
  v_mfma_f32_16x16x32_bf16 v[152:155], a[160:163], v[128:131], 0
  s_mul_i32 s36, s96, 2637824
  s_mul_i32 s97, s64, 7
  s_lshr_b32 s98, s39, 2
  v_mfma_f32_16x16x32_bf16 v[152:155], a[164:167], v[132:135], v[152:155]
  s_add_u32 s97, s97, s98
  buffer_load_dwordx4 v4, s[12:15], s66 offen offset:0 sc1 lds
  v_mfma_f32_16x16x32_bf16 v[152:155], a[168:171], v[136:139], v[152:155]
  s_mul_i32 s97, s97, 94208
  ds_read_b128 a[140:143], v5 offset:19456
  s_add_u32 s36, s36, s97
  v_mfma_f32_16x16x32_bf16 v[152:155], a[172:175], v[140:143], v[152:155]
  s_waitcnt lgkmcnt(4)
  s_and_b32 s97, s39, 3
  s_lshl_b32 s97, s97, 10
  v_mfma_f32_16x16x32_bf16 v[152:155], a[176:179], v[160:163], v[152:155]
  s_add_u32 s36, s36, s97
  ds_read_b128 a[144:147], v5 offset:20480
  s_add_u32 s36, s36, 51380224
  v_mfma_f32_16x16x32_bf16 v[152:155], a[180:183], v[164:167], v[152:155]
  s_bfe_u32 s97, s39, 0x10001
  s_lshl1_add_u32 s96, s96, s97
  s_lshl2_add_u32 s96, s96, s64
  v_mfma_f32_16x16x32_bf16 v[152:155], a[184:187], v[168:171], v[152:155]
  s_mul_i32 s96, s96, 14336
  ds_read_b128 a[148:151], v5 offset:21504
  s_lshr_b32 s97, s39, 2
  v_mfma_f32_16x16x32_bf16 v[152:155], a[188:191], v[172:175], v[152:155]
  s_and_b32 s98, s39, 1
  s_lshl1_add_u32 s97, s97, s98
  v_mfma_f32_16x16x32_bf16 v[156:159], a[160:163], v[192:195], 0
  s_lshl_b32 s44, s97, 6
  ds_read_b128 a[152:155], v5 offset:22528
  s_add_u32 s42, s96, s44
  v_mfma_f32_16x16x32_bf16 v[156:159], a[164:167], v[196:199], v[156:159]
  s_add_u32 s43, s42, 57344
  buffer_load_dwordx4 v4, s[12:15], s66 offen offset:1024 sc1 lds
  v_mfma_f32_16x16x32_bf16 v[156:159], a[168:171], v[200:203], v[156:159]
  s_add_u32 s18, s73, 1024
  ds_read_b128 a[156:159], v5 offset:23552
  v_and_b32 v22, 0x3f803f80, v30
  v_mfma_f32_16x16x32_bf16 v[156:159], a[172:175], v[204:207], v[156:159]
  v_and_b32 v23, 0x3f803f80, v31
  v_and_b32 v28, 0x3f803f80, v30
  v_and_b32 v29, 0x3f803f80, v31
  v_mov_b32 v30, v28
  v_mov_b32 v31, v29
  s_mov_b32 s76, 0xbfb8aa3b
  s_mov_b32 s63, 0x4000
  s_mov_b32 s37, 0xff800000
  s_mov_b32 s45, 0
  v_mfma_f32_16x16x32_bf16 v[156:159], a[176:179], v[224:227], v[156:159]
  ds_read_b128 a[160:163], v5 offset:24576
  ds_read_b128 a[164:167], v5 offset:25600
  v_mfma_f32_16x16x32_bf16 v[156:159], a[180:183], v[228:231], v[156:159]
  buffer_store_dwordx4 v[80:83], v1, s[12:15], s18 offen sc1
  v_mfma_f32_16x16x32_bf16 v[156:159], a[184:187], v[232:235], v[156:159]
  buffer_load_dword v12, v13, s[12:15], s40 offen sc1
  v_mfma_f32_16x16x32_bf16 v[156:159], a[188:191], v[236:239], v[156:159]
  s_waitcnt lgkmcnt(6)
  ds_read_b128 a[168:171], v5 offset:26624
  v_mul_f32 v182, v89, v182
  v_mfma_f32_16x16x32_bf16 v[176:179], a[128:131], v[128:131], 0
  v_mul_f32 v183, v89, v183
  v_cvt_pk_bf16_f32 v85, v182, v183
  v_mfma_f32_16x16x32_bf16 v[176:179], a[132:135], v[132:135], v[176:179]
  buffer_load_dwordx4 v4, s[12:15], s66 offen offset:2048 sc1 lds
  v_mfma_f32_16x16x32_bf16 v[176:179], a[136:139], v[136:139], v[176:179]
  ds_read_b128 a[172:175], v5 offset:27648
  v_mul_f32 v188, v89, v188
  v_mfma_f32_16x16x32_bf16 v[176:179], a[140:143], v[140:143], v[176:179]
  s_waitcnt lgkmcnt(4)
  v_mul_f32 v189, v89, v189
  v_cvt_pk_bf16_f32 v86, v188, v189
  v_mfma_f32_16x16x32_bf16 v[176:179], a[144:147], v[160:163], v[176:179]
  ds_read_b128 a[176:179], v5 offset:28672
  v_mul_f32 v190, v89, v190
  v_mfma_f32_16x16x32_bf16 v[176:179], a[148:151], v[164:167], v[176:179]
  v_mul_f32 v191, v89, v191
  v_cvt_pk_bf16_f32 v87, v190, v191
  s_add_u32 s19, s73, 3072
  buffer_store_dwordx4 v[84:87], v1, s[12:15], s19 offen sc1
  v_mfma_f32_16x16x32_bf16 v[176:179], a[152:155], v[168:171], v[176:179]
  ds_read_b128 a[180:183], v5 offset:29696
  v_mul_f32 v144, v88, v144
  v_mfma_f32_16x16x32_bf16 v[176:179], a[156:159], v[172:175], v[176:179]
  v_mul_f32 v145, v88, v145
  v_cvt_pk_bf16_f32 v72, v144, v145
  v_mfma_f32_16x16x32_bf16 v[180:183], a[128:131], v[192:195], 0
  ds_read_b128 a[184:187], v5 offset:30720
  buffer_load_dwordx4 v4, s[12:15], s66 offen offset:3072 sc1 lds
  v_mfma_f32_16x16x32_bf16 v[180:183], a[132:135], v[196:199], v[180:183]
  s_add_u32 s66, s66, 0x8000
  ds_read_b128 a[188:191], v5 offset:31744
  v_mul_f32 v146, v88, v146
  v_mfma_f32_16x16x32_bf16 v[180:183], a[136:139], v[200:203], v[180:183]
  s_add_u32 m0, s67, s65
  v_mul_f32 v147, v88, v147
  v_cvt_pk_bf16_f32 v73, v146, v147
  v_mfma_f32_16x16x32_bf16 v[180:183], a[140:143], v[204:207], v[180:183]
  v_mul_f32 v152, v88, v152
  v_mul_f32 v153, v88, v153
  v_cvt_pk_bf16_f32 v74, v152, v153
  v_mul_f32 v154, v88, v154
  v_mul_f32 v155, v88, v155
  v_cvt_pk_bf16_f32 v75, v154, v155
  s_add_u32 s16, s73, 94208
  buffer_store_dwordx4 v[72:75], v1, s[12:15], s16 offen sc1
  v_mfma_f32_16x16x32_bf16 v[180:183], a[144:147], v[224:227], v[180:183]
  s_add_u32 s67, s67, 0x8000
  v_mul_f32 v148, v89, v148
  v_mul_f32 v149, v89, v149
  v_mfma_f32_16x16x32_bf16 v[180:183], a[148:151], v[228:231], v[180:183]
  s_and_b32 s67, s67, 0x1ffff
  v_cvt_pk_bf16_f32 v76, v148, v149
  v_mul_f32 v150, v89, v150
  v_mfma_f32_16x16x32_bf16 v[180:183], a[152:155], v[232:235], v[180:183]
  s_waitcnt vmcnt(22) lgkmcnt(0)
  v_mul_f32 v151, v89, v151
  v_cvt_pk_bf16_f32 v77, v150, v151
  v_mfma_f32_16x16x32_bf16 v[180:183], a[156:159], v[236:239], v[180:183]
  s_barrier
  v_add_u32 v5, s67, v1
  v_mul_f32 v156, v89, v156
  v_mfma_f32_16x16x32_bf16 v[184:187], a[160:163], v[128:131], 0
  v_mul_f32 v157, v89, v157
  v_cvt_pk_bf16_f32 v78, v156, v157
  v_mfma_f32_16x16x32_bf16 v[184:187], a[164:167], v[132:135], v[184:187]
  buffer_load_dwordx4 v3, s[12:15], s66 offen offset:0 sc1 lds
  v_mfma_f32_16x16x32_bf16 v[184:187], a[168:171], v[136:139], v[184:187]
  ds_read_b128 a[128:131], v5 offset:0
  ds_read_b128 a[132:135], v5 offset:1024
  ds_read_b128 a[136:139], v5 offset:2048
  ds_read_b128 a[140:143], v5 offset:3072
  v_mfma_f32_16x16x32_bf16 v[184:187], a[172:175], v[140:143], v[184:187]
  v_mul_f32 v158, v89, v158
  v_mul_f32 v159, v89, v159
  v_cvt_pk_bf16_f32 v79, v158, v159
  s_add_u32 s17, s73, 96256
  buffer_store_dwordx4 v[76:79], v1, s[12:15], s17 offen sc1
  v_mfma_f32_16x16x32_bf16 v[184:187], a[176:179], v[160:163], v[184:187]
  ds_read_b128 a[144:147], v5 offset:4096
  ds_read_b128 a[148:151], v5 offset:5120
  v_mfma_f32_16x16x32_bf16 v[184:187], a[180:183], v[164:167], v[184:187]
  v_mul_f32 v176, v88, v176
  v_mul_f32 v177, v88, v177
  v_mfma_f32_16x16x32_bf16 v[184:187], a[184:187], v[168:171], v[184:187]
  ds_read_b128 a[152:155], v5 offset:6144
  v_cvt_pk_bf16_f32 v80, v176, v177
  v_mfma_f32_16x16x32_bf16 v[184:187], a[188:191], v[172:175], v[184:187]
  v_mul_f32 v178, v88, v178
  v_mul_f32 v179, v88, v179
  v_mfma_f32_16x16x32_bf16 v[188:191], a[160:163], v[192:195], 0
  ds_read_b128 a[156:159], v5 offset:7168
  v_cvt_pk_bf16_f32 v81, v178, v179
  v_mfma_f32_16x16x32_bf16 v[188:191], a[164:167], v[196:199], v[188:191]
  buffer_load_dwordx4 v3, s[12:15], s66 offen offset:1024 sc1 lds
  v_mfma_f32_16x16x32_bf16 v[188:191], a[168:171], v[200:203], v[188:191]
  ds_read_b128 a[160:163], v5 offset:8192
  v_mul_f32 v184, v88, v184
  v_mfma_f32_16x16x32_bf16 v[188:191], a[172:175], v[204:207], v[188:191]
  v_mul_f32 v185, v88, v185
  v_cvt_pk_bf16_f32 v82, v184, v185
  v_mfma_f32_16x16x32_bf16 v[188:191], a[176:179], v[224:227], v[188:191]
  ds_read_b128 a[164:167], v5 offset:9216
  v_mul_f32 v186, v88, v186
  v_mfma_f32_16x16x32_bf16 v[188:191], a[180:183], v[228:231], v[188:191]
  v_mul_f32 v187, v88, v187
  v_cvt_pk_bf16_f32 v83, v186, v187
  v_mfma_f32_16x16x32_bf16 v[188:191], a[184:187], v[232:235], v[188:191]
  s_add_u32 s18, s73, 95232
  ds_read_b128 a[168:171], v5 offset:10240
  v_mul_f32 v180, v89, v180
  v_mfma_f32_16x16x32_bf16 v[188:191], a[188:191], v[236:239], v[188:191]
  s_waitcnt lgkmcnt(7)
  buffer_store_dwordx4 v[80:83], v1, s[12:15], s18 offen sc1
  v_mfma_f32_16x16x32_bf16 v[144:147], a[128:131], v[128:131], 0
  ds_read_b128 a[172:175], v5 offset:11264
  v_mul_f32 v181, v89, v181
  v_mfma_f32_16x16x32_bf16 v[144:147], a[132:135], v[132:135], v[144:147]
  buffer_load_dwordx4 v3, s[12:15], s66 offen offset:2048 sc1 lds
  v_mfma_f32_16x16x32_bf16 v[144:147], a[136:139], v[136:139], v[144:147]
  ds_read_b128 a[176:179], v5 offset:12288
  v_cvt_pk_bf16_f32 v84, v180, v181
  v_mfma_f32_16x16x32_bf16 v[144:147], a[140:143], v[140:143], v[144:147]
  s_waitcnt lgkmcnt(5)
  v_mul_f32 v182, v89, v182
  v_mul_f32 v183, v89, v183
  v_mfma_f32_16x16x32_bf16 v[144:147], a[144:147], v[160:163], v[144:147]
  ds_read_b128 a[180:183], v5 offset:13312
  v_cvt_pk_bf16_f32 v85, v182, v183
  v_mfma_f32_16x16x32_bf16 v[144:147], a[148:151], v[164:167], v[144:147]
  v_mul_f32 v188, v89, v188
  v_mul_f32 v189, v89, v189
  v_mfma_f32_16x16x32_bf16 v[144:147], a[152:155], v[168:171], v[144:147]
  ds_read_b128 a[184:187], v5 offset:14336
  v_cvt_pk_bf16_f32 v86, v188, v189
  v_mfma_f32_16x16x32_bf16 v[144:147], a[156:159], v[172:175], v[144:147]
  v_mul_f32 v190, v89, v190
  v_mul_f32 v191, v89, v191
  v_mfma_f32_16x16x32_bf16 v[148:151], a[128:131], v[192:195], 0
  ds_read_b128 a[188:191], v5 offset:15360
  v_cvt_pk_bf16_f32 v87, v190, v191
  v_mfma_f32_16x16x32_bf16 v[148:151], a[132:135], v[196:199], v[148:151]
  s_add_u32 s19, s73, 97280
  buffer_load_dwordx4 v3, s[12:15], s66 offen offset:3072 sc1 lds
  v_mfma_f32_16x16x32_bf16 v[148:151], a[136:139], v[200:203], v[148:151]
  s_add_u32 m0, m0, 0x4000
  ds_read_b128 a[128:131], v5 offset:16384
  v_mul_f32 v144, v88, v144
  v_mfma_f32_16x16x32_bf16 v[148:151], a[140:143], v[204:207], v[148:151]
  buffer_store_dwordx4 v[84:87], v1, s[12:15], s19 offen sc1
  v_mfma_f32_16x16x32_bf16 v[148:151], a[144:147], v[224:227], v[148:151]
  ds_read_b128 a[132:135], v5 offset:17408
  v_mul_f32 v145, v88, v145
  v_mfma_f32_16x16x32_bf16 v[148:151], a[148:151], v[228:231], v[148:151]
  v_cvt_pk_bf16_f32 v72, v144, v145
  v_mul_f32 v146, v88, v146
  v_mfma_f32_16x16x32_bf16 v[148:151], a[152:155], v[232:235], v[148:151]
  ds_read_b128 a[136:139], v5 offset:18432
  v_mul_f32 v147, v88, v147
  v_mfma_f32_16x16x32_bf16 v[148:151], a[156:159], v[236:239], v[148:151]
  s_waitcnt lgkmcnt(7)
  v_cvt_pk_bf16_f32 v73, v146, v147
  v_mfma_f32_16x16x32_bf16 v[152:155], a[160:163], v[128:131], 0
  ds_read_b128 a[140:143], v5 offset:19456
  v_mfma_f32_16x16x32_bf16 v[152:155], a[164:167], v[132:135], v[152:155]
  buffer_load_dwordx4 v4, s[12:15], s66 offen offset:0 sc1 lds
  v_mfma_f32_16x16x32_bf16 v[152:155], a[168:171], v[136:139], v[152:155]
  ds_read_b128 a[144:147], v5 offset:20480
  v_mfma_f32_16x16x32_bf16 v[152:155], a[172:175], v[140:143], v[152:155]
  s_waitcnt lgkmcnt(5)
  v_mul_f32 v148, v89, v148
  v_mul_f32 v149, v89, v149
  v_mfma_f32_16x16x32_bf16 v[152:155], a[176:179], v[160:163], v[152:155]
  ds_read_b128 a[148:151], v5 offset:21504
  v_cvt_pk_bf16_f32 v76, v148, v149
  v_mfma_f32_16x16x32_bf16 v[152:155], a[180:183], v[164:167], v[152:155]
  v_mul_f32 v150, v89, v150
  v_mul_f32 v151, v89, v151
  v_mfma_f32_16x16x32_bf16 v[152:155], a[184:187], v[168:171], v[152:155]
  ds_read_b128 a[152:155], v5 offset:22528
  v_cvt_pk_bf16_f32 v77, v150, v151
  v_mfma_f32_16x16x32_bf16 v[152:155], a[188:191], v[172:175], v[152:155]
  v_mfma_f32_16x16x32_bf16 v[156:159], a[160:163], v[192:195], 0
  ds_read_b128 a[156:159], v5 offset:23552
  v_mfma_f32_16x16x32_bf16 v[156:159], a[164:167], v[196:199], v[156:159]
  buffer_load_dwordx4 v4, s[12:15], s66 offen offset:1024 sc1 lds
  v_mfma_f32_16x16x32_bf16 v[156:159], a[168:171], v[200:203], v[156:159]
  ds_read_b128 a[160:163], v5 offset:24576
  v_mfma_f32_16x16x32_bf16 v[156:159], a[172:175], v[204:207], v[156:159]
  v_mfma_f32_16x16x32_bf16 v[156:159], a[176:179], v[224:227], v[156:159]
  ds_read_b128 a[164:167], v5 offset:25600
  v_mul_f32 v152, v88, v152
  v_mfma_f32_16x16x32_bf16 v[156:159], a[180:183], v[228:231], v[156:159]
  v_mul_f32 v153, v88, v153
  v_cvt_pk_bf16_f32 v74, v152, v153
  v_mfma_f32_16x16x32_bf16 v[156:159], a[184:187], v[232:235], v[156:159]
  ds_read_b128 a[168:171], v5 offset:26624
  v_mul_f32 v154, v88, v154
  v_mfma_f32_16x16x32_bf16 v[156:159], a[188:191], v[236:239], v[156:159]
  s_waitcnt lgkmcnt(7)
  v_mul_f32 v155, v88, v155
  v_cvt_pk_bf16_f32 v75, v154, v155
  v_mfma_f32_16x16x32_bf16 v[176:179], a[128:131], v[128:131], 0
  s_add_u32 s16, s73, 188416
  ds_read_b128 a[172:175], v5 offset:27648
  v_mfma_f32_16x16x32_bf16 v[176:179], a[132:135], v[132:135], v[176:179]
  buffer_load_dwordx4 v4, s[12:15], s66 offen offset:2048 sc1 lds
  v_mfma_f32_16x16x32_bf16 v[176:179], a[136:139], v[136:139], v[176:179]
  ds_read_b128 a[176:179], v5 offset:28672
  v_mul_f32 v156, v89, v156
  v_mfma_f32_16x16x32_bf16 v[176:179], a[140:143], v[140:143], v[176:179]
  s_waitcnt lgkmcnt(5)
  buffer_store_dwordx4 v[72:75], v1, s[12:15], s16 offen sc1
  v_mfma_f32_16x16x32_bf16 v[176:179], a[144:147], v[160:163], v[176:179]
  ds_read_b128 a[180:183], v5 offset:29696
  v_mul_f32 v157, v89, v157
  v_mfma_f32_16x16x32_bf16 v[176:179], a[148:151], v[164:167], v[176:179]
  v_cvt_pk_bf16_f32 v78, v156, v157
  v_mul_f32 v158, v89, v158
  v_mfma_f32_16x16x32_bf16 v[176:179], a[152:155], v[168:171], v[176:179]
  ds_read_b128 a[184:187], v5 offset:30720
  v_mul_f32 v159, v89, v159
  v_mfma_f32_16x16x32_bf16 v[176:179], a[156:159], v[172:175], v[176:179]
  v_cvt_pk_bf16_f32 v79, v158, v159
  v_mfma_f32_16x16x32_bf16 v[180:183], a[128:131], v[192:195], 0
  s_add_u32 s17, s73, 190464
  buffer_load_dwordx4 v4, s[12:15], s66 offen offset:3072 sc1 lds
  v_mfma_f32_16x16x32_bf16 v[180:183], a[132:135], v[196:199], v[180:183]
  s_add_u32 s66, s66, 0x8000
  ds_read_b128 a[188:191], v5 offset:31744
  v_mfma_f32_16x16x32_bf16 v[180:183], a[136:139], v[200:203], v[180:183]
  s_add_u32 m0, s67, s65
  buffer_store_dwordx4 v[76:79], v1, s[12:15], s17 offen sc1
  v_mfma_f32_16x16x32_bf16 v[180:183], a[140:143], v[204:207], v[180:183]
  v_mul_f32 v176, v88, v176
  v_mul_f32 v177, v88, v177
  v_mfma_f32_16x16x32_bf16 v[180:183], a[144:147], v[224:227], v[180:183]
  s_add_u32 s67, s67, 0x8000
  v_cvt_pk_bf16_f32 v80, v176, v177
  v_mul_f32 v178, v88, v178
  v_mfma_f32_16x16x32_bf16 v[180:183], a[148:151], v[228:231], v[180:183]
  s_and_b32 s67, s67, 0x1ffff
  v_add_u32 v5, s67, v1
  v_mul_f32 v179, v88, v179
  v_mfma_f32_16x16x32_bf16 v[180:183], a[152:155], v[232:235], v[180:183]
  s_waitcnt vmcnt(27) lgkmcnt(0)
  v_cvt_pk_bf16_f32 v81, v178, v179
  v_mfma_f32_16x16x32_bf16 v[180:183], a[156:159], v[236:239], v[180:183]
  s_barrier
  v_mfma_f32_16x16x32_bf16 v[184:187], a[160:163], v[128:131], 0
  ds_read_b128 a[128:131], v5 offset:0
  ds_read_b128 a[132:135], v5 offset:1024
  v_mfma_f32_16x16x32_bf16 v[184:187], a[164:167], v[132:135], v[184:187]
  buffer_load_dwordx4 v3, s[12:15], s66 offen offset:0 sc1 lds
  v_mfma_f32_16x16x32_bf16 v[184:187], a[168:171], v[136:139], v[184:187]
  ds_read_b128 a[136:139], v5 offset:2048
  ds_read_b128 a[140:143], v5 offset:3072
  v_mfma_f32_16x16x32_bf16 v[184:187], a[172:175], v[140:143], v[184:187]
  ds_read_b128 a[144:147], v5 offset:4096
  v_mul_f32 v180, v89, v180
  v_mfma_f32_16x16x32_bf16 v[184:187], a[176:179], v[160:163], v[184:187]
  ds_read_b128 a[148:151], v5 offset:5120
  v_mul_f32 v181, v89, v181
  v_mfma_f32_16x16x32_bf16 v[184:187], a[180:183], v[164:167], v[184:187]
  v_cvt_pk_bf16_f32 v84, v180, v181
  v_mul_f32 v182, v89, v182
  v_mfma_f32_16x16x32_bf16 v[184:187], a[184:187], v[168:171], v[184:187]
  ds_read_b128 a[152:155], v5 offset:6144
  v_mul_f32 v183, v89, v183
  v_mfma_f32_16x16x32_bf16 v[184:187], a[188:191], v[172:175], v[184:187]
  v_cvt_pk_bf16_f32 v85, v182, v183
  v_mfma_f32_16x16x32_bf16 v[188:191], a[160:163], v[192:195], 0
  ds_read_b128 a[156:159], v5 offset:7168
  v_mfma_f32_16x16x32_bf16 v[188:191], a[164:167], v[196:199], v[188:191]
  buffer_load_dwordx4 v3, s[12:15], s66 offen offset:1024 sc1 lds
  v_mfma_f32_16x16x32_bf16 v[188:191], a[168:171], v[200:203], v[188:191]
  ds_read_b128 a[160:163], v5 offset:8192
  v_mfma_f32_16x16x32_bf16 v[188:191], a[172:175], v[204:207], v[188:191]
  v_mul_f32 v184, v88, v184
  v_mul_f32 v185, v88, v185
  v_mfma_f32_16x16x32_bf16 v[188:191], a[176:179], v[224:227], v[188:191]
  ds_read_b128 a[164:167], v5 offset:9216
  v_cvt_pk_bf16_f32 v82, v184, v185
  v_mfma_f32_16x16x32_bf16 v[188:191], a[180:183], v[228:231], v[188:191]
  v_mul_f32 v186, v88, v186
  v_mul_f32 v187, v88, v187
  v_mfma_f32_16x16x32_bf16 v[188:191], a[184:187], v[232:235], v[188:191]
  ds_read_b128 a[168:171], v5 offset:10240
  v_cvt_pk_bf16_f32 v83, v186, v187
  v_mfma_f32_16x16x32_bf16 v[188:191], a[188:191], v[236:239], v[188:191]
  s_waitcnt lgkmcnt(7)
  v_mfma_f32_16x16x32_bf16 v[144:147], a[128:131], v[128:131], 0
  s_add_u32 s18, s73, 189440
  ds_read_b128 a[172:175], v5 offset:11264
  v_mfma_f32_16x16x32_bf16 v[144:147], a[132:135], v[132:135], v[144:147]
  buffer_load_dwordx4 v3, s[12:15], s66 offen offset:2048 sc1 lds
  v_mfma_f32_16x16x32_bf16 v[144:147], a[136:139], v[136:139], v[144:147]
  ds_read_b128 a[176:179], v5 offset:12288
  v_mfma_f32_16x16x32_bf16 v[144:147], a[140:143], v[140:143], v[144:147]
  s_waitcnt lgkmcnt(5)
  buffer_store_dwordx4 v[80:83], v1, s[12:15], s18 offen sc1
  v_mfma_f32_16x16x32_bf16 v[144:147], a[144:147], v[160:163], v[144:147]
  ds_read_b128 a[180:183], v5 offset:13312
  v_mul_f32 v188, v89, v188
  v_mfma_f32_16x16x32_bf16 v[144:147], a[148:151], v[164:167], v[144:147]
  v_mul_f32 v189, v89, v189
  v_cvt_pk_bf16_f32 v86, v188, v189
  v_mfma_f32_16x16x32_bf16 v[144:147], a[152:155], v[168:171], v[144:147]
  ds_read_b128 a[184:187], v5 offset:14336
  v_mul_f32 v190, v89, v190
  v_mfma_f32_16x16x32_bf16 v[144:147], a[156:159], v[172:175], v[144:147]
  v_mul_f32 v191, v89, v191
  v_cvt_pk_bf16_f32 v87, v190, v191
  v_mfma_f32_16x16x32_bf16 v[148:151], a[128:131], v[192:195], 0
  s_add_u32 s19, s73, 191488
  ds_read_b128 a[188:191], v5 offset:15360
  v_mfma_f32_16x16x32_bf16 v[148:151], a[132:135], v[196:199], v[148:151]
  buffer_load_dwordx4 v3, s[12:15], s66 offen offset:3072 sc1 lds
  v_mfma_f32_16x16x32_bf16 v[148:151], a[136:139], v[200:203], v[148:151]
  s_add_u32 m0, m0, 0x4000
  ds_read_b128 a[128:131], v5 offset:16384
  v_mul_f32 v144, v88, v144
  v_mfma_f32_16x16x32_bf16 v[148:151], a[140:143], v[204:207], v[148:151]
  buffer_store_dwordx4 v[84:87], v1, s[12:15], s19 offen sc1
  v_mfma_f32_16x16x32_bf16 v[148:151], a[144:147], v[224:227], v[148:151]
  ds_read_b128 a[132:135], v5 offset:17408
  v_mul_f32 v145, v88, v145
  v_mfma_f32_16x16x32_bf16 v[148:151], a[148:151], v[228:231], v[148:151]
  v_cvt_pk_bf16_f32 v72, v144, v145
  v_mul_f32 v146, v88, v146
  v_mfma_f32_16x16x32_bf16 v[148:151], a[152:155], v[232:235], v[148:151]
  ds_read_b128 a[136:139], v5 offset:18432
  v_mul_f32 v147, v88, v147
  v_mfma_f32_16x16x32_bf16 v[148:151], a[156:159], v[236:239], v[148:151]
  s_waitcnt lgkmcnt(7)
  v_cvt_pk_bf16_f32 v73, v146, v147
  v_mfma_f32_16x16x32_bf16 v[152:155], a[160:163], v[128:131], 0
  ds_read_b128 a[140:143], v5 offset:19456
  v_mfma_f32_16x16x32_bf16 v[152:155], a[164:167], v[132:135], v[152:155]
  buffer_load_dwordx4 v4, s[12:15], s66 offen offset:0 sc1 lds
  v_mfma_f32_16x16x32_bf16 v[152:155], a[168:171], v[136:139], v[152:155]
  ds_read_b128 a[144:147], v5 offset:20480
  v_mfma_f32_16x16x32_bf16 v[152:155], a[172:175], v[140:143], v[152:155]
  s_waitcnt lgkmcnt(5)
  v_mul_f32 v148, v89, v148
  v_mul_f32 v149, v89, v149
  v_mfma_f32_16x16x32_bf16 v[152:155], a[176:179], v[160:163], v[152:155]
  ds_read_b128 a[148:151], v5 offset:21504
  v_cvt_pk_bf16_f32 v76, v148, v149
  v_mfma_f32_16x16x32_bf16 v[152:155], a[180:183], v[164:167], v[152:155]
  v_mul_f32 v150, v89, v150
  v_mul_f32 v151, v89, v151
  v_mfma_f32_16x16x32_bf16 v[152:155], a[184:187], v[168:171], v[152:155]
  ds_read_b128 a[152:155], v5 offset:22528
  v_cvt_pk_bf16_f32 v77, v150, v151
  v_mfma_f32_16x16x32_bf16 v[152:155], a[188:191], v[172:175], v[152:155]
  v_mfma_f32_16x16x32_bf16 v[156:159], a[160:163], v[192:195], 0
  ds_read_b128 a[156:159], v5 offset:23552
  v_mfma_f32_16x16x32_bf16 v[156:159], a[164:167], v[196:199], v[156:159]
  buffer_load_dwordx4 v4, s[12:15], s66 offen offset:1024 sc1 lds
  v_mfma_f32_16x16x32_bf16 v[156:159], a[168:171], v[200:203], v[156:159]
  ds_read_b128 a[160:163], v5 offset:24576
  v_mfma_f32_16x16x32_bf16 v[156:159], a[172:175], v[204:207], v[156:159]
  v_mfma_f32_16x16x32_bf16 v[156:159], a[176:179], v[224:227], v[156:159]
  ds_read_b128 a[164:167], v5 offset:25600
  v_mul_f32 v152, v88, v152
  v_mfma_f32_16x16x32_bf16 v[156:159], a[180:183], v[228:231], v[156:159]
  v_mul_f32 v153, v88, v153
  v_cvt_pk_bf16_f32 v74, v152, v153
  v_mfma_f32_16x16x32_bf16 v[156:159], a[184:187], v[232:235], v[156:159]
  ds_read_b128 a[168:171], v5 offset:26624
  v_mul_f32 v154, v88, v154
  v_mfma_f32_16x16x32_bf16 v[156:159], a[188:191], v[236:239], v[156:159]
  s_waitcnt lgkmcnt(7)
  v_mul_f32 v155, v88, v155
  v_cvt_pk_bf16_f32 v75, v154, v155
  v_mfma_f32_16x16x32_bf16 v[176:179], a[128:131], v[128:131], 0
  s_add_u32 s16, s73, 282624
  ds_read_b128 a[172:175], v5 offset:27648
  s_waitcnt vmcnt(25)
  v_cmp_eq_u32 vcc, 0, v12
  v_mfma_f32_16x16x32_bf16 v[176:179], a[132:135], v[132:135], v[176:179]
  s_and_b32 s97, vcc_lo, 0xffff
  buffer_load_dwordx4 v4, s[12:15], s66 offen offset:2048 sc1 lds
  v_mfma_f32_16x16x32_bf16 v[176:179], a[136:139], v[136:139], v[176:179]
  s_xor_b32 s98, s41, 2
  ds_read_b128 a[176:179], v5 offset:28672
  v_mul_f32 v156, v89, v156
  v_mfma_f32_16x16x32_bf16 v[176:179], a[140:143], v[140:143], v[176:179]
  s_waitcnt lgkmcnt(5)
  buffer_store_dwordx4 v[72:75], v1, s[12:15], s16 offen sc1
  v_mfma_f32_16x16x32_bf16 v[176:179], a[144:147], v[160:163], v[176:179]
  s_or_b32 s38, s97, s98
  ds_read_b128 a[180:183], v5 offset:29696
  v_mul_f32 v157, v89, v157
  v_mfma_f32_16x16x32_bf16 v[176:179], a[148:151], v[164:167], v[176:179]
  v_cvt_pk_bf16_f32 v78, v156, v157
  v_mul_f32 v158, v89, v158
  v_mfma_f32_16x16x32_bf16 v[176:179], a[152:155], v[168:171], v[176:179]
  ds_read_b128 a[184:187], v5 offset:30720
  v_mul_f32 v159, v89, v159
  v_mfma_f32_16x16x32_bf16 v[176:179], a[156:159], v[172:175], v[176:179]
  v_cvt_pk_bf16_f32 v79, v158, v159
  v_mfma_f32_16x16x32_bf16 v[180:183], a[128:131], v[192:195], 0
  s_add_u32 s17, s73, 284672
  buffer_load_dwordx4 v4, s[12:15], s66 offen offset:3072 sc1 lds
  v_mfma_f32_16x16x32_bf16 v[180:183], a[132:135], v[196:199], v[180:183]
  s_add_u32 s67, s67, 0x8000
  ds_read_b128 a[188:191], v5 offset:31744
  v_mfma_f32_16x16x32_bf16 v[180:183], a[136:139], v[200:203], v[180:183]
  s_and_b32 s67, s67, 0x1ffff
  v_add_u32 v5, s67, v1
  v_mul_f32 v176, v88, v176
  v_mfma_f32_16x16x32_bf16 v[180:183], a[140:143], v[204:207], v[180:183]
  buffer_store_dwordx4 v[76:79], v1, s[12:15], s17 offen sc1
  v_mfma_f32_16x16x32_bf16 v[180:183], a[144:147], v[224:227], v[180:183]
  v_mul_f32 v177, v88, v177
  v_cvt_pk_bf16_f32 v80, v176, v177
  v_mfma_f32_16x16x32_bf16 v[180:183], a[148:151], v[228:231], v[180:183]
  v_mul_f32 v178, v88, v178
  v_mul_f32 v179, v88, v179
  v_mfma_f32_16x16x32_bf16 v[180:183], a[152:155], v[232:235], v[180:183]
  s_waitcnt vmcnt(26) lgkmcnt(0)
  v_cvt_pk_bf16_f32 v81, v178, v179
  v_mfma_f32_16x16x32_bf16 v[180:183], a[156:159], v[236:239], v[180:183]
  s_barrier
  v_mfma_f32_16x16x32_bf16 v[184:187], a[160:163], v[128:131], 0
  ds_read_b128 a[128:131], v5 offset:0
  ds_read_b128 a[132:135], v5 offset:1024
  s_cmp_eq_u32 s38, 0
  s_cbranch_scc1 L_kf_kernel_opb_99
  v_mfma_f32_16x16x32_bf16 v[184:187], a[164:167], v[132:135], v[184:187]
  ds_read_b128 a[136:139], v5 offset:2048
  ds_read_b128 a[140:143], v5 offset:3072
  v_mfma_f32_16x16x32_bf16 v[184:187], a[168:171], v[136:139], v[184:187]
  ds_read_b128 a[144:147], v5 offset:4096
  v_mul_f32 v180, v89, v180
  v_mfma_f32_16x16x32_bf16 v[184:187], a[172:175], v[140:143], v[184:187]
  v_mul_f32 v181, v89, v181
  v_cvt_pk_bf16_f32 v84, v180, v181
  v_mfma_f32_16x16x32_bf16 v[184:187], a[176:179], v[160:163], v[184:187]
  ds_read_b128 a[148:151], v5 offset:5120
  v_mul_f32 v182, v89, v182
  v_mfma_f32_16x16x32_bf16 v[184:187], a[180:183], v[164:167], v[184:187]
  v_mul_f32 v183, v89, v183
  v_cvt_pk_bf16_f32 v85, v182, v183
  v_mfma_f32_16x16x32_bf16 v[184:187], a[184:187], v[168:171], v[184:187]
  ds_read_b128 a[152:155], v5 offset:6144
  v_mfma_f32_16x16x32_bf16 v[184:187], a[188:191], v[172:175], v[184:187]
  v_mfma_f32_16x16x32_bf16 v[188:191], a[160:163], v[192:195], 0
  ds_read_b128 a[156:159], v5 offset:7168
  v_mfma_f32_16x16x32_bf16 v[188:191], a[164:167], v[196:199], v[188:191]
  v_mfma_f32_16x16x32_bf16 v[188:191], a[168:171], v[200:203], v[188:191]
  s_nop 0
  ds_read_b128 a[160:163], v5 offset:8192
  v_mfma_f32_16x16x32_bf16 v[188:191], a[172:175], v[204:207], v[188:191]
  buffer_store_dword v11, v0, s[12:15], s74 offen offset:0 sc1
  v_mfma_f32_16x16x32_bf16 v[188:191], a[176:179], v[224:227], v[188:191]
  ds_read_b128 a[164:167], v5 offset:9216
  v_mul_f32 v184, v88, v184
  v_mfma_f32_16x16x32_bf16 v[188:191], a[180:183], v[228:231], v[188:191]
  buffer_load_dwordx2 v[112:113], v9, s[20:23], s44 offen offset:0
  v_mfma_f32_16x16x32_bf16 v[188:191], a[184:187], v[232:235], v[188:191]
  ds_read_b128 a[168:171], v5 offset:10240
  v_mul_f32 v185, v88, v185
  v_mfma_f32_16x16x32_bf16 v[188:191], a[188:191], v[236:239], v[188:191]
  s_waitcnt lgkmcnt(7)
  v_cvt_pk_bf16_f32 v82, v184, v185
  v_mul_f32 v186, v88, v186
  v_mfma_f32_16x16x32_bf16 v[144:147], a[128:131], v[128:131], 0
  ds_read_b128 a[172:175], v5 offset:11264
  v_mul_f32 v187, v88, v187
  v_mfma_f32_16x16x32_bf16 v[144:147], a[132:135], v[132:135], v[144:147]
  v_cvt_pk_bf16_f32 v83, v186, v187
  v_mfma_f32_16x16x32_bf16 v[144:147], a[136:139], v[136:139], v[144:147]
  s_add_u32 s18, s73, 283648
  ds_read_b128 a[176:179], v5 offset:12288
  v_mul_f32 v188, v89, v188
  v_mfma_f32_16x16x32_bf16 v[144:147], a[140:143], v[140:143], v[144:147]
  s_waitcnt lgkmcnt(5)
  buffer_store_dwordx4 v[80:83], v1, s[12:15], s18 offen sc1
  v_mfma_f32_16x16x32_bf16 v[144:147], a[144:147], v[160:163], v[144:147]
  ds_read_b128 a[180:183], v5 offset:13312
  v_mul_f32 v189, v89, v189
  v_mfma_f32_16x16x32_bf16 v[144:147], a[148:151], v[164:167], v[144:147]
  buffer_load_dwordx2 v[114:115], v9, s[20:23], s44 offen offset:32
  v_mfma_f32_16x16x32_bf16 v[144:147], a[152:155], v[168:171], v[144:147]
  ds_read_b128 a[184:187], v5 offset:14336
  v_cvt_pk_bf16_f32 v86, v188, v189
  v_mfma_f32_16x16x32_bf16 v[144:147], a[156:159], v[172:175], v[144:147]
  v_mul_f32 v190, v89, v190
  v_mul_f32 v191, v89, v191
  v_mfma_f32_16x16x32_bf16 v[148:151], a[128:131], v[192:195], 0
  ds_read_b128 a[188:191], v5 offset:15360
  v_cvt_pk_bf16_f32 v87, v190, v191
  v_mfma_f32_16x16x32_bf16 v[148:151], a[132:135], v[196:199], v[148:151]
  s_add_u32 s19, s73, 285696
  buffer_store_dwordx4 v[84:87], v1, s[12:15], s19 offen sc1
  v_mfma_f32_16x16x32_bf16 v[148:151], a[136:139], v[200:203], v[148:151]
  ds_read_b128 a[128:131], v5 offset:16384
  v_mul_f32 v144, v88, v144
  v_mfma_f32_16x16x32_bf16 v[148:151], a[140:143], v[204:207], v[148:151]
  v_mul_f32 v145, v88, v145
  v_cvt_pk_bf16_f32 v72, v144, v145
  v_mfma_f32_16x16x32_bf16 v[148:151], a[144:147], v[224:227], v[148:151]
  ds_read_b128 a[132:135], v5 offset:17408
  v_mul_f32 v146, v88, v146
  v_mfma_f32_16x16x32_bf16 v[148:151], a[148:151], v[228:231], v[148:151]
  v_mul_f32 v147, v88, v147
  v_cvt_pk_bf16_f32 v73, v146, v147
  v_mfma_f32_16x16x32_bf16 v[148:151], a[152:155], v[232:235], v[148:151]
  ds_read_b128 a[136:139], v5 offset:18432
  v_mfma_f32_16x16x32_bf16 v[148:151], a[156:159], v[236:239], v[148:151]
  s_waitcnt lgkmcnt(7)
  v_mfma_f32_16x16x32_bf16 v[152:155], a[160:163], v[128:131], 0
  ds_read_b128 a[140:143], v5 offset:19456
  v_mfma_f32_16x16x32_bf16 v[152:155], a[164:167], v[132:135], v[152:155]
  buffer_load_dwordx2 v[96:97], v8, s[4:7], s42 offen offset:0
  v_mfma_f32_16x16x32_bf16 v[152:155], a[168:171], v[136:139], v[152:155]
  ds_read_b128 a[144:147], v5 offset:20480
  v_mfma_f32_16x16x32_bf16 v[152:155], a[172:175], v[140:143], v[152:155]
  s_waitcnt lgkmcnt(5)
  v_mfma_f32_16x16x32_bf16 v[152:155], a[176:179], v[160:163], v[152:155]
  ds_read_b128 a[148:151], v5 offset:21504
  v_mul_f32 v148, v89, v148
  v_mfma_f32_16x16x32_bf16 v[152:155], a[180:183], v[164:167], v[152:155]
  v_mul_f32 v149, v89, v149
  v_cvt_pk_bf16_f32 v76, v148, v149
  v_mfma_f32_16x16x32_bf16 v[152:155], a[184:187], v[168:171], v[152:155]
  ds_read_b128 a[152:155], v5 offset:22528
  v_mul_f32 v150, v89, v150
  v_mfma_f32_16x16x32_bf16 v[152:155], a[188:191], v[172:175], v[152:155]
  v_mul_f32 v151, v89, v151
  v_cvt_pk_bf16_f32 v77, v150, v151
  v_mfma_f32_16x16x32_bf16 v[156:159], a[160:163], v[192:195], 0
  ds_read_b128 a[156:159], v5 offset:23552
  v_mfma_f32_16x16x32_bf16 v[156:159], a[164:167], v[196:199], v[156:159]
  v_mfma_f32_16x16x32_bf16 v[156:159], a[168:171], v[200:203], v[156:159]
  ds_read_b128 a[160:163], v5 offset:24576
  v_mfma_f32_16x16x32_bf16 v[156:159], a[172:175], v[204:207], v[156:159]
  buffer_load_dwordx2 v[98:99], v8, s[4:7], s42 offen offset:32
  v_mfma_f32_16x16x32_bf16 v[156:159], a[176:179], v[224:227], v[156:159]
  ds_read_b128 a[164:167], v5 offset:25600
  v_mul_f32 v152, v88, v152
  v_mfma_f32_16x16x32_bf16 v[156:159], a[180:183], v[228:231], v[156:159]
  v_mul_f32 v153, v88, v153
  v_cvt_pk_bf16_f32 v74, v152, v153
  v_mfma_f32_16x16x32_bf16 v[156:159], a[184:187], v[232:235], v[156:159]
  ds_read_b128 a[168:171], v5 offset:26624
  v_mul_f32 v154, v88, v154
  v_mfma_f32_16x16x32_bf16 v[156:159], a[188:191], v[236:239], v[156:159]
  s_waitcnt lgkmcnt(7)
  v_mul_f32 v155, v88, v155
  v_cvt_pk_bf16_f32 v75, v154, v155
  v_mfma_f32_16x16x32_bf16 v[176:179], a[128:131], v[128:131], 0
  s_add_u32 s16, s73, 376832
  ds_read_b128 a[172:175], v5 offset:27648
  v_mfma_f32_16x16x32_bf16 v[176:179], a[132:135], v[132:135], v[176:179]
  buffer_store_dwordx4 v[72:75], v1, s[12:15], s16 offen sc1
  v_mfma_f32_16x16x32_bf16 v[176:179], a[136:139], v[136:139], v[176:179]
  ds_read_b128 a[176:179], v5 offset:28672
  v_mul_f32 v156, v89, v156
  v_mfma_f32_16x16x32_bf16 v[176:179], a[140:143], v[140:143], v[176:179]
  s_waitcnt lgkmcnt(5)
  v_mul_f32 v157, v89, v157
  v_cvt_pk_bf16_f32 v78, v156, v157
  v_mfma_f32_16x16x32_bf16 v[176:179], a[144:147], v[160:163], v[176:179]
  ds_read_b128 a[180:183], v5 offset:29696
  v_mul_f32 v158, v89, v158
  v_mfma_f32_16x16x32_bf16 v[176:179], a[148:151], v[164:167], v[176:179]
  v_mul_f32 v159, v89, v159
  v_cvt_pk_bf16_f32 v79, v158, v159
  v_mfma_f32_16x16x32_bf16 v[176:179], a[152:155], v[168:171], v[176:179]
  s_add_u32 s17, s73, 378880
  ds_read_b128 a[184:187], v5 offset:30720
  v_mfma_f32_16x16x32_bf16 v[176:179], a[156:159], v[172:175], v[176:179]
  buffer_store_dwordx4 v[76:79], v1, s[12:15], s17 offen sc1
  v_mfma_f32_16x16x32_bf16 v[180:183], a[128:131], v[192:195], 0
  ds_read_b128 a[188:191], v5 offset:31744
  v_mfma_f32_16x16x32_bf16 v[180:183], a[132:135], v[196:199], v[180:183]
  s_add_u32 s67, s67, 0x8000
  v_mfma_f32_16x16x32_bf16 v[180:183], a[136:139], v[200:203], v[180:183]
  s_and_b32 s67, s67, 0x1ffff
  v_add_u32 v5, s67, v1
  v_mul_f32 v176, v88, v176
  v_mfma_f32_16x16x32_bf16 v[180:183], a[140:143], v[204:207], v[180:183]
  v_mul_f32 v177, v88, v177
  v_cvt_pk_bf16_f32 v80, v176, v177
  v_mfma_f32_16x16x32_bf16 v[180:183], a[144:147], v[224:227], v[180:183]
  v_mul_f32 v178, v88, v178
  v_mul_f32 v179, v88, v179
  v_mfma_f32_16x16x32_bf16 v[180:183], a[148:151], v[228:231], v[180:183]
  v_cvt_pk_bf16_f32 v81, v178, v179
  v_mfma_f32_16x16x32_bf16 v[180:183], a[152:155], v[232:235], v[180:183]
  s_waitcnt vmcnt(22) lgkmcnt(0)
  v_mfma_f32_16x16x32_bf16 v[180:183], a[156:159], v[236:239], v[180:183]
  s_barrier
  v_mfma_f32_16x16x32_bf16 v[184:187], a[160:163], v[128:131], 0
  ds_read_b128 a[128:131], v5 offset:0
  ds_read_b128 a[132:135], v5 offset:1024
  v_mfma_f32_16x16x32_bf16 v[184:187], a[164:167], v[132:135], v[184:187]
  ds_read_b128 a[136:139], v5 offset:2048
  ds_read_b128 a[140:143], v5 offset:3072
  v_mfma_f32_16x16x32_bf16 v[184:187], a[168:171], v[136:139], v[184:187]
  ds_read_b128 a[144:147], v5 offset:4096
  v_mul_f32 v180, v89, v180
  v_mfma_f32_16x16x32_bf16 v[184:187], a[172:175], v[140:143], v[184:187]
  v_mul_f32 v181, v89, v181
  v_cvt_pk_bf16_f32 v84, v180, v181
  v_mfma_f32_16x16x32_bf16 v[184:187], a[176:179], v[160:163], v[184:187]
  ds_read_b128 a[148:151], v5 offset:5120
  v_mul_f32 v182, v89, v182
  v_mfma_f32_16x16x32_bf16 v[184:187], a[180:183], v[164:167], v[184:187]
  v_mul_f32 v183, v89, v183
  v_cvt_pk_bf16_f32 v85, v182, v183
  v_mfma_f32_16x16x32_bf16 v[184:187], a[184:187], v[168:171], v[184:187]
  ds_read_b128 a[152:155], v5 offset:6144
  v_mfma_f32_16x16x32_bf16 v[184:187], a[188:191], v[172:175], v[184:187]
  v_mfma_f32_16x16x32_bf16 v[188:191], a[160:163], v[192:195], 0
  ds_read_b128 a[156:159], v5 offset:7168
  v_mfma_f32_16x16x32_bf16 v[188:191], a[164:167], v[196:199], v[188:191]
  v_mfma_f32_16x16x32_bf16 v[188:191], a[168:171], v[200:203], v[188:191]
  s_nop 0
  ds_read_b128 a[160:163], v5 offset:8192
  v_mfma_f32_16x16x32_bf16 v[188:191], a[172:175], v[204:207], v[188:191]
  buffer_store_dword v11, v0, s[12:15], s74 offen offset:512 sc1
  v_mfma_f32_16x16x32_bf16 v[188:191], a[176:179], v[224:227], v[188:191]
  ds_read_b128 a[164:167], v5 offset:9216
  v_mul_f32 v184, v88, v184
  v_mfma_f32_16x16x32_bf16 v[188:191], a[180:183], v[228:231], v[188:191]
  v_mul_f32 v185, v88, v185
  v_cvt_pk_bf16_f32 v82, v184, v185
  v_mfma_f32_16x16x32_bf16 v[188:191], a[184:187], v[232:235], v[188:191]
  ds_read_b128 a[168:171], v5 offset:10240
  v_mul_f32 v186, v88, v186
  v_mfma_f32_16x16x32_bf16 v[188:191], a[188:191], v[236:239], v[188:191]
  s_waitcnt lgkmcnt(7)
  v_mul_f32 v187, v88, v187
  v_cvt_pk_bf16_f32 v83, v186, v187
  v_mfma_f32_16x16x32_bf16 v[144:147], a[128:131], v[128:131], 0
  s_add_u32 s18, s73, 377856
  ds_read_b128 a[172:175], v5 offset:11264
  v_mfma_f32_16x16x32_bf16 v[144:147], a[132:135], v[132:135], v[144:147]
  buffer_store_dwordx4 v[80:83], v1, s[12:15], s18 offen sc1
  v_mfma_f32_16x16x32_bf16 v[144:147], a[136:139], v[136:139], v[144:147]
  ds_read_b128 a[176:179], v5 offset:12288
  v_mul_f32 v188, v89, v188
  v_mfma_f32_16x16x32_bf16 v[144:147], a[140:143], v[140:143], v[144:147]
  s_waitcnt lgkmcnt(5)
  v_mul_f32 v189, v89, v189
  v_cvt_pk_bf16_f32 v86, v188, v189
  v_mfma_f32_16x16x32_bf16 v[144:147], a[144:147], v[160:163], v[144:147]
  ds_read_b128 a[180:183], v5 offset:13312
  v_mul_f32 v190, v89, v190
  v_mfma_f32_16x16x32_bf16 v[144:147], a[148:151], v[164:167], v[144:147]
  v_mul_f32 v191, v89, v191
  v_cvt_pk_bf16_f32 v87, v190, v191
  v_mfma_f32_16x16x32_bf16 v[144:147], a[152:155], v[168:171], v[144:147]
  s_add_u32 s19, s73, 379904
  ds_read_b128 a[184:187], v5 offset:14336
  v_mfma_f32_16x16x32_bf16 v[144:147], a[156:159], v[172:175], v[144:147]
  buffer_store_dwordx4 v[84:87], v1, s[12:15], s19 offen sc1
  v_mfma_f32_16x16x32_bf16 v[148:151], a[128:131], v[192:195], 0
  ds_read_b128 a[188:191], v5 offset:15360
  v_mfma_f32_16x16x32_bf16 v[148:151], a[132:135], v[196:199], v[148:151]
  v_mfma_f32_16x16x32_bf16 v[148:151], a[136:139], v[200:203], v[148:151]
  ds_read_b128 a[128:131], v5 offset:16384
  v_mfma_f32_16x16x32_bf16 v[148:151], a[140:143], v[204:207], v[148:151]
  v_mfma_f32_16x16x32_bf16 v[148:151], a[144:147], v[224:227], v[148:151]
  ds_read_b128 a[132:135], v5 offset:17408
  v_mul_f32 v144, v88, v144
  v_mfma_f32_16x16x32_bf16 v[148:151], a[148:151], v[228:231], v[148:151]
  v_mul_f32 v145, v88, v145
  v_cvt_pk_bf16_f32 v72, v144, v145
  v_mfma_f32_16x16x32_bf16 v[148:151], a[152:155], v[232:235], v[148:151]
  ds_read_b128 a[136:139], v5 offset:18432
  v_mul_f32 v146, v88, v146
  v_mfma_f32_16x16x32_bf16 v[148:151], a[156:159], v[236:239], v[148:151]
  s_waitcnt lgkmcnt(7)
  v_mul_f32 v147, v88, v147
  v_cvt_pk_bf16_f32 v73, v146, v147
  v_mfma_f32_16x16x32_bf16 v[152:155], a[160:163], v[128:131], 0
  ds_read_b128 a[140:143], v5 offset:19456
  v_mfma_f32_16x16x32_bf16 v[152:155], a[164:167], v[132:135], v[152:155]
  v_mfma_f32_16x16x32_bf16 v[152:155], a[168:171], v[136:139], v[152:155]
  ds_read_b128 a[144:147], v5 offset:20480
  v_mfma_f32_16x16x32_bf16 v[152:155], a[172:175], v[140:143], v[152:155]
  s_waitcnt lgkmcnt(5)
  v_mul_f32 v148, v89, v148
  v_mul_f32 v149, v89, v149
  v_mfma_f32_16x16x32_bf16 v[152:155], a[176:179], v[160:163], v[152:155]
  ds_read_b128 a[148:151], v5 offset:21504
  v_cvt_pk_bf16_f32 v76, v148, v149
  v_mfma_f32_16x16x32_bf16 v[152:155], a[180:183], v[164:167], v[152:155]
  v_mul_f32 v150, v89, v150
  v_mul_f32 v151, v89, v151
  v_mfma_f32_16x16x32_bf16 v[152:155], a[184:187], v[168:171], v[152:155]
  ds_read_b128 a[152:155], v5 offset:22528
  v_cvt_pk_bf16_f32 v77, v150, v151
  v_mfma_f32_16x16x32_bf16 v[152:155], a[188:191], v[172:175], v[152:155]
  v_mfma_f32_16x16x32_bf16 v[156:159], a[160:163], v[192:195], 0
  ds_read_b128 a[156:159], v5 offset:23552
  v_mfma_f32_16x16x32_bf16 v[156:159], a[164:167], v[196:199], v[156:159]
  v_mfma_f32_16x16x32_bf16 v[156:159], a[168:171], v[200:203], v[156:159]
  ds_read_b128 a[160:163], v5 offset:24576
  v_mfma_f32_16x16x32_bf16 v[156:159], a[172:175], v[204:207], v[156:159]
  v_mfma_f32_16x16x32_bf16 v[156:159], a[176:179], v[224:227], v[156:159]
  ds_read_b128 a[164:167], v5 offset:25600
  v_mul_f32 v152, v88, v152
  v_mfma_f32_16x16x32_bf16 v[156:159], a[180:183], v[228:231], v[156:159]
  v_mul_f32 v153, v88, v153
  v_cvt_pk_bf16_f32 v74, v152, v153
  v_mfma_f32_16x16x32_bf16 v[156:159], a[184:187], v[232:235], v[156:159]
  ds_read_b128 a[168:171], v5 offset:26624
  v_mul_f32 v154, v88, v154
  v_mfma_f32_16x16x32_bf16 v[156:159], a[188:191], v[236:239], v[156:159]
  s_waitcnt lgkmcnt(7)
  v_mul_f32 v155, v88, v155
  v_cvt_pk_bf16_f32 v75, v154, v155
  v_mfma_f32_16x16x32_bf16 v[176:179], a[128:131], v[128:131], 0
  s_add_u32 s16, s73, 471040
  ds_read_b128 a[172:175], v5 offset:27648
  v_mfma_f32_16x16x32_bf16 v[176:179], a[132:135], v[132:135], v[176:179]
  buffer_store_dwordx4 v[72:75], v1, s[12:15], s16 offen sc1
  v_mfma_f32_16x16x32_bf16 v[176:179], a[136:139], v[136:139], v[176:179]
  ds_read_b128 a[176:179], v5 offset:28672
  v_mul_f32 v156, v89, v156
  v_mfma_f32_16x16x32_bf16 v[176:179], a[140:143], v[140:143], v[176:179]
  s_waitcnt lgkmcnt(5)
  v_mul_f32 v157, v89, v157
  v_cvt_pk_bf16_f32 v78, v156, v157
  v_mfma_f32_16x16x32_bf16 v[176:179], a[144:147], v[160:163], v[176:179]
  ds_read_b128 a[180:183], v5 offset:29696
  v_mul_f32 v158, v89, v158
  v_mfma_f32_16x16x32_bf16 v[176:179], a[148:151], v[164:167], v[176:179]
  v_mul_f32 v159, v89, v159
  v_cvt_pk_bf16_f32 v79, v158, v159
  v_mfma_f32_16x16x32_bf16 v[176:179], a[152:155], v[168:171], v[176:179]
  s_add_u32 s17, s73, 473088
  ds_read_b128 a[184:187], v5 offset:30720
  v_mfma_f32_16x16x32_bf16 v[176:179], a[156:159], v[172:175], v[176:179]
  buffer_store_dwordx4 v[76:79], v1, s[12:15], s17 offen sc1
  v_mfma_f32_16x16x32_bf16 v[180:183], a[128:131], v[192:195], 0
  ds_read_b128 a[188:191], v5 offset:31744
  v_mfma_f32_16x16x32_bf16 v[180:183], a[132:135], v[196:199], v[180:183]
  s_add_u32 s67, s67, 0x8000
  v_mfma_f32_16x16x32_bf16 v[180:183], a[136:139], v[200:203], v[180:183]
  s_and_b32 s67, s67, 0x1ffff
  v_add_u32 v5, s67, v1
  v_mul_f32 v176, v88, v176
  v_mfma_f32_16x16x32_bf16 v[180:183], a[140:143], v[204:207], v[180:183]
  v_mul_f32 v177, v88, v177
  v_cvt_pk_bf16_f32 v80, v176, v177
  v_mfma_f32_16x16x32_bf16 v[180:183], a[144:147], v[224:227], v[180:183]
  v_mul_f32 v178, v88, v178
  v_mul_f32 v179, v88, v179
  v_mfma_f32_16x16x32_bf16 v[180:183], a[148:151], v[228:231], v[180:183]
  v_cvt_pk_bf16_f32 v81, v178, v179
  v_mfma_f32_16x16x32_bf16 v[180:183], a[152:155], v[232:235], v[180:183]
  s_waitcnt vmcnt(15) lgkmcnt(0)
  v_mfma_f32_16x16x32_bf16 v[180:183], a[156:159], v[236:239], v[180:183]
  s_barrier
  v_mfma_f32_16x16x32_bf16 v[184:187], a[160:163], v[128:131], 0
  ds_read_b128 a[128:131], v5 offset:0
  ds_read_b128 a[132:135], v5 offset:1024
  v_mfma_f32_16x16x32_bf16 v[184:187], a[164:167], v[132:135], v[184:187]
  ds_read_b128 a[136:139], v5 offset:2048
  ds_read_b128 a[140:143], v5 offset:3072
  v_mfma_f32_16x16x32_bf16 v[184:187], a[168:171], v[136:139], v[184:187]
  ds_read_b128 a[144:147], v5 offset:4096
  v_mul_f32 v180, v89, v180
  v_mfma_f32_16x16x32_bf16 v[184:187], a[172:175], v[140:143], v[184:187]
  v_mul_f32 v181, v89, v181
  v_cvt_pk_bf16_f32 v84, v180, v181
  v_mfma_f32_16x16x32_bf16 v[184:187], a[176:179], v[160:163], v[184:187]
  ds_read_b128 a[148:151], v5 offset:5120
  v_mul_f32 v182, v89, v182
  v_mfma_f32_16x16x32_bf16 v[184:187], a[180:183], v[164:167], v[184:187]
  v_mul_f32 v183, v89, v183
  v_cvt_pk_bf16_f32 v85, v182, v183
  v_mfma_f32_16x16x32_bf16 v[184:187], a[184:187], v[168:171], v[184:187]
  ds_read_b128 a[152:155], v5 offset:6144
  v_mfma_f32_16x16x32_bf16 v[184:187], a[188:191], v[172:175], v[184:187]
  v_mfma_f32_16x16x32_bf16 v[188:191], a[160:163], v[192:195], 0
  ds_read_b128 a[156:159], v5 offset:7168
  v_mfma_f32_16x16x32_bf16 v[188:191], a[164:167], v[196:199], v[188:191]
  v_mfma_f32_16x16x32_bf16 v[188:191], a[168:171], v[200:203], v[188:191]
  s_nop 0
  ds_read_b128 a[160:163], v5 offset:8192
  v_mfma_f32_16x16x32_bf16 v[188:191], a[172:175], v[204:207], v[188:191]
  buffer_store_dword v11, v0, s[12:15], s74 offen offset:1024 sc1
  v_mfma_f32_16x16x32_bf16 v[188:191], a[176:179], v[224:227], v[188:191]
  ds_read_b128 a[164:167], v5 offset:9216
  v_mul_f32 v184, v88, v184
  v_mfma_f32_16x16x32_bf16 v[188:191], a[180:183], v[228:231], v[188:191]
  v_mul_f32 v185, v88, v185
  v_cvt_pk_bf16_f32 v82, v184, v185
  v_mfma_f32_16x16x32_bf16 v[188:191], a[184:187], v[232:235], v[188:191]
  ds_read_b128 a[168:171], v5 offset:10240
  v_mul_f32 v186, v88, v186
  v_mfma_f32_16x16x32_bf16 v[188:191], a[188:191], v[236:239], v[188:191]
  s_waitcnt lgkmcnt(7)
  v_mul_f32 v187, v88, v187
  v_cvt_pk_bf16_f32 v83, v186, v187
  v_mfma_f32_16x16x32_bf16 v[144:147], a[128:131], v[128:131], 0
  s_add_u32 s18, s73, 472064
  ds_read_b128 a[172:175], v5 offset:11264
  v_mfma_f32_16x16x32_bf16 v[144:147], a[132:135], v[132:135], v[144:147]
  buffer_store_dwordx4 v[80:83], v1, s[12:15], s18 offen sc1
  v_mfma_f32_16x16x32_bf16 v[144:147], a[136:139], v[136:139], v[144:147]
  ds_read_b128 a[176:179], v5 offset:12288
  v_mul_f32 v188, v89, v188
  v_mfma_f32_16x16x32_bf16 v[144:147], a[140:143], v[140:143], v[144:147]
  s_waitcnt lgkmcnt(5)
  v_mul_f32 v189, v89, v189
  v_cvt_pk_bf16_f32 v86, v188, v189
  v_mfma_f32_16x16x32_bf16 v[144:147], a[144:147], v[160:163], v[144:147]
  ds_read_b128 a[180:183], v5 offset:13312
  v_mul_f32 v190, v89, v190
  v_mfma_f32_16x16x32_bf16 v[144:147], a[148:151], v[164:167], v[144:147]
  v_mul_f32 v191, v89, v191
  v_cvt_pk_bf16_f32 v87, v190, v191
  v_mfma_f32_16x16x32_bf16 v[144:147], a[152:155], v[168:171], v[144:147]
  s_add_u32 s19, s73, 474112
  ds_read_b128 a[184:187], v5 offset:14336
  v_mfma_f32_16x16x32_bf16 v[144:147], a[156:159], v[172:175], v[144:147]
  buffer_store_dwordx4 v[84:87], v1, s[12:15], s19 offen sc1
  v_mfma_f32_16x16x32_bf16 v[148:151], a[128:131], v[192:195], 0
  ds_read_b128 a[188:191], v5 offset:15360
  v_mfma_f32_16x16x32_bf16 v[148:151], a[132:135], v[196:199], v[148:151]
  v_mfma_f32_16x16x32_bf16 v[148:151], a[136:139], v[200:203], v[148:151]
  ds_read_b128 a[128:131], v5 offset:16384
  v_mfma_f32_16x16x32_bf16 v[148:151], a[140:143], v[204:207], v[148:151]
  v_mfma_f32_16x16x32_bf16 v[148:151], a[144:147], v[224:227], v[148:151]
  ds_read_b128 a[132:135], v5 offset:17408
  v_mul_f32 v144, v88, v144
  v_mfma_f32_16x16x32_bf16 v[148:151], a[148:151], v[228:231], v[148:151]
  v_mul_f32 v145, v88, v145
  v_cvt_pk_bf16_f32 v72, v144, v145
  v_mfma_f32_16x16x32_bf16 v[148:151], a[152:155], v[232:235], v[148:151]
  ds_read_b128 a[136:139], v5 offset:18432
  v_mul_f32 v146, v88, v146
  v_mfma_f32_16x16x32_bf16 v[148:151], a[156:159], v[236:239], v[148:151]
  s_waitcnt lgkmcnt(7)
  v_mul_f32 v147, v88, v147
  v_cvt_pk_bf16_f32 v73, v146, v147
  v_mfma_f32_16x16x32_bf16 v[152:155], a[160:163], v[128:131], 0
  ds_read_b128 a[140:143], v5 offset:19456
  v_mfma_f32_16x16x32_bf16 v[152:155], a[164:167], v[132:135], v[152:155]
  v_mfma_f32_16x16x32_bf16 v[152:155], a[168:171], v[136:139], v[152:155]
  ds_read_b128 a[144:147], v5 offset:20480
  v_mfma_f32_16x16x32_bf16 v[152:155], a[172:175], v[140:143], v[152:155]
  s_waitcnt lgkmcnt(5)
  v_mul_f32 v148, v89, v148
  v_mul_f32 v149, v89, v149
  v_mfma_f32_16x16x32_bf16 v[152:155], a[176:179], v[160:163], v[152:155]
  ds_read_b128 a[148:151], v5 offset:21504
  v_cvt_pk_bf16_f32 v76, v148, v149
  v_mfma_f32_16x16x32_bf16 v[152:155], a[180:183], v[164:167], v[152:155]
  v_mul_f32 v150, v89, v150
  v_mul_f32 v151, v89, v151
  v_mfma_f32_16x16x32_bf16 v[152:155], a[184:187], v[168:171], v[152:155]
  ds_read_b128 a[152:155], v5 offset:22528
  v_cvt_pk_bf16_f32 v77, v150, v151
  v_mfma_f32_16x16x32_bf16 v[152:155], a[188:191], v[172:175], v[152:155]
  v_mfma_f32_16x16x32_bf16 v[156:159], a[160:163], v[192:195], 0
  ds_read_b128 a[156:159], v5 offset:23552
  v_mfma_f32_16x16x32_bf16 v[156:159], a[164:167], v[196:199], v[156:159]
  v_mfma_f32_16x16x32_bf16 v[156:159], a[168:171], v[200:203], v[156:159]
  ds_read_b128 a[160:163], v5 offset:24576
  v_mfma_f32_16x16x32_bf16 v[156:159], a[172:175], v[204:207], v[156:159]
  v_mfma_f32_16x16x32_bf16 v[156:159], a[176:179], v[224:227], v[156:159]
  ds_read_b128 a[164:167], v5 offset:25600
  v_mul_f32 v152, v88, v152
  v_mfma_f32_16x16x32_bf16 v[156:159], a[180:183], v[228:231], v[156:159]
  v_mul_f32 v153, v88, v153
  v_cvt_pk_bf16_f32 v74, v152, v153
  v_mfma_f32_16x16x32_bf16 v[156:159], a[184:187], v[232:235], v[156:159]
  ds_read_b128 a[168:171], v5 offset:26624
  v_mul_f32 v154, v88, v154
  v_mfma_f32_16x16x32_bf16 v[156:159], a[188:191], v[236:239], v[156:159]
  s_waitcnt lgkmcnt(7)
  v_mul_f32 v155, v88, v155
  v_cvt_pk_bf16_f32 v75, v154, v155
  v_mfma_f32_16x16x32_bf16 v[176:179], a[128:131], v[128:131], 0
  s_add_u32 s16, s73, 565248
  ds_read_b128 a[172:175], v5 offset:27648
  v_mfma_f32_16x16x32_bf16 v[176:179], a[132:135], v[132:135], v[176:179]
  buffer_store_dwordx4 v[72:75], v1, s[12:15], s16 offen sc1
  v_mfma_f32_16x16x32_bf16 v[176:179], a[136:139], v[136:139], v[176:179]
  ds_read_b128 a[176:179], v5 offset:28672
  v_mul_f32 v156, v89, v156
  v_mfma_f32_16x16x32_bf16 v[176:179], a[140:143], v[140:143], v[176:179]
  s_waitcnt lgkmcnt(5)
  v_mul_f32 v157, v89, v157
  v_cvt_pk_bf16_f32 v78, v156, v157
  v_mfma_f32_16x16x32_bf16 v[176:179], a[144:147], v[160:163], v[176:179]
  ds_read_b128 a[180:183], v5 offset:29696
  v_mul_f32 v158, v89, v158
  v_mfma_f32_16x16x32_bf16 v[176:179], a[148:151], v[164:167], v[176:179]
  v_mul_f32 v159, v89, v159
  v_cvt_pk_bf16_f32 v79, v158, v159
  v_mfma_f32_16x16x32_bf16 v[176:179], a[152:155], v[168:171], v[176:179]
  s_add_u32 s17, s73, 567296
  ds_read_b128 a[184:187], v5 offset:30720
  v_mfma_f32_16x16x32_bf16 v[176:179], a[156:159], v[172:175], v[176:179]
  buffer_store_dwordx4 v[76:79], v1, s[12:15], s17 offen sc1
  v_mfma_f32_16x16x32_bf16 v[180:183], a[128:131], v[192:195], 0
  ds_read_b128 a[188:191], v5 offset:31744
  v_mfma_f32_16x16x32_bf16 v[180:183], a[132:135], v[196:199], v[180:183]
  v_mfma_f32_16x16x32_bf16 v[180:183], a[136:139], v[200:203], v[180:183]
  v_mfma_f32_16x16x32_bf16 v[180:183], a[140:143], v[204:207], v[180:183]
  v_mfma_f32_16x16x32_bf16 v[180:183], a[144:147], v[224:227], v[180:183]
  v_mfma_f32_16x16x32_bf16 v[180:183], a[148:151], v[228:231], v[180:183]
  v_mul_f32 v176, v88, v176
  v_mul_f32 v177, v88, v177
  v_mfma_f32_16x16x32_bf16 v[180:183], a[152:155], v[232:235], v[180:183]
  v_cvt_pk_bf16_f32 v80, v176, v177
  v_mul_f32 v178, v88, v178
  v_mfma_f32_16x16x32_bf16 v[180:183], a[156:159], v[236:239], v[180:183]
  s_waitcnt lgkmcnt(4)
  v_mul_f32 v179, v88, v179
  v_cvt_pk_bf16_f32 v81, v178, v179
  v_mfma_f32_16x16x32_bf16 v[184:187], a[160:163], v[128:131], 0
  v_mfma_f32_16x16x32_bf16 v[184:187], a[164:167], v[132:135], v[184:187]
  v_mfma_f32_16x16x32_bf16 v[184:187], a[168:171], v[136:139], v[184:187]
  v_mfma_f32_16x16x32_bf16 v[184:187], a[172:175], v[140:143], v[184:187]
  s_waitcnt lgkmcnt(0)
  v_mfma_f32_16x16x32_bf16 v[184:187], a[176:179], v[160:163], v[184:187]
  v_mfma_f32_16x16x32_bf16 v[184:187], a[180:183], v[164:167], v[184:187]
  v_mul_f32 v180, v89, v180
  v_mul_f32 v181, v89, v181
  v_mfma_f32_16x16x32_bf16 v[184:187], a[184:187], v[168:171], v[184:187]
  v_cvt_pk_bf16_f32 v84, v180, v181
  v_mul_f32 v182, v89, v182
  v_mfma_f32_16x16x32_bf16 v[184:187], a[188:191], v[172:175], v[184:187]
  v_mul_f32 v183, v89, v183
  v_cvt_pk_bf16_f32 v85, v182, v183
  v_mfma_f32_16x16x32_bf16 v[188:191], a[160:163], v[192:195], 0
  buffer_load_dword v12, v13, s[12:15], s40 offen sc1
  v_mfma_f32_16x16x32_bf16 v[188:191], a[164:167], v[196:199], v[188:191]
  v_mfma_f32_16x16x32_bf16 v[188:191], a[168:171], v[200:203], v[188:191]
  s_nop 0
  s_waitcnt vmcnt(15)
  buffer_store_dword v11, v0, s[12:15], s74 offen offset:1536 sc1
  v_mfma_f32_16x16x32_bf16 v[188:191], a[172:175], v[204:207], v[188:191]
  v_mul_f32 v184, v88, v184
  v_mul_f32 v185, v88, v185
  v_mfma_f32_16x16x32_bf16 v[188:191], a[176:179], v[224:227], v[188:191]
  v_cvt_pk_bf16_f32 v82, v184, v185
  v_mul_f32 v186, v88, v186
  v_mfma_f32_16x16x32_bf16 v[188:191], a[180:183], v[228:231], v[188:191]
  v_mul_f32 v187, v88, v187
  v_cvt_pk_bf16_f32 v83, v186, v187
  v_mfma_f32_16x16x32_bf16 v[188:191], a[184:187], v[232:235], v[188:191]
  s_add_u32 s18, s73, 566272
  buffer_store_dwordx4 v[80:83], v1, s[12:15], s18 offen sc1
  v_mfma_f32_16x16x32_bf16 v[188:191], a[188:191], v[236:239], v[188:191]
  s_nop 7
  v_mul_f32 v188, v89, v188
  v_mul_f32 v189, v89, v189
  v_cvt_pk_bf16_f32 v86, v188, v189
  v_mul_f32 v190, v89, v190
  v_mul_f32 v191, v89, v191
  v_cvt_pk_bf16_f32 v87, v190, v191
  s_add_u32 s19, s73, 568320
  buffer_store_dwordx4 v[84:87], v1, s[12:15], s19 offen sc1
  s_nop 0
  s_waitcnt vmcnt(11)
  buffer_store_dword v11, v0, s[12:15], s74 offen offset:2048 sc1
  s_waitcnt vmcnt(7)
  buffer_store_dword v11, v0, s[12:15], s74 offen offset:2560 sc1
  s_waitcnt vmcnt(2)
  buffer_store_dword v11, v0, s[12:15], s74 offen offset:3072 sc1
  s_cmp_eq_u32 s41, 2
  s_cbranch_scc1 L_kf_kernel_t2_102
  s_cmp_eq_u32 s41, 4
  s_cbranch_scc1 L_kf_kernel_t4_101
  s_cmp_eq_u32 s41, 0
  s_cbranch_scc1 L_kf_kernel_fin_100
L_kf_kernel_gl_103:
  v_cmp_ne_u32 vcc, 0, v12
  s_nop 0
  s_andn2_b32 s38, vcc_lo, s37
  s_cbranch_scc0 L_kf_kernel_gc_104
  s_or_b32 s37, s37, s38
  s_and_b32 s97, s38, 0xf0000
  s_cbranch_scc0 L_kf_kernel_gg_107
  s_bitcmp1_b32 s38, 16
  s_cbranch_scc0 L_kf_kernel_gs_108
  s_add_u32 s97, s36, 65536
  s_waitcnt vmcnt(9)
  buffer_load_dwordx4 a[64:67], v1, s[12:15], s97 offen offset:0 sc1
L_kf_kernel_gs_108:
  s_bitcmp1_b32 s38, 17
  s_cbranch_scc0 L_kf_kernel_gs_109
  s_add_u32 s97, s36, 69632
  s_waitcnt vmcnt(9)
  buffer_load_dwordx4 a[68:71], v1, s[12:15], s97 offen offset:0 sc1
L_kf_kernel_gs_109:
  s_bitcmp1_b32 s38, 18
  s_cbranch_scc0 L_kf_kernel_gs_110
  s_add_u32 s97, s36, 73728
  s_waitcnt vmcnt(9)
  buffer_load_dwordx4 a[72:75], v1, s[12:15], s97 offen offset:0 sc1
L_kf_kernel_gs_110:
  s_bitcmp1_b32 s38, 19
  s_cbranch_scc0 L_kf_kernel_gs_111
  s_add_u32 s97, s36, 77824
  s_waitcnt vmcnt(9)
  buffer_load_dwordx4 a[76:79], v1, s[12:15], s97 offen offset:0 sc1
L_kf_kernel_gs_111:
L_kf_kernel_gg_107:
  s_and_b32 s97, s38, 0x700001
  s_cbranch_scc0 L_kf_kernel_gg_112
  s_bitcmp1_b32 s38, 20
  s_cbranch_scc0 L_kf_kernel_gs_113
  s_add_u32 s97, s36, 81920
  s_waitcnt vmcnt(9)
  buffer_load_dwordx4 a[80:83], v1, s[12:15], s97 offen offset:0 sc1
L_kf_kernel_gs_113:
  s_bitcmp1_b32 s38, 21
  s_cbranch_scc0 L_kf_kernel_gs_114
  s_add_u32 s97, s36, 86016
  s_waitcnt vmcnt(9)
  buffer_load_dwordx4 a[84:87], v1, s[12:15], s97 offen offset:0 sc1
L_kf_kernel_gs_114:
  s_bitcmp1_b32 s38, 22
  s_cbranch_scc0 L_kf_kernel_gs_115
  s_add_u32 s97, s36, 90112
  s_waitcnt vmcnt(9)
  buffer_load_dwordx4 a[88:91], v1, s[12:15], s97 offen offset:0 sc1
L_kf_kernel_gs_115:
  s_bitcmp1_b32 s38, 0
  s_cbranch_scc0 L_kf_kernel_gs_116
  s_add_u32 s97, s36, 0
  s_waitcnt vmcnt(9)
  buffer_load_dwordx4 a[0:3], v1, s[12:15], s97 offen offset:0 sc1
L_kf_kernel_gs_116:
L_kf_kernel_gg_112:
  s_and_b32 s97, s38, 0x1e
  s_cbranch_scc0 L_kf_kernel_gg_117
  s_bitcmp1_b32 s38, 1
  s_cbranch_scc0 L_kf_kernel_gs_118
  s_add_u32 s97, s36, 4096
  s_waitcnt vmcnt(9)
  buffer_load_dwordx4 a[4:7], v1, s[12:15], s97 offen offset:0 sc1
L_kf_kernel_gs_118:
  s_bitcmp1_b32 s38, 2
  s_cbranch_scc0 L_kf_kernel_gs_119
  s_add_u32 s97, s36, 8192
  s_waitcnt vmcnt(9)
  buffer_load_dwordx4 a[8:11], v1, s[12:15], s97 offen offset:0 sc1
L_kf_kernel_gs_119:
  s_bitcmp1_b32 s38, 3
  s_cbranch_scc0 L_kf_kernel_gs_120
  s_add_u32 s97, s36, 12288
  s_waitcnt vmcnt(9)
  buffer_load_dwordx4 a[12:15], v1, s[12:15], s97 offen offset:0 sc1
L_kf_kernel_gs_120:
  s_bitcmp1_b32 s38, 4
  s_cbranch_scc0 L_kf_kernel_gs_121
  s_add_u32 s97, s36, 16384
  s_waitcnt vmcnt(9)
  buffer_load_dwordx4 a[16:19], v1, s[12:15], s97 offen offset:0 sc1
L_kf_kernel_gs_121:
L_kf_kernel_gg_117:
  s_and_b32 s97, s38, 0x1e0
  s_cbranch_scc0 L_kf_kernel_gg_122
  s_bitcmp1_b32 s38, 5
  s_cbranch_scc0 L_kf_kernel_gs_123
  s_add_u32 s97, s36, 20480
  s_waitcnt vmcnt(9)
  buffer_load_dwordx4 a[20:23], v1, s[12:15], s97 offen offset:0 sc1
L_kf_kernel_gs_123:
  s_bitcmp1_b32 s38, 6
  s_cbranch_scc0 L_kf_kernel_gs_124
  s_add_u32 s97, s36, 24576
  s_waitcnt vmcnt(9)
  buffer_load_dwordx4 a[24:27], v1, s[12:15], s97 offen offset:0 sc1
L_kf_kernel_gs_124:
  s_bitcmp1_b32 s38, 7
  s_cbranch_scc0 L_kf_kernel_gs_125
  s_add_u32 s97, s36, 28672
  s_waitcnt vmcnt(9)
  buffer_load_dwordx4 a[28:31], v1, s[12:15], s97 offen offset:0 sc1
L_kf_kernel_gs_125:
  s_bitcmp1_b32 s38, 8
  s_cbranch_scc0 L_kf_kernel_gs_126
  s_add_u32 s97, s36, 32768
  s_waitcnt vmcnt(9)
  buffer_load_dwordx4 a[32:35], v1, s[12:15], s97 offen offset:0 sc1
L_kf_kernel_gs_126:
L_kf_kernel_gg_122:
  s_and_b32 s97, s38, 0x1e00
  s_cbranch_scc0 L_kf_kernel_gg_127
  s_bitcmp1_b32 s38, 9
  s_cbranch_scc0 L_kf_kernel_gs_128
  s_add_u32 s97, s36, 36864
  s_waitcnt vmcnt(9)
  buffer_load_dwordx4 a[36:39], v1, s[12:15], s97 offen offset:0 sc1
L_kf_kernel_gs_128:
  s_bitcmp1_b32 s38, 10
  s_cbranch_scc0 L_kf_kernel_gs_129
  s_add_u32 s97, s36, 40960
  s_waitcnt vmcnt(9)
  buffer_load_dwordx4 a[40:43], v1, s[12:15], s97 offen offset:0 sc1
L_kf_kernel_gs_129:
  s_bitcmp1_b32 s38, 11
  s_cbranch_scc0 L_kf_kernel_gs_130
  s_add_u32 s97, s36, 45056
  s_waitcnt vmcnt(9)
  buffer_load_dwordx4 a[44:47], v1, s[12:15], s97 offen offset:0 sc1
L_kf_kernel_gs_130:
  s_bitcmp1_b32 s38, 12
  s_cbranch_scc0 L_kf_kernel_gs_131
  s_add_u32 s97, s36, 49152
  s_waitcnt vmcnt(9)
  buffer_load_dwordx4 a[48:51], v1, s[12:15], s97 offen offset:0 sc1
L_kf_kernel_gs_131:
L_kf_kernel_gg_127:
  s_and_b32 s97, s38, 0xe000
  s_cbranch_scc0 L_kf_kernel_gg_132
  s_bitcmp1_b32 s38, 13
  s_cbranch_scc0 L_kf_kernel_gs_133
  s_add_u32 s97, s36, 53248
  s_waitcnt vmcnt(9)
  buffer_load_dwordx4 a[52:55], v1, s[12:15], s97 offen offset:0 sc1
L_kf_kernel_gs_133:
  s_bitcmp1_b32 s38, 14
  s_cbranch_scc0 L_kf_kernel_gs_134
  s_add_u32 s97, s36, 57344
  s_waitcnt vmcnt(9)
  buffer_load_dwordx4 a[56:59], v1, s[12:15], s97 offen offset:0 sc1
L_kf_kernel_gs_134:
  s_bitcmp1_b32 s38, 15
  s_cbranch_scc0 L_kf_kernel_gs_135
  s_add_u32 s97, s36, 61440
  s_waitcnt vmcnt(9)
  buffer_load_dwordx4 a[60:63], v1, s[12:15], s97 offen offset:0 sc1
L_kf_kernel_gs_135:
L_kf_kernel_gg_132:
L_kf_kernel_gc_104:
  s_andn2_b32 s97, 0x7fffff, s37
  s_cbranch_scc0 L_kf_kernel_gw_106
  buffer_load_dword v12, v13, s[12:15], s40 offen sc1
L_kf_kernel_gw_106:
  s_andn2_b32 s97, 0xffff, s45
  s_cbranch_scc1 L_kf_kernel_w1_136
  v_mfma_f32_16x16x32_bf16 v[32:35], v[22:25], a[0:3], 0
  s_xor_b32 s45, s45, 0x1000001
  v_lshlrev_b32 v128, 16, v96
  v_and_b32 v129, 0xffff0000, v96
  v_mfma_f32_16x16x32_bf16 v[36:39], v[28:31], a[2:5], 0
  v_lshlrev_b32 v130, 16, v97
  v_and_b32 v131, 0xffff0000, v97
  v_mfma_f32_16x16x32_bf16 v[32:35], v[28:31], a[6:9], v[32:35]
  v_lshlrev_b32 v132, 16, v98
  v_and_b32 v133, 0xffff0000, v98
  v_mfma_f32_16x16x32_bf16 v[36:39], v[28:31], a[10:13], v[36:39]
  v_lshlrev_b32 v134, 16, v99
  v_and_b32 v135, 0xffff0000, v99
  v_mfma_f32_16x16x32_bf16 v[32:35], v[28:31], a[14:17], v[32:35]
  v_mfma_f32_16x16x32_bf16 v[36:39], v[28:31], a[18:21], v[36:39]
  v_mfma_f32_16x16x32_bf16 v[32:35], v[28:31], a[22:25], v[32:35]
  v_mfma_f32_16x16x32_bf16 v[36:39], v[28:31], a[26:29], v[36:39]
  v_mfma_f32_16x16x32_bf16 v[32:35], v[28:31], a[30:33], v[32:35]
  v_mfma_f32_16x16x32_bf16 v[36:39], v[28:31], a[34:37], v[36:39]
  v_mfma_f32_16x16x32_bf16 v[32:35], v[28:31], a[38:41], v[32:35]
  v_mfma_f32_16x16x32_bf16 v[36:39], v[28:31], a[42:45], v[36:39]
  v_mfma_f32_16x16x32_bf16 v[32:35], v[28:31], a[46:49], v[32:35]
  v_mfma_f32_16x16x32_bf16 v[36:39], v[28:31], a[50:53], v[36:39]
  v_mfma_f32_16x16x32_bf16 v[32:35], v[28:31], a[54:57], v[32:35]
  v_mfma_f32_16x16x32_bf16 v[36:39], v[28:31], a[58:61], v[36:39]
  v_mfma_f32_16x16x32_bf16 v[32:35], v[26:29], a[60:63], v[32:35]
  s_nop 7
  v_cvt_pk_bf16_f32 v32, 0, v32
  v_cvt_pk_bf16_f32 v33, 0, v33
  v_cvt_pk_bf16_f32 v34, 0, v34
  v_cvt_pk_bf16_f32 v35, 0, v35
  v_cvt_pk_bf16_f32 v36, 0, v36
  v_cvt_pk_bf16_f32 v37, 0, v37
  v_cvt_pk_bf16_f32 v38, 0, v38
  v_cvt_pk_bf16_f32 v39, 0, v39
L_kf_kernel_w1_136:
  s_andn2_b32 s97, 0x7f0000, s45
  s_cbranch_scc1 L_kf_kernel_w2_137
  v_mfma_f32_16x16x32_bf16 v[64:67], v[22:25], a[64:67], 0
  s_xor_b32 s45, s45, 0x2010000
  v_lshlrev_b32 v136, 16, v112
  v_and_b32 v137, 0xffff0000, v112
  v_mfma_f32_16x16x32_bf16 v[68:71], v[28:31], a[66:69], 0
  v_lshlrev_b32 v138, 16, v113
  v_and_b32 v139, 0xffff0000, v113
  v_mfma_f32_16x16x32_bf16 v[64:67], v[28:31], a[70:73], v[64:67]
  v_lshlrev_b32 v140, 16, v114
  v_and_b32 v141, 0xffff0000, v114
  v_mfma_f32_16x16x32_bf16 v[68:71], v[28:31], a[74:77], v[68:71]
  v_lshlrev_b32 v142, 16, v115
  v_and_b32 v143, 0xffff0000, v115
  v_mfma_f32_16x16x32_bf16 v[64:67], v[28:31], a[78:81], v[64:67]
  v_mfma_f32_16x16x32_bf16 v[68:71], v[28:31], a[82:85], v[68:71]
  v_mfma_f32_16x16x32_bf16 v[64:67], v[28:31], a[86:89], v[64:67]
  v_mfma_f32_16x16x32_bf16 v[68:71], v[26:29], a[88:91], v[68:71]
  s_nop 6
  v_cvt_pk_bf16_f32 v64, 0, v64
  v_cvt_pk_bf16_f32 v65, 0, v65
  v_cvt_pk_bf16_f32 v66, 0, v66
  v_cvt_pk_bf16_f32 v67, 0, v67
  v_cvt_pk_bf16_f32 v68, 0, v68
  v_cvt_pk_bf16_f32 v69, 0, v69
  v_cvt_pk_bf16_f32 v70, 0, v70
  v_cvt_pk_bf16_f32 v71, 0, v71
  v_add_f32 v64, v64, v136
  v_add_f32 v65, v65, v137
  v_add_f32 v66, v66, v138
  v_add_f32 v67, v67, v139
  v_add_f32 v68, v68, v140
  v_add_f32 v69, v69, v141
  v_add_f32 v70, v70, v142
  v_add_f32 v71, v71, v143
  v_cvt_pk_bf16_f32 v64, 0, v64
  v_cvt_pk_bf16_f32 v65, 0, v65
  v_cvt_pk_bf16_f32 v66, 0, v66
  v_cvt_pk_bf16_f32 v67, 0, v67
  v_cvt_pk_bf16_f32 v68, 0, v68
  v_cvt_pk_bf16_f32 v69, 0, v69
  v_cvt_pk_bf16_f32 v70, 0, v70
  v_cvt_pk_bf16_f32 v71, 0, v71
  v_mul_f32 v136, s76, v64
  v_mul_f32 v137, s76, v65
  v_mul_f32 v138, s76, v66
  v_mul_f32 v139, s76, v67
  v_mul_f32 v140, s76, v68
  v_mul_f32 v141, s76, v69
  v_mul_f32 v142, s76, v70
  v_mul_f32 v143, s76, v71
  v_exp_f32 v136, v136
  v_exp_f32 v137, v137
  v_exp_f32 v138, v138
  v_exp_f32 v139, v139
  v_exp_f32 v140, v140
  v_exp_f32 v141, v141
  v_exp_f32 v142, v142
  v_exp_f32 v143, v143
  v_add_f32 v136, 1.0, v136
  v_add_f32 v137, 1.0, v137
  v_add_f32 v138, 1.0, v138
  v_add_f32 v139, 1.0, v139
  v_add_f32 v140, 1.0, v140
  v_add_f32 v141, 1.0, v141
  v_add_f32 v142, 1.0, v142
  v_add_f32 v143, 1.0, v143
  v_rcp_f32 v136, v136
  v_rcp_f32 v137, v137
  v_rcp_f32 v138, v138
  v_rcp_f32 v139, v139
  v_rcp_f32 v140, v140
  v_rcp_f32 v141, v141
  v_rcp_f32 v142, v142
  v_rcp_f32 v143, v143
  v_mul_f32 v64, v64, v136
  v_mul_f32 v65, v65, v137
  v_mul_f32 v66, v66, v138
  v_mul_f32 v67, v67, v139
  v_mul_f32 v68, v68, v140
  v_mul_f32 v69, v69, v141
  v_mul_f32 v70, v70, v142
  v_mul_f32 v71, v71, v143
  v_cvt_pk_bf16_f32 v64, 0, v64
  v_cvt_pk_bf16_f32 v65, 0, v65
  v_cvt_pk_bf16_f32 v66, 0, v66
  v_cvt_pk_bf16_f32 v67, 0, v67
  v_cvt_pk_bf16_f32 v68, 0, v68
  v_cvt_pk_bf16_f32 v69, 0, v69
  v_cvt_pk_bf16_f32 v70, 0, v70
  v_cvt_pk_bf16_f32 v71, 0, v71
L_kf_kernel_w2_137:
  s_cmp_ge_u32 s45, 0x3000000
  s_cbranch_scc1 L_kf_kernel_gd_105
  s_or_b32 s45, s45, s38
  s_sub_u32 s63, s63, 1
  s_waitcnt vmcnt(0)
  s_cbranch_scc0 L_kf_kernel_gl_103
L_kf_kernel_gd_105:
  v_mul_f32 v64, v64, v32
  v_mul_f32 v65, v65, v33
  v_mul_f32 v66, v66, v34
  v_mul_f32 v67, v67, v35
  v_mul_f32 v68, v68, v36
  v_mul_f32 v69, v69, v37
  v_mul_f32 v70, v70, v38
  v_mul_f32 v71, v71, v39
  v_cvt_pk_bf16_f32 v64, 0, v64
  v_cvt_pk_bf16_f32 v65, 0, v65
  v_cvt_pk_bf16_f32 v66, 0, v66
  v_cvt_pk_bf16_f32 v67, 0, v67
  v_cvt_pk_bf16_f32 v68, 0, v68
  v_cvt_pk_bf16_f32 v69, 0, v69
  v_cvt_pk_bf16_f32 v70, 0, v70
  v_cvt_pk_bf16_f32 v71, 0, v71
  v_add_f32 v64, v64, v128
  v_add_f32 v65, v65, v129
  v_add_f32 v66, v66, v130
  v_add_f32 v67, v67, v131
  v_add_f32 v68, v68, v132
  v_add_f32 v69, v69, v133
  v_add_f32 v70, v70, v134
  v_add_f32 v71, v71, v135
  v_cvt_pk_bf16_f32 v64, v64, v65
  v_cvt_pk_bf16_f32 v65, v66, v67
  buffer_store_dwordx2 v[64:65], v8, s[8:11], s42 offen offset:0
  v_cvt_pk_bf16_f32 v66, v68, v69
  v_cvt_pk_bf16_f32 v67, v70, v71
  buffer_store_dwordx2 v[66:67], v8, s[8:11], s42 offen offset:32
  s_endpgm
L_kf_kernel_t2_102:
  buffer_load_dwordx2 v[116:117], v9, s[20:23], s44 offen offset:64
  buffer_load_dwordx2 v[118:119], v9, s[20:23], s44 offen offset:96
  buffer_load_dwordx2 v[100:101], v8, s[4:7], s42 offen offset:64
  buffer_load_dwordx2 v[102:103], v8, s[4:7], s42 offen offset:96
L_kf_kernel_t2b_69:
L_kf_kernel_gl_138:
  v_cmp_ne_u32 vcc, 0, v12
  s_nop 0
  s_andn2_b32 s38, vcc_lo, s37
  s_cbranch_scc0 L_kf_kernel_gc_139
  s_or_b32 s37, s37, s38
  s_and_b32 s97, s38, 0xf0000
  s_cbranch_scc0 L_kf_kernel_gg_142
  s_bitcmp1_b32 s38, 16
  s_cbranch_scc0 L_kf_kernel_gs_143
  s_add_u32 s97, s36, 65536
  s_waitcnt vmcnt(8)
  buffer_load_dwordx4 a[64:67], v1, s[12:15], s97 offen offset:0 sc1
  buffer_load_dwordx4 a[92:95], v1, s[12:15], s97 offen offset:1024 sc1
L_kf_kernel_gs_143:
  s_bitcmp1_b32 s38, 17
  s_cbranch_scc0 L_kf_kernel_gs_144
  s_add_u32 s97, s36, 69632
  s_waitcnt vmcnt(8)
  buffer_load_dwordx4 a[68:71], v1, s[12:15], s97 offen offset:0 sc1
  buffer_load_dwordx4 a[96:99], v1, s[12:15], s97 offen offset:1024 sc1
L_kf_kernel_gs_144:
  s_bitcmp1_b32 s38, 18
  s_cbranch_scc0 L_kf_kernel_gs_145
  s_add_u32 s97, s36, 73728
  s_waitcnt vmcnt(8)
  buffer_load_dwordx4 a[72:75], v1, s[12:15], s97 offen offset:0 sc1
  buffer_load_dwordx4 a[100:103], v1, s[12:15], s97 offen offset:1024 sc1
L_kf_kernel_gs_145:
  s_bitcmp1_b32 s38, 19
  s_cbranch_scc0 L_kf_kernel_gs_146
  s_add_u32 s97, s36, 77824
  s_waitcnt vmcnt(8)
  buffer_load_dwordx4 a[76:79], v1, s[12:15], s97 offen offset:0 sc1
  buffer_load_dwordx4 a[104:107], v1, s[12:15], s97 offen offset:1024 sc1
L_kf_kernel_gs_146:
L_kf_kernel_gg_142:
  s_and_b32 s97, s38, 0x700001
  s_cbranch_scc0 L_kf_kernel_gg_147
  s_bitcmp1_b32 s38, 20
  s_cbranch_scc0 L_kf_kernel_gs_148
  s_add_u32 s97, s36, 81920
  s_waitcnt vmcnt(8)
  buffer_load_dwordx4 a[80:83], v1, s[12:15], s97 offen offset:0 sc1
  buffer_load_dwordx4 a[108:111], v1, s[12:15], s97 offen offset:1024 sc1
L_kf_kernel_gs_148:
  s_bitcmp1_b32 s38, 21
  s_cbranch_scc0 L_kf_kernel_gs_149
  s_add_u32 s97, s36, 86016
  s_waitcnt vmcnt(8)
  buffer_load_dwordx4 a[84:87], v1, s[12:15], s97 offen offset:0 sc1
  buffer_load_dwordx4 a[112:115], v1, s[12:15], s97 offen offset:1024 sc1
L_kf_kernel_gs_149:
  s_bitcmp1_b32 s38, 22
  s_cbranch_scc0 L_kf_kernel_gs_150
  s_add_u32 s97, s36, 90112
  s_waitcnt vmcnt(8)
  buffer_load_dwordx4 a[88:91], v1, s[12:15], s97 offen offset:0 sc1
  buffer_load_dwordx4 a[116:119], v1, s[12:15], s97 offen offset:1024 sc1
L_kf_kernel_gs_150:
  s_bitcmp1_b32 s38, 0
  s_cbranch_scc0 L_kf_kernel_gs_151
  s_add_u32 s97, s36, 0
  s_waitcnt vmcnt(8)
  buffer_load_dwordx4 a[0:3], v1, s[12:15], s97 offen offset:0 sc1
  buffer_load_dwordx4 a[192:195], v1, s[12:15], s97 offen offset:1024 sc1
L_kf_kernel_gs_151:
L_kf_kernel_gg_147:
  s_and_b32 s97, s38, 0x1e
  s_cbranch_scc0 L_kf_kernel_gg_152
  s_bitcmp1_b32 s38, 1
  s_cbranch_scc0 L_kf_kernel_gs_153
  s_add_u32 s97, s36, 4096
  s_waitcnt vmcnt(8)
  buffer_load_dwordx4 a[4:7], v1, s[12:15], s97 offen offset:0 sc1
  buffer_load_dwordx4 a[196:199], v1, s[12:15], s97 offen offset:1024 sc1
L_kf_kernel_gs_153:
  s_bitcmp1_b32 s38, 2
  s_cbranch_scc0 L_kf_kernel_gs_154
  s_add_u32 s97, s36, 8192
  s_waitcnt vmcnt(8)
  buffer_load_dwordx4 a[8:11], v1, s[12:15], s97 offen offset:0 sc1
  buffer_load_dwordx4 a[200:203], v1, s[12:15], s97 offen offset:1024 sc1
L_kf_kernel_gs_154:
  s_bitcmp1_b32 s38, 3
  s_cbranch_scc0 L_kf_kernel_gs_155
  s_add_u32 s97, s36, 12288
  s_waitcnt vmcnt(8)
  buffer_load_dwordx4 a[12:15], v1, s[12:15], s97 offen offset:0 sc1
  buffer_load_dwordx4 a[204:207], v1, s[12:15], s97 offen offset:1024 sc1
L_kf_kernel_gs_155:
  s_bitcmp1_b32 s38, 4
  s_cbranch_scc0 L_kf_kernel_gs_156
  s_add_u32 s97, s36, 16384
  s_waitcnt vmcnt(8)
  buffer_load_dwordx4 a[16:19], v1, s[12:15], s97 offen offset:0 sc1
  buffer_load_dwordx4 a[208:211], v1, s[12:15], s97 offen offset:1024 sc1
L_kf_kernel_gs_156:
L_kf_kernel_gg_152:
  s_and_b32 s97, s38, 0x1e0
  s_cbranch_scc0 L_kf_kernel_gg_157
  s_bitcmp1_b32 s38, 5
  s_cbranch_scc0 L_kf_kernel_gs_158
  s_add_u32 s97, s36, 20480
  s_waitcnt vmcnt(8)
  buffer_load_dwordx4 a[20:23], v1, s[12:15], s97 offen offset:0 sc1
  buffer_load_dwordx4 a[212:215], v1, s[12:15], s97 offen offset:1024 sc1
L_kf_kernel_gs_158:
  s_bitcmp1_b32 s38, 6
  s_cbranch_scc0 L_kf_kernel_gs_159
  s_add_u32 s97, s36, 24576
  s_waitcnt vmcnt(8)
  buffer_load_dwordx4 a[24:27], v1, s[12:15], s97 offen offset:0 sc1
  buffer_load_dwordx4 a[216:219], v1, s[12:15], s97 offen offset:1024 sc1
L_kf_kernel_gs_159:
  s_bitcmp1_b32 s38, 7
  s_cbranch_scc0 L_kf_kernel_gs_160
  s_add_u32 s97, s36, 28672
  s_waitcnt vmcnt(8)
  buffer_load_dwordx4 a[28:31], v1, s[12:15], s97 offen offset:0 sc1
  buffer_load_dwordx4 a[220:223], v1, s[12:15], s97 offen offset:1024 sc1
L_kf_kernel_gs_160:
  s_bitcmp1_b32 s38, 8
  s_cbranch_scc0 L_kf_kernel_gs_161
  s_add_u32 s97, s36, 32768
  s_waitcnt vmcnt(8)
  buffer_load_dwordx4 a[32:35], v1, s[12:15], s97 offen offset:0 sc1
  buffer_load_dwordx4 a[224:227], v1, s[12:15], s97 offen offset:1024 sc1
L_kf_kernel_gs_161:
L_kf_kernel_gg_157:
  s_and_b32 s97, s38, 0x1e00
  s_cbranch_scc0 L_kf_kernel_gg_162
  s_bitcmp1_b32 s38, 9
  s_cbranch_scc0 L_kf_kernel_gs_163
  s_add_u32 s97, s36, 36864
  s_waitcnt vmcnt(8)
  buffer_load_dwordx4 a[36:39], v1, s[12:15], s97 offen offset:0 sc1
  buffer_load_dwordx4 a[228:231], v1, s[12:15], s97 offen offset:1024 sc1
L_kf_kernel_gs_163:
  s_bitcmp1_b32 s38, 10
  s_cbranch_scc0 L_kf_kernel_gs_164
  s_add_u32 s97, s36, 40960
  s_waitcnt vmcnt(8)
  buffer_load_dwordx4 a[40:43], v1, s[12:15], s97 offen offset:0 sc1
  buffer_load_dwordx4 a[232:235], v1, s[12:15], s97 offen offset:1024 sc1
L_kf_kernel_gs_164:
  s_bitcmp1_b32 s38, 11
  s_cbranch_scc0 L_kf_kernel_gs_165
  s_add_u32 s97, s36, 45056
  s_waitcnt vmcnt(8)
  buffer_load_dwordx4 a[44:47], v1, s[12:15], s97 offen offset:0 sc1
  buffer_load_dwordx4 a[236:239], v1, s[12:15], s97 offen offset:1024 sc1
L_kf_kernel_gs_165:
  s_bitcmp1_b32 s38, 12
  s_cbranch_scc0 L_kf_kernel_gs_166
  s_add_u32 s97, s36, 49152
  s_waitcnt vmcnt(8)
  buffer_load_dwordx4 a[48:51], v1, s[12:15], s97 offen offset:0 sc1
  buffer_load_dwordx4 a[240:243], v1, s[12:15], s97 offen offset:1024 sc1
L_kf_kernel_gs_166:
L_kf_kernel_gg_162:
  s_and_b32 s97, s38, 0xe000
  s_cbranch_scc0 L_kf_kernel_gg_167
  s_bitcmp1_b32 s38, 13
  s_cbranch_scc0 L_kf_kernel_gs_168
  s_add_u32 s97, s36, 53248
  s_waitcnt vmcnt(8)
  buffer_load_dwordx4 a[52:55], v1, s[12:15], s97 offen offset:0 sc1
  buffer_load_dwordx4 a[244:247], v1, s[12:15], s97 offen offset:1024 sc1
L_kf_kernel_gs_168:
  s_bitcmp1_b32 s38, 14
  s_cbranch_scc0 L_kf_kernel_gs_169
  s_add_u32 s97, s36, 57344
  s_waitcnt vmcnt(8)
  buffer_load_dwordx4 a[56:59], v1, s[12:15], s97 offen offset:0 sc1
  buffer_load_dwordx4 a[248:251], v1, s[12:15], s97 offen offset:1024 sc1
L_kf_kernel_gs_169:
  s_bitcmp1_b32 s38, 15
  s_cbranch_scc0 L_kf_kernel_gs_170
  s_add_u32 s97, s36, 61440
  s_waitcnt vmcnt(8)
  buffer_load_dwordx4 a[60:63], v1, s[12:15], s97 offen offset:0 sc1
  buffer_load_dwordx4 a[252:255], v1, s[12:15], s97 offen offset:1024 sc1
L_kf_kernel_gs_170:
L_kf_kernel_gg_167:
L_kf_kernel_gc_139:
  s_andn2_b32 s97, 0x7fffff, s37
  s_cbranch_scc0 L_kf_kernel_gw_141
  buffer_load_dword v12, v13, s[12:15], s40 offen sc1
L_kf_kernel_gw_141:
  s_andn2_b32 s97, 0xffff, s45
  s_cbranch_scc1 L_kf_kernel_w1_171
  v_mfma_f32_16x16x32_bf16 v[32:35], v[22:25], a[0:3], 0
  s_xor_b32 s45, s45, 0x1000001
  v_lshlrev_b32 v128, 16, v96
  v_and_b32 v129, 0xffff0000, v96
  v_mfma_f32_16x16x32_bf16 v[36:39], v[28:31], a[2:5], 0
  v_lshlrev_b32 v130, 16, v97
  v_and_b32 v131, 0xffff0000, v97
  v_mfma_f32_16x16x32_bf16 v[32:35], v[28:31], a[6:9], v[32:35]
  v_lshlrev_b32 v132, 16, v98
  v_and_b32 v133, 0xffff0000, v98
  v_mfma_f32_16x16x32_bf16 v[36:39], v[28:31], a[10:13], v[36:39]
  v_lshlrev_b32 v134, 16, v99
  v_and_b32 v135, 0xffff0000, v99
  v_mfma_f32_16x16x32_bf16 v[32:35], v[28:31], a[14:17], v[32:35]
  v_lshlrev_b32 v144, 16, v100
  v_and_b32 v145, 0xffff0000, v100
  v_mfma_f32_16x16x32_bf16 v[36:39], v[28:31], a[18:21], v[36:39]
  v_lshlrev_b32 v146, 16, v101
  v_and_b32 v147, 0xffff0000, v101
  v_mfma_f32_16x16x32_bf16 v[32:35], v[28:31], a[22:25], v[32:35]
  v_lshlrev_b32 v148, 16, v102
  v_and_b32 v149, 0xffff0000, v102
  v_mfma_f32_16x16x32_bf16 v[36:39], v[28:31], a[26:29], v[36:39]
  v_lshlrev_b32 v150, 16, v103
  v_and_b32 v151, 0xffff0000, v103
  v_mfma_f32_16x16x32_bf16 v[32:35], v[28:31], a[30:33], v[32:35]
  v_mfma_f32_16x16x32_bf16 v[36:39], v[28:31], a[34:37], v[36:39]
  v_mfma_f32_16x16x32_bf16 v[32:35], v[28:31], a[38:41], v[32:35]
  v_mfma_f32_16x16x32_bf16 v[36:39], v[28:31], a[42:45], v[36:39]
  v_mfma_f32_16x16x32_bf16 v[32:35], v[28:31], a[46:49], v[32:35]
  v_mfma_f32_16x16x32_bf16 v[36:39], v[28:31], a[50:53], v[36:39]
  v_mfma_f32_16x16x32_bf16 v[32:35], v[28:31], a[54:57], v[32:35]
  v_mfma_f32_16x16x32_bf16 v[36:39], v[28:31], a[58:61], v[36:39]
  v_mfma_f32_16x16x32_bf16 v[32:35], v[26:29], a[60:63], v[32:35]
  v_mfma_f32_16x16x32_bf16 v[40:43], v[22:25], a[192:195], 0
  v_mfma_f32_16x16x32_bf16 v[44:47], v[28:31], a[194:197], 0
  v_mfma_f32_16x16x32_bf16 v[40:43], v[28:31], a[198:201], v[40:43]
  v_mfma_f32_16x16x32_bf16 v[44:47], v[28:31], a[202:205], v[44:47]
  v_mfma_f32_16x16x32_bf16 v[40:43], v[28:31], a[206:209], v[40:43]
  v_mfma_f32_16x16x32_bf16 v[44:47], v[28:31], a[210:213], v[44:47]
  v_mfma_f32_16x16x32_bf16 v[40:43], v[28:31], a[214:217], v[40:43]
  v_mfma_f32_16x16x32_bf16 v[44:47], v[28:31], a[218:221], v[44:47]
  v_cvt_pk_bf16_f32 v32, 0, v32
  v_cvt_pk_bf16_f32 v33, 0, v33
  v_mfma_f32_16x16x32_bf16 v[40:43], v[28:31], a[222:225], v[40:43]
  v_cvt_pk_bf16_f32 v34, 0, v34
  v_cvt_pk_bf16_f32 v35, 0, v35
  v_mfma_f32_16x16x32_bf16 v[44:47], v[28:31], a[226:229], v[44:47]
  v_cvt_pk_bf16_f32 v36, 0, v36
  v_cvt_pk_bf16_f32 v37, 0, v37
  v_mfma_f32_16x16x32_bf16 v[40:43], v[28:31], a[230:233], v[40:43]
  v_cvt_pk_bf16_f32 v38, 0, v38
  v_cvt_pk_bf16_f32 v39, 0, v39
  v_mfma_f32_16x16x32_bf16 v[44:47], v[28:31], a[234:237], v[44:47]
  v_mfma_f32_16x16x32_bf16 v[40:43], v[28:31], a[238:241], v[40:43]
  v_mfma_f32_16x16x32_bf16 v[44:47], v[28:31], a[242:245], v[44:47]
  v_mfma_f32_16x16x32_bf16 v[40:43], v[28:31], a[246:249], v[40:43]
  v_mfma_f32_16x16x32_bf16 v[44:47], v[28:31], a[250:253], v[44:47]
  v_mfma_f32_16x16x32_bf16 v[40:43], v[26:29], a[252:255], v[40:43]
  s_nop 7
  v_cvt_pk_bf16_f32 v40, 0, v40
  v_cvt_pk_bf16_f32 v41, 0, v41
  v_cvt_pk_bf16_f32 v42, 0, v42
  v_cvt_pk_bf16_f32 v43, 0, v43
  v_cvt_pk_bf16_f32 v44, 0, v44
  v_cvt_pk_bf16_f32 v45, 0, v45
  v_cvt_pk_bf16_f32 v46, 0, v46
  v_cvt_pk_bf16_f32 v47, 0, v47
L_kf_kernel_w1_171:
  s_andn2_b32 s97, 0x7f0000, s45
  s_cbranch_scc1 L_kf_kernel_w2_172
  v_mfma_f32_16x16x32_bf16 v[64:67], v[22:25], a[64:67], 0
  s_xor_b32 s45, s45, 0x2010000
  v_lshlrev_b32 v136, 16, v112
  v_and_b32 v137, 0xffff0000, v112
  v_mfma_f32_16x16x32_bf16 v[68:71], v[28:31], a[66:69], 0
  v_lshlrev_b32 v138, 16, v113
  v_and_b32 v139, 0xffff0000, v113
  v_mfma_f32_16x16x32_bf16 v[64:67], v[28:31], a[70:73], v[64:67]
  v_lshlrev_b32 v140, 16, v114
  v_and_b32 v141, 0xffff0000, v114
  v_mfma_f32_16x16x32_bf16 v[68:71], v[28:31], a[74:77], v[68:71]
  v_lshlrev_b32 v142, 16, v115
  v_and_b32 v143, 0xffff0000, v115
  v_mfma_f32_16x16x32_bf16 v[64:67], v[28:31], a[78:81], v[64:67]
  v_lshlrev_b32 v152, 16, v116
  v_and_b32 v153, 0xffff0000, v116
  v_mfma_f32_16x16x32_bf16 v[68:71], v[28:31], a[82:85], v[68:71]
  v_lshlrev_b32 v154, 16, v117
  v_and_b32 v155, 0xffff0000, v117
  v_mfma_f32_16x16x32_bf16 v[64:67], v[28:31], a[86:89], v[64:67]
  v_lshlrev_b32 v156, 16, v118
  v_and_b32 v157, 0xffff0000, v118
  v_mfma_f32_16x16x32_bf16 v[68:71], v[26:29], a[88:91], v[68:71]
  v_lshlrev_b32 v158, 16, v119
  v_and_b32 v159, 0xffff0000, v119
  v_mfma_f32_16x16x32_bf16 v[72:75], v[22:25], a[92:95], 0
  v_mfma_f32_16x16x32_bf16 v[76:79], v[28:31], a[94:97], 0
  v_mfma_f32_16x16x32_bf16 v[72:75], v[28:31], a[98:101], v[72:75]
  v_cvt_pk_bf16_f32 v64, 0, v64
  v_cvt_pk_bf16_f32 v65, 0, v65
  v_mfma_f32_16x16x32_bf16 v[76:79], v[28:31], a[102:105], v[76:79]
  v_cvt_pk_bf16_f32 v66, 0, v66
  v_cvt_pk_bf16_f32 v67, 0, v67
  v_mfma_f32_16x16x32_bf16 v[72:75], v[28:31], a[106:109], v[72:75]
  v_cvt_pk_bf16_f32 v68, 0, v68
  v_cvt_pk_bf16_f32 v69, 0, v69
  v_mfma_f32_16x16x32_bf16 v[76:79], v[28:31], a[110:113], v[76:79]
  v_cvt_pk_bf16_f32 v70, 0, v70
  v_cvt_pk_bf16_f32 v71, 0, v71
  v_mfma_f32_16x16x32_bf16 v[72:75], v[28:31], a[114:117], v[72:75]
  v_add_f32 v64, v64, v136
  v_add_f32 v65, v65, v137
  v_mfma_f32_16x16x32_bf16 v[76:79], v[26:29], a[116:119], v[76:79]
  v_add_f32 v66, v66, v138
  v_add_f32 v67, v67, v139
  v_add_f32 v68, v68, v140
  v_add_f32 v69, v69, v141
  v_add_f32 v70, v70, v142
  v_add_f32 v71, v71, v143
  v_cvt_pk_bf16_f32 v64, 0, v64
  v_cvt_pk_bf16_f32 v65, 0, v65
  v_cvt_pk_bf16_f32 v66, 0, v66
  v_cvt_pk_bf16_f32 v67, 0, v67
  v_cvt_pk_bf16_f32 v68, 0, v68
  v_cvt_pk_bf16_f32 v69, 0, v69
  v_cvt_pk_bf16_f32 v70, 0, v70
  v_cvt_pk_bf16_f32 v71, 0, v71
  v_mul_f32 v136, s76, v64
  v_mul_f32 v137, s76, v65
  v_mul_f32 v138, s76, v66
  v_mul_f32 v139, s76, v67
  v_mul_f32 v140, s76, v68
  v_mul_f32 v141, s76, v69
  v_mul_f32 v142, s76, v70
  v_mul_f32 v143, s76, v71
  v_exp_f32 v136, v136
  v_exp_f32 v137, v137
  v_exp_f32 v138, v138
  v_exp_f32 v139, v139
  v_exp_f32 v140, v140
  v_exp_f32 v141, v141
  v_exp_f32 v142, v142
  v_exp_f32 v143, v143
  v_add_f32 v136, 1.0, v136
  v_add_f32 v137, 1.0, v137
  v_add_f32 v138, 1.0, v138
  v_add_f32 v139, 1.0, v139
  v_add_f32 v140, 1.0, v140
  v_add_f32 v141, 1.0, v141
  v_add_f32 v142, 1.0, v142
  v_add_f32 v143, 1.0, v143
  v_rcp_f32 v136, v136
  v_rcp_f32 v137, v137
  v_rcp_f32 v138, v138
  v_rcp_f32 v139, v139
  v_rcp_f32 v140, v140
  v_rcp_f32 v141, v141
  v_rcp_f32 v142, v142
  v_rcp_f32 v143, v143
  v_mul_f32 v64, v64, v136
  v_mul_f32 v65, v65, v137
  v_mul_f32 v66, v66, v138
  v_mul_f32 v67, v67, v139
  v_mul_f32 v68, v68, v140
  v_mul_f32 v69, v69, v141
  v_mul_f32 v70, v70, v142
  v_mul_f32 v71, v71, v143
  v_cvt_pk_bf16_f32 v64, 0, v64
  v_cvt_pk_bf16_f32 v65, 0, v65
  v_cvt_pk_bf16_f32 v66, 0, v66
  v_cvt_pk_bf16_f32 v67, 0, v67
  v_cvt_pk_bf16_f32 v68, 0, v68
  v_cvt_pk_bf16_f32 v69, 0, v69
  v_cvt_pk_bf16_f32 v70, 0, v70
  v_cvt_pk_bf16_f32 v71, 0, v71
  v_cvt_pk_bf16_f32 v72, 0, v72
  v_cvt_pk_bf16_f32 v73, 0, v73
  v_cvt_pk_bf16_f32 v74, 0, v74
  v_cvt_pk_bf16_f32 v75, 0, v75
  v_cvt_pk_bf16_f32 v76, 0, v76
  v_cvt_pk_bf16_f32 v77, 0, v77
  v_cvt_pk_bf16_f32 v78, 0, v78
  v_cvt_pk_bf16_f32 v79, 0, v79
  v_add_f32 v72, v72, v152
  v_add_f32 v73, v73, v153
  v_add_f32 v74, v74, v154
  v_add_f32 v75, v75, v155
  v_add_f32 v76, v76, v156
  v_add_f32 v77, v77, v157
  v_add_f32 v78, v78, v158
  v_add_f32 v79, v79, v159
  v_cvt_pk_bf16_f32 v72, 0, v72
  v_cvt_pk_bf16_f32 v73, 0, v73
  v_cvt_pk_bf16_f32 v74, 0, v74
  v_cvt_pk_bf16_f32 v75, 0, v75
  v_cvt_pk_bf16_f32 v76, 0, v76
  v_cvt_pk_bf16_f32 v77, 0, v77
  v_cvt_pk_bf16_f32 v78, 0, v78
  v_cvt_pk_bf16_f32 v79, 0, v79
  v_mul_f32 v152, s76, v72
  v_mul_f32 v153, s76, v73
  v_mul_f32 v154, s76, v74
  v_mul_f32 v155, s76, v75
  v_mul_f32 v156, s76, v76
  v_mul_f32 v157, s76, v77
  v_mul_f32 v158, s76, v78
  v_mul_f32 v159, s76, v79
  v_exp_f32 v152, v152
  v_exp_f32 v153, v153
  v_exp_f32 v154, v154
  v_exp_f32 v155, v155
  v_exp_f32 v156, v156
  v_exp_f32 v157, v157
  v_exp_f32 v158, v158
  v_exp_f32 v159, v159
  v_add_f32 v152, 1.0, v152
  v_add_f32 v153, 1.0, v153
  v_add_f32 v154, 1.0, v154
  v_add_f32 v155, 1.0, v155
  v_add_f32 v156, 1.0, v156
  v_add_f32 v157, 1.0, v157
  v_add_f32 v158, 1.0, v158
  v_add_f32 v159, 1.0, v159
  v_rcp_f32 v152, v152
  v_rcp_f32 v153, v153
  v_rcp_f32 v154, v154
  v_rcp_f32 v155, v155
  v_rcp_f32 v156, v156
  v_rcp_f32 v157, v157
  v_rcp_f32 v158, v158
  v_rcp_f32 v159, v159
  v_mul_f32 v72, v72, v152
  v_mul_f32 v73, v73, v153
  v_mul_f32 v74, v74, v154
  v_mul_f32 v75, v75, v155
  v_mul_f32 v76, v76, v156
  v_mul_f32 v77, v77, v157
  v_mul_f32 v78, v78, v158
  v_mul_f32 v79, v79, v159
  v_cvt_pk_bf16_f32 v72, 0, v72
  v_cvt_pk_bf16_f32 v73, 0, v73
  v_cvt_pk_bf16_f32 v74, 0, v74
  v_cvt_pk_bf16_f32 v75, 0, v75
  v_cvt_pk_bf16_f32 v76, 0, v76
  v_cvt_pk_bf16_f32 v77, 0, v77
  v_cvt_pk_bf16_f32 v78, 0, v78
  v_cvt_pk_bf16_f32 v79, 0, v79
L_kf_kernel_w2_172:
  s_cmp_ge_u32 s45, 0x3000000
  s_cbranch_scc1 L_kf_kernel_gd_140
  s_or_b32 s45, s45, s38
  s_sub_u32 s63, s63, 1
  s_waitcnt vmcnt(0)
  s_cbranch_scc0 L_kf_kernel_gl_138
L_kf_kernel_gd_140:
  v_mul_f32 v64, v64, v32
  v_mul_f32 v65, v65, v33
  v_mul_f32 v66, v66, v34
  v_mul_f32 v67, v67, v35
  v_mul_f32 v68, v68, v36
  v_mul_f32 v69, v69, v37
  v_mul_f32 v70, v70, v38
  v_mul_f32 v71, v71, v39
  v_cvt_pk_bf16_f32 v64, 0, v64
  v_cvt_pk_bf16_f32 v65, 0, v65
  v_cvt_pk_bf16_f32 v66, 0, v66
  v_cvt_pk_bf16_f32 v67, 0, v67
  v_cvt_pk_bf16_f32 v68, 0, v68
  v_cvt_pk_bf16_f32 v69, 0, v69
  v_cvt_pk_bf16_f32 v70, 0, v70
  v_cvt_pk_bf16_f32 v71, 0, v71
  v_add_f32 v64, v64, v128
  v_add_f32 v65, v65, v129
  v_add_f32 v66, v66, v130
  v_add_f32 v67, v67, v131
  v_add_f32 v68, v68, v132
  v_add_f32 v69, v69, v133
  v_add_f32 v70, v70, v134
  v_add_f32 v71, v71, v135
  v_cvt_pk_bf16_f32 v64, v64, v65
  v_cvt_pk_bf16_f32 v65, v66, v67
  buffer_store_dwordx2 v[64:65], v8, s[8:11], s42 offen offset:0
  v_cvt_pk_bf16_f32 v66, v68, v69
  v_cvt_pk_bf16_f32 v67, v70, v71
  buffer_store_dwordx2 v[66:67], v8, s[8:11], s42 offen offset:32
  v_mul_f32 v72, v72, v40
  v_mul_f32 v73, v73, v41
  v_mul_f32 v74, v74, v42
  v_mul_f32 v75, v75, v43
  v_mul_f32 v76, v76, v44
  v_mul_f32 v77, v77, v45
  v_mul_f32 v78, v78, v46
  v_mul_f32 v79, v79, v47
  v_cvt_pk_bf16_f32 v72, 0, v72
  v_cvt_pk_bf16_f32 v73, 0, v73
  v_cvt_pk_bf16_f32 v74, 0, v74
  v_cvt_pk_bf16_f32 v75, 0, v75
  v_cvt_pk_bf16_f32 v76, 0, v76
  v_cvt_pk_bf16_f32 v77, 0, v77
  v_cvt_pk_bf16_f32 v78, 0, v78
  v_cvt_pk_bf16_f32 v79, 0, v79
  v_add_f32 v72, v72, v144
  v_add_f32 v73, v73, v145
  v_add_f32 v74, v74, v146
  v_add_f32 v75, v75, v147
  v_add_f32 v76, v76, v148
  v_add_f32 v77, v77, v149
  v_add_f32 v78, v78, v150
  v_add_f32 v79, v79, v151
  v_cvt_pk_bf16_f32 v72, v72, v73
  v_cvt_pk_bf16_f32 v73, v74, v75
  buffer_store_dwordx2 v[72:73], v8, s[8:11], s42 offen offset:64
  v_cvt_pk_bf16_f32 v74, v76, v77
  v_cvt_pk_bf16_f32 v75, v78, v79
  buffer_store_dwordx2 v[74:75], v8, s[8:11], s42 offen offset:96
  s_endpgm
L_kf_kernel_t4_101:
  buffer_load_dwordx2 v[116:117], v9, s[20:23], s44 offen offset:64
  buffer_load_dwordx2 v[118:119], v9, s[20:23], s44 offen offset:96
  buffer_load_dwordx2 v[100:101], v8, s[4:7], s42 offen offset:64
  buffer_load_dwordx2 v[102:103], v8, s[4:7], s42 offen offset:96
  buffer_load_dwordx2 v[104:105], v8, s[4:7], s43 offen offset:0
  buffer_load_dwordx2 v[106:107], v8, s[4:7], s43 offen offset:32
  buffer_load_dwordx2 v[108:109], v8, s[4:7], s43 offen offset:64
  buffer_load_dwordx2 v[110:111], v8, s[4:7], s43 offen offset:96
  v_lshlrev_b32 v128, 16, v96
  v_and_b32 v129, 0xffff0000, v96
  v_lshlrev_b32 v130, 16, v97
  v_and_b32 v131, 0xffff0000, v97
  v_lshlrev_b32 v132, 16, v98
  v_and_b32 v133, 0xffff0000, v98
  v_lshlrev_b32 v134, 16, v99
  v_and_b32 v135, 0xffff0000, v99
  v_lshlrev_b32 v136, 16, v112
  v_and_b32 v137, 0xffff0000, v112
  v_lshlrev_b32 v138, 16, v113
  v_and_b32 v139, 0xffff0000, v113
  v_lshlrev_b32 v140, 16, v114
  v_and_b32 v141, 0xffff0000, v114
  v_lshlrev_b32 v142, 16, v115
  v_and_b32 v143, 0xffff0000, v115
  s_waitcnt vmcnt(5)
  v_lshlrev_b32 v144, 16, v100
  v_and_b32 v145, 0xffff0000, v100
  v_lshlrev_b32 v146, 16, v101
  v_and_b32 v147, 0xffff0000, v101
  s_waitcnt vmcnt(4)
  v_lshlrev_b32 v148, 16, v102
  v_and_b32 v149, 0xffff0000, v102
  v_lshlrev_b32 v150, 16, v103
  v_and_b32 v151, 0xffff0000, v103
  v_lshlrev_b32 v152, 16, v116
  v_and_b32 v153, 0xffff0000, v116
  v_lshlrev_b32 v154, 16, v117
  v_and_b32 v155, 0xffff0000, v117
  v_lshlrev_b32 v156, 16, v118
  v_and_b32 v157, 0xffff0000, v118
  v_lshlrev_b32 v158, 16, v119
  v_and_b32 v159, 0xffff0000, v119
  s_waitcnt vmcnt(3)
  v_lshlrev_b32 v160, 16, v104
  v_and_b32 v161, 0xffff0000, v104
  v_lshlrev_b32 v162, 16, v105
  v_and_b32 v163, 0xffff0000, v105
  s_waitcnt vmcnt(2)
  v_lshlrev_b32 v164, 16, v106
  v_and_b32 v165, 0xffff0000, v106
  v_lshlrev_b32 v166, 16, v107
  v_and_b32 v167, 0xffff0000, v107
  v_lshlrev_b32 v168, 16, v112
  v_and_b32 v169, 0xffff0000, v112
  v_lshlrev_b32 v170, 16, v113
  v_and_b32 v171, 0xffff0000, v113
  v_lshlrev_b32 v172, 16, v114
  v_and_b32 v173, 0xffff0000, v114
  v_lshlrev_b32 v174, 16, v115
  v_and_b32 v175, 0xffff0000, v115
  s_waitcnt vmcnt(1)
  v_lshlrev_b32 v176, 16, v108
  v_and_b32 v177, 0xffff0000, v108
  v_lshlrev_b32 v178, 16, v109
  v_and_b32 v179, 0xffff0000, v109
  s_waitcnt vmcnt(0)
  v_lshlrev_b32 v180, 16, v110
  v_and_b32 v181, 0xffff0000, v110
  v_lshlrev_b32 v182, 16, v111
  v_and_b32 v183, 0xffff0000, v111
  v_lshlrev_b32 v184, 16, v116
  v_and_b32 v185, 0xffff0000, v116
  v_lshlrev_b32 v186, 16, v117
  v_and_b32 v187, 0xffff0000, v117
  v_lshlrev_b32 v188, 16, v118
  v_and_b32 v189, 0xffff0000, v118
  v_lshlrev_b32 v190, 16, v119
  v_and_b32 v191, 0xffff0000, v119
L_kf_kernel_gl_173:
  v_cmp_ne_u32 vcc, 0, v12
  s_nop 0
  s_andn2_b32 s38, vcc_lo, s37
  s_cbranch_scc0 L_kf_kernel_gc_174
  s_or_b32 s37, s37, s38
  s_and_b32 s97, s38, 0xf0000
  s_cbranch_scc0 L_kf_kernel_gg_177
  s_bitcmp1_b32 s38, 16
  s_cbranch_scc0 L_kf_kernel_gs_178
  s_add_u32 s97, s36, 65536
  s_waitcnt vmcnt(6)
  buffer_load_dwordx4 a[0:3], v1, s[12:15], s97 offen offset:0 sc1
  buffer_load_dwordx4 a[28:31], v1, s[12:15], s97 offen offset:1024 sc1
  buffer_load_dwordx4 a[56:59], v1, s[12:15], s97 offen offset:2048 sc1
  buffer_load_dwordx4 a[84:87], v1, s[12:15], s97 offen offset:3072 sc1
L_kf_kernel_gs_178:
  s_bitcmp1_b32 s38, 17
  s_cbranch_scc0 L_kf_kernel_gs_179
  s_add_u32 s97, s36, 69632
  s_waitcnt vmcnt(6)
  buffer_load_dwordx4 a[4:7], v1, s[12:15], s97 offen offset:0 sc1
  buffer_load_dwordx4 a[32:35], v1, s[12:15], s97 offen offset:1024 sc1
  buffer_load_dwordx4 a[60:63], v1, s[12:15], s97 offen offset:2048 sc1
  buffer_load_dwordx4 a[88:91], v1, s[12:15], s97 offen offset:3072 sc1
L_kf_kernel_gs_179:
  s_bitcmp1_b32 s38, 18
  s_cbranch_scc0 L_kf_kernel_gs_180
  s_add_u32 s97, s36, 73728
  s_waitcnt vmcnt(6)
  buffer_load_dwordx4 a[8:11], v1, s[12:15], s97 offen offset:0 sc1
  buffer_load_dwordx4 a[36:39], v1, s[12:15], s97 offen offset:1024 sc1
  buffer_load_dwordx4 a[64:67], v1, s[12:15], s97 offen offset:2048 sc1
  buffer_load_dwordx4 a[92:95], v1, s[12:15], s97 offen offset:3072 sc1
L_kf_kernel_gs_180:
  s_bitcmp1_b32 s38, 19
  s_cbranch_scc0 L_kf_kernel_gs_181
  s_add_u32 s97, s36, 77824
  s_waitcnt vmcnt(6)
  buffer_load_dwordx4 a[12:15], v1, s[12:15], s97 offen offset:0 sc1
  buffer_load_dwordx4 a[40:43], v1, s[12:15], s97 offen offset:1024 sc1
  buffer_load_dwordx4 a[68:71], v1, s[12:15], s97 offen offset:2048 sc1
  buffer_load_dwordx4 a[96:99], v1, s[12:15], s97 offen offset:3072 sc1
L_kf_kernel_gs_181:
L_kf_kernel_gg_177:
  s_and_b32 s97, s38, 0x700000
  s_cbranch_scc0 L_kf_kernel_gg_182
  s_bitcmp1_b32 s38, 20
  s_cbranch_scc0 L_kf_kernel_gs_183
  s_add_u32 s97, s36, 81920
  s_waitcnt vmcnt(6)
  buffer_load_dwordx4 a[16:19], v1, s[12:15], s97 offen offset:0 sc1
  buffer_load_dwordx4 a[44:47], v1, s[12:15], s97 offen offset:1024 sc1
  buffer_load_dwordx4 a[72:75], v1, s[12:15], s97 offen offset:2048 sc1
  buffer_load_dwordx4 a[100:103], v1, s[12:15], s97 offen offset:3072 sc1
L_kf_kernel_gs_183:
  s_bitcmp1_b32 s38, 21
  s_cbranch_scc0 L_kf_kernel_gs_184
  s_add_u32 s97, s36, 86016
  s_waitcnt vmcnt(6)
  buffer_load_dwordx4 a[20:23], v1, s[12:15], s97 offen offset:0 sc1
  buffer_load_dwordx4 a[48:51], v1, s[12:15], s97 offen offset:1024 sc1
  buffer_load_dwordx4 a[76:79], v1, s[12:15], s97 offen offset:2048 sc1
  buffer_load_dwordx4 a[104:107], v1, s[12:15], s97 offen offset:3072 sc1
L_kf_kernel_gs_184:
  s_bitcmp1_b32 s38, 22
  s_cbranch_scc0 L_kf_kernel_gs_185
  s_add_u32 s97, s36, 90112
  s_waitcnt vmcnt(6)
  buffer_load_dwordx4 a[24:27], v1, s[12:15], s97 offen offset:0 sc1
  buffer_load_dwordx4 a[52:55], v1, s[12:15], s97 offen offset:1024 sc1
  buffer_load_dwordx4 a[80:83], v1, s[12:15], s97 offen offset:2048 sc1
  buffer_load_dwordx4 a[108:111], v1, s[12:15], s97 offen offset:3072 sc1
L_kf_kernel_gs_185:
L_kf_kernel_gg_182:
L_kf_kernel_gc_174:
  s_andn2_b32 s97, 0x7f0000, s37
  s_cbranch_scc0 L_kf_kernel_gd_175
  buffer_load_dword v12, v13, s[12:15], s40 offen sc1
  s_sub_u32 s63, s63, 1
  s_waitcnt vmcnt(0)
  s_cbranch_scc0 L_kf_kernel_gl_173
L_kf_kernel_gd_175:
  s_waitcnt vmcnt(0)
  v_mfma_f32_16x16x32_bf16 v[64:67], v[22:25], a[0:3], 0
  v_mfma_f32_16x16x32_bf16 v[68:71], v[28:31], a[2:5], 0
  v_mfma_f32_16x16x32_bf16 v[64:67], v[28:31], a[6:9], v[64:67]
  v_mfma_f32_16x16x32_bf16 v[68:71], v[28:31], a[10:13], v[68:71]
  v_mfma_f32_16x16x32_bf16 v[64:67], v[28:31], a[14:17], v[64:67]
  v_mfma_f32_16x16x32_bf16 v[68:71], v[28:31], a[18:21], v[68:71]
  v_mfma_f32_16x16x32_bf16 v[64:67], v[28:31], a[22:25], v[64:67]
  v_mfma_f32_16x16x32_bf16 v[68:71], v[26:29], a[24:27], v[68:71]
  v_mfma_f32_16x16x32_bf16 v[72:75], v[22:25], a[28:31], 0
  v_mfma_f32_16x16x32_bf16 v[76:79], v[28:31], a[30:33], 0
  v_mfma_f32_16x16x32_bf16 v[72:75], v[28:31], a[34:37], v[72:75]
  v_mfma_f32_16x16x32_bf16 v[76:79], v[28:31], a[38:41], v[76:79]
  v_mfma_f32_16x16x32_bf16 v[72:75], v[28:31], a[42:45], v[72:75]
  v_mfma_f32_16x16x32_bf16 v[76:79], v[28:31], a[46:49], v[76:79]
  v_mfma_f32_16x16x32_bf16 v[72:75], v[28:31], a[50:53], v[72:75]
  v_cvt_pk_bf16_f32 v64, 0, v64
  v_cvt_pk_bf16_f32 v65, 0, v65
  v_mfma_f32_16x16x32_bf16 v[76:79], v[26:29], a[52:55], v[76:79]
  v_cvt_pk_bf16_f32 v66, 0, v66
  v_cvt_pk_bf16_f32 v67, 0, v67
  v_mfma_f32_16x16x32_bf16 v[80:83], v[22:25], a[56:59], 0
  v_cvt_pk_bf16_f32 v68, 0, v68
  v_cvt_pk_bf16_f32 v69, 0, v69
  v_mfma_f32_16x16x32_bf16 v[84:87], v[28:31], a[58:61], 0
  v_cvt_pk_bf16_f32 v70, 0, v70
  v_cvt_pk_bf16_f32 v71, 0, v71
  v_mfma_f32_16x16x32_bf16 v[80:83], v[28:31], a[62:65], v[80:83]
  v_add_f32 v64, v64, v136
  v_add_f32 v65, v65, v137
  v_mfma_f32_16x16x32_bf16 v[84:87], v[28:31], a[66:69], v[84:87]
  v_add_f32 v66, v66, v138
  v_add_f32 v67, v67, v139
  v_mfma_f32_16x16x32_bf16 v[80:83], v[28:31], a[70:73], v[80:83]
  v_add_f32 v68, v68, v140
  v_add_f32 v69, v69, v141
  v_mfma_f32_16x16x32_bf16 v[84:87], v[28:31], a[74:77], v[84:87]
  v_add_f32 v70, v70, v142
  v_add_f32 v71, v71, v143
  v_mfma_f32_16x16x32_bf16 v[80:83], v[28:31], a[78:81], v[80:83]
  v_cvt_pk_bf16_f32 v64, 0, v64
  v_cvt_pk_bf16_f32 v65, 0, v65
  v_mfma_f32_16x16x32_bf16 v[84:87], v[26:29], a[80:83], v[84:87]
  v_cvt_pk_bf16_f32 v66, 0, v66
  v_cvt_pk_bf16_f32 v67, 0, v67
  v_mfma_f32_16x16x32_bf16 v[88:91], v[22:25], a[84:87], 0
  v_cvt_pk_bf16_f32 v68, 0, v68
  v_cvt_pk_bf16_f32 v69, 0, v69
  v_mfma_f32_16x16x32_bf16 v[92:95], v[28:31], a[86:89], 0
  v_cvt_pk_bf16_f32 v70, 0, v70
  v_cvt_pk_bf16_f32 v71, 0, v71
  v_mfma_f32_16x16x32_bf16 v[88:91], v[28:31], a[90:93], v[88:91]
  v_mul_f32 v136, s76, v64
  v_mul_f32 v137, s76, v65
  v_mfma_f32_16x16x32_bf16 v[92:95], v[28:31], a[94:97], v[92:95]
  v_mul_f32 v138, s76, v66
  v_mul_f32 v139, s76, v67
  v_mfma_f32_16x16x32_bf16 v[88:91], v[28:31], a[98:101], v[88:91]
  v_mul_f32 v140, s76, v68
  v_mul_f32 v141, s76, v69
  v_mfma_f32_16x16x32_bf16 v[92:95], v[28:31], a[102:105], v[92:95]
  v_mul_f32 v142, s76, v70
  v_mul_f32 v143, s76, v71
  v_mfma_f32_16x16x32_bf16 v[88:91], v[28:31], a[106:109], v[88:91]
  v_exp_f32 v136, v136
  v_mfma_f32_16x16x32_bf16 v[92:95], v[26:29], a[108:111], v[92:95]
  v_exp_f32 v137, v137
  v_exp_f32 v138, v138
  v_exp_f32 v139, v139
  v_exp_f32 v140, v140
  v_exp_f32 v141, v141
  v_exp_f32 v142, v142
  v_exp_f32 v143, v143
  v_add_f32 v136, 1.0, v136
  v_add_f32 v137, 1.0, v137
  v_add_f32 v138, 1.0, v138
  v_add_f32 v139, 1.0, v139
  v_add_f32 v140, 1.0, v140
  v_add_f32 v141, 1.0, v141
  v_add_f32 v142, 1.0, v142
  v_add_f32 v143, 1.0, v143
  v_rcp_f32 v136, v136
  v_rcp_f32 v137, v137
  v_rcp_f32 v138, v138
  v_rcp_f32 v139, v139
  v_rcp_f32 v140, v140
  v_rcp_f32 v141, v141
  v_rcp_f32 v142, v142
  v_rcp_f32 v143, v143
  v_mul_f32 v64, v64, v136
  v_mul_f32 v65, v65, v137
  v_mul_f32 v66, v66, v138
  v_mul_f32 v67, v67, v139
  v_mul_f32 v68, v68, v140
  v_mul_f32 v69, v69, v141
  v_mul_f32 v70, v70, v142
  v_mul_f32 v71, v71, v143
  v_cvt_pk_bf16_f32 v64, 0, v64
  v_cvt_pk_bf16_f32 v65, 0, v65
  v_cvt_pk_bf16_f32 v66, 0, v66
  v_cvt_pk_bf16_f32 v67, 0, v67
  v_cvt_pk_bf16_f32 v68, 0, v68
  v_cvt_pk_bf16_f32 v69, 0, v69
  v_cvt_pk_bf16_f32 v70, 0, v70
  v_cvt_pk_bf16_f32 v71, 0, v71
  v_mul_f32 v64, v64, v32
  v_mul_f32 v65, v65, v33
  v_mul_f32 v66, v66, v34
  v_mul_f32 v67, v67, v35
  v_mul_f32 v68, v68, v36
  v_mul_f32 v69, v69, v37
  v_mul_f32 v70, v70, v38
  v_mul_f32 v71, v71, v39
  v_cvt_pk_bf16_f32 v64, 0, v64
  v_cvt_pk_bf16_f32 v65, 0, v65
  v_cvt_pk_bf16_f32 v66, 0, v66
  v_cvt_pk_bf16_f32 v67, 0, v67
  v_cvt_pk_bf16_f32 v68, 0, v68
  v_cvt_pk_bf16_f32 v69, 0, v69
  v_cvt_pk_bf16_f32 v70, 0, v70
  v_cvt_pk_bf16_f32 v71, 0, v71
  v_add_f32 v64, v64, v128
  v_add_f32 v65, v65, v129
  v_add_f32 v66, v66, v130
  v_add_f32 v67, v67, v131
  v_add_f32 v68, v68, v132
  v_add_f32 v69, v69, v133
  v_add_f32 v70, v70, v134
  v_add_f32 v71, v71, v135
  v_cvt_pk_bf16_f32 v64, v64, v65
  v_cvt_pk_bf16_f32 v65, v66, v67
  buffer_store_dwordx2 v[64:65], v8, s[8:11], s42 offen offset:0
  v_cvt_pk_bf16_f32 v66, v68, v69
  v_cvt_pk_bf16_f32 v67, v70, v71
  buffer_store_dwordx2 v[66:67], v8, s[8:11], s42 offen offset:32
  v_cvt_pk_bf16_f32 v72, 0, v72
  v_cvt_pk_bf16_f32 v73, 0, v73
  v_cvt_pk_bf16_f32 v74, 0, v74
  v_cvt_pk_bf16_f32 v75, 0, v75
  v_cvt_pk_bf16_f32 v76, 0, v76
  v_cvt_pk_bf16_f32 v77, 0, v77
  v_cvt_pk_bf16_f32 v78, 0, v78
  v_cvt_pk_bf16_f32 v79, 0, v79
  v_add_f32 v72, v72, v152
  v_add_f32 v73, v73, v153
  v_add_f32 v74, v74, v154
  v_add_f32 v75, v75, v155
  v_add_f32 v76, v76, v156
  v_add_f32 v77, v77, v157
  v_add_f32 v78, v78, v158
  v_add_f32 v79, v79, v159
  v_cvt_pk_bf16_f32 v72, 0, v72
  v_cvt_pk_bf16_f32 v73, 0, v73
  v_cvt_pk_bf16_f32 v74, 0, v74
  v_cvt_pk_bf16_f32 v75, 0, v75
  v_cvt_pk_bf16_f32 v76, 0, v76
  v_cvt_pk_bf16_f32 v77, 0, v77
  v_cvt_pk_bf16_f32 v78, 0, v78
  v_cvt_pk_bf16_f32 v79, 0, v79
  v_mul_f32 v152, s76, v72
  v_mul_f32 v153, s76, v73
  v_mul_f32 v154, s76, v74
  v_mul_f32 v155, s76, v75
  v_mul_f32 v156, s76, v76
  v_mul_f32 v157, s76, v77
  v_mul_f32 v158, s76, v78
  v_mul_f32 v159, s76, v79
  v_exp_f32 v152, v152
  v_exp_f32 v153, v153
  v_exp_f32 v154, v154
  v_exp_f32 v155, v155
  v_exp_f32 v156, v156
  v_exp_f32 v157, v157
  v_exp_f32 v158, v158
  v_exp_f32 v159, v159
  v_add_f32 v152, 1.0, v152
  v_add_f32 v153, 1.0, v153
  v_add_f32 v154, 1.0, v154
  v_add_f32 v155, 1.0, v155
  v_add_f32 v156, 1.0, v156
  v_add_f32 v157, 1.0, v157
  v_add_f32 v158, 1.0, v158
  v_add_f32 v159, 1.0, v159
  v_rcp_f32 v152, v152
  v_rcp_f32 v153, v153
  v_rcp_f32 v154, v154
  v_rcp_f32 v155, v155
  v_rcp_f32 v156, v156
  v_rcp_f32 v157, v157
  v_rcp_f32 v158, v158
  v_rcp_f32 v159, v159
  v_mul_f32 v72, v72, v152
  v_mul_f32 v73, v73, v153
  v_mul_f32 v74, v74, v154
  v_mul_f32 v75, v75, v155
  v_mul_f32 v76, v76, v156
  v_mul_f32 v77, v77, v157
  v_mul_f32 v78, v78, v158
  v_mul_f32 v79, v79, v159
  v_cvt_pk_bf16_f32 v72, 0, v72
  v_cvt_pk_bf16_f32 v73, 0, v73
  v_cvt_pk_bf16_f32 v74, 0, v74
  v_cvt_pk_bf16_f32 v75, 0, v75
  v_cvt_pk_bf16_f32 v76, 0, v76
  v_cvt_pk_bf16_f32 v77, 0, v77
  v_cvt_pk_bf16_f32 v78, 0, v78
  v_cvt_pk_bf16_f32 v79, 0, v79
  v_mul_f32 v72, v72, v40
  v_mul_f32 v73, v73, v41
  v_mul_f32 v74, v74, v42
  v_mul_f32 v75, v75, v43
  v_mul_f32 v76, v76, v44
  v_mul_f32 v77, v77, v45
  v_mul_f32 v78, v78, v46
  v_mul_f32 v79, v79, v47
  v_cvt_pk_bf16_f32 v72, 0, v72
  v_cvt_pk_bf16_f32 v73, 0, v73
  v_cvt_pk_bf16_f32 v74, 0, v74
  v_cvt_pk_bf16_f32 v75, 0, v75
  v_cvt_pk_bf16_f32 v76, 0, v76
  v_cvt_pk_bf16_f32 v77, 0, v77
  v_cvt_pk_bf16_f32 v78, 0, v78
  v_cvt_pk_bf16_f32 v79, 0, v79
  v_add_f32 v72, v72, v144
  v_add_f32 v73, v73, v145
  v_add_f32 v74, v74, v146
  v_add_f32 v75, v75, v147
  v_add_f32 v76, v76, v148
  v_add_f32 v77, v77, v149
  v_add_f32 v78, v78, v150
  v_add_f32 v79, v79, v151
  v_cvt_pk_bf16_f32 v72, v72, v73
  v_cvt_pk_bf16_f32 v73, v74, v75
  buffer_store_dwordx2 v[72:73], v8, s[8:11], s42 offen offset:64
  v_cvt_pk_bf16_f32 v74, v76, v77
  v_cvt_pk_bf16_f32 v75, v78, v79
  buffer_store_dwordx2 v[74:75], v8, s[8:11], s42 offen offset:96
  v_cvt_pk_bf16_f32 v80, 0, v80
  v_cvt_pk_bf16_f32 v81, 0, v81
  v_cvt_pk_bf16_f32 v82, 0, v82
  v_cvt_pk_bf16_f32 v83, 0, v83
  v_cvt_pk_bf16_f32 v84, 0, v84
  v_cvt_pk_bf16_f32 v85, 0, v85
  v_cvt_pk_bf16_f32 v86, 0, v86
  v_cvt_pk_bf16_f32 v87, 0, v87
  v_add_f32 v80, v80, v168
  v_add_f32 v81, v81, v169
  v_add_f32 v82, v82, v170
  v_add_f32 v83, v83, v171
  v_add_f32 v84, v84, v172
  v_add_f32 v85, v85, v173
  v_add_f32 v86, v86, v174
  v_add_f32 v87, v87, v175
  v_cvt_pk_bf16_f32 v80, 0, v80
  v_cvt_pk_bf16_f32 v81, 0, v81
  v_cvt_pk_bf16_f32 v82, 0, v82
  v_cvt_pk_bf16_f32 v83, 0, v83
  v_cvt_pk_bf16_f32 v84, 0, v84
  v_cvt_pk_bf16_f32 v85, 0, v85
  v_cvt_pk_bf16_f32 v86, 0, v86
  v_cvt_pk_bf16_f32 v87, 0, v87
  v_mul_f32 v168, s76, v80
  v_mul_f32 v169, s76, v81
  v_mul_f32 v170, s76, v82
  v_mul_f32 v171, s76, v83
  v_mul_f32 v172, s76, v84
  v_mul_f32 v173, s76, v85
  v_mul_f32 v174, s76, v86
  v_mul_f32 v175, s76, v87
  v_exp_f32 v168, v168
  v_exp_f32 v169, v169
  v_exp_f32 v170, v170
  v_exp_f32 v171, v171
  v_exp_f32 v172, v172
  v_exp_f32 v173, v173
  v_exp_f32 v174, v174
  v_exp_f32 v175, v175
  v_add_f32 v168, 1.0, v168
  v_add_f32 v169, 1.0, v169
  v_add_f32 v170, 1.0, v170
  v_add_f32 v171, 1.0, v171
  v_add_f32 v172, 1.0, v172
  v_add_f32 v173, 1.0, v173
  v_add_f32 v174, 1.0, v174
  v_add_f32 v175, 1.0, v175
  v_rcp_f32 v168, v168
  v_rcp_f32 v169, v169
  v_rcp_f32 v170, v170
  v_rcp_f32 v171, v171
  v_rcp_f32 v172, v172
  v_rcp_f32 v173, v173
  v_rcp_f32 v174, v174
  v_rcp_f32 v175, v175
  v_mul_f32 v80, v80, v168
  v_mul_f32 v81, v81, v169
  v_mul_f32 v82, v82, v170
  v_mul_f32 v83, v83, v171
  v_mul_f32 v84, v84, v172
  v_mul_f32 v85, v85, v173
  v_mul_f32 v86, v86, v174
  v_mul_f32 v87, v87, v175
  v_cvt_pk_bf16_f32 v80, 0, v80
  v_cvt_pk_bf16_f32 v81, 0, v81
  v_cvt_pk_bf16_f32 v82, 0, v82
  v_cvt_pk_bf16_f32 v83, 0, v83
  v_cvt_pk_bf16_f32 v84, 0, v84
  v_cvt_pk_bf16_f32 v85, 0, v85
  v_cvt_pk_bf16_f32 v86, 0, v86
  v_cvt_pk_bf16_f32 v87, 0, v87
  v_mul_f32 v80, v80, v48
  v_mul_f32 v81, v81, v49
  v_mul_f32 v82, v82, v50
  v_mul_f32 v83, v83, v51
  v_mul_f32 v84, v84, v52
  v_mul_f32 v85, v85, v53
  v_mul_f32 v86, v86, v54
  v_mul_f32 v87, v87, v55
  v_cvt_pk_bf16_f32 v80, 0, v80
  v_cvt_pk_bf16_f32 v81, 0, v81
  v_cvt_pk_bf16_f32 v82, 0, v82
  v_cvt_pk_bf16_f32 v83, 0, v83
  v_cvt_pk_bf16_f32 v84, 0, v84
  v_cvt_pk_bf16_f32 v85, 0, v85
  v_cvt_pk_bf16_f32 v86, 0, v86
  v_cvt_pk_bf16_f32 v87, 0, v87
  v_add_f32 v80, v80, v160
  v_add_f32 v81, v81, v161
  v_add_f32 v82, v82, v162
  v_add_f32 v83, v83, v163
  v_add_f32 v84, v84, v164
  v_add_f32 v85, v85, v165
  v_add_f32 v86, v86, v166
  v_add_f32 v87, v87, v167
  v_cvt_pk_bf16_f32 v80, v80, v81
  v_cvt_pk_bf16_f32 v81, v82, v83
  buffer_store_dwordx2 v[80:81], v8, s[8:11], s43 offen offset:0
  v_cvt_pk_bf16_f32 v82, v84, v85
  v_cvt_pk_bf16_f32 v83, v86, v87
  buffer_store_dwordx2 v[82:83], v8, s[8:11], s43 offen offset:32
  v_cvt_pk_bf16_f32 v88, 0, v88
  v_cvt_pk_bf16_f32 v89, 0, v89
  v_cvt_pk_bf16_f32 v90, 0, v90
  v_cvt_pk_bf16_f32 v91, 0, v91
  v_cvt_pk_bf16_f32 v92, 0, v92
  v_cvt_pk_bf16_f32 v93, 0, v93
  v_cvt_pk_bf16_f32 v94, 0, v94
  v_cvt_pk_bf16_f32 v95, 0, v95
  v_add_f32 v88, v88, v184
  v_add_f32 v89, v89, v185
  v_add_f32 v90, v90, v186
  v_add_f32 v91, v91, v187
  v_add_f32 v92, v92, v188
  v_add_f32 v93, v93, v189
  v_add_f32 v94, v94, v190
  v_add_f32 v95, v95, v191
  v_cvt_pk_bf16_f32 v88, 0, v88
  v_cvt_pk_bf16_f32 v89, 0, v89
  v_cvt_pk_bf16_f32 v90, 0, v90
  v_cvt_pk_bf16_f32 v91, 0, v91
  v_cvt_pk_bf16_f32 v92, 0, v92
  v_cvt_pk_bf16_f32 v93, 0, v93
  v_cvt_pk_bf16_f32 v94, 0, v94
  v_cvt_pk_bf16_f32 v95, 0, v95
  v_mul_f32 v184, s76, v88
  v_mul_f32 v185, s76, v89
  v_mul_f32 v186, s76, v90
  v_mul_f32 v187, s76, v91
  v_mul_f32 v188, s76, v92
  v_mul_f32 v189, s76, v93
  v_mul_f32 v190, s76, v94
  v_mul_f32 v191, s76, v95
  v_exp_f32 v184, v184
  v_exp_f32 v185, v185
  v_exp_f32 v186, v186
  v_exp_f32 v187, v187
  v_exp_f32 v188, v188
  v_exp_f32 v189, v189
  v_exp_f32 v190, v190
  v_exp_f32 v191, v191
  v_add_f32 v184, 1.0, v184
  v_add_f32 v185, 1.0, v185
  v_add_f32 v186, 1.0, v186
  v_add_f32 v187, 1.0, v187
  v_add_f32 v188, 1.0, v188
  v_add_f32 v189, 1.0, v189
  v_add_f32 v190, 1.0, v190
  v_add_f32 v191, 1.0, v191
  v_rcp_f32 v184, v184
  v_rcp_f32 v185, v185
  v_rcp_f32 v186, v186
  v_rcp_f32 v187, v187
  v_rcp_f32 v188, v188
  v_rcp_f32 v189, v189
  v_rcp_f32 v190, v190
  v_rcp_f32 v191, v191
  v_mul_f32 v88, v88, v184
  v_mul_f32 v89, v89, v185
  v_mul_f32 v90, v90, v186
  v_mul_f32 v91, v91, v187
  v_mul_f32 v92, v92, v188
  v_mul_f32 v93, v93, v189
  v_mul_f32 v94, v94, v190
  v_mul_f32 v95, v95, v191
  v_cvt_pk_bf16_f32 v88, 0, v88
  v_cvt_pk_bf16_f32 v89, 0, v89
  v_cvt_pk_bf16_f32 v90, 0, v90
  v_cvt_pk_bf16_f32 v91, 0, v91
  v_cvt_pk_bf16_f32 v92, 0, v92
  v_cvt_pk_bf16_f32 v93, 0, v93
  v_cvt_pk_bf16_f32 v94, 0, v94
  v_cvt_pk_bf16_f32 v95, 0, v95
  v_mul_f32 v88, v88, v56
  v_mul_f32 v89, v89, v57
  v_mul_f32 v90, v90, v58
  v_mul_f32 v91, v91, v59
  v_mul_f32 v92, v92, v60
  v_mul_f32 v93, v93, v61
  v_mul_f32 v94, v94, v62
  v_mul_f32 v95, v95, v63
  v_cvt_pk_bf16_f32 v88, 0, v88
  v_cvt_pk_bf16_f32 v89, 0, v89
  v_cvt_pk_bf16_f32 v90, 0, v90
  v_cvt_pk_bf16_f32 v91, 0, v91
  v_cvt_pk_bf16_f32 v92, 0, v92
  v_cvt_pk_bf16_f32 v93, 0, v93
  v_cvt_pk_bf16_f32 v94, 0, v94
  v_cvt_pk_bf16_f32 v95, 0, v95
  v_add_f32 v88, v88, v176
  v_add_f32 v89, v89, v177
  v_add_f32 v90, v90, v178
  v_add_f32 v91, v91, v179
  v_add_f32 v92, v92, v180
  v_add_f32 v93, v93, v181
  v_add_f32 v94, v94, v182
  v_add_f32 v95, v95, v183
  v_cvt_pk_bf16_f32 v88, v88, v89
  v_cvt_pk_bf16_f32 v89, v90, v91
  buffer_store_dwordx2 v[88:89], v8, s[8:11], s43 offen offset:64
  v_cvt_pk_bf16_f32 v90, v92, v93
  v_cvt_pk_bf16_f32 v91, v94, v95
  buffer_store_dwordx2 v[90:91], v8, s[8:11], s43 offen offset:96
L_kf_kernel_fin_100:
L_kf_kernel_end_1:
  s_endpgm
L_kf_kernel_spin_8:
  s_mov_b32 s54, 0x4000
L_kf_kernel_spin2_10:
  s_sub_u32 s54, s54, 1
  s_cbranch_scc1 L_kf_kernel_spinr_9
  buffer_load_dword v12, v13, s[24:27], s17 offen sc1
  s_waitcnt vmcnt(0)
  v_cmp_ne_u32 s[56:57], s51, v12
  v_add_u32 v12, 0xfefefeff, v12
  v_and_b32 v12, 0x80808080, v12
  v_and_b32 v12, s16, v12
  v_cmp_ne_u32 vcc, 0, v12
  s_nop 0
  s_cbranch_vccnz L_kf_kernel_spin2_10
  s_branch L_kf_kernel_spinr_9
L_kf_kernel_spin_15:
  s_mov_b32 s54, 0x4000
L_kf_kernel_spin2_17:
  s_sub_u32 s54, s54, 1
  s_cbranch_scc1 L_kf_kernel_spinr_16
  buffer_load_dword v12, v13, s[24:27], s17 offen sc1
  s_waitcnt vmcnt(0)
  v_cmp_ne_u32 s[56:57], s51, v12
  v_add_u32 v12, 0xfefefeff, v12
  v_and_b32 v12, 0x80808080, v12
  v_and_b32 v12, s16, v12
  v_cmp_ne_u32 vcc, 0, v12
  s_nop 0
  s_cbranch_vccnz L_kf_kernel_spin2_17
  s_branch L_kf_kernel_spinr_16
L_kf_kernel_mask_29:
  v_fma_f32 v48, v112, s52, v48
  v_fma_f32 v49, v113, s52, v49
  v_fma_f32 v50, v114, s52, v50
  v_fma_f32 v51, v115, s52, v51
  v_fma_f32 v56, v112, s53, v56
  v_fma_f32 v57, v113, s53, v57
  v_fma_f32 v58, v114, s53, v58
  v_fma_f32 v59, v115, s53, v59
  s_branch L_kf_kernel_maskr_30
L_kf_kernel_wb_32:
  buffer_wbl2 sc1
  s_waitcnt vmcnt(0)
  s_branch L_kf_kernel_wbr_33
L_kf_kernel_spin_34:
  s_mov_b32 s54, 0x4000
L_kf_kernel_spin2_36:
  s_sub_u32 s54, s54, 1
  s_cbranch_scc1 L_kf_kernel_spinr_35
  buffer_load_dword v12, v14, s[12:15], s61 offen sc1
  s_waitcnt vmcnt(0)
  v_cmp_eq_u32 vcc, 0, v12
  s_nop 0
  s_and_b32 s97, vcc_lo, s96
  s_cbranch_scc1 L_kf_kernel_spin2_36
  s_branch L_kf_kernel_spinr_35
L_kf_kernel_spin_37:
  s_mov_b32 s54, 0x4000
L_kf_kernel_spin2_39:
  s_sub_u32 s54, s54, 1
  s_cbranch_scc1 L_kf_kernel_spinr_38
  buffer_load_dword v12, v14, s[12:15], s61 offen sc1
  s_waitcnt vmcnt(0)
  v_cmp_eq_u32 vcc, 0, v12
  s_nop 0
  s_and_b32 s97, vcc_lo, s17
  s_cbranch_scc1 L_kf_kernel_spin2_39
  s_branch L_kf_kernel_spinr_38
L_kf_kernel_wb_40:
  buffer_wbl2 sc1
  s_waitcnt vmcnt(0)
  s_branch L_kf_kernel_wbr_41
L_kf_kernel_qst_27:
  v_mfma_f32_16x16x32_bf16 v[32:35], a[0:3], a[192:195], v[48:51]
  s_add_u32 s97, s67, s65
  v_exp_f32 v86, v46
  v_mfma_f32_16x16x32_bf16 v[32:35], a[4:7], a[196:199], v[32:35]
  s_add_u32 s67, s67, 0x8000
  ds_read_b128 a[144:147], v5 offset:28672
  v_add_f32 v93, v93, v85
  v_mfma_f32_16x16x32_bf16 v[32:35], a[8:11], a[200:203], v[32:35]
  s_and_b32 s67, s67, 0x1ffff
  buffer_load_dwordx4 v4, s[12:15], s66 offen offset:2048 sc1 lds
  v_mfma_f32_16x16x32_bf16 v[32:35], a[12:15], a[204:207], v[32:35]
  s_waitcnt lgkmcnt(5)
  ds_read_b128 a[148:151], v5 offset:29696
  v_add_f32 v93, v93, v86
  v_mfma_f32_16x16x32_bf16 v[32:35], a[16:19], a[208:211], v[32:35]
  s_add_u32 s98, s66, 0x8000
  ds_read_b128 a[152:155], v5 offset:30720
  v_cvt_pk_bf16_f32 v70, v84, v85
  v_mfma_f32_16x16x32_bf16 v[32:35], a[20:23], a[212:215], v[32:35]
  s_cmp_eq_u32 s71, 3
  v_exp_f32 v87, v47
  v_mfma_f32_16x16x32_bf16 v[32:35], a[24:27], a[216:219], v[32:35]
  s_cselect_b32 s98, s63, s98
  ds_read_b128 a[156:159], v5 offset:31744
  v_add_f32 v93, v93, v87
  v_mfma_f32_16x16x32_bf16 v[32:35], a[28:31], a[220:223], v[32:35]
  s_waitcnt lgkmcnt(4)
  buffer_store_dwordx4 a[192:195], v1, s[12:15], s41 offen offset:0 sc1
  v_cvt_pk_bf16_f32 v71, v86, v87
  v_cmp_lt_f32 vcc, s75, v93
  v_mfma_f32_16x16x32_bf16 v[40:43], a[128:131], a[192:195], v[56:59]
  buffer_load_dwordx4 v4, s[12:15], s66 offen offset:3072 sc1 lds
  v_mfma_f32_16x16x32_bf16 v[40:43], a[132:135], a[196:199], v[40:43]
  s_cbranch_vccnz L_kf_kernel_rare_186
L_kf_kernel_rarer_187:
  v_add_f32 v89, v89, v93
  v_mfma_f32_16x16x32_bf16 v[40:43], a[136:139], a[200:203], v[40:43]
  s_mov_b32 m0, s97
  v_exp_f32 v72, v32
  v_mfma_f32_16x16x32_bf16 v[40:43], a[140:143], a[204:207], v[40:43]
  s_waitcnt lgkmcnt(0)
  v_exp_f32 v73, v33
  v_mfma_f32_16x16x32_bf16 v[40:43], a[144:147], a[208:211], v[40:43]
  v_add_u32 v5, s67, v1
  s_mov_b32 s66, s98
  v_mfma_f32_16x16x32_bf16 v[40:43], a[148:151], a[212:215], v[40:43]
  s_barrier
  buffer_store_dwordx4 a[196:199], v1, s[12:15], s41 offen offset:1024 sc1
  v_mfma_f32_16x16x32_bf16 v[40:43], a[152:155], a[216:219], v[40:43]
  v_exp_f32 v74, v34
  v_mfma_f32_16x16x32_bf16 v[40:43], a[156:159], a[220:223], v[40:43]
  v_exp_f32 v75, v35
  v_mfma_f32_16x16x32_bf16 v[192:195], a[160:163], v[68:71], v[192:195]
  buffer_load_dwordx4 v3, s[12:15], s66 offen offset:0 sc1 lds
  v_mfma_f32_16x16x32_bf16 v[196:199], a[164:167], v[68:71], v[196:199]
  s_sub_u32 s71, s71, 1
  ds_read_b128 a[160:163], v5 offset:0
  v_add_f32 v92, v72, v73
  v_mfma_f32_16x16x32_bf16 v[200:203], a[168:171], v[68:71], v[200:203]
  v_exp_f32 v76, v40
  v_mfma_f32_16x16x32_bf16 v[204:207], a[172:175], v[68:71], v[204:207]
  ds_read_b128 a[164:167], v5 offset:1024
  v_add_f32 v92, v92, v74
  v_mfma_f32_16x16x32_bf16 v[208:211], a[176:179], v[68:71], v[208:211]
  ds_read_b128 a[168:171], v5 offset:2048
  v_add_f32 v92, v92, v75
  v_mfma_f32_16x16x32_bf16 v[212:215], a[180:183], v[68:71], v[212:215]
  buffer_store_dwordx4 a[224:227], v1, s[12:15], s41 offen offset:2048 sc1
  v_exp_f32 v77, v41
  v_mfma_f32_16x16x32_bf16 v[216:219], a[184:187], v[68:71], v[216:219]
  ds_read_b128 a[172:175], v5 offset:3072
  v_cvt_pk_bf16_f32 v64, v72, v73
  v_mfma_f32_16x16x32_bf16 v[220:223], a[188:191], v[68:71], v[220:223]
  v_exp_f32 v78, v42
  v_mfma_f32_16x16x32_bf16 v[224:227], a[32:35], v[68:71], v[224:227]
  ds_read_b128 a[176:179], v5 offset:4096
  v_cvt_pk_bf16_f32 v65, v74, v75
  v_mfma_f32_16x16x32_bf16 v[228:231], a[36:39], v[68:71], v[228:231]
  ds_read_b128 a[180:183], v5 offset:5120
  v_add_f32 v92, v92, v76
  v_mfma_f32_16x16x32_bf16 v[232:235], a[40:43], v[68:71], v[232:235]
  v_exp_f32 v79, v43
  v_mfma_f32_16x16x32_bf16 v[236:239], a[44:47], v[68:71], v[236:239]
  ds_read_b128 a[184:187], v5 offset:6144
  v_add_f32 v92, v92, v77
  v_mfma_f32_16x16x32_bf16 v[240:243], a[112:115], v[68:71], v[240:243]
  buffer_store_dwordx4 a[228:231], v1, s[12:15], s41 offen offset:3072 sc1
  buffer_load_dwordx4 v3, s[12:15], s66 offen offset:1024 sc1 lds
  s_add_u32 s41, s41, 4096
  v_mfma_f32_16x16x32_bf16 v[244:247], a[116:119], v[68:71], v[244:247]
  ds_read_b128 a[188:191], v5 offset:7168
  v_add_f32 v92, v92, v78
  v_mfma_f32_16x16x32_bf16 v[248:251], a[120:123], v[68:71], v[248:251]
  v_add_f32 v92, v92, v79
  v_cvt_pk_bf16_f32 v66, v76, v77
  v_mfma_f32_16x16x32_bf16 v[252:255], a[124:127], v[68:71], v[252:255]
  ds_read_b128 a[32:35], v5 offset:8192
  v_cvt_pk_bf16_f32 v67, v78, v79
  v_mfma_f32_16x16x32_bf16 v[36:39], a[0:3], a[224:227], v[52:55]
  ds_read_b128 a[36:39], v5 offset:9216
  v_cmp_lt_f32 vcc, s75, v92
  v_mfma_f32_16x16x32_bf16 v[36:39], a[4:7], a[228:231], v[36:39]
  s_cbranch_vccnz L_kf_kernel_rare_188
L_kf_kernel_rarer_189:
  v_mfma_f32_16x16x32_bf16 v[36:39], a[8:11], a[232:235], v[36:39]
  ds_read_b128 a[40:43], v5 offset:10240
  v_add_f32 v88, v88, v92
  v_mfma_f32_16x16x32_bf16 v[36:39], a[12:15], a[236:239], v[36:39]
  buffer_load_dwordx4 v3, s[12:15], s66 offen offset:2048 sc1 lds
  buffer_store_dwordx4 a[200:203], v1, s[12:15], s41 offen offset:0 sc1
  v_mfma_f32_16x16x32_bf16 v[36:39], a[16:19], a[240:243], v[36:39]
  ds_read_b128 a[44:47], v5 offset:11264
  v_mfma_f32_16x16x32_bf16 v[36:39], a[20:23], a[244:247], v[36:39]
  ds_read_b128 a[112:115], v5 offset:12288
  v_mfma_f32_16x16x32_bf16 v[36:39], a[24:27], a[248:251], v[36:39]
  v_mfma_f32_16x16x32_bf16 v[36:39], a[28:31], a[252:255], v[36:39]
  ds_read_b128 a[116:119], v5 offset:13312
  v_mfma_f32_16x16x32_bf16 v[44:47], a[128:131], a[224:227], v[60:63]
  buffer_load_dwordx4 v3, s[12:15], s66 offen offset:3072 sc1 lds
  v_mfma_f32_16x16x32_bf16 v[44:47], a[132:135], a[228:231], v[44:47]
  s_add_u32 m0, m0, 0x4000
  ds_read_b128 a[120:123], v5 offset:14336
  v_mfma_f32_16x16x32_bf16 v[44:47], a[136:139], a[232:235], v[44:47]
  buffer_store_dwordx4 a[204:207], v1, s[12:15], s41 offen offset:1024 sc1
  v_exp_f32 v80, v36
  v_mfma_f32_16x16x32_bf16 v[44:47], a[140:143], a[236:239], v[44:47]
  ds_read_b128 a[124:127], v5 offset:15360
  v_mfma_f32_16x16x32_bf16 v[44:47], a[144:147], a[240:243], v[44:47]
  ds_read_b128 a[0:3], v5 offset:16384
  v_mfma_f32_16x16x32_bf16 v[44:47], a[148:151], a[244:247], v[44:47]
  v_exp_f32 v81, v37
  v_mfma_f32_16x16x32_bf16 v[44:47], a[152:155], a[248:251], v[44:47]
  ds_read_b128 a[4:7], v5 offset:17408
  v_add_f32 v93, v80, v81
  v_mfma_f32_16x16x32_bf16 v[44:47], a[156:159], a[252:255], v[44:47]
  s_waitcnt lgkmcnt(14)
  v_exp_f32 v82, v38
  v_mfma_f32_16x16x32_bf16 v[128:131], a[160:163], v[64:67], v[128:131]
  ds_read_b128 a[8:11], v5 offset:18432
  v_add_f32 v93, v93, v82
  v_mfma_f32_16x16x32_bf16 v[132:135], a[164:167], v[64:67], v[132:135]
  ds_read_b128 a[12:15], v5 offset:19456
  buffer_store_dwordx4 a[232:235], v1, s[12:15], s41 offen offset:2048 sc1
  v_mfma_f32_16x16x32_bf16 v[136:139], a[168:171], v[64:67], v[136:139]
  v_exp_f32 v83, v39
  v_mfma_f32_16x16x32_bf16 v[140:143], a[172:175], v[64:67], v[140:143]
  s_waitcnt lgkmcnt(12)
  ds_read_b128 a[16:19], v5 offset:20480
  v_add_f32 v93, v93, v83
  v_mfma_f32_16x16x32_bf16 v[144:147], a[176:179], v[64:67], v[144:147]
  buffer_load_dwordx4 v4, s[12:15], s66 offen offset:0 sc1 lds
  v_mfma_f32_16x16x32_bf16 v[148:151], a[180:183], v[64:67], v[148:151]
  ds_read_b128 a[20:23], v5 offset:21504
  v_cvt_pk_bf16_f32 v68, v80, v81
  v_mfma_f32_16x16x32_bf16 v[152:155], a[184:187], v[64:67], v[152:155]
  v_exp_f32 v84, v44
  v_mfma_f32_16x16x32_bf16 v[156:159], a[188:191], v[64:67], v[156:159]
  s_waitcnt lgkmcnt(10)
  ds_read_b128 a[24:27], v5 offset:22528
  v_cvt_pk_bf16_f32 v69, v82, v83
  v_mfma_f32_16x16x32_bf16 v[160:163], a[32:35], v[64:67], v[160:163]
  buffer_store_dwordx4 a[236:239], v1, s[12:15], s41 offen offset:3072 sc1
  ds_read_b128 a[28:31], v5 offset:23552
  v_add_f32 v93, v93, v84
  s_add_u32 s41, s41, 4096
  v_mfma_f32_16x16x32_bf16 v[164:167], a[36:39], v[64:67], v[164:167]
  buffer_load_dwordx4 v4, s[12:15], s66 offen offset:1024 sc1 lds
  v_mfma_f32_16x16x32_bf16 v[168:171], a[40:43], v[64:67], v[168:171]
  ds_read_b128 a[128:131], v5 offset:24576
  v_mfma_f32_16x16x32_bf16 v[172:175], a[44:47], v[64:67], v[172:175]
  s_waitcnt lgkmcnt(9)
  v_exp_f32 v85, v45
  v_mfma_f32_16x16x32_bf16 v[176:179], a[112:115], v[64:67], v[176:179]
  ds_read_b128 a[132:135], v5 offset:25600
  v_mfma_f32_16x16x32_bf16 v[180:183], a[116:119], v[64:67], v[180:183]
  s_waitcnt lgkmcnt(6)
  ds_read_b128 a[136:139], v5 offset:26624
  v_mfma_f32_16x16x32_bf16 v[184:187], a[120:123], v[64:67], v[184:187]
  ds_read_b128 a[140:143], v5 offset:27648
  v_mfma_f32_16x16x32_bf16 v[188:191], a[124:127], v[64:67], v[188:191]
  v_mfma_f32_16x16x32_bf16 v[32:35], a[0:3], a[192:195], v[48:51]
  s_add_u32 s97, s67, s65
  v_exp_f32 v86, v46
  v_mfma_f32_16x16x32_bf16 v[32:35], a[4:7], a[196:199], v[32:35]
  s_add_u32 s67, s67, 0x8000
  ds_read_b128 a[144:147], v5 offset:28672
  v_add_f32 v93, v93, v85
  v_mfma_f32_16x16x32_bf16 v[32:35], a[8:11], a[200:203], v[32:35]
  s_and_b32 s67, s67, 0x1ffff
  buffer_load_dwordx4 v4, s[12:15], s66 offen offset:2048 sc1 lds
  v_mfma_f32_16x16x32_bf16 v[32:35], a[12:15], a[204:207], v[32:35]
  s_waitcnt lgkmcnt(5)
  ds_read_b128 a[148:151], v5 offset:29696
  v_add_f32 v93, v93, v86
  v_mfma_f32_16x16x32_bf16 v[32:35], a[16:19], a[208:211], v[32:35]
  s_add_u32 s98, s66, 0x8000
  ds_read_b128 a[152:155], v5 offset:30720
  v_cvt_pk_bf16_f32 v70, v84, v85
  v_mfma_f32_16x16x32_bf16 v[32:35], a[20:23], a[212:215], v[32:35]
  s_cmp_eq_u32 s71, 3
  v_exp_f32 v87, v47
  v_mfma_f32_16x16x32_bf16 v[32:35], a[24:27], a[216:219], v[32:35]
  s_cselect_b32 s98, s63, s98
  ds_read_b128 a[156:159], v5 offset:31744
  v_add_f32 v93, v93, v87
  v_mfma_f32_16x16x32_bf16 v[32:35], a[28:31], a[220:223], v[32:35]
  s_waitcnt lgkmcnt(4)
  buffer_store_dwordx4 a[208:211], v1, s[12:15], s41 offen offset:0 sc1
  v_cvt_pk_bf16_f32 v71, v86, v87
  v_cmp_lt_f32 vcc, s75, v93
  v_mfma_f32_16x16x32_bf16 v[40:43], a[128:131], a[192:195], v[56:59]
  buffer_load_dwordx4 v4, s[12:15], s66 offen offset:3072 sc1 lds
  v_mfma_f32_16x16x32_bf16 v[40:43], a[132:135], a[196:199], v[40:43]
  s_cbranch_vccnz L_kf_kernel_rare_190
L_kf_kernel_rarer_191:
  v_add_f32 v89, v89, v93
  v_mfma_f32_16x16x32_bf16 v[40:43], a[136:139], a[200:203], v[40:43]
  s_mov_b32 m0, s97
  v_exp_f32 v72, v32
  v_mfma_f32_16x16x32_bf16 v[40:43], a[140:143], a[204:207], v[40:43]
  s_waitcnt lgkmcnt(0)
  v_exp_f32 v73, v33
  v_mfma_f32_16x16x32_bf16 v[40:43], a[144:147], a[208:211], v[40:43]
  v_add_u32 v5, s67, v1
  s_mov_b32 s66, s98
  v_mfma_f32_16x16x32_bf16 v[40:43], a[148:151], a[212:215], v[40:43]
  s_barrier
  buffer_store_dwordx4 a[212:215], v1, s[12:15], s41 offen offset:1024 sc1
  v_mfma_f32_16x16x32_bf16 v[40:43], a[152:155], a[216:219], v[40:43]
  v_exp_f32 v74, v34
  v_mfma_f32_16x16x32_bf16 v[40:43], a[156:159], a[220:223], v[40:43]
  v_exp_f32 v75, v35
  v_mfma_f32_16x16x32_bf16 v[192:195], a[160:163], v[68:71], v[192:195]
  buffer_load_dwordx4 v3, s[12:15], s66 offen offset:0 sc1 lds
  v_mfma_f32_16x16x32_bf16 v[196:199], a[164:167], v[68:71], v[196:199]
  s_sub_u32 s71, s71, 1
  ds_read_b128 a[160:163], v5 offset:0
  v_add_f32 v92, v72, v73
  v_mfma_f32_16x16x32_bf16 v[200:203], a[168:171], v[68:71], v[200:203]
  v_exp_f32 v76, v40
  v_mfma_f32_16x16x32_bf16 v[204:207], a[172:175], v[68:71], v[204:207]
  ds_read_b128 a[164:167], v5 offset:1024
  v_add_f32 v92, v92, v74
  v_mfma_f32_16x16x32_bf16 v[208:211], a[176:179], v[68:71], v[208:211]
  ds_read_b128 a[168:171], v5 offset:2048
  v_add_f32 v92, v92, v75
  v_mfma_f32_16x16x32_bf16 v[212:215], a[180:183], v[68:71], v[212:215]
  buffer_store_dwordx4 a[240:243], v1, s[12:15], s41 offen offset:2048 sc1
  v_exp_f32 v77, v41
  v_mfma_f32_16x16x32_bf16 v[216:219], a[184:187], v[68:71], v[216:219]
  ds_read_b128 a[172:175], v5 offset:3072
  v_cvt_pk_bf16_f32 v64, v72, v73
  v_mfma_f32_16x16x32_bf16 v[220:223], a[188:191], v[68:71], v[220:223]
  v_exp_f32 v78, v42
  v_mfma_f32_16x16x32_bf16 v[224:227], a[32:35], v[68:71], v[224:227]
  ds_read_b128 a[176:179], v5 offset:4096
  v_cvt_pk_bf16_f32 v65, v74, v75
  v_mfma_f32_16x16x32_bf16 v[228:231], a[36:39], v[68:71], v[228:231]
  ds_read_b128 a[180:183], v5 offset:5120
  v_add_f32 v92, v92, v76
  v_mfma_f32_16x16x32_bf16 v[232:235], a[40:43], v[68:71], v[232:235]
  v_exp_f32 v79, v43
  v_mfma_f32_16x16x32_bf16 v[236:239], a[44:47], v[68:71], v[236:239]
  ds_read_b128 a[184:187], v5 offset:6144
  v_add_f32 v92, v92, v77
  v_mfma_f32_16x16x32_bf16 v[240:243], a[112:115], v[68:71], v[240:243]
  buffer_store_dwordx4 a[244:247], v1, s[12:15], s41 offen offset:3072 sc1
  buffer_load_dwordx4 v3, s[12:15], s66 offen offset:1024 sc1 lds
  s_add_u32 s41, s41, 4096
  v_mfma_f32_16x16x32_bf16 v[244:247], a[116:119], v[68:71], v[244:247]
  ds_read_b128 a[188:191], v5 offset:7168
  v_add_f32 v92, v92, v78
  v_mfma_f32_16x16x32_bf16 v[248:251], a[120:123], v[68:71], v[248:251]
  v_add_f32 v92, v92, v79
  v_cvt_pk_bf16_f32 v66, v76, v77
  v_mfma_f32_16x16x32_bf16 v[252:255], a[124:127], v[68:71], v[252:255]
  ds_read_b128 a[32:35], v5 offset:8192
  v_cvt_pk_bf16_f32 v67, v78, v79
  v_mfma_f32_16x16x32_bf16 v[36:39], a[0:3], a[224:227], v[52:55]
  ds_read_b128 a[36:39], v5 offset:9216
  v_cmp_lt_f32 vcc, s75, v92
  v_mfma_f32_16x16x32_bf16 v[36:39], a[4:7], a[228:231], v[36:39]
  s_cbranch_vccnz L_kf_kernel_rare_192
L_kf_kernel_rarer_193:
  v_mfma_f32_16x16x32_bf16 v[36:39], a[8:11], a[232:235], v[36:39]
  ds_read_b128 a[40:43], v5 offset:10240
  v_add_f32 v88, v88, v92
  v_mfma_f32_16x16x32_bf16 v[36:39], a[12:15], a[236:239], v[36:39]
  buffer_load_dwordx4 v3, s[12:15], s66 offen offset:2048 sc1 lds
  buffer_store_dwordx4 a[216:219], v1, s[12:15], s41 offen offset:0 sc1
  v_mfma_f32_16x16x32_bf16 v[36:39], a[16:19], a[240:243], v[36:39]
  ds_read_b128 a[44:47], v5 offset:11264
  v_mfma_f32_16x16x32_bf16 v[36:39], a[20:23], a[244:247], v[36:39]
  ds_read_b128 a[112:115], v5 offset:12288
  v_mfma_f32_16x16x32_bf16 v[36:39], a[24:27], a[248:251], v[36:39]
  v_mfma_f32_16x16x32_bf16 v[36:39], a[28:31], a[252:255], v[36:39]
  ds_read_b128 a[116:119], v5 offset:13312
  v_mfma_f32_16x16x32_bf16 v[44:47], a[128:131], a[224:227], v[60:63]
  buffer_load_dwordx4 v3, s[12:15], s66 offen offset:3072 sc1 lds
  v_mfma_f32_16x16x32_bf16 v[44:47], a[132:135], a[228:231], v[44:47]
  s_add_u32 m0, m0, 0x4000
  ds_read_b128 a[120:123], v5 offset:14336
  v_mfma_f32_16x16x32_bf16 v[44:47], a[136:139], a[232:235], v[44:47]
  buffer_store_dwordx4 a[220:223], v1, s[12:15], s41 offen offset:1024 sc1
  v_exp_f32 v80, v36
  v_mfma_f32_16x16x32_bf16 v[44:47], a[140:143], a[236:239], v[44:47]
  ds_read_b128 a[124:127], v5 offset:15360
  v_mfma_f32_16x16x32_bf16 v[44:47], a[144:147], a[240:243], v[44:47]
  ds_read_b128 a[0:3], v5 offset:16384
  v_mfma_f32_16x16x32_bf16 v[44:47], a[148:151], a[244:247], v[44:47]
  v_exp_f32 v81, v37
  v_mfma_f32_16x16x32_bf16 v[44:47], a[152:155], a[248:251], v[44:47]
  ds_read_b128 a[4:7], v5 offset:17408
  v_add_f32 v93, v80, v81
  v_mfma_f32_16x16x32_bf16 v[44:47], a[156:159], a[252:255], v[44:47]
  s_waitcnt lgkmcnt(14)
  v_exp_f32 v82, v38
  v_mfma_f32_16x16x32_bf16 v[128:131], a[160:163], v[64:67], v[128:131]
  ds_read_b128 a[8:11], v5 offset:18432
  v_add_f32 v93, v93, v82
  v_mfma_f32_16x16x32_bf16 v[132:135], a[164:167], v[64:67], v[132:135]
  ds_read_b128 a[12:15], v5 offset:19456
  buffer_store_dwordx4 a[248:251], v1, s[12:15], s41 offen offset:2048 sc1
  v_mfma_f32_16x16x32_bf16 v[136:139], a[168:171], v[64:67], v[136:139]
  v_exp_f32 v83, v39
  v_mfma_f32_16x16x32_bf16 v[140:143], a[172:175], v[64:67], v[140:143]
  s_waitcnt lgkmcnt(12)
  ds_read_b128 a[16:19], v5 offset:20480
  v_add_f32 v93, v93, v83
  v_mfma_f32_16x16x32_bf16 v[144:147], a[176:179], v[64:67], v[144:147]
  buffer_load_dwordx4 v4, s[12:15], s66 offen offset:0 sc1 lds
  v_mfma_f32_16x16x32_bf16 v[148:151], a[180:183], v[64:67], v[148:151]
  ds_read_b128 a[20:23], v5 offset:21504
  v_cvt_pk_bf16_f32 v68, v80, v81
  v_mfma_f32_16x16x32_bf16 v[152:155], a[184:187], v[64:67], v[152:155]
  v_exp_f32 v84, v44
  v_mfma_f32_16x16x32_bf16 v[156:159], a[188:191], v[64:67], v[156:159]
  s_waitcnt lgkmcnt(10)
  ds_read_b128 a[24:27], v5 offset:22528
  v_cvt_pk_bf16_f32 v69, v82, v83
  v_mfma_f32_16x16x32_bf16 v[160:163], a[32:35], v[64:67], v[160:163]
  buffer_store_dwordx4 a[252:255], v1, s[12:15], s41 offen offset:3072 sc1
  ds_read_b128 a[28:31], v5 offset:23552
  v_add_f32 v93, v93, v84
  s_add_u32 s41, s41, 4096
  v_mfma_f32_16x16x32_bf16 v[164:167], a[36:39], v[64:67], v[164:167]
  buffer_load_dwordx4 v4, s[12:15], s66 offen offset:1024 sc1 lds
  v_mfma_f32_16x16x32_bf16 v[168:171], a[40:43], v[64:67], v[168:171]
  ds_read_b128 a[128:131], v5 offset:24576
  v_mfma_f32_16x16x32_bf16 v[172:175], a[44:47], v[64:67], v[172:175]
  s_waitcnt lgkmcnt(9)
  v_exp_f32 v85, v45
  v_mfma_f32_16x16x32_bf16 v[176:179], a[112:115], v[64:67], v[176:179]
  ds_read_b128 a[132:135], v5 offset:25600
  v_mfma_f32_16x16x32_bf16 v[180:183], a[116:119], v[64:67], v[180:183]
  s_waitcnt lgkmcnt(6)
  ds_read_b128 a[136:139], v5 offset:26624
  v_mfma_f32_16x16x32_bf16 v[184:187], a[120:123], v[64:67], v[184:187]
  ds_read_b128 a[140:143], v5 offset:27648
  v_mfma_f32_16x16x32_bf16 v[188:191], a[124:127], v[64:67], v[188:191]
  s_branch L_kf_kernel_aloop_18
L_kf_kernel_e1_28:
  s_cmp_lt_u32 s36, s1
  s_cbranch_scc1 L_kf_kernel_e3_194
  s_waitcnt vmcnt(16)
  buffer_store_dword v11, v0, s[12:15], s0 offen offset:128 sc1
  buffer_load_dwordx4 v[96:99], v14, s[12:15], s61 offen offset:16 sc1
  s_sub_u32 s36, s36, 1
  s_branch L_kf_kernel_aloop_18
L_kf_kernel_e3_194:
  s_cmp_eq_u32 s36, 1
  s_cbranch_scc1 L_kf_kernel_alast_21
  s_cmp_lg_u32 s1, 255
  s_cbranch_scc1 L_kf_kernel_e4_195
  s_waitcnt vmcnt(12)
  buffer_store_dword v11, v14, s[12:15], s74 offen sc1
  s_mov_b32 s36, 1
  s_branch L_kf_kernel_aloop_18
L_kf_kernel_e4_195:
  s_waitcnt vmcnt(8)
  v_and_b32 v96, v96, v97
  v_and_b32 v98, v98, v99
  v_and_b32 v96, v96, v98
  v_cmp_eq_u32 vcc, 0, v96
  s_nop 0
  s_and_b32 s97, vcc_lo, s17
  s_cbranch_scc1 L_kf_kernel_spin_196
L_kf_kernel_spinr_197:
  s_mov_b32 s36, 4
  s_branch L_kf_kernel_aloop_18
L_kf_kernel_at0_19:
  s_add_u32 s60, s79, 0
  buffer_load_dwordx4 a[48:51], v1, s[12:15], s60 offen offset:0 sc1
  buffer_load_dwordx4 a[52:55], v1, s[12:15], s60 offen offset:1024 sc1
  buffer_load_dwordx2 v[96:97], v9, s[28:31], s3 offen offset:0
  buffer_load_dwordx4 a[56:59], v1, s[12:15], s60 offen offset:2048 sc1
  buffer_load_dwordx4 a[60:63], v1, s[12:15], s60 offen offset:3072 sc1
  buffer_load_dwordx2 v[98:99], v9, s[28:31], s3 offen offset:32
  s_add_u32 s60, s79, 4096
  buffer_load_dwordx4 a[64:67], v1, s[12:15], s60 offen offset:0 sc1
  buffer_load_dwordx4 a[68:71], v1, s[12:15], s60 offen offset:1024 sc1
  buffer_load_dwordx2 v[100:101], v9, s[28:31], s3 offen offset:64
  buffer_load_dwordx4 a[72:75], v1, s[12:15], s60 offen offset:2048 sc1
  buffer_load_dwordx4 a[76:79], v1, s[12:15], s60 offen offset:3072 sc1
  buffer_load_dwordx2 v[102:103], v9, s[28:31], s3 offen offset:96
  v_fma_f32 v48, v112, s58, v48
  v_fma_f32 v49, v113, s58, v49
  v_fma_f32 v50, v114, s58, v50
  v_fma_f32 v51, v115, s58, v51
  v_fma_f32 v56, v112, s59, v56
  v_fma_f32 v57, v113, s59, v57
  v_fma_f32 v58, v114, s59, v58
  v_fma_f32 v59, v115, s59, v59
  s_branch L_kf_kernel_at2_20
L_kf_kernel_spin_42:
  s_mov_b32 s54, 0x4000
L_kf_kernel_spin2_44:
  s_sub_u32 s54, s54, 1
  s_cbranch_scc1 L_kf_kernel_spinr_43
  buffer_load_dword v12, v0, s[12:15], s40 offen offset:256 sc1
  s_waitcnt vmcnt(0)
  v_readfirstlane_b32 s97, v12
  s_nop 0
  s_or_b32 s97, s97, 0
  s_cbranch_scc0 L_kf_kernel_spin2_44
  s_branch L_kf_kernel_spinr_43
L_kf_kernel_rare_46:
  s_mov_b32 s54, 0
  s_branch L_kf_kernel_rareb_45
L_kf_kernel_rare_49:
  s_mov_b32 s54, 0
  s_branch L_kf_kernel_rareb_48
L_kf_kernel_rare_53:
  s_mov_b32 s54, 1
  s_branch L_kf_kernel_rareb_45
L_kf_kernel_rare_55:
  s_mov_b32 s54, 1
  s_branch L_kf_kernel_rareb_48
L_kf_kernel_rare_57:
  s_mov_b32 s54, 2
  s_branch L_kf_kernel_rareb_45
L_kf_kernel_rare_59:
  s_mov_b32 s54, 2
  s_branch L_kf_kernel_rareb_48
L_kf_kernel_mid_52:
  v_mfma_f32_16x16x32_bf16 v[32:35], a[0:3], a[192:195], v[48:51]
  s_add_u32 s97, s67, s65
  v_exp_f32 v86, v46
  v_mfma_f32_16x16x32_bf16 v[32:35], a[4:7], a[196:199], v[32:35]
  s_add_u32 s67, s67, 0x8000
  ds_read_b128 a[144:147], v5 offset:28672
  v_add_f32 v93, v93, v85
  v_mfma_f32_16x16x32_bf16 v[32:35], a[8:11], a[200:203], v[32:35]
  s_and_b32 s67, s67, 0x1ffff
  v_mfma_f32_16x16x32_bf16 v[32:35], a[12:15], a[204:207], v[32:35]
  s_waitcnt lgkmcnt(5)
  ds_read_b128 a[148:151], v5 offset:29696
  v_add_f32 v93, v93, v86
  v_mfma_f32_16x16x32_bf16 v[32:35], a[16:19], a[208:211], v[32:35]
  s_add_u32 s98, s66, 0x8000
  ds_read_b128 a[152:155], v5 offset:30720
  v_cvt_pk_bf16_f32 v70, v84, v85
  v_mfma_f32_16x16x32_bf16 v[32:35], a[20:23], a[212:215], v[32:35]
  s_cmp_eq_u32 s71, 3
  v_exp_f32 v87, v47
  v_mfma_f32_16x16x32_bf16 v[32:35], a[24:27], a[216:219], v[32:35]
  s_cselect_b32 s98, s63, s98
  ds_read_b128 a[156:159], v5 offset:31744
  v_add_f32 v93, v93, v87
  v_mfma_f32_16x16x32_bf16 v[32:35], a[28:31], a[220:223], v[32:35]
  s_waitcnt lgkmcnt(4)
  v_cvt_pk_bf16_f32 v71, v86, v87
  v_cmp_lt_f32 vcc, s75, v93
  v_mfma_f32_16x16x32_bf16 v[40:43], a[128:131], a[192:195], v[56:59]
  v_mfma_f32_16x16x32_bf16 v[40:43], a[132:135], a[196:199], v[40:43]
  s_cbranch_vccnz L_kf_kernel_rare_199
L_kf_kernel_rarer_200:
  v_add_f32 v89, v89, v93
  v_mfma_f32_16x16x32_bf16 v[40:43], a[136:139], a[200:203], v[40:43]
  s_mov_b32 m0, s97
  v_exp_f32 v72, v32
  v_mfma_f32_16x16x32_bf16 v[40:43], a[140:143], a[204:207], v[40:43]
  s_waitcnt lgkmcnt(0)
  v_exp_f32 v73, v33
  v_mfma_f32_16x16x32_bf16 v[40:43], a[144:147], a[208:211], v[40:43]
  s_waitcnt vmcnt(13)
  v_add_u32 v5, s67, v1
  s_mov_b32 s66, s98
  v_mfma_f32_16x16x32_bf16 v[40:43], a[148:151], a[212:215], v[40:43]
  s_barrier
  v_mfma_f32_16x16x32_bf16 v[40:43], a[152:155], a[216:219], v[40:43]
  v_exp_f32 v74, v34
  v_mfma_f32_16x16x32_bf16 v[40:43], a[156:159], a[220:223], v[40:43]
  v_exp_f32 v75, v35
  v_mfma_f32_16x16x32_bf16 v[192:195], a[160:163], v[68:71], v[192:195]
  buffer_load_dwordx4 v3, s[12:15], s66 offen offset:0 sc1 lds
  v_mfma_f32_16x16x32_bf16 v[196:199], a[164:167], v[68:71], v[196:199]
  s_sub_u32 s71, s71, 1
  ds_read_b128 a[160:163], v5 offset:0
  v_add_f32 v92, v72, v73
  v_mfma_f32_16x16x32_bf16 v[200:203], a[168:171], v[68:71], v[200:203]
  v_exp_f32 v76, v40
  v_mfma_f32_16x16x32_bf16 v[204:207], a[172:175], v[68:71], v[204:207]
  ds_read_b128 a[164:167], v5 offset:1024
  v_add_f32 v92, v92, v74
  v_mfma_f32_16x16x32_bf16 v[208:211], a[176:179], v[68:71], v[208:211]
  ds_read_b128 a[168:171], v5 offset:2048
  v_add_f32 v92, v92, v75
  v_mfma_f32_16x16x32_bf16 v[212:215], a[180:183], v[68:71], v[212:215]
  v_exp_f32 v77, v41
  v_mfma_f32_16x16x32_bf16 v[216:219], a[184:187], v[68:71], v[216:219]
  ds_read_b128 a[172:175], v5 offset:3072
  v_cvt_pk_bf16_f32 v64, v72, v73
  v_mfma_f32_16x16x32_bf16 v[220:223], a[188:191], v[68:71], v[220:223]
  v_exp_f32 v78, v42
  v_mfma_f32_16x16x32_bf16 v[224:227], a[32:35], v[68:71], v[224:227]
  ds_read_b128 a[176:179], v5 offset:4096
  v_cvt_pk_bf16_f32 v65, v74, v75
  v_mfma_f32_16x16x32_bf16 v[228:231], a[36:39], v[68:71], v[228:231]
  ds_read_b128 a[180:183], v5 offset:5120
  v_add_f32 v92, v92, v76
  v_mfma_f32_16x16x32_bf16 v[232:235], a[40:43], v[68:71], v[232:235]
  v_exp_f32 v79, v43
  v_mfma_f32_16x16x32_bf16 v[236:239], a[44:47], v[68:71], v[236:239]
  ds_read_b128 a[184:187], v5 offset:6144
  v_add_f32 v92, v92, v77
  v_mfma_f32_16x16x32_bf16 v[240:243], a[112:115], v[68:71], v[240:243]
  buffer_load_dwordx4 v3, s[12:15], s66 offen offset:1024 sc1 lds
  v_mfma_f32_16x16x32_bf16 v[244:247], a[116:119], v[68:71], v[244:247]
  ds_read_b128 a[188:191], v5 offset:7168
  v_add_f32 v92, v92, v78
  v_mfma_f32_16x16x32_bf16 v[248:251], a[120:123], v[68:71], v[248:251]
  v_add_f32 v92, v92, v79
  v_cvt_pk_bf16_f32 v66, v76, v77
  v_mfma_f32_16x16x32_bf16 v[252:255], a[124:127], v[68:71], v[252:255]
  ds_read_b128 a[32:35], v5 offset:8192
  v_cvt_pk_bf16_f32 v67, v78, v79
  v_mfma_f32_16x16x32_bf16 v[36:39], a[0:3], a[224:227], v[52:55]
  ds_read_b128 a[36:39], v5 offset:9216
  v_cmp_lt_f32 vcc, s75, v92
  v_mfma_f32_16x16x32_bf16 v[36:39], a[4:7], a[228:231], v[36:39]
  s_cbranch_vccnz L_kf_kernel_rare_201
L_kf_kernel_rarer_202:
  v_mfma_f32_16x16x32_bf16 v[36:39], a[8:11], a[232:235], v[36:39]
  ds_read_b128 a[40:43], v5 offset:10240
  v_add_f32 v88, v88, v92
  v_mfma_f32_16x16x32_bf16 v[36:39], a[12:15], a[236:239], v[36:39]
  buffer_load_dwordx4 v3, s[12:15], s66 offen offset:2048 sc1 lds
  v_mfma_f32_16x16x32_bf16 v[36:39], a[16:19], a[240:243], v[36:39]
  ds_read_b128 a[44:47], v5 offset:11264
  v_fma_f32 v48, v112, s52, v52
  v_mfma_f32_16x16x32_bf16 v[36:39], a[20:23], a[244:247], v[36:39]
  ds_read_b128 a[112:115], v5 offset:12288
  v_fma_f32 v49, v113, s52, v53
  v_mfma_f32_16x16x32_bf16 v[36:39], a[24:27], a[248:251], v[36:39]
  v_fma_f32 v50, v114, s52, v54
  v_fma_f32 v51, v115, s52, v55
  v_mfma_f32_16x16x32_bf16 v[36:39], a[28:31], a[252:255], v[36:39]
  ds_read_b128 a[116:119], v5 offset:13312
  s_waitcnt vmcnt(7)
  v_mov_b32 v12, 1
  v_mfma_f32_16x16x32_bf16 v[44:47], a[128:131], a[224:227], v[60:63]
  s_lshl_b32 s96, s64, 9
  buffer_load_dwordx4 v3, s[12:15], s66 offen offset:3072 sc1 lds
  v_mfma_f32_16x16x32_bf16 v[44:47], a[132:135], a[228:231], v[44:47]
  s_add_u32 m0, m0, 0x4000
  ds_read_b128 a[120:123], v5 offset:14336
  v_fma_f32 v56, v112, s53, v60
  v_mfma_f32_16x16x32_bf16 v[44:47], a[136:139], a[232:235], v[44:47]
  s_add_u32 s96, s96, 38567936
  v_exp_f32 v80, v36
  v_mfma_f32_16x16x32_bf16 v[44:47], a[140:143], a[236:239], v[44:47]
  ds_read_b128 a[124:127], v5 offset:15360
  v_fma_f32 v57, v113, s53, v61
  v_mfma_f32_16x16x32_bf16 v[44:47], a[144:147], a[240:243], v[44:47]
  ds_read_b128 a[0:3], v5 offset:16384
  v_fma_f32 v58, v114, s53, v62
  v_mfma_f32_16x16x32_bf16 v[44:47], a[148:151], a[244:247], v[44:47]
  v_exp_f32 v81, v37
  v_mfma_f32_16x16x32_bf16 v[44:47], a[152:155], a[248:251], v[44:47]
  ds_read_b128 a[4:7], v5 offset:17408
  v_add_f32 v93, v80, v81
  v_mfma_f32_16x16x32_bf16 v[44:47], a[156:159], a[252:255], v[44:47]
  s_waitcnt lgkmcnt(14)
  v_exp_f32 v82, v38
  v_mfma_f32_16x16x32_bf16 v[128:131], a[160:163], v[64:67], v[128:131]
  ds_read_b128 a[8:11], v5 offset:18432
  v_add_f32 v93, v93, v82
  v_mfma_f32_16x16x32_bf16 v[132:135], a[164:167], v[64:67], v[132:135]
  ds_read_b128 a[12:15], v5 offset:19456
  v_fma_f32 v59, v115, s53, v63
  v_mfma_f32_16x16x32_bf16 v[136:139], a[168:171], v[64:67], v[136:139]
  v_exp_f32 v83, v39
  v_mfma_f32_16x16x32_bf16 v[140:143], a[172:175], v[64:67], v[140:143]
  s_waitcnt lgkmcnt(12)
  ds_read_b128 a[16:19], v5 offset:20480
  v_add_f32 v93, v93, v83
  v_mfma_f32_16x16x32_bf16 v[144:147], a[176:179], v[64:67], v[144:147]
  buffer_load_dwordx4 v4, s[12:15], s66 offen offset:0 sc1 lds
  v_mfma_f32_16x16x32_bf16 v[148:151], a[180:183], v[64:67], v[148:151]
  ds_read_b128 a[20:23], v5 offset:21504
  v_cvt_pk_bf16_f32 v68, v80, v81
  v_mfma_f32_16x16x32_bf16 v[152:155], a[184:187], v[64:67], v[152:155]
  v_exp_f32 v84, v44
  v_mfma_f32_16x16x32_bf16 v[156:159], a[188:191], v[64:67], v[156:159]
  s_waitcnt lgkmcnt(10)
  ds_read_b128 a[24:27], v5 offset:22528
  v_cvt_pk_bf16_f32 v69, v82, v83
  v_mfma_f32_16x16x32_bf16 v[160:163], a[32:35], v[64:67], v[160:163]
  ds_read_b128 a[28:31], v5 offset:23552
  v_add_f32 v93, v93, v84
  v_mfma_f32_16x16x32_bf16 v[164:167], a[36:39], v[64:67], v[164:167]
  buffer_load_dwordx4 v4, s[12:15], s66 offen offset:1024 sc1 lds
  v_mfma_f32_16x16x32_bf16 v[168:171], a[40:43], v[64:67], v[168:171]
  ds_read_b128 a[128:131], v5 offset:24576
  v_mfma_f32_16x16x32_bf16 v[172:175], a[44:47], v[64:67], v[172:175]
  s_waitcnt lgkmcnt(9)
  v_exp_f32 v85, v45
  v_mfma_f32_16x16x32_bf16 v[176:179], a[112:115], v[64:67], v[176:179]
  ds_read_b128 a[132:135], v5 offset:25600
  v_mfma_f32_16x16x32_bf16 v[180:183], a[116:119], v[64:67], v[180:183]
  s_waitcnt lgkmcnt(6)
  ds_read_b128 a[136:139], v5 offset:26624
  buffer_atomic_add v12, v0, s[12:15], s96 offen offset:384 sc0 sc1
  v_mfma_f32_16x16x32_bf16 v[184:187], a[120:123], v[64:67], v[184:187]
  ds_read_b128 a[140:143], v5 offset:27648
  v_mfma_f32_16x16x32_bf16 v[188:191], a[124:127], v[64:67], v[188:191]
  v_mfma_f32_16x16x32_bf16 v[32:35], a[0:3], a[224:227], v[48:51]
  s_add_u32 s97, s67, s65
  v_exp_f32 v86, v46
  v_mfma_f32_16x16x32_bf16 v[32:35], a[4:7], a[228:231], v[32:35]
  s_add_u32 s67, s67, 0x8000
  ds_read_b128 a[144:147], v5 offset:28672
  v_add_f32 v93, v93, v85
  v_mfma_f32_16x16x32_bf16 v[32:35], a[8:11], a[232:235], v[32:35]
  s_and_b32 s67, s67, 0x1ffff
  buffer_load_dwordx4 v4, s[12:15], s66 offen offset:2048 sc1 lds
  v_mfma_f32_16x16x32_bf16 v[32:35], a[12:15], a[236:239], v[32:35]
  s_waitcnt lgkmcnt(5)
  ds_read_b128 a[148:151], v5 offset:29696
  v_add_f32 v93, v93, v86
  v_mfma_f32_16x16x32_bf16 v[32:35], a[16:19], a[240:243], v[32:35]
  s_add_u32 s98, s66, 0x8000
  ds_read_b128 a[152:155], v5 offset:30720
  v_cvt_pk_bf16_f32 v70, v84, v85
  v_mfma_f32_16x16x32_bf16 v[32:35], a[20:23], a[244:247], v[32:35]
  s_cmp_eq_u32 s71, 3
  v_exp_f32 v87, v47
  v_mfma_f32_16x16x32_bf16 v[32:35], a[24:27], a[248:251], v[32:35]
  s_cselect_b32 s98, s63, s98
  ds_read_b128 a[156:159], v5 offset:31744
  v_add_f32 v93, v93, v87
  v_mfma_f32_16x16x32_bf16 v[32:35], a[28:31], a[252:255], v[32:35]
  s_waitcnt lgkmcnt(4)
  v_cvt_pk_bf16_f32 v71, v86, v87
  v_cmp_lt_f32 vcc, s75, v93
  v_mfma_f32_16x16x32_bf16 v[40:43], a[128:131], a[224:227], v[56:59]
  buffer_load_dwordx4 v4, s[12:15], s66 offen offset:3072 sc1 lds
  v_mfma_f32_16x16x32_bf16 v[40:43], a[132:135], a[228:231], v[40:43]
  s_cbranch_vccnz L_kf_kernel_rare_203
L_kf_kernel_rarer_204:
  v_add_f32 v89, v89, v93
  v_mfma_f32_16x16x32_bf16 v[40:43], a[136:139], a[232:235], v[40:43]
  s_mov_b32 m0, s97
  v_fma_f32 v52, v112, s58, v52
  v_fma_f32 v53, v113, s58, v53
  v_mfma_f32_16x16x32_bf16 v[40:43], a[140:143], a[236:239], v[40:43]
  s_waitcnt lgkmcnt(0)
  v_fma_f32 v54, v114, s58, v54
  v_fma_f32 v55, v115, s58, v55
  v_mfma_f32_16x16x32_bf16 v[40:43], a[144:147], a[240:243], v[40:43]
  v_add_u32 v5, s67, v1
  s_mov_b32 s66, s98
  v_mfma_f32_16x16x32_bf16 v[40:43], a[148:151], a[244:247], v[40:43]
  s_barrier
  v_exp_f32 v72, v32
  v_mfma_f32_16x16x32_bf16 v[40:43], a[152:155], a[248:251], v[40:43]
  ds_read_b128 a[0:3], v5 offset:16384
  ds_read_b128 a[4:7], v5 offset:17408
  v_mfma_f32_16x16x32_bf16 v[40:43], a[156:159], a[252:255], v[40:43]
  buffer_load_dwordx4 v3, s[12:15], s66 offen offset:0 sc1 lds
  v_mfma_f32_16x16x32_bf16 v[192:195], a[160:163], v[68:71], v[192:195]
  ds_read_b128 a[8:11], v5 offset:18432
  ds_read_b128 a[12:15], v5 offset:19456
  v_mfma_f32_16x16x32_bf16 v[196:199], a[164:167], v[68:71], v[196:199]
  ds_read_b128 a[16:19], v5 offset:20480
  ds_read_b128 a[20:23], v5 offset:21504
  v_mfma_f32_16x16x32_bf16 v[200:203], a[168:171], v[68:71], v[200:203]
  buffer_load_dwordx4 v3, s[12:15], s66 offen offset:1024 sc1 lds
  v_mfma_f32_16x16x32_bf16 v[204:207], a[172:175], v[68:71], v[204:207]
  ds_read_b128 a[24:27], v5 offset:22528
  ds_read_b128 a[28:31], v5 offset:23552
  v_mfma_f32_16x16x32_bf16 v[208:211], a[176:179], v[68:71], v[208:211]
  v_exp_f32 v73, v33
  v_mfma_f32_16x16x32_bf16 v[212:215], a[180:183], v[68:71], v[212:215]
  ds_read_b128 a[128:131], v5 offset:24576
  ds_read_b128 a[132:135], v5 offset:25600
  v_mfma_f32_16x16x32_bf16 v[216:219], a[184:187], v[68:71], v[216:219]
  buffer_load_dwordx4 v3, s[12:15], s66 offen offset:2048 sc1 lds
  v_mfma_f32_16x16x32_bf16 v[220:223], a[188:191], v[68:71], v[220:223]
  v_exp_f32 v74, v34
  v_mfma_f32_16x16x32_bf16 v[224:227], a[32:35], v[68:71], v[224:227]
  v_exp_f32 v75, v35
  v_mfma_f32_16x16x32_bf16 v[228:231], a[36:39], v[68:71], v[228:231]
  ds_read_b128 a[136:139], v5 offset:26624
  ds_read_b128 a[160:163], v5 offset:0
  v_mfma_f32_16x16x32_bf16 v[232:235], a[40:43], v[68:71], v[232:235]
  buffer_load_dwordx4 v3, s[12:15], s66 offen offset:3072 sc1 lds
  v_mfma_f32_16x16x32_bf16 v[236:239], a[44:47], v[68:71], v[236:239]
  s_add_u32 m0, m0, 0x4000
  ds_read_b128 a[140:143], v5 offset:27648
  v_mfma_f32_16x16x32_bf16 v[240:243], a[112:115], v[68:71], v[240:243]
  v_exp_f32 v76, v40
  v_mfma_f32_16x16x32_bf16 v[244:247], a[116:119], v[68:71], v[244:247]
  buffer_load_dwordx4 v4, s[12:15], s66 offen offset:0 sc1 lds
  v_mfma_f32_16x16x32_bf16 v[248:251], a[120:123], v[68:71], v[248:251]
  ds_read_b128 a[164:167], v5 offset:1024
  v_fma_f32 v60, v112, s59, v60
  v_mfma_f32_16x16x32_bf16 v[252:255], a[124:127], v[68:71], v[252:255]
  s_waitcnt lgkmcnt(10)
  v_exp_f32 v77, v41
  v_mfma_f32_16x16x32_bf16 v[36:39], a[0:3], a[224:227], v[52:55]
  ds_read_b128 a[168:171], v5 offset:2048
  v_fma_f32 v61, v113, s59, v61
  v_mfma_f32_16x16x32_bf16 v[36:39], a[4:7], a[228:231], v[36:39]
  buffer_load_dwordx4 v4, s[12:15], s66 offen offset:1024 sc1 lds
  v_mfma_f32_16x16x32_bf16 v[36:39], a[8:11], a[232:235], v[36:39]
  ds_read_b128 a[144:147], v5 offset:28672
  ds_read_b128 a[172:175], v5 offset:3072
  v_mfma_f32_16x16x32_bf16 v[36:39], a[12:15], a[236:239], v[36:39]
  s_waitcnt lgkmcnt(9)
  v_exp_f32 v78, v42
  v_mfma_f32_16x16x32_bf16 v[36:39], a[16:19], a[240:243], v[36:39]
  ds_read_b128 a[148:151], v5 offset:29696
  v_fma_f32 v62, v114, s59, v62
  v_fma_f32 v63, v115, s59, v63
  v_mfma_f32_16x16x32_bf16 v[36:39], a[20:23], a[244:247], v[36:39]
  ds_read_b128 a[152:155], v5 offset:30720
  buffer_load_dwordx4 v4, s[12:15], s66 offen offset:2048 sc1 lds
  v_mfma_f32_16x16x32_bf16 v[36:39], a[24:27], a[248:251], v[36:39]
  ds_read_b128 a[156:159], v5 offset:31744
  ds_read_b128 a[176:179], v5 offset:4096
  v_mfma_f32_16x16x32_bf16 v[36:39], a[28:31], a[252:255], v[36:39]
  s_waitcnt lgkmcnt(8)
  ds_read_b128 a[180:183], v5 offset:5120
  ds_read_b128 a[184:187], v5 offset:6144
  v_mfma_f32_16x16x32_bf16 v[44:47], a[128:131], a[224:227], v[60:63]
  v_exp_f32 v79, v43
  v_mfma_f32_16x16x32_bf16 v[44:47], a[132:135], a[228:231], v[44:47]
  ds_read_b128 a[188:191], v5 offset:7168
  ds_read_b128 a[32:35], v5 offset:8192
  ds_read_b128 a[36:39], v5 offset:9216
  ds_read_b128 a[40:43], v5 offset:10240
  ds_read_b128 a[44:47], v5 offset:11264
  ds_read_b128 a[112:115], v5 offset:12288
  ds_read_b128 a[116:119], v5 offset:13312
  ds_read_b128 a[120:123], v5 offset:14336
  ds_read_b128 a[124:127], v5 offset:15360
  buffer_load_dwordx4 v4, s[12:15], s66 offen offset:3072 sc1 lds
  v_mfma_f32_16x16x32_bf16 v[44:47], a[136:139], a[232:235], v[44:47]
  s_add_u32 s66, s66, 0x8000
  v_add_f32 v92, v72, v73
  v_add_f32 v92, v92, v74
  v_mfma_f32_16x16x32_bf16 v[44:47], a[140:143], a[236:239], v[44:47]
  s_waitcnt lgkmcnt(12)
  v_add_f32 v92, v92, v75
  v_add_f32 v92, v92, v76
  v_add_f32 v92, v92, v77
  v_add_f32 v92, v92, v78
  v_add_f32 v92, v92, v79
  v_cmp_lt_f32 vcc, s75, v92
  v_cvt_pk_bf16_f32 v64, v72, v73
  v_cvt_pk_bf16_f32 v65, v74, v75
  v_cvt_pk_bf16_f32 v66, v76, v77
  v_cvt_pk_bf16_f32 v67, v78, v79
  s_cbranch_vccnz L_kf_kernel_rare_205
L_kf_kernel_rarer_206:
  v_add_f32 v89, v89, v92
  v_mfma_f32_16x16x32_bf16 v[44:47], a[144:147], a[240:243], v[44:47]
  s_waitcnt vmcnt(17) lgkmcnt(0)
  s_add_u32 m0, s67, s65
  s_add_u32 s67, s67, 0x8000
  v_mfma_f32_16x16x32_bf16 v[44:47], a[148:151], a[244:247], v[44:47]
  s_barrier
  s_and_b32 s67, s67, 0x1ffff
  v_add_u32 v5, s67, v1
  v_mfma_f32_16x16x32_bf16 v[44:47], a[152:155], a[248:251], v[44:47]
  buffer_load_dwordx4 v3, s[12:15], s66 offen offset:0 sc1 lds
  v_mfma_f32_16x16x32_bf16 v[44:47], a[156:159], a[252:255], v[44:47]
  v_exp_f32 v80, v36
  v_mfma_f32_16x16x32_bf16 v[192:195], a[160:163], v[64:67], v[192:195]
  buffer_load_dwordx4 v3, s[12:15], s66 offen offset:1024 sc1 lds
  v_mfma_f32_16x16x32_bf16 v[196:199], a[164:167], v[64:67], v[196:199]
  v_exp_f32 v81, v37
  v_mfma_f32_16x16x32_bf16 v[200:203], a[168:171], v[64:67], v[200:203]
  ds_read_b128 a[160:163], v5 offset:0
  ds_read_b128 a[164:167], v5 offset:1024
  v_mfma_f32_16x16x32_bf16 v[204:207], a[172:175], v[64:67], v[204:207]
  buffer_load_dwordx4 v3, s[12:15], s66 offen offset:2048 sc1 lds
  v_mfma_f32_16x16x32_bf16 v[208:211], a[176:179], v[64:67], v[208:211]
  v_exp_f32 v82, v38
  v_mfma_f32_16x16x32_bf16 v[212:215], a[180:183], v[64:67], v[212:215]
  ds_read_b128 a[168:171], v5 offset:2048
  ds_read_b128 a[172:175], v5 offset:3072
  v_mfma_f32_16x16x32_bf16 v[216:219], a[184:187], v[64:67], v[216:219]
  buffer_load_dwordx4 v3, s[12:15], s66 offen offset:3072 sc1 lds
  v_mfma_f32_16x16x32_bf16 v[220:223], a[188:191], v[64:67], v[220:223]
  ds_read_b128 a[176:179], v5 offset:4096
  s_add_u32 m0, m0, 0x4000
  v_mfma_f32_16x16x32_bf16 v[224:227], a[32:35], v[64:67], v[224:227]
  ds_read_b128 a[180:183], v5 offset:5120
  buffer_load_dwordx4 v4, s[12:15], s66 offen offset:0 sc1 lds
  v_mfma_f32_16x16x32_bf16 v[228:231], a[36:39], v[64:67], v[228:231]
  ds_read_b128 a[184:187], v5 offset:6144
  ds_read_b128 a[188:191], v5 offset:7168
  v_mfma_f32_16x16x32_bf16 v[232:235], a[40:43], v[64:67], v[232:235]
  v_exp_f32 v83, v39
  v_mfma_f32_16x16x32_bf16 v[236:239], a[44:47], v[64:67], v[236:239]
  ds_read_b128 a[32:35], v5 offset:8192
  buffer_load_dwordx4 v4, s[12:15], s66 offen offset:1024 sc1 lds
  v_mfma_f32_16x16x32_bf16 v[240:243], a[112:115], v[64:67], v[240:243]
  ds_read_b128 a[36:39], v5 offset:9216
  ds_read_b128 a[40:43], v5 offset:10240
  v_mfma_f32_16x16x32_bf16 v[244:247], a[116:119], v[64:67], v[244:247]
  v_exp_f32 v84, v44
  v_mfma_f32_16x16x32_bf16 v[248:251], a[120:123], v[64:67], v[248:251]
  ds_read_b128 a[44:47], v5 offset:11264
  buffer_load_dwordx4 v4, s[12:15], s66 offen offset:2048 sc1 lds
  v_exp_f32 v85, v45
  v_exp_f32 v86, v46
  v_exp_f32 v87, v47
  v_add_f32 v93, v80, v81
  v_add_f32 v93, v93, v82
  v_add_f32 v93, v93, v83
  v_add_f32 v93, v93, v84
  v_add_f32 v93, v93, v85
  v_add_f32 v93, v93, v86
  v_add_f32 v93, v93, v87
  v_cmp_lt_f32 vcc, s75, v93
  v_cvt_pk_bf16_f32 v68, v80, v81
  v_cvt_pk_bf16_f32 v69, v82, v83
  v_cvt_pk_bf16_f32 v70, v84, v85
  v_cvt_pk_bf16_f32 v71, v86, v87
  v_mfma_f32_16x16x32_bf16 v[252:255], a[124:127], v[64:67], v[252:255]
  s_cbranch_vccnz L_kf_kernel_rare_207
L_kf_kernel_rarer_208:
  ds_read_b128 a[112:115], v5 offset:12288
  s_waitcnt lgkmcnt(12)
  v_mfma_f32_16x16x32_bf16 v[192:195], a[160:163], v[68:71], v[192:195]
  ds_read_b128 a[116:119], v5 offset:13312
  ds_read_b128 a[120:123], v5 offset:14336
  s_waitcnt lgkmcnt(13)
  v_mfma_f32_16x16x32_bf16 v[196:199], a[164:167], v[68:71], v[196:199]
  buffer_load_dwordx4 v4, s[12:15], s66 offen offset:3072 sc1 lds
  s_waitcnt lgkmcnt(12)
  v_mfma_f32_16x16x32_bf16 v[200:203], a[168:171], v[68:71], v[200:203]
  s_add_u32 s66, s66, 0x8000
  ds_read_b128 a[124:127], v5 offset:15360
  v_cvt_pk_bf16_f32 v128, v128, v129
  s_waitcnt lgkmcnt(12)
  v_mfma_f32_16x16x32_bf16 v[204:207], a[172:175], v[68:71], v[204:207]
  s_waitcnt lgkmcnt(8)
  v_cvt_pk_bf16_f32 v129, v130, v131
  v_cvt_pk_bf16_f32 v130, v132, v133
  v_mfma_f32_16x16x32_bf16 v[208:211], a[176:179], v[68:71], v[208:211]
  s_waitcnt vmcnt(16) lgkmcnt(0)
  s_add_u32 m0, s67, s65
  v_cvt_pk_bf16_f32 v131, v134, v135
  v_mfma_f32_16x16x32_bf16 v[212:215], a[180:183], v[68:71], v[212:215]
  s_barrier
  s_add_u32 s67, s67, 0x8000
  s_and_b32 s67, s67, 0x1ffff
  v_add_u32 v5, s67, v1
  v_add_f32 v89, v89, v93
  v_mfma_f32_16x16x32_bf16 v[216:219], a[184:187], v[68:71], v[216:219]
  ds_read_b128 a[128:131], v5 offset:0
  ds_read_b128 a[132:135], v5 offset:1024
  v_mfma_f32_16x16x32_bf16 v[220:223], a[188:191], v[68:71], v[220:223]
  ds_read_b128 a[136:139], v5 offset:2048
  v_cvt_pk_bf16_f32 v132, v136, v137
  v_mfma_f32_16x16x32_bf16 v[224:227], a[32:35], v[68:71], v[224:227]
  buffer_load_dwordx4 v3, s[12:15], s66 offen offset:0 sc1 lds
  ds_read_b128 a[140:143], v5 offset:3072
  v_mfma_f32_16x16x32_bf16 v[228:231], a[36:39], v[68:71], v[228:231]
  ds_read_b128 a[144:147], v5 offset:4096
  v_cvt_pk_bf16_f32 v133, v138, v139
  v_mfma_f32_16x16x32_bf16 v[232:235], a[40:43], v[68:71], v[232:235]
  ds_read_b128 a[148:151], v5 offset:5120
  v_cvt_pk_bf16_f32 v134, v140, v141
  v_mfma_f32_16x16x32_bf16 v[236:239], a[44:47], v[68:71], v[236:239]
  ds_read_b128 a[152:155], v5 offset:6144
  v_cvt_pk_bf16_f32 v135, v142, v143
  v_mfma_f32_16x16x32_bf16 v[240:243], a[112:115], v[68:71], v[240:243]
  ds_read_b128 a[156:159], v5 offset:7168
  v_cvt_pk_bf16_f32 v136, v144, v145
  v_mfma_f32_16x16x32_bf16 v[244:247], a[116:119], v[68:71], v[244:247]
  ds_read_b128 a[160:163], v5 offset:8192
  v_cvt_pk_bf16_f32 v137, v146, v147
  v_cvt_pk_bf16_f32 v138, v148, v149
  v_cvt_pk_bf16_f32 v139, v150, v151
  v_mfma_f32_16x16x32_bf16 v[248:251], a[120:123], v[68:71], v[248:251]
  ds_read_b128 a[164:167], v5 offset:9216
  v_cvt_pk_bf16_f32 v140, v152, v153
  v_cvt_pk_bf16_f32 v141, v154, v155
  v_cvt_pk_bf16_f32 v142, v156, v157
  v_cvt_pk_bf16_f32 v143, v158, v159
  v_mfma_f32_16x16x32_bf16 v[252:255], a[124:127], v[68:71], v[252:255]
  s_waitcnt lgkmcnt(6)
  ds_read_b128 a[168:171], v5 offset:10240
  v_cvt_pk_bf16_f32 v160, v160, v161
  v_cvt_pk_bf16_f32 v161, v162, v163
  v_cvt_pk_bf16_f32 v162, v164, v165
  v_cvt_pk_bf16_f32 v163, v166, v167
  v_mfma_f32_16x16x32_bf16 v[144:147], a[128:131], v[128:131], 0
  ds_read_b128 a[172:175], v5 offset:11264
  v_cvt_pk_bf16_f32 v164, v168, v169
  v_cvt_pk_bf16_f32 v165, v170, v171
  v_cvt_pk_bf16_f32 v166, v172, v173
  v_cvt_pk_bf16_f32 v167, v174, v175
  v_mfma_f32_16x16x32_bf16 v[144:147], a[132:135], v[132:135], v[144:147]
  ds_read_b128 a[176:179], v5 offset:12288
  v_cvt_pk_bf16_f32 v168, v176, v177
  v_cvt_pk_bf16_f32 v169, v178, v179
  v_cvt_pk_bf16_f32 v170, v180, v181
  v_cvt_pk_bf16_f32 v171, v182, v183
  v_mfma_f32_16x16x32_bf16 v[144:147], a[136:139], v[136:139], v[144:147]
  buffer_load_dwordx4 v3, s[12:15], s66 offen offset:1024 sc1 lds
  ds_read_b128 a[180:183], v5 offset:13312
  v_cvt_pk_bf16_f32 v172, v184, v185
  v_cvt_pk_bf16_f32 v173, v186, v187
  v_cvt_pk_bf16_f32 v174, v188, v189
  v_cvt_pk_bf16_f32 v175, v190, v191
  v_mfma_f32_16x16x32_bf16 v[144:147], a[140:143], v[140:143], v[144:147]
  s_waitcnt lgkmcnt(6)
  ds_read_b128 a[184:187], v5 offset:14336
  ds_read_b128 a[188:191], v5 offset:15360
  v_mfma_f32_16x16x32_bf16 v[144:147], a[144:147], v[160:163], v[144:147]
  v_cvt_pk_bf16_f32 v192, v192, v193
  v_cvt_pk_bf16_f32 v193, v194, v195
  v_mfma_f32_16x16x32_bf16 v[144:147], a[148:151], v[164:167], v[144:147]
  v_cvt_pk_bf16_f32 v194, v196, v197
  v_cvt_pk_bf16_f32 v195, v198, v199
  v_mfma_f32_16x16x32_bf16 v[144:147], a[152:155], v[168:171], v[144:147]
  v_cvt_pk_bf16_f32 v196, v200, v201
  v_cvt_pk_bf16_f32 v197, v202, v203
  v_mfma_f32_16x16x32_bf16 v[144:147], a[156:159], v[172:175], v[144:147]
  s_waitcnt lgkmcnt(4)
  v_cvt_pk_bf16_f32 v198, v204, v205
  v_cvt_pk_bf16_f32 v199, v206, v207
  v_mfma_f32_16x16x32_bf16 v[152:155], a[160:163], v[128:131], 0
  v_cvt_pk_bf16_f32 v200, v208, v209
  v_cvt_pk_bf16_f32 v201, v210, v211
  v_mfma_f32_16x16x32_bf16 v[152:155], a[164:167], v[132:135], v[152:155]
  v_cvt_pk_bf16_f32 v202, v212, v213
  v_cvt_pk_bf16_f32 v203, v214, v215
  v_mfma_f32_16x16x32_bf16 v[152:155], a[168:171], v[136:139], v[152:155]
  v_cvt_pk_bf16_f32 v204, v216, v217
  v_cvt_pk_bf16_f32 v205, v218, v219
  v_mfma_f32_16x16x32_bf16 v[152:155], a[172:175], v[140:143], v[152:155]
  s_waitcnt lgkmcnt(0)
  v_cvt_pk_bf16_f32 v206, v220, v221
  v_cvt_pk_bf16_f32 v207, v222, v223
  v_mfma_f32_16x16x32_bf16 v[152:155], a[176:179], v[160:163], v[152:155]
  v_cvt_pk_bf16_f32 v224, v224, v225
  v_cvt_pk_bf16_f32 v225, v226, v227
  v_mfma_f32_16x16x32_bf16 v[152:155], a[180:183], v[164:167], v[152:155]
  v_cvt_pk_bf16_f32 v226, v228, v229
  v_cvt_pk_bf16_f32 v227, v230, v231
  v_mfma_f32_16x16x32_bf16 v[152:155], a[184:187], v[168:171], v[152:155]
  v_cvt_pk_bf16_f32 v228, v232, v233
  v_cvt_pk_bf16_f32 v229, v234, v235
  v_mfma_f32_16x16x32_bf16 v[152:155], a[188:191], v[172:175], v[152:155]
  v_cvt_pk_bf16_f32 v230, v236, v237
  v_cvt_pk_bf16_f32 v231, v238, v239
  v_cvt_pk_bf16_f32 v232, v240, v241
  v_cvt_pk_bf16_f32 v233, v242, v243
  v_cvt_pk_bf16_f32 v234, v244, v245
  v_cvt_pk_bf16_f32 v235, v246, v247
  v_cvt_pk_bf16_f32 v236, v248, v249
  v_cvt_pk_bf16_f32 v237, v250, v251
  v_cvt_pk_bf16_f32 v238, v252, v253
  v_cvt_pk_bf16_f32 v239, v254, v255
  s_branch L_kf_kernel_opl_24
L_kf_kernel_rare_62:
  s_mov_b32 s54, 0
  s_branch L_kf_kernel_rareb_61
L_kf_kernel_rare_65:
  s_mov_b32 s54, 0
  s_branch L_kf_kernel_rareb_64
L_kf_kernel_rare_67:
  s_mov_b32 s54, 3
  s_branch L_kf_kernel_rareb_45
L_kf_kernel_spin_70:
  s_mov_b32 s54, 0x4000
L_kf_kernel_spin2_72:
  s_sub_u32 s54, s54, 1
  s_cbranch_scc1 L_kf_kernel_spinr_71
  buffer_load_dword v12, v0, s[12:15], s40 offen offset:128 sc1
  s_waitcnt vmcnt(0)
  v_readfirstlane_b32 s97, v12
  s_nop 0
  s_or_b32 s97, s97, s45
  s_cbranch_scc0 L_kf_kernel_spin2_72
  s_branch L_kf_kernel_spinr_71
L_kf_kernel_rare_73:
  s_mov_b32 s54, 4
  s_branch L_kf_kernel_rareb_45
L_kf_kernel_rare_75:
  s_mov_b32 s54, 3
  s_branch L_kf_kernel_rareb_48
L_kf_kernel_rare_77:
  s_mov_b32 s54, 5
  s_branch L_kf_kernel_rareb_45
L_kf_kernel_rare_79:
  s_mov_b32 s54, 4
  s_branch L_kf_kernel_rareb_48
L_kf_kernel_rare_81:
  s_mov_b32 s54, 1
  s_branch L_kf_kernel_rareb_61
L_kf_kernel_rare_83:
  s_mov_b32 s54, 1
  s_branch L_kf_kernel_rareb_64
L_kf_kernel_rare_85:
  s_mov_b32 s54, 6
  s_branch L_kf_kernel_rareb_45
L_kf_kernel_mrare_87:
  s_nop 7
  s_nop 3
  v_max_f32 v20, 0, v18
  v_sub_f32 v18, v18, v20
  v_sub_f32 v20, 0, v20
  v_exp_f32 v20, v20
  s_nop 0
  v_mul_f32 v88, v88, v20
  v_mul_f32 v128, v128, v20
  v_mul_f32 v129, v129, v20
  v_mul_f32 v130, v130, v20
  v_mul_f32 v131, v131, v20
  v_mul_f32 v132, v132, v20
  v_mul_f32 v133, v133, v20
  v_mul_f32 v134, v134, v20
  v_mul_f32 v135, v135, v20
  v_mul_f32 v136, v136, v20
  v_mul_f32 v137, v137, v20
  v_mul_f32 v138, v138, v20
  v_mul_f32 v139, v139, v20
  v_mul_f32 v140, v140, v20
  v_mul_f32 v141, v141, v20
  v_mul_f32 v142, v142, v20
  v_mul_f32 v143, v143, v20
  v_mul_f32 v144, v144, v20
  v_mul_f32 v145, v145, v20
  v_mul_f32 v146, v146, v20
  v_mul_f32 v147, v147, v20
  v_mul_f32 v148, v148, v20
  v_mul_f32 v149, v149, v20
  v_mul_f32 v150, v150, v20
  v_mul_f32 v151, v151, v20
  v_mul_f32 v152, v152, v20
  v_mul_f32 v153, v153, v20
  v_mul_f32 v154, v154, v20
  v_mul_f32 v155, v155, v20
  v_mul_f32 v156, v156, v20
  v_mul_f32 v157, v157, v20
  v_mul_f32 v158, v158, v20
  v_mul_f32 v159, v159, v20
  v_mul_f32 v160, v160, v20
  v_mul_f32 v161, v161, v20
  v_mul_f32 v162, v162, v20
  v_mul_f32 v163, v163, v20
  v_mul_f32 v164, v164, v20
  v_mul_f32 v165, v165, v20
  v_mul_f32 v166, v166, v20
  v_mul_f32 v167, v167, v20
  v_mul_f32 v168, v168, v20
  v_mul_f32 v169, v169, v20
  v_mul_f32 v170, v170, v20
  v_mul_f32 v171, v171, v20
  v_mul_f32 v172, v172, v20
  v_mul_f32 v173, v173, v20
  v_mul_f32 v174, v174, v20
  v_mul_f32 v175, v175, v20
  v_mul_f32 v176, v176, v20
  v_mul_f32 v177, v177, v20
  v_mul_f32 v178, v178, v20
  v_mul_f32 v179, v179, v20
  v_mul_f32 v180, v180, v20
  v_mul_f32 v181, v181, v20
  v_mul_f32 v182, v182, v20
  v_mul_f32 v183, v183, v20
  v_mul_f32 v184, v184, v20
  v_mul_f32 v185, v185, v20
  v_mul_f32 v186, v186, v20
  v_mul_f32 v187, v187, v20
  v_mul_f32 v188, v188, v20
  v_mul_f32 v189, v189, v20
  v_mul_f32 v190, v190, v20
  v_mul_f32 v191, v191, v20
  v_exp_f32 v19, v18
  s_nop 0
  v_cvt_pk_bf16_f32 v20, v19, v19
  v_and_b32 v22, v20, v30
  v_and_b32 v23, v20, v31
  v_and_b32 v28, v20, v30
  v_and_b32 v29, v20, v31
  s_nop 1
  s_branch L_kf_kernel_mrarer_88
L_kf_kernel_mrare_89:
  s_nop 7
  s_nop 3
  v_max_f32 v20, 0, v18
  v_sub_f32 v18, v18, v20
  v_sub_f32 v20, 0, v20
  v_exp_f32 v20, v20
  s_nop 0
  v_mul_f32 v89, v89, v20
  v_mul_f32 v192, v192, v20
  v_mul_f32 v193, v193, v20
  v_mul_f32 v194, v194, v20
  v_mul_f32 v195, v195, v20
  v_mul_f32 v196, v196, v20
  v_mul_f32 v197, v197, v20
  v_mul_f32 v198, v198, v20
  v_mul_f32 v199, v199, v20
  v_mul_f32 v200, v200, v20
  v_mul_f32 v201, v201, v20
  v_mul_f32 v202, v202, v20
  v_mul_f32 v203, v203, v20
  v_mul_f32 v204, v204, v20
  v_mul_f32 v205, v205, v20
  v_mul_f32 v206, v206, v20
  v_mul_f32 v207, v207, v20
  v_mul_f32 v208, v208, v20
  v_mul_f32 v209, v209, v20
  v_mul_f32 v210, v210, v20
  v_mul_f32 v211, v211, v20
  v_mul_f32 v212, v212, v20
  v_mul_f32 v213, v213, v20
  v_mul_f32 v214, v214, v20
  v_mul_f32 v215, v215, v20
  v_mul_f32 v216, v216, v20
  v_mul_f32 v217, v217, v20
  v_mul_f32 v218, v218, v20
  v_mul_f32 v219, v219, v20
  v_mul_f32 v220, v220, v20
  v_mul_f32 v221, v221, v20
  v_mul_f32 v222, v222, v20
  v_mul_f32 v223, v223, v20
  v_mul_f32 v224, v224, v20
  v_mul_f32 v225, v225, v20
  v_mul_f32 v226, v226, v20
  v_mul_f32 v227, v227, v20
  v_mul_f32 v228, v228, v20
  v_mul_f32 v229, v229, v20
  v_mul_f32 v230, v230, v20
  v_mul_f32 v231, v231, v20
  v_mul_f32 v232, v232, v20
  v_mul_f32 v233, v233, v20
  v_mul_f32 v234, v234, v20
  v_mul_f32 v235, v235, v20
  v_mul_f32 v236, v236, v20
  v_mul_f32 v237, v237, v20
  v_mul_f32 v238, v238, v20
  v_mul_f32 v239, v239, v20
  v_mul_f32 v240, v240, v20
  v_mul_f32 v241, v241, v20
  v_mul_f32 v242, v242, v20
  v_mul_f32 v243, v243, v20
  v_mul_f32 v244, v244, v20
  v_mul_f32 v245, v245, v20
  v_mul_f32 v246, v246, v20
  v_mul_f32 v247, v247, v20
  v_mul_f32 v248, v248, v20
  v_mul_f32 v249, v249, v20
  v_mul_f32 v250, v250, v20
  v_mul_f32 v251, v251, v20
  v_mul_f32 v252, v252, v20
  v_mul_f32 v253, v253, v20
  v_mul_f32 v254, v254, v20
  v_mul_f32 v255, v255, v20
  v_exp_f32 v19, v18
  s_nop 0
  v_cvt_pk_bf16_f32 v20, v19, v19
  v_and_b32 v22, v20, v30
  v_and_b32 v23, v20, v31
  v_and_b32 v28, v20, v30
  v_and_b32 v29, v20, v31
  s_nop 1
  s_branch L_kf_kernel_mrarer_90
L_kf_kernel_rare_91:
  s_mov_b32 s54, 7
  s_branch L_kf_kernel_rareb_45
L_kf_kernel_rare_93:
  s_mov_b32 s54, 5
  s_branch L_kf_kernel_rareb_48
L_kf_kernel_rare_95:
  s_mov_b32 s54, 8
  s_branch L_kf_kernel_rareb_45
L_kf_kernel_opb_99:
  v_mfma_f32_16x16x32_bf16 v[184:187], a[164:167], v[132:135], v[184:187]
  ds_read_b128 a[136:139], v5 offset:2048
  ds_read_b128 a[140:143], v5 offset:3072
  v_mfma_f32_16x16x32_bf16 v[184:187], a[168:171], v[136:139], v[184:187]
  ds_read_b128 a[144:147], v5 offset:4096
  v_mul_f32 v180, v89, v180
  v_mfma_f32_16x16x32_bf16 v[184:187], a[172:175], v[140:143], v[184:187]
  buffer_load_dwordx2 v[116:117], v9, s[20:23], s44 offen offset:64
  v_mfma_f32_16x16x32_bf16 v[184:187], a[176:179], v[160:163], v[184:187]
  ds_read_b128 a[148:151], v5 offset:5120
  v_mul_f32 v181, v89, v181
  v_mfma_f32_16x16x32_bf16 v[184:187], a[180:183], v[164:167], v[184:187]
  v_cvt_pk_bf16_f32 v84, v180, v181
  v_mul_f32 v182, v89, v182
  v_mfma_f32_16x16x32_bf16 v[184:187], a[184:187], v[168:171], v[184:187]
  ds_read_b128 a[152:155], v5 offset:6144
  v_mul_f32 v183, v89, v183
  v_mfma_f32_16x16x32_bf16 v[184:187], a[188:191], v[172:175], v[184:187]
  buffer_load_dwordx2 v[118:119], v9, s[20:23], s44 offen offset:96
  v_mfma_f32_16x16x32_bf16 v[188:191], a[160:163], v[192:195], 0
  ds_read_b128 a[156:159], v5 offset:7168
  v_cvt_pk_bf16_f32 v85, v182, v183
  v_mfma_f32_16x16x32_bf16 v[188:191], a[164:167], v[196:199], v[188:191]
  v_mfma_f32_16x16x32_bf16 v[188:191], a[168:171], v[200:203], v[188:191]
  s_nop 0
  ds_read_b128 a[160:163], v5 offset:8192
  v_mul_f32 v184, v88, v184
  v_mfma_f32_16x16x32_bf16 v[188:191], a[172:175], v[204:207], v[188:191]
  buffer_store_dword v11, v0, s[12:15], s74 offen offset:0 sc1
  v_mfma_f32_16x16x32_bf16 v[188:191], a[176:179], v[224:227], v[188:191]
  s_or_b32 s37, s37, 0xffff
  ds_read_b128 a[164:167], v5 offset:9216
  v_mul_f32 v185, v88, v185
  v_mfma_f32_16x16x32_bf16 v[188:191], a[180:183], v[228:231], v[188:191]
  s_mov_b32 s45, 0xffff
  buffer_load_dwordx2 v[112:113], v9, s[20:23], s44 offen offset:0
  v_mfma_f32_16x16x32_bf16 v[188:191], a[184:187], v[232:235], v[188:191]
  buffer_load_dwordx2 v[100:101], v8, s[4:7], s42 offen offset:64
  v_mfma_f32_16x16x32_bf16 v[188:191], a[188:191], v[236:239], v[188:191]
  s_waitcnt lgkmcnt(6)
  ds_read_b128 a[168:171], v5 offset:10240
  v_cvt_pk_bf16_f32 v82, v184, v185
  v_mfma_f32_16x16x32_bf16 v[144:147], a[128:131], v[128:131], 0
  ds_read_b128 a[172:175], v5 offset:11264
  v_mul_f32 v186, v88, v186
  v_mfma_f32_16x16x32_bf16 v[144:147], a[132:135], v[132:135], v[144:147]
  buffer_load_dwordx2 v[102:103], v8, s[4:7], s42 offen offset:96
  v_mfma_f32_16x16x32_bf16 v[144:147], a[136:139], v[136:139], v[144:147]
  ds_read_b128 a[176:179], v5 offset:12288
  v_mul_f32 v187, v88, v187
  v_mfma_f32_16x16x32_bf16 v[144:147], a[140:143], v[140:143], v[144:147]
  s_waitcnt lgkmcnt(5)
  v_cvt_pk_bf16_f32 v83, v186, v187
  v_mul_f32 v188, v89, v188
  v_mfma_f32_16x16x32_bf16 v[144:147], a[144:147], v[160:163], v[144:147]
  s_add_u32 s18, s73, 283648
  ds_read_b128 a[180:183], v5 offset:13312
  v_mul_f32 v189, v89, v189
  v_mfma_f32_16x16x32_bf16 v[144:147], a[148:151], v[164:167], v[144:147]
  buffer_load_dwordx2 v[114:115], v9, s[20:23], s44 offen offset:32
  v_mfma_f32_16x16x32_bf16 v[144:147], a[152:155], v[168:171], v[144:147]
  ds_read_b128 a[184:187], v5 offset:14336
  v_cvt_pk_bf16_f32 v86, v188, v189
  v_mfma_f32_16x16x32_bf16 v[144:147], a[156:159], v[172:175], v[144:147]
  s_add_u32 s98, s36, 0
  v_mul_f32 v190, v89, v190
  v_mfma_f32_16x16x32_bf16 v[148:151], a[128:131], v[192:195], 0
  ds_read_b128 a[188:191], v5 offset:15360
  v_mul_f32 v191, v89, v191
  v_mfma_f32_16x16x32_bf16 v[148:151], a[132:135], v[196:199], v[148:151]
  buffer_load_dwordx4 a[0:3], v1, s[12:15], s98 offen offset:0 sc1
  v_mfma_f32_16x16x32_bf16 v[148:151], a[136:139], v[200:203], v[148:151]
  buffer_store_dwordx4 v[80:83], v1, s[12:15], s18 offen sc1
  v_mfma_f32_16x16x32_bf16 v[148:151], a[140:143], v[204:207], v[148:151]
  ds_read_b128 a[128:131], v5 offset:16384
  v_cvt_pk_bf16_f32 v87, v190, v191
  v_mfma_f32_16x16x32_bf16 v[148:151], a[144:147], v[224:227], v[148:151]
  s_add_u32 s19, s73, 285696
  ds_read_b128 a[132:135], v5 offset:17408
  v_mul_f32 v144, v88, v144
  v_mfma_f32_16x16x32_bf16 v[148:151], a[148:151], v[228:231], v[148:151]
  buffer_load_dwordx4 a[192:195], v1, s[12:15], s98 offen offset:1024 sc1
  v_mfma_f32_16x16x32_bf16 v[148:151], a[152:155], v[232:235], v[148:151]
  ds_read_b128 a[136:139], v5 offset:18432
  v_mul_f32 v145, v88, v145
  v_mfma_f32_16x16x32_bf16 v[148:151], a[156:159], v[236:239], v[148:151]
  s_waitcnt lgkmcnt(7)
  buffer_store_dwordx4 v[84:87], v1, s[12:15], s19 offen sc1
  v_mfma_f32_16x16x32_bf16 v[152:155], a[160:163], v[128:131], 0
  ds_read_b128 a[140:143], v5 offset:19456
  v_cvt_pk_bf16_f32 v72, v144, v145
  v_mfma_f32_16x16x32_bf16 v[152:155], a[164:167], v[132:135], v[152:155]
  s_add_u32 s98, s36, 4096
  buffer_load_dwordx4 a[4:7], v1, s[12:15], s98 offen offset:0 sc1
  v_mfma_f32_16x16x32_bf16 v[152:155], a[168:171], v[136:139], v[152:155]
  ds_read_b128 a[144:147], v5 offset:20480
  v_mul_f32 v146, v88, v146
  v_mfma_f32_16x16x32_bf16 v[152:155], a[172:175], v[140:143], v[152:155]
  s_waitcnt lgkmcnt(5)
  buffer_load_dwordx2 v[96:97], v8, s[4:7], s42 offen offset:0
  v_mfma_f32_16x16x32_bf16 v[152:155], a[176:179], v[160:163], v[152:155]
  ds_read_b128 a[148:151], v5 offset:21504
  v_mul_f32 v147, v88, v147
  v_mfma_f32_16x16x32_bf16 v[152:155], a[180:183], v[164:167], v[152:155]
  v_cvt_pk_bf16_f32 v73, v146, v147
  v_mul_f32 v148, v89, v148
  v_mfma_f32_16x16x32_bf16 v[152:155], a[184:187], v[168:171], v[152:155]
  ds_read_b128 a[152:155], v5 offset:22528
  v_mul_f32 v149, v89, v149
  v_mfma_f32_16x16x32_bf16 v[152:155], a[188:191], v[172:175], v[152:155]
  buffer_load_dwordx4 a[196:199], v1, s[12:15], s98 offen offset:1024 sc1
  v_mfma_f32_16x16x32_bf16 v[156:159], a[160:163], v[192:195], 0
  ds_read_b128 a[156:159], v5 offset:23552
  v_cvt_pk_bf16_f32 v76, v148, v149
  v_mfma_f32_16x16x32_bf16 v[156:159], a[164:167], v[196:199], v[156:159]
  v_mul_f32 v150, v89, v150
  v_mul_f32 v151, v89, v151
  v_mfma_f32_16x16x32_bf16 v[156:159], a[168:171], v[200:203], v[156:159]
  ds_read_b128 a[160:163], v5 offset:24576
  v_mul_f32 v152, v88, v152
  v_mfma_f32_16x16x32_bf16 v[156:159], a[172:175], v[204:207], v[156:159]
  buffer_load_dwordx2 v[98:99], v8, s[4:7], s42 offen offset:32
  v_mfma_f32_16x16x32_bf16 v[156:159], a[176:179], v[224:227], v[156:159]
  s_add_u32 s98, s36, 8192
  ds_read_b128 a[164:167], v5 offset:25600
  v_mul_f32 v153, v88, v153
  v_mfma_f32_16x16x32_bf16 v[156:159], a[180:183], v[228:231], v[156:159]
  buffer_load_dwordx4 a[8:11], v1, s[12:15], s98 offen offset:0 sc1
  v_mfma_f32_16x16x32_bf16 v[156:159], a[184:187], v[232:235], v[156:159]
  ds_read_b128 a[168:171], v5 offset:26624
  v_cvt_pk_bf16_f32 v74, v152, v153
  v_mfma_f32_16x16x32_bf16 v[156:159], a[188:191], v[236:239], v[156:159]
  s_waitcnt lgkmcnt(7)
  v_mul_f32 v154, v88, v154
  v_mul_f32 v155, v88, v155
  v_mfma_f32_16x16x32_bf16 v[176:179], a[128:131], v[128:131], 0
  ds_read_b128 a[172:175], v5 offset:27648
  v_cvt_pk_bf16_f32 v75, v154, v155
  v_mfma_f32_16x16x32_bf16 v[176:179], a[132:135], v[132:135], v[176:179]
  s_add_u32 s16, s73, 376832
  buffer_load_dwordx4 a[200:203], v1, s[12:15], s98 offen offset:1024 sc1
  v_mfma_f32_16x16x32_bf16 v[176:179], a[136:139], v[136:139], v[176:179]
  ds_read_b128 a[176:179], v5 offset:28672
  v_cvt_pk_bf16_f32 v77, v150, v151
  v_mfma_f32_16x16x32_bf16 v[176:179], a[140:143], v[140:143], v[176:179]
  s_waitcnt lgkmcnt(5)
  buffer_store_dwordx4 v[72:75], v1, s[12:15], s16 offen sc1
  v_mfma_f32_16x16x32_bf16 v[176:179], a[144:147], v[160:163], v[176:179]
  ds_read_b128 a[180:183], v5 offset:29696
  v_mul_f32 v156, v89, v156
  v_mfma_f32_16x16x32_bf16 v[176:179], a[148:151], v[164:167], v[176:179]
  v_mul_f32 v157, v89, v157
  v_cvt_pk_bf16_f32 v78, v156, v157
  v_mfma_f32_16x16x32_bf16 v[176:179], a[152:155], v[168:171], v[176:179]
  s_add_u32 s98, s36, 12288
  ds_read_b128 a[184:187], v5 offset:30720
  v_mul_f32 v158, v89, v158
  v_mfma_f32_16x16x32_bf16 v[176:179], a[156:159], v[172:175], v[176:179]
  buffer_load_dwordx4 a[12:15], v1, s[12:15], s98 offen offset:0 sc1
  v_mfma_f32_16x16x32_bf16 v[180:183], a[128:131], v[192:195], 0
  ds_read_b128 a[188:191], v5 offset:31744
  v_mul_f32 v159, v89, v159
  v_mfma_f32_16x16x32_bf16 v[180:183], a[132:135], v[196:199], v[180:183]
  s_add_u32 s67, s67, 0x8000
  v_cvt_pk_bf16_f32 v79, v158, v159
  v_mfma_f32_16x16x32_bf16 v[180:183], a[136:139], v[200:203], v[180:183]
  s_and_b32 s67, s67, 0x1ffff
  v_add_u32 v5, s67, v1
  v_mul_f32 v176, v88, v176
  v_mfma_f32_16x16x32_bf16 v[180:183], a[140:143], v[204:207], v[180:183]
  buffer_load_dwordx4 a[204:207], v1, s[12:15], s98 offen offset:1024 sc1
  v_mfma_f32_16x16x32_bf16 v[180:183], a[144:147], v[224:227], v[180:183]
  s_add_u32 s17, s73, 378880
  buffer_store_dwordx4 v[76:79], v1, s[12:15], s17 offen sc1
  v_mfma_f32_16x16x32_bf16 v[180:183], a[148:151], v[228:231], v[180:183]
  v_mul_f32 v177, v88, v177
  v_cvt_pk_bf16_f32 v80, v176, v177
  v_mfma_f32_16x16x32_bf16 v[180:183], a[152:155], v[232:235], v[180:183]
  s_waitcnt vmcnt(34) lgkmcnt(0)
  v_mul_f32 v178, v88, v178
  v_mul_f32 v179, v88, v179
  v_mfma_f32_16x16x32_bf16 v[180:183], a[156:159], v[236:239], v[180:183]
  s_barrier
  v_cvt_pk_bf16_f32 v81, v178, v179
  v_mfma_f32_16x16x32_bf16 v[184:187], a[160:163], v[128:131], 0
  ds_read_b128 a[128:131], v5 offset:0
  ds_read_b128 a[132:135], v5 offset:1024
  v_mfma_f32_16x16x32_bf16 v[184:187], a[164:167], v[132:135], v[184:187]
  s_add_u32 s98, s36, 16384
  ds_read_b128 a[136:139], v5 offset:2048
  ds_read_b128 a[140:143], v5 offset:3072
  v_mfma_f32_16x16x32_bf16 v[184:187], a[168:171], v[136:139], v[184:187]
  ds_read_b128 a[144:147], v5 offset:4096
  v_mul_f32 v180, v89, v180
  v_mfma_f32_16x16x32_bf16 v[184:187], a[172:175], v[140:143], v[184:187]
  buffer_load_dwordx4 a[16:19], v1, s[12:15], s98 offen offset:0 sc1
  v_mfma_f32_16x16x32_bf16 v[184:187], a[176:179], v[160:163], v[184:187]
  ds_read_b128 a[148:151], v5 offset:5120
  v_mul_f32 v181, v89, v181
  v_mfma_f32_16x16x32_bf16 v[184:187], a[180:183], v[164:167], v[184:187]
  v_cvt_pk_bf16_f32 v84, v180, v181
  v_mul_f32 v182, v89, v182
  v_mfma_f32_16x16x32_bf16 v[184:187], a[184:187], v[168:171], v[184:187]
  ds_read_b128 a[152:155], v5 offset:6144
  v_mul_f32 v183, v89, v183
  v_mfma_f32_16x16x32_bf16 v[184:187], a[188:191], v[172:175], v[184:187]
  buffer_load_dwordx4 a[208:211], v1, s[12:15], s98 offen offset:1024 sc1
  v_mfma_f32_16x16x32_bf16 v[188:191], a[160:163], v[192:195], 0
  ds_read_b128 a[156:159], v5 offset:7168
  v_cvt_pk_bf16_f32 v85, v182, v183
  v_mfma_f32_16x16x32_bf16 v[188:191], a[164:167], v[196:199], v[188:191]
  v_mfma_f32_16x16x32_bf16 v[188:191], a[168:171], v[200:203], v[188:191]
  s_nop 0
  ds_read_b128 a[160:163], v5 offset:8192
  v_mul_f32 v184, v88, v184
  v_mfma_f32_16x16x32_bf16 v[188:191], a[172:175], v[204:207], v[188:191]
  buffer_store_dword v11, v0, s[12:15], s74 offen offset:512 sc1
  v_mfma_f32_16x16x32_bf16 v[188:191], a[176:179], v[224:227], v[188:191]
  s_add_u32 s98, s36, 20480
  ds_read_b128 a[164:167], v5 offset:9216
  v_mul_f32 v185, v88, v185
  v_mfma_f32_16x16x32_bf16 v[188:191], a[180:183], v[228:231], v[188:191]
  buffer_load_dwordx4 a[20:23], v1, s[12:15], s98 offen offset:0 sc1
  v_mfma_f32_16x16x32_bf16 v[188:191], a[184:187], v[232:235], v[188:191]
  ds_read_b128 a[168:171], v5 offset:10240
  v_cvt_pk_bf16_f32 v82, v184, v185
  v_mfma_f32_16x16x32_bf16 v[188:191], a[188:191], v[236:239], v[188:191]
  s_waitcnt lgkmcnt(7)
  v_mul_f32 v186, v88, v186
  v_mul_f32 v187, v88, v187
  v_mfma_f32_16x16x32_bf16 v[144:147], a[128:131], v[128:131], 0
  ds_read_b128 a[172:175], v5 offset:11264
  v_cvt_pk_bf16_f32 v83, v186, v187
  v_mfma_f32_16x16x32_bf16 v[144:147], a[132:135], v[132:135], v[144:147]
  s_add_u32 s18, s73, 377856
  buffer_load_dwordx4 a[212:215], v1, s[12:15], s98 offen offset:1024 sc1
  v_mfma_f32_16x16x32_bf16 v[144:147], a[136:139], v[136:139], v[144:147]
  ds_read_b128 a[176:179], v5 offset:12288
  v_mul_f32 v188, v89, v188
  v_mfma_f32_16x16x32_bf16 v[144:147], a[140:143], v[140:143], v[144:147]
  s_waitcnt lgkmcnt(5)
  buffer_store_dwordx4 v[80:83], v1, s[12:15], s18 offen sc1
  v_mfma_f32_16x16x32_bf16 v[144:147], a[144:147], v[160:163], v[144:147]
  ds_read_b128 a[180:183], v5 offset:13312
  v_mul_f32 v189, v89, v189
  v_mfma_f32_16x16x32_bf16 v[144:147], a[148:151], v[164:167], v[144:147]
  v_cvt_pk_bf16_f32 v86, v188, v189
  v_mul_f32 v190, v89, v190
  v_mfma_f32_16x16x32_bf16 v[144:147], a[152:155], v[168:171], v[144:147]
  s_add_u32 s98, s36, 24576
  ds_read_b128 a[184:187], v5 offset:14336
  v_mul_f32 v191, v89, v191
  v_mfma_f32_16x16x32_bf16 v[144:147], a[156:159], v[172:175], v[144:147]
  buffer_load_dwordx4 a[24:27], v1, s[12:15], s98 offen offset:0 sc1
  v_mfma_f32_16x16x32_bf16 v[148:151], a[128:131], v[192:195], 0
  ds_read_b128 a[188:191], v5 offset:15360
  v_cvt_pk_bf16_f32 v87, v190, v191
  v_mfma_f32_16x16x32_bf16 v[148:151], a[132:135], v[196:199], v[148:151]
  s_add_u32 s19, s73, 379904
  buffer_store_dwordx4 v[84:87], v1, s[12:15], s19 offen sc1
  v_mfma_f32_16x16x32_bf16 v[148:151], a[136:139], v[200:203], v[148:151]
  ds_read_b128 a[128:131], v5 offset:16384
  v_mul_f32 v144, v88, v144
  v_mfma_f32_16x16x32_bf16 v[148:151], a[140:143], v[204:207], v[148:151]
  buffer_load_dwordx4 a[216:219], v1, s[12:15], s98 offen offset:1024 sc1
  v_mfma_f32_16x16x32_bf16 v[148:151], a[144:147], v[224:227], v[148:151]
  ds_read_b128 a[132:135], v5 offset:17408
  v_mul_f32 v145, v88, v145
  v_mfma_f32_16x16x32_bf16 v[148:151], a[148:151], v[228:231], v[148:151]
  v_cvt_pk_bf16_f32 v72, v144, v145
  v_mul_f32 v146, v88, v146
  v_mfma_f32_16x16x32_bf16 v[148:151], a[152:155], v[232:235], v[148:151]
  ds_read_b128 a[136:139], v5 offset:18432
  v_mul_f32 v147, v88, v147
  v_mfma_f32_16x16x32_bf16 v[148:151], a[156:159], v[236:239], v[148:151]
  s_waitcnt lgkmcnt(7)
  v_cvt_pk_bf16_f32 v73, v146, v147
  v_mfma_f32_16x16x32_bf16 v[152:155], a[160:163], v[128:131], 0
  s_add_u32 s98, s36, 28672
  ds_read_b128 a[140:143], v5 offset:19456
  v_mfma_f32_16x16x32_bf16 v[152:155], a[164:167], v[132:135], v[152:155]
  buffer_load_dwordx4 a[28:31], v1, s[12:15], s98 offen offset:0 sc1
  v_mfma_f32_16x16x32_bf16 v[152:155], a[168:171], v[136:139], v[152:155]
  ds_read_b128 a[144:147], v5 offset:20480
  v_mul_f32 v148, v89, v148
  v_mfma_f32_16x16x32_bf16 v[152:155], a[172:175], v[140:143], v[152:155]
  s_waitcnt lgkmcnt(5)
  v_mul_f32 v149, v89, v149
  v_cvt_pk_bf16_f32 v76, v148, v149
  v_mfma_f32_16x16x32_bf16 v[152:155], a[176:179], v[160:163], v[152:155]
  ds_read_b128 a[148:151], v5 offset:21504
  v_mul_f32 v150, v89, v150
  v_mfma_f32_16x16x32_bf16 v[152:155], a[180:183], v[164:167], v[152:155]
  buffer_load_dwordx4 a[220:223], v1, s[12:15], s98 offen offset:1024 sc1
  v_mfma_f32_16x16x32_bf16 v[152:155], a[184:187], v[168:171], v[152:155]
  ds_read_b128 a[152:155], v5 offset:22528
  v_mul_f32 v151, v89, v151
  v_mfma_f32_16x16x32_bf16 v[152:155], a[188:191], v[172:175], v[152:155]
  v_cvt_pk_bf16_f32 v77, v150, v151
  v_mfma_f32_16x16x32_bf16 v[156:159], a[160:163], v[192:195], 0
  ds_read_b128 a[156:159], v5 offset:23552
  v_mfma_f32_16x16x32_bf16 v[156:159], a[164:167], v[196:199], v[156:159]
  v_mfma_f32_16x16x32_bf16 v[156:159], a[168:171], v[200:203], v[156:159]
  ds_read_b128 a[160:163], v5 offset:24576
  v_mfma_f32_16x16x32_bf16 v[156:159], a[172:175], v[204:207], v[156:159]
  s_add_u32 s98, s36, 32768
  v_mul_f32 v152, v88, v152
  v_mfma_f32_16x16x32_bf16 v[156:159], a[176:179], v[224:227], v[156:159]
  ds_read_b128 a[164:167], v5 offset:25600
  v_mul_f32 v153, v88, v153
  v_mfma_f32_16x16x32_bf16 v[156:159], a[180:183], v[228:231], v[156:159]
  buffer_load_dwordx4 a[32:35], v1, s[12:15], s98 offen offset:0 sc1
  v_mfma_f32_16x16x32_bf16 v[156:159], a[184:187], v[232:235], v[156:159]
  ds_read_b128 a[168:171], v5 offset:26624
  v_cvt_pk_bf16_f32 v74, v152, v153
  v_mfma_f32_16x16x32_bf16 v[156:159], a[188:191], v[236:239], v[156:159]
  s_waitcnt lgkmcnt(7)
  v_mul_f32 v154, v88, v154
  v_mul_f32 v155, v88, v155
  v_mfma_f32_16x16x32_bf16 v[176:179], a[128:131], v[128:131], 0
  ds_read_b128 a[172:175], v5 offset:27648
  v_cvt_pk_bf16_f32 v75, v154, v155
  v_mfma_f32_16x16x32_bf16 v[176:179], a[132:135], v[132:135], v[176:179]
  s_add_u32 s16, s73, 471040
  buffer_load_dwordx4 a[224:227], v1, s[12:15], s98 offen offset:1024 sc1
  v_mfma_f32_16x16x32_bf16 v[176:179], a[136:139], v[136:139], v[176:179]
  ds_read_b128 a[176:179], v5 offset:28672
  v_mul_f32 v156, v89, v156
  v_mfma_f32_16x16x32_bf16 v[176:179], a[140:143], v[140:143], v[176:179]
  s_waitcnt lgkmcnt(5)
  buffer_store_dwordx4 v[72:75], v1, s[12:15], s16 offen sc1
  v_mfma_f32_16x16x32_bf16 v[176:179], a[144:147], v[160:163], v[176:179]
  ds_read_b128 a[180:183], v5 offset:29696
  v_mul_f32 v157, v89, v157
  v_mfma_f32_16x16x32_bf16 v[176:179], a[148:151], v[164:167], v[176:179]
  s_add_u32 s98, s36, 36864
  buffer_load_dwordx4 a[36:39], v1, s[12:15], s98 offen offset:0 sc1
  v_mfma_f32_16x16x32_bf16 v[176:179], a[152:155], v[168:171], v[176:179]
  ds_read_b128 a[184:187], v5 offset:30720
  v_cvt_pk_bf16_f32 v78, v156, v157
  v_mfma_f32_16x16x32_bf16 v[176:179], a[156:159], v[172:175], v[176:179]
  v_mul_f32 v158, v89, v158
  v_mul_f32 v159, v89, v159
  v_mfma_f32_16x16x32_bf16 v[180:183], a[128:131], v[192:195], 0
  ds_read_b128 a[188:191], v5 offset:31744
  v_cvt_pk_bf16_f32 v79, v158, v159
  v_mfma_f32_16x16x32_bf16 v[180:183], a[132:135], v[196:199], v[180:183]
  s_add_u32 s67, s67, 0x8000
  v_mfma_f32_16x16x32_bf16 v[180:183], a[136:139], v[200:203], v[180:183]
  s_and_b32 s67, s67, 0x1ffff
  buffer_load_dwordx4 a[228:231], v1, s[12:15], s98 offen offset:1024 sc1
  v_mfma_f32_16x16x32_bf16 v[180:183], a[140:143], v[204:207], v[180:183]
  v_add_u32 v5, s67, v1
  v_mul_f32 v176, v88, v176
  v_mfma_f32_16x16x32_bf16 v[180:183], a[144:147], v[224:227], v[180:183]
  s_add_u32 s17, s73, 473088
  buffer_store_dwordx4 v[76:79], v1, s[12:15], s17 offen sc1
  v_mfma_f32_16x16x32_bf16 v[180:183], a[148:151], v[228:231], v[180:183]
  v_mul_f32 v177, v88, v177
  v_cvt_pk_bf16_f32 v80, v176, v177
  v_mfma_f32_16x16x32_bf16 v[180:183], a[152:155], v[232:235], v[180:183]
  s_waitcnt vmcnt(39) lgkmcnt(0)
  v_mul_f32 v178, v88, v178
  v_mul_f32 v179, v88, v179
  v_mfma_f32_16x16x32_bf16 v[180:183], a[156:159], v[236:239], v[180:183]
  s_barrier
  v_cvt_pk_bf16_f32 v81, v178, v179
  v_mfma_f32_16x16x32_bf16 v[184:187], a[160:163], v[128:131], 0
  s_add_u32 s98, s36, 40960
  ds_read_b128 a[128:131], v5 offset:0
  ds_read_b128 a[132:135], v5 offset:1024
  v_mfma_f32_16x16x32_bf16 v[184:187], a[164:167], v[132:135], v[184:187]
  ds_read_b128 a[136:139], v5 offset:2048
  ds_read_b128 a[140:143], v5 offset:3072
  v_mfma_f32_16x16x32_bf16 v[184:187], a[168:171], v[136:139], v[184:187]
  buffer_load_dwordx4 a[40:43], v1, s[12:15], s98 offen offset:0 sc1
  v_mfma_f32_16x16x32_bf16 v[184:187], a[172:175], v[140:143], v[184:187]
  ds_read_b128 a[144:147], v5 offset:4096
  v_mul_f32 v180, v89, v180
  v_mfma_f32_16x16x32_bf16 v[184:187], a[176:179], v[160:163], v[184:187]
  ds_read_b128 a[148:151], v5 offset:5120
  v_mul_f32 v181, v89, v181
  v_mfma_f32_16x16x32_bf16 v[184:187], a[180:183], v[164:167], v[184:187]
  buffer_load_dwordx4 a[232:235], v1, s[12:15], s98 offen offset:1024 sc1
  v_mfma_f32_16x16x32_bf16 v[184:187], a[184:187], v[168:171], v[184:187]
  ds_read_b128 a[152:155], v5 offset:6144
  v_cvt_pk_bf16_f32 v84, v180, v181
  v_mfma_f32_16x16x32_bf16 v[184:187], a[188:191], v[172:175], v[184:187]
  v_mul_f32 v182, v89, v182
  v_mul_f32 v183, v89, v183
  v_mfma_f32_16x16x32_bf16 v[188:191], a[160:163], v[192:195], 0
  ds_read_b128 a[156:159], v5 offset:7168
  v_cvt_pk_bf16_f32 v85, v182, v183
  v_mfma_f32_16x16x32_bf16 v[188:191], a[164:167], v[196:199], v[188:191]
  v_mfma_f32_16x16x32_bf16 v[188:191], a[168:171], v[200:203], v[188:191]
  s_nop 0
  ds_read_b128 a[160:163], v5 offset:8192
  s_add_u32 s98, s36, 45056
  v_mfma_f32_16x16x32_bf16 v[188:191], a[172:175], v[204:207], v[188:191]
  buffer_store_dword v11, v0, s[12:15], s74 offen offset:1024 sc1
  v_mfma_f32_16x16x32_bf16 v[188:191], a[176:179], v[224:227], v[188:191]
  buffer_load_dwordx4 a[44:47], v1, s[12:15], s98 offen offset:0 sc1
  v_mfma_f32_16x16x32_bf16 v[188:191], a[180:183], v[228:231], v[188:191]
  ds_read_b128 a[164:167], v5 offset:9216
  v_mul_f32 v184, v88, v184
  v_mfma_f32_16x16x32_bf16 v[188:191], a[184:187], v[232:235], v[188:191]
  ds_read_b128 a[168:171], v5 offset:10240
  v_mul_f32 v185, v88, v185
  v_mfma_f32_16x16x32_bf16 v[188:191], a[188:191], v[236:239], v[188:191]
  s_waitcnt lgkmcnt(7)
  buffer_load_dwordx4 a[236:239], v1, s[12:15], s98 offen offset:1024 sc1
  v_mfma_f32_16x16x32_bf16 v[144:147], a[128:131], v[128:131], 0
  ds_read_b128 a[172:175], v5 offset:11264
  v_cvt_pk_bf16_f32 v82, v184, v185
  v_mfma_f32_16x16x32_bf16 v[144:147], a[132:135], v[132:135], v[144:147]
  v_mul_f32 v186, v88, v186
  v_mul_f32 v187, v88, v187
  v_mfma_f32_16x16x32_bf16 v[144:147], a[136:139], v[136:139], v[144:147]
  ds_read_b128 a[176:179], v5 offset:12288
  v_cvt_pk_bf16_f32 v83, v186, v187
  v_mfma_f32_16x16x32_bf16 v[144:147], a[140:143], v[140:143], v[144:147]
  s_waitcnt lgkmcnt(5)
  v_mul_f32 v188, v89, v188
  v_mul_f32 v189, v89, v189
  v_mfma_f32_16x16x32_bf16 v[144:147], a[144:147], v[160:163], v[144:147]
  s_add_u32 s18, s73, 472064
  ds_read_b128 a[180:183], v5 offset:13312
  v_cvt_pk_bf16_f32 v86, v188, v189
  v_mfma_f32_16x16x32_bf16 v[144:147], a[148:151], v[164:167], v[144:147]
  s_add_u32 s98, s36, 49152
  buffer_load_dwordx4 a[48:51], v1, s[12:15], s98 offen offset:0 sc1
  v_mfma_f32_16x16x32_bf16 v[144:147], a[152:155], v[168:171], v[144:147]
  ds_read_b128 a[184:187], v5 offset:14336
  v_mul_f32 v190, v89, v190
  v_mfma_f32_16x16x32_bf16 v[144:147], a[156:159], v[172:175], v[144:147]
  buffer_store_dwordx4 v[80:83], v1, s[12:15], s18 offen sc1
  v_mfma_f32_16x16x32_bf16 v[148:151], a[128:131], v[192:195], 0
  ds_read_b128 a[188:191], v5 offset:15360
  v_mul_f32 v191, v89, v191
  v_mfma_f32_16x16x32_bf16 v[148:151], a[132:135], v[196:199], v[148:151]
  v_cvt_pk_bf16_f32 v87, v190, v191
  v_mfma_f32_16x16x32_bf16 v[148:151], a[136:139], v[200:203], v[148:151]
  s_add_u32 s19, s73, 474112
  ds_read_b128 a[128:131], v5 offset:16384
  v_mul_f32 v144, v88, v144
  v_mfma_f32_16x16x32_bf16 v[148:151], a[140:143], v[204:207], v[148:151]
  buffer_load_dwordx4 a[240:243], v1, s[12:15], s98 offen offset:1024 sc1
  v_mfma_f32_16x16x32_bf16 v[148:151], a[144:147], v[224:227], v[148:151]
  ds_read_b128 a[132:135], v5 offset:17408
  v_mul_f32 v145, v88, v145
  v_mfma_f32_16x16x32_bf16 v[148:151], a[148:151], v[228:231], v[148:151]
  buffer_store_dwordx4 v[84:87], v1, s[12:15], s19 offen sc1
  v_mfma_f32_16x16x32_bf16 v[148:151], a[152:155], v[232:235], v[148:151]
  ds_read_b128 a[136:139], v5 offset:18432
  v_cvt_pk_bf16_f32 v72, v144, v145
  v_mfma_f32_16x16x32_bf16 v[148:151], a[156:159], v[236:239], v[148:151]
  s_waitcnt lgkmcnt(7)
  s_add_u32 s98, s36, 53248
  v_mul_f32 v146, v88, v146
  v_mfma_f32_16x16x32_bf16 v[152:155], a[160:163], v[128:131], 0
  ds_read_b128 a[140:143], v5 offset:19456
  v_mul_f32 v147, v88, v147
  v_mfma_f32_16x16x32_bf16 v[152:155], a[164:167], v[132:135], v[152:155]
  buffer_load_dwordx4 a[52:55], v1, s[12:15], s98 offen offset:0 sc1
  v_mfma_f32_16x16x32_bf16 v[152:155], a[168:171], v[136:139], v[152:155]
  ds_read_b128 a[144:147], v5 offset:20480
  v_cvt_pk_bf16_f32 v73, v146, v147
  v_mfma_f32_16x16x32_bf16 v[152:155], a[172:175], v[140:143], v[152:155]
  s_waitcnt lgkmcnt(5)
  v_mul_f32 v148, v89, v148
  v_mul_f32 v149, v89, v149
  v_mfma_f32_16x16x32_bf16 v[152:155], a[176:179], v[160:163], v[152:155]
  ds_read_b128 a[148:151], v5 offset:21504
  v_cvt_pk_bf16_f32 v76, v148, v149
  v_mfma_f32_16x16x32_bf16 v[152:155], a[180:183], v[164:167], v[152:155]
  buffer_load_dwordx4 a[244:247], v1, s[12:15], s98 offen offset:1024 sc1
  v_mfma_f32_16x16x32_bf16 v[152:155], a[184:187], v[168:171], v[152:155]
  ds_read_b128 a[152:155], v5 offset:22528
  v_mul_f32 v150, v89, v150
  v_mfma_f32_16x16x32_bf16 v[152:155], a[188:191], v[172:175], v[152:155]
  v_mul_f32 v151, v89, v151
  v_cvt_pk_bf16_f32 v77, v150, v151
  v_mfma_f32_16x16x32_bf16 v[156:159], a[160:163], v[192:195], 0
  ds_read_b128 a[156:159], v5 offset:23552
  v_mfma_f32_16x16x32_bf16 v[156:159], a[164:167], v[196:199], v[156:159]
  v_mfma_f32_16x16x32_bf16 v[156:159], a[168:171], v[200:203], v[156:159]
  s_add_u32 s98, s36, 57344
  ds_read_b128 a[160:163], v5 offset:24576
  v_mul_f32 v152, v88, v152
  v_mfma_f32_16x16x32_bf16 v[156:159], a[172:175], v[204:207], v[156:159]
  buffer_load_dwordx4 a[56:59], v1, s[12:15], s98 offen offset:0 sc1
  v_mfma_f32_16x16x32_bf16 v[156:159], a[176:179], v[224:227], v[156:159]
  ds_read_b128 a[164:167], v5 offset:25600
  v_mul_f32 v153, v88, v153
  v_mfma_f32_16x16x32_bf16 v[156:159], a[180:183], v[228:231], v[156:159]
  v_cvt_pk_bf16_f32 v74, v152, v153
  v_mul_f32 v154, v88, v154
  v_mfma_f32_16x16x32_bf16 v[156:159], a[184:187], v[232:235], v[156:159]
  ds_read_b128 a[168:171], v5 offset:26624
  v_mul_f32 v155, v88, v155
  v_mfma_f32_16x16x32_bf16 v[156:159], a[188:191], v[236:239], v[156:159]
  s_waitcnt lgkmcnt(7)
  buffer_load_dwordx4 a[248:251], v1, s[12:15], s98 offen offset:1024 sc1
  v_mfma_f32_16x16x32_bf16 v[176:179], a[128:131], v[128:131], 0
  ds_read_b128 a[172:175], v5 offset:27648
  v_cvt_pk_bf16_f32 v75, v154, v155
  v_mfma_f32_16x16x32_bf16 v[176:179], a[132:135], v[132:135], v[176:179]
  s_add_u32 s16, s73, 565248
  buffer_store_dwordx4 v[72:75], v1, s[12:15], s16 offen sc1
  v_mfma_f32_16x16x32_bf16 v[176:179], a[136:139], v[136:139], v[176:179]
  ds_read_b128 a[176:179], v5 offset:28672
  v_mul_f32 v156, v89, v156
  v_mfma_f32_16x16x32_bf16 v[176:179], a[140:143], v[140:143], v[176:179]
  s_waitcnt lgkmcnt(5)
  v_mul_f32 v157, v89, v157
  v_cvt_pk_bf16_f32 v78, v156, v157
  v_mfma_f32_16x16x32_bf16 v[176:179], a[144:147], v[160:163], v[176:179]
  s_add_u32 s98, s36, 61440
  ds_read_b128 a[180:183], v5 offset:29696
  v_mul_f32 v158, v89, v158
  v_mfma_f32_16x16x32_bf16 v[176:179], a[148:151], v[164:167], v[176:179]
  buffer_load_dwordx4 a[60:63], v1, s[12:15], s98 offen offset:0 sc1
  v_mfma_f32_16x16x32_bf16 v[176:179], a[152:155], v[168:171], v[176:179]
  ds_read_b128 a[184:187], v5 offset:30720
  v_mul_f32 v159, v89, v159
  v_mfma_f32_16x16x32_bf16 v[176:179], a[156:159], v[172:175], v[176:179]
  v_cvt_pk_bf16_f32 v79, v158, v159
  v_mfma_f32_16x16x32_bf16 v[180:183], a[128:131], v[192:195], 0
  s_add_u32 s17, s73, 567296
  ds_read_b128 a[188:191], v5 offset:31744
  v_mfma_f32_16x16x32_bf16 v[180:183], a[132:135], v[196:199], v[180:183]
  buffer_load_dwordx4 a[252:255], v1, s[12:15], s98 offen offset:1024 sc1
  v_mfma_f32_16x16x32_bf16 v[180:183], a[136:139], v[200:203], v[180:183]
  buffer_store_dwordx4 v[76:79], v1, s[12:15], s17 offen sc1
  v_mfma_f32_16x16x32_bf16 v[180:183], a[140:143], v[204:207], v[180:183]
  v_mul_f32 v176, v88, v176
  v_mul_f32 v177, v88, v177
  v_mfma_f32_16x16x32_bf16 v[180:183], a[144:147], v[224:227], v[180:183]
  v_cvt_pk_bf16_f32 v80, v176, v177
  v_mul_f32 v178, v88, v178
  v_mfma_f32_16x16x32_bf16 v[180:183], a[148:151], v[228:231], v[180:183]
  v_mul_f32 v179, v88, v179
  v_cvt_pk_bf16_f32 v81, v178, v179
  v_mfma_f32_16x16x32_bf16 v[180:183], a[152:155], v[232:235], v[180:183]
  v_mfma_f32_16x16x32_bf16 v[180:183], a[156:159], v[236:239], v[180:183]
  s_waitcnt lgkmcnt(4)
  v_mfma_f32_16x16x32_bf16 v[184:187], a[160:163], v[128:131], 0
  v_mfma_f32_16x16x32_bf16 v[184:187], a[164:167], v[132:135], v[184:187]
  v_mfma_f32_16x16x32_bf16 v[184:187], a[168:171], v[136:139], v[184:187]
  v_mfma_f32_16x16x32_bf16 v[184:187], a[172:175], v[140:143], v[184:187]
  s_waitcnt lgkmcnt(0)
  v_mfma_f32_16x16x32_bf16 v[184:187], a[176:179], v[160:163], v[184:187]
  v_mfma_f32_16x16x32_bf16 v[184:187], a[180:183], v[164:167], v[184:187]
  v_mfma_f32_16x16x32_bf16 v[184:187], a[184:187], v[168:171], v[184:187]
  v_mfma_f32_16x16x32_bf16 v[184:187], a[188:191], v[172:175], v[184:187]
  v_mul_f32 v180, v89, v180
  v_mul_f32 v181, v89, v181
  v_mfma_f32_16x16x32_bf16 v[188:191], a[160:163], v[192:195], 0
  buffer_load_dword v12, v13, s[12:15], s40 offen sc1
  v_mfma_f32_16x16x32_bf16 v[188:191], a[164:167], v[196:199], v[188:191]
  v_cvt_pk_bf16_f32 v84, v180, v181
  v_mul_f32 v182, v89, v182
  v_mfma_f32_16x16x32_bf16 v[188:191], a[168:171], v[200:203], v[188:191]
  s_nop 0
  s_waitcnt vmcnt(45)
  buffer_store_dword v11, v0, s[12:15], s74 offen offset:1536 sc1
  v_mfma_f32_16x16x32_bf16 v[188:191], a[172:175], v[204:207], v[188:191]
  v_mul_f32 v184, v88, v184
  v_mul_f32 v185, v88, v185
  v_mfma_f32_16x16x32_bf16 v[188:191], a[176:179], v[224:227], v[188:191]
  v_cvt_pk_bf16_f32 v82, v184, v185
  v_mul_f32 v186, v88, v186
  v_mfma_f32_16x16x32_bf16 v[188:191], a[180:183], v[228:231], v[188:191]
  v_mul_f32 v187, v88, v187
  v_cvt_pk_bf16_f32 v83, v186, v187
  v_mfma_f32_16x16x32_bf16 v[188:191], a[184:187], v[232:235], v[188:191]
  s_add_u32 s18, s73, 566272
  buffer_store_dwordx4 v[80:83], v1, s[12:15], s18 offen sc1
  v_mfma_f32_16x16x32_bf16 v[188:191], a[188:191], v[236:239], v[188:191]
  v_mul_f32 v183, v89, v183
  v_cvt_pk_bf16_f32 v85, v182, v183
  s_nop 5
  v_mul_f32 v188, v89, v188
  v_mul_f32 v189, v89, v189
  v_cvt_pk_bf16_f32 v86, v188, v189
  v_mul_f32 v190, v89, v190
  v_mul_f32 v191, v89, v191
  v_cvt_pk_bf16_f32 v87, v190, v191
  s_add_u32 s19, s73, 568320
  buffer_store_dwordx4 v[84:87], v1, s[12:15], s19 offen sc1
  s_nop 0
  s_waitcnt vmcnt(30)
  buffer_store_dword v11, v0, s[12:15], s74 offen offset:2048 sc1
  s_waitcnt vmcnt(13)
  buffer_store_dword v11, v0, s[12:15], s74 offen offset:2560 sc1
  s_waitcnt vmcnt(2)
  buffer_store_dword v11, v0, s[12:15], s74 offen offset:3072 sc1
  s_branch L_kf_kernel_t2b_69
L_kf_kernel_pre_97:
  v_and_b32 v13, 127, v13
  v_readfirstlane_b32 s96, v12
  s_nop 0
  s_lshr_b32 s97, s96, 2
  v_readlane_b32 s98, v7, s97
  v_readlane_b32 s97, v10, s97
  s_bitcmp1_b32 s96, 1
  s_cselect_b32 s98, s97, s98
  s_lshl_b32 s96, s96, 4
  s_lshr_b32 s98, s98, s96
  s_and_b32 s96, s98, 15
  s_bfe_u32 s39, s98, 0x50004
  s_bfe_u32 s41, s98, 0x30009
  s_lshl_b32 s40, s96, 6
  s_add_u32 s40, s40, s39
  s_andn2_b32 s40, s40, 3
  s_add_u32 s40, s40, s64
  s_lshl_b32 s40, s40, 7
  s_add_u32 s40, s40, 38666240
  s_mul_i32 s36, s96, 2637824
  s_mul_i32 s97, s64, 7
  s_lshr_b32 s98, s39, 2
  s_add_u32 s97, s97, s98
  s_mul_i32 s97, s97, 94208
  s_add_u32 s36, s36, s97
  s_and_b32 s97, s39, 3
  s_lshl_b32 s97, s97, 10
  s_add_u32 s36, s36, s97
  s_add_u32 s36, s36, 51380224
  s_bfe_u32 s97, s39, 0x10001
  s_lshl1_add_u32 s96, s96, s97
  s_lshl2_add_u32 s96, s96, s64
  s_mul_i32 s96, s96, 14336
  s_lshr_b32 s97, s39, 2
  s_and_b32 s98, s39, 1
  s_lshl1_add_u32 s97, s97, s98
  s_lshl_b32 s44, s97, 6
  s_add_u32 s42, s96, s44
  s_add_u32 s43, s42, 57344
  v_and_b32 v22, 0x3f803f80, v30
  v_and_b32 v23, 0x3f803f80, v31
  v_and_b32 v28, 0x3f803f80, v30
  v_and_b32 v29, 0x3f803f80, v31
  v_mov_b32 v30, v28
  v_mov_b32 v31, v29
  s_mov_b32 s76, 0xbfb8aa3b
  s_mov_b32 s63, 0x4000
  s_mov_b32 s37, 0xff800000
  s_mov_b32 s45, 0
L_kf_kernel_gl_209:
  buffer_load_dword v16, v13, s[12:15], s40 offen sc1
  s_waitcnt vmcnt(0)
  v_cmp_eq_u32 vcc, 0, v16
  s_nop 0
  s_and_b32 s97, vcc_lo, 0xffff
  s_cbranch_scc0 L_kf_kernel_gd_210
  s_sub_u32 s63, s63, 1
  s_cbranch_scc0 L_kf_kernel_gl_209
L_kf_kernel_gd_210:
  s_add_u32 s97, s36, 0
  buffer_load_dwordx4 a[0:3], v1, s[12:15], s97 offen offset:0 sc1
  s_add_u32 s97, s36, 4096
  buffer_load_dwordx4 a[4:7], v1, s[12:15], s97 offen offset:0 sc1
  s_add_u32 s97, s36, 8192
  buffer_load_dwordx4 a[8:11], v1, s[12:15], s97 offen offset:0 sc1
  s_add_u32 s97, s36, 12288
  buffer_load_dwordx4 a[12:15], v1, s[12:15], s97 offen offset:0 sc1
  s_add_u32 s97, s36, 16384
  buffer_load_dwordx4 a[16:19], v1, s[12:15], s97 offen offset:0 sc1
  s_add_u32 s97, s36, 20480
  buffer_load_dwordx4 a[20:23], v1, s[12:15], s97 offen offset:0 sc1
  s_add_u32 s97, s36, 24576
  buffer_load_dwordx4 a[24:27], v1, s[12:15], s97 offen offset:0 sc1
  s_add_u32 s97, s36, 28672
  buffer_load_dwordx4 a[28:31], v1, s[12:15], s97 offen offset:0 sc1
  s_add_u32 s97, s36, 32768
  buffer_load_dwordx4 a[32:35], v1, s[12:15], s97 offen offset:0 sc1
  s_add_u32 s97, s36, 36864
  buffer_load_dwordx4 a[36:39], v1, s[12:15], s97 offen offset:0 sc1
  s_add_u32 s97, s36, 40960
  buffer_load_dwordx4 a[40:43], v1, s[12:15], s97 offen offset:0 sc1
  s_add_u32 s97, s36, 45056
  buffer_load_dwordx4 a[44:47], v1, s[12:15], s97 offen offset:0 sc1
  s_add_u32 s97, s36, 49152
  buffer_load_dwordx4 a[48:51], v1, s[12:15], s97 offen offset:0 sc1
  s_add_u32 s97, s36, 53248
  buffer_load_dwordx4 a[52:55], v1, s[12:15], s97 offen offset:0 sc1
  s_add_u32 s97, s36, 57344
  buffer_load_dwordx4 a[56:59], v1, s[12:15], s97 offen offset:0 sc1
  s_add_u32 s97, s36, 61440
  buffer_load_dwordx4 a[60:63], v1, s[12:15], s97 offen offset:0 sc1
  s_add_u32 s97, s36, 0
  buffer_load_dwordx4 a[64:67], v1, s[12:15], s97 offen offset:1024 sc1
  s_add_u32 s97, s36, 4096
  buffer_load_dwordx4 a[68:71], v1, s[12:15], s97 offen offset:1024 sc1
  s_add_u32 s97, s36, 8192
  buffer_load_dwordx4 a[72:75], v1, s[12:15], s97 offen offset:1024 sc1
  s_add_u32 s97, s36, 12288
  buffer_load_dwordx4 a[76:79], v1, s[12:15], s97 offen offset:1024 sc1
  s_add_u32 s97, s36, 16384
  buffer_load_dwordx4 a[80:83], v1, s[12:15], s97 offen offset:1024 sc1
  s_add_u32 s97, s36, 20480
  buffer_load_dwordx4 a[84:87], v1, s[12:15], s97 offen offset:1024 sc1
  s_add_u32 s97, s36, 24576
  buffer_load_dwordx4 a[88:91], v1, s[12:15], s97 offen offset:1024 sc1
  s_add_u32 s97, s36, 28672
  buffer_load_dwordx4 a[92:95], v1, s[12:15], s97 offen offset:1024 sc1
  s_add_u32 s97, s36, 32768
  buffer_load_dwordx4 a[96:99], v1, s[12:15], s97 offen offset:1024 sc1
  s_waitcnt vmcnt(24)
  v_mfma_f32_16x16x32_bf16 v[32:35], v[22:25], a[0:3], 0
  s_add_u32 s97, s36, 36864
  buffer_load_dwordx4 a[100:103], v1, s[12:15], s97 offen offset:1024 sc1
  s_waitcnt vmcnt(24)
  v_mfma_f32_16x16x32_bf16 v[36:39], v[28:31], a[2:5], 0
  s_add_u32 s97, s36, 40960
  buffer_load_dwordx4 a[104:107], v1, s[12:15], s97 offen offset:1024 sc1
  s_waitcnt vmcnt(24)
  v_mfma_f32_16x16x32_bf16 v[32:35], v[28:31], a[6:9], v[32:35]
  s_add_u32 s97, s36, 45056
  buffer_load_dwordx4 a[108:111], v1, s[12:15], s97 offen offset:1024 sc1
  s_waitcnt vmcnt(24)
  v_mfma_f32_16x16x32_bf16 v[36:39], v[28:31], a[10:13], v[36:39]
  s_add_u32 s97, s36, 49152
  buffer_load_dwordx4 a[112:115], v1, s[12:15], s97 offen offset:1024 sc1
  s_waitcnt vmcnt(24)
  v_mfma_f32_16x16x32_bf16 v[32:35], v[28:31], a[14:17], v[32:35]
  s_add_u32 s97, s36, 53248
  buffer_load_dwordx4 a[116:119], v1, s[12:15], s97 offen offset:1024 sc1
  s_waitcnt vmcnt(24)
  v_mfma_f32_16x16x32_bf16 v[36:39], v[28:31], a[18:21], v[36:39]
  s_add_u32 s97, s36, 57344
  buffer_load_dwordx4 a[120:123], v1, s[12:15], s97 offen offset:1024 sc1
  s_waitcnt vmcnt(24)
  v_mfma_f32_16x16x32_bf16 v[32:35], v[28:31], a[22:25], v[32:35]
  s_add_u32 s97, s36, 61440
  buffer_load_dwordx4 a[124:127], v1, s[12:15], s97 offen offset:1024 sc1
  s_waitcnt vmcnt(24)
  v_mfma_f32_16x16x32_bf16 v[36:39], v[28:31], a[26:29], v[36:39]
  s_add_u32 s97, s36, 0
  buffer_load_dwordx4 a[192:195], v1, s[12:15], s97 offen offset:2048 sc1
  s_waitcnt vmcnt(24)
  v_mfma_f32_16x16x32_bf16 v[32:35], v[28:31], a[30:33], v[32:35]
  s_add_u32 s97, s36, 4096
  buffer_load_dwordx4 a[196:199], v1, s[12:15], s97 offen offset:2048 sc1
  s_waitcnt vmcnt(24)
  v_mfma_f32_16x16x32_bf16 v[36:39], v[28:31], a[34:37], v[36:39]
  s_add_u32 s97, s36, 8192
  buffer_load_dwordx4 a[200:203], v1, s[12:15], s97 offen offset:2048 sc1
  s_waitcnt vmcnt(24)
  v_mfma_f32_16x16x32_bf16 v[32:35], v[28:31], a[38:41], v[32:35]
  s_add_u32 s97, s36, 12288
  buffer_load_dwordx4 a[204:207], v1, s[12:15], s97 offen offset:2048 sc1
  s_waitcnt vmcnt(24)
  v_mfma_f32_16x16x32_bf16 v[36:39], v[28:31], a[42:45], v[36:39]
  s_add_u32 s97, s36, 16384
  buffer_load_dwordx4 a[208:211], v1, s[12:15], s97 offen offset:2048 sc1
  s_waitcnt vmcnt(24)
  v_mfma_f32_16x16x32_bf16 v[32:35], v[28:31], a[46:49], v[32:35]
  s_add_u32 s97, s36, 20480
  buffer_load_dwordx4 a[212:215], v1, s[12:15], s97 offen offset:2048 sc1
  s_waitcnt vmcnt(24)
  v_mfma_f32_16x16x32_bf16 v[36:39], v[28:31], a[50:53], v[36:39]
  s_add_u32 s97, s36, 24576
  buffer_load_dwordx4 a[216:219], v1, s[12:15], s97 offen offset:2048 sc1
  s_waitcnt vmcnt(24)
  v_mfma_f32_16x16x32_bf16 v[32:35], v[28:31], a[54:57], v[32:35]
  s_add_u32 s97, s36, 28672
  buffer_load_dwordx4 a[220:223], v1, s[12:15], s97 offen offset:2048 sc1
  s_waitcnt vmcnt(24)
  v_mfma_f32_16x16x32_bf16 v[36:39], v[28:31], a[58:61], v[36:39]
  v_mfma_f32_16x16x32_bf16 v[32:35], v[26:29], a[60:63], v[32:35]
  s_add_u32 s97, s36, 32768
  buffer_load_dwordx4 a[224:227], v1, s[12:15], s97 offen offset:2048 sc1
  s_waitcnt vmcnt(24)
  v_mfma_f32_16x16x32_bf16 v[40:43], v[22:25], a[64:67], 0
  s_add_u32 s97, s36, 36864
  buffer_load_dwordx4 a[228:231], v1, s[12:15], s97 offen offset:2048 sc1
  s_waitcnt vmcnt(24)
  v_mfma_f32_16x16x32_bf16 v[44:47], v[28:31], a[66:69], 0
  s_add_u32 s97, s36, 40960
  buffer_load_dwordx4 a[232:235], v1, s[12:15], s97 offen offset:2048 sc1
  s_waitcnt vmcnt(24)
  v_mfma_f32_16x16x32_bf16 v[40:43], v[28:31], a[70:73], v[40:43]
  s_add_u32 s97, s36, 45056
  buffer_load_dwordx4 a[236:239], v1, s[12:15], s97 offen offset:2048 sc1
  s_waitcnt vmcnt(24)
  v_mfma_f32_16x16x32_bf16 v[44:47], v[28:31], a[74:77], v[44:47]
  s_add_u32 s97, s36, 49152
  buffer_load_dwordx4 a[240:243], v1, s[12:15], s97 offen offset:2048 sc1
  s_waitcnt vmcnt(24)
  v_mfma_f32_16x16x32_bf16 v[40:43], v[28:31], a[78:81], v[40:43]
  s_add_u32 s97, s36, 53248
  buffer_load_dwordx4 a[244:247], v1, s[12:15], s97 offen offset:2048 sc1
  s_waitcnt vmcnt(24)
  v_mfma_f32_16x16x32_bf16 v[44:47], v[28:31], a[82:85], v[44:47]
  s_add_u32 s97, s36, 57344
  buffer_load_dwordx4 a[248:251], v1, s[12:15], s97 offen offset:2048 sc1
  s_waitcnt vmcnt(24)
  v_mfma_f32_16x16x32_bf16 v[40:43], v[28:31], a[86:89], v[40:43]
  s_add_u32 s97, s36, 61440
  buffer_load_dwordx4 a[252:255], v1, s[12:15], s97 offen offset:2048 sc1
  s_waitcnt vmcnt(24)
  v_mfma_f32_16x16x32_bf16 v[44:47], v[28:31], a[90:93], v[44:47]
  s_add_u32 s97, s36, 0
  buffer_load_dwordx4 a[0:3], v1, s[12:15], s97 offen offset:3072 sc1
  s_waitcnt vmcnt(24)
  v_mfma_f32_16x16x32_bf16 v[40:43], v[28:31], a[94:97], v[40:43]
  s_add_u32 s97, s36, 4096
  buffer_load_dwordx4 a[4:7], v1, s[12:15], s97 offen offset:3072 sc1
  s_waitcnt vmcnt(24)
  v_mfma_f32_16x16x32_bf16 v[44:47], v[28:31], a[98:101], v[44:47]
  s_add_u32 s97, s36, 8192
  buffer_load_dwordx4 a[8:11], v1, s[12:15], s97 offen offset:3072 sc1
  s_waitcnt vmcnt(24)
  v_mfma_f32_16x16x32_bf16 v[40:43], v[28:31], a[102:105], v[40:43]
  s_add_u32 s97, s36, 12288
  buffer_load_dwordx4 a[12:15], v1, s[12:15], s97 offen offset:3072 sc1
  s_waitcnt vmcnt(24)
  v_mfma_f32_16x16x32_bf16 v[44:47], v[28:31], a[106:109], v[44:47]
  s_add_u32 s97, s36, 16384
  buffer_load_dwordx4 a[16:19], v1, s[12:15], s97 offen offset:3072 sc1
  s_waitcnt vmcnt(24)
  v_mfma_f32_16x16x32_bf16 v[40:43], v[28:31], a[110:113], v[40:43]
  s_add_u32 s97, s36, 20480
  buffer_load_dwordx4 a[20:23], v1, s[12:15], s97 offen offset:3072 sc1
  s_waitcnt vmcnt(24)
  v_mfma_f32_16x16x32_bf16 v[44:47], v[28:31], a[114:117], v[44:47]
  s_add_u32 s97, s36, 24576
  buffer_load_dwordx4 a[24:27], v1, s[12:15], s97 offen offset:3072 sc1
  s_waitcnt vmcnt(24)
  v_mfma_f32_16x16x32_bf16 v[40:43], v[28:31], a[118:121], v[40:43]
  s_add_u32 s97, s36, 28672
  buffer_load_dwordx4 a[28:31], v1, s[12:15], s97 offen offset:3072 sc1
  s_waitcnt vmcnt(24)
  v_mfma_f32_16x16x32_bf16 v[44:47], v[28:31], a[122:125], v[44:47]
  v_mfma_f32_16x16x32_bf16 v[40:43], v[26:29], a[124:127], v[40:43]
  s_add_u32 s97, s36, 32768
  buffer_load_dwordx4 a[32:35], v1, s[12:15], s97 offen offset:3072 sc1
  s_waitcnt vmcnt(24)
  v_mfma_f32_16x16x32_bf16 v[48:51], v[22:25], a[192:195], 0
  s_add_u32 s97, s36, 36864
  buffer_load_dwordx4 a[36:39], v1, s[12:15], s97 offen offset:3072 sc1
  s_waitcnt vmcnt(24)
  v_mfma_f32_16x16x32_bf16 v[52:55], v[28:31], a[194:197], 0
  s_add_u32 s97, s36, 40960
  buffer_load_dwordx4 a[40:43], v1, s[12:15], s97 offen offset:3072 sc1
  s_waitcnt vmcnt(24)
  v_mfma_f32_16x16x32_bf16 v[48:51], v[28:31], a[198:201], v[48:51]
  s_add_u32 s97, s36, 45056
  buffer_load_dwordx4 a[44:47], v1, s[12:15], s97 offen offset:3072 sc1
  s_waitcnt vmcnt(24)
  v_mfma_f32_16x16x32_bf16 v[52:55], v[28:31], a[202:205], v[52:55]
  s_add_u32 s97, s36, 49152
  buffer_load_dwordx4 a[48:51], v1, s[12:15], s97 offen offset:3072 sc1
  s_waitcnt vmcnt(24)
  v_mfma_f32_16x16x32_bf16 v[48:51], v[28:31], a[206:209], v[48:51]
  s_add_u32 s97, s36, 53248
  buffer_load_dwordx4 a[52:55], v1, s[12:15], s97 offen offset:3072 sc1
  s_waitcnt vmcnt(24)
  v_mfma_f32_16x16x32_bf16 v[52:55], v[28:31], a[210:213], v[52:55]
  s_add_u32 s97, s36, 57344
  buffer_load_dwordx4 a[56:59], v1, s[12:15], s97 offen offset:3072 sc1
  s_waitcnt vmcnt(24)
  v_mfma_f32_16x16x32_bf16 v[48:51], v[28:31], a[214:217], v[48:51]
  s_add_u32 s97, s36, 61440
  buffer_load_dwordx4 a[60:63], v1, s[12:15], s97 offen offset:3072 sc1
  s_waitcnt vmcnt(24)
  v_mfma_f32_16x16x32_bf16 v[52:55], v[28:31], a[218:221], v[52:55]
  s_waitcnt vmcnt(23)
  v_mfma_f32_16x16x32_bf16 v[48:51], v[28:31], a[222:225], v[48:51]
  s_waitcnt vmcnt(22)
  v_mfma_f32_16x16x32_bf16 v[52:55], v[28:31], a[226:229], v[52:55]
  s_waitcnt vmcnt(21)
  v_mfma_f32_16x16x32_bf16 v[48:51], v[28:31], a[230:233], v[48:51]
  s_waitcnt vmcnt(20)
  v_mfma_f32_16x16x32_bf16 v[52:55], v[28:31], a[234:237], v[52:55]
  s_waitcnt vmcnt(19)
  v_mfma_f32_16x16x32_bf16 v[48:51], v[28:31], a[238:241], v[48:51]
  s_waitcnt vmcnt(18)
  v_mfma_f32_16x16x32_bf16 v[52:55], v[28:31], a[242:245], v[52:55]
  s_waitcnt vmcnt(17)
  v_mfma_f32_16x16x32_bf16 v[48:51], v[28:31], a[246:249], v[48:51]
  s_waitcnt vmcnt(16)
  v_mfma_f32_16x16x32_bf16 v[52:55], v[28:31], a[250:253], v[52:55]
  v_mfma_f32_16x16x32_bf16 v[48:51], v[26:29], a[252:255], v[48:51]
  s_waitcnt vmcnt(15)
  v_mfma_f32_16x16x32_bf16 v[56:59], v[22:25], a[0:3], 0
  s_waitcnt vmcnt(14)
  v_mfma_f32_16x16x32_bf16 v[60:63], v[28:31], a[2:5], 0
  s_waitcnt vmcnt(13)
  v_mfma_f32_16x16x32_bf16 v[56:59], v[28:31], a[6:9], v[56:59]
  s_waitcnt vmcnt(12)
  v_mfma_f32_16x16x32_bf16 v[60:63], v[28:31], a[10:13], v[60:63]
  s_waitcnt vmcnt(11)
  v_mfma_f32_16x16x32_bf16 v[56:59], v[28:31], a[14:17], v[56:59]
  s_waitcnt vmcnt(10)
  v_mfma_f32_16x16x32_bf16 v[60:63], v[28:31], a[18:21], v[60:63]
  s_waitcnt vmcnt(9)
  v_mfma_f32_16x16x32_bf16 v[56:59], v[28:31], a[22:25], v[56:59]
  s_waitcnt vmcnt(8)
  v_mfma_f32_16x16x32_bf16 v[60:63], v[28:31], a[26:29], v[60:63]
  s_waitcnt vmcnt(7)
  v_mfma_f32_16x16x32_bf16 v[56:59], v[28:31], a[30:33], v[56:59]
  s_waitcnt vmcnt(6)
  v_mfma_f32_16x16x32_bf16 v[60:63], v[28:31], a[34:37], v[60:63]
  s_waitcnt vmcnt(5)
  v_mfma_f32_16x16x32_bf16 v[56:59], v[28:31], a[38:41], v[56:59]
  s_waitcnt vmcnt(4)
  v_mfma_f32_16x16x32_bf16 v[60:63], v[28:31], a[42:45], v[60:63]
  s_waitcnt vmcnt(3)
  v_mfma_f32_16x16x32_bf16 v[56:59], v[28:31], a[46:49], v[56:59]
  s_waitcnt vmcnt(2)
  v_mfma_f32_16x16x32_bf16 v[60:63], v[28:31], a[50:53], v[60:63]
  s_waitcnt vmcnt(1)
  v_mfma_f32_16x16x32_bf16 v[56:59], v[28:31], a[54:57], v[56:59]
  s_waitcnt vmcnt(0)
  v_mfma_f32_16x16x32_bf16 v[60:63], v[28:31], a[58:61], v[60:63]
  v_mfma_f32_16x16x32_bf16 v[56:59], v[26:29], a[60:63], v[56:59]
  v_cvt_pk_bf16_f32 v32, 0, v32
  v_cvt_pk_bf16_f32 v33, 0, v33
  v_cvt_pk_bf16_f32 v34, 0, v34
  v_cvt_pk_bf16_f32 v35, 0, v35
  v_cvt_pk_bf16_f32 v36, 0, v36
  v_cvt_pk_bf16_f32 v37, 0, v37
  v_cvt_pk_bf16_f32 v38, 0, v38
  v_cvt_pk_bf16_f32 v39, 0, v39
  v_cvt_pk_bf16_f32 v40, 0, v40
  v_cvt_pk_bf16_f32 v41, 0, v41
  v_cvt_pk_bf16_f32 v42, 0, v42
  v_cvt_pk_bf16_f32 v43, 0, v43
  v_cvt_pk_bf16_f32 v44, 0, v44
  v_cvt_pk_bf16_f32 v45, 0, v45
  v_cvt_pk_bf16_f32 v46, 0, v46
  v_cvt_pk_bf16_f32 v47, 0, v47
  v_cvt_pk_bf16_f32 v48, 0, v48
  v_cvt_pk_bf16_f32 v49, 0, v49
  v_cvt_pk_bf16_f32 v50, 0, v50
  v_cvt_pk_bf16_f32 v51, 0, v51
  v_cvt_pk_bf16_f32 v52, 0, v52
  v_cvt_pk_bf16_f32 v53, 0, v53
  v_cvt_pk_bf16_f32 v54, 0, v54
  v_cvt_pk_bf16_f32 v55, 0, v55
  v_cvt_pk_bf16_f32 v56, 0, v56
  v_cvt_pk_bf16_f32 v57, 0, v57
  v_cvt_pk_bf16_f32 v58, 0, v58
  v_cvt_pk_bf16_f32 v59, 0, v59
  v_cvt_pk_bf16_f32 v60, 0, v60
  v_cvt_pk_bf16_f32 v61, 0, v61
  v_cvt_pk_bf16_f32 v62, 0, v62
  v_cvt_pk_bf16_f32 v63, 0, v63
  s_branch L_kf_kernel_opl2_98
L_kf_kernel_rare_186:
  s_mov_b32 s54, 9
  s_branch L_kf_kernel_rareb_45
L_kf_kernel_rare_188:
  s_mov_b32 s54, 6
  s_branch L_kf_kernel_rareb_48
L_kf_kernel_rare_190:
  s_mov_b32 s54, 10
  s_branch L_kf_kernel_rareb_45
L_kf_kernel_rare_192:
  s_mov_b32 s54, 7
  s_branch L_kf_kernel_rareb_48
L_kf_kernel_spin_196:
  s_mov_b32 s54, 0x4000
L_kf_kernel_spin2_198:
  s_sub_u32 s54, s54, 1
  s_cbranch_scc1 L_kf_kernel_spinr_197
  buffer_load_dwordx4 v[96:99], v14, s[12:15], s61 offen offset:16 sc1
  s_waitcnt vmcnt(0)
  v_and_b32 v96, v96, v97
  v_and_b32 v98, v98, v99
  v_and_b32 v96, v96, v98
  v_cmp_eq_u32 vcc, 0, v96
  s_nop 0
  s_and_b32 s97, vcc_lo, s17
  s_cbranch_scc1 L_kf_kernel_spin2_198
  s_branch L_kf_kernel_spinr_197
L_kf_kernel_rare_199:
  s_mov_b32 s54, 11
  s_branch L_kf_kernel_rareb_45
L_kf_kernel_rare_201:
  s_mov_b32 s54, 8
  s_branch L_kf_kernel_rareb_48
L_kf_kernel_rare_203:
  s_mov_b32 s54, 2
  s_branch L_kf_kernel_rareb_61
L_kf_kernel_rare_205:
  s_mov_b32 s54, 2
  s_branch L_kf_kernel_rareb_64
L_kf_kernel_rare_207:
  s_mov_b32 s54, 12
  s_branch L_kf_kernel_rareb_45
L_kf_kernel_rareb_45:
  s_cselect_b32 s55, 1, 0
  s_waitcnt vmcnt(0) lgkmcnt(0)
  s_nop 7
  s_nop 3
  v_max3_f32 v95, v36, v37, v38
  v_max3_f32 v95, v95, v39, v44
  v_max3_f32 v95, v95, v45, v46
  v_max_f32 v95, v95, v47
  v_mov_b32 v16, v95
  v_mov_b32 v17, v95
  s_nop 1
  v_permlane32_swap_b32 v16, v17
  v_max_f32 v95, v16, v17
  v_mov_b32 v16, v95
  v_mov_b32 v17, v95
  s_nop 1
  v_permlane16_swap_b32 v16, v17
  v_max_f32 v95, v16, v17
  v_max_f32 v95, 0, v95
  v_ceil_f32 v95, v95
  v_sub_f32 v16, 0, v95
  v_exp_f32 v16, v16
  v_add_f32 v91, v91, v95
  v_sub_f32 v36, v36, v95
  v_sub_f32 v37, v37, v95
  v_sub_f32 v38, v38, v95
  v_sub_f32 v39, v39, v95
  v_sub_f32 v44, v44, v95
  v_sub_f32 v45, v45, v95
  v_sub_f32 v46, v46, v95
  v_sub_f32 v47, v47, v95
  v_sub_f32 v52, v52, v95
  v_sub_f32 v53, v53, v95
  v_sub_f32 v54, v54, v95
  v_sub_f32 v55, v55, v95
  v_sub_f32 v60, v60, v95
  v_sub_f32 v61, v61, v95
  v_sub_f32 v62, v62, v95
  v_sub_f32 v63, v63, v95
  v_mul_f32 v89, v89, v16
  v_mul_f32 v192, v192, v16
  v_mul_f32 v193, v193, v16
  v_mul_f32 v194, v194, v16
  v_mul_f32 v195, v195, v16
  v_mul_f32 v196, v196, v16
  v_mul_f32 v197, v197, v16
  v_mul_f32 v198, v198, v16
  v_mul_f32 v199, v199, v16
  v_mul_f32 v200, v200, v16
  v_mul_f32 v201, v201, v16
  v_mul_f32 v202, v202, v16
  v_mul_f32 v203, v203, v16
  v_mul_f32 v204, v204, v16
  v_mul_f32 v205, v205, v16
  v_mul_f32 v206, v206, v16
  v_mul_f32 v207, v207, v16
  v_mul_f32 v208, v208, v16
  v_mul_f32 v209, v209, v16
  v_mul_f32 v210, v210, v16
  v_mul_f32 v211, v211, v16
  v_mul_f32 v212, v212, v16
  v_mul_f32 v213, v213, v16
  v_mul_f32 v214, v214, v16
  v_mul_f32 v215, v215, v16
  v_mul_f32 v216, v216, v16
  v_mul_f32 v217, v217, v16
  v_mul_f32 v218, v218, v16
  v_mul_f32 v219, v219, v16
  v_mul_f32 v220, v220, v16
  v_mul_f32 v221, v221, v16
  v_mul_f32 v222, v222, v16
  v_mul_f32 v223, v223, v16
  v_mul_f32 v224, v224, v16
  v_mul_f32 v225, v225, v16
  v_mul_f32 v226, v226, v16
  v_mul_f32 v227, v227, v16
  v_mul_f32 v228, v228, v16
  v_mul_f32 v229, v229, v16
  v_mul_f32 v230, v230, v16
  v_mul_f32 v231, v231, v16
  v_mul_f32 v232, v232, v16
  v_mul_f32 v233, v233, v16
  v_mul_f32 v234, v234, v16
  v_mul_f32 v235, v235, v16
  v_mul_f32 v236, v236, v16
  v_mul_f32 v237, v237, v16
  v_mul_f32 v238, v238, v16
  v_mul_f32 v239, v239, v16
  v_mul_f32 v240, v240, v16
  v_mul_f32 v241, v241, v16
  v_mul_f32 v242, v242, v16
  v_mul_f32 v243, v243, v16
  v_mul_f32 v244, v244, v16
  v_mul_f32 v245, v245, v16
  v_mul_f32 v246, v246, v16
  v_mul_f32 v247, v247, v16
  v_mul_f32 v248, v248, v16
  v_mul_f32 v249, v249, v16
  v_mul_f32 v250, v250, v16
  v_mul_f32 v251, v251, v16
  v_mul_f32 v252, v252, v16
  v_mul_f32 v253, v253, v16
  v_mul_f32 v254, v254, v16
  v_mul_f32 v255, v255, v16
  v_exp_f32 v80, v36
  v_exp_f32 v81, v37
  v_exp_f32 v82, v38
  v_exp_f32 v83, v39
  v_exp_f32 v84, v44
  v_exp_f32 v85, v45
  v_exp_f32 v86, v46
  v_exp_f32 v87, v47
  v_cvt_pk_bf16_f32 v68, v80, v81
  v_cvt_pk_bf16_f32 v69, v82, v83
  v_cvt_pk_bf16_f32 v70, v84, v85
  v_cvt_pk_bf16_f32 v71, v86, v87
  v_add_f32 v93, v80, v81
  v_add_f32 v93, v93, v82
  v_add_f32 v93, v93, v83
  v_add_f32 v93, v93, v84
  v_add_f32 v93, v93, v85
  v_add_f32 v93, v93, v86
  v_add_f32 v93, v93, v87
  s_cmp_lg_u32 s54, 0
  s_cbranch_scc1 L_kf_kernel_rx_211
  s_cmp_lg_u32 s55, 0
  s_branch L_kf_kernel_rarer_47
L_kf_kernel_rx_211:
  s_cmp_lg_u32 s54, 1
  s_cbranch_scc1 L_kf_kernel_rx_212
  s_cmp_lg_u32 s55, 0
  s_branch L_kf_kernel_rarer_54
L_kf_kernel_rx_212:
  s_cmp_lg_u32 s54, 2
  s_cbranch_scc1 L_kf_kernel_rx_213
  s_cmp_lg_u32 s55, 0
  s_branch L_kf_kernel_rarer_58
L_kf_kernel_rx_213:
  s_cmp_lg_u32 s54, 3
  s_cbranch_scc1 L_kf_kernel_rx_214
  s_cmp_lg_u32 s55, 0
  s_branch L_kf_kernel_rarer_68
L_kf_kernel_rx_214:
  s_cmp_lg_u32 s54, 4
  s_cbranch_scc1 L_kf_kernel_rx_215
  s_cmp_lg_u32 s55, 0
  s_branch L_kf_kernel_rarer_74
L_kf_kernel_rx_215:
  s_cmp_lg_u32 s54, 5
  s_cbranch_scc1 L_kf_kernel_rx_216
  s_cmp_lg_u32 s55, 0
  s_branch L_kf_kernel_rarer_78
L_kf_kernel_rx_216:
  s_cmp_lg_u32 s54, 6
  s_cbranch_scc1 L_kf_kernel_rx_217
  s_cmp_lg_u32 s55, 0
  s_branch L_kf_kernel_rarer_86
L_kf_kernel_rx_217:
  s_cmp_lg_u32 s54, 7
  s_cbranch_scc1 L_kf_kernel_rx_218
  s_cmp_lg_u32 s55, 0
  s_branch L_kf_kernel_rarer_92
L_kf_kernel_rx_218:
  s_cmp_lg_u32 s54, 8
  s_cbranch_scc1 L_kf_kernel_rx_219
  s_cmp_lg_u32 s55, 0
  s_branch L_kf_kernel_rarer_96
L_kf_kernel_rx_219:
  s_cmp_lg_u32 s54, 9
  s_cbranch_scc1 L_kf_kernel_rx_220
  s_cmp_lg_u32 s55, 0
  s_branch L_kf_kernel_rarer_187
L_kf_kernel_rx_220:
  s_cmp_lg_u32 s54, 10
  s_cbranch_scc1 L_kf_kernel_rx_221
  s_cmp_lg_u32 s55, 0
  s_branch L_kf_kernel_rarer_191
L_kf_kernel_rx_221:
  s_cmp_lg_u32 s54, 11
  s_cbranch_scc1 L_kf_kernel_rx_222
  s_cmp_lg_u32 s55, 0
  s_branch L_kf_kernel_rarer_200
L_kf_kernel_rx_222:
  s_cmp_lg_u32 s55, 0
  s_branch L_kf_kernel_rarer_208
L_kf_kernel_rareb_48:
  s_cselect_b32 s55, 1, 0
  s_waitcnt vmcnt(0) lgkmcnt(0)
  s_nop 7
  s_nop 3
  v_max3_f32 v94, v32, v33, v34
  v_max3_f32 v94, v94, v35, v40
  v_max3_f32 v94, v94, v41, v42
  v_max_f32 v94, v94, v43
  v_mov_b32 v16, v94
  v_mov_b32 v17, v94
  s_nop 1
  v_permlane32_swap_b32 v16, v17
  v_max_f32 v94, v16, v17
  v_mov_b32 v16, v94
  v_mov_b32 v17, v94
  s_nop 1
  v_permlane16_swap_b32 v16, v17
  v_max_f32 v94, v16, v17
  v_max_f32 v94, 0, v94
  v_ceil_f32 v94, v94
  v_sub_f32 v16, 0, v94
  v_exp_f32 v16, v16
  v_add_f32 v90, v90, v94
  v_sub_f32 v32, v32, v94
  v_sub_f32 v33, v33, v94
  v_sub_f32 v34, v34, v94
  v_sub_f32 v35, v35, v94
  v_sub_f32 v40, v40, v94
  v_sub_f32 v41, v41, v94
  v_sub_f32 v42, v42, v94
  v_sub_f32 v43, v43, v94
  v_sub_f32 v48, v48, v94
  v_sub_f32 v49, v49, v94
  v_sub_f32 v50, v50, v94
  v_sub_f32 v51, v51, v94
  v_sub_f32 v56, v56, v94
  v_sub_f32 v57, v57, v94
  v_sub_f32 v58, v58, v94
  v_sub_f32 v59, v59, v94
  v_mul_f32 v88, v88, v16
  v_mul_f32 v128, v128, v16
  v_mul_f32 v129, v129, v16
  v_mul_f32 v130, v130, v16
  v_mul_f32 v131, v131, v16
  v_mul_f32 v132, v132, v16
  v_mul_f32 v133, v133, v16
  v_mul_f32 v134, v134, v16
  v_mul_f32 v135, v135, v16
  v_mul_f32 v136, v136, v16
  v_mul_f32 v137, v137, v16
  v_mul_f32 v138, v138, v16
  v_mul_f32 v139, v139, v16
  v_mul_f32 v140, v140, v16
  v_mul_f32 v141, v141, v16
  v_mul_f32 v142, v142, v16
  v_mul_f32 v143, v143, v16
  v_mul_f32 v144, v144, v16
  v_mul_f32 v145, v145, v16
  v_mul_f32 v146, v146, v16
  v_mul_f32 v147, v147, v16
  v_mul_f32 v148, v148, v16
  v_mul_f32 v149, v149, v16
  v_mul_f32 v150, v150, v16
  v_mul_f32 v151, v151, v16
  v_mul_f32 v152, v152, v16
  v_mul_f32 v153, v153, v16
  v_mul_f32 v154, v154, v16
  v_mul_f32 v155, v155, v16
  v_mul_f32 v156, v156, v16
  v_mul_f32 v157, v157, v16
  v_mul_f32 v158, v158, v16
  v_mul_f32 v159, v159, v16
  v_mul_f32 v160, v160, v16
  v_mul_f32 v161, v161, v16
  v_mul_f32 v162, v162, v16
  v_mul_f32 v163, v163, v16
  v_mul_f32 v164, v164, v16
  v_mul_f32 v165, v165, v16
  v_mul_f32 v166, v166, v16
  v_mul_f32 v167, v167, v16
  v_mul_f32 v168, v168, v16
  v_mul_f32 v169, v169, v16
  v_mul_f32 v170, v170, v16
  v_mul_f32 v171, v171, v16
  v_mul_f32 v172, v172, v16
  v_mul_f32 v173, v173, v16
  v_mul_f32 v174, v174, v16
  v_mul_f32 v175, v175, v16
  v_mul_f32 v176, v176, v16
  v_mul_f32 v177, v177, v16
  v_mul_f32 v178, v178, v16
  v_mul_f32 v179, v179, v16
  v_mul_f32 v180, v180, v16
  v_mul_f32 v181, v181, v16
  v_mul_f32 v182, v182, v16
  v_mul_f32 v183, v183, v16
  v_mul_f32 v184, v184, v16
  v_mul_f32 v185, v185, v16
  v_mul_f32 v186, v186, v16
  v_mul_f32 v187, v187, v16
  v_mul_f32 v188, v188, v16
  v_mul_f32 v189, v189, v16
  v_mul_f32 v190, v190, v16
  v_mul_f32 v191, v191, v16
  v_exp_f32 v72, v32
  v_exp_f32 v73, v33
  v_exp_f32 v74, v34
  v_exp_f32 v75, v35
  v_exp_f32 v76, v40
  v_exp_f32 v77, v41
  v_exp_f32 v78, v42
  v_exp_f32 v79, v43
  v_cvt_pk_bf16_f32 v64, v72, v73
  v_cvt_pk_bf16_f32 v65, v74, v75
  v_cvt_pk_bf16_f32 v66, v76, v77
  v_cvt_pk_bf16_f32 v67, v78, v79
  v_add_f32 v92, v72, v73
  v_add_f32 v92, v92, v74
  v_add_f32 v92, v92, v75
  v_add_f32 v92, v92, v76
  v_add_f32 v92, v92, v77
  v_add_f32 v92, v92, v78
  v_add_f32 v92, v92, v79
  s_cmp_lg_u32 s54, 0
  s_cbranch_scc1 L_kf_kernel_rx_224
  s_cmp_lg_u32 s55, 0
  s_branch L_kf_kernel_rarer_50
L_kf_kernel_rx_224:
  s_cmp_lg_u32 s54, 1
  s_cbranch_scc1 L_kf_kernel_rx_225
  s_cmp_lg_u32 s55, 0
  s_branch L_kf_kernel_rarer_56
L_kf_kernel_rx_225:
  s_cmp_lg_u32 s54, 2
  s_cbranch_scc1 L_kf_kernel_rx_226
  s_cmp_lg_u32 s55, 0
  s_branch L_kf_kernel_rarer_60
L_kf_kernel_rx_226:
  s_cmp_lg_u32 s54, 3
  s_cbranch_scc1 L_kf_kernel_rx_227
  s_cmp_lg_u32 s55, 0
  s_branch L_kf_kernel_rarer_76
L_kf_kernel_rx_227:
  s_cmp_lg_u32 s54, 4
  s_cbranch_scc1 L_kf_kernel_rx_228
  s_cmp_lg_u32 s55, 0
  s_branch L_kf_kernel_rarer_80
L_kf_kernel_rx_228:
  s_cmp_lg_u32 s54, 5
  s_cbranch_scc1 L_kf_kernel_rx_229
  s_cmp_lg_u32 s55, 0
  s_branch L_kf_kernel_rarer_94
L_kf_kernel_rx_229:
  s_cmp_lg_u32 s54, 6
  s_cbranch_scc1 L_kf_kernel_rx_230
  s_cmp_lg_u32 s55, 0
  s_branch L_kf_kernel_rarer_189
L_kf_kernel_rx_230:
  s_cmp_lg_u32 s54, 7
  s_cbranch_scc1 L_kf_kernel_rx_231
  s_cmp_lg_u32 s55, 0
  s_branch L_kf_kernel_rarer_193
L_kf_kernel_rx_231:
  s_cmp_lg_u32 s55, 0
  s_branch L_kf_kernel_rarer_202
L_kf_kernel_rareb_61:
  s_cselect_b32 s55, 1, 0
  s_waitcnt vmcnt(0) lgkmcnt(0)
  s_nop 7
  s_nop 3
  v_max3_f32 v95, v36, v37, v38
  v_max3_f32 v95, v95, v39, v44
  v_max3_f32 v95, v95, v45, v46
  v_max_f32 v95, v95, v47
  v_mov_b32 v16, v95
  v_mov_b32 v17, v95
  s_nop 1
  v_permlane32_swap_b32 v16, v17
  v_max_f32 v95, v16, v17
  v_mov_b32 v16, v95
  v_mov_b32 v17, v95
  s_nop 1
  v_permlane16_swap_b32 v16, v17
  v_max_f32 v95, v16, v17
  v_max_f32 v95, 0, v95
  v_ceil_f32 v95, v95
  v_sub_f32 v16, 0, v95
  v_exp_f32 v16, v16
  v_add_f32 v91, v91, v95
  v_sub_f32 v32, v32, v95
  v_sub_f32 v33, v33, v95
  v_sub_f32 v34, v34, v95
  v_sub_f32 v35, v35, v95
  v_sub_f32 v40, v40, v95
  v_sub_f32 v41, v41, v95
  v_sub_f32 v42, v42, v95
  v_sub_f32 v43, v43, v95
  v_sub_f32 v48, v48, v95
  v_sub_f32 v49, v49, v95
  v_sub_f32 v50, v50, v95
  v_sub_f32 v51, v51, v95
  v_sub_f32 v56, v56, v95
  v_sub_f32 v57, v57, v95
  v_sub_f32 v58, v58, v95
  v_sub_f32 v59, v59, v95
  v_sub_f32 v36, v36, v95
  v_sub_f32 v37, v37, v95
  v_sub_f32 v38, v38, v95
  v_sub_f32 v39, v39, v95
  v_sub_f32 v44, v44, v95
  v_sub_f32 v45, v45, v95
  v_sub_f32 v46, v46, v95
  v_sub_f32 v47, v47, v95
  v_sub_f32 v52, v52, v95
  v_sub_f32 v53, v53, v95
  v_sub_f32 v54, v54, v95
  v_sub_f32 v55, v55, v95
  v_sub_f32 v60, v60, v95
  v_sub_f32 v61, v61, v95
  v_sub_f32 v62, v62, v95
  v_sub_f32 v63, v63, v95
  v_mul_f32 v89, v89, v16
  v_mul_f32 v192, v192, v16
  v_mul_f32 v193, v193, v16
  v_mul_f32 v194, v194, v16
  v_mul_f32 v195, v195, v16
  v_mul_f32 v196, v196, v16
  v_mul_f32 v197, v197, v16
  v_mul_f32 v198, v198, v16
  v_mul_f32 v199, v199, v16
  v_mul_f32 v200, v200, v16
  v_mul_f32 v201, v201, v16
  v_mul_f32 v202, v202, v16
  v_mul_f32 v203, v203, v16
  v_mul_f32 v204, v204, v16
  v_mul_f32 v205, v205, v16
  v_mul_f32 v206, v206, v16
  v_mul_f32 v207, v207, v16
  v_mul_f32 v208, v208, v16
  v_mul_f32 v209, v209, v16
  v_mul_f32 v210, v210, v16
  v_mul_f32 v211, v211, v16
  v_mul_f32 v212, v212, v16
  v_mul_f32 v213, v213, v16
  v_mul_f32 v214, v214, v16
  v_mul_f32 v215, v215, v16
  v_mul_f32 v216, v216, v16
  v_mul_f32 v217, v217, v16
  v_mul_f32 v218, v218, v16
  v_mul_f32 v219, v219, v16
  v_mul_f32 v220, v220, v16
  v_mul_f32 v221, v221, v16
  v_mul_f32 v222, v222, v16
  v_mul_f32 v223, v223, v16
  v_mul_f32 v224, v224, v16
  v_mul_f32 v225, v225, v16
  v_mul_f32 v226, v226, v16
  v_mul_f32 v227, v227, v16
  v_mul_f32 v228, v228, v16
  v_mul_f32 v229, v229, v16
  v_mul_f32 v230, v230, v16
  v_mul_f32 v231, v231, v16
  v_mul_f32 v232, v232, v16
  v_mul_f32 v233, v233, v16
  v_mul_f32 v234, v234, v16
  v_mul_f32 v235, v235, v16
  v_mul_f32 v236, v236, v16
  v_mul_f32 v237, v237, v16
  v_mul_f32 v238, v238, v16
  v_mul_f32 v239, v239, v16
  v_mul_f32 v240, v240, v16
  v_mul_f32 v241, v241, v16
  v_mul_f32 v242, v242, v16
  v_mul_f32 v243, v243, v16
  v_mul_f32 v244, v244, v16
  v_mul_f32 v245, v245, v16
  v_mul_f32 v246, v246, v16
  v_mul_f32 v247, v247, v16
  v_mul_f32 v248, v248, v16
  v_mul_f32 v249, v249, v16
  v_mul_f32 v250, v250, v16
  v_mul_f32 v251, v251, v16
  v_mul_f32 v252, v252, v16
  v_mul_f32 v253, v253, v16
  v_mul_f32 v254, v254, v16
  v_mul_f32 v255, v255, v16
  v_exp_f32 v80, v36
  v_exp_f32 v81, v37
  v_exp_f32 v82, v38
  v_exp_f32 v83, v39
  v_exp_f32 v84, v44
  v_exp_f32 v85, v45
  v_exp_f32 v86, v46
  v_exp_f32 v87, v47
  v_cvt_pk_bf16_f32 v68, v80, v81
  v_cvt_pk_bf16_f32 v69, v82, v83
  v_cvt_pk_bf16_f32 v70, v84, v85
  v_cvt_pk_bf16_f32 v71, v86, v87
  v_add_f32 v93, v80, v81
  v_add_f32 v93, v93, v82
  v_add_f32 v93, v93, v83
  v_add_f32 v93, v93, v84
  v_add_f32 v93, v93, v85
  v_add_f32 v93, v93, v86
  v_add_f32 v93, v93, v87
  s_cmp_lg_u32 s54, 0
  s_cbranch_scc1 L_kf_kernel_rx_233
  s_cmp_lg_u32 s55, 0
  s_branch L_kf_kernel_rarer_63
L_kf_kernel_rx_233:
  s_cmp_lg_u32 s54, 1
  s_cbranch_scc1 L_kf_kernel_rx_234
  s_cmp_lg_u32 s55, 0
  s_branch L_kf_kernel_rarer_82
L_kf_kernel_rx_234:
  s_cmp_lg_u32 s55, 0
  s_branch L_kf_kernel_rarer_204
L_kf_kernel_rareb_64:
  s_cselect_b32 s55, 1, 0
  s_waitcnt vmcnt(0) lgkmcnt(0)
  s_nop 7
  s_nop 3
  v_max3_f32 v94, v32, v33, v34
  v_max3_f32 v94, v94, v35, v40
  v_max3_f32 v94, v94, v41, v42
  v_max_f32 v94, v94, v43
  v_mov_b32 v16, v94
  v_mov_b32 v17, v94
  s_nop 1
  v_permlane32_swap_b32 v16, v17
  v_max_f32 v94, v16, v17
  v_mov_b32 v16, v94
  v_mov_b32 v17, v94
  s_nop 1
  v_permlane16_swap_b32 v16, v17
  v_max_f32 v94, v16, v17
  v_max_f32 v94, 0, v94
  v_ceil_f32 v94, v94
  v_sub_f32 v16, 0, v94
  v_exp_f32 v16, v16
  v_add_f32 v91, v91, v94
  v_sub_f32 v32, v32, v94
  v_sub_f32 v33, v33, v94
  v_sub_f32 v34, v34, v94
  v_sub_f32 v35, v35, v94
  v_sub_f32 v40, v40, v94
  v_sub_f32 v41, v41, v94
  v_sub_f32 v42, v42, v94
  v_sub_f32 v43, v43, v94
  v_sub_f32 v48, v48, v94
  v_sub_f32 v49, v49, v94
  v_sub_f32 v50, v50, v94
  v_sub_f32 v51, v51, v94
  v_sub_f32 v56, v56, v94
  v_sub_f32 v57, v57, v94
  v_sub_f32 v58, v58, v94
  v_sub_f32 v59, v59, v94
  v_sub_f32 v36, v36, v94
  v_sub_f32 v37, v37, v94
  v_sub_f32 v38, v38, v94
  v_sub_f32 v39, v39, v94
  v_sub_f32 v44, v44, v94
  v_sub_f32 v45, v45, v94
  v_sub_f32 v46, v46, v94
  v_sub_f32 v47, v47, v94
  v_sub_f32 v52, v52, v94
  v_sub_f32 v53, v53, v94
  v_sub_f32 v54, v54, v94
  v_sub_f32 v55, v55, v94
  v_sub_f32 v60, v60, v94
  v_sub_f32 v61, v61, v94
  v_sub_f32 v62, v62, v94
  v_sub_f32 v63, v63, v94
  v_mul_f32 v89, v89, v16
  v_mul_f32 v192, v192, v16
  v_mul_f32 v193, v193, v16
  v_mul_f32 v194, v194, v16
  v_mul_f32 v195, v195, v16
  v_mul_f32 v196, v196, v16
  v_mul_f32 v197, v197, v16
  v_mul_f32 v198, v198, v16
  v_mul_f32 v199, v199, v16
  v_mul_f32 v200, v200, v16
  v_mul_f32 v201, v201, v16
  v_mul_f32 v202, v202, v16
  v_mul_f32 v203, v203, v16
  v_mul_f32 v204, v204, v16
  v_mul_f32 v205, v205, v16
  v_mul_f32 v206, v206, v16
  v_mul_f32 v207, v207, v16
  v_mul_f32 v208, v208, v16
  v_mul_f32 v209, v209, v16
  v_mul_f32 v210, v210, v16
  v_mul_f32 v211, v211, v16
  v_mul_f32 v212, v212, v16
  v_mul_f32 v213, v213, v16
  v_mul_f32 v214, v214, v16
  v_mul_f32 v215, v215, v16
  v_mul_f32 v216, v216, v16
  v_mul_f32 v217, v217, v16
  v_mul_f32 v218, v218, v16
  v_mul_f32 v219, v219, v16
  v_mul_f32 v220, v220, v16
  v_mul_f32 v221, v221, v16
  v_mul_f32 v222, v222, v16
  v_mul_f32 v223, v223, v16
  v_mul_f32 v224, v224, v16
  v_mul_f32 v225, v225, v16
  v_mul_f32 v226, v226, v16
  v_mul_f32 v227, v227, v16
  v_mul_f32 v228, v228, v16
  v_mul_f32 v229, v229, v16
  v_mul_f32 v230, v230, v16
  v_mul_f32 v231, v231, v16
  v_mul_f32 v232, v232, v16
  v_mul_f32 v233, v233, v16
  v_mul_f32 v234, v234, v16
  v_mul_f32 v235, v235, v16
  v_mul_f32 v236, v236, v16
  v_mul_f32 v237, v237, v16
  v_mul_f32 v238, v238, v16
  v_mul_f32 v239, v239, v16
  v_mul_f32 v240, v240, v16
  v_mul_f32 v241, v241, v16
  v_mul_f32 v242, v242, v16
  v_mul_f32 v243, v243, v16
  v_mul_f32 v244, v244, v16
  v_mul_f32 v245, v245, v16
  v_mul_f32 v246, v246, v16
  v_mul_f32 v247, v247, v16
  v_mul_f32 v248, v248, v16
  v_mul_f32 v249, v249, v16
  v_mul_f32 v250, v250, v16
  v_mul_f32 v251, v251, v16
  v_mul_f32 v252, v252, v16
  v_mul_f32 v253, v253, v16
  v_mul_f32 v254, v254, v16
  v_mul_f32 v255, v255, v16
  v_exp_f32 v72, v32
  v_exp_f32 v73, v33
  v_exp_f32 v74, v34
  v_exp_f32 v75, v35
  v_exp_f32 v76, v40
  v_exp_f32 v77, v41
  v_exp_f32 v78, v42
  v_exp_f32 v79, v43
  v_cvt_pk_bf16_f32 v64, v72, v73
  v_cvt_pk_bf16_f32 v65, v74, v75
  v_cvt_pk_bf16_f32 v66, v76, v77
  v_cvt_pk_bf16_f32 v67, v78, v79
  v_add_f32 v92, v72, v73
  v_add_f32 v92, v92, v74
  v_add_f32 v92, v92, v75
  v_add_f32 v92, v92, v76
  v_add_f32 v92, v92, v77
  v_add_f32 v92, v92, v78
  v_add_f32 v92, v92, v79
  s_cmp_lg_u32 s54, 0
  s_cbranch_scc1 L_kf_kernel_rx_236
  s_cmp_lg_u32 s55, 0
  s_branch L_kf_kernel_rarer_66
L_kf_kernel_rx_236:
  s_cmp_lg_u32 s54, 1
  s_cbranch_scc1 L_kf_kernel_rx_237
  s_cmp_lg_u32 s55, 0
  s_branch L_kf_kernel_rarer_84
L_kf_kernel_rx_237:
  s_cmp_lg_u32 s55, 0
  s_branch L_kf_kernel_rarer_206
.p2align 6
.type kf_kernel_tab,@object
kf_kernel_tab:
.long 262144, 1039, 20, 0
.long 262144, 1039, 20, 0
.long 262144, 1039, 20, 0
.long 262144, 1039, 20, 0
.long 262144, 1039, 20, 0
.long 262144, 1039, 20, 0
.long 262144, 1039, 20, 0
.long 262144, 1039, 20, 0
.long 262144, 1039, 20, 0
.long 262144, 1039, 20, 0
.long 262144, 1039, 20, 0
.long 262144, 1039, 20, 0
.long 262144, 1039, 20, 0
.long 262144, 1039, 20, 0
.long 262144, 1039, 20, 0
.long 262144, 1039, 20, 0
.long 524289, 1038, 17, 1
.long 524289, 1038, 17, 1
.long 524289, 1038, 17, 1
.long 524289, 1038, 17, 1
.long 524289, 1038, 17, 1
.long 524289, 1038, 17, 1
.long 524289, 1038, 17, 1
.long 524289, 1038, 17, 1
.long 524289, 1038, 17, 1
.long 524289, 1038, 17, 1
.long 524289, 1038, 17, 1
.long 524289, 1038, 17, 1
.long 524289, 1038, 17, 1
.long 524289, 1038, 17, 1
.long 524289, 1038, 17, 1
.long 524289, 1038, 17, 1
.long 786434, 1037, 13, 2
.long 786434, 1037, 13, 2
.long 786434, 1037, 13, 2
.long 786434, 1037, 13, 2
.long 786434, 1037, 13, 2
.long 786434, 1037, 13, 2
.long 786434, 1037, 13, 2
.long 786434, 1037, 13, 2
.long 786434, 1037, 13, 2
.long 786434, 1037, 13, 2
.long 786434, 1037, 13, 2
.long 786434, 1037, 13, 2
.long 786434, 1037, 13, 2
.long 786434, 1037, 13, 2
.long 786434, 1037, 13, 2
.long 786434, 1037, 13, 2
.long 1048579, 1036, 9, 3
.long 1048579, 1036, 9, 3
.long 1048579, 1036, 9, 3
.long 1048579, 1036, 9, 3
.long 1048579, 1036, 9, 3
.long 1048579, 1036, 9, 3
.long 1048579, 1036, 9, 3
.long 1048579, 1036, 9, 3
.long 1048579, 1036, 9, 3
.long 1048579, 1036, 9, 3
.long 1048579, 1036, 9, 3
.long 1048579, 1036, 9, 3
.long 1048579, 1036, 9, 3
.long 1048579, 1036, 9, 3
.long 1048579, 1036, 9, 3
.long 1048579, 1036, 9, 3
.long 1310724, 1035, 5, 4
.long 1310724, 1035, 5, 4
.long 1310724, 1035, 5, 4
.long 1310724, 1035, 5, 4
.long 1310724, 1035, 5, 4
.long 1310724, 1035, 5, 4
.long 1310724, 1035, 5, 4
.long 1310724, 1035, 5, 4
.long 1310724, 1035, 5, 4
.long 1310724, 1035, 5, 4
.long 1310724, 1035, 5, 4
.long 1310724, 1035, 5, 4
.long 1310724, 1035, 5, 4
.long 1310724, 1035, 5, 4
.long 1310724, 1035, 5, 4
.long 1310724, 1035, 5, 4
.long 1572869, 1024, 0, 5
.long 1572869, 1024, 0, 5
.long 1572869, 1024, 0, 5
.long 1572869, 1024, 0, 5
.long 1572869, 1024, 0, 5
.long 1572869, 1024, 0, 5
.long 1572869, 1024, 0, 5
.long 1572869, 1024, 0, 5
.long 1572869, 1024, 0, 5
.long 1572869, 1024, 0, 5
.long 1572869, 1024, 0, 5
.long 1572869, 1024, 0, 5
.long 1572869, 1024, 0, 5
.long 1572869, 1024, 0, 5
.long 1572869, 1024, 0, 5
.long 1572869, 1024, 0, 5
.long 1835014, 1024, 0, 6
.long 1835014, 1024, 0, 6
.long 1835014, 1024, 0, 6
.long 1835014, 1024, 0, 6
.long 1835014, 1024, 0, 6
.long 1835014, 1024, 0, 6
.long 1835014, 1024, 0, 6
.long 1835014, 1024, 0, 6
.long 1835014, 1024, 0, 6
.long 1835014, 1024, 0, 6
.long 1835014, 1024, 0, 6
.long 1835014, 1024, 0, 6
.long 1835014, 1024, 0, 6
.long 1835014, 1024, 0, 6
.long 1835014, 1024, 0, 6
.long 1835014, 1024, 0, 6
.long 2097159, 6912, 0, 255
.long 2097159, 6912, 0, 255
.long 2097159, 6912, 0, 255
.long 2097159, 6912, 0, 255
.long 2097159, 6912, 0, 255
.long 2097159, 6912, 0, 255
.long 2097159, 6912, 0, 255
.long 2097159, 6912, 0, 255
.long 2097159, 6912, 0, 255
.long 2097159, 6912, 0, 255
.long 2097159, 6912, 0, 255
.long 2097159, 6912, 0, 255
.long 2097159, 6912, 0, 255
.long 2097159, 6912, 0, 255
.long 2097159, 6912, 0, 255
.long 2097159, 6912, 0, 255
.long 2359304, 7936, 0, 255
.long 2359304, 7936, 0, 255
.long 2359304, 7936, 0, 255
.long 2359304, 7936, 0, 255
.long 2359304, 7936, 0, 255
.long 2359304, 7936, 0, 255
.long 2359304, 7936, 0, 255
.long 2359304, 7936, 0, 255
.long 2359304, 7936, 0, 255
.long 2359304, 7936, 0, 255
.long 2359304, 7936, 0, 255
.long 2359304, 7936, 0, 255
.long 2359304, 7936, 0, 255
.long 2359304, 7936, 0, 255
.long 2359304, 7936, 0, 255
.long 2359304, 7936, 0, 255
.long 2621449, 8960, 0, 255
.long 2621449, 8960, 0, 255
.long 2621449, 8960, 0, 255
.long 2621449, 8960, 0, 255
.long 2621449, 8960, 0, 255
.long 2621449, 8960, 0, 255
.long 2621449, 8960, 0, 255
.long 2621449, 8960, 0, 255
.long 2621449, 8960, 0, 255
.long 2621449, 8960, 0, 255
.long 2621449, 8960, 0, 255
.long 2621449, 8960, 0, 255
.long 2621449, 8960, 0, 255
.long 2621449, 8960, 0, 255
.long 2621449, 8960, 0, 255
.long 2621449, 8960, 0, 255
.long 2883594, 9984, 0, 255
.long 2883594, 9984, 0, 255
.long 2883594, 9984, 0, 255
.long 2883594, 9984, 0, 255
.long 2883594, 9984, 0, 255
.long 2883594, 9984, 0, 255
.long 2883594, 9984, 0, 255
.long 2883594, 9984, 0, 255
.long 2883594, 9984, 0, 255
.long 2883594, 9984, 0, 255
.long 2883594, 9984, 0, 255
.long 2883594, 9984, 0, 255
.long 2883594, 9984, 0, 255
.long 2883594, 9984, 0, 255
.long 2883594, 9984, 0, 255
.long 2883594, 9984, 0, 255
.long 2819339, 9728, 0, 255
.long 2819339, 9728, 0, 255
.long 2819339, 9728, 0, 255
.long 2819339, 9728, 0, 255
.long 2819339, 9728, 0, 255
.long 2819339, 9728, 0, 255
.long 2819339, 9728, 0, 255
.long 2819339, 9728, 0, 255
.long 2819339, 9728, 0, 255
.long 2819339, 9728, 0, 255
.long 2819339, 9728, 0, 255
.long 2819339, 9728, 0, 255
.long 2819339, 9728, 0, 255
.long 2819339, 9728, 0, 255
.long 2819339, 9728, 0, 255
.long 2819339, 9728, 0, 255
.long 2820364, 9728, 0, 255
.long 2820364, 9728, 0, 255
.long 2820364, 9728, 0, 255
.long 2820364, 9728, 0, 255
.long 2820364, 9728, 0, 255
.long 2820364, 9728, 0, 255
.long 2820364, 9728, 0, 255
.long 2820364, 9728, 0, 255
.long 2820364, 9728, 0, 255
.long 2820364, 9728, 0, 255
.long 2820364, 9728, 0, 255
.long 2820364, 9728, 0, 255
.long 2820364, 9728, 0, 255
.long 2820364, 9728, 0, 255
.long 2820364, 9728, 0, 255
.long 2820364, 9728, 0, 255
.long 2821389, 9728, 0, 255
.long 2821389, 9728, 0, 255
.long 2821389, 9728, 0, 255
.long 2821389, 9728, 0, 255
.long 2821389, 9728, 0, 255
.long 2821389, 9728, 0, 255
.long 2821389, 9728, 0, 255
.long 2821389, 9728, 0, 255
.long 2821389, 9728, 0, 255
.long 2821389, 9728, 0, 255
.long 2821389, 9728, 0, 255
.long 2821389, 9728, 0, 255
.long 2821389, 9728, 0, 255
.long 2821389, 9728, 0, 255
.long 2821389, 9728, 0, 255
.long 2821389, 9728, 0, 255
.long 2822414, 9728, 0, 255
.long 2822414, 9728, 0, 255
.long 2822414, 9728, 0, 255
.long 2822414, 9728, 0, 255
.long 2822414, 9728, 0, 255
.long 2822414, 9728, 0, 255
.long 2822414, 9728, 0, 255
.long 2822414, 9728, 0, 255
.long 2822414, 9728, 0, 255
.long 2822414, 9728, 0, 255
.long 2822414, 9728, 0, 255
.long 2822414, 9728, 0, 255
.long 2822414, 9728, 0, 255
.long 2822414, 9728, 0, 255
.long 2822414, 9728, 0, 255
.long 2822414, 9728, 0, 255
.long 2888719, 9984, 0, 255
.long 2888719, 9984, 0, 255
.long 2888719, 9984, 0, 255
.long 2888719, 9984, 0, 255
.long 2888719, 9984, 0, 255
.long 2888719, 9984, 0, 255
.long 2888719, 9984, 0, 255
.long 2888719, 9984, 0, 255
.long 2888719, 9984, 0, 255
.long 2888719, 9984, 0, 255
.long 2888719, 9984, 0, 255
.long 2888719, 9984, 0, 255
.long 2888719, 9984, 0, 255
.long 2888719, 9984, 0, 255
.long 2888719, 9984, 0, 255
.long 2888719, 9984, 0, 255
.short 2048, 2112, 2176, 2240, 2304, 2049, 2113, 2177, 2241, 2305, 2050, 2114, 2178, 2242, 2306, 2051
.short 2115, 2179, 2243, 2307, 2052, 2116, 2180, 2244, 2308, 2053, 2117, 2181, 2245, 2309, 2054, 2118
.short 1344, 1376, 1408, 1440, 1345, 1377, 1409, 1441, 1346, 1378, 1410, 1442, 1347, 1379, 1411, 1443
.short 1348, 1380, 1412, 1444, 1349, 1381, 1413, 1445, 1158, 1190, 1222, 1254, 1286, 1318, 1350, 1382
.short 1414, 1446, 1031, 1063, 1032, 1064, 1033, 1065, 1034, 1066, 1035, 1067, 1036, 1068, 1037, 1069
.short 1038, 1070, 1039, 1071, 1095, 1127, 1096, 1128, 1097, 1129, 1098, 1130, 1099, 1131, 1100, 1132
.short 1101, 1133, 1102, 1134, 1103, 1135, 1159, 1191, 1160, 1192, 1161, 1193, 1162, 1194, 1163, 1195
.short 1164, 1196, 1165, 1197, 1166, 1198, 1167, 1199, 1223, 1255, 1224, 1256, 1225, 1257, 1226, 1258
.short 1227, 1259, 1228, 1260, 1229, 1261, 1230, 1262, 1231, 1263, 1287, 1319, 1288, 1320, 777, 793
.short 809, 825, 778, 794, 810, 826, 779, 795, 811, 827, 780, 796, 812, 828, 781, 797
.short 813, 829, 782, 798, 814, 830, 783, 799, 815, 831, 839, 855, 871, 887, 840, 856
.short 872, 888, 841, 857, 873, 889, 842, 858, 874, 890, 843, 859, 875, 891, 844, 860
.short 876, 892, 845, 861, 877, 893, 846, 862, 878, 894, 847, 863, 879, 895, 903, 919
.short 935, 951, 904, 920, 936, 952, 905, 921, 937, 953, 906, 922, 938, 954, 907, 923
.short 939, 955, 908, 924, 940, 956, 909, 925, 941, 957, 910, 926, 942, 958, 911, 927
.short 943, 959, 0, 0, 0, 0, 0, 0, 0, 0, 0, 0, 0, 0, 0, 0
.size kf_kernel_tab, 4608

L_text_end:
.section .rodata,"a"
.p2align 6
.amdhsa_kernel kf_kernel
  .amdhsa_next_free_vgpr 512
  .amdhsa_next_free_sgpr 102
  .amdhsa_accum_offset 256
  .amdhsa_group_segment_fixed_size 0
  .amdhsa_kernarg_size 112
  .amdhsa_user_sgpr_count 2
  .amdhsa_user_sgpr_kernarg_segment_ptr 1
  .amdhsa_system_sgpr_workgroup_id_x 1
.end_amdhsa_kernel
```
